```python
import torch

def _softmax(x, axis=-1):
    return torch.softmax(x, dim=axis)
def _gelu(x):
    return torch.nn.functional.gelu(x, approximate="tanh")
def _silu(x):
    return torch.nn.functional.silu(x)
def _sigmoid(x):
    return torch.sigmoid(x)
def _layernorm(x, axis=-1, eps=1e-5):
    m = x.mean(dim=axis, keepdim=True)
    v = x.var(dim=axis, keepdim=True, unbiased=False)
    return (x - m) / torch.sqrt(v + eps)
def _scatter_add(tgt, idx, src, axis=0):
    return tgt.clone().index_add_(axis, idx, src)
def _segment_sum(src, seg, n):
    out = torch.zeros((n,) + src.shape[1:], dtype=src.dtype)
    return out.index_add_(0, seg, src)
def _pad(x, pw):
    flat = tuple(v for pair in reversed(pw) for v in pair)
    return torch.nn.functional.pad(x, flat)

kernel_name = 'concat_heads__linear_attn_block__ssm_conv_h3__prompt'

def setup_inputs():

    _w = (lambda a: (lambda t: t.to(torch.bfloat16) if t.is_floating_point() else t)(torch.as_tensor(a)))
    def _A_setup():
        B, S, D = 1, 2048, 1024
        return {
            "x": _w((lambda *s: torch.randn(*s, dtype=torch.bfloat16) * 0.05)(B, S, D)),
            "wqkv": _w((lambda *s: torch.randn(*s, dtype=torch.bfloat16) * 1.6)(D, 3 * D)),
            "wo": _w((lambda *s: torch.randn(*s, dtype=torch.bfloat16) * 0.1)(D, D)),
        }
    _A_in = _A_setup()

    def _B_setup():
        B, S, D = 1, 2048, 1024
        ks = 4
        return {
            "q": _w((lambda *s: torch.randn(*s, dtype=torch.bfloat16) * 0.05)(B, S, D)),
            "k": _w((lambda *s: torch.randn(*s, dtype=torch.bfloat16) * 0.8)(B, S, D)),
            "v": _w((lambda *s: torch.randn(*s, dtype=torch.bfloat16) * 0.4)(B, S, D)),
            "shift_k": _w((lambda *s: torch.randn(*s, dtype=torch.bfloat16) * 0.8)(D, ks) * 0.5),
            "ssm_k": _w((lambda *s: torch.randn(*s, dtype=torch.bfloat16) * 3.2)(D, S) * (1.0 / S ** 0.5)),
            "ssm_D": _w((lambda *s: torch.randn(*s, dtype=torch.bfloat16) * 0.8)(D)),
        }
    _B_in = _B_setup()

    return {
        "A_x": _A_in["x"],
        "A_wqkv": _A_in["wqkv"],
        "A_wo": _A_in["wo"],
        "B_q": _B_in["q"],
        "B_k": _B_in["k"],
        "B_v": _B_in["v"],
        "B_shift_k": _B_in["shift_k"],
        "B_ssm_k": _B_in["ssm_k"],
        "B_ssm_D": _B_in["ssm_D"],
    }

def reference(A_x, A_wqkv, A_wo, B_q, B_k, B_v, B_shift_k, B_ssm_k, B_ssm_D):
    def _A_ref(x, wqkv, wo):
        B, S, D = x.shape
        H = 32; Dh = D // H
        qkv = (lambda x, *d: x.permute(*d))((x @ wqkv).reshape(B, S, 3, H, Dh), 2, 0, 3, 1, 4)
        q, k, v = qkv[0], qkv[1], qkv[2]
        phi = lambda t: torch.where(t > 0, t + 1, torch.exp(t)) + 1e-6
        pq, pk = phi(q), phi(k)
        kv = torch.einsum("bhsd,bhse->bhde", pk, v)
        z = torch.einsum("bhsd->bhd", pk)
        num = torch.einsum("bhqd,bhde->bhqe", pq, kv)
        den = torch.einsum("bhqd,bhd->bhq", pq, z)[..., None] + 1e-6
        o = num / den
        return (lambda x, *d: x.permute(*d))(o, 0, 2, 1, 3).reshape(B, S, D) @ wo

    def _B_ref(q, k, v, shift_k, ssm_k, ssm_D):
        B, S, D = q.shape
        ks = shift_k.shape[-1]
        k_pad = _pad(k, ((0, 0), (ks - 1, 0), (0, 0)))
        k_shift = torch.zeros_like(k)
        for t in range(ks):
            k_shift = k_shift + k_pad[:, t:t + S, :] * shift_k[:, ks - 1 - t][None, None, :]
        kv = k_shift * v
        L = 2 * S
        kv_pad = _pad(kv, ((0, 0), (0, S), (0, 0)))
        kf_pad = _pad(ssm_k, ((0, 0), (0, S)))
        kv_f = (lambda x, axes=(-2,-1): torch.fft.rfft2(x.float(), dim=axes))(kv_pad[:, None, :, :], axes=(1, 2))
        kf_f = (lambda x, axes=(-2,-1): torch.fft.rfft2(x.float(), dim=axes))(kf_pad[:, None, :], axes=(1, 2))
        kf_f = (lambda x, *d: x.permute(*d))(kf_f, 1, 2, 0)
        y_f = kv_f * kf_f[None, :, :, :]
        y = (lambda x, s, axes=(-2,-1): torch.fft.irfft2(x, s=s, dim=axes).to(torch.bfloat16))(y_f, (1, L), axes=(1, 2))[:, 0, :S, :]
        y = y + kv * ssm_D[None, None, :]
        return q * y

    a = _A_ref(A_x, A_wqkv, A_wo)
    b = _B_ref(B_q, B_k, B_v, B_shift_k, B_ssm_k, B_ssm_D)
    return torch.concatenate([a, b], axis=-1)
```

```asm
; @launch kernel=k1_kernel grid=(256,1,1) block=(640,1,1) lds=122880
; @launch kernel=k2_kernel grid=(256,1,1) block=(512,1,1) lds=150528
.amdgcn_target "amdgcn-amd-amdhsa--gfx950"
.text
.globl k1_kernel
.p2align 8
.type k1_kernel,@function
k1_kernel:
    s_cmp_ge_u32 s2, 256
    s_cbranch_scc1 K1_END
    s_load_dwordx4 s[4:7], s[0:1], 0
    s_load_dwordx2 s[8:9], s[0:1], 88
    s_load_dwordx4 s[40:43], s[0:1], 32
    s_load_dwordx2 s[44:45], s[0:1], 48
    v_lshrrev_b32 v1, 6, v0
    v_and_b32 v0, 63, v0
    s_and_b32 s10, s2, 7
    s_lshr_b32 s11, s2, 3
    v_readfirstlane_b32 s3, v1
    s_and_b32 s12, s10, 1
    s_lshl_b32 s12, s12, 3
    s_and_b32 s13, s11, 7
    s_add_u32 s12, s12, s13
    s_lshr_b32 s13, s10, 1
    s_lshl_b32 s13, s13, 2
    s_lshr_b32 s14, s11, 3
    s_add_u32 s13, s13, s14
    s_cmp_ge_u32 s3, 8
    s_cbranch_scc1 K1_PRE
    s_cmp_ge_u32 s3, 4
    s_cbranch_scc1 K1_HELP
    s_lshr_b32 s15, s3, 1
    s_and_b32 s16, s3, 1
    v_and_b32 v7, 31, v0
    v_lshrrev_b32 v8, 5, v0
    v_lshrrev_b32 v9, 1, v7
    v_and_b32 v9, 7, v9
    v_xor_b32 v9, v9, v8
    v_lshlrev_b32 v9, 4, v9
    s_lshl_b32 s17, s15, 13
    v_lshlrev_b32 v10, 7, v7
    v_add3_u32 v2, v10, v9, s17
    v_xor_b32 v3, 32, v2
    v_xor_b32 v4, 64, v2
    v_xor_b32 v5, 96, v2
    v_bfe_u32 v7, v0, 2, 2
    v_lshrrev_b32 v8, 5, v0
    v_lshl_add_u32 v9, v8, 3, v7
    v_lshlrev_b32 v9, 7, v9
    v_bfe_u32 v10, v0, 4, 1
    v_lshlrev_b32 v10, 5, v10
    v_and_b32 v11, 3, v0
    v_lshl_add_u32 v10, v11, 3, v10
    v_bfe_u32 v11, v0, 3, 1
    v_xor_b32 v11, s16, v11
    v_lshl_add_u32 v10, v11, 6, v10
    v_add_u32 v9, v9, v10
    v_add_u32 v6, 16384, v9
    s_mov_b32 s18, 0x358637bd
    v_mov_b32 v64, s18
    v_mov_b32 v65, s18
    v_mov_b32 v66, s18
    v_mov_b32 v67, s18
    v_mov_b32 v68, s18
    v_mov_b32 v69, s18
    v_mov_b32 v70, s18
    v_mov_b32 v71, s18
    v_mov_b32 v72, s18
    v_mov_b32 v73, s18
    v_mov_b32 v74, s18
    v_mov_b32 v75, s18
    v_mov_b32 v76, s18
    v_mov_b32 v77, s18
    v_mov_b32 v78, s18
    v_mov_b32 v79, s18
    v_mov_b32 v80, s18
    v_mov_b32 v81, s18
    v_mov_b32 v82, s18
    v_mov_b32 v83, s18
    v_mov_b32 v84, s18
    v_mov_b32 v85, s18
    v_mov_b32 v86, s18
    v_mov_b32 v87, s18
    v_mov_b32 v88, s18
    v_mov_b32 v89, s18
    v_mov_b32 v90, s18
    v_mov_b32 v91, s18
    v_mov_b32 v92, s18
    v_mov_b32 v93, s18
    v_mov_b32 v94, s18
    v_mov_b32 v95, s18
    v_mov_b32 v96, s18
    v_mov_b32 v97, s18
    v_mov_b32 v98, s18
    v_mov_b32 v99, s18
    v_mov_b32 v100, s18
    v_mov_b32 v101, s18
    v_mov_b32 v102, s18
    v_mov_b32 v103, s18
    v_mov_b32 v104, s18
    v_mov_b32 v105, s18
    v_mov_b32 v106, s18
    v_mov_b32 v107, s18
    v_mov_b32 v108, s18
    v_mov_b32 v109, s18
    v_mov_b32 v110, s18
    v_mov_b32 v111, s18
    v_mov_b32 v112, s18
    v_mov_b32 v113, s18
    v_mov_b32 v114, s18
    v_mov_b32 v115, s18
    v_mov_b32 v116, s18
    v_mov_b32 v117, s18
    v_mov_b32 v118, s18
    v_mov_b32 v119, s18
    v_mov_b32 v120, s18
    v_mov_b32 v121, s18
    v_mov_b32 v122, s18
    v_mov_b32 v123, s18
    v_mov_b32 v124, s18
    v_mov_b32 v125, s18
    v_mov_b32 v126, s18
    v_mov_b32 v127, s18
    v_mov_b32 v128, 0
    v_mov_b32 v129, 0
    v_mov_b32 v130, 0
    v_mov_b32 v131, 0
    v_mov_b32 v132, 0
    v_mov_b32 v133, 0
    v_mov_b32 v134, 0
    v_mov_b32 v135, 0
    v_mov_b32 v136, 0
    v_mov_b32 v137, 0
    v_mov_b32 v138, 0
    v_mov_b32 v139, 0
    v_mov_b32 v140, 0
    v_mov_b32 v141, 0
    v_mov_b32 v142, 0
    v_mov_b32 v143, 0
    v_mov_b32 v144, 0
    v_mov_b32 v145, 0
    v_mov_b32 v146, 0
    v_mov_b32 v147, 0
    v_mov_b32 v148, 0
    v_mov_b32 v149, 0
    v_mov_b32 v150, 0
    v_mov_b32 v151, 0
    v_mov_b32 v152, 0
    v_mov_b32 v153, 0
    v_mov_b32 v154, 0
    v_mov_b32 v155, 0
    v_mov_b32 v156, 0
    v_mov_b32 v157, 0
    v_mov_b32 v158, 0
    v_mov_b32 v159, 0
    s_mov_b32 s19, 0
    s_mov_b32 s20, 0
    s_mov_b32 s22, 0xfffec000
    s_mov_b32 s23, 40960
    s_barrier
    ds_read_b128 v[16:19], v2
    ds_read_b64_tr_b16 v[28:29], v6 offset:8192
    ds_read_b64_tr_b16 v[30:31], v6 offset:8704
    ds_read_b128 v[20:23], v2 offset:4096
    ds_read_b64_tr_b16 v[32:33], v6 offset:16384
    ds_read_b64_tr_b16 v[34:35], v6 offset:16896
    ds_read_b64_tr_b16 v[24:25], v6 offset:0
    ds_read_b64_tr_b16 v[26:27], v6 offset:512
.p2align 6
K1_LOOP:
    s_waitcnt lgkmcnt(0)
    v_mfma_f32_32x32x16_bf16 v[96:111], v[16:19], v[28:31], v[96:111]
    ds_read_b128 v[36:39], v3
    ds_read_b64_tr_b16 v[48:49], v6 offset:10240
    v_mfma_f32_32x32x16_bf16 v[112:127], v[20:23], v[28:31], v[112:127]
    ds_read_b64_tr_b16 v[50:51], v6 offset:10752
    ds_read_b128 v[40:43], v3 offset:4096
    v_mfma_f32_32x32x16_bf16 v[128:143], v[16:19], v[32:35], v[128:143]
    ds_read_b64_tr_b16 v[52:53], v6 offset:18432
    ds_read_b64_tr_b16 v[54:55], v6 offset:18944
    v_mfma_f32_32x32x16_bf16 v[144:159], v[20:23], v[32:35], v[144:159]
    ds_read_b64_tr_b16 v[44:45], v6 offset:2048
    ds_read_b64_tr_b16 v[46:47], v6 offset:2560
    v_mfma_f32_32x32x16_bf16 v[64:79], v[24:27], v[16:19], v[64:79]
    v_mfma_f32_32x32x16_bf16 v[80:95], v[24:27], v[20:23], v[80:95]
    s_waitcnt lgkmcnt(0)
    v_mfma_f32_32x32x16_bf16 v[96:111], v[36:39], v[48:51], v[96:111]
    ds_read_b128 v[16:19], v4
    ds_read_b64_tr_b16 v[28:29], v6 offset:12288
    v_mfma_f32_32x32x16_bf16 v[112:127], v[40:43], v[48:51], v[112:127]
    ds_read_b64_tr_b16 v[30:31], v6 offset:12800
    ds_read_b128 v[20:23], v4 offset:4096
    v_mfma_f32_32x32x16_bf16 v[128:143], v[36:39], v[52:55], v[128:143]
    ds_read_b64_tr_b16 v[32:33], v6 offset:20480
    ds_read_b64_tr_b16 v[34:35], v6 offset:20992
    v_mfma_f32_32x32x16_bf16 v[144:159], v[40:43], v[52:55], v[144:159]
    ds_read_b64_tr_b16 v[24:25], v6 offset:4096
    ds_read_b64_tr_b16 v[26:27], v6 offset:4608
    v_mfma_f32_32x32x16_bf16 v[64:79], v[44:47], v[36:39], v[64:79]
    v_mfma_f32_32x32x16_bf16 v[80:95], v[44:47], v[40:43], v[80:95]
    s_waitcnt lgkmcnt(0)
    v_mfma_f32_32x32x16_bf16 v[96:111], v[16:19], v[28:31], v[96:111]
    ds_read_b128 v[36:39], v5
    ds_read_b64_tr_b16 v[48:49], v6 offset:14336
    v_mfma_f32_32x32x16_bf16 v[112:127], v[20:23], v[28:31], v[112:127]
    ds_read_b64_tr_b16 v[50:51], v6 offset:14848
    ds_read_b128 v[40:43], v5 offset:4096
    v_mfma_f32_32x32x16_bf16 v[128:143], v[16:19], v[32:35], v[128:143]
    ds_read_b64_tr_b16 v[52:53], v6 offset:22528
    ds_read_b64_tr_b16 v[54:55], v6 offset:23040
    v_mfma_f32_32x32x16_bf16 v[144:159], v[20:23], v[32:35], v[144:159]
    ds_read_b64_tr_b16 v[44:45], v6 offset:6144
    ds_read_b64_tr_b16 v[46:47], v6 offset:6656
    v_mfma_f32_32x32x16_bf16 v[64:79], v[24:27], v[16:19], v[64:79]
    v_mfma_f32_32x32x16_bf16 v[80:95], v[24:27], v[20:23], v[80:95]
    s_waitcnt lgkmcnt(0)
    v_mfma_f32_32x32x16_bf16 v[96:111], v[36:39], v[48:51], v[96:111]
    s_add_u32 s20, s20, 1
    s_cmp_eq_u32 s20, 3
    s_cselect_b32 s21, s22, s23
    s_cselect_b32 s20, 0, s20
    s_barrier
    v_mfma_f32_32x32x16_bf16 v[112:127], v[40:43], v[48:51], v[112:127]
    v_add_u32 v2, s21, v2
    v_add_u32 v6, s21, v6
    ds_read_b128 v[16:19], v2
    ds_read_b64_tr_b16 v[28:29], v6 offset:8192
    v_mfma_f32_32x32x16_bf16 v[128:143], v[36:39], v[52:55], v[128:143]
    ds_read_b64_tr_b16 v[30:31], v6 offset:8704
    ds_read_b128 v[20:23], v2 offset:4096
    ds_read_b64_tr_b16 v[32:33], v6 offset:16384
    v_mfma_f32_32x32x16_bf16 v[144:159], v[40:43], v[52:55], v[144:159]
    ds_read_b64_tr_b16 v[34:35], v6 offset:16896
    ds_read_b64_tr_b16 v[24:25], v6 offset:0
    ds_read_b64_tr_b16 v[26:27], v6 offset:512
    v_mfma_f32_32x32x16_bf16 v[64:79], v[44:47], v[36:39], v[64:79]
    v_add_u32 v3, s21, v3
    v_add_u32 v4, s21, v4
    v_add_u32 v5, s21, v5
    s_add_u32 s19, s19, 1
    s_cmp_lt_u32 s19, 16
    v_mfma_f32_32x32x16_bf16 v[80:95], v[44:47], v[40:43], v[80:95]
    s_cbranch_scc1 K1_LOOP
    s_waitcnt lgkmcnt(0)
    s_mov_b32 s24, s8
    s_mov_b32 s25, s9
    s_mov_b32 s26, 0x10000000
    s_mov_b32 s27, 0x00020000
    s_mov_b32 s28, 0x3fb8aa3b
    v_mul_f32 v8, s28, v96
    v_mul_f32 v9, s28, v97
    v_mul_f32 v10, s28, v98
    v_mul_f32 v11, s28, v99
    v_exp_f32 v8, v8 clamp
    v_exp_f32 v9, v9 clamp
    v_exp_f32 v10, v10 clamp
    v_exp_f32 v11, v11 clamp
    v_max_f32 v12, s18, v96
    v_max_f32 v13, s18, v97
    v_max_f32 v14, s18, v98
    v_max_f32 v15, s18, v99
    v_add_f32 v8, v8, v12
    v_add_f32 v9, v9, v13
    v_add_f32 v10, v10, v14
    v_add_f32 v11, v11, v15
    v_cvt_pk_bf16_f32 v16, v8, v9
    v_cvt_pk_bf16_f32 v17, v10, v11
    v_mul_f32 v8, s28, v100
    v_mul_f32 v9, s28, v101
    v_mul_f32 v10, s28, v102
    v_mul_f32 v11, s28, v103
    v_exp_f32 v8, v8 clamp
    v_exp_f32 v9, v9 clamp
    v_exp_f32 v10, v10 clamp
    v_exp_f32 v11, v11 clamp
    v_max_f32 v12, s18, v100
    v_max_f32 v13, s18, v101
    v_max_f32 v14, s18, v102
    v_max_f32 v15, s18, v103
    v_add_f32 v8, v8, v12
    v_add_f32 v9, v9, v13
    v_add_f32 v10, v10, v14
    v_add_f32 v11, v11, v15
    v_cvt_pk_bf16_f32 v18, v8, v9
    v_cvt_pk_bf16_f32 v19, v10, v11
    v_mul_f32 v8, s28, v104
    v_mul_f32 v9, s28, v105
    v_mul_f32 v10, s28, v106
    v_mul_f32 v11, s28, v107
    v_exp_f32 v8, v8 clamp
    v_exp_f32 v9, v9 clamp
    v_exp_f32 v10, v10 clamp
    v_exp_f32 v11, v11 clamp
    v_max_f32 v12, s18, v104
    v_max_f32 v13, s18, v105
    v_max_f32 v14, s18, v106
    v_max_f32 v15, s18, v107
    v_add_f32 v8, v8, v12
    v_add_f32 v9, v9, v13
    v_add_f32 v10, v10, v14
    v_add_f32 v11, v11, v15
    v_cvt_pk_bf16_f32 v20, v8, v9
    v_cvt_pk_bf16_f32 v21, v10, v11
    v_mul_f32 v8, s28, v108
    v_mul_f32 v9, s28, v109
    v_mul_f32 v10, s28, v110
    v_mul_f32 v11, s28, v111
    v_exp_f32 v8, v8 clamp
    v_exp_f32 v9, v9 clamp
    v_exp_f32 v10, v10 clamp
    v_exp_f32 v11, v11 clamp
    v_max_f32 v12, s18, v108
    v_max_f32 v13, s18, v109
    v_max_f32 v14, s18, v110
    v_max_f32 v15, s18, v111
    v_add_f32 v8, v8, v12
    v_add_f32 v9, v9, v13
    v_add_f32 v10, v10, v14
    v_add_f32 v11, v11, v15
    v_cvt_pk_bf16_f32 v22, v8, v9
    v_cvt_pk_bf16_f32 v23, v10, v11
    v_mul_f32 v8, s28, v112
    v_mul_f32 v9, s28, v113
    v_mul_f32 v10, s28, v114
    v_mul_f32 v11, s28, v115
    v_exp_f32 v8, v8 clamp
    v_exp_f32 v9, v9 clamp
    v_exp_f32 v10, v10 clamp
    v_exp_f32 v11, v11 clamp
    v_max_f32 v12, s18, v112
    v_max_f32 v13, s18, v113
    v_max_f32 v14, s18, v114
    v_max_f32 v15, s18, v115
    v_add_f32 v8, v8, v12
    v_add_f32 v9, v9, v13
    v_add_f32 v10, v10, v14
    v_add_f32 v11, v11, v15
    v_cvt_pk_bf16_f32 v24, v8, v9
    v_cvt_pk_bf16_f32 v25, v10, v11
    v_mul_f32 v8, s28, v116
    v_mul_f32 v9, s28, v117
    v_mul_f32 v10, s28, v118
    v_mul_f32 v11, s28, v119
    v_exp_f32 v8, v8 clamp
    v_exp_f32 v9, v9 clamp
    v_exp_f32 v10, v10 clamp
    v_exp_f32 v11, v11 clamp
    v_max_f32 v12, s18, v116
    v_max_f32 v13, s18, v117
    v_max_f32 v14, s18, v118
    v_max_f32 v15, s18, v119
    v_add_f32 v8, v8, v12
    v_add_f32 v9, v9, v13
    v_add_f32 v10, v10, v14
    v_add_f32 v11, v11, v15
    v_cvt_pk_bf16_f32 v26, v8, v9
    v_cvt_pk_bf16_f32 v27, v10, v11
    v_mul_f32 v8, s28, v120
    v_mul_f32 v9, s28, v121
    v_mul_f32 v10, s28, v122
    v_mul_f32 v11, s28, v123
    v_exp_f32 v8, v8 clamp
    v_exp_f32 v9, v9 clamp
    v_exp_f32 v10, v10 clamp
    v_exp_f32 v11, v11 clamp
    v_max_f32 v12, s18, v120
    v_max_f32 v13, s18, v121
    v_max_f32 v14, s18, v122
    v_max_f32 v15, s18, v123
    v_add_f32 v8, v8, v12
    v_add_f32 v9, v9, v13
    v_add_f32 v10, v10, v14
    v_add_f32 v11, v11, v15
    v_cvt_pk_bf16_f32 v28, v8, v9
    v_cvt_pk_bf16_f32 v29, v10, v11
    v_mul_f32 v8, s28, v124
    v_mul_f32 v9, s28, v125
    v_mul_f32 v10, s28, v126
    v_mul_f32 v11, s28, v127
    v_exp_f32 v8, v8 clamp
    v_exp_f32 v9, v9 clamp
    v_exp_f32 v10, v10 clamp
    v_exp_f32 v11, v11 clamp
    v_max_f32 v12, s18, v124
    v_max_f32 v13, s18, v125
    v_max_f32 v14, s18, v126
    v_max_f32 v15, s18, v127
    v_add_f32 v8, v8, v12
    v_add_f32 v9, v9, v13
    v_add_f32 v10, v10, v14
    v_add_f32 v11, v11, v15
    v_cvt_pk_bf16_f32 v30, v8, v9
    v_cvt_pk_bf16_f32 v31, v10, v11
    v_cvt_pk_bf16_f32 v32, v128, v129
    v_cvt_pk_bf16_f32 v33, v130, v131
    v_cvt_pk_bf16_f32 v34, v132, v133
    v_cvt_pk_bf16_f32 v35, v134, v135
    v_cvt_pk_bf16_f32 v36, v136, v137
    v_cvt_pk_bf16_f32 v37, v138, v139
    v_cvt_pk_bf16_f32 v38, v140, v141
    v_cvt_pk_bf16_f32 v39, v142, v143
    v_cvt_pk_bf16_f32 v40, v144, v145
    v_cvt_pk_bf16_f32 v41, v146, v147
    v_cvt_pk_bf16_f32 v42, v148, v149
    v_cvt_pk_bf16_f32 v43, v150, v151
    v_cvt_pk_bf16_f32 v44, v152, v153
    v_cvt_pk_bf16_f32 v45, v154, v155
    v_cvt_pk_bf16_f32 v46, v156, v157
    v_cvt_pk_bf16_f32 v47, v158, v159
    s_mov_b32 s29, 0x3f803f80
    v_mov_b32 v160, s29
    v_mov_b32 v161, s29
    v_mov_b32 v162, s29
    v_mov_b32 v163, s29
    v_mfma_f32_32x32x16_bf16 v[96:111], v[16:19], v[32:35], 0
    s_nop 0
    v_mfma_f32_32x32x16_bf16 v[112:127], v[16:19], v[160:163], 0
    v_mfma_f32_32x32x16_bf16 v[96:111], v[20:23], v[36:39], v[96:111]
    v_mfma_f32_32x32x16_bf16 v[112:127], v[20:23], v[160:163], v[112:127]
    v_mfma_f32_32x32x16_bf16 v[96:111], v[24:27], v[40:43], v[96:111]
    v_mfma_f32_32x32x16_bf16 v[112:127], v[24:27], v[160:163], v[112:127]
    v_mfma_f32_32x32x16_bf16 v[96:111], v[28:31], v[44:47], v[96:111]
    v_mfma_f32_32x32x16_bf16 v[112:127], v[28:31], v[160:163], v[112:127]
    v_mul_f32 v8, s28, v64
    v_mul_f32 v9, s28, v65
    v_mul_f32 v10, s28, v66
    v_mul_f32 v11, s28, v67
    v_exp_f32 v8, v8 clamp
    v_exp_f32 v9, v9 clamp
    v_exp_f32 v10, v10 clamp
    v_exp_f32 v11, v11 clamp
    v_max_f32 v12, s18, v64
    v_max_f32 v13, s18, v65
    v_max_f32 v14, s18, v66
    v_max_f32 v15, s18, v67
    v_add_f32 v8, v8, v12
    v_add_f32 v9, v9, v13
    v_add_f32 v10, v10, v14
    v_add_f32 v11, v11, v15
    v_cvt_pk_bf16_f32 v48, v8, v9
    v_cvt_pk_bf16_f32 v49, v10, v11
    v_mul_f32 v8, s28, v68
    v_mul_f32 v9, s28, v69
    v_mul_f32 v10, s28, v70
    v_mul_f32 v11, s28, v71
    v_exp_f32 v8, v8 clamp
    v_exp_f32 v9, v9 clamp
    v_exp_f32 v10, v10 clamp
    v_exp_f32 v11, v11 clamp
    v_max_f32 v12, s18, v68
    v_max_f32 v13, s18, v69
    v_max_f32 v14, s18, v70
    v_max_f32 v15, s18, v71
    v_add_f32 v8, v8, v12
    v_add_f32 v9, v9, v13
    v_add_f32 v10, v10, v14
    v_add_f32 v11, v11, v15
    v_cvt_pk_bf16_f32 v50, v8, v9
    v_cvt_pk_bf16_f32 v51, v10, v11
    v_mul_f32 v8, s28, v72
    v_mul_f32 v9, s28, v73
    v_mul_f32 v10, s28, v74
    v_mul_f32 v11, s28, v75
    v_exp_f32 v8, v8 clamp
    v_exp_f32 v9, v9 clamp
    v_exp_f32 v10, v10 clamp
    v_exp_f32 v11, v11 clamp
    v_max_f32 v12, s18, v72
    v_max_f32 v13, s18, v73
    v_max_f32 v14, s18, v74
    v_max_f32 v15, s18, v75
    v_add_f32 v8, v8, v12
    v_add_f32 v9, v9, v13
    v_add_f32 v10, v10, v14
    v_add_f32 v11, v11, v15
    v_cvt_pk_bf16_f32 v52, v8, v9
    v_cvt_pk_bf16_f32 v53, v10, v11
    v_mul_f32 v8, s28, v76
    v_mul_f32 v9, s28, v77
    v_mul_f32 v10, s28, v78
    v_mul_f32 v11, s28, v79
    v_exp_f32 v8, v8 clamp
    v_exp_f32 v9, v9 clamp
    v_exp_f32 v10, v10 clamp
    v_exp_f32 v11, v11 clamp
    v_max_f32 v12, s18, v76
    v_max_f32 v13, s18, v77
    v_max_f32 v14, s18, v78
    v_max_f32 v15, s18, v79
    v_add_f32 v8, v8, v12
    v_add_f32 v9, v9, v13
    v_add_f32 v10, v10, v14
    v_add_f32 v11, v11, v15
    v_cvt_pk_bf16_f32 v54, v8, v9
    v_cvt_pk_bf16_f32 v55, v10, v11
    v_mul_f32 v8, s28, v80
    v_mul_f32 v9, s28, v81
    v_mul_f32 v10, s28, v82
    v_mul_f32 v11, s28, v83
    v_exp_f32 v8, v8 clamp
    v_exp_f32 v9, v9 clamp
    v_exp_f32 v10, v10 clamp
    v_exp_f32 v11, v11 clamp
    v_max_f32 v12, s18, v80
    v_max_f32 v13, s18, v81
    v_max_f32 v14, s18, v82
    v_max_f32 v15, s18, v83
    v_add_f32 v8, v8, v12
    v_add_f32 v9, v9, v13
    v_add_f32 v10, v10, v14
    v_add_f32 v11, v11, v15
    v_cvt_pk_bf16_f32 v56, v8, v9
    v_cvt_pk_bf16_f32 v57, v10, v11
    v_mul_f32 v8, s28, v84
    v_mul_f32 v9, s28, v85
    v_mul_f32 v10, s28, v86
    v_mul_f32 v11, s28, v87
    v_exp_f32 v8, v8 clamp
    v_exp_f32 v9, v9 clamp
    v_exp_f32 v10, v10 clamp
    v_exp_f32 v11, v11 clamp
    v_max_f32 v12, s18, v84
    v_max_f32 v13, s18, v85
    v_max_f32 v14, s18, v86
    v_max_f32 v15, s18, v87
    v_add_f32 v8, v8, v12
    v_add_f32 v9, v9, v13
    v_add_f32 v10, v10, v14
    v_add_f32 v11, v11, v15
    v_cvt_pk_bf16_f32 v58, v8, v9
    v_cvt_pk_bf16_f32 v59, v10, v11
    v_mul_f32 v8, s28, v88
    v_mul_f32 v9, s28, v89
    v_mul_f32 v10, s28, v90
    v_mul_f32 v11, s28, v91
    v_exp_f32 v8, v8 clamp
    v_exp_f32 v9, v9 clamp
    v_exp_f32 v10, v10 clamp
    v_exp_f32 v11, v11 clamp
    v_max_f32 v12, s18, v88
    v_max_f32 v13, s18, v89
    v_max_f32 v14, s18, v90
    v_max_f32 v15, s18, v91
    v_add_f32 v8, v8, v12
    v_add_f32 v9, v9, v13
    v_add_f32 v10, v10, v14
    v_add_f32 v11, v11, v15
    v_cvt_pk_bf16_f32 v60, v8, v9
    v_cvt_pk_bf16_f32 v61, v10, v11
    v_mul_f32 v8, s28, v92
    v_mul_f32 v9, s28, v93
    v_mul_f32 v10, s28, v94
    v_mul_f32 v11, s28, v95
    v_exp_f32 v8, v8 clamp
    v_exp_f32 v9, v9 clamp
    v_exp_f32 v10, v10 clamp
    v_exp_f32 v11, v11 clamp
    v_max_f32 v12, s18, v92
    v_max_f32 v13, s18, v93
    v_max_f32 v14, s18, v94
    v_max_f32 v15, s18, v95
    v_add_f32 v8, v8, v12
    v_add_f32 v9, v9, v13
    v_add_f32 v10, v10, v14
    v_add_f32 v11, v11, v15
    v_cvt_pk_bf16_f32 v62, v8, v9
    v_cvt_pk_bf16_f32 v63, v10, v11
    v_and_b32 v7, 15, v0
    v_lshlrev_b32 v7, 4, v7
    v_lshrrev_b32 v8, 5, v0
    v_lshl_add_u32 v7, v8, 8, v7
    v_bfe_u32 v8, v0, 4, 1
    v_lshl_add_u32 v9, v8, 15, v7
    v_lshl_add_u32 v10, v8, 11, v7
    s_lshl_b32 s30, s12, 3
    s_lshl_b32 s31, s15, 2
    s_add_u32 s30, s30, s31
    s_lshl_b32 s30, s30, 5
    s_lshl_b32 s31, s13, 1
    s_add_u32 s31, s31, s16
    s_add_u32 s30, s30, s31
    s_lshl_b32 s30, s30, 10
    s_add_u32 s32, s30, 65536
    buffer_store_dwordx4 v[48:51], v9, s[24:27], s30 offen offset:0
    buffer_store_dwordx4 v[52:55], v9, s[24:27], s30 offen offset:512
    buffer_store_dwordx4 v[56:59], v9, s[24:27], s32 offen offset:0
    buffer_store_dwordx4 v[60:63], v9, s[24:27], s32 offen offset:512
    v_lshlrev_b32 v11, 4, v0
    s_lshl_b32 s33, s3, 12
    v_add_u32 v12, s33, v11
    s_xor_b32 s33, s33, 8192
    v_add_u32 v13, s33, v11
    s_lshl_b32 s34, s31, 4
    s_add_u32 s34, s34, s12
    s_lshl_b32 s35, s34, 12
    s_add_u32 s35, s35, 4194304
    s_lshl_b32 s36, s15, 9
    s_add_u32 s35, s35, s36
    s_lshl_b32 s34, s34, 7
    s_add_u32 s34, s34, 6291456
    s_lshl_b32 s36, s15, 6
    s_add_u32 s34, s34, s36
    v_lshrrev_b32 v14, 5, v0
    v_lshlrev_b32 v14, 5, v14
    s_cmp_eq_u32 s15, 0
    s_cbranch_scc0 K1_EX1
    ds_write_b128 v12, v[104:107]
    ds_write_b128 v12, v[108:111] offset:1024
    ds_write_b128 v12, v[120:123] offset:2048
    ds_write_b128 v12, v[124:127] offset:3072
    s_waitcnt lgkmcnt(0)
    s_barrier
    ds_read_b128 v[16:19], v13
    ds_read_b128 v[20:23], v13 offset:1024
    ds_read_b128 v[24:27], v13 offset:2048
    ds_read_b128 v[28:31], v13 offset:3072
    s_waitcnt lgkmcnt(2)
    v_add_f32 v16, v16, v96
    v_add_f32 v17, v17, v97
    v_add_f32 v18, v18, v98
    v_add_f32 v19, v19, v99
    v_add_f32 v20, v20, v100
    v_add_f32 v21, v21, v101
    v_add_f32 v22, v22, v102
    v_add_f32 v23, v23, v103
    s_waitcnt lgkmcnt(0)
    v_add_f32 v24, v24, v112
    v_add_f32 v25, v25, v113
    v_add_f32 v26, v26, v114
    v_add_f32 v27, v27, v115
    v_add_f32 v28, v28, v116
    v_add_f32 v29, v29, v117
    v_add_f32 v30, v30, v118
    v_add_f32 v31, v31, v119
    s_branch K1_EX2
K1_EX1:
    ds_write_b128 v12, v[96:99]
    ds_write_b128 v12, v[100:103] offset:1024
    ds_write_b128 v12, v[112:115] offset:2048
    ds_write_b128 v12, v[116:119] offset:3072
    s_waitcnt lgkmcnt(0)
    s_barrier
    ds_read_b128 v[16:19], v13
    ds_read_b128 v[20:23], v13 offset:1024
    ds_read_b128 v[24:27], v13 offset:2048
    ds_read_b128 v[28:31], v13 offset:3072
    s_waitcnt lgkmcnt(2)
    v_add_f32 v16, v16, v104
    v_add_f32 v17, v17, v105
    v_add_f32 v18, v18, v106
    v_add_f32 v19, v19, v107
    v_add_f32 v20, v20, v108
    v_add_f32 v21, v21, v109
    v_add_f32 v22, v22, v110
    v_add_f32 v23, v23, v111
    s_waitcnt lgkmcnt(0)
    v_add_f32 v24, v24, v120
    v_add_f32 v25, v25, v121
    v_add_f32 v26, v26, v122
    v_add_f32 v27, v27, v123
    v_add_f32 v28, v28, v124
    v_add_f32 v29, v29, v125
    v_add_f32 v30, v30, v126
    v_add_f32 v31, v31, v127
K1_EX2:
    buffer_store_dwordx4 v[16:19], v10, s[24:27], s35 offen
    buffer_store_dwordx4 v[20:23], v10, s[24:27], s35 offen offset:1024
    s_mov_b32 exec_lo, 1
    s_mov_b32 exec_hi, 1
    buffer_store_dwordx4 v[24:27], v14, s[24:27], s34 offen
    buffer_store_dwordx4 v[28:31], v14, s[24:27], s34 offen offset:16
    s_endpgm
K1_HELP:
    s_sub_u32 s3, s3, 4
    s_waitcnt lgkmcnt(0)
    s_mov_b32 s16, s4
    s_mov_b32 s17, s5
    s_mov_b32 s18, 0x400000
    s_mov_b32 s19, 0x00020000
    s_mov_b32 s20, s6
    s_mov_b32 s21, s7
    s_mov_b32 s22, 0x600000
    s_mov_b32 s23, 0x00020000
    v_lshrrev_b32 v1, 3, v0
    s_lshl_b32 s15, s3, 3
    v_add_u32 v1, s15, v1
    v_and_b32 v2, 7, v0
    v_lshrrev_b32 v3, 4, v0
    s_and_b32 s15, s3, 1
    s_lshl_b32 s15, s15, 2
    v_add_u32 v4, s15, v3
    v_xor_b32 v4, v4, v2
    v_lshlrev_b32 v4, 4, v4
    v_lshl_add_u32 v10, v1, 11, v4
    v_and_b32 v3, 1, v3
    v_lshlrev_b32 v3, 2, v3
    v_xor_b32 v3, v3, v2
    v_lshlrev_b32 v3, 4, v3
    v_mul_u32_u24 v11, 6144, v1
    v_add_u32 v11, v11, v3
    s_lshl_b32 s24, s12, 18
    s_add_u32 s25, s24, 65536
    s_add_u32 s26, s24, 131072
    s_add_u32 s27, s24, 196608
    s_lshl_b32 s28, s13, 7
    s_add_u32 s29, s28, 196608
    s_add_u32 s30, s28, 2048
    s_add_u32 s31, s28, 198656
    s_add_u32 s32, s28, 4096
    s_add_u32 s33, s28, 200704
    s_lshl_b32 s34, s3, 10
    s_mov_b32 s35, 0
    s_mov_b32 s36, 393216
    s_mov_b32 s38, 0
K1_HPRO:
    s_add_u32 m0, s34, 0
    s_nop 0
    buffer_load_dwordx4 v10, s[16:19], s24 offen lds
    s_add_u32 m0, s34, 4096
    s_nop 0
    buffer_load_dwordx4 v10, s[16:19], s25 offen lds
    s_add_u32 m0, s34, 8192
    s_nop 0
    buffer_load_dwordx4 v10, s[16:19], s26 offen lds
    s_add_u32 m0, s34, 12288
    s_nop 0
    buffer_load_dwordx4 v10, s[16:19], s27 offen lds
    s_add_u32 m0, s34, 24576
    s_nop 0
    buffer_load_dwordx4 v11, s[20:23], s30 offen lds
    s_add_u32 m0, s34, 28672
    s_nop 0
    buffer_load_dwordx4 v11, s[20:23], s31 offen lds
    s_add_u32 m0, s34, 32768
    s_nop 0
    buffer_load_dwordx4 v11, s[20:23], s32 offen lds
    s_add_u32 m0, s34, 36864
    s_nop 0
    buffer_load_dwordx4 v11, s[20:23], s33 offen lds
    s_add_u32 m0, s34, 16384
    s_nop 0
    buffer_load_dwordx4 v11, s[20:23], s28 offen lds
    s_add_u32 m0, s34, 20480
    s_nop 0
    buffer_load_dwordx4 v11, s[20:23], s29 offen lds
    v_add_u32 v10, 128, v10
    v_add_u32 v11, s36, v11
    s_add_u32 s34, s34, 40960
    s_add_u32 s35, s35, 1
    s_cmp_eq_u32 s35, 3
    s_cselect_b32 s37, 122880, 0
    s_cselect_b32 s35, 0, s35
    s_sub_u32 s34, s34, s37
    s_add_u32 s38, s38, 1
    s_cmp_lt_u32 s38, 3
    s_cbranch_scc1 K1_HPRO
    s_waitcnt vmcnt(20)
    s_barrier
K1_HLOOP:
    s_waitcnt vmcnt(10)
    s_barrier
    s_add_u32 m0, s34, 0
    s_nop 0
    buffer_load_dwordx4 v10, s[16:19], s24 offen lds
    s_add_u32 m0, s34, 4096
    s_nop 0
    buffer_load_dwordx4 v10, s[16:19], s25 offen lds
    s_add_u32 m0, s34, 8192
    s_nop 0
    buffer_load_dwordx4 v10, s[16:19], s26 offen lds
    s_add_u32 m0, s34, 12288
    s_nop 0
    buffer_load_dwordx4 v10, s[16:19], s27 offen lds
    s_add_u32 m0, s34, 24576
    s_nop 0
    buffer_load_dwordx4 v11, s[20:23], s30 offen lds
    s_add_u32 m0, s34, 28672
    s_nop 0
    buffer_load_dwordx4 v11, s[20:23], s31 offen lds
    s_add_u32 m0, s34, 32768
    s_nop 0
    buffer_load_dwordx4 v11, s[20:23], s32 offen lds
    s_add_u32 m0, s34, 36864
    s_nop 0
    buffer_load_dwordx4 v11, s[20:23], s33 offen lds
    s_add_u32 m0, s34, 16384
    s_nop 0
    buffer_load_dwordx4 v11, s[20:23], s28 offen lds
    s_add_u32 m0, s34, 20480
    s_nop 0
    buffer_load_dwordx4 v11, s[20:23], s29 offen lds
    v_add_u32 v10, 128, v10
    v_add_u32 v11, s36, v11
    s_add_u32 s34, s34, 40960
    s_add_u32 s35, s35, 1
    s_cmp_eq_u32 s35, 3
    s_cselect_b32 s37, 122880, 0
    s_cselect_b32 s35, 0, s35
    s_sub_u32 s34, s34, s37
    s_add_u32 s38, s38, 1
    s_cmp_lt_u32 s38, 16
    s_cbranch_scc1 K1_HLOOP
    s_waitcnt vmcnt(10)
    s_barrier
    s_waitcnt vmcnt(0)
    s_barrier
    s_endpgm
K1_PRE:
    s_sub_u32 s3, s3, 8
    s_waitcnt lgkmcnt(0)
    s_mov_b32 s16, s40
    s_mov_b32 s17, s41
    s_mov_b32 s18, 0x400000
    s_mov_b32 s19, 0x00020000
    s_mov_b32 s20, s42
    s_mov_b32 s21, s43
    s_mov_b32 s22, 0x400000
    s_mov_b32 s23, 0x00020000
    s_mov_b32 s24, s44
    s_mov_b32 s25, s45
    s_mov_b32 s26, 0x2000
    s_mov_b32 s27, 0x00020000
    s_mov_b32 s28, s8
    s_mov_b32 s29, s9
    s_mov_b32 s30, 0x10000000
    s_mov_b32 s31, 0x00020000
    s_lshr_b32 s12, s2, 4
    s_and_b32 s13, s2, 15
    s_lshl_b32 s13, s13, 6
    s_lshl_b32 s14, s3, 5
    s_add_u32 s13, s13, s14
    v_and_b32 v1, 7, v0
    v_lshlrev_b32 v1, 2, v1
    v_add_u32 v1, s13, v1
    v_lshrrev_b32 v2, 3, v0
    s_lshl_b32 s14, s12, 3
    v_add_u32 v2, s14, v2
    v_lshlrev_b32 v3, 15, v2
    v_lshl_add_u32 v3, v1, 1, v3
    v_subrev_u32 v4, 6144, v3
    v_subrev_u32 v5, 2048, v3
    v_lshlrev_b32 v6, 3, v1
    v_lshlrev_b32 v7, 12, v1
    v_lshl_add_u32 v7, v2, 4, v7
    s_movk_i32 s33, 4096
    s_movk_i32 s34, 8192
    s_movk_i32 s35, 12288
    s_movk_i32 s36, 16384
    s_movk_i32 s37, 20480
    s_movk_i32 s38, 24576
    s_movk_i32 s39, 28672
    buffer_load_dwordx4 v[86:89], v6, s[24:27], 0 offen
    buffer_load_dwordx4 v[90:93], v6, s[24:27], 0 offen offset:16
    buffer_load_dwordx2 v[16:17], v4, s[16:19], 0 offen
    buffer_load_dwordx2 v[18:19], v4, s[16:19], 0 offen offset:2048
    buffer_load_dwordx2 v[20:21], v5, s[16:19], 0 offen
    buffer_load_dwordx2 v[22:23], v3, s[16:19], 0 offen offset:0
    buffer_load_dwordx2 v[24:25], v3, s[16:19], 0 offen offset:2048
    buffer_load_dwordx2 v[26:27], v3, s[16:19], s33 offen offset:0
    buffer_load_dwordx2 v[28:29], v3, s[16:19], s33 offen offset:2048
    buffer_load_dwordx2 v[30:31], v3, s[16:19], s34 offen offset:0
    buffer_load_dwordx2 v[32:33], v3, s[16:19], s34 offen offset:2048
    buffer_load_dwordx2 v[34:35], v3, s[16:19], s35 offen offset:0
    buffer_load_dwordx2 v[36:37], v3, s[16:19], s35 offen offset:2048
    buffer_load_dwordx2 v[38:39], v3, s[16:19], s36 offen offset:0
    buffer_load_dwordx2 v[40:41], v3, s[16:19], s36 offen offset:2048
    buffer_load_dwordx2 v[42:43], v3, s[16:19], s37 offen offset:0
    buffer_load_dwordx2 v[44:45], v3, s[16:19], s37 offen offset:2048
    buffer_load_dwordx2 v[46:47], v3, s[16:19], s38 offen offset:0
    buffer_load_dwordx2 v[48:49], v3, s[16:19], s38 offen offset:2048
    buffer_load_dwordx2 v[50:51], v3, s[16:19], s39 offen offset:0
    buffer_load_dwordx2 v[52:53], v3, s[16:19], s39 offen offset:2048
    buffer_load_dwordx2 v[54:55], v3, s[20:23], 0 offen offset:0
    buffer_load_dwordx2 v[56:57], v3, s[20:23], 0 offen offset:2048
    buffer_load_dwordx2 v[58:59], v3, s[20:23], s33 offen offset:0
    buffer_load_dwordx2 v[60:61], v3, s[20:23], s33 offen offset:2048
    buffer_load_dwordx2 v[62:63], v3, s[20:23], s34 offen offset:0
    buffer_load_dwordx2 v[64:65], v3, s[20:23], s34 offen offset:2048
    buffer_load_dwordx2 v[66:67], v3, s[20:23], s35 offen offset:0
    buffer_load_dwordx2 v[68:69], v3, s[20:23], s35 offen offset:2048
    buffer_load_dwordx2 v[70:71], v3, s[20:23], s36 offen offset:0
    buffer_load_dwordx2 v[72:73], v3, s[20:23], s36 offen offset:2048
    buffer_load_dwordx2 v[74:75], v3, s[20:23], s37 offen offset:0
    buffer_load_dwordx2 v[76:77], v3, s[20:23], s37 offen offset:2048
    buffer_load_dwordx2 v[78:79], v3, s[20:23], s38 offen offset:0
    buffer_load_dwordx2 v[80:81], v3, s[20:23], s38 offen offset:2048
    buffer_load_dwordx2 v[82:83], v3, s[20:23], s39 offen offset:0
    buffer_load_dwordx2 v[84:85], v3, s[20:23], s39 offen offset:2048
    v_lshlrev_b32 v8, 2, v0
    v_mov_b32 v9, 0
    s_lshl_b32 s14, s2, 5
    s_add_u32 s14, s14, 0x2000000
    s_mov_b64 exec, 0xff
    buffer_store_dword v9, v8, s[28:31], s14 offen
    s_mov_b64 exec, -1
    s_mov_b32 s44, 0x800000
    s_mov_b32 s45, 0x801000
    s_mov_b32 s46, 0x802000
    s_mov_b32 s47, 0x803000
    s_mov_b32 s48, 0xffff0000
    s_barrier
    s_barrier
    s_barrier
    s_barrier
    s_barrier
    s_barrier
    s_waitcnt vmcnt(0)
    v_lshlrev_b32 v94, 16, v86
    v_and_b32 v95, s48, v86
    v_lshlrev_b32 v96, 16, v87
    v_and_b32 v97, s48, v87
    v_lshlrev_b32 v98, 16, v16
    v_lshlrev_b32 v99, 16, v18
    v_lshlrev_b32 v100, 16, v20
    v_lshlrev_b32 v101, 16, v22
    v_lshlrev_b32 v102, 16, v24
    v_lshlrev_b32 v103, 16, v26
    v_lshlrev_b32 v104, 16, v28
    v_lshlrev_b32 v105, 16, v30
    v_lshlrev_b32 v106, 16, v32
    v_lshlrev_b32 v107, 16, v34
    v_lshlrev_b32 v108, 16, v36
    v_lshlrev_b32 v109, 16, v38
    v_lshlrev_b32 v110, 16, v40
    v_lshlrev_b32 v111, 16, v42
    v_lshlrev_b32 v112, 16, v44
    v_lshlrev_b32 v113, 16, v46
    v_lshlrev_b32 v114, 16, v48
    v_lshlrev_b32 v115, 16, v50
    v_lshlrev_b32 v116, 16, v52
    v_mul_f32 v118, v97, v98
    v_mul_f32 v119, v97, v99
    v_mul_f32 v120, v97, v100
    v_mul_f32 v121, v97, v101
    v_mul_f32 v122, v97, v102
    v_mul_f32 v123, v97, v103
    v_mul_f32 v124, v97, v104
    v_mul_f32 v125, v97, v105
    v_mul_f32 v126, v97, v106
    v_mul_f32 v127, v97, v107
    v_mul_f32 v128, v97, v108
    v_mul_f32 v129, v97, v109
    v_mul_f32 v130, v97, v110
    v_mul_f32 v131, v97, v111
    v_mul_f32 v132, v97, v112
    v_mul_f32 v133, v97, v113
    v_fmac_f32 v118, v96, v99
    v_fmac_f32 v119, v96, v100
    v_fmac_f32 v120, v96, v101
    v_fmac_f32 v121, v96, v102
    v_fmac_f32 v122, v96, v103
    v_fmac_f32 v123, v96, v104
    v_fmac_f32 v124, v96, v105
    v_fmac_f32 v125, v96, v106
    v_fmac_f32 v126, v96, v107
    v_fmac_f32 v127, v96, v108
    v_fmac_f32 v128, v96, v109
    v_fmac_f32 v129, v96, v110
    v_fmac_f32 v130, v96, v111
    v_fmac_f32 v131, v96, v112
    v_fmac_f32 v132, v96, v113
    v_fmac_f32 v133, v96, v114
    v_fmac_f32 v118, v95, v100
    v_fmac_f32 v119, v95, v101
    v_fmac_f32 v120, v95, v102
    v_fmac_f32 v121, v95, v103
    v_fmac_f32 v122, v95, v104
    v_fmac_f32 v123, v95, v105
    v_fmac_f32 v124, v95, v106
    v_fmac_f32 v125, v95, v107
    v_fmac_f32 v126, v95, v108
    s_barrier
    v_fmac_f32 v127, v95, v109
    v_fmac_f32 v128, v95, v110
    v_fmac_f32 v129, v95, v111
    v_fmac_f32 v130, v95, v112
    v_fmac_f32 v131, v95, v113
    v_fmac_f32 v132, v95, v114
    v_fmac_f32 v133, v95, v115
    v_fmac_f32 v118, v94, v101
    v_fmac_f32 v119, v94, v102
    v_fmac_f32 v120, v94, v103
    v_fmac_f32 v121, v94, v104
    v_fmac_f32 v122, v94, v105
    v_fmac_f32 v123, v94, v106
    v_fmac_f32 v124, v94, v107
    v_fmac_f32 v125, v94, v108
    v_fmac_f32 v126, v94, v109
    v_fmac_f32 v127, v94, v110
    v_fmac_f32 v128, v94, v111
    v_fmac_f32 v129, v94, v112
    v_fmac_f32 v130, v94, v113
    v_fmac_f32 v131, v94, v114
    v_fmac_f32 v132, v94, v115
    v_fmac_f32 v133, v94, v116
    v_lshlrev_b32 v98, 16, v54
    v_lshlrev_b32 v99, 16, v56
    v_lshlrev_b32 v100, 16, v58
    v_lshlrev_b32 v101, 16, v60
    v_lshlrev_b32 v102, 16, v62
    v_lshlrev_b32 v103, 16, v64
    v_lshlrev_b32 v104, 16, v66
    v_lshlrev_b32 v105, 16, v68
    v_lshlrev_b32 v106, 16, v70
    v_lshlrev_b32 v107, 16, v72
    v_lshlrev_b32 v108, 16, v74
    v_lshlrev_b32 v109, 16, v76
    v_lshlrev_b32 v110, 16, v78
    v_lshlrev_b32 v111, 16, v80
    v_lshlrev_b32 v112, 16, v82
    v_lshlrev_b32 v113, 16, v84
    v_mul_f32 v118, v118, v98
    v_mul_f32 v119, v119, v99
    v_mul_f32 v120, v120, v100
    v_mul_f32 v121, v121, v101
    v_mul_f32 v122, v122, v102
    v_mul_f32 v123, v123, v103
    v_mul_f32 v124, v124, v104
    v_mul_f32 v125, v125, v105
    v_mul_f32 v126, v126, v106
    v_mul_f32 v127, v127, v107
    v_mul_f32 v128, v128, v108
    v_mul_f32 v129, v129, v109
    v_mul_f32 v130, v130, v110
    v_mul_f32 v131, v131, v111
    v_mul_f32 v132, v132, v112
    v_mul_f32 v133, v133, v113
    v_cvt_pk_bf16_f32 v136, v130, v126
    v_cvt_pk_bf16_f32 v137, v122, v118
    v_cvt_pk_bf16_f32 v138, v132, v128
    v_cvt_pk_bf16_f32 v139, v124, v120
    v_cvt_pk_bf16_f32 v140, v131, v127
    v_cvt_pk_bf16_f32 v141, v123, v119
    v_cvt_pk_bf16_f32 v142, v133, v129
    v_cvt_pk_bf16_f32 v143, v125, v121
    buffer_store_dwordx4 v[136:139], v7, s[28:31], s44 offen offset:0
    s_barrier
    buffer_store_dwordx4 v[140:143], v7, s[28:31], s44 offen offset:2048
    v_lshlrev_b32 v94, 16, v88
    v_and_b32 v95, s48, v88
    v_lshlrev_b32 v96, 16, v89
    v_and_b32 v97, s48, v89
    v_and_b32 v98, s48, v16
    v_and_b32 v99, s48, v18
    v_and_b32 v100, s48, v20
    v_and_b32 v101, s48, v22
    v_and_b32 v102, s48, v24
    v_and_b32 v103, s48, v26
    v_and_b32 v104, s48, v28
    v_and_b32 v105, s48, v30
    v_and_b32 v106, s48, v32
    v_and_b32 v107, s48, v34
    v_and_b32 v108, s48, v36
    v_and_b32 v109, s48, v38
    v_and_b32 v110, s48, v40
    v_and_b32 v111, s48, v42
    v_and_b32 v112, s48, v44
    v_and_b32 v113, s48, v46
    v_and_b32 v114, s48, v48
    v_and_b32 v115, s48, v50
    v_and_b32 v116, s48, v52
    v_mul_f32 v118, v97, v98
    v_mul_f32 v119, v97, v99
    v_mul_f32 v120, v97, v100
    v_mul_f32 v121, v97, v101
    v_mul_f32 v122, v97, v102
    v_mul_f32 v123, v97, v103
    v_mul_f32 v124, v97, v104
    v_mul_f32 v125, v97, v105
    v_mul_f32 v126, v97, v106
    v_mul_f32 v127, v97, v107
    v_mul_f32 v128, v97, v108
    v_mul_f32 v129, v97, v109
    v_mul_f32 v130, v97, v110
    v_mul_f32 v131, v97, v111
    v_mul_f32 v132, v97, v112
    v_mul_f32 v133, v97, v113
    v_fmac_f32 v118, v96, v99
    v_fmac_f32 v119, v96, v100
    v_fmac_f32 v120, v96, v101
    v_fmac_f32 v121, v96, v102
    v_fmac_f32 v122, v96, v103
    v_fmac_f32 v123, v96, v104
    v_fmac_f32 v124, v96, v105
    v_fmac_f32 v125, v96, v106
    v_fmac_f32 v126, v96, v107
    v_fmac_f32 v127, v96, v108
    v_fmac_f32 v128, v96, v109
    v_fmac_f32 v129, v96, v110
    v_fmac_f32 v130, v96, v111
    v_fmac_f32 v131, v96, v112
    v_fmac_f32 v132, v96, v113
    v_fmac_f32 v133, v96, v114
    v_fmac_f32 v118, v95, v100
    v_fmac_f32 v119, v95, v101
    v_fmac_f32 v120, v95, v102
    v_fmac_f32 v121, v95, v103
    v_fmac_f32 v122, v95, v104
    v_fmac_f32 v123, v95, v105
    v_fmac_f32 v124, v95, v106
    v_fmac_f32 v125, v95, v107
    s_barrier
    v_fmac_f32 v126, v95, v108
    v_fmac_f32 v127, v95, v109
    v_fmac_f32 v128, v95, v110
    v_fmac_f32 v129, v95, v111
    v_fmac_f32 v130, v95, v112
    v_fmac_f32 v131, v95, v113
    v_fmac_f32 v132, v95, v114
    v_fmac_f32 v133, v95, v115
    v_fmac_f32 v118, v94, v101
    v_fmac_f32 v119, v94, v102
    v_fmac_f32 v120, v94, v103
    v_fmac_f32 v121, v94, v104
    v_fmac_f32 v122, v94, v105
    v_fmac_f32 v123, v94, v106
    v_fmac_f32 v124, v94, v107
    v_fmac_f32 v125, v94, v108
    v_fmac_f32 v126, v94, v109
    v_fmac_f32 v127, v94, v110
    v_fmac_f32 v128, v94, v111
    v_fmac_f32 v129, v94, v112
    v_fmac_f32 v130, v94, v113
    v_fmac_f32 v131, v94, v114
    v_fmac_f32 v132, v94, v115
    v_fmac_f32 v133, v94, v116
    v_and_b32 v98, s48, v54
    v_and_b32 v99, s48, v56
    v_and_b32 v100, s48, v58
    v_and_b32 v101, s48, v60
    v_and_b32 v102, s48, v62
    v_and_b32 v103, s48, v64
    v_and_b32 v104, s48, v66
    v_and_b32 v105, s48, v68
    v_and_b32 v106, s48, v70
    v_and_b32 v107, s48, v72
    v_and_b32 v108, s48, v74
    v_and_b32 v109, s48, v76
    v_and_b32 v110, s48, v78
    v_and_b32 v111, s48, v80
    v_and_b32 v112, s48, v82
    v_and_b32 v113, s48, v84
    v_mul_f32 v118, v118, v98
    v_mul_f32 v119, v119, v99
    v_mul_f32 v120, v120, v100
    v_mul_f32 v121, v121, v101
    v_mul_f32 v122, v122, v102
    v_mul_f32 v123, v123, v103
    v_mul_f32 v124, v124, v104
    v_mul_f32 v125, v125, v105
    v_mul_f32 v126, v126, v106
    v_mul_f32 v127, v127, v107
    v_mul_f32 v128, v128, v108
    v_mul_f32 v129, v129, v109
    v_mul_f32 v130, v130, v110
    v_mul_f32 v131, v131, v111
    v_mul_f32 v132, v132, v112
    v_mul_f32 v133, v133, v113
    v_cvt_pk_bf16_f32 v136, v130, v126
    v_cvt_pk_bf16_f32 v137, v122, v118
    v_cvt_pk_bf16_f32 v138, v132, v128
    v_cvt_pk_bf16_f32 v139, v124, v120
    v_cvt_pk_bf16_f32 v140, v131, v127
    v_cvt_pk_bf16_f32 v141, v123, v119
    v_cvt_pk_bf16_f32 v142, v133, v129
    v_cvt_pk_bf16_f32 v143, v125, v121
    s_barrier
    buffer_store_dwordx4 v[136:139], v7, s[28:31], s45 offen offset:0
    buffer_store_dwordx4 v[140:143], v7, s[28:31], s45 offen offset:2048
    v_lshlrev_b32 v94, 16, v90
    v_and_b32 v95, s48, v90
    v_lshlrev_b32 v96, 16, v91
    v_and_b32 v97, s48, v91
    v_lshlrev_b32 v98, 16, v17
    v_lshlrev_b32 v99, 16, v19
    v_lshlrev_b32 v100, 16, v21
    v_lshlrev_b32 v101, 16, v23
    v_lshlrev_b32 v102, 16, v25
    v_lshlrev_b32 v103, 16, v27
    v_lshlrev_b32 v104, 16, v29
    v_lshlrev_b32 v105, 16, v31
    v_lshlrev_b32 v106, 16, v33
    v_lshlrev_b32 v107, 16, v35
    v_lshlrev_b32 v108, 16, v37
    v_lshlrev_b32 v109, 16, v39
    v_lshlrev_b32 v110, 16, v41
    v_lshlrev_b32 v111, 16, v43
    v_lshlrev_b32 v112, 16, v45
    v_lshlrev_b32 v113, 16, v47
    v_lshlrev_b32 v114, 16, v49
    v_lshlrev_b32 v115, 16, v51
    v_lshlrev_b32 v116, 16, v53
    v_mul_f32 v118, v97, v98
    v_mul_f32 v119, v97, v99
    v_mul_f32 v120, v97, v100
    v_mul_f32 v121, v97, v101
    v_mul_f32 v122, v97, v102
    v_mul_f32 v123, v97, v103
    v_mul_f32 v124, v97, v104
    v_mul_f32 v125, v97, v105
    v_mul_f32 v126, v97, v106
    v_mul_f32 v127, v97, v107
    v_mul_f32 v128, v97, v108
    v_mul_f32 v129, v97, v109
    v_mul_f32 v130, v97, v110
    v_mul_f32 v131, v97, v111
    v_mul_f32 v132, v97, v112
    v_mul_f32 v133, v97, v113
    v_fmac_f32 v118, v96, v99
    v_fmac_f32 v119, v96, v100
    v_fmac_f32 v120, v96, v101
    v_fmac_f32 v121, v96, v102
    v_fmac_f32 v122, v96, v103
    v_fmac_f32 v123, v96, v104
    v_fmac_f32 v124, v96, v105
    v_fmac_f32 v125, v96, v106
    v_fmac_f32 v126, v96, v107
    v_fmac_f32 v127, v96, v108
    v_fmac_f32 v128, v96, v109
    v_fmac_f32 v129, v96, v110
    v_fmac_f32 v130, v96, v111
    v_fmac_f32 v131, v96, v112
    v_fmac_f32 v132, v96, v113
    v_fmac_f32 v133, v96, v114
    v_fmac_f32 v118, v95, v100
    v_fmac_f32 v119, v95, v101
    v_fmac_f32 v120, v95, v102
    v_fmac_f32 v121, v95, v103
    v_fmac_f32 v122, v95, v104
    v_fmac_f32 v123, v95, v105
    v_fmac_f32 v124, v95, v106
    s_barrier
    v_fmac_f32 v125, v95, v107
    v_fmac_f32 v126, v95, v108
    v_fmac_f32 v127, v95, v109
    v_fmac_f32 v128, v95, v110
    v_fmac_f32 v129, v95, v111
    v_fmac_f32 v130, v95, v112
    v_fmac_f32 v131, v95, v113
    v_fmac_f32 v132, v95, v114
    v_fmac_f32 v133, v95, v115
    v_fmac_f32 v118, v94, v101
    v_fmac_f32 v119, v94, v102
    v_fmac_f32 v120, v94, v103
    v_fmac_f32 v121, v94, v104
    v_fmac_f32 v122, v94, v105
    v_fmac_f32 v123, v94, v106
    v_fmac_f32 v124, v94, v107
    v_fmac_f32 v125, v94, v108
    v_fmac_f32 v126, v94, v109
    v_fmac_f32 v127, v94, v110
    v_fmac_f32 v128, v94, v111
    v_fmac_f32 v129, v94, v112
    v_fmac_f32 v130, v94, v113
    v_fmac_f32 v131, v94, v114
    v_fmac_f32 v132, v94, v115
    v_fmac_f32 v133, v94, v116
    v_lshlrev_b32 v98, 16, v55
    v_lshlrev_b32 v99, 16, v57
    v_lshlrev_b32 v100, 16, v59
    v_lshlrev_b32 v101, 16, v61
    v_lshlrev_b32 v102, 16, v63
    v_lshlrev_b32 v103, 16, v65
    v_lshlrev_b32 v104, 16, v67
    v_lshlrev_b32 v105, 16, v69
    v_lshlrev_b32 v106, 16, v71
    v_lshlrev_b32 v107, 16, v73
    v_lshlrev_b32 v108, 16, v75
    v_lshlrev_b32 v109, 16, v77
    v_lshlrev_b32 v110, 16, v79
    v_lshlrev_b32 v111, 16, v81
    v_lshlrev_b32 v112, 16, v83
    v_lshlrev_b32 v113, 16, v85
    v_mul_f32 v118, v118, v98
    v_mul_f32 v119, v119, v99
    v_mul_f32 v120, v120, v100
    v_mul_f32 v121, v121, v101
    v_mul_f32 v122, v122, v102
    v_mul_f32 v123, v123, v103
    v_mul_f32 v124, v124, v104
    v_mul_f32 v125, v125, v105
    v_mul_f32 v126, v126, v106
    v_mul_f32 v127, v127, v107
    v_mul_f32 v128, v128, v108
    v_mul_f32 v129, v129, v109
    v_mul_f32 v130, v130, v110
    v_mul_f32 v131, v131, v111
    v_mul_f32 v132, v132, v112
    v_mul_f32 v133, v133, v113
    v_cvt_pk_bf16_f32 v136, v130, v126
    v_cvt_pk_bf16_f32 v137, v122, v118
    v_cvt_pk_bf16_f32 v138, v132, v128
    v_cvt_pk_bf16_f32 v139, v124, v120
    v_cvt_pk_bf16_f32 v140, v131, v127
    v_cvt_pk_bf16_f32 v141, v123, v119
    v_cvt_pk_bf16_f32 v142, v133, v129
    s_barrier
    v_cvt_pk_bf16_f32 v143, v125, v121
    buffer_store_dwordx4 v[136:139], v7, s[28:31], s46 offen offset:0
    buffer_store_dwordx4 v[140:143], v7, s[28:31], s46 offen offset:2048
    v_lshlrev_b32 v94, 16, v92
    v_and_b32 v95, s48, v92
    v_lshlrev_b32 v96, 16, v93
    v_and_b32 v97, s48, v93
    v_and_b32 v98, s48, v17
    v_and_b32 v99, s48, v19
    v_and_b32 v100, s48, v21
    v_and_b32 v101, s48, v23
    v_and_b32 v102, s48, v25
    v_and_b32 v103, s48, v27
    v_and_b32 v104, s48, v29
    v_and_b32 v105, s48, v31
    v_and_b32 v106, s48, v33
    v_and_b32 v107, s48, v35
    v_and_b32 v108, s48, v37
    v_and_b32 v109, s48, v39
    v_and_b32 v110, s48, v41
    v_and_b32 v111, s48, v43
    v_and_b32 v112, s48, v45
    v_and_b32 v113, s48, v47
    v_and_b32 v114, s48, v49
    v_and_b32 v115, s48, v51
    v_and_b32 v116, s48, v53
    v_mul_f32 v118, v97, v98
    v_mul_f32 v119, v97, v99
    v_mul_f32 v120, v97, v100
    v_mul_f32 v121, v97, v101
    v_mul_f32 v122, v97, v102
    v_mul_f32 v123, v97, v103
    v_mul_f32 v124, v97, v104
    v_mul_f32 v125, v97, v105
    v_mul_f32 v126, v97, v106
    v_mul_f32 v127, v97, v107
    v_mul_f32 v128, v97, v108
    v_mul_f32 v129, v97, v109
    v_mul_f32 v130, v97, v110
    v_mul_f32 v131, v97, v111
    v_mul_f32 v132, v97, v112
    v_mul_f32 v133, v97, v113
    v_fmac_f32 v118, v96, v99
    v_fmac_f32 v119, v96, v100
    v_fmac_f32 v120, v96, v101
    v_fmac_f32 v121, v96, v102
    v_fmac_f32 v122, v96, v103
    v_fmac_f32 v123, v96, v104
    v_fmac_f32 v124, v96, v105
    v_fmac_f32 v125, v96, v106
    v_fmac_f32 v126, v96, v107
    v_fmac_f32 v127, v96, v108
    v_fmac_f32 v128, v96, v109
    v_fmac_f32 v129, v96, v110
    v_fmac_f32 v130, v96, v111
    v_fmac_f32 v131, v96, v112
    v_fmac_f32 v132, v96, v113
    v_fmac_f32 v133, v96, v114
    v_fmac_f32 v118, v95, v100
    v_fmac_f32 v119, v95, v101
    v_fmac_f32 v120, v95, v102
    v_fmac_f32 v121, v95, v103
    v_fmac_f32 v122, v95, v104
    v_fmac_f32 v123, v95, v105
    s_barrier
    v_fmac_f32 v124, v95, v106
    v_fmac_f32 v125, v95, v107
    v_fmac_f32 v126, v95, v108
    v_fmac_f32 v127, v95, v109
    v_fmac_f32 v128, v95, v110
    v_fmac_f32 v129, v95, v111
    v_fmac_f32 v130, v95, v112
    v_fmac_f32 v131, v95, v113
    v_fmac_f32 v132, v95, v114
    v_fmac_f32 v133, v95, v115
    v_fmac_f32 v118, v94, v101
    v_fmac_f32 v119, v94, v102
    v_fmac_f32 v120, v94, v103
    v_fmac_f32 v121, v94, v104
    v_fmac_f32 v122, v94, v105
    v_fmac_f32 v123, v94, v106
    v_fmac_f32 v124, v94, v107
    v_fmac_f32 v125, v94, v108
    v_fmac_f32 v126, v94, v109
    v_fmac_f32 v127, v94, v110
    v_fmac_f32 v128, v94, v111
    v_fmac_f32 v129, v94, v112
    v_fmac_f32 v130, v94, v113
    v_fmac_f32 v131, v94, v114
    v_fmac_f32 v132, v94, v115
    v_fmac_f32 v133, v94, v116
    v_and_b32 v98, s48, v55
    v_and_b32 v99, s48, v57
    v_and_b32 v100, s48, v59
    v_and_b32 v101, s48, v61
    v_and_b32 v102, s48, v63
    v_and_b32 v103, s48, v65
    v_and_b32 v104, s48, v67
    v_and_b32 v105, s48, v69
    v_and_b32 v106, s48, v71
    v_and_b32 v107, s48, v73
    v_and_b32 v108, s48, v75
    v_and_b32 v109, s48, v77
    v_and_b32 v110, s48, v79
    v_and_b32 v111, s48, v81
    v_and_b32 v112, s48, v83
    v_and_b32 v113, s48, v85
    v_mul_f32 v118, v118, v98
    v_mul_f32 v119, v119, v99
    v_mul_f32 v120, v120, v100
    v_mul_f32 v121, v121, v101
    v_mul_f32 v122, v122, v102
    v_mul_f32 v123, v123, v103
    v_mul_f32 v124, v124, v104
    v_mul_f32 v125, v125, v105
    v_mul_f32 v126, v126, v106
    v_mul_f32 v127, v127, v107
    v_mul_f32 v128, v128, v108
    v_mul_f32 v129, v129, v109
    v_mul_f32 v130, v130, v110
    v_mul_f32 v131, v131, v111
    v_mul_f32 v132, v132, v112
    v_mul_f32 v133, v133, v113
    v_cvt_pk_bf16_f32 v136, v130, v126
    v_cvt_pk_bf16_f32 v137, v122, v118
    v_cvt_pk_bf16_f32 v138, v132, v128
    v_cvt_pk_bf16_f32 v139, v124, v120
    v_cvt_pk_bf16_f32 v140, v131, v127
    v_cvt_pk_bf16_f32 v141, v123, v119
    s_barrier
    v_cvt_pk_bf16_f32 v142, v133, v129
    v_cvt_pk_bf16_f32 v143, v125, v121
    buffer_store_dwordx4 v[136:139], v7, s[28:31], s47 offen offset:0
    buffer_store_dwordx4 v[140:143], v7, s[28:31], s47 offen offset:2048
    s_endpgm
K1_END:
    s_endpgm

.globl k2_kernel
.p2align 8
.type k2_kernel,@function
k2_kernel:
    s_cmp_ge_u32 s2, 256
    s_cbranch_scc1 K2_END
    s_load_dwordx4 s[4:7], s[0:1], 16
    s_load_dwordx4 s[8:11], s[0:1], 56
    s_load_dwordx2 s[12:13], s[0:1], 72
    s_load_dwordx2 s[14:15], s[0:1], 88
    v_lshrrev_b32 v1, 6, v0
    v_and_b32 v0, 63, v0
    s_and_b32 s16, s2, 7
    s_lshr_b32 s17, s2, 3
    v_readfirstlane_b32 s3, v1
    s_and_b32 s18, s17, 1
    s_lshl_b32 s19, s16, 1
    s_add_u32 s18, s18, s19
    s_lshr_b32 s19, s17, 1
    v_lshlrev_b32 v1, 4, v0
    v_bfe_u32 v2, v0, 4, 1
    v_lshlrev_b32 v2, 2, v2
    v_and_b32 v3, 7, v0
    v_xor_b32 v2, v2, v3
    v_lshlrev_b32 v2, 4, v2
    v_lshrrev_b32 v3, 3, v0
    v_lshl_add_u32 v2, v3, 11, v2
    s_waitcnt lgkmcnt(0)
    s_mov_b32 s20, s14
    s_mov_b32 s21, s15
    s_mov_b32 s22, 0x10000000
    s_mov_b32 s23, 0x00020000
    s_mov_b32 s24, s4
    s_mov_b32 s25, s5
    s_mov_b32 s26, 0x200000
    s_mov_b32 s27, 0x00020000
    s_mov_b32 s28, s12
    s_mov_b32 s29, s13
    s_mov_b32 s30, 0x800000
    s_mov_b32 s31, 0x00020000
    s_cmp_ge_u32 s3, 4
    s_cbranch_scc1 K2_G
    s_mov_b32 s32, s8
    s_mov_b32 s33, s9
    s_mov_b32 s34, 0x400000
    s_mov_b32 s35, 0x00020000
    s_lshl_b32 s36, s2, 2
    s_add_u32 s36, s36, s3
    s_mul_i32 s37, s3, 13056
    s_lshl_b32 s38, s36, 12
    s_add_u32 s39, s38, 0x800000
    s_add_u32 m0, s37, 32
    s_nop 0
    buffer_load_dwordx4 v1, s[32:35], s38 offen offset:0 lds
    buffer_load_dwordx4 v1, s[32:35], s38 offen offset:1024 lds
    buffer_load_dwordx4 v1, s[32:35], s38 offen offset:2048 lds
    buffer_load_dwordx4 v1, s[32:35], s38 offen offset:3072 lds
    s_add_u32 m0, s37, 8576
    s_nop 0
    buffer_load_dwordx4 v1, s[20:23], s39 offen offset:0 lds
    buffer_load_dwordx4 v1, s[20:23], s39 offen offset:1024 lds
    s_add_u32 m0, s37, 4196
    s_nop 0
    buffer_load_dwordx4 v1, s[32:35], s38 offen offset:0 lds
    buffer_load_dwordx4 v1, s[32:35], s38 offen offset:1024 lds
    buffer_load_dwordx4 v1, s[32:35], s38 offen offset:2048 lds
    buffer_load_dwordx4 v1, s[32:35], s38 offen offset:3072 lds
    s_add_u32 m0, s37, 8832
    s_nop 0
    buffer_load_dwordx4 v1, s[20:23], s39 offen offset:2048 lds
    buffer_load_dwordx4 v1, s[20:23], s39 offen offset:3072 lds
    s_add_u32 s40, s8, s38
    s_addc_u32 s41, s9, 0
    s_load_dword s42, s[40:41], 0
    s_lshl_b32 s43, s36, 1
    s_and_b32 s43, s43, 0xfffffffc
    s_add_u32 s40, s10, s43
    s_addc_u32 s41, s11, 0
    s_load_dword s43, s[40:41], 0
    v_add_u32 v4, 8320, v1
    v_add_u32 v5, 10368, v1
    v_cmp_gt_u32 vcc, 16, v0
    s_nop 1
    v_cndmask_b32 v4, v5, v4, vcc
    v_and_b32 v5, 1, v0
    v_lshlrev_b32 v5, 4, v5
    v_bfe_u32 v6, v0, 1, 1
    v_mul_u32_u24 v6, 4160, v6
    v_add_u32 v5, v5, v6
    v_cmp_gt_u32 vcc, 32, v0
    s_nop 1
    v_cndmask_b32 v4, v5, v4, vcc
    v_add_u32 v4, s37, v4
    v_mov_b32 v8, 0
    v_mov_b32 v9, 0
    v_mov_b32 v10, 0
    v_mov_b32 v11, 0
    ds_write_b128 v4, v[8:11]
    v_mov_b32 v5, s37
    ds_write_b32 v5, v8 offset:4192
    v_and_b32 v12, 3, v0
    v_bfe_u32 v13, v0, 2, 2
    v_add_u32 v12, v12, v13
    v_lshlrev_b32 v12, 3, v12
    v_lshrrev_b32 v13, 4, v0
    v_lshl_add_u32 v12, v13, 5, v12
    s_add_u32 s44, s37, 8
    v_add_u32 v6, s44, v12
    v_and_b32 v12, 15, v0
    v_sub_u32 v12, v12, v13
    v_lshlrev_b32 v12, 4, v12
    s_add_u32 s44, s37, 8512
    v_add_u32 v7, s44, v12
    v_mov_b32 v96, 0
    v_mov_b32 v97, 0
    v_mov_b32 v98, 0
    v_mov_b32 v99, 0
    v_mov_b32 v100, 0
    v_mov_b32 v101, 0
    v_mov_b32 v102, 0
    v_mov_b32 v103, 0
    v_mov_b32 v104, 0
    v_mov_b32 v105, 0
    v_mov_b32 v106, 0
    v_mov_b32 v107, 0
    v_mov_b32 v108, 0
    v_mov_b32 v109, 0
    v_mov_b32 v110, 0
    v_mov_b32 v111, 0
    v_mov_b32 v112, 0
    v_mov_b32 v113, 0
    v_mov_b32 v114, 0
    v_mov_b32 v115, 0
    v_mov_b32 v116, 0
    v_mov_b32 v117, 0
    v_mov_b32 v118, 0
    v_mov_b32 v119, 0
    v_mov_b32 v120, 0
    v_mov_b32 v121, 0
    v_mov_b32 v122, 0
    v_mov_b32 v123, 0
    v_mov_b32 v124, 0
    v_mov_b32 v125, 0
    v_mov_b32 v126, 0
    v_mov_b32 v127, 0
    v_mov_b32 v128, 0
    v_mov_b32 v129, 0
    v_mov_b32 v130, 0
    v_mov_b32 v131, 0
    v_mov_b32 v132, 0
    v_mov_b32 v133, 0
    v_mov_b32 v134, 0
    v_mov_b32 v135, 0
    v_mov_b32 v136, 0
    v_mov_b32 v137, 0
    v_mov_b32 v138, 0
    v_mov_b32 v139, 0
    v_mov_b32 v140, 0
    v_mov_b32 v141, 0
    v_mov_b32 v142, 0
    v_mov_b32 v143, 0
    v_mov_b32 v144, 0
    v_mov_b32 v145, 0
    v_mov_b32 v146, 0
    v_mov_b32 v147, 0
    v_mov_b32 v148, 0
    v_mov_b32 v149, 0
    v_mov_b32 v150, 0
    v_mov_b32 v151, 0
    v_mov_b32 v152, 0
    v_mov_b32 v153, 0
    v_mov_b32 v154, 0
    v_mov_b32 v155, 0
    v_mov_b32 v156, 0
    v_mov_b32 v157, 0
    v_mov_b32 v158, 0
    v_mov_b32 v159, 0
    v_subrev_u32 v12, 16, v0
    v_add_u32 v13, 47, v0
    v_cmp_gt_u32 vcc, 16, v0
    s_nop 1
    v_cndmask_b32 v12, v12, v13, vcc
    v_cmp_eq_u32 s[46:47], 0, v0
    v_mov_b32 v13, 63
    s_nop 0
    v_cndmask_b32 v12, v12, v13, s[46:47]
    v_lshlrev_b32 v14, 2, v12
    s_waitcnt lgkmcnt(0)
    s_lshl_b32 s42, s42, 16
    s_bitcmp1_b32 s36, 0
    s_cselect_b32 s45, 0, 16
    s_lshl_b32 s43, s43, s45
    s_and_b32 s43, s43, 0xffff0000
    v_mov_b32 v12, s42
    v_add_f32 v12, s43, v12
    v_cvt_pk_bf16_f32 v12, v12, v12
    s_waitcnt vmcnt(0)
    ds_write_b16 v5, v12 offset:32
    ds_write_b16 v5, v12 offset:4196
    ds_read_b128 v[76:79], v7 offset:1856
    ds_read_b64_tr_b16 v[16:17], v6 offset:0
    ds_read_b64_tr_b16 v[18:19], v6 offset:4160
    ds_read_b128 v[72:75], v7 offset:1600
    ds_read_b64_tr_b16 v[20:21], v6 offset:512
    ds_read_b64_tr_b16 v[22:23], v6 offset:4672
    ds_read_b128 v[68:71], v7 offset:1344
    ds_read_b64_tr_b16 v[24:25], v6 offset:1024
    ds_read_b64_tr_b16 v[26:27], v6 offset:5184
    ds_read_b128 v[64:67], v7 offset:1088
    ds_read_b64_tr_b16 v[28:29], v6 offset:1536
    ds_read_b64_tr_b16 v[30:31], v6 offset:5696
    ds_read_b128 v[60:63], v7 offset:832
    ds_read_b64_tr_b16 v[32:33], v6 offset:2048
    ds_read_b64_tr_b16 v[34:35], v6 offset:6208
    ds_read_b128 v[56:59], v7 offset:576
    ds_read_b64_tr_b16 v[36:37], v6 offset:2560
    ds_read_b64_tr_b16 v[38:39], v6 offset:6720
    ds_read_b128 v[52:55], v7 offset:320
    ds_read_b64_tr_b16 v[40:41], v6 offset:3072
    ds_read_b64_tr_b16 v[42:43], v6 offset:7232
    ds_read_b128 v[48:51], v7 offset:64
    ds_read_b64_tr_b16 v[44:45], v6 offset:3584
    ds_read_b64_tr_b16 v[46:47], v6 offset:7744
    s_mov_b32 s48, 0
    s_add_u32 s49, s3, 12
    s_lshl_b32 s49, s49, 17
    s_lshl_b32 s50, s19, 7
    s_add_u32 s49, s49, s50
.p2align 6
K2_CLOOP:
    s_waitcnt lgkmcnt(15)
    v_mfma_f32_16x16x32_bf16 v[124:127], v[16:19], v[76:79], v[124:127]
    ds_read_b128 v[80:83], v7 offset:2368
    ds_read_b128 v[76:79], v7 offset:4160
    v_mfma_f32_16x16x32_bf16 v[120:123], v[16:19], v[72:75], v[120:123]
    v_mfma_f32_16x16x32_bf16 v[124:127], v[20:23], v[72:75], v[124:127]
    ds_read_b128 v[72:75], v7 offset:3904
    v_mfma_f32_16x16x32_bf16 v[116:119], v[16:19], v[68:71], v[116:119]
    v_mfma_f32_16x16x32_bf16 v[120:123], v[20:23], v[68:71], v[120:123]
    s_waitcnt lgkmcnt(15)
    v_mfma_f32_16x16x32_bf16 v[124:127], v[24:27], v[68:71], v[124:127]
    ds_read_b128 v[68:71], v7 offset:3648
    s_waitcnt lgkmcnt(15)
    v_mfma_f32_16x16x32_bf16 v[112:115], v[16:19], v[64:67], v[112:115]
    v_mfma_f32_16x16x32_bf16 v[116:119], v[20:23], v[64:67], v[116:119]
    v_mfma_f32_16x16x32_bf16 v[120:123], v[24:27], v[64:67], v[120:123]
    v_mfma_f32_16x16x32_bf16 v[124:127], v[28:31], v[64:67], v[124:127]
    ds_read_b128 v[64:67], v7 offset:3392
    s_waitcnt lgkmcnt(15)
    v_mfma_f32_16x16x32_bf16 v[108:111], v[16:19], v[60:63], v[108:111]
    v_mfma_f32_16x16x32_bf16 v[112:115], v[20:23], v[60:63], v[112:115]
    v_mfma_f32_16x16x32_bf16 v[116:119], v[24:27], v[60:63], v[116:119]
    v_mfma_f32_16x16x32_bf16 v[120:123], v[28:31], v[60:63], v[120:123]
    s_waitcnt lgkmcnt(13)
    v_mfma_f32_16x16x32_bf16 v[124:127], v[32:35], v[60:63], v[124:127]
    ds_read_b128 v[60:63], v7 offset:3136
    s_waitcnt lgkmcnt(13)
    v_mfma_f32_16x16x32_bf16 v[104:107], v[16:19], v[56:59], v[104:107]
    v_mfma_f32_16x16x32_bf16 v[108:111], v[20:23], v[56:59], v[108:111]
    v_mfma_f32_16x16x32_bf16 v[112:115], v[24:27], v[56:59], v[112:115]
    v_mfma_f32_16x16x32_bf16 v[116:119], v[28:31], v[56:59], v[116:119]
    v_mfma_f32_16x16x32_bf16 v[120:123], v[32:35], v[56:59], v[120:123]
    s_waitcnt lgkmcnt(11)
    v_mfma_f32_16x16x32_bf16 v[124:127], v[36:39], v[56:59], v[124:127]
    ds_read_b128 v[56:59], v7 offset:2880
    s_waitcnt lgkmcnt(11)
    v_mfma_f32_16x16x32_bf16 v[100:103], v[16:19], v[52:55], v[100:103]
    v_mfma_f32_16x16x32_bf16 v[104:107], v[20:23], v[52:55], v[104:107]
    v_mfma_f32_16x16x32_bf16 v[108:111], v[24:27], v[52:55], v[108:111]
    v_mfma_f32_16x16x32_bf16 v[112:115], v[28:31], v[52:55], v[112:115]
    v_mfma_f32_16x16x32_bf16 v[116:119], v[32:35], v[52:55], v[116:119]
    v_mfma_f32_16x16x32_bf16 v[120:123], v[36:39], v[52:55], v[120:123]
    s_waitcnt lgkmcnt(9)
    v_mfma_f32_16x16x32_bf16 v[124:127], v[40:43], v[52:55], v[124:127]
    ds_read_b128 v[52:55], v7 offset:2624
    s_waitcnt lgkmcnt(10)
    v_mfma_f32_16x16x32_bf16 v[96:99], v[16:19], v[48:51], v[96:99]
    v_mfma_f32_16x16x32_bf16 v[100:103], v[20:23], v[48:51], v[100:103]
    v_mfma_f32_16x16x32_bf16 v[104:107], v[24:27], v[48:51], v[104:107]
    v_mfma_f32_16x16x32_bf16 v[108:111], v[28:31], v[48:51], v[108:111]
    v_mfma_f32_16x16x32_bf16 v[112:115], v[32:35], v[48:51], v[112:115]
    v_mfma_f32_16x16x32_bf16 v[116:119], v[36:39], v[48:51], v[116:119]
    v_mfma_f32_16x16x32_bf16 v[120:123], v[40:43], v[48:51], v[120:123]
    s_waitcnt lgkmcnt(8)
    v_mfma_f32_16x16x32_bf16 v[124:127], v[44:47], v[48:51], v[124:127]
    s_cmp_lg_u32 s48, 3
    s_cbranch_scc1 K2_CNODMA
    s_add_u32 m0, s37, 0
    s_add_u32 s50, s49, 0
    buffer_load_dwordx4 v2, s[24:27], s50 offen lds
    s_add_u32 m0, s37, 1024
    s_add_u32 s50, s49, 16384
    buffer_load_dwordx4 v2, s[24:27], s50 offen lds
    s_add_u32 m0, s37, 2048
    s_add_u32 s50, s49, 32768
    buffer_load_dwordx4 v2, s[24:27], s50 offen lds
    s_add_u32 m0, s37, 3072
    s_add_u32 s50, s49, 49152
    buffer_load_dwordx4 v2, s[24:27], s50 offen lds
    s_add_u32 m0, s37, 4096
    s_add_u32 s50, s49, 65536
    buffer_load_dwordx4 v2, s[24:27], s50 offen lds
    s_add_u32 m0, s37, 5120
    s_add_u32 s50, s49, 81920
    buffer_load_dwordx4 v2, s[24:27], s50 offen lds
    s_add_u32 m0, s37, 6144
    s_add_u32 s50, s49, 98304
    buffer_load_dwordx4 v2, s[24:27], s50 offen lds
    s_add_u32 m0, s37, 7168
    s_add_u32 s50, s49, 114688
    buffer_load_dwordx4 v2, s[24:27], s50 offen lds
K2_CNODMA:
    s_waitcnt lgkmcnt(6)
    v_mfma_f32_16x16x32_bf16 v[156:159], v[16:19], v[76:79], v[156:159]
    ds_read_b128 v[48:51], v7 offset:0
    ds_read_b128 v[76:79], v7 offset:1792
    s_waitcnt lgkmcnt(7)
    v_mfma_f32_16x16x32_bf16 v[152:155], v[16:19], v[72:75], v[152:155]
    s_waitcnt lgkmcnt(6)
    v_mfma_f32_16x16x32_bf16 v[148:151], v[16:19], v[68:71], v[148:151]
    s_waitcnt lgkmcnt(5)
    v_mfma_f32_16x16x32_bf16 v[144:147], v[16:19], v[64:67], v[144:147]
    s_waitcnt lgkmcnt(4)
    v_mfma_f32_16x16x32_bf16 v[140:143], v[16:19], v[60:63], v[140:143]
    s_waitcnt lgkmcnt(3)
    v_mfma_f32_16x16x32_bf16 v[136:139], v[16:19], v[56:59], v[136:139]
    s_waitcnt lgkmcnt(2)
    v_mfma_f32_16x16x32_bf16 v[132:135], v[16:19], v[52:55], v[132:135]
    v_mfma_f32_16x16x32_bf16 v[128:131], v[16:19], v[80:83], v[128:131]
    ds_read_b64_tr_b16 v[16:17], v6 offset:128
    ds_read_b64_tr_b16 v[18:19], v6 offset:4288
    v_mfma_f32_16x16x32_bf16 v[156:159], v[20:23], v[72:75], v[156:159]
    ds_read_b128 v[72:75], v7 offset:1536
    v_mfma_f32_16x16x32_bf16 v[152:155], v[20:23], v[68:71], v[152:155]
    v_mfma_f32_16x16x32_bf16 v[148:151], v[20:23], v[64:67], v[148:151]
    v_mfma_f32_16x16x32_bf16 v[144:147], v[20:23], v[60:63], v[144:147]
    v_mfma_f32_16x16x32_bf16 v[140:143], v[20:23], v[56:59], v[140:143]
    v_mfma_f32_16x16x32_bf16 v[136:139], v[20:23], v[52:55], v[136:139]
    v_mfma_f32_16x16x32_bf16 v[132:135], v[20:23], v[80:83], v[132:135]
    ds_read_b64_tr_b16 v[20:21], v6 offset:640
    ds_read_b64_tr_b16 v[22:23], v6 offset:4800
    v_mfma_f32_16x16x32_bf16 v[156:159], v[24:27], v[68:71], v[156:159]
    ds_read_b128 v[68:71], v7 offset:1280
    v_mfma_f32_16x16x32_bf16 v[152:155], v[24:27], v[64:67], v[152:155]
    v_mfma_f32_16x16x32_bf16 v[148:151], v[24:27], v[60:63], v[148:151]
    v_mfma_f32_16x16x32_bf16 v[144:147], v[24:27], v[56:59], v[144:147]
    v_mfma_f32_16x16x32_bf16 v[140:143], v[24:27], v[52:55], v[140:143]
    v_mfma_f32_16x16x32_bf16 v[136:139], v[24:27], v[80:83], v[136:139]
    ds_read_b64_tr_b16 v[24:25], v6 offset:1152
    ds_read_b64_tr_b16 v[26:27], v6 offset:5312
    v_mfma_f32_16x16x32_bf16 v[156:159], v[28:31], v[64:67], v[156:159]
    ds_read_b128 v[64:67], v7 offset:1024
    v_mfma_f32_16x16x32_bf16 v[152:155], v[28:31], v[60:63], v[152:155]
    v_mfma_f32_16x16x32_bf16 v[148:151], v[28:31], v[56:59], v[148:151]
    v_mfma_f32_16x16x32_bf16 v[144:147], v[28:31], v[52:55], v[144:147]
    v_mfma_f32_16x16x32_bf16 v[140:143], v[28:31], v[80:83], v[140:143]
    ds_read_b64_tr_b16 v[28:29], v6 offset:1664
    ds_read_b64_tr_b16 v[30:31], v6 offset:5824
    v_mfma_f32_16x16x32_bf16 v[156:159], v[32:35], v[60:63], v[156:159]
    ds_read_b128 v[60:63], v7 offset:768
    v_mfma_f32_16x16x32_bf16 v[152:155], v[32:35], v[56:59], v[152:155]
    v_mfma_f32_16x16x32_bf16 v[148:151], v[32:35], v[52:55], v[148:151]
    v_mfma_f32_16x16x32_bf16 v[144:147], v[32:35], v[80:83], v[144:147]
    ds_read_b64_tr_b16 v[32:33], v6 offset:2176
    ds_read_b64_tr_b16 v[34:35], v6 offset:6336
    v_mfma_f32_16x16x32_bf16 v[156:159], v[36:39], v[56:59], v[156:159]
    ds_read_b128 v[56:59], v7 offset:512
    v_mfma_f32_16x16x32_bf16 v[152:155], v[36:39], v[52:55], v[152:155]
    v_mfma_f32_16x16x32_bf16 v[148:151], v[36:39], v[80:83], v[148:151]
    ds_read_b64_tr_b16 v[36:37], v6 offset:2688
    ds_read_b64_tr_b16 v[38:39], v6 offset:6848
    v_mfma_f32_16x16x32_bf16 v[156:159], v[40:43], v[52:55], v[156:159]
    ds_read_b128 v[52:55], v7 offset:256
    v_mfma_f32_16x16x32_bf16 v[152:155], v[40:43], v[80:83], v[152:155]
    ds_read_b64_tr_b16 v[40:41], v6 offset:3200
    ds_read_b64_tr_b16 v[42:43], v6 offset:7360
    v_mfma_f32_16x16x32_bf16 v[156:159], v[44:47], v[80:83], v[156:159]
    ds_read_b64_tr_b16 v[44:45], v6 offset:3712
    ds_read_b64_tr_b16 v[46:47], v6 offset:7872
    v_add_u32 v6, 128, v6
    v_subrev_u32 v7, 64, v7
    s_add_u32 s48, s48, 1
    s_cmp_lt_u32 s48, 4
    s_cbranch_scc1 K2_CLOOP
    s_waitcnt lgkmcnt(0)
    ds_bpermute_b32 v17, v14, v131
    ds_bpermute_b32 v18, v14, v135
    ds_bpermute_b32 v19, v14, v139
    ds_bpermute_b32 v20, v14, v143
    ds_bpermute_b32 v21, v14, v147
    ds_bpermute_b32 v22, v14, v151
    ds_bpermute_b32 v23, v14, v155
    ds_bpermute_b32 v24, v14, v159
    v_mov_b32 v16, 0
    v_add_f32 v97, v97, v128
    v_add_f32 v98, v98, v129
    v_add_f32 v99, v99, v130
    v_add_f32 v101, v101, v132
    v_add_f32 v102, v102, v133
    v_add_f32 v103, v103, v134
    v_add_f32 v105, v105, v136
    v_add_f32 v106, v106, v137
    v_add_f32 v107, v107, v138
    v_add_f32 v109, v109, v140
    v_add_f32 v110, v110, v141
    v_add_f32 v111, v111, v142
    v_add_f32 v113, v113, v144
    v_add_f32 v114, v114, v145
    v_add_f32 v115, v115, v146
    v_add_f32 v117, v117, v148
    v_add_f32 v118, v118, v149
    v_add_f32 v119, v119, v150
    v_add_f32 v121, v121, v152
    v_add_f32 v122, v122, v153
    v_add_f32 v123, v123, v154
    v_add_f32 v125, v125, v156
    v_add_f32 v126, v126, v157
    v_add_f32 v127, v127, v158
    s_waitcnt lgkmcnt(0)
    v_cndmask_b32 v28, v17, v16, s[46:47]
    v_cndmask_b32 v29, v18, v17, s[46:47]
    v_cndmask_b32 v30, v19, v18, s[46:47]
    v_cndmask_b32 v31, v20, v19, s[46:47]
    v_cndmask_b32 v32, v21, v20, s[46:47]
    v_cndmask_b32 v33, v22, v21, s[46:47]
    v_cndmask_b32 v34, v23, v22, s[46:47]
    v_cndmask_b32 v35, v24, v23, s[46:47]
    v_add_f32 v96, v96, v28
    v_add_f32 v100, v100, v29
    v_add_f32 v104, v104, v30
    v_add_f32 v108, v108, v31
    v_add_f32 v112, v112, v32
    v_add_f32 v116, v116, v33
    v_add_f32 v120, v120, v34
    v_add_f32 v124, v124, v35
    v_cvt_pk_bf16_f32 v48, v96, v97
    v_cvt_pk_bf16_f32 v49, v98, v99
    v_cvt_pk_bf16_f32 v50, v100, v101
    v_cvt_pk_bf16_f32 v51, v102, v103
    v_cvt_pk_bf16_f32 v52, v104, v105
    v_cvt_pk_bf16_f32 v53, v106, v107
    v_cvt_pk_bf16_f32 v54, v108, v109
    v_cvt_pk_bf16_f32 v55, v110, v111
    v_cvt_pk_bf16_f32 v56, v112, v113
    v_cvt_pk_bf16_f32 v57, v114, v115
    v_cvt_pk_bf16_f32 v58, v116, v117
    v_cvt_pk_bf16_f32 v59, v118, v119
    v_cvt_pk_bf16_f32 v60, v120, v121
    v_cvt_pk_bf16_f32 v61, v122, v123
    v_cvt_pk_bf16_f32 v62, v124, v125
    v_cvt_pk_bf16_f32 v63, v126, v127
    s_add_u32 s39, s38, 0x1800000
    buffer_store_dwordx4 v[48:51], v1, s[20:23], s39 offen offset:0 sc1
    buffer_store_dwordx4 v[52:55], v1, s[20:23], s39 offen offset:1024 sc1
    buffer_store_dwordx4 v[56:59], v1, s[20:23], s39 offen offset:2048 sc1
    buffer_store_dwordx4 v[60:63], v1, s[20:23], s39 offen offset:3072 sc1
    s_lshl_b32 s40, s36, 2
    s_add_u32 s40, s40, 0x2001000
    v_mov_b32 v8, 0
    v_mov_b32 v9, 1
    s_waitcnt vmcnt(0)
    s_mov_b64 exec, 1
    buffer_store_dword v9, v8, s[20:23], s40 offen sc1
    s_mov_b64 exec, -1
    s_barrier
    s_cmp_ge_u32 s3, 2
    s_cbranch_scc1 K2_CEND
    s_mov_b32 s32, s6
    s_mov_b32 s33, s7
    s_mov_b32 s34, 0x400000
    s_mov_b32 s35, 0x00020000
    s_and_b32 s36, s2, 15
    s_lshr_b32 s37, s2, 4
    s_lshl_b32 s37, s37, 4
    s_lshl_b32 s38, s3, 3
    s_add_u32 s37, s37, s38
    v_lshrrev_b32 v3, 3, v0
    v_add_u32 v3, s37, v3
    v_and_b32 v4, 7, v0
    v_lshlrev_b32 v5, 15, v4
    v_lshl_add_u32 v5, v3, 4, v5
    s_lshl_b32 s38, s36, 18
    s_add_u32 s38, s38, 0x1800000
    v_lshrrev_b32 v6, 6, v3
    v_lshlrev_b32 v6, 9, v6
    v_and_b32 v7, 15, v3
    v_lshl_add_u32 v6, v7, 4, v6
    v_bfe_u32 v7, v3, 4, 2
    v_lshl_add_u32 v6, v7, 2, v6
    v_lshlrev_b32 v4, 4, v4
    v_lshl_add_u32 v7, v6, 11, v4
    v_lshl_add_u32 v6, v6, 12, v4
    s_lshl_b32 s39, s36, 7
    s_add_u32 s40, s39, 0
    buffer_load_dwordx4 v[16:19], v7, s[32:35], s40 offen offset:0
    s_add_u32 s40, s39, 0
    buffer_load_dwordx4 v[20:23], v7, s[32:35], s40 offen offset:2048
    s_add_u32 s40, s39, 4096
    buffer_load_dwordx4 v[24:27], v7, s[32:35], s40 offen offset:0
    s_add_u32 s40, s39, 4096
    buffer_load_dwordx4 v[28:31], v7, s[32:35], s40 offen offset:2048
    s_add_u32 s40, s39, 524288
    buffer_load_dwordx4 v[32:35], v7, s[32:35], s40 offen offset:0
    s_add_u32 s40, s39, 524288
    buffer_load_dwordx4 v[36:39], v7, s[32:35], s40 offen offset:2048
    s_add_u32 s40, s39, 528384
    buffer_load_dwordx4 v[40:43], v7, s[32:35], s40 offen offset:0
    s_add_u32 s40, s39, 528384
    buffer_load_dwordx4 v[44:47], v7, s[32:35], s40 offen offset:2048
    s_lshl_b32 s41, s36, 8
    s_add_u32 s41, s41, 0x2001000
    v_lshlrev_b32 v8, 2, v0
    s_mov_b32 s42, 0
K2_YPOLL:
    buffer_load_dword v9, v8, s[20:23], s41 offen sc1
    s_add_u32 s42, s42, 1
    s_waitcnt vmcnt(0)
    v_cmp_ne_u32 vcc, 0, v9
    s_cmp_gt_u32 s42, 200000
    s_cbranch_scc1 K2_YPOLL_X
    s_cmp_eq_u64 vcc, -1
    s_cbranch_scc1 K2_YPOLL_X
    s_sleep 1
    s_branch K2_YPOLL
K2_YPOLL_X:
    s_add_u32 s40, s38, 0
    buffer_load_dwordx4 v[48:51], v5, s[20:23], s40 offen sc1
    s_add_u32 s40, s38, 4096
    buffer_load_dwordx4 v[52:55], v5, s[20:23], s40 offen sc1
    s_add_u32 s40, s38, 8192
    buffer_load_dwordx4 v[56:59], v5, s[20:23], s40 offen sc1
    s_add_u32 s40, s38, 12288
    buffer_load_dwordx4 v[60:63], v5, s[20:23], s40 offen sc1
    s_add_u32 s40, s38, 16384
    buffer_load_dwordx4 v[64:67], v5, s[20:23], s40 offen sc1
    s_add_u32 s40, s38, 20480
    buffer_load_dwordx4 v[68:71], v5, s[20:23], s40 offen sc1
    s_add_u32 s40, s38, 24576
    buffer_load_dwordx4 v[72:75], v5, s[20:23], s40 offen sc1
    s_add_u32 s40, s38, 28672
    buffer_load_dwordx4 v[76:79], v5, s[20:23], s40 offen sc1
    s_mov_b32 s43, 0xffff0000
    s_add_u32 s39, s39, 2048
    s_waitcnt vmcnt(0)
    v_lshlrev_b32 v80, 16, v16
    v_lshlrev_b32 v88, 16, v48
    v_and_b32 v81, s43, v16
    v_lshlrev_b32 v89, 16, v52
    v_lshlrev_b32 v82, 16, v17
    v_lshlrev_b32 v90, 16, v56
    v_and_b32 v83, s43, v17
    v_lshlrev_b32 v91, 16, v60
    v_lshlrev_b32 v84, 16, v18
    v_lshlrev_b32 v92, 16, v64
    v_and_b32 v85, s43, v18
    v_lshlrev_b32 v93, 16, v68
    v_lshlrev_b32 v86, 16, v19
    v_lshlrev_b32 v94, 16, v72
    v_and_b32 v87, s43, v19
    v_lshlrev_b32 v95, 16, v76
    v_mul_f32 v80, v80, v88
    v_mul_f32 v81, v81, v89
    v_mul_f32 v82, v82, v90
    v_mul_f32 v83, v83, v91
    v_mul_f32 v84, v84, v92
    v_mul_f32 v85, v85, v93
    v_mul_f32 v86, v86, v94
    v_mul_f32 v87, v87, v95
    v_cvt_pk_bf16_f32 v100, v80, v81
    v_cvt_pk_bf16_f32 v101, v82, v83
    v_cvt_pk_bf16_f32 v102, v84, v85
    v_cvt_pk_bf16_f32 v103, v86, v87
    s_add_u32 s40, s39, 0
    buffer_store_dwordx4 v[100:103], v6, s[28:31], s40 offen
    v_lshlrev_b32 v80, 16, v20
    v_and_b32 v88, s43, v48
    v_and_b32 v81, s43, v20
    v_and_b32 v89, s43, v52
    v_lshlrev_b32 v82, 16, v21
    v_and_b32 v90, s43, v56
    v_and_b32 v83, s43, v21
    v_and_b32 v91, s43, v60
    v_lshlrev_b32 v84, 16, v22
    v_and_b32 v92, s43, v64
    v_and_b32 v85, s43, v22
    v_and_b32 v93, s43, v68
    v_lshlrev_b32 v86, 16, v23
    v_and_b32 v94, s43, v72
    v_and_b32 v87, s43, v23
    v_and_b32 v95, s43, v76
    v_mul_f32 v80, v80, v88
    v_mul_f32 v81, v81, v89
    v_mul_f32 v82, v82, v90
    v_mul_f32 v83, v83, v91
    v_mul_f32 v84, v84, v92
    v_mul_f32 v85, v85, v93
    v_mul_f32 v86, v86, v94
    v_mul_f32 v87, v87, v95
    v_cvt_pk_bf16_f32 v104, v80, v81
    v_cvt_pk_bf16_f32 v105, v82, v83
    v_cvt_pk_bf16_f32 v106, v84, v85
    v_cvt_pk_bf16_f32 v107, v86, v87
    s_add_u32 s40, s39, 4096
    buffer_store_dwordx4 v[104:107], v6, s[28:31], s40 offen
    v_lshlrev_b32 v80, 16, v24
    v_lshlrev_b32 v88, 16, v49
    v_and_b32 v81, s43, v24
    v_lshlrev_b32 v89, 16, v53
    v_lshlrev_b32 v82, 16, v25
    v_lshlrev_b32 v90, 16, v57
    v_and_b32 v83, s43, v25
    v_lshlrev_b32 v91, 16, v61
    v_lshlrev_b32 v84, 16, v26
    v_lshlrev_b32 v92, 16, v65
    v_and_b32 v85, s43, v26
    v_lshlrev_b32 v93, 16, v69
    v_lshlrev_b32 v86, 16, v27
    v_lshlrev_b32 v94, 16, v73
    v_and_b32 v87, s43, v27
    v_lshlrev_b32 v95, 16, v77
    v_mul_f32 v80, v80, v88
    v_mul_f32 v81, v81, v89
    v_mul_f32 v82, v82, v90
    v_mul_f32 v83, v83, v91
    v_mul_f32 v84, v84, v92
    v_mul_f32 v85, v85, v93
    v_mul_f32 v86, v86, v94
    v_mul_f32 v87, v87, v95
    v_cvt_pk_bf16_f32 v108, v80, v81
    v_cvt_pk_bf16_f32 v109, v82, v83
    v_cvt_pk_bf16_f32 v110, v84, v85
    v_cvt_pk_bf16_f32 v111, v86, v87
    s_add_u32 s40, s39, 8192
    buffer_store_dwordx4 v[108:111], v6, s[28:31], s40 offen
    v_lshlrev_b32 v80, 16, v28
    v_and_b32 v88, s43, v49
    v_and_b32 v81, s43, v28
    v_and_b32 v89, s43, v53
    v_lshlrev_b32 v82, 16, v29
    v_and_b32 v90, s43, v57
    v_and_b32 v83, s43, v29
    v_and_b32 v91, s43, v61
    v_lshlrev_b32 v84, 16, v30
    v_and_b32 v92, s43, v65
    v_and_b32 v85, s43, v30
    v_and_b32 v93, s43, v69
    v_lshlrev_b32 v86, 16, v31
    v_and_b32 v94, s43, v73
    v_and_b32 v87, s43, v31
    v_and_b32 v95, s43, v77
    v_mul_f32 v80, v80, v88
    v_mul_f32 v81, v81, v89
    v_mul_f32 v82, v82, v90
    v_mul_f32 v83, v83, v91
    v_mul_f32 v84, v84, v92
    v_mul_f32 v85, v85, v93
    v_mul_f32 v86, v86, v94
    v_mul_f32 v87, v87, v95
    v_cvt_pk_bf16_f32 v112, v80, v81
    v_cvt_pk_bf16_f32 v113, v82, v83
    v_cvt_pk_bf16_f32 v114, v84, v85
    v_cvt_pk_bf16_f32 v115, v86, v87
    s_add_u32 s40, s39, 12288
    buffer_store_dwordx4 v[112:115], v6, s[28:31], s40 offen
    v_lshlrev_b32 v80, 16, v32
    v_lshlrev_b32 v88, 16, v50
    v_and_b32 v81, s43, v32
    v_lshlrev_b32 v89, 16, v54
    v_lshlrev_b32 v82, 16, v33
    v_lshlrev_b32 v90, 16, v58
    v_and_b32 v83, s43, v33
    v_lshlrev_b32 v91, 16, v62
    v_lshlrev_b32 v84, 16, v34
    v_lshlrev_b32 v92, 16, v66
    v_and_b32 v85, s43, v34
    v_lshlrev_b32 v93, 16, v70
    v_lshlrev_b32 v86, 16, v35
    v_lshlrev_b32 v94, 16, v74
    v_and_b32 v87, s43, v35
    v_lshlrev_b32 v95, 16, v78
    v_mul_f32 v80, v80, v88
    v_mul_f32 v81, v81, v89
    v_mul_f32 v82, v82, v90
    v_mul_f32 v83, v83, v91
    v_mul_f32 v84, v84, v92
    v_mul_f32 v85, v85, v93
    v_mul_f32 v86, v86, v94
    v_mul_f32 v87, v87, v95
    v_cvt_pk_bf16_f32 v116, v80, v81
    v_cvt_pk_bf16_f32 v117, v82, v83
    v_cvt_pk_bf16_f32 v118, v84, v85
    v_cvt_pk_bf16_f32 v119, v86, v87
    s_add_u32 s40, s39, 1048576
    buffer_store_dwordx4 v[116:119], v6, s[28:31], s40 offen
    v_lshlrev_b32 v80, 16, v36
    v_and_b32 v88, s43, v50
    v_and_b32 v81, s43, v36
    v_and_b32 v89, s43, v54
    v_lshlrev_b32 v82, 16, v37
    v_and_b32 v90, s43, v58
    v_and_b32 v83, s43, v37
    v_and_b32 v91, s43, v62
    v_lshlrev_b32 v84, 16, v38
    v_and_b32 v92, s43, v66
    v_and_b32 v85, s43, v38
    v_and_b32 v93, s43, v70
    v_lshlrev_b32 v86, 16, v39
    v_and_b32 v94, s43, v74
    v_and_b32 v87, s43, v39
    v_and_b32 v95, s43, v78
    v_mul_f32 v80, v80, v88
    v_mul_f32 v81, v81, v89
    v_mul_f32 v82, v82, v90
    v_mul_f32 v83, v83, v91
    v_mul_f32 v84, v84, v92
    v_mul_f32 v85, v85, v93
    v_mul_f32 v86, v86, v94
    v_mul_f32 v87, v87, v95
    v_cvt_pk_bf16_f32 v120, v80, v81
    v_cvt_pk_bf16_f32 v121, v82, v83
    v_cvt_pk_bf16_f32 v122, v84, v85
    v_cvt_pk_bf16_f32 v123, v86, v87
    s_add_u32 s40, s39, 1052672
    buffer_store_dwordx4 v[120:123], v6, s[28:31], s40 offen
    v_lshlrev_b32 v80, 16, v40
    v_lshlrev_b32 v88, 16, v51
    v_and_b32 v81, s43, v40
    v_lshlrev_b32 v89, 16, v55
    v_lshlrev_b32 v82, 16, v41
    v_lshlrev_b32 v90, 16, v59
    v_and_b32 v83, s43, v41
    v_lshlrev_b32 v91, 16, v63
    v_lshlrev_b32 v84, 16, v42
    v_lshlrev_b32 v92, 16, v67
    v_and_b32 v85, s43, v42
    v_lshlrev_b32 v93, 16, v71
    v_lshlrev_b32 v86, 16, v43
    v_lshlrev_b32 v94, 16, v75
    v_and_b32 v87, s43, v43
    v_lshlrev_b32 v95, 16, v79
    v_mul_f32 v80, v80, v88
    v_mul_f32 v81, v81, v89
    v_mul_f32 v82, v82, v90
    v_mul_f32 v83, v83, v91
    v_mul_f32 v84, v84, v92
    v_mul_f32 v85, v85, v93
    v_mul_f32 v86, v86, v94
    v_mul_f32 v87, v87, v95
    v_cvt_pk_bf16_f32 v124, v80, v81
    v_cvt_pk_bf16_f32 v125, v82, v83
    v_cvt_pk_bf16_f32 v126, v84, v85
    v_cvt_pk_bf16_f32 v127, v86, v87
    s_add_u32 s40, s39, 1056768
    buffer_store_dwordx4 v[124:127], v6, s[28:31], s40 offen
    v_lshlrev_b32 v80, 16, v44
    v_and_b32 v88, s43, v51
    v_and_b32 v81, s43, v44
    v_and_b32 v89, s43, v55
    v_lshlrev_b32 v82, 16, v45
    v_and_b32 v90, s43, v59
    v_and_b32 v83, s43, v45
    v_and_b32 v91, s43, v63
    v_lshlrev_b32 v84, 16, v46
    v_and_b32 v92, s43, v67
    v_and_b32 v85, s43, v46
    v_and_b32 v93, s43, v71
    v_lshlrev_b32 v86, 16, v47
    v_and_b32 v94, s43, v75
    v_and_b32 v87, s43, v47
    v_and_b32 v95, s43, v79
    v_mul_f32 v80, v80, v88
    v_mul_f32 v81, v81, v89
    v_mul_f32 v82, v82, v90
    v_mul_f32 v83, v83, v91
    v_mul_f32 v84, v84, v92
    v_mul_f32 v85, v85, v93
    v_mul_f32 v86, v86, v94
    v_mul_f32 v87, v87, v95
    v_cvt_pk_bf16_f32 v128, v80, v81
    v_cvt_pk_bf16_f32 v129, v82, v83
    v_cvt_pk_bf16_f32 v130, v84, v85
    v_cvt_pk_bf16_f32 v131, v86, v87
    s_add_u32 s40, s39, 1060864
    buffer_store_dwordx4 v[128:131], v6, s[28:31], s40 offen
K2_CEND:
    s_endpgm
K2_G:
    s_sub_u32 s36, s3, 4
    s_and_b32 s37, s36, 1
    s_lshl_b32 s38, s18, 1
    s_add_u32 s37, s37, s38
    s_lshr_b32 s38, s36, 1
    v_and_b32 v3, 15, v0
    v_lshlrev_b32 v3, 7, v3
    v_lshrrev_b32 v4, 4, v0
    v_lshl_add_u32 v3, v4, 5, v3
    s_lshl_b32 s39, s37, 11
    s_add_u32 s39, s39, 0x600000
    buffer_load_dwordx4 v[8:11], v3, s[20:23], s39 offen
    buffer_load_dwordx4 v[12:15], v3, s[20:23], s39 offen offset:16
    s_lshl_b32 s39, s37, 16
    s_lshl_b32 s40, s38, 11
    s_add_u32 s39, s39, s40
    s_add_u32 s39, s39, 0x400000
    buffer_load_dwordx4 v[64:67], v1, s[20:23], s39 offen offset:0
    buffer_load_dwordx4 v[68:71], v1, s[20:23], s39 offen offset:1024
    s_add_u32 s39, s39, 4096
    buffer_load_dwordx4 v[72:75], v1, s[20:23], s39 offen offset:0
    buffer_load_dwordx4 v[76:79], v1, s[20:23], s39 offen offset:1024
    s_add_u32 s39, s39, 4096
    buffer_load_dwordx4 v[80:83], v1, s[20:23], s39 offen offset:0
    buffer_load_dwordx4 v[84:87], v1, s[20:23], s39 offen offset:1024
    s_add_u32 s39, s39, 4096
    buffer_load_dwordx4 v[88:91], v1, s[20:23], s39 offen offset:0
    buffer_load_dwordx4 v[92:95], v1, s[20:23], s39 offen offset:1024
    s_add_u32 s39, s39, 4096
    buffer_load_dwordx4 v[96:99], v1, s[20:23], s39 offen offset:0
    buffer_load_dwordx4 v[100:103], v1, s[20:23], s39 offen offset:1024
    s_add_u32 s39, s39, 4096
    buffer_load_dwordx4 v[104:107], v1, s[20:23], s39 offen offset:0
    buffer_load_dwordx4 v[108:111], v1, s[20:23], s39 offen offset:1024
    s_add_u32 s39, s39, 4096
    buffer_load_dwordx4 v[112:115], v1, s[20:23], s39 offen offset:0
    buffer_load_dwordx4 v[116:119], v1, s[20:23], s39 offen offset:1024
    s_add_u32 s39, s39, 4096
    buffer_load_dwordx4 v[120:123], v1, s[20:23], s39 offen offset:0
    buffer_load_dwordx4 v[124:127], v1, s[20:23], s39 offen offset:1024
    s_add_u32 s39, s39, 4096
    buffer_load_dwordx4 v[128:131], v1, s[20:23], s39 offen offset:0
    buffer_load_dwordx4 v[132:135], v1, s[20:23], s39 offen offset:1024
    s_add_u32 s39, s39, 4096
    buffer_load_dwordx4 v[136:139], v1, s[20:23], s39 offen offset:0
    buffer_load_dwordx4 v[140:143], v1, s[20:23], s39 offen offset:1024
    s_add_u32 s39, s39, 4096
    buffer_load_dwordx4 v[144:147], v1, s[20:23], s39 offen offset:0
    buffer_load_dwordx4 v[148:151], v1, s[20:23], s39 offen offset:1024
    s_add_u32 s39, s39, 4096
    buffer_load_dwordx4 v[152:155], v1, s[20:23], s39 offen offset:0
    buffer_load_dwordx4 v[156:159], v1, s[20:23], s39 offen offset:1024
    s_add_u32 s39, s39, 4096
    buffer_load_dwordx4 v[160:163], v1, s[20:23], s39 offen offset:0
    buffer_load_dwordx4 v[164:167], v1, s[20:23], s39 offen offset:1024
    s_add_u32 s39, s39, 4096
    buffer_load_dwordx4 v[168:171], v1, s[20:23], s39 offen offset:0
    buffer_load_dwordx4 v[172:175], v1, s[20:23], s39 offen offset:1024
    s_add_u32 s39, s39, 4096
    buffer_load_dwordx4 v[176:179], v1, s[20:23], s39 offen offset:0
    buffer_load_dwordx4 v[180:183], v1, s[20:23], s39 offen offset:1024
    s_add_u32 s39, s39, 4096
    buffer_load_dwordx4 v[184:187], v1, s[20:23], s39 offen offset:0
    buffer_load_dwordx4 v[188:191], v1, s[20:23], s39 offen offset:1024
    s_lshl_b32 s39, s19, 18
    s_lshl_b32 s40, s37, 10
    s_add_u32 s39, s39, s40
    buffer_load_dwordx4 v[16:19], v1, s[20:23], s39 offen
    s_add_u32 s39, s39, 32768
    buffer_load_dwordx4 v[20:23], v1, s[20:23], s39 offen
    s_add_u32 s39, s39, 32768
    buffer_load_dwordx4 v[24:27], v1, s[20:23], s39 offen
    s_add_u32 s39, s39, 32768
    buffer_load_dwordx4 v[28:31], v1, s[20:23], s39 offen
    s_add_u32 s39, s39, 32768
    buffer_load_dwordx4 v[32:35], v1, s[20:23], s39 offen
    s_add_u32 s39, s39, 32768
    buffer_load_dwordx4 v[36:39], v1, s[20:23], s39 offen
    s_add_u32 s39, s39, 32768
    buffer_load_dwordx4 v[40:43], v1, s[20:23], s39 offen
    s_add_u32 s39, s39, 32768
    buffer_load_dwordx4 v[44:47], v1, s[20:23], s39 offen
    s_waitcnt vmcnt(40)
    v_add_f32_dpp v8, v8, v8 row_ror:8 row_mask:0xf bank_mask:0xf
    v_add_f32_dpp v9, v9, v9 row_ror:8 row_mask:0xf bank_mask:0xf
    v_add_f32_dpp v10, v10, v10 row_ror:8 row_mask:0xf bank_mask:0xf
    v_add_f32_dpp v11, v11, v11 row_ror:8 row_mask:0xf bank_mask:0xf
    v_add_f32_dpp v12, v12, v12 row_ror:8 row_mask:0xf bank_mask:0xf
    v_add_f32_dpp v13, v13, v13 row_ror:8 row_mask:0xf bank_mask:0xf
    v_add_f32_dpp v14, v14, v14 row_ror:8 row_mask:0xf bank_mask:0xf
    v_add_f32_dpp v15, v15, v15 row_ror:8 row_mask:0xf bank_mask:0xf
    v_add_f32_dpp v8, v8, v8 row_ror:4 row_mask:0xf bank_mask:0xf
    v_add_f32_dpp v9, v9, v9 row_ror:4 row_mask:0xf bank_mask:0xf
    v_add_f32_dpp v10, v10, v10 row_ror:4 row_mask:0xf bank_mask:0xf
    v_add_f32_dpp v11, v11, v11 row_ror:4 row_mask:0xf bank_mask:0xf
    v_add_f32_dpp v12, v12, v12 row_ror:4 row_mask:0xf bank_mask:0xf
    v_add_f32_dpp v13, v13, v13 row_ror:4 row_mask:0xf bank_mask:0xf
    v_add_f32_dpp v14, v14, v14 row_ror:4 row_mask:0xf bank_mask:0xf
    v_add_f32_dpp v15, v15, v15 row_ror:4 row_mask:0xf bank_mask:0xf
    v_add_f32_dpp v8, v8, v8 row_ror:2 row_mask:0xf bank_mask:0xf
    v_add_f32_dpp v9, v9, v9 row_ror:2 row_mask:0xf bank_mask:0xf
    v_add_f32_dpp v10, v10, v10 row_ror:2 row_mask:0xf bank_mask:0xf
    v_add_f32_dpp v11, v11, v11 row_ror:2 row_mask:0xf bank_mask:0xf
    v_add_f32_dpp v12, v12, v12 row_ror:2 row_mask:0xf bank_mask:0xf
    v_add_f32_dpp v13, v13, v13 row_ror:2 row_mask:0xf bank_mask:0xf
    v_add_f32_dpp v14, v14, v14 row_ror:2 row_mask:0xf bank_mask:0xf
    v_add_f32_dpp v15, v15, v15 row_ror:2 row_mask:0xf bank_mask:0xf
    v_add_f32_dpp v8, v8, v8 row_ror:1 row_mask:0xf bank_mask:0xf
    v_add_f32_dpp v9, v9, v9 row_ror:1 row_mask:0xf bank_mask:0xf
    v_add_f32_dpp v10, v10, v10 row_ror:1 row_mask:0xf bank_mask:0xf
    v_add_f32_dpp v11, v11, v11 row_ror:1 row_mask:0xf bank_mask:0xf
    v_add_f32_dpp v12, v12, v12 row_ror:1 row_mask:0xf bank_mask:0xf
    v_add_f32_dpp v13, v13, v13 row_ror:1 row_mask:0xf bank_mask:0xf
    v_add_f32_dpp v14, v14, v14 row_ror:1 row_mask:0xf bank_mask:0xf
    v_add_f32_dpp v15, v15, v15 row_ror:1 row_mask:0xf bank_mask:0xf
    v_cvt_pk_bf16_f32 v48, v8, v9
    v_cvt_pk_bf16_f32 v49, v10, v11
    v_cvt_pk_bf16_f32 v50, v12, v13
    v_cvt_pk_bf16_f32 v51, v14, v15
    s_mov_b32 s41, 0x358637bd
    v_mov_b32 v56, s41
    v_mov_b32 v57, s41
    v_mov_b32 v58, s41
    v_mov_b32 v59, s41
    s_waitcnt vmcnt(36)
    v_add_f32 v64, v64, v72
    v_add_f32 v65, v65, v73
    v_add_f32 v66, v66, v74
    v_add_f32 v67, v67, v75
    v_add_f32 v68, v68, v76
    v_add_f32 v69, v69, v77
    v_add_f32 v70, v70, v78
    v_add_f32 v71, v71, v79
    s_waitcnt vmcnt(34)
    v_add_f32 v64, v64, v80
    v_add_f32 v65, v65, v81
    v_add_f32 v66, v66, v82
    v_add_f32 v67, v67, v83
    v_add_f32 v68, v68, v84
    v_add_f32 v69, v69, v85
    v_add_f32 v70, v70, v86
    v_add_f32 v71, v71, v87
    s_waitcnt vmcnt(32)
    v_add_f32 v64, v64, v88
    v_add_f32 v65, v65, v89
    v_add_f32 v66, v66, v90
    v_add_f32 v67, v67, v91
    v_add_f32 v68, v68, v92
    v_add_f32 v69, v69, v93
    v_add_f32 v70, v70, v94
    v_add_f32 v71, v71, v95
    s_waitcnt vmcnt(30)
    v_add_f32 v64, v64, v96
    v_add_f32 v65, v65, v97
    v_add_f32 v66, v66, v98
    v_add_f32 v67, v67, v99
    v_add_f32 v68, v68, v100
    v_add_f32 v69, v69, v101
    v_add_f32 v70, v70, v102
    v_add_f32 v71, v71, v103
    s_waitcnt vmcnt(28)
    v_add_f32 v64, v64, v104
    v_add_f32 v65, v65, v105
    v_add_f32 v66, v66, v106
    v_add_f32 v67, v67, v107
    v_add_f32 v68, v68, v108
    v_add_f32 v69, v69, v109
    v_add_f32 v70, v70, v110
    v_add_f32 v71, v71, v111
    s_waitcnt vmcnt(26)
    v_add_f32 v64, v64, v112
    v_add_f32 v65, v65, v113
    v_add_f32 v66, v66, v114
    v_add_f32 v67, v67, v115
    v_add_f32 v68, v68, v116
    v_add_f32 v69, v69, v117
    v_add_f32 v70, v70, v118
    v_add_f32 v71, v71, v119
    s_waitcnt vmcnt(24)
    v_add_f32 v64, v64, v120
    v_add_f32 v65, v65, v121
    v_add_f32 v66, v66, v122
    v_add_f32 v67, v67, v123
    v_add_f32 v68, v68, v124
    v_add_f32 v69, v69, v125
    v_add_f32 v70, v70, v126
    v_add_f32 v71, v71, v127
    s_waitcnt vmcnt(22)
    v_add_f32 v64, v64, v128
    v_add_f32 v65, v65, v129
    v_add_f32 v66, v66, v130
    v_add_f32 v67, v67, v131
    v_add_f32 v68, v68, v132
    v_add_f32 v69, v69, v133
    v_add_f32 v70, v70, v134
    v_add_f32 v71, v71, v135
    s_waitcnt vmcnt(20)
    v_add_f32 v64, v64, v136
    v_add_f32 v65, v65, v137
    v_add_f32 v66, v66, v138
    v_add_f32 v67, v67, v139
    v_add_f32 v68, v68, v140
    v_add_f32 v69, v69, v141
    v_add_f32 v70, v70, v142
    v_add_f32 v71, v71, v143
    s_waitcnt vmcnt(18)
    v_add_f32 v64, v64, v144
    v_add_f32 v65, v65, v145
    v_add_f32 v66, v66, v146
    v_add_f32 v67, v67, v147
    v_add_f32 v68, v68, v148
    v_add_f32 v69, v69, v149
    v_add_f32 v70, v70, v150
    v_add_f32 v71, v71, v151
    s_waitcnt vmcnt(16)
    v_add_f32 v64, v64, v152
    v_add_f32 v65, v65, v153
    v_add_f32 v66, v66, v154
    v_add_f32 v67, v67, v155
    v_add_f32 v68, v68, v156
    v_add_f32 v69, v69, v157
    v_add_f32 v70, v70, v158
    v_add_f32 v71, v71, v159
    s_waitcnt vmcnt(14)
    v_add_f32 v64, v64, v160
    v_add_f32 v65, v65, v161
    v_add_f32 v66, v66, v162
    v_add_f32 v67, v67, v163
    v_add_f32 v68, v68, v164
    v_add_f32 v69, v69, v165
    v_add_f32 v70, v70, v166
    v_add_f32 v71, v71, v167
    s_waitcnt vmcnt(12)
    v_add_f32 v64, v64, v168
    v_add_f32 v65, v65, v169
    v_add_f32 v66, v66, v170
    v_add_f32 v67, v67, v171
    v_add_f32 v68, v68, v172
    v_add_f32 v69, v69, v173
    v_add_f32 v70, v70, v174
    v_add_f32 v71, v71, v175
    s_waitcnt vmcnt(10)
    v_add_f32 v64, v64, v176
    v_add_f32 v65, v65, v177
    v_add_f32 v66, v66, v178
    v_add_f32 v67, v67, v179
    v_add_f32 v68, v68, v180
    v_add_f32 v69, v69, v181
    v_add_f32 v70, v70, v182
    v_add_f32 v71, v71, v183
    s_waitcnt vmcnt(8)
    v_add_f32 v64, v64, v184
    v_add_f32 v65, v65, v185
    v_add_f32 v66, v66, v186
    v_add_f32 v67, v67, v187
    v_add_f32 v68, v68, v188
    v_add_f32 v69, v69, v189
    v_add_f32 v70, v70, v190
    v_add_f32 v71, v71, v191
    v_cvt_pk_bf16_f32 v52, v64, v65
    v_cvt_pk_bf16_f32 v53, v66, v67
    v_cvt_pk_bf16_f32 v54, v68, v69
    v_cvt_pk_bf16_f32 v55, v70, v71
    s_waitcnt vmcnt(0)
    v_mfma_f32_16x16x32_bf16 v[104:107], v[48:51], v[16:19], v[56:59]
    v_mfma_f32_16x16x32_bf16 v[108:111], v[48:51], v[20:23], v[56:59]
    v_mfma_f32_16x16x32_bf16 v[112:115], v[48:51], v[24:27], v[56:59]
    v_mfma_f32_16x16x32_bf16 v[116:119], v[48:51], v[28:31], v[56:59]
    v_mfma_f32_16x16x32_bf16 v[120:123], v[48:51], v[32:35], v[56:59]
    v_mfma_f32_16x16x32_bf16 v[124:127], v[48:51], v[36:39], v[56:59]
    v_mfma_f32_16x16x32_bf16 v[128:131], v[48:51], v[40:43], v[56:59]
    v_mfma_f32_16x16x32_bf16 v[132:135], v[48:51], v[44:47], v[56:59]
    v_mfma_f32_16x16x32_bf16 v[72:75], v[52:55], v[16:19], 0
    v_mfma_f32_16x16x32_bf16 v[76:79], v[52:55], v[20:23], 0
    v_mfma_f32_16x16x32_bf16 v[80:83], v[52:55], v[24:27], 0
    v_mfma_f32_16x16x32_bf16 v[84:87], v[52:55], v[28:31], 0
    v_mfma_f32_16x16x32_bf16 v[88:91], v[52:55], v[32:35], 0
    v_mfma_f32_16x16x32_bf16 v[92:95], v[52:55], v[36:39], 0
    v_mfma_f32_16x16x32_bf16 v[96:99], v[52:55], v[40:43], 0
    v_mfma_f32_16x16x32_bf16 v[100:103], v[52:55], v[44:47], 0
    v_rcp_f32 v104, v104
    v_rcp_f32 v108, v108
    v_rcp_f32 v112, v112
    v_rcp_f32 v116, v116
    v_rcp_f32 v120, v120
    v_rcp_f32 v124, v124
    v_rcp_f32 v128, v128
    v_rcp_f32 v132, v132
    v_mul_f32 v72, v72, v104
    v_mul_f32 v73, v73, v104
    v_mul_f32 v74, v74, v104
    v_mul_f32 v75, v75, v104
    v_mul_f32 v76, v76, v108
    v_mul_f32 v77, v77, v108
    v_mul_f32 v78, v78, v108
    v_mul_f32 v79, v79, v108
    v_mul_f32 v80, v80, v112
    v_mul_f32 v81, v81, v112
    v_mul_f32 v82, v82, v112
    v_mul_f32 v83, v83, v112
    v_mul_f32 v84, v84, v116
    v_mul_f32 v85, v85, v116
    v_mul_f32 v86, v86, v116
    v_mul_f32 v87, v87, v116
    v_mul_f32 v88, v88, v120
    v_mul_f32 v89, v89, v120
    v_mul_f32 v90, v90, v120
    v_mul_f32 v91, v91, v120
    v_mul_f32 v92, v92, v124
    v_mul_f32 v93, v93, v124
    v_mul_f32 v94, v94, v124
    v_mul_f32 v95, v95, v124
    v_mul_f32 v96, v96, v128
    v_mul_f32 v97, v97, v128
    v_mul_f32 v98, v98, v128
    v_mul_f32 v99, v99, v128
    v_mul_f32 v100, v100, v132
    v_mul_f32 v101, v101, v132
    v_mul_f32 v102, v102, v132
    v_mul_f32 v103, v103, v132
    v_cvt_pk_bf16_f32 v136, v72, v73
    v_cvt_pk_bf16_f32 v137, v74, v75
    v_cvt_pk_bf16_f32 v138, v76, v77
    v_cvt_pk_bf16_f32 v139, v78, v79
    v_cvt_pk_bf16_f32 v140, v80, v81
    v_cvt_pk_bf16_f32 v141, v82, v83
    v_cvt_pk_bf16_f32 v142, v84, v85
    v_cvt_pk_bf16_f32 v143, v86, v87
    v_cvt_pk_bf16_f32 v144, v88, v89
    v_cvt_pk_bf16_f32 v145, v90, v91
    v_cvt_pk_bf16_f32 v146, v92, v93
    v_cvt_pk_bf16_f32 v147, v94, v95
    v_cvt_pk_bf16_f32 v148, v96, v97
    v_cvt_pk_bf16_f32 v149, v98, v99
    v_cvt_pk_bf16_f32 v150, v100, v101
    v_cvt_pk_bf16_f32 v151, v102, v103
    s_lshl_b32 s39, s19, 18
    s_lshl_b32 s40, s37, 1
    s_add_u32 s40, s40, s38
    s_lshl_b32 s41, s40, 10
    s_add_u32 s39, s39, s41
    s_add_u32 s39, s39, 0x1000000
    v_permlane16_swap_b32 v136, v138
    v_permlane16_swap_b32 v137, v139
    buffer_store_dwordx4 v[136:139], v1, s[20:23], s39 offen sc1
    s_add_u32 s39, s39, 65536
    v_permlane16_swap_b32 v140, v142
    v_permlane16_swap_b32 v141, v143
    buffer_store_dwordx4 v[140:143], v1, s[20:23], s39 offen sc1
    s_add_u32 s39, s39, 65536
    v_permlane16_swap_b32 v144, v146
    v_permlane16_swap_b32 v145, v147
    buffer_store_dwordx4 v[144:147], v1, s[20:23], s39 offen sc1
    s_add_u32 s39, s39, 65536
    v_permlane16_swap_b32 v148, v150
    v_permlane16_swap_b32 v149, v151
    buffer_store_dwordx4 v[148:151], v1, s[20:23], s39 offen sc1
    s_lshl_b32 s41, s19, 8
    s_lshl_b32 s40, s40, 2
    s_add_u32 s41, s41, s40
    s_add_u32 s41, s41, 0x2000000
    v_mov_b32 v8, 0
    v_mov_b32 v9, 1
    s_waitcnt vmcnt(0)
    s_mov_b64 exec, 1
    buffer_store_dword v9, v8, s[20:23], s41 offen sc1
    s_mov_b64 exec, -1
    s_lshl_b32 s42, s36, 10
    s_add_u32 s42, s42, 52224
    s_lshl_b32 s43, s36, 14
    s_lshl_b32 s44, s19, 7
    s_add_u32 s43, s43, s44
    s_mov_b32 s44, 0
K2_WLOOP:
    s_mov_b32 m0, s42
    s_add_u32 s42, s42, 4096
    buffer_load_dwordx4 v2, s[24:27], s43 offen lds
    s_add_u32 s43, s43, 65536
    s_add_u32 s44, s44, 1
    s_cmp_lt_u32 s44, 24
    s_cbranch_scc1 K2_WLOOP
    v_bfe_u32 v7, v0, 2, 2
    v_lshrrev_b32 v8, 5, v0
    v_lshl_add_u32 v9, v8, 3, v7
    v_lshlrev_b32 v9, 7, v9
    v_bfe_u32 v10, v0, 4, 1
    v_lshlrev_b32 v10, 5, v10
    v_and_b32 v11, 3, v0
    v_lshl_add_u32 v10, v11, 3, v10
    v_bfe_u32 v11, v0, 3, 1
    v_lshl_add_u32 v10, v11, 6, v10
    v_add_u32 v9, v9, v10
    v_mov_b32 v14, v9
    v_xor_b32 v15, 64, v9
    v_add_u32 v10, 52224, v14
    v_add_u32 v11, 52224, v15
    v_add_u32 v12, 101376, v14
    v_add_u32 v13, 101376, v15
    v_mov_b32 v16, 0
    v_mov_b32 v17, 0
    v_mov_b32 v18, 0
    v_mov_b32 v19, 0
    v_mov_b32 v20, 0
    v_mov_b32 v21, 0
    v_mov_b32 v22, 0
    v_mov_b32 v23, 0
    v_mov_b32 v24, 0
    v_mov_b32 v25, 0
    v_mov_b32 v26, 0
    v_mov_b32 v27, 0
    v_mov_b32 v28, 0
    v_mov_b32 v29, 0
    v_mov_b32 v30, 0
    v_mov_b32 v31, 0
    v_mov_b32 v32, 0
    v_mov_b32 v33, 0
    v_mov_b32 v34, 0
    v_mov_b32 v35, 0
    v_mov_b32 v36, 0
    v_mov_b32 v37, 0
    v_mov_b32 v38, 0
    v_mov_b32 v39, 0
    v_mov_b32 v40, 0
    v_mov_b32 v41, 0
    v_mov_b32 v42, 0
    v_mov_b32 v43, 0
    v_mov_b32 v44, 0
    v_mov_b32 v45, 0
    v_mov_b32 v46, 0
    v_mov_b32 v47, 0
    s_lshl_b32 s41, s18, 8
    s_add_u32 s41, s41, 0x2000000
    v_lshlrev_b32 v8, 2, v0
    s_mov_b32 s42, 0
K2_OPOLL:
    buffer_load_dword v9, v8, s[20:23], s41 offen sc1
    s_add_u32 s42, s42, 1
    s_waitcnt vmcnt(0)
    v_cmp_ne_u32 vcc, 0, v9
    s_cmp_gt_u32 s42, 200000
    s_cbranch_scc1 K2_OPOLL_X
    s_cmp_eq_u64 vcc, -1
    s_cbranch_scc1 K2_OPOLL_X
    s_sleep 1
    s_branch K2_OPOLL
K2_OPOLL_X:
    s_lshl_b32 s39, s18, 2
    s_add_u32 s39, s39, s36
    s_lshl_b32 s39, s39, 16
    s_add_u32 s39, s39, 0x1000000
    buffer_load_dwordx4 v[64:67], v1, s[20:23], s39 offen offset:0 sc1
    buffer_load_dwordx4 v[68:71], v1, s[20:23], s39 offen offset:1024 sc1
    buffer_load_dwordx4 v[72:75], v1, s[20:23], s39 offen offset:2048 sc1
    buffer_load_dwordx4 v[76:79], v1, s[20:23], s39 offen offset:3072 sc1
    s_add_u32 s39, s39, 4096
    buffer_load_dwordx4 v[80:83], v1, s[20:23], s39 offen offset:0 sc1
    buffer_load_dwordx4 v[84:87], v1, s[20:23], s39 offen offset:1024 sc1
    buffer_load_dwordx4 v[88:91], v1, s[20:23], s39 offen offset:2048 sc1
    buffer_load_dwordx4 v[92:95], v1, s[20:23], s39 offen offset:3072 sc1
    s_add_u32 s39, s39, 4096
    buffer_load_dwordx4 v[96:99], v1, s[20:23], s39 offen offset:0 sc1
    buffer_load_dwordx4 v[100:103], v1, s[20:23], s39 offen offset:1024 sc1
    buffer_load_dwordx4 v[104:107], v1, s[20:23], s39 offen offset:2048 sc1
    buffer_load_dwordx4 v[108:111], v1, s[20:23], s39 offen offset:3072 sc1
    s_add_u32 s39, s39, 4096
    buffer_load_dwordx4 v[112:115], v1, s[20:23], s39 offen offset:0 sc1
    buffer_load_dwordx4 v[116:119], v1, s[20:23], s39 offen offset:1024 sc1
    buffer_load_dwordx4 v[120:123], v1, s[20:23], s39 offen offset:2048 sc1
    buffer_load_dwordx4 v[124:127], v1, s[20:23], s39 offen offset:3072 sc1
    s_add_u32 s39, s39, 4096
    buffer_load_dwordx4 v[128:131], v1, s[20:23], s39 offen offset:0 sc1
    buffer_load_dwordx4 v[132:135], v1, s[20:23], s39 offen offset:1024 sc1
    buffer_load_dwordx4 v[136:139], v1, s[20:23], s39 offen offset:2048 sc1
    buffer_load_dwordx4 v[140:143], v1, s[20:23], s39 offen offset:3072 sc1
    s_add_u32 s39, s39, 4096
    buffer_load_dwordx4 v[144:147], v1, s[20:23], s39 offen offset:0 sc1
    buffer_load_dwordx4 v[148:151], v1, s[20:23], s39 offen offset:1024 sc1
    buffer_load_dwordx4 v[152:155], v1, s[20:23], s39 offen offset:2048 sc1
    buffer_load_dwordx4 v[156:159], v1, s[20:23], s39 offen offset:3072 sc1
    s_add_u32 s39, s39, 4096
    buffer_load_dwordx4 v[160:163], v1, s[20:23], s39 offen offset:0 sc1
    buffer_load_dwordx4 v[164:167], v1, s[20:23], s39 offen offset:1024 sc1
    buffer_load_dwordx4 v[168:171], v1, s[20:23], s39 offen offset:2048 sc1
    buffer_load_dwordx4 v[172:175], v1, s[20:23], s39 offen offset:3072 sc1
    s_add_u32 s39, s39, 4096
    buffer_load_dwordx4 v[176:179], v1, s[20:23], s39 offen offset:0 sc1
    buffer_load_dwordx4 v[180:183], v1, s[20:23], s39 offen offset:1024 sc1
    buffer_load_dwordx4 v[184:187], v1, s[20:23], s39 offen offset:2048 sc1
    buffer_load_dwordx4 v[188:191], v1, s[20:23], s39 offen offset:3072 sc1
    s_add_u32 s39, s39, 4096
    buffer_load_dwordx4 v[192:195], v1, s[20:23], s39 offen offset:0 sc1
    buffer_load_dwordx4 v[196:199], v1, s[20:23], s39 offen offset:1024 sc1
    buffer_load_dwordx4 v[200:203], v1, s[20:23], s39 offen offset:2048 sc1
    buffer_load_dwordx4 v[204:207], v1, s[20:23], s39 offen offset:3072 sc1
    s_add_u32 s39, s39, 4096
    buffer_load_dwordx4 v[208:211], v1, s[20:23], s39 offen offset:0 sc1
    buffer_load_dwordx4 v[212:215], v1, s[20:23], s39 offen offset:1024 sc1
    buffer_load_dwordx4 v[216:219], v1, s[20:23], s39 offen offset:2048 sc1
    buffer_load_dwordx4 v[220:223], v1, s[20:23], s39 offen offset:3072 sc1
    s_barrier
    ds_read_b64_tr_b16 v[48:49], v10 offset:0
    ds_read_b64_tr_b16 v[50:51], v10 offset:512
    ds_read_b64_tr_b16 v[52:53], v11 offset:0
    ds_read_b64_tr_b16 v[54:55], v11 offset:512
    s_waitcnt vmcnt(39) lgkmcnt(2)
    v_mfma_f32_32x32x16_bf16 v[16:31], v[48:51], v[64:67], v[16:31]
    ds_read_b64_tr_b16 v[56:57], v10 offset:2048
    ds_read_b64_tr_b16 v[58:59], v10 offset:2560
    ds_read_b64_tr_b16 v[60:61], v11 offset:2048
    ds_read_b64_tr_b16 v[62:63], v11 offset:2560
    s_waitcnt lgkmcnt(4)
    v_mfma_f32_32x32x16_bf16 v[32:47], v[52:55], v[64:67], v[32:47]
    s_add_u32 s39, s39, 4096
    buffer_load_dwordx4 v[64:67], v1, s[20:23], s39 offen offset:0 sc1
    s_waitcnt vmcnt(39) lgkmcnt(2)
    v_mfma_f32_32x32x16_bf16 v[16:31], v[56:59], v[68:71], v[16:31]
    ds_read_b64_tr_b16 v[48:49], v10 offset:4096
    ds_read_b64_tr_b16 v[50:51], v10 offset:4608
    ds_read_b64_tr_b16 v[52:53], v11 offset:4096
    ds_read_b64_tr_b16 v[54:55], v11 offset:4608
    s_waitcnt lgkmcnt(4)
    v_mfma_f32_32x32x16_bf16 v[32:47], v[60:63], v[68:71], v[32:47]
    buffer_load_dwordx4 v[68:71], v1, s[20:23], s39 offen offset:1024 sc1
    s_waitcnt vmcnt(39) lgkmcnt(2)
    v_mfma_f32_32x32x16_bf16 v[16:31], v[48:51], v[72:75], v[16:31]
    ds_read_b64_tr_b16 v[56:57], v10 offset:6144
    ds_read_b64_tr_b16 v[58:59], v10 offset:6656
    ds_read_b64_tr_b16 v[60:61], v11 offset:6144
    ds_read_b64_tr_b16 v[62:63], v11 offset:6656
    s_waitcnt lgkmcnt(4)
    v_mfma_f32_32x32x16_bf16 v[32:47], v[52:55], v[72:75], v[32:47]
    buffer_load_dwordx4 v[72:75], v1, s[20:23], s39 offen offset:2048 sc1
    s_waitcnt vmcnt(39) lgkmcnt(2)
    v_mfma_f32_32x32x16_bf16 v[16:31], v[56:59], v[76:79], v[16:31]
    ds_read_b64_tr_b16 v[48:49], v10 offset:8192
    ds_read_b64_tr_b16 v[50:51], v10 offset:8704
    ds_read_b64_tr_b16 v[52:53], v11 offset:8192
    ds_read_b64_tr_b16 v[54:55], v11 offset:8704
    s_waitcnt lgkmcnt(4)
    v_mfma_f32_32x32x16_bf16 v[32:47], v[60:63], v[76:79], v[32:47]
    buffer_load_dwordx4 v[76:79], v1, s[20:23], s39 offen offset:3072 sc1
    s_waitcnt vmcnt(39) lgkmcnt(2)
    v_mfma_f32_32x32x16_bf16 v[16:31], v[48:51], v[80:83], v[16:31]
    ds_read_b64_tr_b16 v[56:57], v10 offset:10240
    ds_read_b64_tr_b16 v[58:59], v10 offset:10752
    ds_read_b64_tr_b16 v[60:61], v11 offset:10240
    ds_read_b64_tr_b16 v[62:63], v11 offset:10752
    s_waitcnt lgkmcnt(4)
    v_mfma_f32_32x32x16_bf16 v[32:47], v[52:55], v[80:83], v[32:47]
    s_add_u32 s39, s39, 4096
    buffer_load_dwordx4 v[80:83], v1, s[20:23], s39 offen offset:0 sc1
    s_waitcnt vmcnt(39) lgkmcnt(2)
    v_mfma_f32_32x32x16_bf16 v[16:31], v[56:59], v[84:87], v[16:31]
    ds_read_b64_tr_b16 v[48:49], v10 offset:12288
    ds_read_b64_tr_b16 v[50:51], v10 offset:12800
    ds_read_b64_tr_b16 v[52:53], v11 offset:12288
    ds_read_b64_tr_b16 v[54:55], v11 offset:12800
    s_waitcnt lgkmcnt(4)
    v_mfma_f32_32x32x16_bf16 v[32:47], v[60:63], v[84:87], v[32:47]
    buffer_load_dwordx4 v[84:87], v1, s[20:23], s39 offen offset:1024 sc1
    s_waitcnt vmcnt(39) lgkmcnt(2)
    v_mfma_f32_32x32x16_bf16 v[16:31], v[48:51], v[88:91], v[16:31]
    ds_read_b64_tr_b16 v[56:57], v10 offset:14336
    ds_read_b64_tr_b16 v[58:59], v10 offset:14848
    ds_read_b64_tr_b16 v[60:61], v11 offset:14336
    ds_read_b64_tr_b16 v[62:63], v11 offset:14848
    s_waitcnt lgkmcnt(4)
    v_mfma_f32_32x32x16_bf16 v[32:47], v[52:55], v[88:91], v[32:47]
    buffer_load_dwordx4 v[88:91], v1, s[20:23], s39 offen offset:2048 sc1
    s_waitcnt vmcnt(39) lgkmcnt(2)
    v_mfma_f32_32x32x16_bf16 v[16:31], v[56:59], v[92:95], v[16:31]
    ds_read_b64_tr_b16 v[48:49], v10 offset:16384
    ds_read_b64_tr_b16 v[50:51], v10 offset:16896
    ds_read_b64_tr_b16 v[52:53], v11 offset:16384
    ds_read_b64_tr_b16 v[54:55], v11 offset:16896
    s_waitcnt lgkmcnt(4)
    v_mfma_f32_32x32x16_bf16 v[32:47], v[60:63], v[92:95], v[32:47]
    buffer_load_dwordx4 v[92:95], v1, s[20:23], s39 offen offset:3072 sc1
    s_waitcnt vmcnt(39) lgkmcnt(2)
    v_mfma_f32_32x32x16_bf16 v[16:31], v[48:51], v[96:99], v[16:31]
    ds_read_b64_tr_b16 v[56:57], v10 offset:18432
    ds_read_b64_tr_b16 v[58:59], v10 offset:18944
    ds_read_b64_tr_b16 v[60:61], v11 offset:18432
    ds_read_b64_tr_b16 v[62:63], v11 offset:18944
    s_waitcnt lgkmcnt(4)
    v_mfma_f32_32x32x16_bf16 v[32:47], v[52:55], v[96:99], v[32:47]
    s_add_u32 s39, s39, 4096
    buffer_load_dwordx4 v[96:99], v1, s[20:23], s39 offen offset:0 sc1
    s_waitcnt vmcnt(39) lgkmcnt(2)
    v_mfma_f32_32x32x16_bf16 v[16:31], v[56:59], v[100:103], v[16:31]
    ds_read_b64_tr_b16 v[48:49], v10 offset:20480
    ds_read_b64_tr_b16 v[50:51], v10 offset:20992
    ds_read_b64_tr_b16 v[52:53], v11 offset:20480
    ds_read_b64_tr_b16 v[54:55], v11 offset:20992
    s_waitcnt lgkmcnt(4)
    v_mfma_f32_32x32x16_bf16 v[32:47], v[60:63], v[100:103], v[32:47]
    buffer_load_dwordx4 v[100:103], v1, s[20:23], s39 offen offset:1024 sc1
    s_waitcnt vmcnt(39) lgkmcnt(2)
    v_mfma_f32_32x32x16_bf16 v[16:31], v[48:51], v[104:107], v[16:31]
    ds_read_b64_tr_b16 v[56:57], v10 offset:22528
    ds_read_b64_tr_b16 v[58:59], v10 offset:23040
    ds_read_b64_tr_b16 v[60:61], v11 offset:22528
    ds_read_b64_tr_b16 v[62:63], v11 offset:23040
    s_waitcnt lgkmcnt(4)
    v_mfma_f32_32x32x16_bf16 v[32:47], v[52:55], v[104:107], v[32:47]
    buffer_load_dwordx4 v[104:107], v1, s[20:23], s39 offen offset:2048 sc1
    s_waitcnt vmcnt(39) lgkmcnt(2)
    v_mfma_f32_32x32x16_bf16 v[16:31], v[56:59], v[108:111], v[16:31]
    ds_read_b64_tr_b16 v[48:49], v10 offset:24576
    ds_read_b64_tr_b16 v[50:51], v10 offset:25088
    ds_read_b64_tr_b16 v[52:53], v11 offset:24576
    ds_read_b64_tr_b16 v[54:55], v11 offset:25088
    s_waitcnt lgkmcnt(4)
    v_mfma_f32_32x32x16_bf16 v[32:47], v[60:63], v[108:111], v[32:47]
    buffer_load_dwordx4 v[108:111], v1, s[20:23], s39 offen offset:3072 sc1
    s_waitcnt vmcnt(39) lgkmcnt(2)
    v_mfma_f32_32x32x16_bf16 v[16:31], v[48:51], v[112:115], v[16:31]
    ds_read_b64_tr_b16 v[56:57], v10 offset:26624
    ds_read_b64_tr_b16 v[58:59], v10 offset:27136
    ds_read_b64_tr_b16 v[60:61], v11 offset:26624
    ds_read_b64_tr_b16 v[62:63], v11 offset:27136
    s_waitcnt lgkmcnt(4)
    v_mfma_f32_32x32x16_bf16 v[32:47], v[52:55], v[112:115], v[32:47]
    s_add_u32 s39, s39, 4096
    buffer_load_dwordx4 v[112:115], v1, s[20:23], s39 offen offset:0 sc1
    s_waitcnt vmcnt(39) lgkmcnt(2)
    v_mfma_f32_32x32x16_bf16 v[16:31], v[56:59], v[116:119], v[16:31]
    ds_read_b64_tr_b16 v[48:49], v10 offset:28672
    ds_read_b64_tr_b16 v[50:51], v10 offset:29184
    ds_read_b64_tr_b16 v[52:53], v11 offset:28672
    ds_read_b64_tr_b16 v[54:55], v11 offset:29184
    s_waitcnt lgkmcnt(4)
    v_mfma_f32_32x32x16_bf16 v[32:47], v[60:63], v[116:119], v[32:47]
    buffer_load_dwordx4 v[116:119], v1, s[20:23], s39 offen offset:1024 sc1
    s_waitcnt vmcnt(39) lgkmcnt(2)
    v_mfma_f32_32x32x16_bf16 v[16:31], v[48:51], v[120:123], v[16:31]
    ds_read_b64_tr_b16 v[56:57], v10 offset:30720
    ds_read_b64_tr_b16 v[58:59], v10 offset:31232
    ds_read_b64_tr_b16 v[60:61], v11 offset:30720
    ds_read_b64_tr_b16 v[62:63], v11 offset:31232
    s_waitcnt lgkmcnt(4)
    v_mfma_f32_32x32x16_bf16 v[32:47], v[52:55], v[120:123], v[32:47]
    buffer_load_dwordx4 v[120:123], v1, s[20:23], s39 offen offset:2048 sc1
    s_waitcnt vmcnt(39) lgkmcnt(2)
    v_mfma_f32_32x32x16_bf16 v[16:31], v[56:59], v[124:127], v[16:31]
    ds_read_b64_tr_b16 v[48:49], v10 offset:32768
    ds_read_b64_tr_b16 v[50:51], v10 offset:33280
    ds_read_b64_tr_b16 v[52:53], v11 offset:32768
    ds_read_b64_tr_b16 v[54:55], v11 offset:33280
    s_waitcnt lgkmcnt(4)
    v_mfma_f32_32x32x16_bf16 v[32:47], v[60:63], v[124:127], v[32:47]
    buffer_load_dwordx4 v[124:127], v1, s[20:23], s39 offen offset:3072 sc1
    s_waitcnt vmcnt(39) lgkmcnt(2)
    v_mfma_f32_32x32x16_bf16 v[16:31], v[48:51], v[128:131], v[16:31]
    ds_read_b64_tr_b16 v[56:57], v10 offset:34816
    ds_read_b64_tr_b16 v[58:59], v10 offset:35328
    ds_read_b64_tr_b16 v[60:61], v11 offset:34816
    ds_read_b64_tr_b16 v[62:63], v11 offset:35328
    s_waitcnt lgkmcnt(4)
    v_mfma_f32_32x32x16_bf16 v[32:47], v[52:55], v[128:131], v[32:47]
    s_add_u32 s39, s39, 4096
    buffer_load_dwordx4 v[128:131], v1, s[20:23], s39 offen offset:0 sc1
    s_waitcnt vmcnt(39) lgkmcnt(2)
    v_mfma_f32_32x32x16_bf16 v[16:31], v[56:59], v[132:135], v[16:31]
    ds_read_b64_tr_b16 v[48:49], v10 offset:36864
    ds_read_b64_tr_b16 v[50:51], v10 offset:37376
    ds_read_b64_tr_b16 v[52:53], v11 offset:36864
    ds_read_b64_tr_b16 v[54:55], v11 offset:37376
    s_waitcnt lgkmcnt(4)
    v_mfma_f32_32x32x16_bf16 v[32:47], v[60:63], v[132:135], v[32:47]
    buffer_load_dwordx4 v[132:135], v1, s[20:23], s39 offen offset:1024 sc1
    s_waitcnt vmcnt(39) lgkmcnt(2)
    v_mfma_f32_32x32x16_bf16 v[16:31], v[48:51], v[136:139], v[16:31]
    ds_read_b64_tr_b16 v[56:57], v10 offset:38912
    ds_read_b64_tr_b16 v[58:59], v10 offset:39424
    ds_read_b64_tr_b16 v[60:61], v11 offset:38912
    ds_read_b64_tr_b16 v[62:63], v11 offset:39424
    s_waitcnt lgkmcnt(4)
    v_mfma_f32_32x32x16_bf16 v[32:47], v[52:55], v[136:139], v[32:47]
    buffer_load_dwordx4 v[136:139], v1, s[20:23], s39 offen offset:2048 sc1
    s_waitcnt vmcnt(39) lgkmcnt(2)
    v_mfma_f32_32x32x16_bf16 v[16:31], v[56:59], v[140:143], v[16:31]
    ds_read_b64_tr_b16 v[48:49], v10 offset:40960
    ds_read_b64_tr_b16 v[50:51], v10 offset:41472
    ds_read_b64_tr_b16 v[52:53], v11 offset:40960
    ds_read_b64_tr_b16 v[54:55], v11 offset:41472
    s_waitcnt lgkmcnt(4)
    v_mfma_f32_32x32x16_bf16 v[32:47], v[60:63], v[140:143], v[32:47]
    buffer_load_dwordx4 v[140:143], v1, s[20:23], s39 offen offset:3072 sc1
    s_waitcnt vmcnt(39) lgkmcnt(2)
    v_mfma_f32_32x32x16_bf16 v[16:31], v[48:51], v[144:147], v[16:31]
    ds_read_b64_tr_b16 v[56:57], v10 offset:43008
    ds_read_b64_tr_b16 v[58:59], v10 offset:43520
    ds_read_b64_tr_b16 v[60:61], v11 offset:43008
    ds_read_b64_tr_b16 v[62:63], v11 offset:43520
    s_waitcnt lgkmcnt(4)
    v_mfma_f32_32x32x16_bf16 v[32:47], v[52:55], v[144:147], v[32:47]
    s_add_u32 s39, s39, 4096
    buffer_load_dwordx4 v[144:147], v1, s[20:23], s39 offen offset:0 sc1
    s_waitcnt vmcnt(39) lgkmcnt(2)
    v_mfma_f32_32x32x16_bf16 v[16:31], v[56:59], v[148:151], v[16:31]
    ds_read_b64_tr_b16 v[48:49], v10 offset:45056
    ds_read_b64_tr_b16 v[50:51], v10 offset:45568
    ds_read_b64_tr_b16 v[52:53], v11 offset:45056
    ds_read_b64_tr_b16 v[54:55], v11 offset:45568
    s_waitcnt lgkmcnt(4)
    v_mfma_f32_32x32x16_bf16 v[32:47], v[60:63], v[148:151], v[32:47]
    buffer_load_dwordx4 v[148:151], v1, s[20:23], s39 offen offset:1024 sc1
    s_waitcnt vmcnt(39) lgkmcnt(2)
    v_mfma_f32_32x32x16_bf16 v[16:31], v[48:51], v[152:155], v[16:31]
    ds_read_b64_tr_b16 v[56:57], v10 offset:47104
    ds_read_b64_tr_b16 v[58:59], v10 offset:47616
    ds_read_b64_tr_b16 v[60:61], v11 offset:47104
    ds_read_b64_tr_b16 v[62:63], v11 offset:47616
    s_waitcnt lgkmcnt(4)
    v_mfma_f32_32x32x16_bf16 v[32:47], v[52:55], v[152:155], v[32:47]
    buffer_load_dwordx4 v[152:155], v1, s[20:23], s39 offen offset:2048 sc1
    s_waitcnt vmcnt(39) lgkmcnt(2)
    v_mfma_f32_32x32x16_bf16 v[16:31], v[56:59], v[156:159], v[16:31]
    ds_read_b64_tr_b16 v[48:49], v12 offset:0
    ds_read_b64_tr_b16 v[50:51], v12 offset:512
    ds_read_b64_tr_b16 v[52:53], v13 offset:0
    ds_read_b64_tr_b16 v[54:55], v13 offset:512
    s_waitcnt lgkmcnt(4)
    v_mfma_f32_32x32x16_bf16 v[32:47], v[60:63], v[156:159], v[32:47]
    buffer_load_dwordx4 v[156:159], v1, s[20:23], s39 offen offset:3072 sc1
    s_waitcnt vmcnt(39) lgkmcnt(2)
    v_mfma_f32_32x32x16_bf16 v[16:31], v[48:51], v[160:163], v[16:31]
    ds_read_b64_tr_b16 v[56:57], v12 offset:2048
    ds_read_b64_tr_b16 v[58:59], v12 offset:2560
    ds_read_b64_tr_b16 v[60:61], v13 offset:2048
    ds_read_b64_tr_b16 v[62:63], v13 offset:2560
    s_waitcnt lgkmcnt(4)
    v_mfma_f32_32x32x16_bf16 v[32:47], v[52:55], v[160:163], v[32:47]
    s_waitcnt vmcnt(38) lgkmcnt(2)
    v_mfma_f32_32x32x16_bf16 v[16:31], v[56:59], v[164:167], v[16:31]
    ds_read_b64_tr_b16 v[48:49], v12 offset:4096
    ds_read_b64_tr_b16 v[50:51], v12 offset:4608
    ds_read_b64_tr_b16 v[52:53], v13 offset:4096
    ds_read_b64_tr_b16 v[54:55], v13 offset:4608
    s_waitcnt lgkmcnt(4)
    v_mfma_f32_32x32x16_bf16 v[32:47], v[60:63], v[164:167], v[32:47]
    s_waitcnt vmcnt(37) lgkmcnt(2)
    v_mfma_f32_32x32x16_bf16 v[16:31], v[48:51], v[168:171], v[16:31]
    ds_read_b64_tr_b16 v[56:57], v12 offset:6144
    ds_read_b64_tr_b16 v[58:59], v12 offset:6656
    ds_read_b64_tr_b16 v[60:61], v13 offset:6144
    ds_read_b64_tr_b16 v[62:63], v13 offset:6656
    s_waitcnt lgkmcnt(4)
    v_mfma_f32_32x32x16_bf16 v[32:47], v[52:55], v[168:171], v[32:47]
    s_waitcnt vmcnt(36) lgkmcnt(2)
    v_mfma_f32_32x32x16_bf16 v[16:31], v[56:59], v[172:175], v[16:31]
    ds_read_b64_tr_b16 v[48:49], v12 offset:8192
    ds_read_b64_tr_b16 v[50:51], v12 offset:8704
    ds_read_b64_tr_b16 v[52:53], v13 offset:8192
    ds_read_b64_tr_b16 v[54:55], v13 offset:8704
    s_waitcnt lgkmcnt(4)
    v_mfma_f32_32x32x16_bf16 v[32:47], v[60:63], v[172:175], v[32:47]
    s_waitcnt vmcnt(35) lgkmcnt(2)
    v_mfma_f32_32x32x16_bf16 v[16:31], v[48:51], v[176:179], v[16:31]
    ds_read_b64_tr_b16 v[56:57], v12 offset:10240
    ds_read_b64_tr_b16 v[58:59], v12 offset:10752
    ds_read_b64_tr_b16 v[60:61], v13 offset:10240
    ds_read_b64_tr_b16 v[62:63], v13 offset:10752
    s_waitcnt lgkmcnt(4)
    v_mfma_f32_32x32x16_bf16 v[32:47], v[52:55], v[176:179], v[32:47]
    s_waitcnt vmcnt(34) lgkmcnt(2)
    v_mfma_f32_32x32x16_bf16 v[16:31], v[56:59], v[180:183], v[16:31]
    ds_read_b64_tr_b16 v[48:49], v12 offset:12288
    ds_read_b64_tr_b16 v[50:51], v12 offset:12800
    ds_read_b64_tr_b16 v[52:53], v13 offset:12288
    ds_read_b64_tr_b16 v[54:55], v13 offset:12800
    s_waitcnt lgkmcnt(4)
    v_mfma_f32_32x32x16_bf16 v[32:47], v[60:63], v[180:183], v[32:47]
    s_waitcnt vmcnt(33) lgkmcnt(2)
    v_mfma_f32_32x32x16_bf16 v[16:31], v[48:51], v[184:187], v[16:31]
    ds_read_b64_tr_b16 v[56:57], v12 offset:14336
    ds_read_b64_tr_b16 v[58:59], v12 offset:14848
    ds_read_b64_tr_b16 v[60:61], v13 offset:14336
    ds_read_b64_tr_b16 v[62:63], v13 offset:14848
    s_waitcnt lgkmcnt(4)
    v_mfma_f32_32x32x16_bf16 v[32:47], v[52:55], v[184:187], v[32:47]
    s_waitcnt vmcnt(32) lgkmcnt(2)
    v_mfma_f32_32x32x16_bf16 v[16:31], v[56:59], v[188:191], v[16:31]
    ds_read_b64_tr_b16 v[48:49], v12 offset:16384
    ds_read_b64_tr_b16 v[50:51], v12 offset:16896
    ds_read_b64_tr_b16 v[52:53], v13 offset:16384
    ds_read_b64_tr_b16 v[54:55], v13 offset:16896
    s_waitcnt lgkmcnt(4)
    v_mfma_f32_32x32x16_bf16 v[32:47], v[60:63], v[188:191], v[32:47]
    s_waitcnt vmcnt(31) lgkmcnt(2)
    v_mfma_f32_32x32x16_bf16 v[16:31], v[48:51], v[192:195], v[16:31]
    ds_read_b64_tr_b16 v[56:57], v12 offset:18432
    ds_read_b64_tr_b16 v[58:59], v12 offset:18944
    ds_read_b64_tr_b16 v[60:61], v13 offset:18432
    ds_read_b64_tr_b16 v[62:63], v13 offset:18944
    s_waitcnt lgkmcnt(4)
    v_mfma_f32_32x32x16_bf16 v[32:47], v[52:55], v[192:195], v[32:47]
    s_waitcnt vmcnt(30) lgkmcnt(2)
    v_mfma_f32_32x32x16_bf16 v[16:31], v[56:59], v[196:199], v[16:31]
    ds_read_b64_tr_b16 v[48:49], v12 offset:20480
    ds_read_b64_tr_b16 v[50:51], v12 offset:20992
    ds_read_b64_tr_b16 v[52:53], v13 offset:20480
    ds_read_b64_tr_b16 v[54:55], v13 offset:20992
    s_waitcnt lgkmcnt(4)
    v_mfma_f32_32x32x16_bf16 v[32:47], v[60:63], v[196:199], v[32:47]
    s_waitcnt vmcnt(29) lgkmcnt(2)
    v_mfma_f32_32x32x16_bf16 v[16:31], v[48:51], v[200:203], v[16:31]
    ds_read_b64_tr_b16 v[56:57], v12 offset:22528
    ds_read_b64_tr_b16 v[58:59], v12 offset:23040
    ds_read_b64_tr_b16 v[60:61], v13 offset:22528
    ds_read_b64_tr_b16 v[62:63], v13 offset:23040
    s_waitcnt lgkmcnt(4)
    v_mfma_f32_32x32x16_bf16 v[32:47], v[52:55], v[200:203], v[32:47]
    s_waitcnt vmcnt(28) lgkmcnt(2)
    v_mfma_f32_32x32x16_bf16 v[16:31], v[56:59], v[204:207], v[16:31]
    ds_read_b64_tr_b16 v[48:49], v12 offset:24576
    ds_read_b64_tr_b16 v[50:51], v12 offset:25088
    ds_read_b64_tr_b16 v[52:53], v13 offset:24576
    ds_read_b64_tr_b16 v[54:55], v13 offset:25088
    s_waitcnt lgkmcnt(4)
    v_mfma_f32_32x32x16_bf16 v[32:47], v[60:63], v[204:207], v[32:47]
    s_waitcnt vmcnt(27) lgkmcnt(2)
    v_mfma_f32_32x32x16_bf16 v[16:31], v[48:51], v[208:211], v[16:31]
    ds_read_b64_tr_b16 v[56:57], v12 offset:26624
    ds_read_b64_tr_b16 v[58:59], v12 offset:27136
    ds_read_b64_tr_b16 v[60:61], v13 offset:26624
    ds_read_b64_tr_b16 v[62:63], v13 offset:27136
    s_waitcnt lgkmcnt(4)
    v_mfma_f32_32x32x16_bf16 v[32:47], v[52:55], v[208:211], v[32:47]
    s_waitcnt vmcnt(26) lgkmcnt(2)
    v_mfma_f32_32x32x16_bf16 v[16:31], v[56:59], v[212:215], v[16:31]
    ds_read_b64_tr_b16 v[48:49], v12 offset:28672
    ds_read_b64_tr_b16 v[50:51], v12 offset:29184
    ds_read_b64_tr_b16 v[52:53], v13 offset:28672
    ds_read_b64_tr_b16 v[54:55], v13 offset:29184
    s_waitcnt lgkmcnt(4)
    v_mfma_f32_32x32x16_bf16 v[32:47], v[60:63], v[212:215], v[32:47]
    s_waitcnt vmcnt(25) lgkmcnt(2)
    v_mfma_f32_32x32x16_bf16 v[16:31], v[48:51], v[216:219], v[16:31]
    ds_read_b64_tr_b16 v[56:57], v12 offset:30720
    ds_read_b64_tr_b16 v[58:59], v12 offset:31232
    ds_read_b64_tr_b16 v[60:61], v13 offset:30720
    ds_read_b64_tr_b16 v[62:63], v13 offset:31232
    s_waitcnt lgkmcnt(4)
    v_mfma_f32_32x32x16_bf16 v[32:47], v[52:55], v[216:219], v[32:47]
    s_waitcnt vmcnt(24) lgkmcnt(2)
    v_mfma_f32_32x32x16_bf16 v[16:31], v[56:59], v[220:223], v[16:31]
    ds_read_b64_tr_b16 v[48:49], v12 offset:32768
    ds_read_b64_tr_b16 v[50:51], v12 offset:33280
    ds_read_b64_tr_b16 v[52:53], v13 offset:32768
    ds_read_b64_tr_b16 v[54:55], v13 offset:33280
    s_waitcnt lgkmcnt(4)
    v_mfma_f32_32x32x16_bf16 v[32:47], v[60:63], v[220:223], v[32:47]
    s_waitcnt vmcnt(23) lgkmcnt(2)
    v_mfma_f32_32x32x16_bf16 v[16:31], v[48:51], v[64:67], v[16:31]
    ds_read_b64_tr_b16 v[56:57], v12 offset:34816
    ds_read_b64_tr_b16 v[58:59], v12 offset:35328
    ds_read_b64_tr_b16 v[60:61], v13 offset:34816
    ds_read_b64_tr_b16 v[62:63], v13 offset:35328
    s_waitcnt lgkmcnt(4)
    v_mfma_f32_32x32x16_bf16 v[32:47], v[52:55], v[64:67], v[32:47]
    s_waitcnt vmcnt(22) lgkmcnt(2)
    v_mfma_f32_32x32x16_bf16 v[16:31], v[56:59], v[68:71], v[16:31]
    ds_read_b64_tr_b16 v[48:49], v12 offset:36864
    ds_read_b64_tr_b16 v[50:51], v12 offset:37376
    ds_read_b64_tr_b16 v[52:53], v13 offset:36864
    ds_read_b64_tr_b16 v[54:55], v13 offset:37376
    s_waitcnt lgkmcnt(4)
    v_mfma_f32_32x32x16_bf16 v[32:47], v[60:63], v[68:71], v[32:47]
    s_waitcnt vmcnt(21) lgkmcnt(2)
    v_mfma_f32_32x32x16_bf16 v[16:31], v[48:51], v[72:75], v[16:31]
    ds_read_b64_tr_b16 v[56:57], v12 offset:38912
    ds_read_b64_tr_b16 v[58:59], v12 offset:39424
    ds_read_b64_tr_b16 v[60:61], v13 offset:38912
    ds_read_b64_tr_b16 v[62:63], v13 offset:39424
    s_waitcnt lgkmcnt(4)
    v_mfma_f32_32x32x16_bf16 v[32:47], v[52:55], v[72:75], v[32:47]
    s_waitcnt vmcnt(20) lgkmcnt(2)
    v_mfma_f32_32x32x16_bf16 v[16:31], v[56:59], v[76:79], v[16:31]
    ds_read_b64_tr_b16 v[48:49], v12 offset:40960
    ds_read_b64_tr_b16 v[50:51], v12 offset:41472
    ds_read_b64_tr_b16 v[52:53], v13 offset:40960
    ds_read_b64_tr_b16 v[54:55], v13 offset:41472
    s_waitcnt lgkmcnt(4)
    v_mfma_f32_32x32x16_bf16 v[32:47], v[60:63], v[76:79], v[32:47]
    s_waitcnt vmcnt(19) lgkmcnt(2)
    v_mfma_f32_32x32x16_bf16 v[16:31], v[48:51], v[80:83], v[16:31]
    ds_read_b64_tr_b16 v[56:57], v12 offset:43008
    ds_read_b64_tr_b16 v[58:59], v12 offset:43520
    ds_read_b64_tr_b16 v[60:61], v13 offset:43008
    ds_read_b64_tr_b16 v[62:63], v13 offset:43520
    s_waitcnt lgkmcnt(4)
    v_mfma_f32_32x32x16_bf16 v[32:47], v[52:55], v[80:83], v[32:47]
    s_waitcnt vmcnt(18) lgkmcnt(2)
    v_mfma_f32_32x32x16_bf16 v[16:31], v[56:59], v[84:87], v[16:31]
    ds_read_b64_tr_b16 v[48:49], v12 offset:45056
    ds_read_b64_tr_b16 v[50:51], v12 offset:45568
    ds_read_b64_tr_b16 v[52:53], v13 offset:45056
    ds_read_b64_tr_b16 v[54:55], v13 offset:45568
    s_waitcnt lgkmcnt(4)
    v_mfma_f32_32x32x16_bf16 v[32:47], v[60:63], v[84:87], v[32:47]
    s_waitcnt vmcnt(17) lgkmcnt(2)
    v_mfma_f32_32x32x16_bf16 v[16:31], v[48:51], v[88:91], v[16:31]
    ds_read_b64_tr_b16 v[56:57], v12 offset:47104
    ds_read_b64_tr_b16 v[58:59], v12 offset:47616
    ds_read_b64_tr_b16 v[60:61], v13 offset:47104
    ds_read_b64_tr_b16 v[62:63], v13 offset:47616
    s_waitcnt lgkmcnt(4)
    v_mfma_f32_32x32x16_bf16 v[32:47], v[52:55], v[88:91], v[32:47]
    s_waitcnt vmcnt(16) lgkmcnt(2)
    v_mfma_f32_32x32x16_bf16 v[16:31], v[56:59], v[92:95], v[16:31]
    ds_read_b64_tr_b16 v[48:49], v14 offset:0
    ds_read_b64_tr_b16 v[50:51], v14 offset:512
    ds_read_b64_tr_b16 v[52:53], v15 offset:0
    ds_read_b64_tr_b16 v[54:55], v15 offset:512
    s_waitcnt lgkmcnt(4)
    v_mfma_f32_32x32x16_bf16 v[32:47], v[60:63], v[92:95], v[32:47]
    s_waitcnt vmcnt(15) lgkmcnt(2)
    v_mfma_f32_32x32x16_bf16 v[16:31], v[48:51], v[96:99], v[16:31]
    ds_read_b64_tr_b16 v[56:57], v14 offset:2048
    ds_read_b64_tr_b16 v[58:59], v14 offset:2560
    ds_read_b64_tr_b16 v[60:61], v15 offset:2048
    ds_read_b64_tr_b16 v[62:63], v15 offset:2560
    s_waitcnt lgkmcnt(4)
    v_mfma_f32_32x32x16_bf16 v[32:47], v[52:55], v[96:99], v[32:47]
    s_waitcnt vmcnt(14) lgkmcnt(2)
    v_mfma_f32_32x32x16_bf16 v[16:31], v[56:59], v[100:103], v[16:31]
    ds_read_b64_tr_b16 v[48:49], v14 offset:4096
    ds_read_b64_tr_b16 v[50:51], v14 offset:4608
    ds_read_b64_tr_b16 v[52:53], v15 offset:4096
    ds_read_b64_tr_b16 v[54:55], v15 offset:4608
    s_waitcnt lgkmcnt(4)
    v_mfma_f32_32x32x16_bf16 v[32:47], v[60:63], v[100:103], v[32:47]
    s_waitcnt vmcnt(13) lgkmcnt(2)
    v_mfma_f32_32x32x16_bf16 v[16:31], v[48:51], v[104:107], v[16:31]
    ds_read_b64_tr_b16 v[56:57], v14 offset:6144
    ds_read_b64_tr_b16 v[58:59], v14 offset:6656
    ds_read_b64_tr_b16 v[60:61], v15 offset:6144
    ds_read_b64_tr_b16 v[62:63], v15 offset:6656
    s_waitcnt lgkmcnt(4)
    v_mfma_f32_32x32x16_bf16 v[32:47], v[52:55], v[104:107], v[32:47]
    s_waitcnt vmcnt(12) lgkmcnt(2)
    v_mfma_f32_32x32x16_bf16 v[16:31], v[56:59], v[108:111], v[16:31]
    ds_read_b64_tr_b16 v[48:49], v14 offset:13056
    ds_read_b64_tr_b16 v[50:51], v14 offset:13568
    ds_read_b64_tr_b16 v[52:53], v15 offset:13056
    ds_read_b64_tr_b16 v[54:55], v15 offset:13568
    s_waitcnt lgkmcnt(4)
    v_mfma_f32_32x32x16_bf16 v[32:47], v[60:63], v[108:111], v[32:47]
    s_waitcnt vmcnt(11) lgkmcnt(2)
    v_mfma_f32_32x32x16_bf16 v[16:31], v[48:51], v[112:115], v[16:31]
    ds_read_b64_tr_b16 v[56:57], v14 offset:15104
    ds_read_b64_tr_b16 v[58:59], v14 offset:15616
    ds_read_b64_tr_b16 v[60:61], v15 offset:15104
    ds_read_b64_tr_b16 v[62:63], v15 offset:15616
    s_waitcnt lgkmcnt(4)
    v_mfma_f32_32x32x16_bf16 v[32:47], v[52:55], v[112:115], v[32:47]
    s_waitcnt vmcnt(10) lgkmcnt(2)
    v_mfma_f32_32x32x16_bf16 v[16:31], v[56:59], v[116:119], v[16:31]
    ds_read_b64_tr_b16 v[48:49], v14 offset:17152
    ds_read_b64_tr_b16 v[50:51], v14 offset:17664
    ds_read_b64_tr_b16 v[52:53], v15 offset:17152
    ds_read_b64_tr_b16 v[54:55], v15 offset:17664
    s_waitcnt lgkmcnt(4)
    v_mfma_f32_32x32x16_bf16 v[32:47], v[60:63], v[116:119], v[32:47]
    s_waitcnt vmcnt(9) lgkmcnt(2)
    v_mfma_f32_32x32x16_bf16 v[16:31], v[48:51], v[120:123], v[16:31]
    ds_read_b64_tr_b16 v[56:57], v14 offset:19200
    ds_read_b64_tr_b16 v[58:59], v14 offset:19712
    ds_read_b64_tr_b16 v[60:61], v15 offset:19200
    ds_read_b64_tr_b16 v[62:63], v15 offset:19712
    s_waitcnt lgkmcnt(4)
    v_mfma_f32_32x32x16_bf16 v[32:47], v[52:55], v[120:123], v[32:47]
    s_waitcnt vmcnt(8) lgkmcnt(2)
    v_mfma_f32_32x32x16_bf16 v[16:31], v[56:59], v[124:127], v[16:31]
    ds_read_b64_tr_b16 v[48:49], v14 offset:26112
    ds_read_b64_tr_b16 v[50:51], v14 offset:26624
    ds_read_b64_tr_b16 v[52:53], v15 offset:26112
    ds_read_b64_tr_b16 v[54:55], v15 offset:26624
    s_waitcnt lgkmcnt(4)
    v_mfma_f32_32x32x16_bf16 v[32:47], v[60:63], v[124:127], v[32:47]
    s_waitcnt vmcnt(7) lgkmcnt(2)
    v_mfma_f32_32x32x16_bf16 v[16:31], v[48:51], v[128:131], v[16:31]
    ds_read_b64_tr_b16 v[56:57], v14 offset:28160
    ds_read_b64_tr_b16 v[58:59], v14 offset:28672
    ds_read_b64_tr_b16 v[60:61], v15 offset:28160
    ds_read_b64_tr_b16 v[62:63], v15 offset:28672
    s_waitcnt lgkmcnt(4)
    v_mfma_f32_32x32x16_bf16 v[32:47], v[52:55], v[128:131], v[32:47]
    s_waitcnt vmcnt(6) lgkmcnt(2)
    v_mfma_f32_32x32x16_bf16 v[16:31], v[56:59], v[132:135], v[16:31]
    ds_read_b64_tr_b16 v[48:49], v14 offset:30208
    ds_read_b64_tr_b16 v[50:51], v14 offset:30720
    ds_read_b64_tr_b16 v[52:53], v15 offset:30208
    ds_read_b64_tr_b16 v[54:55], v15 offset:30720
    s_waitcnt lgkmcnt(4)
    v_mfma_f32_32x32x16_bf16 v[32:47], v[60:63], v[132:135], v[32:47]
    s_waitcnt vmcnt(5) lgkmcnt(2)
    v_mfma_f32_32x32x16_bf16 v[16:31], v[48:51], v[136:139], v[16:31]
    ds_read_b64_tr_b16 v[56:57], v14 offset:32256
    ds_read_b64_tr_b16 v[58:59], v14 offset:32768
    ds_read_b64_tr_b16 v[60:61], v15 offset:32256
    ds_read_b64_tr_b16 v[62:63], v15 offset:32768
    s_waitcnt lgkmcnt(4)
    v_mfma_f32_32x32x16_bf16 v[32:47], v[52:55], v[136:139], v[32:47]
    s_waitcnt vmcnt(4) lgkmcnt(2)
    v_mfma_f32_32x32x16_bf16 v[16:31], v[56:59], v[140:143], v[16:31]
    ds_read_b64_tr_b16 v[48:49], v14 offset:39168
    ds_read_b64_tr_b16 v[50:51], v14 offset:39680
    ds_read_b64_tr_b16 v[52:53], v15 offset:39168
    ds_read_b64_tr_b16 v[54:55], v15 offset:39680
    s_waitcnt lgkmcnt(4)
    v_mfma_f32_32x32x16_bf16 v[32:47], v[60:63], v[140:143], v[32:47]
    s_waitcnt vmcnt(3) lgkmcnt(2)
    v_mfma_f32_32x32x16_bf16 v[16:31], v[48:51], v[144:147], v[16:31]
    ds_read_b64_tr_b16 v[56:57], v14 offset:41216
    ds_read_b64_tr_b16 v[58:59], v14 offset:41728
    ds_read_b64_tr_b16 v[60:61], v15 offset:41216
    ds_read_b64_tr_b16 v[62:63], v15 offset:41728
    s_waitcnt lgkmcnt(4)
    v_mfma_f32_32x32x16_bf16 v[32:47], v[52:55], v[144:147], v[32:47]
    s_waitcnt vmcnt(2) lgkmcnt(2)
    v_mfma_f32_32x32x16_bf16 v[16:31], v[56:59], v[148:151], v[16:31]
    ds_read_b64_tr_b16 v[48:49], v14 offset:43264
    ds_read_b64_tr_b16 v[50:51], v14 offset:43776
    ds_read_b64_tr_b16 v[52:53], v15 offset:43264
    ds_read_b64_tr_b16 v[54:55], v15 offset:43776
    s_waitcnt lgkmcnt(4)
    v_mfma_f32_32x32x16_bf16 v[32:47], v[60:63], v[148:151], v[32:47]
    s_waitcnt vmcnt(1) lgkmcnt(2)
    v_mfma_f32_32x32x16_bf16 v[16:31], v[48:51], v[152:155], v[16:31]
    ds_read_b64_tr_b16 v[56:57], v14 offset:45312
    ds_read_b64_tr_b16 v[58:59], v14 offset:45824
    ds_read_b64_tr_b16 v[60:61], v15 offset:45312
    ds_read_b64_tr_b16 v[62:63], v15 offset:45824
    s_waitcnt lgkmcnt(4)
    v_mfma_f32_32x32x16_bf16 v[32:47], v[52:55], v[152:155], v[32:47]
    s_waitcnt vmcnt(0) lgkmcnt(2)
    v_mfma_f32_32x32x16_bf16 v[16:31], v[56:59], v[156:159], v[16:31]
    s_waitcnt lgkmcnt(0)
    v_mfma_f32_32x32x16_bf16 v[32:47], v[60:63], v[156:159], v[32:47]
    s_nop 9
    v_cvt_pk_bf16_f32 v48, v16, v17
    v_cvt_pk_bf16_f32 v49, v18, v19
    v_cvt_pk_bf16_f32 v50, v20, v21
    v_cvt_pk_bf16_f32 v51, v22, v23
    v_cvt_pk_bf16_f32 v52, v24, v25
    v_cvt_pk_bf16_f32 v53, v26, v27
    v_cvt_pk_bf16_f32 v54, v28, v29
    v_cvt_pk_bf16_f32 v55, v30, v31
    v_cvt_pk_bf16_f32 v56, v32, v33
    v_cvt_pk_bf16_f32 v57, v34, v35
    v_cvt_pk_bf16_f32 v58, v36, v37
    v_cvt_pk_bf16_f32 v59, v38, v39
    v_cvt_pk_bf16_f32 v60, v40, v41
    v_cvt_pk_bf16_f32 v61, v42, v43
    v_cvt_pk_bf16_f32 v62, v44, v45
    v_cvt_pk_bf16_f32 v63, v46, v47
    v_and_b32 v3, 31, v0
    v_lshlrev_b32 v3, 12, v3
    v_lshrrev_b32 v4, 5, v0
    v_lshl_add_u32 v3, v4, 4, v3
    s_lshl_b32 s39, s18, 2
    s_add_u32 s39, s39, s36
    s_lshl_b32 s39, s39, 17
    s_lshl_b32 s40, s19, 7
    s_add_u32 s39, s39, s40
    v_permlane32_swap_b32 v48, v50
    v_permlane32_swap_b32 v49, v51
    buffer_store_dwordx4 v[48:51], v3, s[28:31], s39 offen offset:0
    v_permlane32_swap_b32 v52, v54
    v_permlane32_swap_b32 v53, v55
    buffer_store_dwordx4 v[52:55], v3, s[28:31], s39 offen offset:32
    v_permlane32_swap_b32 v56, v58
    v_permlane32_swap_b32 v57, v59
    buffer_store_dwordx4 v[56:59], v3, s[28:31], s39 offen offset:64
    v_permlane32_swap_b32 v60, v62
    v_permlane32_swap_b32 v61, v63
    buffer_store_dwordx4 v[60:63], v3, s[28:31], s39 offen offset:96
    s_endpgm
K2_END:
    s_endpgm

.section .rodata,"a"
.p2align 6
.amdhsa_kernel k1_kernel
  .amdhsa_next_free_vgpr 164
  .amdhsa_next_free_sgpr 49
  .amdhsa_accum_offset 164
  .amdhsa_group_segment_fixed_size 0
  .amdhsa_kernarg_size 96
  .amdhsa_user_sgpr_count 2
  .amdhsa_user_sgpr_kernarg_segment_ptr 1
  .amdhsa_system_sgpr_workgroup_id_x 1
  .amdhsa_float_denorm_mode_32 3
  .amdhsa_float_denorm_mode_16_64 3
.end_amdhsa_kernel

.p2align 6
.amdhsa_kernel k2_kernel
  .amdhsa_next_free_vgpr 224
  .amdhsa_next_free_sgpr 51
  .amdhsa_accum_offset 224
  .amdhsa_group_segment_fixed_size 0
  .amdhsa_kernarg_size 96
  .amdhsa_user_sgpr_count 2
  .amdhsa_user_sgpr_kernarg_segment_ptr 1
  .amdhsa_system_sgpr_workgroup_id_x 1
  .amdhsa_float_denorm_mode_32 3
  .amdhsa_float_denorm_mode_16_64 3
.end_amdhsa_kernel
```

```asm
; @launch grid=(256,1,1) block=(512,1,1) lds=163840
.amdgcn_target "amdgcn-amd-amdhsa--gfx950"
.text
.globl concat_heads__linear_attn_block__ssm_conv_h3__prompt_kernel
.p2align 8
.type concat_heads__linear_attn_block__ssm_conv_h3__prompt_kernel,@function
concat_heads__linear_attn_block__ssm_conv_h3__prompt_kernel:
    s_load_dwordx16 s[4:19], s[0:1], 0
    s_cmp_ge_u32 s2, 256
    s_cbranch_scc1 F_END
    v_lshrrev_b32 v1, 6, v0
    v_and_b32 v0, 63, v0
    s_and_b32 s28, s2, 7
    s_lshr_b32 s29, s2, 3
    v_readfirstlane_b32 s3, v1
    s_and_b32 s30, s28, 1
    s_lshl_b32 s30, s30, 3
    s_and_b32 s31, s29, 7
    s_add_u32 s30, s30, s31
    s_lshr_b32 s31, s28, 1
    s_lshl_b32 s31, s31, 2
    s_lshr_b32 s32, s29, 3
    s_add_u32 s31, s31, s32
    s_cmp_lt_u32 s3, 4
    s_cbranch_scc1 F_C
    s_sub_u32 s34, s3, 4
    v_lshrrev_b32 v2, 3, v0
    v_and_b32 v4, 7, v0
    v_lshlrev_b32 v8, 11, v4
    v_and_b32 v9, 15, v0
    v_min_u32 v9, 11, v9
    v_lshrrev_b32 v7, 2, v9
    v_and_b32 v9, 3, v9
    v_lshlrev_b32 v9, 7, v9
    v_lshl_add_u32 v9, v7, 11, v9
    s_and_b32 s100, s28, 1
    s_lshr_b32 s101, s28, 1
    s_lshl_b32 s40, s100, 21
    s_lshl_b32 s41, s101, 19
    s_add_u32 s99, s40, s41
    s_lshl_b32 s40, s29, 14
    s_lshl_b32 s41, s34, 7
    s_add_u32 s42, s40, s41
    s_add_u32 s42, s42, s99
    s_mul_i32 s98, s100, 6144
    s_lshl_b32 s41, s101, 9
    s_add_u32 s98, s98, s41
    s_lshl_b32 s43, s29, 2
    s_add_u32 s43, s43, s34
    s_mul_i32 s43, s43, 12288
    s_add_u32 s43, s43, s98
    s_mov_b32 s46, 0x400000
    s_mov_b32 s47, 0x00020000
    s_mov_b32 s50, 0x600000
    s_mov_b32 s51, 0x00020000
    s_lshl_b32 s40, s34, 3
    v_add_u32 v3, s40, v2
    v_lshrrev_b32 v5, 4, v0
    s_and_b32 s40, s34, 1
    s_lshl_b32 s41, s40, 2
    v_add_u32 v6, s41, v5
    v_xor_b32 v6, v6, v4
    v_lshlrev_b32 v6, 4, v6
    v_lshl_add_u32 v10, v3, 11, v6
    v_and_b32 v6, 1, v5
    v_lshlrev_b32 v6, 1, v6
    v_or_b32 v6, s41, v6
    v_xor_b32 v6, v6, v4
    v_lshlrev_b32 v6, 4, v6
    v_mul_u32_u24 v11, 6144, v3
    v_add_u32 v11, v11, v6
    s_lshl_b32 s52, s30, 18
    s_add_u32 s53, s52, 64512
    s_add_u32 s54, s52, 129024
    s_add_u32 s55, s52, 193536
    s_lshl_b32 s56, s31, 7
    s_add_u32 s57, s56, 1024
    s_add_u32 s58, s56, 2048
    s_add_u32 s59, s56, 193536
    s_add_u32 s60, s56, 198656
    s_add_u32 s61, s56, 199680
    s_mul_i32 s62, s34, 10240
    s_mov_b32 s63, 393216
    s_waitcnt lgkmcnt(0)
    s_mov_b64 s[44:45], s[4:5]
    s_mov_b64 s[48:49], s[6:7]
    buffer_load_dword v250, v9, s[48:51], s43 offen
    buffer_load_dword v250, v8, s[44:47], s42 offen
    s_add_u32 m0, s62, 45056
    s_nop 0
    buffer_load_dwordx4 v11, s[48:51], s57 offen offset:1024 lds
    buffer_load_dwordx4 v11, s[48:51], s58 offen offset:2048 lds
    buffer_load_dwordx4 v11, s[48:51], s56 offen offset:0 lds
    buffer_load_dwordx4 v11, s[48:51], s59 offen offset:3072 lds
    s_add_u32 m0, s62, 40960
    s_nop 0
    buffer_load_dwordx4 v10, s[44:47], s52 offen offset:0 lds
    buffer_load_dwordx4 v10, s[44:47], s53 offen offset:1024 lds
    buffer_load_dwordx4 v10, s[44:47], s54 offen offset:2048 lds
    buffer_load_dwordx4 v10, s[44:47], s55 offen offset:3072 lds
    s_add_u32 m0, s62, 49152
    s_nop 0
    buffer_load_dwordx4 v11, s[48:51], s60 offen offset:0 lds
    buffer_load_dwordx4 v11, s[48:51], s61 offen offset:1024 lds
    v_add_u32 v10, 128, v10
    v_add_u32 v11, s63, v11
    s_add_u32 m0, s62, 86016
    s_nop 0
    buffer_load_dwordx4 v11, s[48:51], s57 offen offset:1024 lds
    buffer_load_dwordx4 v11, s[48:51], s58 offen offset:2048 lds
    buffer_load_dwordx4 v11, s[48:51], s56 offen offset:0 lds
    buffer_load_dwordx4 v11, s[48:51], s59 offen offset:3072 lds
    s_add_u32 m0, s62, 81920
    s_nop 0
    buffer_load_dwordx4 v10, s[44:47], s52 offen offset:0 lds
    buffer_load_dwordx4 v10, s[44:47], s53 offen offset:1024 lds
    buffer_load_dwordx4 v10, s[44:47], s54 offen offset:2048 lds
    buffer_load_dwordx4 v10, s[44:47], s55 offen offset:3072 lds
    s_add_u32 m0, s62, 90112
    s_nop 0
    buffer_load_dwordx4 v11, s[48:51], s60 offen offset:0 lds
    buffer_load_dwordx4 v11, s[48:51], s61 offen offset:1024 lds
    v_add_u32 v10, 128, v10
    v_add_u32 v11, s63, v11
    s_load_dwordx8 s[20:27], s[0:1], 64
    s_and_b32 s32, s29, 3
    s_lshr_b32 s33, s28, 1
    s_lshl_b32 s33, s33, 2
    s_add_u32 s32, s32, s33
    s_and_b32 s33, s28, 1
    s_lshl_b32 s33, s33, 3
    s_lshr_b32 s35, s29, 2
    s_add_u32 s33, s33, s35
    v_lshlrev_b32 v1, 4, v0
    v_lshlrev_b32 v6, 1, v5
    v_xor_b32 v6, v6, v4
    v_lshlrev_b32 v6, 4, v6
    v_lshl_add_u32 v12, v2, 11, v6
    v_mov_b32 v13, 0
    s_lshl_b32 s35, s2, 2
    s_add_u32 s35, s35, s34
    s_and_b32 s96, s29, 3
    s_waitcnt lgkmcnt(0)
    s_mov_b32 s36, s26
    s_mov_b32 s37, s27
    s_mov_b32 s38, 0x10000000
    s_mov_b32 s39, 0x00020000
    s_mov_b32 s64, s24
    s_mov_b32 s65, s25
    s_mov_b32 s66, 0x100
    s_mov_b32 s67, 0x00020000
    s_lshr_b32 s69, s29, 2
    s_mul_i32 s40, s96, 3
    s_add_u32 s40, s40, 4
    s_add_u32 s41, s40, s34
    s_lshl_b32 s41, s41, 7
    s_add_u32 s99, s99, s41
    s_lshl_b32 s41, s69, 16
    s_add_u32 s99, s99, s41
    s_lshl_b32 s40, s40, 5
    s_mul_i32 s41, s69, 12
    s_add_u32 s40, s40, s41
    s_lshl_b32 s41, s34, 2
    s_add_u32 s40, s40, s41
    s_mul_i32 s40, s40, 12288
    s_add_u32 s98, s98, s40
    s_lshl_b32 s100, s100, 10
    s_lshl_b32 s101, s101, 19
    s_add_u32 s100, s100, s101
    s_lshl_b32 s41, s29, 14
    s_add_u32 s100, s100, s41
    v_and_b32 v16, 31, v0
    v_lshlrev_b32 v16, 11, v16
    v_mul_u32_u24 v17, 12288, v5
    v_add_u32 v17, v17, v9
    v_lshlrev_b32 v18, 7, v4
    v_lshl_add_u32 v18, v2, 11, v18
    s_add_u32 s40, s2, s34
    s_cmp_lg_u32 s40, 0
    s_cbranch_scc1 F_NOTOK
    s_memrealtime s[68:69]
    s_waitcnt lgkmcnt(0)
    s_or_b32 s68, s68, 1
    v_mov_b32 v14, s68
    s_mov_b64 exec, 1
    buffer_store_dword v14, v13, s[64:67], 0 offen sc1
    s_mov_b64 exec, -1
F_NOTOK:
    s_cmp_lg_u32 s96, 0
    s_cbranch_scc1 F_PF0X
    s_cmp_eq_u32 s34, 3
    s_cbranch_scc1 F_PF0X
    buffer_load_dword v250, v17, s[48:51], s98 offen
    buffer_load_dword v250, v16, s[44:47], s99 offen
F_PF0X:
    s_cmp_lg_u32 s96, 0
    s_cbranch_scc1 F_PW0X
    s_cmp_lg_u32 s34, 3
    s_cbranch_scc1 F_PW0X
    s_mov_b32 s40, s8
    s_mov_b32 s41, s9
    s_mov_b32 s42, 0x200000
    s_mov_b32 s43, 0x00020000
    buffer_load_dword v250, v18, s[40:43], s100 offen
F_PW0X:
    s_lshl_b32 s40, s34, 1
    v_xor_b32 v20, s40, v4
    v_lshlrev_b32 v20, 4, v20
    v_lshl_add_u32 v20, v2, 11, v20
    s_lshr_b32 s40, s2, 4
    s_lshl_b32 s40, s40, 18
    s_and_b32 s41, s2, 15
    s_lshl_b32 s41, s41, 7
    s_add_u32 s40, s40, s41
    v_xor_b32 v21, 6, v4
    v_lshlrev_b32 v21, 4, v21
    v_lshl_add_u32 v21, v2, 11, v21
    v_add_u32 v21, s40, v21
    v_subrev_u32 v21, 6144, v21
    s_lshl_b32 s41, s34, 15
    s_add_u32 s40, s40, s41
    v_add_u32 v20, s40, v20
    v_and_b32 v22, 3, v2
    v_xor_b32 v22, s34, v22
    v_lshlrev_b32 v22, 5, v22
    v_lshl_add_u32 v22, v4, 2, v22
    v_lshl_add_u32 v22, v2, 11, v22
    v_add_u32 v22, 123264, v22
    v_add_u32 v23, 3, v2
    v_and_b32 v23, 3, v23
    v_xor_b32 v23, s34, v23
    v_lshlrev_b32 v23, 5, v23
    v_lshl_add_u32 v23, v4, 2, v23
    v_lshl_add_u32 v23, v2, 11, v23
    v_add_u32 v23, 122880, v23
    s_and_b32 s40, s2, 15
    s_lshl_b32 s40, s40, 6
    s_lshl_b32 s41, s34, 4
    s_add_u32 s40, s40, s41
    v_lshlrev_b32 v24, 1, v4
    v_add_u32 v24, s40, v24
    v_mul_u32_u24 v25, 4224, v24
    v_lshlrev_b32 v24, 3, v24
    s_lshr_b32 s40, s2, 4
    s_lshl_b32 s40, s40, 3
    v_add_u32 v26, s40, v2
    v_lshl_add_u32 v25, v26, 4, v25
    v_mov_b32 v44, 0
    v_mov_b32 v45, 0
    v_mov_b32 v46, 0
    v_mov_b32 v47, 0
    v_mov_b32 v48, 0
    v_mov_b32 v49, 0
    v_mov_b32 v50, 0
    v_mov_b32 v51, 0
    v_mov_b32 v52, 0
    v_mov_b32 v53, 0
    v_mov_b32 v54, 0
    v_mov_b32 v55, 0
    v_mov_b32 v56, 0
    v_mov_b32 v57, 0
    v_mov_b32 v58, 0
    v_mov_b32 v59, 0
    v_mov_b32 v60, 0
    v_mov_b32 v61, 0
    v_mov_b32 v62, 0
    v_mov_b32 v63, 0
    v_mov_b32 v64, 0
    v_mov_b32 v65, 0
    v_mov_b32 v66, 0
    v_mov_b32 v67, 0
    v_mov_b32 v68, 0
    v_mov_b32 v69, 0
    v_mov_b32 v70, 0
    v_mov_b32 v71, 0
    v_mov_b32 v72, 0
    v_mov_b32 v73, 0
    v_mov_b32 v74, 0
    v_mov_b32 v75, 0
    v_mov_b32 v76, 0
    v_mov_b32 v77, 0
    v_mov_b32 v78, 0
    v_mov_b32 v79, 0
    s_and_b32 s40, s34, 1
    s_lshl_b32 s41, s31, 1
    s_add_u32 s40, s40, s41
    s_lshr_b32 s41, s34, 1
    s_lshl_b32 s6, s30, 1
    s_add_u32 s6, s6, s41
    s_mul_i32 s6, s6, 132
    s_add_u32 s6, s6, s40
    s_lshl_b32 s6, s6, 10
    s_add_u32 s6, s6, 0x200000
    s_lshl_b32 s4, s40, 15
    s_lshl_b32 s5, s41, 10
    s_add_u32 s7, s4, s5
    s_lshl_b32 s4, s30, 11
    s_add_u32 s4, s4, s7
    s_lshl_b32 s40, s40, 11
    s_add_u32 s69, s40, s5
    s_add_u32 s69, s69, 0x100000
    s_lshl_b32 s5, s30, 6
    s_add_u32 s5, s5, s69
    v_mov_b32 v112, -1
    v_mov_b32 v113, -1
    v_mov_b32 v114, -1
    v_mov_b32 v115, -1
    v_lshlrev_b32 v27, 4, v5
    s_mov_b32 s7, 0xffff0000
    s_lshr_b32 s40, s2, 4
    s_lshl_b32 s40, s40, 4
    s_lshl_b32 s41, s34, 3
    s_add_u32 s40, s40, s41
    v_add_u32 v28, s40, v2
    v_mul_u32_u24 v232, 33792, v4
    v_lshl_add_u32 v232, v28, 4, v232
    v_lshrrev_b32 v29, 6, v28
    v_lshlrev_b32 v29, 9, v29
    v_and_b32 v30, 15, v28
    v_lshl_add_u32 v29, v30, 4, v29
    v_bfe_u32 v30, v28, 4, 2
    v_lshl_add_u32 v29, v30, 2, v29
    v_lshlrev_b32 v30, 4, v4
    v_lshl_add_u32 v234, v29, 11, v30
    v_lshl_add_u32 v233, v29, 12, v30
    s_waitcnt vmcnt(10)
    s_barrier
    s_add_u32 m0, s62, 4096
    s_nop 0
    buffer_load_dwordx4 v11, s[48:51], s57 offen offset:1024 lds
    buffer_load_dwordx4 v11, s[48:51], s58 offen offset:2048 lds
    buffer_load_dwordx4 v11, s[48:51], s56 offen offset:0 lds
    buffer_load_dwordx4 v11, s[48:51], s59 offen offset:3072 lds
    s_add_u32 m0, s62, 0
    s_nop 0
    buffer_load_dwordx4 v10, s[44:47], s52 offen offset:0 lds
    buffer_load_dwordx4 v10, s[44:47], s53 offen offset:1024 lds
    buffer_load_dwordx4 v10, s[44:47], s54 offen offset:2048 lds
    buffer_load_dwordx4 v10, s[44:47], s55 offen offset:3072 lds
    s_add_u32 m0, s62, 8192
    s_nop 0
    buffer_load_dwordx4 v11, s[48:51], s60 offen offset:0 lds
    buffer_load_dwordx4 v11, s[48:51], s61 offen offset:1024 lds
    s_cmp_lg_u32 s96, 2
    s_cbranch_scc1 F_KV2X
    s_lshl_b32 s69, s34, 11
    s_mov_b32 s40, s12
    s_mov_b32 s41, s13
    s_mov_b32 s42, 0x400000
    s_mov_b32 s43, 0x00020000
    s_mov_b32 m0, 122880
    s_mov_b64 exec, 0xffffff
    buffer_load_dwordx4 v21, s[40:43], 0 offen nt lds
    s_mov_b64 exec, -1
    s_add_u32 m0, s69, 123264
    s_mov_b32 s97, 0
    buffer_load_dwordx4 v20, s[40:43], s97 offen nt lds
    s_mov_b32 s97, 15360
    buffer_load_dwordx4 v20, s[40:43], s97 offen offset:1024 nt lds
    s_add_u32 m0, s69, 131456
    s_mov_b32 s97, 131072
    buffer_load_dwordx4 v20, s[40:43], s97 offen nt lds
    s_mov_b32 s97, 146432
    buffer_load_dwordx4 v20, s[40:43], s97 offen offset:1024 nt lds
    s_mov_b32 s40, s14
    s_mov_b32 s41, s15
    s_mov_b32 s42, 0x400000
    s_mov_b32 s43, 0x00020000
    s_add_u32 m0, s69, 139648
    s_mov_b32 s97, 0
    buffer_load_dwordx4 v20, s[40:43], s97 offen nt lds
    s_mov_b32 s97, 15360
    buffer_load_dwordx4 v20, s[40:43], s97 offen offset:1024 nt lds
    s_add_u32 m0, s69, 147840
    s_mov_b32 s97, 131072
    buffer_load_dwordx4 v20, s[40:43], s97 offen nt lds
    s_mov_b32 s97, 146432
    buffer_load_dwordx4 v20, s[40:43], s97 offen offset:1024 nt lds
    s_mov_b32 s40, s16
    s_mov_b32 s41, s17
    s_mov_b32 s42, 0x2000
    s_mov_b32 s43, 0x00020000
    buffer_load_dwordx4 v[32:35], v24, s[40:43], 0 offen
F_KV2X:
    v_add_u32 v10, 128, v10
    v_add_u32 v11, s63, v11
    s_cmp_lg_u32 s96, 2
    s_cbranch_scc1 F_Q2X
    s_cmp_ge_u32 s34, 2
    s_cbranch_scc1 F_Q2X
    s_mov_b32 s40, s10
    s_mov_b32 s41, s11
    s_mov_b32 s42, 0x400000
    s_mov_b32 s43, 0x00020000
    s_and_b32 s69, s2, 15
    s_lshl_b32 s69, s69, 7
    s_add_u32 s97, s69, 0
    buffer_load_dwordx4 v[200:203], v234, s[40:43], s97 offen offset:0 nt
    s_add_u32 s97, s69, 0
    buffer_load_dwordx4 v[204:207], v234, s[40:43], s97 offen offset:2048 nt
    s_add_u32 s97, s69, 4096
    buffer_load_dwordx4 v[208:211], v234, s[40:43], s97 offen offset:0 nt
    s_add_u32 s97, s69, 4096
    buffer_load_dwordx4 v[212:215], v234, s[40:43], s97 offen offset:2048 nt
    s_add_u32 s97, s69, 524288
    buffer_load_dwordx4 v[216:219], v234, s[40:43], s97 offen offset:0 nt
    s_add_u32 s97, s69, 524288
    buffer_load_dwordx4 v[220:223], v234, s[40:43], s97 offen offset:2048 nt
    s_add_u32 s97, s69, 528384
    buffer_load_dwordx4 v[224:227], v234, s[40:43], s97 offen offset:0 nt
    s_add_u32 s97, s69, 528384
    buffer_load_dwordx4 v[228:231], v234, s[40:43], s97 offen offset:2048 nt
F_Q2X:
    s_waitcnt vmcnt(10)
    s_barrier
    s_add_u32 m0, s62, 45056
    s_nop 0
    buffer_load_dwordx4 v11, s[48:51], s57 offen offset:1024 lds
    buffer_load_dwordx4 v11, s[48:51], s58 offen offset:2048 lds
    buffer_load_dwordx4 v11, s[48:51], s56 offen offset:0 lds
    buffer_load_dwordx4 v11, s[48:51], s59 offen offset:3072 lds
    s_cmp_lg_u32 s96, 1
    s_cbranch_scc1 F_PF1X
    s_cmp_eq_u32 s34, 3
    s_cbranch_scc1 F_PF1X
    buffer_load_dword v250, v17, s[48:51], s98 offen
    buffer_load_dword v250, v16, s[44:47], s99 offen
F_PF1X:
    s_add_u32 m0, s62, 40960
    s_nop 0
    buffer_load_dwordx4 v10, s[44:47], s52 offen offset:0 lds
    buffer_load_dwordx4 v10, s[44:47], s53 offen offset:1024 lds
    buffer_load_dwordx4 v10, s[44:47], s54 offen offset:2048 lds
    buffer_load_dwordx4 v10, s[44:47], s55 offen offset:3072 lds
    s_cmp_lg_u32 s96, 1
    s_cbranch_scc1 F_PW1X
    s_cmp_lg_u32 s34, 3
    s_cbranch_scc1 F_PW1X
    s_mov_b32 s40, s8
    s_mov_b32 s41, s9
    s_mov_b32 s42, 0x200000
    s_mov_b32 s43, 0x00020000
    buffer_load_dword v250, v18, s[40:43], s100 offen
F_PW1X:
    s_add_u32 m0, s62, 49152
    s_nop 0
    buffer_load_dwordx4 v11, s[48:51], s60 offen offset:0 lds
    buffer_load_dwordx4 v11, s[48:51], s61 offen offset:1024 lds
    v_add_u32 v10, 128, v10
    v_add_u32 v11, s63, v11
    s_cmp_lg_u32 s96, 3
    s_cbranch_scc1 F_KV3X
    s_lshl_b32 s69, s34, 11
    s_mov_b32 s40, s12
    s_mov_b32 s41, s13
    s_mov_b32 s42, 0x400000
    s_mov_b32 s43, 0x00020000
    s_mov_b32 m0, 122880
    s_mov_b64 exec, 0xffffff
    buffer_load_dwordx4 v21, s[40:43], 0 offen nt lds
    s_mov_b64 exec, -1
    s_add_u32 m0, s69, 123264
    s_mov_b32 s97, 0
    buffer_load_dwordx4 v20, s[40:43], s97 offen nt lds
    s_mov_b32 s97, 15360
    buffer_load_dwordx4 v20, s[40:43], s97 offen offset:1024 nt lds
    s_add_u32 m0, s69, 131456
    s_mov_b32 s97, 131072
    buffer_load_dwordx4 v20, s[40:43], s97 offen nt lds
    s_mov_b32 s97, 146432
    buffer_load_dwordx4 v20, s[40:43], s97 offen offset:1024 nt lds
    s_mov_b32 s40, s14
    s_mov_b32 s41, s15
    s_mov_b32 s42, 0x400000
    s_mov_b32 s43, 0x00020000
    s_add_u32 m0, s69, 139648
    s_mov_b32 s97, 0
    buffer_load_dwordx4 v20, s[40:43], s97 offen nt lds
    s_mov_b32 s97, 15360
    buffer_load_dwordx4 v20, s[40:43], s97 offen offset:1024 nt lds
    s_add_u32 m0, s69, 147840
    s_mov_b32 s97, 131072
    buffer_load_dwordx4 v20, s[40:43], s97 offen nt lds
    s_mov_b32 s97, 146432
    buffer_load_dwordx4 v20, s[40:43], s97 offen offset:1024 nt lds
    s_mov_b32 s40, s16
    s_mov_b32 s41, s17
    s_mov_b32 s42, 0x2000
    s_mov_b32 s43, 0x00020000
    buffer_load_dwordx4 v[32:35], v24, s[40:43], 0 offen
F_KV3X:
    s_cmp_lg_u32 s96, 3
    s_cbranch_scc1 F_Q3X
    s_cmp_ge_u32 s34, 2
    s_cbranch_scc1 F_Q3X
    s_mov_b32 s40, s10
    s_mov_b32 s41, s11
    s_mov_b32 s42, 0x400000
    s_mov_b32 s43, 0x00020000
    s_and_b32 s69, s2, 15
    s_lshl_b32 s69, s69, 7
    s_add_u32 s97, s69, 0
    buffer_load_dwordx4 v[200:203], v234, s[40:43], s97 offen offset:0 nt
    s_add_u32 s97, s69, 0
    buffer_load_dwordx4 v[204:207], v234, s[40:43], s97 offen offset:2048 nt
    s_add_u32 s97, s69, 4096
    buffer_load_dwordx4 v[208:211], v234, s[40:43], s97 offen offset:0 nt
    s_add_u32 s97, s69, 4096
    buffer_load_dwordx4 v[212:215], v234, s[40:43], s97 offen offset:2048 nt
    s_add_u32 s97, s69, 524288
    buffer_load_dwordx4 v[216:219], v234, s[40:43], s97 offen offset:0 nt
    s_add_u32 s97, s69, 524288
    buffer_load_dwordx4 v[220:223], v234, s[40:43], s97 offen offset:2048 nt
    s_add_u32 s97, s69, 528384
    buffer_load_dwordx4 v[224:227], v234, s[40:43], s97 offen offset:0 nt
    s_add_u32 s97, s69, 528384
    buffer_load_dwordx4 v[228:231], v234, s[40:43], s97 offen offset:2048 nt
F_Q3X:
    s_waitcnt vmcnt(10)
    s_barrier
    s_add_u32 m0, s62, 86016
    s_nop 0
    buffer_load_dwordx4 v11, s[48:51], s57 offen offset:1024 lds
    buffer_load_dwordx4 v11, s[48:51], s58 offen offset:2048 lds
    buffer_load_dwordx4 v11, s[48:51], s56 offen offset:0 lds
    buffer_load_dwordx4 v11, s[48:51], s59 offen offset:3072 lds
    s_add_u32 m0, s62, 81920
    s_nop 0
    buffer_load_dwordx4 v10, s[44:47], s52 offen offset:0 lds
    buffer_load_dwordx4 v10, s[44:47], s53 offen offset:1024 lds
    buffer_load_dwordx4 v10, s[44:47], s54 offen offset:2048 lds
    buffer_load_dwordx4 v10, s[44:47], s55 offen offset:3072 lds
    s_cmp_lg_u32 s96, 0
    s_cbranch_scc1 F_KV0X
    s_lshl_b32 s69, s34, 11
    s_mov_b32 s40, s12
    s_mov_b32 s41, s13
    s_mov_b32 s42, 0x400000
    s_mov_b32 s43, 0x00020000
    s_mov_b32 m0, 122880
    s_mov_b64 exec, 0xffffff
    buffer_load_dwordx4 v21, s[40:43], 0 offen nt lds
    s_mov_b64 exec, -1
    s_add_u32 m0, s69, 123264
    s_mov_b32 s97, 0
    buffer_load_dwordx4 v20, s[40:43], s97 offen nt lds
    s_mov_b32 s97, 15360
    buffer_load_dwordx4 v20, s[40:43], s97 offen offset:1024 nt lds
    s_add_u32 m0, s69, 131456
    s_mov_b32 s97, 131072
    buffer_load_dwordx4 v20, s[40:43], s97 offen nt lds
    s_mov_b32 s97, 146432
    buffer_load_dwordx4 v20, s[40:43], s97 offen offset:1024 nt lds
    s_mov_b32 s40, s14
    s_mov_b32 s41, s15
    s_mov_b32 s42, 0x400000
    s_mov_b32 s43, 0x00020000
    s_add_u32 m0, s69, 139648
    s_mov_b32 s97, 0
    buffer_load_dwordx4 v20, s[40:43], s97 offen nt lds
    s_mov_b32 s97, 15360
    buffer_load_dwordx4 v20, s[40:43], s97 offen offset:1024 nt lds
    s_add_u32 m0, s69, 147840
    s_mov_b32 s97, 131072
    buffer_load_dwordx4 v20, s[40:43], s97 offen nt lds
    s_mov_b32 s97, 146432
    buffer_load_dwordx4 v20, s[40:43], s97 offen offset:1024 nt lds
    s_mov_b32 s40, s16
    s_mov_b32 s41, s17
    s_mov_b32 s42, 0x2000
    s_mov_b32 s43, 0x00020000
    buffer_load_dwordx4 v[32:35], v24, s[40:43], 0 offen
F_KV0X:
    s_add_u32 m0, s62, 90112
    s_nop 0
    buffer_load_dwordx4 v11, s[48:51], s60 offen offset:0 lds
    buffer_load_dwordx4 v11, s[48:51], s61 offen offset:1024 lds
    s_cmp_lg_u32 s96, 1
    s_cbranch_scc1 F_KV1X
    s_lshl_b32 s69, s34, 11
    s_mov_b32 s40, s12
    s_mov_b32 s41, s13
    s_mov_b32 s42, 0x400000
    s_mov_b32 s43, 0x00020000
    s_mov_b32 m0, 122880
    s_mov_b64 exec, 0xffffff
    buffer_load_dwordx4 v21, s[40:43], 0 offen nt lds
    s_mov_b64 exec, -1
    s_add_u32 m0, s69, 123264
    s_mov_b32 s97, 0
    buffer_load_dwordx4 v20, s[40:43], s97 offen nt lds
    s_mov_b32 s97, 15360
    buffer_load_dwordx4 v20, s[40:43], s97 offen offset:1024 nt lds
    s_add_u32 m0, s69, 131456
    s_mov_b32 s97, 131072
    buffer_load_dwordx4 v20, s[40:43], s97 offen nt lds
    s_mov_b32 s97, 146432
    buffer_load_dwordx4 v20, s[40:43], s97 offen offset:1024 nt lds
    s_mov_b32 s40, s14
    s_mov_b32 s41, s15
    s_mov_b32 s42, 0x400000
    s_mov_b32 s43, 0x00020000
    s_add_u32 m0, s69, 139648
    s_mov_b32 s97, 0
    buffer_load_dwordx4 v20, s[40:43], s97 offen nt lds
    s_mov_b32 s97, 15360
    buffer_load_dwordx4 v20, s[40:43], s97 offen offset:1024 nt lds
    s_add_u32 m0, s69, 147840
    s_mov_b32 s97, 131072
    buffer_load_dwordx4 v20, s[40:43], s97 offen nt lds
    s_mov_b32 s97, 146432
    buffer_load_dwordx4 v20, s[40:43], s97 offen offset:1024 nt lds
    s_mov_b32 s40, s16
    s_mov_b32 s41, s17
    s_mov_b32 s42, 0x2000
    s_mov_b32 s43, 0x00020000
    buffer_load_dwordx4 v[32:35], v24, s[40:43], 0 offen
F_KV1X:
    v_add_u32 v10, 128, v10
    v_add_u32 v11, s63, v11
    s_cmp_lg_u32 s96, 2
    s_cbranch_scc1 F_CL2X
    buffer_store_dwordx4 v[112:115], v1, s[36:39], s4 offen sc1
    s_mov_b32 exec_lo, 0x00010001
    s_mov_b32 exec_hi, 0x00010001
    buffer_store_dwordx4 v[112:115], v27, s[36:39], s5 offen sc1
    s_mov_b64 exec, -1
    buffer_store_dwordx4 v[112:115], v1, s[36:39], s6 offen sc1
    s_add_u32 s6, s6, 33792
    buffer_store_dwordx4 v[112:115], v1, s[36:39], s6 offen sc1
    s_add_u32 s6, s6, 33792
    buffer_store_dwordx4 v[112:115], v1, s[36:39], s6 offen sc1
    s_add_u32 s6, s6, 33792
    buffer_store_dwordx4 v[112:115], v1, s[36:39], s6 offen sc1
F_CL2X:
    s_cmp_lg_u32 s96, 0
    s_cbranch_scc1 F_Q0X
    s_cmp_ge_u32 s34, 2
    s_cbranch_scc1 F_Q0X
    s_mov_b32 s40, s10
    s_mov_b32 s41, s11
    s_mov_b32 s42, 0x400000
    s_mov_b32 s43, 0x00020000
    s_and_b32 s69, s2, 15
    s_lshl_b32 s69, s69, 7
    s_add_u32 s97, s69, 0
    buffer_load_dwordx4 v[200:203], v234, s[40:43], s97 offen offset:0 nt
    s_add_u32 s97, s69, 0
    buffer_load_dwordx4 v[204:207], v234, s[40:43], s97 offen offset:2048 nt
    s_add_u32 s97, s69, 4096
    buffer_load_dwordx4 v[208:211], v234, s[40:43], s97 offen offset:0 nt
    s_add_u32 s97, s69, 4096
    buffer_load_dwordx4 v[212:215], v234, s[40:43], s97 offen offset:2048 nt
    s_add_u32 s97, s69, 524288
    buffer_load_dwordx4 v[216:219], v234, s[40:43], s97 offen offset:0 nt
    s_add_u32 s97, s69, 524288
    buffer_load_dwordx4 v[220:223], v234, s[40:43], s97 offen offset:2048 nt
    s_add_u32 s97, s69, 528384
    buffer_load_dwordx4 v[224:227], v234, s[40:43], s97 offen offset:0 nt
    s_add_u32 s97, s69, 528384
    buffer_load_dwordx4 v[228:231], v234, s[40:43], s97 offen offset:2048 nt
F_Q0X:
    s_cmp_lg_u32 s96, 1
    s_cbranch_scc1 F_Q1X
    s_cmp_ge_u32 s34, 2
    s_cbranch_scc1 F_Q1X
    s_mov_b32 s40, s10
    s_mov_b32 s41, s11
    s_mov_b32 s42, 0x400000
    s_mov_b32 s43, 0x00020000
    s_and_b32 s69, s2, 15
    s_lshl_b32 s69, s69, 7
    s_add_u32 s97, s69, 0
    buffer_load_dwordx4 v[200:203], v234, s[40:43], s97 offen offset:0 nt
    s_add_u32 s97, s69, 0
    buffer_load_dwordx4 v[204:207], v234, s[40:43], s97 offen offset:2048 nt
    s_add_u32 s97, s69, 4096
    buffer_load_dwordx4 v[208:211], v234, s[40:43], s97 offen offset:0 nt
    s_add_u32 s97, s69, 4096
    buffer_load_dwordx4 v[212:215], v234, s[40:43], s97 offen offset:2048 nt
    s_add_u32 s97, s69, 524288
    buffer_load_dwordx4 v[216:219], v234, s[40:43], s97 offen offset:0 nt
    s_add_u32 s97, s69, 524288
    buffer_load_dwordx4 v[220:223], v234, s[40:43], s97 offen offset:2048 nt
    s_add_u32 s97, s69, 528384
    buffer_load_dwordx4 v[224:227], v234, s[40:43], s97 offen offset:0 nt
    s_add_u32 s97, s69, 528384
    buffer_load_dwordx4 v[228:231], v234, s[40:43], s97 offen offset:2048 nt
F_Q1X:
    s_waitcnt vmcnt(10)
    s_barrier
    s_add_u32 m0, s62, 4096
    s_nop 0
    buffer_load_dwordx4 v11, s[48:51], s57 offen offset:1024 lds
    buffer_load_dword v14, v13, s[64:67], 0 offen sc1
    buffer_load_dwordx4 v11, s[48:51], s58 offen offset:2048 lds
    buffer_load_dwordx4 v11, s[48:51], s56 offen offset:0 lds
    buffer_load_dwordx4 v11, s[48:51], s59 offen offset:3072 lds
    s_add_u32 m0, s62, 0
    s_nop 0
    buffer_load_dwordx4 v10, s[44:47], s52 offen offset:0 lds
    buffer_load_dwordx4 v10, s[44:47], s53 offen offset:1024 lds
    buffer_load_dwordx4 v10, s[44:47], s54 offen offset:2048 lds
    buffer_load_dwordx4 v10, s[44:47], s55 offen offset:3072 lds
    s_add_u32 m0, s62, 8192
    s_nop 0
    buffer_load_dwordx4 v11, s[48:51], s60 offen offset:0 lds
    buffer_load_dwordx4 v11, s[48:51], s61 offen offset:1024 lds
    s_cmp_lg_u32 s96, 3
    s_cbranch_scc1 F_CL3X
    buffer_store_dwordx4 v[112:115], v1, s[36:39], s4 offen sc1
    s_mov_b32 exec_lo, 0x00010001
    s_mov_b32 exec_hi, 0x00010001
    buffer_store_dwordx4 v[112:115], v27, s[36:39], s5 offen sc1
    s_mov_b64 exec, -1
    buffer_store_dwordx4 v[112:115], v1, s[36:39], s6 offen sc1
    s_add_u32 s6, s6, 33792
    buffer_store_dwordx4 v[112:115], v1, s[36:39], s6 offen sc1
    s_add_u32 s6, s6, 33792
    buffer_store_dwordx4 v[112:115], v1, s[36:39], s6 offen sc1
    s_add_u32 s6, s6, 33792
    buffer_store_dwordx4 v[112:115], v1, s[36:39], s6 offen sc1
F_CL3X:
    v_add_u32 v10, 128, v10
    v_add_u32 v11, s63, v11
    s_waitcnt vmcnt(11)
    s_barrier
    s_add_u32 m0, s62, 45056
    s_nop 0
    buffer_load_dwordx4 v11, s[48:51], s57 offen offset:1024 lds
    buffer_load_dwordx4 v11, s[48:51], s58 offen offset:2048 lds
    buffer_load_dwordx4 v11, s[48:51], s56 offen offset:0 lds
    buffer_load_dwordx4 v11, s[48:51], s59 offen offset:3072 lds
    s_cmp_lg_u32 s96, 2
    s_cbranch_scc1 F_PF2X
    s_cmp_eq_u32 s34, 3
    s_cbranch_scc1 F_PF2X
    buffer_load_dword v250, v17, s[48:51], s98 offen
    buffer_load_dword v250, v16, s[44:47], s99 offen
F_PF2X:
    s_add_u32 m0, s62, 40960
    s_nop 0
    buffer_load_dwordx4 v10, s[44:47], s52 offen offset:0 lds
    buffer_load_dwordx4 v10, s[44:47], s53 offen offset:1024 lds
    buffer_load_dwordx4 v10, s[44:47], s54 offen offset:2048 lds
    buffer_load_dwordx4 v10, s[44:47], s55 offen offset:3072 lds
    s_cmp_lg_u32 s96, 2
    s_cbranch_scc1 F_PW2X
    s_cmp_lg_u32 s34, 3
    s_cbranch_scc1 F_PW2X
    s_mov_b32 s40, s8
    s_mov_b32 s41, s9
    s_mov_b32 s42, 0x200000
    s_mov_b32 s43, 0x00020000
    buffer_load_dword v250, v18, s[40:43], s100 offen
F_PW2X:
    s_add_u32 m0, s62, 49152
    s_nop 0
    buffer_load_dwordx4 v11, s[48:51], s60 offen offset:0 lds
    buffer_load_dwordx4 v11, s[48:51], s61 offen offset:1024 lds
    v_add_u32 v10, 128, v10
    v_add_u32 v11, s63, v11
    s_cmp_lg_u32 s96, 0
    s_cbranch_scc1 F_CL0X
    buffer_store_dwordx4 v[112:115], v1, s[36:39], s4 offen sc1
    s_mov_b32 exec_lo, 0x00010001
    s_mov_b32 exec_hi, 0x00010001
    buffer_store_dwordx4 v[112:115], v27, s[36:39], s5 offen sc1
    s_mov_b64 exec, -1
    buffer_store_dwordx4 v[112:115], v1, s[36:39], s6 offen sc1
    s_add_u32 s6, s6, 33792
    buffer_store_dwordx4 v[112:115], v1, s[36:39], s6 offen sc1
    s_add_u32 s6, s6, 33792
    buffer_store_dwordx4 v[112:115], v1, s[36:39], s6 offen sc1
    s_add_u32 s6, s6, 33792
    buffer_store_dwordx4 v[112:115], v1, s[36:39], s6 offen sc1
F_CL0X:
    s_waitcnt vmcnt(10)
    s_barrier
    s_add_u32 m0, s62, 86016
    s_nop 0
    buffer_load_dwordx4 v11, s[48:51], s57 offen offset:1024 lds
    buffer_load_dwordx4 v11, s[48:51], s58 offen offset:2048 lds
    buffer_load_dwordx4 v11, s[48:51], s56 offen offset:0 lds
    buffer_load_dwordx4 v11, s[48:51], s59 offen offset:3072 lds
    v_readfirstlane_b32 s68, v14
    s_mov_b32 s69, 0
F_TK:
    s_cmp_lg_u32 s68, 0
    s_cbranch_scc1 F_TKX
    buffer_load_dword v14, v13, s[64:67], 0 offen sc1
    s_waitcnt vmcnt(0)
    v_readfirstlane_b32 s68, v14
    s_add_u32 s69, s69, 1
    s_cmp_lt_u32 s69, 400000
    s_cbranch_scc1 F_TK
F_TKX:
    ds_read_u16_d16_hi v44, v23 offset:0
    ds_read_u16_d16_hi v45, v23 offset:128
    ds_read_u16_d16_hi v46, v23 offset:256
    ds_read_u16_d16_hi v47, v22 offset:0
    ds_read_u16_d16_hi v48, v22 offset:128
    s_add_u32 m0, s62, 81920
    s_nop 0
    buffer_load_dwordx4 v10, s[44:47], s52 offen offset:0 lds
    ds_read_u16_d16_hi v49, v22 offset:256
    ds_read_u16_d16_hi v50, v22 offset:384
    ds_read_u16_d16_hi v51, v22 offset:512
    ds_read_u16_d16_hi v52, v22 offset:640
    ds_read_u16_d16_hi v53, v22 offset:768
    ds_read_u16_d16_hi v54, v22 offset:896
    buffer_load_dwordx4 v10, s[44:47], s53 offen offset:1024 lds
    ds_read_u16_d16_hi v55, v22 offset:1024
    v_lshlrev_b32 v36, 16, v32
    v_and_b32 v37, s7, v32
    v_lshlrev_b32 v38, 16, v33
    v_and_b32 v39, s7, v33
    s_waitcnt lgkmcnt(4)
    v_mul_f32 v80, v39, v44
    buffer_load_dwordx4 v10, s[44:47], s54 offen offset:2048 lds
    ds_read_u16_d16_hi v56, v22 offset:1152
    v_mul_f32 v81, v39, v45
    ds_read_u16_d16_hi v57, v22 offset:1280
    v_mul_f32 v82, v39, v46
    ds_read_u16_d16_hi v58, v22 offset:1408
    v_mul_f32 v83, v39, v47
    buffer_load_dwordx4 v10, s[44:47], s55 offen offset:3072 lds
    ds_read_u16_d16_hi v59, v22 offset:1536
    v_mul_f32 v84, v39, v48
    ds_read_u16_d16_hi v60, v22 offset:1664
    v_mul_f32 v85, v39, v49
    ds_read_u16_d16_hi v61, v22 offset:1792
    v_mul_f32 v86, v39, v50
    s_add_u32 m0, s62, 90112
    s_nop 0
    buffer_load_dwordx4 v11, s[48:51], s60 offen offset:0 lds
    ds_read_u16_d16_hi v62, v22 offset:1920
    v_mul_f32 v87, v39, v51
    ds_read_u16_d16_hi v64, v22 offset:16384
    s_waitcnt lgkmcnt(4)
    v_mul_f32 v88, v39, v52
    ds_read_u16_d16_hi v65, v22 offset:16512
    v_mul_f32 v89, v39, v53
    buffer_load_dwordx4 v11, s[48:51], s61 offen offset:1024 lds
    ds_read_u16_d16_hi v66, v22 offset:16640
    v_mul_f32 v90, v39, v54
    ds_read_u16_d16_hi v67, v22 offset:16768
    v_mul_f32 v91, v39, v55
    ds_read_u16_d16_hi v68, v22 offset:16896
    v_mul_f32 v92, v39, v56
    v_add_u32 v10, 128, v10
    v_add_u32 v11, s63, v11
    ds_read_u16_d16_hi v69, v22 offset:17024
    v_mul_f32 v93, v39, v57
    ds_read_u16_d16_hi v70, v22 offset:17152
    v_mul_f32 v94, v39, v58
    ds_read_u16_d16_hi v71, v22 offset:17280
    v_mul_f32 v95, v39, v59
    ds_read_u16_d16_hi v72, v22 offset:17408
    s_waitcnt lgkmcnt(9)
    v_fmac_f32 v80, v38, v45
    ds_read_u16_d16_hi v73, v22 offset:17536
    v_fmac_f32 v81, v38, v46
    ds_read_u16_d16_hi v74, v22 offset:17664
    s_waitcnt vmcnt(10)
    s_barrier
    s_add_u32 m0, s62, 4096
    s_nop 0
    buffer_load_dwordx4 v11, s[48:51], s57 offen offset:1024 lds
    buffer_load_dwordx4 v11, s[48:51], s58 offen offset:2048 lds
    buffer_load_dwordx4 v11, s[48:51], s56 offen offset:0 lds
    buffer_load_dwordx4 v11, s[48:51], s59 offen offset:3072 lds
    s_cmp_lg_u32 s96, 1
    s_cbranch_scc1 F_CL1X
    buffer_store_dwordx4 v[112:115], v1, s[36:39], s4 offen sc1
    s_mov_b32 exec_lo, 0x00010001
    s_mov_b32 exec_hi, 0x00010001
    buffer_store_dwordx4 v[112:115], v27, s[36:39], s5 offen sc1
    s_mov_b64 exec, -1
    buffer_store_dwordx4 v[112:115], v1, s[36:39], s6 offen sc1
    s_add_u32 s6, s6, 33792
    buffer_store_dwordx4 v[112:115], v1, s[36:39], s6 offen sc1
    s_add_u32 s6, s6, 33792
    buffer_store_dwordx4 v[112:115], v1, s[36:39], s6 offen sc1
    s_add_u32 s6, s6, 33792
    buffer_store_dwordx4 v[112:115], v1, s[36:39], s6 offen sc1
F_CL1X:
    v_fmac_f32 v82, v38, v47
    ds_read_u16_d16_hi v75, v22 offset:17792
    v_fmac_f32 v83, v38, v48
    s_add_u32 m0, s62, 0
    s_nop 0
    buffer_load_dwordx4 v10, s[44:47], s52 offen offset:0 lds
    ds_read_u16_d16_hi v76, v22 offset:17920
    v_fmac_f32 v84, v38, v49
    ds_read_u16_d16_hi v77, v22 offset:18048
    v_fmac_f32 v85, v38, v50
    ds_read_u16_d16_hi v78, v22 offset:18176
    v_fmac_f32 v86, v38, v51
    buffer_load_dwordx4 v10, s[44:47], s53 offen offset:1024 lds
    ds_read_u16_d16_hi v79, v22 offset:18304
    v_fmac_f32 v87, v38, v52
    v_fmac_f32 v88, v38, v53
    v_fmac_f32 v89, v38, v54
    v_fmac_f32 v90, v38, v55
    v_fmac_f32 v91, v38, v56
    buffer_load_dwordx4 v10, s[44:47], s54 offen offset:2048 lds
    v_fmac_f32 v92, v38, v57
    v_fmac_f32 v93, v38, v58
    v_fmac_f32 v94, v38, v59
    v_fmac_f32 v95, v38, v60
    v_fmac_f32 v80, v37, v46
    v_fmac_f32 v81, v37, v47
    buffer_load_dwordx4 v10, s[44:47], s55 offen offset:3072 lds
    v_fmac_f32 v82, v37, v48
    v_fmac_f32 v83, v37, v49
    v_fmac_f32 v84, v37, v50
    v_fmac_f32 v85, v37, v51
    v_fmac_f32 v86, v37, v52
    v_fmac_f32 v87, v37, v53
    s_add_u32 m0, s62, 8192
    s_nop 0
    buffer_load_dwordx4 v11, s[48:51], s60 offen offset:0 lds
    v_fmac_f32 v88, v37, v54
    v_fmac_f32 v89, v37, v55
    v_fmac_f32 v90, v37, v56
    v_fmac_f32 v91, v37, v57
    v_fmac_f32 v92, v37, v58
    v_fmac_f32 v93, v37, v59
    buffer_load_dwordx4 v11, s[48:51], s61 offen offset:1024 lds
    v_fmac_f32 v94, v37, v60
    v_fmac_f32 v95, v37, v61
    v_fmac_f32 v80, v36, v47
    v_fmac_f32 v81, v36, v48
    v_fmac_f32 v82, v36, v49
    v_fmac_f32 v83, v36, v50
    v_add_u32 v10, 128, v10
    v_add_u32 v11, s63, v11
    v_fmac_f32 v84, v36, v51
    v_fmac_f32 v85, v36, v52
    v_fmac_f32 v86, v36, v53
    v_fmac_f32 v87, v36, v54
    v_fmac_f32 v88, v36, v55
    v_fmac_f32 v89, v36, v56
    v_fmac_f32 v90, v36, v57
    v_fmac_f32 v91, v36, v58
    v_fmac_f32 v92, v36, v59
    v_fmac_f32 v93, v36, v60
    v_fmac_f32 v94, v36, v61
    v_fmac_f32 v95, v36, v62
    s_waitcnt lgkmcnt(0)
    v_mul_f32 v80, v80, v64
    s_waitcnt vmcnt(10)
    s_barrier
    s_add_u32 m0, s62, 45056
    s_nop 0
    buffer_load_dwordx4 v11, s[48:51], s57 offen offset:1024 lds
    buffer_load_dwordx4 v11, s[48:51], s58 offen offset:2048 lds
    buffer_load_dwordx4 v11, s[48:51], s56 offen offset:0 lds
    buffer_load_dwordx4 v11, s[48:51], s59 offen offset:3072 lds
    s_cmp_lg_u32 s96, 3
    s_cbranch_scc1 F_PF3X
    s_cmp_eq_u32 s34, 3
    s_cbranch_scc1 F_PF3X
    buffer_load_dword v250, v17, s[48:51], s98 offen
    buffer_load_dword v250, v16, s[44:47], s99 offen
F_PF3X:
    s_cmp_lg_u32 s96, 3
    s_cbranch_scc1 F_PW3X
    s_cmp_lg_u32 s34, 3
    s_cbranch_scc1 F_PW3X
    s_mov_b32 s40, s8
    s_mov_b32 s41, s9
    s_mov_b32 s42, 0x200000
    s_mov_b32 s43, 0x00020000
    buffer_load_dword v250, v18, s[40:43], s100 offen
F_PW3X:
    v_mul_f32 v81, v81, v65
    v_mul_f32 v82, v82, v66
    v_mul_f32 v83, v83, v67
    v_mul_f32 v84, v84, v68
    s_add_u32 m0, s62, 40960
    s_nop 0
    buffer_load_dwordx4 v10, s[44:47], s52 offen offset:0 lds
    v_mul_f32 v85, v85, v69
    v_mul_f32 v86, v86, v70
    v_mul_f32 v87, v87, v71
    v_mul_f32 v88, v88, v72
    v_mul_f32 v89, v89, v73
    v_mul_f32 v90, v90, v74
    buffer_load_dwordx4 v10, s[44:47], s53 offen offset:1024 lds
    v_mul_f32 v91, v91, v75
    v_mul_f32 v92, v92, v76
    v_mul_f32 v93, v93, v77
    v_mul_f32 v94, v94, v78
    v_mul_f32 v95, v95, v79
    v_cvt_pk_bf16_f32 v96, v92, v88
    buffer_load_dwordx4 v10, s[44:47], s54 offen offset:2048 lds
    v_cvt_pk_bf16_f32 v97, v84, v80
    v_cvt_pk_bf16_f32 v98, v94, v90
    v_cvt_pk_bf16_f32 v99, v86, v82
    v_cvt_pk_bf16_f32 v100, v93, v89
    v_cvt_pk_bf16_f32 v101, v85, v81
    v_cvt_pk_bf16_f32 v102, v95, v91
    buffer_load_dwordx4 v10, s[44:47], s55 offen offset:3072 lds
    v_cvt_pk_bf16_f32 v103, v87, v83
    ds_read_u16_d16_hi v44, v23 offset:2
    ds_read_u16_d16_hi v45, v23 offset:130
    ds_read_u16_d16_hi v46, v23 offset:258
    ds_read_u16_d16_hi v47, v22 offset:2
    ds_read_u16_d16_hi v48, v22 offset:130
    s_add_u32 m0, s62, 49152
    s_nop 0
    buffer_load_dwordx4 v11, s[48:51], s60 offen offset:0 lds
    ds_read_u16_d16_hi v49, v22 offset:258
    ds_read_u16_d16_hi v50, v22 offset:386
    ds_read_u16_d16_hi v51, v22 offset:514
    ds_read_u16_d16_hi v52, v22 offset:642
    ds_read_u16_d16_hi v53, v22 offset:770
    ds_read_u16_d16_hi v54, v22 offset:898
    buffer_load_dwordx4 v11, s[48:51], s61 offen offset:1024 lds
    ds_read_u16_d16_hi v55, v22 offset:1026
    v_lshlrev_b32 v36, 16, v34
    v_and_b32 v37, s7, v34
    v_lshlrev_b32 v38, 16, v35
    v_and_b32 v39, s7, v35
    s_waitcnt lgkmcnt(4)
    v_mul_f32 v80, v39, v44
    v_add_u32 v10, 128, v10
    v_add_u32 v11, s63, v11
    ds_read_u16_d16_hi v56, v22 offset:1154
    v_mul_f32 v81, v39, v45
    ds_read_u16_d16_hi v57, v22 offset:1282
    v_mul_f32 v82, v39, v46
    ds_read_u16_d16_hi v58, v22 offset:1410
    v_mul_f32 v83, v39, v47
    ds_read_u16_d16_hi v59, v22 offset:1538
    v_mul_f32 v84, v39, v48
    ds_read_u16_d16_hi v60, v22 offset:1666
    v_mul_f32 v85, v39, v49
    ds_read_u16_d16_hi v61, v22 offset:1794
    v_mul_f32 v86, v39, v50
    s_waitcnt vmcnt(10)
    s_barrier
    s_add_u32 m0, s62, 86016
    s_nop 0
    buffer_load_dwordx4 v11, s[48:51], s57 offen offset:1024 lds
    ds_read_u16_d16_hi v62, v22 offset:1922
    v_mul_f32 v87, v39, v51
    ds_read_u16_d16_hi v64, v22 offset:16386
    s_waitcnt lgkmcnt(4)
    v_mul_f32 v88, v39, v52
    ds_read_u16_d16_hi v65, v22 offset:16514
    v_mul_f32 v89, v39, v53
    buffer_load_dwordx4 v11, s[48:51], s58 offen offset:2048 lds
    ds_read_u16_d16_hi v66, v22 offset:16642
    v_mul_f32 v90, v39, v54
    ds_read_u16_d16_hi v67, v22 offset:16770
    v_mul_f32 v91, v39, v55
    ds_read_u16_d16_hi v68, v22 offset:16898
    v_mul_f32 v92, v39, v56
    buffer_load_dwordx4 v11, s[48:51], s56 offen offset:0 lds
    ds_read_u16_d16_hi v69, v22 offset:17026
    v_mul_f32 v93, v39, v57
    ds_read_u16_d16_hi v70, v22 offset:17154
    v_mul_f32 v94, v39, v58
    ds_read_u16_d16_hi v71, v22 offset:17282
    v_mul_f32 v95, v39, v59
    buffer_load_dwordx4 v11, s[48:51], s59 offen offset:3072 lds
    ds_read_u16_d16_hi v72, v22 offset:17410
    s_waitcnt lgkmcnt(9)
    v_fmac_f32 v80, v38, v45
    ds_read_u16_d16_hi v73, v22 offset:17538
    v_fmac_f32 v81, v38, v46
    ds_read_u16_d16_hi v74, v22 offset:17666
    v_fmac_f32 v82, v38, v47
    s_add_u32 m0, s62, 81920
    s_nop 0
    buffer_load_dwordx4 v10, s[44:47], s52 offen offset:0 lds
    ds_read_u16_d16_hi v75, v22 offset:17794
    v_fmac_f32 v83, v38, v48
    ds_read_u16_d16_hi v76, v22 offset:17922
    v_fmac_f32 v84, v38, v49
    ds_read_u16_d16_hi v77, v22 offset:18050
    v_fmac_f32 v85, v38, v50
    buffer_load_dwordx4 v10, s[44:47], s53 offen offset:1024 lds
    ds_read_u16_d16_hi v78, v22 offset:18178
    v_fmac_f32 v86, v38, v51
    ds_read_u16_d16_hi v79, v22 offset:18306
    v_fmac_f32 v87, v38, v52
    v_fmac_f32 v88, v38, v53
    v_fmac_f32 v89, v38, v54
    buffer_load_dwordx4 v10, s[44:47], s54 offen offset:2048 lds
    v_fmac_f32 v90, v38, v55
    v_fmac_f32 v91, v38, v56
    v_fmac_f32 v92, v38, v57
    v_fmac_f32 v93, v38, v58
    v_fmac_f32 v94, v38, v59
    v_fmac_f32 v95, v38, v60
    buffer_load_dwordx4 v10, s[44:47], s55 offen offset:3072 lds
    v_fmac_f32 v80, v37, v46
    v_fmac_f32 v81, v37, v47
    v_fmac_f32 v82, v37, v48
    v_fmac_f32 v83, v37, v49
    v_fmac_f32 v84, v37, v50
    v_fmac_f32 v85, v37, v51
    s_add_u32 m0, s62, 90112
    s_nop 0
    buffer_load_dwordx4 v11, s[48:51], s60 offen offset:0 lds
    v_fmac_f32 v86, v37, v52
    v_fmac_f32 v87, v37, v53
    v_fmac_f32 v88, v37, v54
    v_fmac_f32 v89, v37, v55
    buffer_load_dwordx4 v11, s[48:51], s61 offen offset:1024 lds
    v_add_u32 v10, 128, v10
    v_add_u32 v11, s63, v11
    s_waitcnt vmcnt(10)
    s_barrier
    s_add_u32 m0, s62, 4096
    s_nop 0
    buffer_load_dwordx4 v11, s[48:51], s57 offen offset:1024 lds
    v_fmac_f32 v90, v37, v56
    v_fmac_f32 v91, v37, v57
    v_fmac_f32 v92, v37, v58
    v_fmac_f32 v93, v37, v59
    v_fmac_f32 v94, v37, v60
    buffer_load_dwordx4 v11, s[48:51], s58 offen offset:2048 lds
    v_fmac_f32 v95, v37, v61
    v_fmac_f32 v80, v36, v47
    v_fmac_f32 v81, v36, v48
    v_fmac_f32 v82, v36, v49
    v_fmac_f32 v83, v36, v50
    buffer_load_dwordx4 v11, s[48:51], s56 offen offset:0 lds
    v_fmac_f32 v84, v36, v51
    v_fmac_f32 v85, v36, v52
    v_fmac_f32 v86, v36, v53
    v_fmac_f32 v87, v36, v54
    v_fmac_f32 v88, v36, v55
    buffer_load_dwordx4 v11, s[48:51], s59 offen offset:3072 lds
    v_fmac_f32 v89, v36, v56
    v_fmac_f32 v90, v36, v57
    v_fmac_f32 v91, v36, v58
    v_fmac_f32 v92, v36, v59
    v_fmac_f32 v93, v36, v60
    s_add_u32 m0, s62, 0
    s_nop 0
    buffer_load_dwordx4 v10, s[44:47], s52 offen offset:0 lds
    v_fmac_f32 v94, v36, v61
    v_fmac_f32 v95, v36, v62
    s_waitcnt lgkmcnt(0)
    v_mul_f32 v80, v80, v64
    v_mul_f32 v81, v81, v65
    v_mul_f32 v82, v82, v66
    buffer_load_dwordx4 v10, s[44:47], s53 offen offset:1024 lds
    v_mul_f32 v83, v83, v67
    v_mul_f32 v84, v84, v68
    v_mul_f32 v85, v85, v69
    v_mul_f32 v86, v86, v70
    v_mul_f32 v87, v87, v71
    buffer_load_dwordx4 v10, s[44:47], s54 offen offset:2048 lds
    v_mul_f32 v88, v88, v72
    v_mul_f32 v89, v89, v73
    v_mul_f32 v90, v90, v74
    v_mul_f32 v91, v91, v75
    v_mul_f32 v92, v92, v76
    buffer_load_dwordx4 v10, s[44:47], s55 offen offset:3072 lds
    v_mul_f32 v93, v93, v77
    v_mul_f32 v94, v94, v78
    v_mul_f32 v95, v95, v79
    v_cvt_pk_bf16_f32 v104, v92, v88
    v_cvt_pk_bf16_f32 v105, v84, v80
    s_add_u32 m0, s62, 8192
    s_nop 0
    buffer_load_dwordx4 v11, s[48:51], s60 offen offset:0 lds
    v_cvt_pk_bf16_f32 v106, v94, v90
    v_cvt_pk_bf16_f32 v107, v86, v82
    v_cvt_pk_bf16_f32 v108, v93, v89
    v_cvt_pk_bf16_f32 v109, v85, v81
    v_cvt_pk_bf16_f32 v110, v95, v91
    buffer_load_dwordx4 v11, s[48:51], s61 offen offset:1024 lds
    v_cvt_pk_bf16_f32 v111, v87, v83
    s_mov_b32 s69, 0x700000
    buffer_store_dwordx4 v[96:99], v25, s[36:39], s69 offen offset:0 sc1
    buffer_store_dwordx4 v[100:103], v25, s[36:39], s69 offen offset:2048 sc1
    s_mov_b32 s69, 0x701080
    buffer_store_dwordx4 v[104:107], v25, s[36:39], s69 offen offset:0 sc1
    buffer_store_dwordx4 v[108:111], v25, s[36:39], s69 offen offset:2048 sc1
    v_add_u32 v10, 128, v10
    v_add_u32 v11, s63, v11
    s_waitcnt vmcnt(14)
    s_barrier
    s_add_u32 m0, s62, 45056
    s_nop 0
    buffer_load_dwordx4 v11, s[48:51], s57 offen offset:1024 lds
    s_lshl_b32 s98, s35, 12
    buffer_load_dwordx4 v11, s[48:51], s58 offen offset:2048 lds
    s_mul_i32 s99, s34, 8320
    buffer_load_dwordx4 v11, s[48:51], s56 offen offset:0 lds
    s_add_u32 s99, s99, 122880
    buffer_load_dwordx4 v11, s[48:51], s59 offen offset:3072 lds
    s_add_u32 m0, s62, 40960
    s_nop 0
    buffer_load_dwordx4 v10, s[44:47], s52 offen offset:0 lds
    buffer_load_dwordx4 v10, s[44:47], s53 offen offset:1024 lds
    buffer_load_dwordx4 v10, s[44:47], s54 offen offset:2048 lds
    buffer_load_dwordx4 v10, s[44:47], s55 offen offset:3072 lds
    s_add_u32 m0, s62, 49152
    s_nop 0
    buffer_load_dwordx4 v11, s[48:51], s60 offen offset:0 lds
    buffer_load_dwordx4 v11, s[48:51], s61 offen offset:1024 lds
    s_cmp_lg_u32 s96, 0
    s_cbranch_scc1 F_H0X
    s_mov_b32 s40, s18
    s_mov_b32 s41, s19
    s_mov_b32 s42, 0x400000
    s_mov_b32 s43, 0x00020000
    s_add_u32 m0, s99, 32
    s_nop 0
    buffer_load_dwordx4 v1, s[40:43], s98 offen offset:0 lds
    s_add_u32 m0, s99, 4196
    s_nop 0
    buffer_load_dwordx4 v1, s[40:43], s98 offen offset:0 lds
    s_add_u32 m0, s99, 32
    s_nop 0
    buffer_load_dwordx4 v1, s[40:43], s98 offen offset:1024 lds
    s_add_u32 m0, s99, 4196
    s_nop 0
    buffer_load_dwordx4 v1, s[40:43], s98 offen offset:1024 lds
    s_add_u32 m0, s99, 32
    s_nop 0
    buffer_load_dwordx4 v1, s[40:43], s98 offen offset:2048 lds
    s_add_u32 m0, s99, 4196
    s_nop 0
    buffer_load_dwordx4 v1, s[40:43], s98 offen offset:2048 lds
    s_add_u32 m0, s99, 32
    s_nop 0
    buffer_load_dwordx4 v1, s[40:43], s98 offen offset:3072 lds
    s_add_u32 m0, s99, 4196
    s_nop 0
    buffer_load_dwordx4 v1, s[40:43], s98 offen offset:3072 lds
F_H0X:
    v_add_u32 v10, 128, v10
    v_add_u32 v11, s63, v11
    s_waitcnt vmcnt(10)
    s_barrier
    s_add_u32 m0, s62, 86016
    s_nop 0
    buffer_load_dwordx4 v11, s[48:51], s57 offen offset:1024 lds
    buffer_load_dwordx4 v11, s[48:51], s58 offen offset:2048 lds
    buffer_load_dwordx4 v11, s[48:51], s56 offen offset:0 lds
    buffer_load_dwordx4 v11, s[48:51], s59 offen offset:3072 lds
    s_cmp_lg_u32 s34, 0
    s_cbranch_scc1 F_NOFA
    s_lshl_b32 s69, s2, 2
    s_add_u32 s69, s69, 0x110000
    v_mov_b32 v14, s68
    s_mov_b64 exec, 1
    buffer_store_dword v14, v13, s[36:39], s69 offen sc1
    s_mov_b64 exec, -1
F_NOFA:
    s_add_u32 m0, s62, 81920
    s_nop 0
    buffer_load_dwordx4 v10, s[44:47], s52 offen offset:0 lds
    buffer_load_dwordx4 v10, s[44:47], s53 offen offset:1024 lds
    buffer_load_dwordx4 v10, s[44:47], s54 offen offset:2048 lds
    buffer_load_dwordx4 v10, s[44:47], s55 offen offset:3072 lds
    s_add_u32 m0, s62, 90112
    s_nop 0
    buffer_load_dwordx4 v11, s[48:51], s60 offen offset:0 lds
    buffer_load_dwordx4 v11, s[48:51], s61 offen offset:1024 lds
    v_add_u32 v10, 128, v10
    v_add_u32 v11, s63, v11
    s_cmp_lg_u32 s96, 1
    s_cbranch_scc1 F_H1X
    s_mov_b32 s40, s18
    s_mov_b32 s41, s19
    s_mov_b32 s42, 0x400000
    s_mov_b32 s43, 0x00020000
    s_add_u32 m0, s99, 32
    s_nop 0
    buffer_load_dwordx4 v1, s[40:43], s98 offen offset:0 lds
    s_add_u32 m0, s99, 4196
    s_nop 0
    buffer_load_dwordx4 v1, s[40:43], s98 offen offset:0 lds
    s_add_u32 m0, s99, 32
    s_nop 0
    buffer_load_dwordx4 v1, s[40:43], s98 offen offset:1024 lds
    s_add_u32 m0, s99, 4196
    s_nop 0
    buffer_load_dwordx4 v1, s[40:43], s98 offen offset:1024 lds
    s_add_u32 m0, s99, 32
    s_nop 0
    buffer_load_dwordx4 v1, s[40:43], s98 offen offset:2048 lds
    s_add_u32 m0, s99, 4196
    s_nop 0
    buffer_load_dwordx4 v1, s[40:43], s98 offen offset:2048 lds
    s_add_u32 m0, s99, 32
    s_nop 0
    buffer_load_dwordx4 v1, s[40:43], s98 offen offset:3072 lds
    s_add_u32 m0, s99, 4196
    s_nop 0
    buffer_load_dwordx4 v1, s[40:43], s98 offen offset:3072 lds
F_H1X:
    s_waitcnt vmcnt(10)
    s_barrier
    s_add_u32 m0, s62, 4096
    s_nop 0
    buffer_load_dwordx4 v11, s[48:51], s57 offen offset:1024 lds
    buffer_load_dwordx4 v11, s[48:51], s58 offen offset:2048 lds
    buffer_load_dwordx4 v11, s[48:51], s56 offen offset:0 lds
    buffer_load_dwordx4 v11, s[48:51], s59 offen offset:3072 lds
    s_add_u32 m0, s62, 0
    s_nop 0
    buffer_load_dwordx4 v10, s[44:47], s52 offen offset:0 lds
    buffer_load_dwordx4 v10, s[44:47], s53 offen offset:1024 lds
    buffer_load_dwordx4 v10, s[44:47], s54 offen offset:2048 lds
    buffer_load_dwordx4 v10, s[44:47], s55 offen offset:3072 lds
    s_add_u32 m0, s62, 8192
    s_nop 0
    buffer_load_dwordx4 v11, s[48:51], s60 offen offset:0 lds
    buffer_load_dwordx4 v11, s[48:51], s61 offen offset:1024 lds
    s_cmp_lg_u32 s96, 2
    s_cbranch_scc1 F_H2X
    s_mov_b32 s40, s18
    s_mov_b32 s41, s19
    s_mov_b32 s42, 0x400000
    s_mov_b32 s43, 0x00020000
    s_add_u32 m0, s99, 32
    s_nop 0
    buffer_load_dwordx4 v1, s[40:43], s98 offen offset:0 lds
    s_add_u32 m0, s99, 4196
    s_nop 0
    buffer_load_dwordx4 v1, s[40:43], s98 offen offset:0 lds
    s_add_u32 m0, s99, 32
    s_nop 0
    buffer_load_dwordx4 v1, s[40:43], s98 offen offset:1024 lds
    s_add_u32 m0, s99, 4196
    s_nop 0
    buffer_load_dwordx4 v1, s[40:43], s98 offen offset:1024 lds
    s_add_u32 m0, s99, 32
    s_nop 0
    buffer_load_dwordx4 v1, s[40:43], s98 offen offset:2048 lds
    s_add_u32 m0, s99, 4196
    s_nop 0
    buffer_load_dwordx4 v1, s[40:43], s98 offen offset:2048 lds
    s_add_u32 m0, s99, 32
    s_nop 0
    buffer_load_dwordx4 v1, s[40:43], s98 offen offset:3072 lds
    s_add_u32 m0, s99, 4196
    s_nop 0
    buffer_load_dwordx4 v1, s[40:43], s98 offen offset:3072 lds
F_H2X:
    v_add_u32 v10, 128, v10
    v_add_u32 v11, s63, v11
    s_waitcnt vmcnt(10)
    s_barrier
    s_add_u32 m0, s62, 45056
    s_nop 0
    buffer_load_dwordx4 v11, s[48:51], s57 offen offset:1024 lds
    buffer_load_dwordx4 v11, s[48:51], s58 offen offset:2048 lds
    buffer_load_dwordx4 v11, s[48:51], s56 offen offset:0 lds
    buffer_load_dwordx4 v11, s[48:51], s59 offen offset:3072 lds
    s_add_u32 m0, s62, 40960
    s_nop 0
    buffer_load_dwordx4 v10, s[44:47], s52 offen offset:0 lds
    buffer_load_dwordx4 v10, s[44:47], s53 offen offset:1024 lds
    buffer_load_dwordx4 v10, s[44:47], s54 offen offset:2048 lds
    buffer_load_dwordx4 v10, s[44:47], s55 offen offset:3072 lds
    s_add_u32 m0, s62, 49152
    s_nop 0
    buffer_load_dwordx4 v11, s[48:51], s60 offen offset:0 lds
    buffer_load_dwordx4 v11, s[48:51], s61 offen offset:1024 lds
    s_cmp_lg_u32 s96, 3
    s_cbranch_scc1 F_H3X
    s_mov_b32 s40, s18
    s_mov_b32 s41, s19
    s_mov_b32 s42, 0x400000
    s_mov_b32 s43, 0x00020000
    s_add_u32 m0, s99, 32
    s_nop 0
    buffer_load_dwordx4 v1, s[40:43], s98 offen offset:0 lds
    s_add_u32 m0, s99, 4196
    s_nop 0
    buffer_load_dwordx4 v1, s[40:43], s98 offen offset:0 lds
    s_add_u32 m0, s99, 32
    s_nop 0
    buffer_load_dwordx4 v1, s[40:43], s98 offen offset:1024 lds
    s_add_u32 m0, s99, 4196
    s_nop 0
    buffer_load_dwordx4 v1, s[40:43], s98 offen offset:1024 lds
    s_add_u32 m0, s99, 32
    s_nop 0
    buffer_load_dwordx4 v1, s[40:43], s98 offen offset:2048 lds
    s_add_u32 m0, s99, 4196
    s_nop 0
    buffer_load_dwordx4 v1, s[40:43], s98 offen offset:2048 lds
    s_add_u32 m0, s99, 32
    s_nop 0
    buffer_load_dwordx4 v1, s[40:43], s98 offen offset:3072 lds
    s_add_u32 m0, s99, 4196
    s_nop 0
    buffer_load_dwordx4 v1, s[40:43], s98 offen offset:3072 lds
F_H3X:
    v_add_u32 v10, 128, v10
    v_add_u32 v11, s63, v11
    s_waitcnt vmcnt(10)
    s_barrier
    s_mov_b32 s69, 0x110000
    buffer_load_dwordx4 v[16:19], v1, s[36:39], s69 offen sc1
    s_lshl_b32 s97, s34, 2
    s_add_u32 s97, s97, 156288
    v_mov_b32 v28, s97
    v_mov_b32 v29, 1
    s_waitcnt vmcnt(1)
    ds_write_b32 v28, v29
    s_mul_i32 s52, s34, 4608
    s_add_u32 s52, s52, 98304
    s_mul_i32 s63, s35, 4224
    s_add_u32 s53, s63, 0x700000
    s_add_u32 s54, s18, s98
    s_addc_u32 s55, s19, 0
    s_load_dword s56, s[54:55], 0
    s_lshl_b32 s57, s35, 1
    s_and_b32 s57, s57, 0xfffffffc
    s_add_u32 s54, s20, s57
    s_addc_u32 s55, s21, 0
    s_load_dword s57, s[54:55], 0
    s_mov_b32 s40, s8
    s_mov_b32 s41, s9
    s_mov_b32 s42, 0x200000
    s_mov_b32 s43, 0x00020000
    s_lshl_b32 s62, s34, 10
    s_lshl_b32 s100, s34, 14
    s_lshl_b32 s101, s33, 7
    s_add_u32 s100, s100, s101
    s_add_u32 m0, s62, 81920
    s_add_u32 s101, s100, 0
    buffer_load_dwordx4 v12, s[40:43], s101 offen lds
    s_add_u32 m0, s62, 86016
    s_add_u32 s101, s100, 65536
    buffer_load_dwordx4 v12, s[40:43], s101 offen lds
    s_add_u32 m0, s62, 90112
    s_add_u32 s101, s100, 131072
    buffer_load_dwordx4 v12, s[40:43], s101 offen lds
    s_add_u32 m0, s62, 94208
    s_add_u32 s101, s100, 196608
    buffer_load_dwordx4 v12, s[40:43], s101 offen lds
    s_waitcnt vmcnt(4)
    v_xor_b32 v16, s68, v16
    v_xor_b32 v17, s68, v17
    v_xor_b32 v18, s68, v18
    v_xor_b32 v19, s68, v19
    v_or3_b32 v16, v16, v17, v18
    v_or_b32 v16, v16, v19
    v_cmp_ne_u32 vcc, 0, v16
    s_cbranch_vccz F_P1_X
    s_mov_b32 s101, 0
F_P1:
    buffer_load_dwordx4 v[16:19], v1, s[36:39], s69 offen sc1
    s_waitcnt vmcnt(0)
    v_xor_b32 v16, s68, v16
    v_xor_b32 v17, s68, v17
    v_xor_b32 v18, s68, v18
    v_xor_b32 v19, s68, v19
    v_or3_b32 v16, v16, v17, v18
    v_or_b32 v16, v16, v19
    v_cmp_ne_u32 vcc, 0, v16
    s_cbranch_vccz F_P1_X
    s_sleep 16
    s_add_u32 s101, s101, 1
    s_cmp_lt_u32 s101, 400000
    s_cbranch_scc1 F_P1
F_P1_X:
    s_add_u32 m0, s52, 256
    s_nop 0
    buffer_load_dwordx4 v1, s[36:39], s53 offen offset:0 sc1 lds
    buffer_load_dwordx4 v1, s[36:39], s53 offen offset:1024 sc1 lds
    s_add_u32 m0, s52, 512
    ds_write_b32 v28, v29 offset:48
    buffer_load_dwordx4 v1, s[36:39], s53 offen offset:2048 sc1 lds
    buffer_load_dwordx4 v1, s[36:39], s53 offen offset:3072 sc1 lds
    v_and_b32 v30, 3, v0
    v_lshlrev_b32 v30, 2, v30
    v_add_u32 v30, 156160, v30
F_WG14:
    ds_read_b32 v11, v30 offset:112
    s_waitcnt lgkmcnt(0)
    v_cmp_ne_u32 vcc, 1, v11
    s_cbranch_vccz F_WG14_X
    s_sleep 1
    s_branch F_WG14
F_WG14_X:
    s_add_u32 m0, s62, 0
    s_add_u32 s101, s100, 262144
    buffer_load_dwordx4 v12, s[40:43], s101 offen lds
    s_add_u32 m0, s62, 4096
    s_add_u32 s101, s100, 327680
    buffer_load_dwordx4 v12, s[40:43], s101 offen lds
    s_add_u32 m0, s62, 8192
    s_add_u32 s101, s100, 393216
    buffer_load_dwordx4 v12, s[40:43], s101 offen lds
    s_add_u32 m0, s62, 12288
    s_add_u32 s101, s100, 458752
    buffer_load_dwordx4 v12, s[40:43], s101 offen lds
    s_add_u32 m0, s62, 16384
    s_add_u32 s101, s100, 524288
    buffer_load_dwordx4 v12, s[40:43], s101 offen lds
    s_add_u32 m0, s62, 20480
    s_add_u32 s101, s100, 589824
    buffer_load_dwordx4 v12, s[40:43], s101 offen lds
    s_add_u32 m0, s62, 24576
    s_add_u32 s101, s100, 655360
    buffer_load_dwordx4 v12, s[40:43], s101 offen lds
    s_add_u32 m0, s62, 28672
    s_add_u32 s101, s100, 720896
    buffer_load_dwordx4 v12, s[40:43], s101 offen lds
    s_add_u32 m0, s62, 32768
    s_add_u32 s101, s100, 786432
    buffer_load_dwordx4 v12, s[40:43], s101 offen lds
    s_add_u32 m0, s62, 36864
    s_add_u32 s101, s100, 851968
    buffer_load_dwordx4 v12, s[40:43], s101 offen lds
    v_add_u32 v16, s52, v1
    v_add_u32 v17, 2048, v16
    v_cmp_gt_u32 vcc, 16, v0
    v_and_b32 v18, 1, v0
    v_lshlrev_b32 v18, 4, v18
    v_cndmask_b32 v16, v17, v16, vcc
    v_bfe_u32 v19, v0, 1, 1
    v_mul_u32_u24 v19, 4160, v19
    v_cmp_gt_u32 vcc, 32, v0
    v_add3_u32 v18, v18, v19, s99
    v_mov_b32 v20, 0
    v_mov_b32 v21, 0
    v_mov_b32 v22, 0
    v_mov_b32 v23, 0
    v_cndmask_b32 v16, v18, v16, vcc
    v_mov_b32 v5, s99
    ds_write_b128 v16, v[20:23]
    ds_write_b32 v5, v20 offset:4192
    v_and_b32 v16, 3, v0
    v_bfe_u32 v17, v0, 2, 2
    v_add_u32 v16, v16, v17
    v_lshlrev_b32 v16, 3, v16
    v_lshrrev_b32 v17, 4, v0
    v_lshl_add_u32 v16, v17, 5, v16
    s_add_u32 s58, s99, 8
    v_add_u32 v6, s58, v16
    v_and_b32 v16, 15, v0
    v_sub_u32 v16, v16, v17
    v_lshlrev_b32 v16, 4, v16
    s_add_u32 s58, s52, 192
    v_add_u32 v7, s58, v16
    v_mov_b32 v96, 0
    v_mov_b32 v97, 0
    v_mov_b32 v98, 0
    v_mov_b32 v99, 0
    v_mov_b32 v100, 0
    v_mov_b32 v101, 0
    v_mov_b32 v102, 0
    v_mov_b32 v103, 0
    v_mov_b32 v104, 0
    v_mov_b32 v105, 0
    v_mov_b32 v106, 0
    v_mov_b32 v107, 0
    v_mov_b32 v108, 0
    v_mov_b32 v109, 0
    v_mov_b32 v110, 0
    v_mov_b32 v111, 0
    v_mov_b32 v112, 0
    v_mov_b32 v113, 0
    v_mov_b32 v114, 0
    v_mov_b32 v115, 0
    v_mov_b32 v116, 0
    v_mov_b32 v117, 0
    v_mov_b32 v118, 0
    v_mov_b32 v119, 0
    v_mov_b32 v120, 0
    v_mov_b32 v121, 0
    v_mov_b32 v122, 0
    v_mov_b32 v123, 0
    v_mov_b32 v124, 0
    v_mov_b32 v125, 0
    v_mov_b32 v126, 0
    v_mov_b32 v127, 0
    v_mov_b32 v128, 0
    v_mov_b32 v129, 0
    v_mov_b32 v130, 0
    v_mov_b32 v131, 0
    v_mov_b32 v132, 0
    v_mov_b32 v133, 0
    v_mov_b32 v134, 0
    v_mov_b32 v135, 0
    v_mov_b32 v136, 0
    v_mov_b32 v137, 0
    v_mov_b32 v138, 0
    v_mov_b32 v139, 0
    v_mov_b32 v140, 0
    v_mov_b32 v141, 0
    v_mov_b32 v142, 0
    v_mov_b32 v143, 0
    v_mov_b32 v144, 0
    v_mov_b32 v145, 0
    v_mov_b32 v146, 0
    v_mov_b32 v147, 0
    v_mov_b32 v148, 0
    v_mov_b32 v149, 0
    v_mov_b32 v150, 0
    v_mov_b32 v151, 0
    v_mov_b32 v152, 0
    v_mov_b32 v153, 0
    v_mov_b32 v154, 0
    v_mov_b32 v155, 0
    v_mov_b32 v156, 0
    v_mov_b32 v157, 0
    v_mov_b32 v158, 0
    v_mov_b32 v159, 0
    v_subrev_u32 v8, 16, v0
    v_add_u32 v9, 47, v0
    v_cmp_gt_u32 vcc, 16, v0
    v_cmp_eq_u32 s[60:61], 0, v0
    v_mov_b32 v10, 63
    v_cndmask_b32 v8, v8, v9, vcc
    v_cndmask_b32 v8, v8, v10, s[60:61]
    v_lshlrev_b32 v8, 2, v8
    s_waitcnt lgkmcnt(0)
    s_lshl_b32 s56, s56, 16
    s_bitcmp1_b32 s35, 0
    s_cselect_b32 s58, 0, 16
    s_lshl_b32 s57, s57, s58
    s_and_b32 s57, s57, 0xffff0000
    v_mov_b32 v9, s56
    v_add_f32 v9, s57, v9
    v_cvt_pk_bf16_f32 v9, v9, v9
    ds_write_b16 v5, v9 offset:32
    ds_write_b16 v5, v9 offset:4196
    s_lshl_b32 s58, s34, 2
    s_add_u32 s58, s58, 156192
    v_mov_b32 v9, s58
    v_mov_b32 v10, 1
    s_waitcnt vmcnt(10)
    ds_read_b128 v[76:79], v7 offset:1856
    ds_read_b64_tr_b16 v[16:17], v6 offset:0
    ds_read_b64_tr_b16 v[18:19], v6 offset:4160
    ds_read_b128 v[72:75], v7 offset:1600
    ds_read_b64_tr_b16 v[20:21], v6 offset:512
    ds_read_b64_tr_b16 v[22:23], v6 offset:4672
    ds_read_b128 v[68:71], v7 offset:1344
    ds_read_b64_tr_b16 v[24:25], v6 offset:1024
    ds_read_b64_tr_b16 v[26:27], v6 offset:5184
    ds_read_b128 v[64:67], v7 offset:1088
    ds_read_b64_tr_b16 v[28:29], v6 offset:1536
    ds_read_b64_tr_b16 v[30:31], v6 offset:5696
    ds_read_b128 v[60:63], v7 offset:832
    ds_read_b64_tr_b16 v[32:33], v6 offset:2048
    ds_read_b64_tr_b16 v[34:35], v6 offset:6208
    ds_read_b128 v[56:59], v7 offset:576
    ds_read_b64_tr_b16 v[36:37], v6 offset:2560
    ds_read_b64_tr_b16 v[38:39], v6 offset:6720
    ds_read_b128 v[52:55], v7 offset:320
    ds_read_b64_tr_b16 v[40:41], v6 offset:3072
    ds_read_b64_tr_b16 v[42:43], v6 offset:7232
    ds_read_b128 v[48:51], v7 offset:64
    ds_read_b64_tr_b16 v[44:45], v6 offset:3584
    ds_read_b64_tr_b16 v[46:47], v6 offset:7744
    s_mov_b32 s58, 0
.p2align 6
F_VLOOP:
    s_waitcnt lgkmcnt(15)
    v_mfma_f32_16x16x32_bf16 v[124:127], v[16:19], v[76:79], v[124:127]
    ds_read_b128 v[80:83], v7 offset:2368
    ds_read_b128 v[76:79], v7 offset:4160
    v_mfma_f32_16x16x32_bf16 v[120:123], v[16:19], v[72:75], v[120:123]
    v_mfma_f32_16x16x32_bf16 v[124:127], v[20:23], v[72:75], v[124:127]
    ds_read_b128 v[72:75], v7 offset:3904
    v_mfma_f32_16x16x32_bf16 v[116:119], v[16:19], v[68:71], v[116:119]
    v_mfma_f32_16x16x32_bf16 v[120:123], v[20:23], v[68:71], v[120:123]
    s_waitcnt lgkmcnt(15)
    v_mfma_f32_16x16x32_bf16 v[124:127], v[24:27], v[68:71], v[124:127]
    ds_read_b128 v[68:71], v7 offset:3648
    s_waitcnt lgkmcnt(15)
    v_mfma_f32_16x16x32_bf16 v[112:115], v[16:19], v[64:67], v[112:115]
    v_mfma_f32_16x16x32_bf16 v[116:119], v[20:23], v[64:67], v[116:119]
    v_mfma_f32_16x16x32_bf16 v[120:123], v[24:27], v[64:67], v[120:123]
    v_mfma_f32_16x16x32_bf16 v[124:127], v[28:31], v[64:67], v[124:127]
    ds_read_b128 v[64:67], v7 offset:3392
    s_waitcnt lgkmcnt(15)
    v_mfma_f32_16x16x32_bf16 v[108:111], v[16:19], v[60:63], v[108:111]
    v_mfma_f32_16x16x32_bf16 v[112:115], v[20:23], v[60:63], v[112:115]
    v_mfma_f32_16x16x32_bf16 v[116:119], v[24:27], v[60:63], v[116:119]
    v_mfma_f32_16x16x32_bf16 v[120:123], v[28:31], v[60:63], v[120:123]
    s_waitcnt lgkmcnt(13)
    v_mfma_f32_16x16x32_bf16 v[124:127], v[32:35], v[60:63], v[124:127]
    ds_read_b128 v[60:63], v7 offset:3136
    s_waitcnt lgkmcnt(13)
    v_mfma_f32_16x16x32_bf16 v[104:107], v[16:19], v[56:59], v[104:107]
    v_mfma_f32_16x16x32_bf16 v[108:111], v[20:23], v[56:59], v[108:111]
    v_mfma_f32_16x16x32_bf16 v[112:115], v[24:27], v[56:59], v[112:115]
    v_mfma_f32_16x16x32_bf16 v[116:119], v[28:31], v[56:59], v[116:119]
    v_mfma_f32_16x16x32_bf16 v[120:123], v[32:35], v[56:59], v[120:123]
    s_waitcnt lgkmcnt(11)
    v_mfma_f32_16x16x32_bf16 v[124:127], v[36:39], v[56:59], v[124:127]
    ds_read_b128 v[56:59], v7 offset:2880
    s_waitcnt lgkmcnt(11)
    v_mfma_f32_16x16x32_bf16 v[100:103], v[16:19], v[52:55], v[100:103]
    v_mfma_f32_16x16x32_bf16 v[104:107], v[20:23], v[52:55], v[104:107]
    v_mfma_f32_16x16x32_bf16 v[108:111], v[24:27], v[52:55], v[108:111]
    v_mfma_f32_16x16x32_bf16 v[112:115], v[28:31], v[52:55], v[112:115]
    v_mfma_f32_16x16x32_bf16 v[116:119], v[32:35], v[52:55], v[116:119]
    v_mfma_f32_16x16x32_bf16 v[120:123], v[36:39], v[52:55], v[120:123]
    s_waitcnt lgkmcnt(9)
    v_mfma_f32_16x16x32_bf16 v[124:127], v[40:43], v[52:55], v[124:127]
    ds_read_b128 v[52:55], v7 offset:2624
    s_waitcnt lgkmcnt(10)
    v_mfma_f32_16x16x32_bf16 v[96:99], v[16:19], v[48:51], v[96:99]
    v_mfma_f32_16x16x32_bf16 v[100:103], v[20:23], v[48:51], v[100:103]
    v_mfma_f32_16x16x32_bf16 v[104:107], v[24:27], v[48:51], v[104:107]
    v_mfma_f32_16x16x32_bf16 v[108:111], v[28:31], v[48:51], v[108:111]
    v_mfma_f32_16x16x32_bf16 v[112:115], v[32:35], v[48:51], v[112:115]
    v_mfma_f32_16x16x32_bf16 v[116:119], v[36:39], v[48:51], v[116:119]
    v_mfma_f32_16x16x32_bf16 v[120:123], v[40:43], v[48:51], v[120:123]
    s_waitcnt lgkmcnt(8)
    v_mfma_f32_16x16x32_bf16 v[124:127], v[44:47], v[48:51], v[124:127]
    s_waitcnt lgkmcnt(6)
    v_mfma_f32_16x16x32_bf16 v[156:159], v[16:19], v[76:79], v[156:159]
    ds_read_b128 v[48:51], v7 offset:0
    ds_read_b128 v[76:79], v7 offset:1792
    s_waitcnt lgkmcnt(7)
    v_mfma_f32_16x16x32_bf16 v[152:155], v[16:19], v[72:75], v[152:155]
    s_waitcnt lgkmcnt(6)
    v_mfma_f32_16x16x32_bf16 v[148:151], v[16:19], v[68:71], v[148:151]
    s_waitcnt lgkmcnt(5)
    v_mfma_f32_16x16x32_bf16 v[144:147], v[16:19], v[64:67], v[144:147]
    s_waitcnt lgkmcnt(4)
    v_mfma_f32_16x16x32_bf16 v[140:143], v[16:19], v[60:63], v[140:143]
    s_waitcnt lgkmcnt(3)
    v_mfma_f32_16x16x32_bf16 v[136:139], v[16:19], v[56:59], v[136:139]
    s_waitcnt lgkmcnt(2)
    v_mfma_f32_16x16x32_bf16 v[132:135], v[16:19], v[52:55], v[132:135]
    v_mfma_f32_16x16x32_bf16 v[128:131], v[16:19], v[80:83], v[128:131]
    ds_read_b64_tr_b16 v[16:17], v6 offset:128
    ds_read_b64_tr_b16 v[18:19], v6 offset:4288
    v_mfma_f32_16x16x32_bf16 v[156:159], v[20:23], v[72:75], v[156:159]
    ds_read_b128 v[72:75], v7 offset:1536
    v_mfma_f32_16x16x32_bf16 v[152:155], v[20:23], v[68:71], v[152:155]
    v_mfma_f32_16x16x32_bf16 v[148:151], v[20:23], v[64:67], v[148:151]
    v_mfma_f32_16x16x32_bf16 v[144:147], v[20:23], v[60:63], v[144:147]
    v_mfma_f32_16x16x32_bf16 v[140:143], v[20:23], v[56:59], v[140:143]
    v_mfma_f32_16x16x32_bf16 v[136:139], v[20:23], v[52:55], v[136:139]
    v_mfma_f32_16x16x32_bf16 v[132:135], v[20:23], v[80:83], v[132:135]
    ds_read_b64_tr_b16 v[20:21], v6 offset:640
    ds_read_b64_tr_b16 v[22:23], v6 offset:4800
    v_mfma_f32_16x16x32_bf16 v[156:159], v[24:27], v[68:71], v[156:159]
    ds_read_b128 v[68:71], v7 offset:1280
    v_mfma_f32_16x16x32_bf16 v[152:155], v[24:27], v[64:67], v[152:155]
    v_mfma_f32_16x16x32_bf16 v[148:151], v[24:27], v[60:63], v[148:151]
    v_mfma_f32_16x16x32_bf16 v[144:147], v[24:27], v[56:59], v[144:147]
    v_mfma_f32_16x16x32_bf16 v[140:143], v[24:27], v[52:55], v[140:143]
    v_mfma_f32_16x16x32_bf16 v[136:139], v[24:27], v[80:83], v[136:139]
    ds_read_b64_tr_b16 v[24:25], v6 offset:1152
    ds_read_b64_tr_b16 v[26:27], v6 offset:5312
    v_mfma_f32_16x16x32_bf16 v[156:159], v[28:31], v[64:67], v[156:159]
    ds_read_b128 v[64:67], v7 offset:1024
    v_mfma_f32_16x16x32_bf16 v[152:155], v[28:31], v[60:63], v[152:155]
    v_mfma_f32_16x16x32_bf16 v[148:151], v[28:31], v[56:59], v[148:151]
    v_mfma_f32_16x16x32_bf16 v[144:147], v[28:31], v[52:55], v[144:147]
    v_mfma_f32_16x16x32_bf16 v[140:143], v[28:31], v[80:83], v[140:143]
    ds_read_b64_tr_b16 v[28:29], v6 offset:1664
    ds_read_b64_tr_b16 v[30:31], v6 offset:5824
    v_mfma_f32_16x16x32_bf16 v[156:159], v[32:35], v[60:63], v[156:159]
    ds_read_b128 v[60:63], v7 offset:768
    v_mfma_f32_16x16x32_bf16 v[152:155], v[32:35], v[56:59], v[152:155]
    v_mfma_f32_16x16x32_bf16 v[148:151], v[32:35], v[52:55], v[148:151]
    v_mfma_f32_16x16x32_bf16 v[144:147], v[32:35], v[80:83], v[144:147]
    ds_read_b64_tr_b16 v[32:33], v6 offset:2176
    ds_read_b64_tr_b16 v[34:35], v6 offset:6336
    v_mfma_f32_16x16x32_bf16 v[156:159], v[36:39], v[56:59], v[156:159]
    ds_read_b128 v[56:59], v7 offset:512
    v_mfma_f32_16x16x32_bf16 v[152:155], v[36:39], v[52:55], v[152:155]
    v_mfma_f32_16x16x32_bf16 v[148:151], v[36:39], v[80:83], v[148:151]
    ds_read_b64_tr_b16 v[36:37], v6 offset:2688
    ds_read_b64_tr_b16 v[38:39], v6 offset:6848
    v_mfma_f32_16x16x32_bf16 v[156:159], v[40:43], v[52:55], v[156:159]
    ds_read_b128 v[52:55], v7 offset:256
    v_mfma_f32_16x16x32_bf16 v[152:155], v[40:43], v[80:83], v[152:155]
    ds_read_b64_tr_b16 v[40:41], v6 offset:3200
    ds_read_b64_tr_b16 v[42:43], v6 offset:7360
    v_mfma_f32_16x16x32_bf16 v[156:159], v[44:47], v[80:83], v[156:159]
    ds_read_b64_tr_b16 v[44:45], v6 offset:3712
    ds_read_b64_tr_b16 v[46:47], v6 offset:7872
    s_waitcnt vmcnt(0)
    ds_write_b32 v9, v10 offset:112
    v_add_u32 v6, 128, v6
    v_subrev_u32 v7, 64, v7
    s_add_u32 s58, s58, 1
    s_cmp_lt_u32 s58, 4
    s_cbranch_scc1 F_VLOOP
    s_waitcnt lgkmcnt(0)
    ds_write_b32 v9, v10
    ds_bpermute_b32 v17, v8, v131
    ds_bpermute_b32 v18, v8, v135
    ds_bpermute_b32 v19, v8, v139
    ds_bpermute_b32 v20, v8, v143
    ds_bpermute_b32 v21, v8, v147
    ds_bpermute_b32 v22, v8, v151
    ds_bpermute_b32 v23, v8, v155
    ds_bpermute_b32 v24, v8, v159
    v_mov_b32 v16, 0
    v_add_f32 v97, v97, v128
    v_add_f32 v98, v98, v129
    v_add_f32 v99, v99, v130
    v_add_f32 v101, v101, v132
    v_add_f32 v102, v102, v133
    v_add_f32 v103, v103, v134
    v_add_f32 v105, v105, v136
    v_add_f32 v106, v106, v137
    v_add_f32 v107, v107, v138
    v_add_f32 v109, v109, v140
    v_add_f32 v110, v110, v141
    v_add_f32 v111, v111, v142
    v_add_f32 v113, v113, v144
    v_add_f32 v114, v114, v145
    v_add_f32 v115, v115, v146
    v_add_f32 v117, v117, v148
    v_add_f32 v118, v118, v149
    v_add_f32 v119, v119, v150
    v_add_f32 v121, v121, v152
    v_add_f32 v122, v122, v153
    v_add_f32 v123, v123, v154
    v_add_f32 v125, v125, v156
    v_add_f32 v126, v126, v157
    v_add_f32 v127, v127, v158
    s_waitcnt lgkmcnt(0)
    v_cndmask_b32 v28, v17, v16, s[60:61]
    v_cndmask_b32 v29, v18, v17, s[60:61]
    v_cndmask_b32 v30, v19, v18, s[60:61]
    v_cndmask_b32 v31, v20, v19, s[60:61]
    v_cndmask_b32 v32, v21, v20, s[60:61]
    v_cndmask_b32 v33, v22, v21, s[60:61]
    v_cndmask_b32 v34, v23, v22, s[60:61]
    v_cndmask_b32 v35, v24, v23, s[60:61]
    v_add_f32 v96, v96, v28
    v_add_f32 v100, v100, v29
    v_add_f32 v104, v104, v30
    v_add_f32 v108, v108, v31
    v_add_f32 v112, v112, v32
    v_add_f32 v116, v116, v33
    v_add_f32 v120, v120, v34
    v_add_f32 v124, v124, v35
    v_cvt_pk_bf16_f32 v48, v96, v97
    v_cvt_pk_bf16_f32 v49, v98, v99
    v_cvt_pk_bf16_f32 v50, v100, v101
    v_cvt_pk_bf16_f32 v51, v102, v103
    v_cvt_pk_bf16_f32 v52, v104, v105
    v_cvt_pk_bf16_f32 v53, v106, v107
    v_cvt_pk_bf16_f32 v54, v108, v109
    v_cvt_pk_bf16_f32 v55, v110, v111
    v_cvt_pk_bf16_f32 v56, v112, v113
    v_cvt_pk_bf16_f32 v57, v114, v115
    v_cvt_pk_bf16_f32 v58, v116, v117
    v_cvt_pk_bf16_f32 v59, v118, v119
    v_cvt_pk_bf16_f32 v60, v120, v121
    v_cvt_pk_bf16_f32 v61, v122, v123
    v_cvt_pk_bf16_f32 v62, v124, v125
    v_cvt_pk_bf16_f32 v63, v126, v127
    s_add_u32 s53, s63, 0xc00000
    buffer_store_dwordx4 v[48:51], v1, s[36:39], s53 offen offset:0 sc1
    buffer_store_dwordx4 v[52:55], v1, s[36:39], s53 offen offset:1024 sc1
    buffer_store_dwordx4 v[56:59], v1, s[36:39], s53 offen offset:2048 sc1
    buffer_store_dwordx4 v[60:63], v1, s[36:39], s53 offen offset:3072 sc1
    s_lshl_b32 s54, s2, 7
    s_lshl_b32 s55, s34, 2
    s_add_u32 s54, s54, s55
    s_add_u32 s54, s54, 0x111000
    v_mov_b32 v14, s68
    s_cmp_ge_u32 s34, 2
    s_cbranch_scc0 F_POST
    v_and_b32 v9, 3, v0
    v_lshlrev_b32 v9, 2, v9
    v_and_b32 v11, 4, v0
    v_lshl_add_u32 v9, v11, 3, v9
    v_add_u32 v9, 156192, v9
F_WL:
    ds_read_b32 v11, v9 offset:0
    s_waitcnt lgkmcnt(0)
    v_cmp_ne_u32 vcc, 1, v11
    s_cbranch_vccz F_WL_X
    s_sleep 1
    s_branch F_WL
F_WL_X:
    s_add_u32 s62, s62, 96256
    s_add_u32 s100, s100, 1540096
    s_add_u32 m0, s62, 0
    s_add_u32 s101, s100, 0
    buffer_load_dwordx4 v12, s[40:43], s101 offen lds
    s_add_u32 m0, s62, 2048
    s_add_u32 s101, s100, 32768
    buffer_load_dwordx4 v12, s[40:43], s101 offen lds
    s_add_u32 m0, s62, 4096
    s_add_u32 s101, s100, 65536
    buffer_load_dwordx4 v12, s[40:43], s101 offen lds
    s_add_u32 m0, s62, 6144
    s_add_u32 s101, s100, 98304
    buffer_load_dwordx4 v12, s[40:43], s101 offen lds
    s_add_u32 m0, s62, 8192
    s_add_u32 s101, s100, 131072
    buffer_load_dwordx4 v12, s[40:43], s101 offen lds
    s_add_u32 m0, s62, 10240
    s_add_u32 s101, s100, 163840
    buffer_load_dwordx4 v12, s[40:43], s101 offen lds
    s_add_u32 m0, s62, 12288
    s_add_u32 s101, s100, 196608
    buffer_load_dwordx4 v12, s[40:43], s101 offen lds
    s_add_u32 m0, s62, 14336
    s_add_u32 s101, s100, 229376
    buffer_load_dwordx4 v12, s[40:43], s101 offen lds
    s_add_u32 m0, s62, 16384
    s_add_u32 s101, s100, 262144
    buffer_load_dwordx4 v12, s[40:43], s101 offen lds
    s_add_u32 m0, s62, 18432
    s_add_u32 s101, s100, 294912
    buffer_load_dwordx4 v12, s[40:43], s101 offen lds
    s_add_u32 m0, s62, 20480
    s_add_u32 s101, s100, 327680
    buffer_load_dwordx4 v12, s[40:43], s101 offen lds
    s_add_u32 m0, s62, 22528
    s_add_u32 s101, s100, 360448
    buffer_load_dwordx4 v12, s[40:43], s101 offen lds
    s_add_u32 m0, s62, 24576
    s_add_u32 s101, s100, 393216
    buffer_load_dwordx4 v12, s[40:43], s101 offen lds
    s_add_u32 m0, s62, 26624
    s_add_u32 s101, s100, 425984
    buffer_load_dwordx4 v12, s[40:43], s101 offen lds
    s_add_u32 m0, s62, 28672
    s_add_u32 s101, s100, 458752
    buffer_load_dwordx4 v12, s[40:43], s101 offen lds
    s_add_u32 m0, s62, 30720
    s_add_u32 s101, s100, 491520
    buffer_load_dwordx4 v12, s[40:43], s101 offen lds
    s_waitcnt vmcnt(16)
    s_mov_b64 exec, 1
    buffer_store_dword v14, v13, s[36:39], s54 offen sc1
    s_mov_b64 exec, -1
    s_lshl_b32 s58, s34, 2
    s_add_u32 s58, s58, 156200
    v_mov_b32 v9, s58
    s_waitcnt vmcnt(1)
    ds_write_b32 v9, v10
    s_waitcnt lgkmcnt(0)
    s_endpgm
F_POST:
    s_and_b32 s52, s2, 15
    s_lshl_b32 s56, s52, 7
    s_waitcnt vmcnt(0)
    s_mov_b64 exec, 1
    buffer_store_dword v14, v13, s[36:39], s54 offen sc1
    s_mov_b64 exec, -1
    s_lshl_b32 s53, s52, 11
    s_add_u32 s53, s53, 0x111000
    v_lshrrev_b32 v8, 2, v0
    v_lshlrev_b32 v8, 7, v8
    v_and_b32 v9, 3, v0
    v_lshl_add_u32 v8, v9, 2, v8
    s_mov_b32 s101, 0
F_P4:
    buffer_load_dword v9, v8, s[36:39], s53 offen sc1
    s_waitcnt vmcnt(0)
    v_cmp_ne_u32 vcc, s68, v9
    s_cbranch_vccz F_P4_X
    s_sleep 32
    s_add_u32 s101, s101, 1
    s_cmp_lt_u32 s101, 400000
    s_cbranch_scc1 F_P4
F_P4_X:
    s_mul_i32 s54, s52, 270336
    s_add_u32 s54, s54, 0xc00000
    buffer_load_dwordx4 v[48:51], v232, s[36:39], s54 offen sc1
    s_add_u32 s54, s54, 4224
    buffer_load_dwordx4 v[52:55], v232, s[36:39], s54 offen sc1
    s_add_u32 s54, s54, 4224
    buffer_load_dwordx4 v[56:59], v232, s[36:39], s54 offen sc1
    s_add_u32 s54, s54, 4224
    buffer_load_dwordx4 v[60:63], v232, s[36:39], s54 offen sc1
    s_add_u32 s54, s54, 4224
    buffer_load_dwordx4 v[64:67], v232, s[36:39], s54 offen sc1
    s_add_u32 s54, s54, 4224
    buffer_load_dwordx4 v[68:71], v232, s[36:39], s54 offen sc1
    s_add_u32 s54, s54, 4224
    buffer_load_dwordx4 v[72:75], v232, s[36:39], s54 offen sc1
    s_add_u32 s54, s54, 4224
    buffer_load_dwordx4 v[76:79], v232, s[36:39], s54 offen sc1
    s_mov_b32 s44, s22
    s_mov_b32 s45, s23
    s_mov_b32 s46, 0x800000
    s_mov_b32 s47, 0x00020000
    s_mov_b32 s55, 0xffff0000
    s_add_u32 s56, s56, 2048
    s_waitcnt vmcnt(0)
    v_lshlrev_b32 v80, 16, v200
    v_lshlrev_b32 v88, 16, v48
    v_and_b32 v81, s55, v200
    v_lshlrev_b32 v89, 16, v52
    v_lshlrev_b32 v82, 16, v201
    v_lshlrev_b32 v90, 16, v56
    v_and_b32 v83, s55, v201
    v_lshlrev_b32 v91, 16, v60
    v_lshlrev_b32 v84, 16, v202
    v_lshlrev_b32 v92, 16, v64
    v_and_b32 v85, s55, v202
    v_lshlrev_b32 v93, 16, v68
    v_lshlrev_b32 v86, 16, v203
    v_lshlrev_b32 v94, 16, v72
    v_and_b32 v87, s55, v203
    v_lshlrev_b32 v95, 16, v76
    v_mul_f32 v80, v80, v88
    v_mul_f32 v81, v81, v89
    v_mul_f32 v82, v82, v90
    v_mul_f32 v83, v83, v91
    v_mul_f32 v84, v84, v92
    v_mul_f32 v85, v85, v93
    v_mul_f32 v86, v86, v94
    v_mul_f32 v87, v87, v95
    v_cvt_pk_bf16_f32 v100, v80, v81
    v_cvt_pk_bf16_f32 v101, v82, v83
    v_cvt_pk_bf16_f32 v102, v84, v85
    v_cvt_pk_bf16_f32 v103, v86, v87
    s_add_u32 s57, s56, 0
    buffer_store_dwordx4 v[100:103], v233, s[44:47], s57 offen sc1
    v_lshlrev_b32 v80, 16, v204
    v_and_b32 v88, s55, v48
    v_and_b32 v81, s55, v204
    v_and_b32 v89, s55, v52
    v_lshlrev_b32 v82, 16, v205
    v_and_b32 v90, s55, v56
    v_and_b32 v83, s55, v205
    v_and_b32 v91, s55, v60
    v_lshlrev_b32 v84, 16, v206
    v_and_b32 v92, s55, v64
    v_and_b32 v85, s55, v206
    v_and_b32 v93, s55, v68
    v_lshlrev_b32 v86, 16, v207
    v_and_b32 v94, s55, v72
    v_and_b32 v87, s55, v207
    v_and_b32 v95, s55, v76
    v_mul_f32 v80, v80, v88
    v_mul_f32 v81, v81, v89
    v_mul_f32 v82, v82, v90
    v_mul_f32 v83, v83, v91
    v_mul_f32 v84, v84, v92
    v_mul_f32 v85, v85, v93
    v_mul_f32 v86, v86, v94
    v_mul_f32 v87, v87, v95
    v_cvt_pk_bf16_f32 v104, v80, v81
    v_cvt_pk_bf16_f32 v105, v82, v83
    v_cvt_pk_bf16_f32 v106, v84, v85
    v_cvt_pk_bf16_f32 v107, v86, v87
    s_add_u32 s57, s56, 4096
    buffer_store_dwordx4 v[104:107], v233, s[44:47], s57 offen sc1
    v_lshlrev_b32 v80, 16, v208
    v_lshlrev_b32 v88, 16, v49
    v_and_b32 v81, s55, v208
    v_lshlrev_b32 v89, 16, v53
    v_lshlrev_b32 v82, 16, v209
    v_lshlrev_b32 v90, 16, v57
    v_and_b32 v83, s55, v209
    v_lshlrev_b32 v91, 16, v61
    v_lshlrev_b32 v84, 16, v210
    v_lshlrev_b32 v92, 16, v65
    v_and_b32 v85, s55, v210
    v_lshlrev_b32 v93, 16, v69
    v_lshlrev_b32 v86, 16, v211
    v_lshlrev_b32 v94, 16, v73
    v_and_b32 v87, s55, v211
    v_lshlrev_b32 v95, 16, v77
    v_mul_f32 v80, v80, v88
    v_mul_f32 v81, v81, v89
    v_mul_f32 v82, v82, v90
    v_mul_f32 v83, v83, v91
    v_mul_f32 v84, v84, v92
    v_mul_f32 v85, v85, v93
    v_mul_f32 v86, v86, v94
    v_mul_f32 v87, v87, v95
    v_cvt_pk_bf16_f32 v108, v80, v81
    v_cvt_pk_bf16_f32 v109, v82, v83
    v_cvt_pk_bf16_f32 v110, v84, v85
    v_cvt_pk_bf16_f32 v111, v86, v87
    s_add_u32 s57, s56, 8192
    buffer_store_dwordx4 v[108:111], v233, s[44:47], s57 offen sc1
    v_lshlrev_b32 v80, 16, v212
    v_and_b32 v88, s55, v49
    v_and_b32 v81, s55, v212
    v_and_b32 v89, s55, v53
    v_lshlrev_b32 v82, 16, v213
    v_and_b32 v90, s55, v57
    v_and_b32 v83, s55, v213
    v_and_b32 v91, s55, v61
    v_lshlrev_b32 v84, 16, v214
    v_and_b32 v92, s55, v65
    v_and_b32 v85, s55, v214
    v_and_b32 v93, s55, v69
    v_lshlrev_b32 v86, 16, v215
    v_and_b32 v94, s55, v73
    v_and_b32 v87, s55, v215
    v_and_b32 v95, s55, v77
    v_mul_f32 v80, v80, v88
    v_mul_f32 v81, v81, v89
    v_mul_f32 v82, v82, v90
    v_mul_f32 v83, v83, v91
    v_mul_f32 v84, v84, v92
    v_mul_f32 v85, v85, v93
    v_mul_f32 v86, v86, v94
    v_mul_f32 v87, v87, v95
    v_cvt_pk_bf16_f32 v112, v80, v81
    v_cvt_pk_bf16_f32 v113, v82, v83
    v_cvt_pk_bf16_f32 v114, v84, v85
    v_cvt_pk_bf16_f32 v115, v86, v87
    s_add_u32 s57, s56, 12288
    buffer_store_dwordx4 v[112:115], v233, s[44:47], s57 offen sc1
    v_lshlrev_b32 v80, 16, v216
    v_lshlrev_b32 v88, 16, v50
    v_and_b32 v81, s55, v216
    v_lshlrev_b32 v89, 16, v54
    v_lshlrev_b32 v82, 16, v217
    v_lshlrev_b32 v90, 16, v58
    v_and_b32 v83, s55, v217
    v_lshlrev_b32 v91, 16, v62
    v_lshlrev_b32 v84, 16, v218
    v_lshlrev_b32 v92, 16, v66
    v_and_b32 v85, s55, v218
    v_lshlrev_b32 v93, 16, v70
    v_lshlrev_b32 v86, 16, v219
    v_lshlrev_b32 v94, 16, v74
    v_and_b32 v87, s55, v219
    v_lshlrev_b32 v95, 16, v78
    v_mul_f32 v80, v80, v88
    v_mul_f32 v81, v81, v89
    v_mul_f32 v82, v82, v90
    v_mul_f32 v83, v83, v91
    v_mul_f32 v84, v84, v92
    v_mul_f32 v85, v85, v93
    v_mul_f32 v86, v86, v94
    v_mul_f32 v87, v87, v95
    v_cvt_pk_bf16_f32 v116, v80, v81
    v_cvt_pk_bf16_f32 v117, v82, v83
    v_cvt_pk_bf16_f32 v118, v84, v85
    v_cvt_pk_bf16_f32 v119, v86, v87
    s_add_u32 s57, s56, 1048576
    buffer_store_dwordx4 v[116:119], v233, s[44:47], s57 offen sc1
    v_lshlrev_b32 v80, 16, v220
    v_and_b32 v88, s55, v50
    v_and_b32 v81, s55, v220
    v_and_b32 v89, s55, v54
    v_lshlrev_b32 v82, 16, v221
    v_and_b32 v90, s55, v58
    v_and_b32 v83, s55, v221
    v_and_b32 v91, s55, v62
    v_lshlrev_b32 v84, 16, v222
    v_and_b32 v92, s55, v66
    v_and_b32 v85, s55, v222
    v_and_b32 v93, s55, v70
    v_lshlrev_b32 v86, 16, v223
    v_and_b32 v94, s55, v74
    v_and_b32 v87, s55, v223
    v_and_b32 v95, s55, v78
    v_mul_f32 v80, v80, v88
    v_mul_f32 v81, v81, v89
    v_mul_f32 v82, v82, v90
    v_mul_f32 v83, v83, v91
    v_mul_f32 v84, v84, v92
    v_mul_f32 v85, v85, v93
    v_mul_f32 v86, v86, v94
    v_mul_f32 v87, v87, v95
    v_cvt_pk_bf16_f32 v120, v80, v81
    v_cvt_pk_bf16_f32 v121, v82, v83
    v_cvt_pk_bf16_f32 v122, v84, v85
    v_cvt_pk_bf16_f32 v123, v86, v87
    s_add_u32 s57, s56, 1052672
    buffer_store_dwordx4 v[120:123], v233, s[44:47], s57 offen sc1
    v_lshlrev_b32 v80, 16, v224
    v_lshlrev_b32 v88, 16, v51
    v_and_b32 v81, s55, v224
    v_lshlrev_b32 v89, 16, v55
    v_lshlrev_b32 v82, 16, v225
    v_lshlrev_b32 v90, 16, v59
    v_and_b32 v83, s55, v225
    v_lshlrev_b32 v91, 16, v63
    v_lshlrev_b32 v84, 16, v226
    v_lshlrev_b32 v92, 16, v67
    v_and_b32 v85, s55, v226
    v_lshlrev_b32 v93, 16, v71
    v_lshlrev_b32 v86, 16, v227
    v_lshlrev_b32 v94, 16, v75
    v_and_b32 v87, s55, v227
    v_lshlrev_b32 v95, 16, v79
    v_mul_f32 v80, v80, v88
    v_mul_f32 v81, v81, v89
    v_mul_f32 v82, v82, v90
    v_mul_f32 v83, v83, v91
    v_mul_f32 v84, v84, v92
    v_mul_f32 v85, v85, v93
    v_mul_f32 v86, v86, v94
    v_mul_f32 v87, v87, v95
    v_cvt_pk_bf16_f32 v124, v80, v81
    v_cvt_pk_bf16_f32 v125, v82, v83
    v_cvt_pk_bf16_f32 v126, v84, v85
    v_cvt_pk_bf16_f32 v127, v86, v87
    s_add_u32 s57, s56, 1056768
    buffer_store_dwordx4 v[124:127], v233, s[44:47], s57 offen sc1
    v_lshlrev_b32 v80, 16, v228
    v_and_b32 v88, s55, v51
    v_and_b32 v81, s55, v228
    v_and_b32 v89, s55, v55
    v_lshlrev_b32 v82, 16, v229
    v_and_b32 v90, s55, v59
    v_and_b32 v83, s55, v229
    v_and_b32 v91, s55, v63
    v_lshlrev_b32 v84, 16, v230
    v_and_b32 v92, s55, v67
    v_and_b32 v85, s55, v230
    v_and_b32 v93, s55, v71
    v_lshlrev_b32 v86, 16, v231
    v_and_b32 v94, s55, v75
    v_and_b32 v87, s55, v231
    v_and_b32 v95, s55, v79
    v_mul_f32 v80, v80, v88
    v_mul_f32 v81, v81, v89
    v_mul_f32 v82, v82, v90
    v_mul_f32 v83, v83, v91
    v_mul_f32 v84, v84, v92
    v_mul_f32 v85, v85, v93
    v_mul_f32 v86, v86, v94
    v_mul_f32 v87, v87, v95
    v_cvt_pk_bf16_f32 v128, v80, v81
    v_cvt_pk_bf16_f32 v129, v82, v83
    v_cvt_pk_bf16_f32 v130, v84, v85
    v_cvt_pk_bf16_f32 v131, v86, v87
    s_add_u32 s57, s56, 1060864
    buffer_store_dwordx4 v[128:131], v233, s[44:47], s57 offen sc1
    s_endpgm
F_C:
    s_load_dwordx8 s[20:27], s[0:1], 64
    s_and_b32 s32, s29, 3
    s_lshr_b32 s33, s28, 1
    s_lshl_b32 s33, s33, 2
    s_add_u32 s32, s32, s33
    s_and_b32 s33, s28, 1
    s_lshl_b32 s33, s33, 3
    s_lshr_b32 s35, s29, 2
    s_add_u32 s33, s33, s35
    v_lshlrev_b32 v1, 4, v0
    s_lshr_b32 s34, s3, 1
    s_and_b32 s35, s3, 1
    v_and_b32 v16, 15, v0
    v_lshrrev_b32 v17, 4, v0
    v_lshrrev_b32 v18, 1, v16
    v_xor_b32 v18, v18, v17
    v_lshlrev_b32 v18, 4, v18
    v_and_b32 v19, 7, v0
    v_lshl_add_u32 v18, v19, 7, v18
    v_bfe_u32 v19, v0, 3, 1
    v_mul_u32_u24 v19, 10240, v19
    s_lshl_b32 s40, s34, 11
    s_add_u32 s40, s40, 40960
    v_add3_u32 v2, v18, v19, s40
    v_xor_b32 v3, 64, v2
    v_bfe_u32 v18, v0, 2, 2
    v_lshlrev_b32 v18, 7, v18
    v_and_b32 v19, 3, v0
    v_lshl_add_u32 v18, v19, 3, v18
    v_bfe_u32 v19, v0, 3, 2
    v_lshlrev_b32 v19, 5, v19
    v_lshl_add_u32 v207, v17, 9, v18
    v_add_u32 v207, v207, v19
    s_lshl_b32 s40, s35, 6
    s_lshl_b32 s41, s34, 5
    s_or_b32 s40, s40, s41
    v_xor_b32 v19, s40, v19
    v_mul_u32_u24 v20, 10240, v17
    v_add3_u32 v18, v18, v19, v20
    v_add_u32 v4, 45056, v18
    v_xor_b32 v5, 32, v4
    v_mov_b32 v18, 0
    v_lshlrev_b32 v19, 2, v0
    v_add_u32 v20, 156160, v19
    ds_write_b32 v20, v18
    s_mov_b32 s42, 0x358637bd
    s_mov_b32 s43, 0x3fb8aa3b
    s_mov_b32 s49, 0x3f803f80
    v_mov_b32 v104, s42
    v_mov_b32 v105, s42
    v_mov_b32 v106, s42
    v_mov_b32 v107, s42
    v_mov_b32 v108, s42
    v_mov_b32 v109, s42
    v_mov_b32 v110, s42
    v_mov_b32 v111, s42
    v_mov_b32 v112, s42
    v_mov_b32 v113, s42
    v_mov_b32 v114, s42
    v_mov_b32 v115, s42
    v_mov_b32 v116, s42
    v_mov_b32 v117, s42
    v_mov_b32 v118, s42
    v_mov_b32 v119, s42
    v_mov_b32 v120, s42
    v_mov_b32 v121, s42
    v_mov_b32 v122, s42
    v_mov_b32 v123, s42
    v_mov_b32 v124, s42
    v_mov_b32 v125, s42
    v_mov_b32 v126, s42
    v_mov_b32 v127, s42
    v_mov_b32 v128, s42
    v_mov_b32 v129, s42
    v_mov_b32 v130, s42
    v_mov_b32 v131, s42
    v_mov_b32 v132, s42
    v_mov_b32 v133, s42
    v_mov_b32 v134, s42
    v_mov_b32 v135, s42
    v_mov_b32 v136, 0
    v_mov_b32 v137, 0
    v_mov_b32 v138, 0
    v_mov_b32 v139, 0
    v_mov_b32 v140, 0
    v_mov_b32 v141, 0
    v_mov_b32 v142, 0
    v_mov_b32 v143, 0
    v_mov_b32 v144, 0
    v_mov_b32 v145, 0
    v_mov_b32 v146, 0
    v_mov_b32 v147, 0
    v_mov_b32 v148, 0
    v_mov_b32 v149, 0
    v_mov_b32 v150, 0
    v_mov_b32 v151, 0
    v_mov_b32 v152, 0
    v_mov_b32 v153, 0
    v_mov_b32 v154, 0
    v_mov_b32 v155, 0
    v_mov_b32 v156, 0
    v_mov_b32 v157, 0
    v_mov_b32 v158, 0
    v_mov_b32 v159, 0
    v_mov_b32 v160, 0
    v_mov_b32 v161, 0
    v_mov_b32 v162, 0
    v_mov_b32 v163, 0
    v_mov_b32 v164, 0
    v_mov_b32 v165, 0
    v_mov_b32 v166, 0
    v_mov_b32 v167, 0
    v_mov_b32 v168, s42
    v_mov_b32 v169, s42
    v_mov_b32 v170, s42
    v_mov_b32 v171, s42
    v_mov_b32 v172, s42
    v_mov_b32 v173, s42
    v_mov_b32 v174, s42
    v_mov_b32 v175, s42
    v_mov_b32 v176, s42
    v_mov_b32 v177, s42
    v_mov_b32 v178, s42
    v_mov_b32 v179, s42
    v_mov_b32 v180, s42
    v_mov_b32 v181, s42
    v_mov_b32 v182, s42
    v_mov_b32 v183, s42
    v_mov_b32 v184, s42
    v_mov_b32 v185, s42
    v_mov_b32 v186, s42
    v_mov_b32 v187, s42
    v_mov_b32 v188, s42
    v_mov_b32 v189, s42
    v_mov_b32 v190, s42
    v_mov_b32 v191, s42
    v_mov_b32 v192, s42
    v_mov_b32 v193, s42
    v_mov_b32 v194, s42
    v_mov_b32 v195, s42
    v_mov_b32 v196, s42
    v_mov_b32 v197, s42
    v_mov_b32 v198, s42
    v_mov_b32 v199, s42
    s_and_b32 s40, s3, 1
    s_lshl_b32 s41, s31, 1
    s_add_u32 s40, s40, s41
    s_lshr_b32 s41, s3, 1
    s_lshl_b32 s52, s30, 1
    s_add_u32 s52, s52, s41
    s_mul_i32 s52, s52, 132
    s_add_u32 s52, s52, s40
    s_lshl_b32 s52, s52, 10
    s_add_u32 s52, s52, 0x200000
    s_lshl_b32 s50, s40, 15
    s_lshl_b32 s51, s41, 10
    s_add_u32 s53, s50, s51
    s_lshl_b32 s50, s30, 11
    s_add_u32 s50, s50, s53
    s_lshl_b32 s40, s40, 11
    s_add_u32 s54, s40, s51
    s_add_u32 s54, s54, 0x100000
    s_lshl_b32 s51, s30, 6
    s_add_u32 s51, s51, s54
    s_mul_i32 s40, s35, 2304
    s_add_u32 s58, s40, 156416
    s_add_u32 s59, s40, 116736
    s_cmp_eq_u32 s34, 0
    s_cselect_b32 s40, s58, s59
    s_cselect_b32 s41, s59, s58
    v_lshlrev_b32 v12, 4, v17
    v_add_u32 v6, s40, v1
    v_add_u32 v7, s41, v1
    v_add_u32 v8, s40, v12
    v_add_u32 v9, s41, v12
    s_lshl_b32 s40, s3, 3
    s_add_u32 s41, s40, 156160
    v_mov_b32 v10, s41
    v_xor_b32 v11, 16, v10
    v_lshl_add_u32 v13, v16, 6, v12
    s_lshl_b32 s40, s34, 3
    s_add_u32 s41, s59, s40
    v_add_u32 v200, s41, v1
    v_xor_b32 v201, 8, v200
    s_add_u32 s41, s58, s40
    v_add_u32 v203, s41, v1
    v_xor_b32 v202, 8, v203
    s_lshl_b32 s40, s3, 2
    s_add_u32 s41, s40, 156240
    v_mov_b32 v204, s41
    s_add_u32 s41, s40, 156224
    v_mov_b32 v206, s41
    v_lshlrev_b32 v18, 1, v17
    v_and_b32 v20, 7, v0
    v_xor_b32 v18, v18, v20
    v_lshlrev_b32 v18, 4, v18
    v_lshrrev_b32 v20, 3, v0
    v_lshl_add_u32 v205, v20, 11, v18
    v_mov_b32 v14, 1
    v_and_b32 v18, 12, v19
    v_add_u32 v209, 156160, v18
    v_add_u32 v211, 144, v209
    v_add_u32 v20, 160, v209
    v_subrev_u32 v21, 12, v0
    v_cmp_gt_u32 vcc, 12, v21
    v_and_b32 v18, 4, v19
    v_add_u32 v18, 156208, v18
    v_cndmask_b32 v211, v211, v20, vcc
    v_and_b32 v21, 31, v0
    v_cmp_lt_u32 vcc, 23, v21
    s_nop 1
    v_cndmask_b32 v211, v211, v18, vcc
    s_lshl_b32 s55, s32, 2
    s_add_u32 s55, s55, s3
    s_lshl_b32 s56, s55, 17
    s_lshl_b32 s40, s33, 7
    s_add_u32 s56, s56, s40
    s_mul_i32 s55, s55, 67584
    s_add_u32 s55, s55, 0x200000
    v_and_b32 v18, 31, v0
    v_add_u32 v18, 33, v18
    v_lshlrev_b32 v208, 10, v18
    s_and_b32 s57, s33, 7
    s_mul_i32 s57, s57, 3
    s_lshr_b32 s57, s57, 2
    v_lshlrev_b32 v210, 12, v16
    v_bfe_u32 v18, v0, 4, 1
    v_lshl_add_u32 v210, v18, 5, v210
    v_lshrrev_b32 v18, 5, v0
    v_lshl_add_u32 v210, v18, 4, v210
    s_mov_b32 s44, 0
    s_mov_b32 s45, 1
    s_mov_b32 s46, 0xfffec000
    s_mov_b32 s47, 40960
    s_waitcnt lgkmcnt(0)
    s_mov_b32 s36, s26
    s_mov_b32 s37, s27
    s_mov_b32 s38, 0x10000000
    s_mov_b32 s39, 0x00020000
    s_mov_b32 s60, s22
    s_mov_b32 s61, s23
    s_mov_b32 s62, 0x800000
    s_mov_b32 s63, 0x00020000
    s_mov_b32 s64, s26
    s_mov_b32 s65, s27
    s_mov_b32 s66, 0x10000000
    s_mov_b32 s67, 0x00020000
    s_mov_b32 s4, s8
    s_mov_b32 s5, s9
    s_mov_b32 s6, 0x200000
    s_mov_b32 s7, 0x00020000
    s_lshl_b32 s68, s3, 10
    s_lshl_b32 s69, s3, 14
    s_lshl_b32 s40, s33, 7
    s_add_u32 s69, s69, s40
    s_barrier
    ds_read_b64_tr_b16 v[80:81], v4 offset:1024
    ds_read_b64_tr_b16 v[82:83], v4 offset:1536
    ds_read_b128 v[16:19], v2 offset:0
    ds_read_b64_tr_b16 v[84:85], v4 offset:4096
    ds_read_b64_tr_b16 v[86:87], v4 offset:4608
    ds_read_b128 v[20:23], v3 offset:0
    ds_read_b128 v[24:27], v2 offset:20480
    ds_read_b128 v[28:31], v3 offset:20480
    ds_read_b128 v[32:35], v2 offset:1024
    ds_read_b128 v[36:39], v3 offset:1024
    ds_read_b64_tr_b16 v[88:89], v5 offset:1024
    ds_read_b64_tr_b16 v[90:91], v5 offset:1536
    ds_read_b64_tr_b16 v[92:93], v5 offset:4096
    ds_read_b64_tr_b16 v[94:95], v5 offset:4608
    ds_read_b128 v[40:43], v2 offset:21504
    ds_read_b128 v[44:47], v3 offset:21504
.p2align 6
F_CLOOP:
    s_waitcnt lgkmcnt(8)
    v_mfma_f32_16x16x32_bf16 v[104:107], v[16:19], v[80:83], v[104:107]
    ds_read_b64_tr_b16 v[96:97], v4 offset:2048
    v_mfma_f32_16x16x32_bf16 v[104:107], v[20:23], v[84:87], v[104:107]
    ds_read_b64_tr_b16 v[98:99], v4 offset:2560
    v_mfma_f32_16x16x32_bf16 v[108:111], v[24:27], v[80:83], v[108:111]
    ds_read_b64_tr_b16 v[100:101], v4 offset:5120
    v_mfma_f32_16x16x32_bf16 v[108:111], v[28:31], v[84:87], v[108:111]
    ds_read_b64_tr_b16 v[102:103], v4 offset:5632
    s_waitcnt lgkmcnt(4)
    v_mfma_f32_16x16x32_bf16 v[112:115], v[32:35], v[80:83], v[112:115]
    v_mfma_f32_16x16x32_bf16 v[112:115], v[36:39], v[84:87], v[112:115]
    v_mfma_f32_16x16x32_bf16 v[116:119], v[40:43], v[80:83], v[116:119]
    v_mfma_f32_16x16x32_bf16 v[116:119], v[44:47], v[84:87], v[116:119]
    v_mfma_f32_16x16x32_bf16 v[120:123], v[16:19], v[88:91], v[120:123]
    ds_read_b64_tr_b16 v[80:81], v5 offset:2048
    v_mfma_f32_16x16x32_bf16 v[120:123], v[20:23], v[92:95], v[120:123]
    ds_read_b64_tr_b16 v[82:83], v5 offset:2560
    v_mfma_f32_16x16x32_bf16 v[124:127], v[24:27], v[88:91], v[124:127]
    ds_read_b64_tr_b16 v[84:85], v5 offset:5120
    v_mfma_f32_16x16x32_bf16 v[124:127], v[28:31], v[92:95], v[124:127]
    ds_read_b64_tr_b16 v[86:87], v5 offset:5632
    v_mfma_f32_16x16x32_bf16 v[128:131], v[32:35], v[88:91], v[128:131]
    v_mfma_f32_16x16x32_bf16 v[128:131], v[36:39], v[92:95], v[128:131]
    v_mfma_f32_16x16x32_bf16 v[132:135], v[40:43], v[88:91], v[132:135]
    v_mfma_f32_16x16x32_bf16 v[132:135], v[44:47], v[92:95], v[132:135]
    s_waitcnt lgkmcnt(4)
    v_mfma_f32_16x16x32_bf16 v[136:139], v[16:19], v[96:99], v[136:139]
    ds_read_b64_tr_b16 v[88:89], v4 offset:0
    v_mfma_f32_16x16x32_bf16 v[136:139], v[20:23], v[100:103], v[136:139]
    ds_read_b64_tr_b16 v[90:91], v4 offset:512
    v_mfma_f32_16x16x32_bf16 v[140:143], v[24:27], v[96:99], v[140:143]
    ds_read_b64_tr_b16 v[92:93], v4 offset:3072
    v_mfma_f32_16x16x32_bf16 v[140:143], v[28:31], v[100:103], v[140:143]
    ds_read_b64_tr_b16 v[94:95], v4 offset:3584
    v_mfma_f32_16x16x32_bf16 v[144:147], v[32:35], v[96:99], v[144:147]
    v_mfma_f32_16x16x32_bf16 v[144:147], v[36:39], v[100:103], v[144:147]
    s_add_u32 s44, s44, 1
    v_mfma_f32_16x16x32_bf16 v[148:151], v[40:43], v[96:99], v[148:151]
    v_mfma_f32_16x16x32_bf16 v[148:151], v[44:47], v[100:103], v[148:151]
    s_waitcnt lgkmcnt(4)
    v_mfma_f32_16x16x32_bf16 v[152:155], v[16:19], v[80:83], v[152:155]
    ds_read_b64_tr_b16 v[96:97], v5 offset:0
    v_mfma_f32_16x16x32_bf16 v[152:155], v[20:23], v[84:87], v[152:155]
    ds_read_b64_tr_b16 v[98:99], v5 offset:512
    v_mfma_f32_16x16x32_bf16 v[156:159], v[24:27], v[80:83], v[156:159]
    ds_read_b64_tr_b16 v[100:101], v5 offset:3072
    v_mfma_f32_16x16x32_bf16 v[156:159], v[28:31], v[84:87], v[156:159]
    ds_read_b64_tr_b16 v[102:103], v5 offset:3584
    v_mfma_f32_16x16x32_bf16 v[160:163], v[32:35], v[80:83], v[160:163]
    s_add_u32 s45, s45, 1
    s_cmp_eq_u32 s45, 3
    v_mfma_f32_16x16x32_bf16 v[160:163], v[36:39], v[84:87], v[160:163]
    s_cselect_b32 s48, s46, s47
    s_cselect_b32 s45, 0, s45
    v_mfma_f32_16x16x32_bf16 v[164:167], v[40:43], v[80:83], v[164:167]
    v_add_u32 v4, s48, v4
    v_add_u32 v2, s48, v2
    v_mfma_f32_16x16x32_bf16 v[164:167], v[44:47], v[84:87], v[164:167]
    v_add_u32 v3, s48, v3
    v_add_u32 v5, s48, v5
    s_waitcnt lgkmcnt(0)
    v_mfma_f32_16x16x32_bf16 v[168:171], v[88:91], v[16:19], v[168:171]
    s_cmp_lt_u32 s44, 8
    s_cbranch_scc0 F_CNB0
    s_barrier
F_CB0:
    v_mfma_f32_16x16x32_bf16 v[168:171], v[92:95], v[20:23], v[168:171]
    ds_read_b64_tr_b16 v[80:81], v4 offset:1024
    ds_read_b64_tr_b16 v[82:83], v4 offset:1536
    v_mfma_f32_16x16x32_bf16 v[172:175], v[88:91], v[24:27], v[172:175]
    ds_read_b128 v[48:51], v2 offset:0
    ds_read_b64_tr_b16 v[84:85], v4 offset:4096
    v_mfma_f32_16x16x32_bf16 v[172:175], v[92:95], v[28:31], v[172:175]
    ds_read_b64_tr_b16 v[86:87], v4 offset:4608
    v_mfma_f32_16x16x32_bf16 v[176:179], v[88:91], v[32:35], v[176:179]
    ds_read_b128 v[52:55], v3 offset:0
    v_mfma_f32_16x16x32_bf16 v[176:179], v[92:95], v[36:39], v[176:179]
    ds_read_b128 v[56:59], v2 offset:20480
    v_mfma_f32_16x16x32_bf16 v[180:183], v[88:91], v[40:43], v[180:183]
    ds_read_b128 v[60:63], v3 offset:20480
    v_mfma_f32_16x16x32_bf16 v[180:183], v[92:95], v[44:47], v[180:183]
    v_mfma_f32_16x16x32_bf16 v[184:187], v[96:99], v[16:19], v[184:187]
    ds_read_b128 v[64:67], v2 offset:1024
    ds_read_b128 v[68:71], v3 offset:1024
    v_mfma_f32_16x16x32_bf16 v[184:187], v[100:103], v[20:23], v[184:187]
    ds_read_b64_tr_b16 v[88:89], v5 offset:1024
    ds_read_b64_tr_b16 v[90:91], v5 offset:1536
    v_mfma_f32_16x16x32_bf16 v[188:191], v[96:99], v[24:27], v[188:191]
    ds_read_b64_tr_b16 v[92:93], v5 offset:4096
    ds_read_b64_tr_b16 v[94:95], v5 offset:4608
    v_mfma_f32_16x16x32_bf16 v[188:191], v[100:103], v[28:31], v[188:191]
    ds_read_b128 v[72:75], v2 offset:21504
    v_mfma_f32_16x16x32_bf16 v[192:195], v[96:99], v[32:35], v[192:195]
    ds_read_b128 v[76:79], v3 offset:21504
    v_mfma_f32_16x16x32_bf16 v[192:195], v[100:103], v[36:39], v[192:195]
    v_mfma_f32_16x16x32_bf16 v[196:199], v[96:99], v[40:43], v[196:199]
    v_mfma_f32_16x16x32_bf16 v[196:199], v[100:103], v[44:47], v[196:199]
    s_waitcnt lgkmcnt(8)
    v_mfma_f32_16x16x32_bf16 v[104:107], v[48:51], v[80:83], v[104:107]
    ds_read_b64_tr_b16 v[96:97], v4 offset:2048
    v_mfma_f32_16x16x32_bf16 v[104:107], v[52:55], v[84:87], v[104:107]
    ds_read_b64_tr_b16 v[98:99], v4 offset:2560
    v_mfma_f32_16x16x32_bf16 v[108:111], v[56:59], v[80:83], v[108:111]
    ds_read_b64_tr_b16 v[100:101], v4 offset:5120
    v_mfma_f32_16x16x32_bf16 v[108:111], v[60:63], v[84:87], v[108:111]
    ds_read_b64_tr_b16 v[102:103], v4 offset:5632
    s_waitcnt lgkmcnt(4)
    v_mfma_f32_16x16x32_bf16 v[112:115], v[64:67], v[80:83], v[112:115]
    v_mfma_f32_16x16x32_bf16 v[112:115], v[68:71], v[84:87], v[112:115]
    v_mfma_f32_16x16x32_bf16 v[116:119], v[72:75], v[80:83], v[116:119]
    v_mfma_f32_16x16x32_bf16 v[116:119], v[76:79], v[84:87], v[116:119]
    v_mfma_f32_16x16x32_bf16 v[120:123], v[48:51], v[88:91], v[120:123]
    ds_read_b64_tr_b16 v[80:81], v5 offset:2048
    v_mfma_f32_16x16x32_bf16 v[120:123], v[52:55], v[92:95], v[120:123]
    ds_read_b64_tr_b16 v[82:83], v5 offset:2560
    v_mfma_f32_16x16x32_bf16 v[124:127], v[56:59], v[88:91], v[124:127]
    ds_read_b64_tr_b16 v[84:85], v5 offset:5120
    v_mfma_f32_16x16x32_bf16 v[124:127], v[60:63], v[92:95], v[124:127]
    ds_read_b64_tr_b16 v[86:87], v5 offset:5632
    v_mfma_f32_16x16x32_bf16 v[128:131], v[64:67], v[88:91], v[128:131]
    v_mfma_f32_16x16x32_bf16 v[128:131], v[68:71], v[92:95], v[128:131]
    v_mfma_f32_16x16x32_bf16 v[132:135], v[72:75], v[88:91], v[132:135]
    v_mfma_f32_16x16x32_bf16 v[132:135], v[76:79], v[92:95], v[132:135]
    s_waitcnt lgkmcnt(4)
    v_mfma_f32_16x16x32_bf16 v[136:139], v[48:51], v[96:99], v[136:139]
    ds_read_b64_tr_b16 v[88:89], v4 offset:0
    v_mfma_f32_16x16x32_bf16 v[136:139], v[52:55], v[100:103], v[136:139]
    ds_read_b64_tr_b16 v[90:91], v4 offset:512
    v_mfma_f32_16x16x32_bf16 v[140:143], v[56:59], v[96:99], v[140:143]
    ds_read_b64_tr_b16 v[92:93], v4 offset:3072
    v_mfma_f32_16x16x32_bf16 v[140:143], v[60:63], v[100:103], v[140:143]
    ds_read_b64_tr_b16 v[94:95], v4 offset:3584
    v_mfma_f32_16x16x32_bf16 v[144:147], v[64:67], v[96:99], v[144:147]
    v_mfma_f32_16x16x32_bf16 v[144:147], v[68:71], v[100:103], v[144:147]
    v_mfma_f32_16x16x32_bf16 v[148:151], v[72:75], v[96:99], v[148:151]
    v_mfma_f32_16x16x32_bf16 v[148:151], v[76:79], v[100:103], v[148:151]
    s_waitcnt lgkmcnt(4)
    v_mfma_f32_16x16x32_bf16 v[152:155], v[48:51], v[80:83], v[152:155]
    ds_read_b64_tr_b16 v[96:97], v5 offset:0
    v_mfma_f32_16x16x32_bf16 v[152:155], v[52:55], v[84:87], v[152:155]
    ds_read_b64_tr_b16 v[98:99], v5 offset:512
    v_mfma_f32_16x16x32_bf16 v[156:159], v[56:59], v[80:83], v[156:159]
    ds_read_b64_tr_b16 v[100:101], v5 offset:3072
    v_mfma_f32_16x16x32_bf16 v[156:159], v[60:63], v[84:87], v[156:159]
    ds_read_b64_tr_b16 v[102:103], v5 offset:3584
    v_mfma_f32_16x16x32_bf16 v[160:163], v[64:67], v[80:83], v[160:163]
    s_add_u32 s45, s45, 1
    s_cmp_eq_u32 s45, 3
    v_mfma_f32_16x16x32_bf16 v[160:163], v[68:71], v[84:87], v[160:163]
    s_cselect_b32 s48, s46, s47
    s_cselect_b32 s45, 0, s45
    v_mfma_f32_16x16x32_bf16 v[164:167], v[72:75], v[80:83], v[164:167]
    v_add_u32 v4, s48, v4
    v_add_u32 v2, s48, v2
    v_mfma_f32_16x16x32_bf16 v[164:167], v[76:79], v[84:87], v[164:167]
    v_add_u32 v3, s48, v3
    v_add_u32 v5, s48, v5
    s_waitcnt lgkmcnt(0)
    v_mfma_f32_16x16x32_bf16 v[168:171], v[88:91], v[48:51], v[168:171]
    s_cmp_lt_u32 s44, 8
    s_cbranch_scc0 F_CNB1
    s_barrier
F_CB1:
    v_mfma_f32_16x16x32_bf16 v[168:171], v[92:95], v[52:55], v[168:171]
    ds_read_b64_tr_b16 v[80:81], v4 offset:1024
    ds_read_b64_tr_b16 v[82:83], v4 offset:1536
    v_mfma_f32_16x16x32_bf16 v[172:175], v[88:91], v[56:59], v[172:175]
    ds_read_b128 v[16:19], v2 offset:0
    ds_read_b64_tr_b16 v[84:85], v4 offset:4096
    v_mfma_f32_16x16x32_bf16 v[172:175], v[92:95], v[60:63], v[172:175]
    ds_read_b64_tr_b16 v[86:87], v4 offset:4608
    v_mfma_f32_16x16x32_bf16 v[176:179], v[88:91], v[64:67], v[176:179]
    ds_read_b128 v[20:23], v3 offset:0
    v_mfma_f32_16x16x32_bf16 v[176:179], v[92:95], v[68:71], v[176:179]
    ds_read_b128 v[24:27], v2 offset:20480
    v_mfma_f32_16x16x32_bf16 v[180:183], v[88:91], v[72:75], v[180:183]
    ds_read_b128 v[28:31], v3 offset:20480
    v_mfma_f32_16x16x32_bf16 v[180:183], v[92:95], v[76:79], v[180:183]
    v_mfma_f32_16x16x32_bf16 v[184:187], v[96:99], v[48:51], v[184:187]
    ds_read_b128 v[32:35], v2 offset:1024
    ds_read_b128 v[36:39], v3 offset:1024
    v_mfma_f32_16x16x32_bf16 v[184:187], v[100:103], v[52:55], v[184:187]
    ds_read_b64_tr_b16 v[88:89], v5 offset:1024
    ds_read_b64_tr_b16 v[90:91], v5 offset:1536
    v_mfma_f32_16x16x32_bf16 v[188:191], v[96:99], v[56:59], v[188:191]
    ds_read_b64_tr_b16 v[92:93], v5 offset:4096
    ds_read_b64_tr_b16 v[94:95], v5 offset:4608
    v_mfma_f32_16x16x32_bf16 v[188:191], v[100:103], v[60:63], v[188:191]
    ds_read_b128 v[40:43], v2 offset:21504
    v_mfma_f32_16x16x32_bf16 v[192:195], v[96:99], v[64:67], v[192:195]
    ds_read_b128 v[44:47], v3 offset:21504
    v_mfma_f32_16x16x32_bf16 v[192:195], v[100:103], v[68:71], v[192:195]
    v_mfma_f32_16x16x32_bf16 v[196:199], v[96:99], v[72:75], v[196:199]
    v_mfma_f32_16x16x32_bf16 v[196:199], v[100:103], v[76:79], v[196:199]
    s_cbranch_scc1 F_CLOOP
    s_setprio 3
    v_mul_f32 v244, s43, v104
    v_mul_f32 v245, s43, v105
    v_mul_f32 v246, s43, v106
    v_mul_f32 v247, s43, v107
    v_mul_f32 v248, s43, v108
    v_mul_f32 v249, s43, v109
    v_mul_f32 v250, s43, v110
    v_mul_f32 v251, s43, v111
    v_exp_f32 v244, v244 clamp
    v_exp_f32 v245, v245 clamp
    v_exp_f32 v246, v246 clamp
    v_exp_f32 v247, v247 clamp
    v_exp_f32 v248, v248 clamp
    v_exp_f32 v249, v249 clamp
    v_exp_f32 v250, v250 clamp
    v_exp_f32 v251, v251 clamp
    v_max_f32 v104, s42, v104
    v_max_f32 v105, s42, v105
    v_max_f32 v106, s42, v106
    v_max_f32 v107, s42, v107
    v_max_f32 v108, s42, v108
    v_max_f32 v109, s42, v109
    v_max_f32 v110, s42, v110
    v_max_f32 v111, s42, v111
    v_add_f32 v244, v244, v104
    v_add_f32 v245, v245, v105
    v_add_f32 v246, v246, v106
    v_add_f32 v247, v247, v107
    v_add_f32 v248, v248, v108
    v_add_f32 v249, v249, v109
    v_add_f32 v250, v250, v110
    v_add_f32 v251, v251, v111
    v_cvt_pk_bf16_f32 v212, v244, v245
    v_cvt_pk_bf16_f32 v213, v246, v247
    v_cvt_pk_bf16_f32 v214, v248, v249
    v_cvt_pk_bf16_f32 v215, v250, v251
    v_mov_b32 v252, s49
    v_mov_b32 v253, s49
    v_mov_b32 v254, s49
    v_mov_b32 v255, s49
    v_cvt_pk_bf16_f32 v228, v136, v137
    v_cvt_pk_bf16_f32 v229, v138, v139
    v_cvt_pk_bf16_f32 v230, v140, v141
    v_cvt_pk_bf16_f32 v231, v142, v143
    v_cvt_pk_bf16_f32 v232, v144, v145
    v_cvt_pk_bf16_f32 v233, v146, v147
    v_cvt_pk_bf16_f32 v234, v148, v149
    v_cvt_pk_bf16_f32 v235, v150, v151
    v_cvt_pk_bf16_f32 v236, v152, v153
    v_cvt_pk_bf16_f32 v237, v154, v155
    v_cvt_pk_bf16_f32 v238, v156, v157
    v_cvt_pk_bf16_f32 v239, v158, v159
    v_cvt_pk_bf16_f32 v240, v160, v161
    v_cvt_pk_bf16_f32 v241, v162, v163
    v_cvt_pk_bf16_f32 v242, v164, v165
    v_cvt_pk_bf16_f32 v243, v166, v167
    v_mfma_f32_16x16x32_bf16 v[140:143], v[212:215], v[236:239], 0
    v_mfma_f32_16x16x32_bf16 v[136:139], v[212:215], v[228:231], 0
    v_mfma_f32_16x16x32_bf16 v[152:155], v[212:215], v[252:255], 0
    v_mul_f32 v244, s43, v120
    v_mul_f32 v245, s43, v121
    v_mul_f32 v246, s43, v122
    v_mul_f32 v247, s43, v123
    v_mul_f32 v248, s43, v124
    v_mul_f32 v249, s43, v125
    v_mul_f32 v250, s43, v126
    v_mul_f32 v251, s43, v127
    v_exp_f32 v244, v244 clamp
    v_exp_f32 v245, v245 clamp
    v_exp_f32 v246, v246 clamp
    v_exp_f32 v247, v247 clamp
    v_exp_f32 v248, v248 clamp
    v_exp_f32 v249, v249 clamp
    v_exp_f32 v250, v250 clamp
    v_exp_f32 v251, v251 clamp
    v_max_f32 v120, s42, v120
    v_max_f32 v121, s42, v121
    v_max_f32 v122, s42, v122
    v_max_f32 v123, s42, v123
    v_max_f32 v124, s42, v124
    v_max_f32 v125, s42, v125
    v_max_f32 v126, s42, v126
    v_max_f32 v127, s42, v127
    v_add_f32 v244, v244, v120
    v_add_f32 v245, v245, v121
    v_add_f32 v246, v246, v122
    v_add_f32 v247, v247, v123
    v_add_f32 v248, v248, v124
    v_add_f32 v249, v249, v125
    v_add_f32 v250, v250, v126
    v_add_f32 v251, v251, v127
    v_cvt_pk_bf16_f32 v216, v244, v245
    v_cvt_pk_bf16_f32 v217, v246, v247
    v_cvt_pk_bf16_f32 v218, v248, v249
    v_cvt_pk_bf16_f32 v219, v250, v251
    s_nop 1
    v_mfma_f32_16x16x32_bf16 v[148:151], v[216:219], v[236:239], 0
    v_mfma_f32_16x16x32_bf16 v[144:147], v[216:219], v[228:231], 0
    v_mfma_f32_16x16x32_bf16 v[156:159], v[216:219], v[252:255], 0
    v_mul_f32 v244, s43, v112
    v_mul_f32 v245, s43, v113
    v_mul_f32 v246, s43, v114
    v_mul_f32 v247, s43, v115
    v_mul_f32 v248, s43, v116
    v_mul_f32 v249, s43, v117
    v_mul_f32 v250, s43, v118
    v_mul_f32 v251, s43, v119
    v_exp_f32 v244, v244 clamp
    v_exp_f32 v245, v245 clamp
    v_exp_f32 v246, v246 clamp
    v_exp_f32 v247, v247 clamp
    v_exp_f32 v248, v248 clamp
    v_exp_f32 v249, v249 clamp
    v_exp_f32 v250, v250 clamp
    v_exp_f32 v251, v251 clamp
    v_max_f32 v112, s42, v112
    v_max_f32 v113, s42, v113
    v_max_f32 v114, s42, v114
    v_max_f32 v115, s42, v115
    v_max_f32 v116, s42, v116
    v_max_f32 v117, s42, v117
    v_max_f32 v118, s42, v118
    v_max_f32 v119, s42, v119
    v_add_f32 v244, v244, v112
    v_add_f32 v245, v245, v113
    v_add_f32 v246, v246, v114
    v_add_f32 v247, v247, v115
    v_add_f32 v248, v248, v116
    v_add_f32 v249, v249, v117
    v_add_f32 v250, v250, v118
    v_add_f32 v251, v251, v119
    v_cvt_pk_bf16_f32 v212, v244, v245
    v_cvt_pk_bf16_f32 v213, v246, v247
    v_cvt_pk_bf16_f32 v214, v248, v249
    v_cvt_pk_bf16_f32 v215, v250, v251
    s_nop 1
    v_mfma_f32_16x16x32_bf16 v[140:143], v[212:215], v[240:243], v[140:143]
    v_mfma_f32_16x16x32_bf16 v[136:139], v[212:215], v[232:235], v[136:139]
    v_mfma_f32_16x16x32_bf16 v[152:155], v[212:215], v[252:255], v[152:155]
    v_mul_f32 v244, s43, v128
    v_mul_f32 v245, s43, v129
    v_mul_f32 v246, s43, v130
    v_mul_f32 v247, s43, v131
    v_mul_f32 v248, s43, v132
    v_mul_f32 v249, s43, v133
    v_mul_f32 v250, s43, v134
    v_mul_f32 v251, s43, v135
    v_exp_f32 v244, v244 clamp
    v_exp_f32 v245, v245 clamp
    v_exp_f32 v246, v246 clamp
    v_exp_f32 v247, v247 clamp
    v_exp_f32 v248, v248 clamp
    v_exp_f32 v249, v249 clamp
    v_exp_f32 v250, v250 clamp
    v_exp_f32 v251, v251 clamp
    v_max_f32 v128, s42, v128
    v_max_f32 v129, s42, v129
    v_max_f32 v130, s42, v130
    v_max_f32 v131, s42, v131
    v_max_f32 v132, s42, v132
    v_max_f32 v133, s42, v133
    v_max_f32 v134, s42, v134
    v_max_f32 v135, s42, v135
    v_add_f32 v244, v244, v128
    v_add_f32 v245, v245, v129
    v_add_f32 v246, v246, v130
    v_add_f32 v247, v247, v131
    v_add_f32 v248, v248, v132
    v_add_f32 v249, v249, v133
    v_add_f32 v250, v250, v134
    v_add_f32 v251, v251, v135
    v_cvt_pk_bf16_f32 v216, v244, v245
    v_cvt_pk_bf16_f32 v217, v246, v247
    v_cvt_pk_bf16_f32 v218, v248, v249
    v_cvt_pk_bf16_f32 v219, v250, v251
    s_nop 1
    v_mfma_f32_16x16x32_bf16 v[148:151], v[216:219], v[240:243], v[148:151]
    v_mfma_f32_16x16x32_bf16 v[144:147], v[216:219], v[232:235], v[144:147]
    v_mfma_f32_16x16x32_bf16 v[156:159], v[216:219], v[252:255], v[156:159]
    ds_write_b128 v6, v[140:143]
    s_nop 4
    ds_write_b128 v6, v[148:151] offset:1024
    s_nop 0
    ds_write_b128 v8, v[156:159] offset:2048
    ds_write_b32 v10, v14
F_XA:
    ds_read_b32 v15, v11
    ds_read_b128 v[212:215], v7 offset:1024
    ds_read_b128 v[216:219], v7
    ds_read_b128 v[220:223], v9 offset:2048
    s_waitcnt lgkmcnt(0)
    v_cmp_ne_u32 vcc, 1, v15
    s_cbranch_vccnz F_XA
    v_add_f32 v212, v212, v136
    v_add_f32 v213, v213, v137
    v_add_f32 v214, v214, v138
    v_add_f32 v215, v215, v139
    v_add_f32 v216, v216, v144
    v_add_f32 v217, v217, v145
    v_add_f32 v218, v218, v146
    v_add_f32 v219, v219, v147
    v_cvt_pk_bf16_f32 v224, v212, v213
    v_cvt_pk_bf16_f32 v225, v214, v215
    v_cvt_pk_bf16_f32 v226, v216, v217
    v_cvt_pk_bf16_f32 v227, v218, v219
    buffer_store_dwordx4 v[224:227], v1, s[36:39], s50 offen sc1
    v_add_f32 v220, v220, v152
    v_add_f32 v221, v221, v153
    v_add_f32 v222, v222, v154
    v_add_f32 v223, v223, v155
    s_mov_b32 exec_lo, 0x00010001
    s_mov_b32 exec_hi, 0x00010001
    buffer_store_dwordx4 v[220:223], v12, s[36:39], s51 offen sc1
    s_mov_b64 exec, -1
F_WGO:
    ds_read_b32 v15, v209 offset:176
    s_waitcnt lgkmcnt(0)
    v_cmp_ne_u32 vcc, 1, v15
    s_cbranch_vccz F_WGO_X
    s_sleep 1
    s_branch F_WGO
F_WGO_X:
F_WGD2:
    ds_read_b32 v15, v209 offset:80
    s_waitcnt lgkmcnt(0)
    v_cmp_ne_u32 vcc, 1, v15
    s_cbranch_vccz F_WGD2_X
    s_sleep 1
    s_branch F_WGD2
F_WGD2_X:
    buffer_load_dwordx4 v[100:103], v13, s[36:39], s54 offen sc1
    v_mul_f32 v244, s43, v168
    v_mul_f32 v245, s43, v169
    v_mul_f32 v246, s43, v170
    v_mul_f32 v247, s43, v171
    v_mul_f32 v248, s43, v184
    v_mul_f32 v249, s43, v185
    v_mul_f32 v250, s43, v186
    v_mul_f32 v251, s43, v187
    v_exp_f32 v244, v244 clamp
    v_exp_f32 v245, v245 clamp
    v_exp_f32 v246, v246 clamp
    v_exp_f32 v247, v247 clamp
    v_exp_f32 v248, v248 clamp
    v_exp_f32 v249, v249 clamp
    v_exp_f32 v250, v250 clamp
    v_exp_f32 v251, v251 clamp
    v_max_f32 v168, s42, v168
    v_max_f32 v169, s42, v169
    v_max_f32 v170, s42, v170
    v_max_f32 v171, s42, v171
    v_max_f32 v184, s42, v184
    v_max_f32 v185, s42, v185
    v_max_f32 v186, s42, v186
    v_max_f32 v187, s42, v187
    v_add_f32 v244, v244, v168
    v_add_f32 v245, v245, v169
    v_add_f32 v246, v246, v170
    v_add_f32 v247, v247, v171
    v_add_f32 v248, v248, v184
    v_add_f32 v249, v249, v185
    v_add_f32 v250, v250, v186
    v_add_f32 v251, v251, v187
    v_cvt_pk_bf16_f32 v84, v244, v245
    v_cvt_pk_bf16_f32 v85, v246, v247
    v_cvt_pk_bf16_f32 v86, v248, v249
    v_cvt_pk_bf16_f32 v87, v250, v251
    v_mul_f32 v244, s43, v172
    v_mul_f32 v245, s43, v173
    v_mul_f32 v246, s43, v174
    v_mul_f32 v247, s43, v175
    v_mul_f32 v248, s43, v188
    v_mul_f32 v249, s43, v189
    v_mul_f32 v250, s43, v190
    v_mul_f32 v251, s43, v191
    v_exp_f32 v244, v244 clamp
    v_exp_f32 v245, v245 clamp
    v_exp_f32 v246, v246 clamp
    v_exp_f32 v247, v247 clamp
    v_exp_f32 v248, v248 clamp
    v_exp_f32 v249, v249 clamp
    v_exp_f32 v250, v250 clamp
    v_exp_f32 v251, v251 clamp
    v_max_f32 v172, s42, v172
    v_max_f32 v173, s42, v173
    v_max_f32 v174, s42, v174
    v_max_f32 v175, s42, v175
    v_max_f32 v188, s42, v188
    v_max_f32 v189, s42, v189
    v_max_f32 v190, s42, v190
    v_max_f32 v191, s42, v191
    v_add_f32 v244, v244, v172
    v_add_f32 v245, v245, v173
    v_add_f32 v246, v246, v174
    v_add_f32 v247, v247, v175
    v_add_f32 v248, v248, v188
    v_add_f32 v249, v249, v189
    v_add_f32 v250, v250, v190
    v_add_f32 v251, v251, v191
    v_cvt_pk_bf16_f32 v88, v244, v245
    v_cvt_pk_bf16_f32 v89, v246, v247
    v_cvt_pk_bf16_f32 v90, v248, v249
    v_cvt_pk_bf16_f32 v91, v250, v251
    v_mul_f32 v244, s43, v176
    v_mul_f32 v245, s43, v177
    v_mul_f32 v246, s43, v178
    v_mul_f32 v247, s43, v179
    v_mul_f32 v248, s43, v192
    v_mul_f32 v249, s43, v193
    v_mul_f32 v250, s43, v194
    v_mul_f32 v251, s43, v195
    v_exp_f32 v244, v244 clamp
    v_exp_f32 v245, v245 clamp
    v_exp_f32 v246, v246 clamp
    v_exp_f32 v247, v247 clamp
    v_exp_f32 v248, v248 clamp
    v_exp_f32 v249, v249 clamp
    v_exp_f32 v250, v250 clamp
    v_exp_f32 v251, v251 clamp
    v_max_f32 v176, s42, v176
    v_max_f32 v177, s42, v177
    v_max_f32 v178, s42, v178
    v_max_f32 v179, s42, v179
    v_max_f32 v192, s42, v192
    v_max_f32 v193, s42, v193
    v_max_f32 v194, s42, v194
    v_max_f32 v195, s42, v195
    v_add_f32 v244, v244, v176
    v_add_f32 v245, v245, v177
    v_add_f32 v246, v246, v178
    v_add_f32 v247, v247, v179
    v_add_f32 v248, v248, v192
    v_add_f32 v249, v249, v193
    v_add_f32 v250, v250, v194
    v_add_f32 v251, v251, v195
    v_cvt_pk_bf16_f32 v92, v244, v245
    v_cvt_pk_bf16_f32 v93, v246, v247
    v_cvt_pk_bf16_f32 v94, v248, v249
    v_cvt_pk_bf16_f32 v95, v250, v251
    v_mul_f32 v244, s43, v180
    v_mul_f32 v245, s43, v181
    v_mul_f32 v246, s43, v182
    v_mul_f32 v247, s43, v183
    v_mul_f32 v248, s43, v196
    v_mul_f32 v249, s43, v197
    v_mul_f32 v250, s43, v198
    v_mul_f32 v251, s43, v199
    v_exp_f32 v244, v244 clamp
    v_exp_f32 v245, v245 clamp
    v_exp_f32 v246, v246 clamp
    v_exp_f32 v247, v247 clamp
    v_exp_f32 v248, v248 clamp
    v_exp_f32 v249, v249 clamp
    v_exp_f32 v250, v250 clamp
    v_exp_f32 v251, v251 clamp
    v_max_f32 v180, s42, v180
    v_max_f32 v181, s42, v181
    v_max_f32 v182, s42, v182
    v_max_f32 v183, s42, v183
    v_max_f32 v196, s42, v196
    v_max_f32 v197, s42, v197
    v_max_f32 v198, s42, v198
    v_max_f32 v199, s42, v199
    v_add_f32 v244, v244, v180
    v_add_f32 v245, v245, v181
    v_add_f32 v246, v246, v182
    v_add_f32 v247, v247, v183
    v_add_f32 v248, v248, v196
    v_add_f32 v249, v249, v197
    v_add_f32 v250, v250, v198
    v_add_f32 v251, v251, v199
    v_cvt_pk_bf16_f32 v96, v244, v245
    v_cvt_pk_bf16_f32 v97, v246, v247
    v_cvt_pk_bf16_f32 v98, v248, v249
    v_cvt_pk_bf16_f32 v99, v250, v251
    s_waitcnt vmcnt(0)
    v_cmp_eq_u32 s[40:41], -1, v100
    s_cmp_lg_u64 s[40:41], 0
    s_cbranch_scc1 F_K1N
    s_lshl_b32 s59, s30, 12
    s_and_b32 s59, s59, 0x7fff
    s_add_u32 s40, s59, s53
    buffer_load_dwordx4 v[16:19], v1, s[36:39], s40 offen offset:0 sc1
    buffer_load_dwordx4 v[20:23], v1, s[36:39], s40 offen offset:2048 sc1
    s_add_u32 s59, s59, 4096
    s_and_b32 s59, s59, 0x7fff
    s_add_u32 s40, s59, s53
    buffer_load_dwordx4 v[24:27], v1, s[36:39], s40 offen offset:0 sc1
    buffer_load_dwordx4 v[28:31], v1, s[36:39], s40 offen offset:2048 sc1
    s_add_u32 s59, s59, 4096
    s_and_b32 s59, s59, 0x7fff
    s_add_u32 s40, s59, s53
    buffer_load_dwordx4 v[32:35], v1, s[36:39], s40 offen offset:0 sc1
    buffer_load_dwordx4 v[36:39], v1, s[36:39], s40 offen offset:2048 sc1
    s_add_u32 s59, s59, 4096
    s_and_b32 s59, s59, 0x7fff
    s_add_u32 s40, s59, s53
    buffer_load_dwordx4 v[40:43], v1, s[36:39], s40 offen offset:0 sc1
    buffer_load_dwordx4 v[44:47], v1, s[36:39], s40 offen offset:2048 sc1
    s_add_u32 s59, s59, 4096
    s_and_b32 s59, s59, 0x7fff
    s_add_u32 s40, s59, s53
    buffer_load_dwordx4 v[48:51], v1, s[36:39], s40 offen offset:0 sc1
    buffer_load_dwordx4 v[52:55], v1, s[36:39], s40 offen offset:2048 sc1
    s_add_u32 s59, s59, 4096
    s_and_b32 s59, s59, 0x7fff
    s_add_u32 s40, s59, s53
    buffer_load_dwordx4 v[56:59], v1, s[36:39], s40 offen offset:0 sc1
    buffer_load_dwordx4 v[60:63], v1, s[36:39], s40 offen offset:2048 sc1
    s_add_u32 s59, s59, 4096
    s_and_b32 s59, s59, 0x7fff
    s_add_u32 s40, s59, s53
    buffer_load_dwordx4 v[64:67], v1, s[36:39], s40 offen offset:0 sc1
    buffer_load_dwordx4 v[68:71], v1, s[36:39], s40 offen offset:2048 sc1
    s_add_u32 s59, s59, 4096
    s_and_b32 s59, s59, 0x7fff
    s_add_u32 s40, s59, s53
    buffer_load_dwordx4 v[72:75], v1, s[36:39], s40 offen offset:0 sc1
    buffer_load_dwordx4 v[76:79], v1, s[36:39], s40 offen offset:2048 sc1
    s_mov_b32 s58, 1
    s_branch F_K1X
F_K1N:
    buffer_load_dwordx4 v[100:103], v13, s[36:39], s54 offen sc1
    s_mov_b32 s58, 0
F_K1X:
    v_mov_b32 v112, s42
    v_mov_b32 v113, s42
    v_mov_b32 v114, s42
    v_mov_b32 v115, s42
    v_bfe_u32 v116, v0, 2, 2
    v_lshrrev_b32 v117, 4, v0
    v_cmp_eq_u32 vcc, v116, v117
    v_and_b32 v116, 1, v0
    v_lshlrev_b32 v116, 4, v116
    v_mov_b32 v117, 0x3f80
    v_lshlrev_b32 v116, v116, v117
    v_cndmask_b32 v116, 0, v116, vcc
    v_and_b32 v117, 2, v0
    v_cmp_eq_u32 vcc, 0, v117
    v_mov_b32 v142, 0
    v_mov_b32 v143, 0
    v_mov_b32 v144, 0
    v_mov_b32 v145, 0
    v_cndmask_b32 v140, 0, v116, vcc
    v_cndmask_b32 v146, 0, v116, vcc
    v_cndmask_b32 v141, v116, v142, vcc
    v_cndmask_b32 v147, v116, v142, vcc
    s_cmp_eq_u32 s58, 1
    s_cbranch_scc1 F_K2
    s_waitcnt vmcnt(0)
    v_cmp_eq_u32 vcc, -1, v100
    s_cbranch_vccz F_P2_X
    s_mov_b32 s45, 0
F_P2:
    buffer_load_dwordx4 v[100:103], v13, s[36:39], s54 offen sc1
    s_waitcnt vmcnt(0)
    v_cmp_eq_u32 vcc, -1, v100
    s_cbranch_vccz F_P2_X
    s_sleep 1
    s_add_u32 s45, s45, 1
    s_cmp_lt_u32 s45, 400000
    s_cbranch_scc1 F_P2
F_P2_X:
    s_lshl_b32 s59, s30, 12
    s_and_b32 s59, s59, 0x7fff
    s_add_u32 s40, s59, s53
    buffer_load_dwordx4 v[16:19], v1, s[36:39], s40 offen offset:0 sc1
    buffer_load_dwordx4 v[20:23], v1, s[36:39], s40 offen offset:2048 sc1
    s_add_u32 s59, s59, 4096
    s_and_b32 s59, s59, 0x7fff
    s_add_u32 s40, s59, s53
    buffer_load_dwordx4 v[24:27], v1, s[36:39], s40 offen offset:0 sc1
    buffer_load_dwordx4 v[28:31], v1, s[36:39], s40 offen offset:2048 sc1
    s_add_u32 s59, s59, 4096
    s_and_b32 s59, s59, 0x7fff
    s_add_u32 s40, s59, s53
    buffer_load_dwordx4 v[32:35], v1, s[36:39], s40 offen offset:0 sc1
    buffer_load_dwordx4 v[36:39], v1, s[36:39], s40 offen offset:2048 sc1
    s_add_u32 s59, s59, 4096
    s_and_b32 s59, s59, 0x7fff
    s_add_u32 s40, s59, s53
    buffer_load_dwordx4 v[40:43], v1, s[36:39], s40 offen offset:0 sc1
    buffer_load_dwordx4 v[44:47], v1, s[36:39], s40 offen offset:2048 sc1
    s_add_u32 s59, s59, 4096
    s_and_b32 s59, s59, 0x7fff
    s_add_u32 s40, s59, s53
    buffer_load_dwordx4 v[48:51], v1, s[36:39], s40 offen offset:0 sc1
    buffer_load_dwordx4 v[52:55], v1, s[36:39], s40 offen offset:2048 sc1
    s_add_u32 s59, s59, 4096
    s_and_b32 s59, s59, 0x7fff
    s_add_u32 s40, s59, s53
    buffer_load_dwordx4 v[56:59], v1, s[36:39], s40 offen offset:0 sc1
    buffer_load_dwordx4 v[60:63], v1, s[36:39], s40 offen offset:2048 sc1
    s_add_u32 s59, s59, 4096
    s_and_b32 s59, s59, 0x7fff
    s_add_u32 s40, s59, s53
    buffer_load_dwordx4 v[64:67], v1, s[36:39], s40 offen offset:0 sc1
    buffer_load_dwordx4 v[68:71], v1, s[36:39], s40 offen offset:2048 sc1
    s_add_u32 s59, s59, 4096
    s_and_b32 s59, s59, 0x7fff
    s_add_u32 s40, s59, s53
    buffer_load_dwordx4 v[72:75], v1, s[36:39], s40 offen offset:0 sc1
    buffer_load_dwordx4 v[76:79], v1, s[36:39], s40 offen offset:2048 sc1
F_K2:
    v_add_f32_dpp v120, v100, v100 row_ror:8 row_mask:0xf bank_mask:0xf
    v_add_f32_dpp v121, v101, v101 row_ror:8 row_mask:0xf bank_mask:0xf
    v_add_f32_dpp v122, v102, v102 row_ror:8 row_mask:0xf bank_mask:0xf
    v_add_f32_dpp v123, v103, v103 row_ror:8 row_mask:0xf bank_mask:0xf
    v_add_f32_dpp v120, v120, v120 row_ror:4 row_mask:0xf bank_mask:0xf
    v_add_f32_dpp v121, v121, v121 row_ror:4 row_mask:0xf bank_mask:0xf
    v_add_f32_dpp v122, v122, v122 row_ror:4 row_mask:0xf bank_mask:0xf
    v_add_f32_dpp v123, v123, v123 row_ror:4 row_mask:0xf bank_mask:0xf
    v_add_f32_dpp v120, v120, v120 row_ror:2 row_mask:0xf bank_mask:0xf
    v_add_f32_dpp v121, v121, v121 row_ror:2 row_mask:0xf bank_mask:0xf
    v_add_f32_dpp v122, v122, v122 row_ror:2 row_mask:0xf bank_mask:0xf
    v_add_f32_dpp v123, v123, v123 row_ror:2 row_mask:0xf bank_mask:0xf
    v_add_f32_dpp v120, v120, v120 row_ror:1 row_mask:0xf bank_mask:0xf
    v_add_f32_dpp v121, v121, v121 row_ror:1 row_mask:0xf bank_mask:0xf
    v_add_f32_dpp v122, v122, v122 row_ror:1 row_mask:0xf bank_mask:0xf
    v_add_f32_dpp v123, v123, v123 row_ror:1 row_mask:0xf bank_mask:0xf
    v_cvt_pk_bf16_f32 v132, v120, v121
    v_cvt_pk_bf16_f32 v133, v122, v123
    v_mov_b32 v15, 0
    s_waitcnt vmcnt(14)
    v_mfma_f32_16x16x32_bf16 v[104:107], v[140:143], v[16:19], 0
    v_mfma_f32_16x16x32_bf16 v[108:111], v[144:147], v[16:19], 0
    v_max3_u32 v15, v15, v16, v20
    v_mfma_f32_16x16x32_bf16 v[104:107], v[140:143], v[20:23], v[104:107]
    v_mfma_f32_16x16x32_bf16 v[108:111], v[144:147], v[20:23], v[108:111]
    s_waitcnt vmcnt(12)
    v_mfma_f32_16x16x32_bf16 v[104:107], v[140:143], v[24:27], v[104:107]
    v_mfma_f32_16x16x32_bf16 v[108:111], v[144:147], v[24:27], v[108:111]
    v_max3_u32 v15, v15, v24, v28
    v_mfma_f32_16x16x32_bf16 v[104:107], v[140:143], v[28:31], v[104:107]
    v_mfma_f32_16x16x32_bf16 v[108:111], v[144:147], v[28:31], v[108:111]
    s_waitcnt vmcnt(10)
    v_mfma_f32_16x16x32_bf16 v[104:107], v[140:143], v[32:35], v[104:107]
    v_mfma_f32_16x16x32_bf16 v[108:111], v[144:147], v[32:35], v[108:111]
    v_max3_u32 v15, v15, v32, v36
    v_mfma_f32_16x16x32_bf16 v[104:107], v[140:143], v[36:39], v[104:107]
    v_mfma_f32_16x16x32_bf16 v[108:111], v[144:147], v[36:39], v[108:111]
    s_waitcnt vmcnt(8)
    v_mfma_f32_16x16x32_bf16 v[104:107], v[140:143], v[40:43], v[104:107]
    v_mfma_f32_16x16x32_bf16 v[108:111], v[144:147], v[40:43], v[108:111]
    v_max3_u32 v15, v15, v40, v44
    v_mfma_f32_16x16x32_bf16 v[104:107], v[140:143], v[44:47], v[104:107]
    v_mfma_f32_16x16x32_bf16 v[108:111], v[144:147], v[44:47], v[108:111]
    s_waitcnt vmcnt(6)
    v_mfma_f32_16x16x32_bf16 v[104:107], v[140:143], v[48:51], v[104:107]
    v_mfma_f32_16x16x32_bf16 v[108:111], v[144:147], v[48:51], v[108:111]
    v_max3_u32 v15, v15, v48, v52
    v_mfma_f32_16x16x32_bf16 v[104:107], v[140:143], v[52:55], v[104:107]
    v_mfma_f32_16x16x32_bf16 v[108:111], v[144:147], v[52:55], v[108:111]
    s_waitcnt vmcnt(4)
    v_mfma_f32_16x16x32_bf16 v[104:107], v[140:143], v[56:59], v[104:107]
    v_mfma_f32_16x16x32_bf16 v[108:111], v[144:147], v[56:59], v[108:111]
    v_max3_u32 v15, v15, v56, v60
    v_mfma_f32_16x16x32_bf16 v[104:107], v[140:143], v[60:63], v[104:107]
    v_mfma_f32_16x16x32_bf16 v[108:111], v[144:147], v[60:63], v[108:111]
    s_waitcnt vmcnt(2)
    v_mfma_f32_16x16x32_bf16 v[104:107], v[140:143], v[64:67], v[104:107]
    v_mfma_f32_16x16x32_bf16 v[108:111], v[144:147], v[64:67], v[108:111]
    v_max3_u32 v15, v15, v64, v68
    v_mfma_f32_16x16x32_bf16 v[104:107], v[140:143], v[68:71], v[104:107]
    v_mfma_f32_16x16x32_bf16 v[108:111], v[144:147], v[68:71], v[108:111]
    s_waitcnt vmcnt(0)
    v_mfma_f32_16x16x32_bf16 v[104:107], v[140:143], v[72:75], v[104:107]
    v_mfma_f32_16x16x32_bf16 v[108:111], v[144:147], v[72:75], v[108:111]
    v_max3_u32 v15, v15, v72, v76
    v_mfma_f32_16x16x32_bf16 v[104:107], v[140:143], v[76:79], v[104:107]
    v_mfma_f32_16x16x32_bf16 v[108:111], v[144:147], v[76:79], v[108:111]
    v_cmp_eq_u32 vcc, -1, v15
    s_cbranch_vccz F_K2X
    s_add_u32 s58, s58, 2
    s_cmp_gt_u32 s58, 400000
    s_cbranch_scc0 F_P2_X
F_K2X:
    s_nop 4
    v_cvt_pk_bf16_f32 v136, v104, v105
    v_cvt_pk_bf16_f32 v137, v106, v107
    v_cvt_pk_bf16_f32 v138, v108, v109
    v_cvt_pk_bf16_f32 v139, v110, v111
    ds_write_b128 v7, v[136:139]
    ds_write_b64 v9, v[132:133] offset:2048
    ds_write_b32 v10, v14 offset:4
    s_add_u32 m0, s68, 40960
    s_add_u32 s40, s69, 917504
    buffer_load_dwordx4 v205, s[4:7], s40 offen lds
    s_add_u32 m0, s68, 45056
    s_add_u32 s40, s69, 983040
    buffer_load_dwordx4 v205, s[4:7], s40 offen lds
    s_add_u32 m0, s68, 49152
    s_add_u32 s40, s69, 1048576
    buffer_load_dwordx4 v205, s[4:7], s40 offen lds
    s_add_u32 m0, s68, 53248
    s_add_u32 s40, s69, 1114112
    buffer_load_dwordx4 v205, s[4:7], s40 offen lds
    s_add_u32 m0, s68, 57344
    s_add_u32 s40, s69, 1179648
    buffer_load_dwordx4 v205, s[4:7], s40 offen lds
F_XB:
    ds_read_b32 v15, v11 offset:4
    ds_read_b64 v[134:135], v8 offset:2048
    ds_read_b64 v[124:125], v200
    ds_read_b64 v[126:127], v201
    ds_read_b64 v[128:129], v202
    ds_read_b64 v[130:131], v203
    s_waitcnt lgkmcnt(0)
    v_cmp_ne_u32 vcc, 1, v15
    s_cbranch_vccnz F_XB
    v_mfma_f32_16x16x32_bf16 v[140:143], v[132:135], v[84:87], v[112:115]
    v_mfma_f32_16x16x32_bf16 v[144:147], v[132:135], v[88:91], v[112:115]
    v_mfma_f32_16x16x32_bf16 v[148:151], v[132:135], v[92:95], v[112:115]
    v_mfma_f32_16x16x32_bf16 v[152:155], v[132:135], v[96:99], v[112:115]
    v_mfma_f32_16x16x32_bf16 v[156:159], v[124:127], v[84:87], 0
    v_mfma_f32_16x16x32_bf16 v[160:163], v[128:131], v[84:87], 0
    v_mfma_f32_16x16x32_bf16 v[164:167], v[124:127], v[88:91], 0
    v_mfma_f32_16x16x32_bf16 v[168:171], v[128:131], v[88:91], 0
    v_mfma_f32_16x16x32_bf16 v[172:175], v[124:127], v[92:95], 0
    v_mfma_f32_16x16x32_bf16 v[176:179], v[128:131], v[92:95], 0
    v_mfma_f32_16x16x32_bf16 v[180:183], v[124:127], v[96:99], 0
    v_mfma_f32_16x16x32_bf16 v[184:187], v[128:131], v[96:99], 0
    ds_write_b32 v206, v14
    s_add_u32 m0, s68, 61440
    s_add_u32 s40, s69, 1245184
    buffer_load_dwordx4 v205, s[4:7], s40 offen lds
    s_add_u32 m0, s68, 65536
    s_add_u32 s40, s69, 1310720
    buffer_load_dwordx4 v205, s[4:7], s40 offen lds
    s_add_u32 m0, s68, 69632
    s_add_u32 s40, s69, 1376256
    buffer_load_dwordx4 v205, s[4:7], s40 offen lds
    s_add_u32 m0, s68, 73728
    s_add_u32 s40, s69, 1441792
    buffer_load_dwordx4 v205, s[4:7], s40 offen lds
    s_add_u32 m0, s68, 77824
    s_add_u32 s40, s69, 1507328
    buffer_load_dwordx4 v205, s[4:7], s40 offen lds
    v_rcp_f32 v140, v140
    v_rcp_f32 v144, v144
    v_rcp_f32 v148, v148
    v_rcp_f32 v152, v152
    v_mul_f32 v156, v156, v140
    v_mul_f32 v157, v157, v140
    v_mul_f32 v158, v158, v140
    v_mul_f32 v159, v159, v140
    v_mul_f32 v160, v160, v140
    v_mul_f32 v161, v161, v140
    v_mul_f32 v162, v162, v140
    v_mul_f32 v163, v163, v140
    v_cvt_pk_bf16_f32 v212, v156, v157
    v_cvt_pk_bf16_f32 v213, v158, v159
    v_cvt_pk_bf16_f32 v214, v160, v161
    v_cvt_pk_bf16_f32 v215, v162, v163
    buffer_store_dwordx4 v[212:215], v1, s[36:39], s52 offen sc1
    s_add_u32 s52, s52, 33792
    v_mul_f32 v164, v164, v144
    v_mul_f32 v165, v165, v144
    v_mul_f32 v166, v166, v144
    v_mul_f32 v167, v167, v144
    v_mul_f32 v168, v168, v144
    v_mul_f32 v169, v169, v144
    v_mul_f32 v170, v170, v144
    v_mul_f32 v171, v171, v144
    v_cvt_pk_bf16_f32 v216, v164, v165
    v_cvt_pk_bf16_f32 v217, v166, v167
    v_cvt_pk_bf16_f32 v218, v168, v169
    v_cvt_pk_bf16_f32 v219, v170, v171
    buffer_store_dwordx4 v[216:219], v1, s[36:39], s52 offen sc1
    s_add_u32 s52, s52, 33792
    v_mul_f32 v172, v172, v148
    v_mul_f32 v173, v173, v148
    v_mul_f32 v174, v174, v148
    v_mul_f32 v175, v175, v148
    v_mul_f32 v176, v176, v148
    v_mul_f32 v177, v177, v148
    v_mul_f32 v178, v178, v148
    v_mul_f32 v179, v179, v148
    v_cvt_pk_bf16_f32 v220, v172, v173
    v_cvt_pk_bf16_f32 v221, v174, v175
    v_cvt_pk_bf16_f32 v222, v176, v177
    v_cvt_pk_bf16_f32 v223, v178, v179
    buffer_store_dwordx4 v[220:223], v1, s[36:39], s52 offen sc1
    s_add_u32 s52, s52, 33792
    v_mul_f32 v180, v180, v152
    v_mul_f32 v181, v181, v152
    v_mul_f32 v182, v182, v152
    v_mul_f32 v183, v183, v152
    v_mul_f32 v184, v184, v152
    v_mul_f32 v185, v185, v152
    v_mul_f32 v186, v186, v152
    v_mul_f32 v187, v187, v152
    v_cvt_pk_bf16_f32 v224, v180, v181
    v_cvt_pk_bf16_f32 v225, v182, v183
    v_cvt_pk_bf16_f32 v226, v184, v185
    v_cvt_pk_bf16_f32 v227, v186, v187
    buffer_store_dwordx4 v[224:227], v1, s[36:39], s52 offen sc1
    v_mov_b32 v16, 0
    v_mov_b32 v17, 0
    v_mov_b32 v18, 0
    v_mov_b32 v19, 0
    v_mov_b32 v20, 0
    v_mov_b32 v21, 0
    v_mov_b32 v22, 0
    v_mov_b32 v23, 0
    v_mov_b32 v24, 0
    v_mov_b32 v25, 0
    v_mov_b32 v26, 0
    v_mov_b32 v27, 0
    v_mov_b32 v28, 0
    v_mov_b32 v29, 0
    v_mov_b32 v30, 0
    v_mov_b32 v31, 0
    v_mov_b32 v32, 0
    v_mov_b32 v33, 0
    v_mov_b32 v34, 0
    v_mov_b32 v35, 0
    v_mov_b32 v36, 0
    v_mov_b32 v37, 0
    v_mov_b32 v38, 0
    v_mov_b32 v39, 0
    v_mov_b32 v40, 0
    v_mov_b32 v41, 0
    v_mov_b32 v42, 0
    v_mov_b32 v43, 0
    v_mov_b32 v44, 0
    v_mov_b32 v45, 0
    v_mov_b32 v46, 0
    v_mov_b32 v47, 0
    v_add_u32 v6, 33792, v1
    s_mov_b32 s46, 0x11111111
    s_mov_b32 s47, 0
    s_mov_b32 s50, -1
    s_mov_b32 s51, -1
    s_mov_b32 s54, 0x76432105
    s_mov_b32 s44, 0
    s_mov_b32 s58, 0
    s_waitcnt vmcnt(4)
    ds_write_b32 v206, v14 offset:96
.p2align 6
F_GLOOP:
    s_cmp_lt_i32 s50, 0
    s_cbranch_scc1 F_GE0
    s_waitcnt vmcnt(8)
F_GC0:
    v_max3_u32 v15, v80, v84, v88
    v_max3_u32 v7, v92, v96, v100
    v_max3_u32 v15, v15, v104, v108
    v_max_u32 v15, v15, v7
    v_cmp_eq_u32 vcc, -1, v15
    s_cbranch_vccnz F_GF0
F_GK0:
    s_waitcnt lgkmcnt(4)
    v_mfma_f32_16x16x32_bf16 v[16:19], v[48:51], v[80:83], v[16:19]
    ds_read_b64_tr_b16 v[64:65], v2 offset:4096
    ds_read_b64_tr_b16 v[66:67], v2 offset:6144
    v_mfma_f32_16x16x32_bf16 v[32:35], v[48:51], v[84:87], v[32:35]
    ds_read_b64_tr_b16 v[68:69], v3 offset:4096
    ds_read_b64_tr_b16 v[70:71], v3 offset:6144
    v_mfma_f32_16x16x32_bf16 v[20:23], v[52:55], v[80:83], v[20:23]
    ds_read_b64_tr_b16 v[72:73], v4 offset:4096
    ds_read_b64_tr_b16 v[74:75], v4 offset:6144
    v_mfma_f32_16x16x32_bf16 v[36:39], v[52:55], v[84:87], v[36:39]
    ds_read_b64_tr_b16 v[76:77], v5 offset:4096
    ds_read_b64_tr_b16 v[78:79], v5 offset:6144
    s_waitcnt lgkmcnt(8)
    v_mfma_f32_16x16x32_bf16 v[24:27], v[56:59], v[80:83], v[24:27]
    s_and_b32 s45, s46, s47
    s_cselect_b32 s66, s38, 0
    v_mfma_f32_16x16x32_bf16 v[40:43], v[56:59], v[84:87], v[40:43]
    s_ff1_i32_b32 s50, s45
    s_bitset0_b32 s46, s50
    v_mfma_f32_16x16x32_bf16 v[28:31], v[60:63], v[80:83], v[28:31]
    s_lshl_b32 s52, s50, 10
    s_add_u32 s52, s52, s55
    v_mfma_f32_16x16x32_bf16 v[44:47], v[60:63], v[84:87], v[44:47]
    s_waitcnt lgkmcnt(4)
    v_mfma_f32_16x16x32_bf16 v[16:19], v[64:67], v[88:91], v[16:19]
    ds_read_b64_tr_b16 v[48:49], v2 offset:8192
    ds_read_b64_tr_b16 v[50:51], v2 offset:10240
    v_mfma_f32_16x16x32_bf16 v[32:35], v[64:67], v[92:95], v[32:35]
    ds_read_b64_tr_b16 v[52:53], v3 offset:8192
    ds_read_b64_tr_b16 v[54:55], v3 offset:10240
    v_mfma_f32_16x16x32_bf16 v[20:23], v[68:71], v[88:91], v[20:23]
    ds_read_b64_tr_b16 v[56:57], v4 offset:8192
    ds_read_b64_tr_b16 v[58:59], v4 offset:10240
    v_mfma_f32_16x16x32_bf16 v[36:39], v[68:71], v[92:95], v[36:39]
    ds_read_b64_tr_b16 v[60:61], v5 offset:8192
    ds_read_b64_tr_b16 v[62:63], v5 offset:10240
    s_waitcnt lgkmcnt(8)
    v_mfma_f32_16x16x32_bf16 v[24:27], v[72:75], v[88:91], v[24:27]
    buffer_load_dwordx4 v[80:83], v1, s[64:67], s52 offen offset:0 sc1
    buffer_load_dwordx4 v[84:87], v6, s[64:67], s52 offen offset:0 sc1
    v_mfma_f32_16x16x32_bf16 v[40:43], v[72:75], v[92:95], v[40:43]
    v_mfma_f32_16x16x32_bf16 v[28:31], v[76:79], v[88:91], v[28:31]
    v_mfma_f32_16x16x32_bf16 v[44:47], v[76:79], v[92:95], v[44:47]
    s_waitcnt lgkmcnt(4)
    v_mfma_f32_16x16x32_bf16 v[16:19], v[48:51], v[96:99], v[16:19]
    ds_read_b64_tr_b16 v[64:65], v2 offset:12288
    ds_read_b64_tr_b16 v[66:67], v2 offset:14336
    v_mfma_f32_16x16x32_bf16 v[32:35], v[48:51], v[100:103], v[32:35]
    ds_read_b64_tr_b16 v[68:69], v3 offset:12288
    ds_read_b64_tr_b16 v[70:71], v3 offset:14336
    v_mfma_f32_16x16x32_bf16 v[20:23], v[52:55], v[96:99], v[20:23]
    ds_read_b64_tr_b16 v[72:73], v4 offset:12288
    ds_read_b64_tr_b16 v[74:75], v4 offset:14336
    v_mfma_f32_16x16x32_bf16 v[36:39], v[52:55], v[100:103], v[36:39]
    ds_read_b64_tr_b16 v[76:77], v5 offset:12288
    ds_read_b64_tr_b16 v[78:79], v5 offset:14336
    s_waitcnt lgkmcnt(8)
    v_mfma_f32_16x16x32_bf16 v[24:27], v[56:59], v[96:99], v[24:27]
    s_lshr_b32 s48, s54, s51
    s_and_b32 s48, s48, 15
    v_mfma_f32_16x16x32_bf16 v[40:43], v[56:59], v[100:103], v[40:43]
    s_lshl_b32 s48, s48, 14
    buffer_load_dwordx4 v[88:91], v1, s[64:67], s52 offen offset:1024 sc1
    v_mfma_f32_16x16x32_bf16 v[28:31], v[60:63], v[96:99], v[28:31]
    buffer_load_dwordx4 v[92:95], v6, s[64:67], s52 offen offset:1024 sc1
    v_mfma_f32_16x16x32_bf16 v[44:47], v[60:63], v[100:103], v[44:47]
    s_waitcnt lgkmcnt(4)
    v_mfma_f32_16x16x32_bf16 v[16:19], v[64:67], v[104:107], v[16:19]
    v_add_u32 v2, s48, v207
    v_xor_b32 v3, 32, v2
    v_mfma_f32_16x16x32_bf16 v[32:35], v[64:67], v[108:111], v[32:35]
    v_xor_b32 v4, 64, v2
    v_xor_b32 v5, 96, v2
    v_mfma_f32_16x16x32_bf16 v[20:23], v[68:71], v[104:107], v[20:23]
    ds_read_b64_tr_b16 v[48:49], v2 offset:0
    ds_read_b64_tr_b16 v[50:51], v2 offset:2048
    v_mfma_f32_16x16x32_bf16 v[36:39], v[68:71], v[108:111], v[36:39]
    ds_read_b64_tr_b16 v[52:53], v3 offset:0
    ds_read_b64_tr_b16 v[54:55], v3 offset:2048
    s_waitcnt lgkmcnt(4)
    v_mfma_f32_16x16x32_bf16 v[24:27], v[72:75], v[104:107], v[24:27]
    ds_read_b64_tr_b16 v[56:57], v4 offset:0
    ds_read_b64_tr_b16 v[58:59], v4 offset:2048
    v_mfma_f32_16x16x32_bf16 v[40:43], v[72:75], v[108:111], v[40:43]
    ds_read_b64_tr_b16 v[60:61], v5 offset:0
    ds_read_b64_tr_b16 v[62:63], v5 offset:2048
    v_mfma_f32_16x16x32_bf16 v[28:31], v[76:79], v[104:107], v[28:31]
    buffer_load_dwordx4 v[96:99], v1, s[64:67], s52 offen offset:2048 sc1
    buffer_load_dwordx4 v[100:103], v6, s[64:67], s52 offen offset:2048 sc1
    v_mfma_f32_16x16x32_bf16 v[44:47], v[76:79], v[108:111], v[44:47]
    buffer_load_dwordx4 v[104:107], v1, s[64:67], s52 offen offset:3072 sc1
    buffer_load_dwordx4 v[108:111], v6, s[64:67], s52 offen offset:3072 sc1
    s_cmp_lt_i32 s51, 0
    s_cbranch_scc1 F_GE1
    s_waitcnt vmcnt(8)
F_GC1:
    v_max3_u32 v15, v112, v116, v120
    v_max3_u32 v7, v124, v128, v132
    v_max3_u32 v15, v15, v136, v140
    v_max_u32 v15, v15, v7
    v_cmp_eq_u32 vcc, -1, v15
    s_cbranch_vccnz F_GF1
F_GK1:
    s_waitcnt lgkmcnt(4)
    v_mfma_f32_16x16x32_bf16 v[16:19], v[48:51], v[112:115], v[16:19]
    ds_read_b64_tr_b16 v[64:65], v2 offset:4096
    ds_read_b64_tr_b16 v[66:67], v2 offset:6144
    v_mfma_f32_16x16x32_bf16 v[32:35], v[48:51], v[116:119], v[32:35]
    ds_read_b64_tr_b16 v[68:69], v3 offset:4096
    ds_read_b64_tr_b16 v[70:71], v3 offset:6144
    v_mfma_f32_16x16x32_bf16 v[20:23], v[52:55], v[112:115], v[20:23]
    ds_read_b64_tr_b16 v[72:73], v4 offset:4096
    ds_read_b64_tr_b16 v[74:75], v4 offset:6144
    v_mfma_f32_16x16x32_bf16 v[36:39], v[52:55], v[116:119], v[36:39]
    ds_read_b64_tr_b16 v[76:77], v5 offset:4096
    ds_read_b64_tr_b16 v[78:79], v5 offset:6144
    s_waitcnt lgkmcnt(8)
    v_mfma_f32_16x16x32_bf16 v[24:27], v[56:59], v[112:115], v[24:27]
    s_and_b32 s45, s46, s47
    s_cselect_b32 s66, s38, 0
    v_mfma_f32_16x16x32_bf16 v[40:43], v[56:59], v[116:119], v[40:43]
    s_ff1_i32_b32 s51, s45
    s_bitset0_b32 s46, s51
    v_mfma_f32_16x16x32_bf16 v[28:31], v[60:63], v[112:115], v[28:31]
    s_lshl_b32 s53, s51, 10
    s_add_u32 s53, s53, s55
    v_mfma_f32_16x16x32_bf16 v[44:47], v[60:63], v[116:119], v[44:47]
    s_waitcnt lgkmcnt(4)
    v_mfma_f32_16x16x32_bf16 v[16:19], v[64:67], v[120:123], v[16:19]
    ds_read_b64_tr_b16 v[48:49], v2 offset:8192
    ds_read_b64_tr_b16 v[50:51], v2 offset:10240
    v_mfma_f32_16x16x32_bf16 v[32:35], v[64:67], v[124:127], v[32:35]
    ds_read_b64_tr_b16 v[52:53], v3 offset:8192
    ds_read_b64_tr_b16 v[54:55], v3 offset:10240
    v_mfma_f32_16x16x32_bf16 v[20:23], v[68:71], v[120:123], v[20:23]
    ds_read_b64_tr_b16 v[56:57], v4 offset:8192
    ds_read_b64_tr_b16 v[58:59], v4 offset:10240
    v_mfma_f32_16x16x32_bf16 v[36:39], v[68:71], v[124:127], v[36:39]
    ds_read_b64_tr_b16 v[60:61], v5 offset:8192
    ds_read_b64_tr_b16 v[62:63], v5 offset:10240
    s_waitcnt lgkmcnt(8)
    v_mfma_f32_16x16x32_bf16 v[24:27], v[72:75], v[120:123], v[24:27]
    buffer_load_dwordx4 v[112:115], v1, s[64:67], s53 offen offset:0 sc1
    buffer_load_dwordx4 v[116:119], v6, s[64:67], s53 offen offset:0 sc1
    v_mfma_f32_16x16x32_bf16 v[40:43], v[72:75], v[124:127], v[40:43]
    v_mfma_f32_16x16x32_bf16 v[28:31], v[76:79], v[120:123], v[28:31]
    v_mfma_f32_16x16x32_bf16 v[44:47], v[76:79], v[124:127], v[44:47]
    s_waitcnt lgkmcnt(4)
    v_mfma_f32_16x16x32_bf16 v[16:19], v[48:51], v[128:131], v[16:19]
    ds_read_b64_tr_b16 v[64:65], v2 offset:12288
    ds_read_b64_tr_b16 v[66:67], v2 offset:14336
    v_mfma_f32_16x16x32_bf16 v[32:35], v[48:51], v[132:135], v[32:35]
    ds_read_b64_tr_b16 v[68:69], v3 offset:12288
    ds_read_b64_tr_b16 v[70:71], v3 offset:14336
    v_mfma_f32_16x16x32_bf16 v[20:23], v[52:55], v[128:131], v[20:23]
    ds_read_b64_tr_b16 v[72:73], v4 offset:12288
    ds_read_b64_tr_b16 v[74:75], v4 offset:14336
    v_mfma_f32_16x16x32_bf16 v[36:39], v[52:55], v[132:135], v[36:39]
    ds_read_b64_tr_b16 v[76:77], v5 offset:12288
    ds_read_b64_tr_b16 v[78:79], v5 offset:14336
    s_waitcnt lgkmcnt(8)
    v_mfma_f32_16x16x32_bf16 v[24:27], v[56:59], v[128:131], v[24:27]
    s_lshr_b32 s48, s54, s50
    s_and_b32 s48, s48, 15
    v_mfma_f32_16x16x32_bf16 v[40:43], v[56:59], v[132:135], v[40:43]
    s_lshl_b32 s48, s48, 14
    buffer_load_dwordx4 v[120:123], v1, s[64:67], s53 offen offset:1024 sc1
    v_mfma_f32_16x16x32_bf16 v[28:31], v[60:63], v[128:131], v[28:31]
    buffer_load_dwordx4 v[124:127], v6, s[64:67], s53 offen offset:1024 sc1
    v_mfma_f32_16x16x32_bf16 v[44:47], v[60:63], v[132:135], v[44:47]
    s_waitcnt lgkmcnt(4)
    v_mfma_f32_16x16x32_bf16 v[16:19], v[64:67], v[136:139], v[16:19]
    v_add_u32 v2, s48, v207
    v_xor_b32 v3, 32, v2
    v_mfma_f32_16x16x32_bf16 v[32:35], v[64:67], v[140:143], v[32:35]
    v_xor_b32 v4, 64, v2
    v_xor_b32 v5, 96, v2
    v_mfma_f32_16x16x32_bf16 v[20:23], v[68:71], v[136:139], v[20:23]
    ds_read_b64_tr_b16 v[48:49], v2 offset:0
    ds_read_b64_tr_b16 v[50:51], v2 offset:2048
    v_mfma_f32_16x16x32_bf16 v[36:39], v[68:71], v[140:143], v[36:39]
    ds_read_b64_tr_b16 v[52:53], v3 offset:0
    ds_read_b64_tr_b16 v[54:55], v3 offset:2048
    s_waitcnt lgkmcnt(4)
    v_mfma_f32_16x16x32_bf16 v[24:27], v[72:75], v[136:139], v[24:27]
    ds_read_b64_tr_b16 v[56:57], v4 offset:0
    ds_read_b64_tr_b16 v[58:59], v4 offset:2048
    v_mfma_f32_16x16x32_bf16 v[40:43], v[72:75], v[140:143], v[40:43]
    ds_read_b64_tr_b16 v[60:61], v5 offset:0
    ds_read_b64_tr_b16 v[62:63], v5 offset:2048
    v_mfma_f32_16x16x32_bf16 v[28:31], v[76:79], v[136:139], v[28:31]
    buffer_load_dwordx4 v[128:131], v1, s[64:67], s53 offen offset:2048 sc1
    buffer_load_dwordx4 v[132:135], v6, s[64:67], s53 offen offset:2048 sc1
    v_mfma_f32_16x16x32_bf16 v[44:47], v[76:79], v[140:143], v[44:47]
    buffer_load_dwordx4 v[136:139], v1, s[64:67], s53 offen offset:3072 sc1
    buffer_load_dwordx4 v[140:143], v6, s[64:67], s53 offen offset:3072 sc1
    s_add_u32 s44, s44, 1
    s_cmp_lt_u32 s44, 4
    s_cbranch_scc1 F_GLOOP
    s_add_u32 s57, s56, 65536
    s_waitcnt lgkmcnt(0)
    v_cvt_pk_bf16_f32 v48, v16, v17
    v_cvt_pk_bf16_f32 v49, v18, v19
    v_cvt_pk_bf16_f32 v50, v20, v21
    v_cvt_pk_bf16_f32 v51, v22, v23
    v_cvt_pk_bf16_f32 v52, v24, v25
    v_cvt_pk_bf16_f32 v53, v26, v27
    v_cvt_pk_bf16_f32 v54, v28, v29
    v_cvt_pk_bf16_f32 v55, v30, v31
    v_cvt_pk_bf16_f32 v56, v32, v33
    v_cvt_pk_bf16_f32 v57, v34, v35
    v_cvt_pk_bf16_f32 v58, v36, v37
    v_cvt_pk_bf16_f32 v59, v38, v39
    v_cvt_pk_bf16_f32 v60, v40, v41
    v_cvt_pk_bf16_f32 v61, v42, v43
    v_cvt_pk_bf16_f32 v62, v44, v45
    v_cvt_pk_bf16_f32 v63, v46, v47
    v_permlane16_swap_b32 v48, v50
    v_permlane16_swap_b32 v49, v51
    buffer_store_dwordx4 v[48:51], v210, s[60:63], s56 offen offset:0 sc1
    v_permlane16_swap_b32 v52, v54
    v_permlane16_swap_b32 v53, v55
    buffer_store_dwordx4 v[52:55], v210, s[60:63], s56 offen offset:64 sc1
    v_permlane16_swap_b32 v56, v58
    v_permlane16_swap_b32 v57, v59
    buffer_store_dwordx4 v[56:59], v210, s[60:63], s57 offen offset:0 sc1
    v_permlane16_swap_b32 v60, v62
    v_permlane16_swap_b32 v61, v63
    buffer_store_dwordx4 v[60:63], v210, s[60:63], s57 offen offset:64 sc1
    s_endpgm
F_CNB0:
    ds_write_b32 v204, v14 offset:32
F_WS15:
    ds_read_b32 v15, v209 offset:128
    s_waitcnt lgkmcnt(0)
    v_cmp_ne_u32 vcc, 1, v15
    s_cbranch_vccz F_WS15_X
    s_branch F_WS15
F_WS15_X:
    s_branch F_CB0
F_CNB1:
    ds_write_b32 v204, v14
    s_branch F_CB1
F_GF0:
    s_add_u32 s58, s58, 1
    s_cmp_gt_u32 s58, 400000
    s_cbranch_scc1 F_GK0
    buffer_load_dwordx4 v[80:83], v1, s[36:39], s52 offen offset:0 sc1
    buffer_load_dwordx4 v[84:87], v6, s[36:39], s52 offen offset:0 sc1
    buffer_load_dwordx4 v[88:91], v1, s[36:39], s52 offen offset:1024 sc1
    buffer_load_dwordx4 v[92:95], v6, s[36:39], s52 offen offset:1024 sc1
    buffer_load_dwordx4 v[96:99], v1, s[36:39], s52 offen offset:2048 sc1
    buffer_load_dwordx4 v[100:103], v6, s[36:39], s52 offen offset:2048 sc1
    buffer_load_dwordx4 v[104:107], v1, s[36:39], s52 offen offset:3072 sc1
    buffer_load_dwordx4 v[108:111], v6, s[36:39], s52 offen offset:3072 sc1
    s_waitcnt vmcnt(0)
    s_branch F_GC0
F_GS0:
    s_sleep 4
F_GE0:
    buffer_load_dword v15, v208, s[36:39], s55 offen offset:1008 sc1
    s_add_u32 s58, s58, 1
    s_waitcnt vmcnt(0)
    ds_read_b32 v7, v211
    v_cmp_eq_u32 vcc, -1, v15
    s_waitcnt lgkmcnt(0)
    v_cmp_ne_u32 s[40:41], 1, v7
    s_or_b32 s45, s40, s41
    s_or_b32 s45, s45, vcc_lo
    s_lshr_b32 s40, s45, 1
    s_or_b32 s45, s45, s40
    s_lshr_b32 s40, s45, 2
    s_or_b32 s45, s45, s40
    s_cmp_gt_u32 s58, 400000
    s_cselect_b32 s45, 0, s45
    s_andn2_b32 s47, s46, s45
    s_cbranch_scc0 F_GS0
    s_and_b32 s45, s46, s47
    s_cselect_b32 s66, s38, 0
    s_ff1_i32_b32 s50, s45
    s_bitset0_b32 s46, s50
    s_lshl_b32 s52, s50, 10
    s_add_u32 s52, s52, s55
    buffer_load_dwordx4 v[80:83], v1, s[36:39], s52 offen offset:0 sc1
    buffer_load_dwordx4 v[84:87], v6, s[36:39], s52 offen offset:0 sc1
    buffer_load_dwordx4 v[88:91], v1, s[36:39], s52 offen offset:1024 sc1
    buffer_load_dwordx4 v[92:95], v6, s[36:39], s52 offen offset:1024 sc1
    buffer_load_dwordx4 v[96:99], v1, s[36:39], s52 offen offset:2048 sc1
    buffer_load_dwordx4 v[100:103], v6, s[36:39], s52 offen offset:2048 sc1
    buffer_load_dwordx4 v[104:107], v1, s[36:39], s52 offen offset:3072 sc1
    buffer_load_dwordx4 v[108:111], v6, s[36:39], s52 offen offset:3072 sc1
    s_lshr_b32 s48, s54, s50
    s_and_b32 s48, s48, 15
    s_lshl_b32 s48, s48, 14
    v_add_u32 v2, s48, v207
    v_xor_b32 v3, 32, v2
    v_xor_b32 v4, 64, v2
    v_xor_b32 v5, 96, v2
    ds_read_b64_tr_b16 v[48:49], v2 offset:0
    ds_read_b64_tr_b16 v[50:51], v2 offset:2048
    ds_read_b64_tr_b16 v[52:53], v3 offset:0
    ds_read_b64_tr_b16 v[54:55], v3 offset:2048
    ds_read_b64_tr_b16 v[56:57], v4 offset:0
    ds_read_b64_tr_b16 v[58:59], v4 offset:2048
    ds_read_b64_tr_b16 v[60:61], v5 offset:0
    ds_read_b64_tr_b16 v[62:63], v5 offset:2048
    s_cmp_lt_i32 s51, 0
    s_cbranch_scc0 F_GN0
    s_and_b32 s45, s46, s47
    s_cselect_b32 s66, s38, 0
    s_ff1_i32_b32 s51, s45
    s_bitset0_b32 s46, s51
    s_lshl_b32 s53, s51, 10
    s_add_u32 s53, s53, s55
    buffer_load_dwordx4 v[112:115], v1, s[64:67], s53 offen offset:0 sc1
    buffer_load_dwordx4 v[116:119], v6, s[64:67], s53 offen offset:0 sc1
    buffer_load_dwordx4 v[120:123], v1, s[64:67], s53 offen offset:1024 sc1
    buffer_load_dwordx4 v[124:127], v6, s[64:67], s53 offen offset:1024 sc1
    buffer_load_dwordx4 v[128:131], v1, s[64:67], s53 offen offset:2048 sc1
    buffer_load_dwordx4 v[132:135], v6, s[64:67], s53 offen offset:2048 sc1
    buffer_load_dwordx4 v[136:139], v1, s[64:67], s53 offen offset:3072 sc1
    buffer_load_dwordx4 v[140:143], v6, s[64:67], s53 offen offset:3072 sc1
    s_waitcnt vmcnt(8)
    s_branch F_GC0
F_GN0:
    s_waitcnt vmcnt(0)
    s_branch F_GC0
F_GF1:
    s_add_u32 s58, s58, 1
    s_cmp_gt_u32 s58, 400000
    s_cbranch_scc1 F_GK1
    buffer_load_dwordx4 v[112:115], v1, s[36:39], s53 offen offset:0 sc1
    buffer_load_dwordx4 v[116:119], v6, s[36:39], s53 offen offset:0 sc1
    buffer_load_dwordx4 v[120:123], v1, s[36:39], s53 offen offset:1024 sc1
    buffer_load_dwordx4 v[124:127], v6, s[36:39], s53 offen offset:1024 sc1
    buffer_load_dwordx4 v[128:131], v1, s[36:39], s53 offen offset:2048 sc1
    buffer_load_dwordx4 v[132:135], v6, s[36:39], s53 offen offset:2048 sc1
    buffer_load_dwordx4 v[136:139], v1, s[36:39], s53 offen offset:3072 sc1
    buffer_load_dwordx4 v[140:143], v6, s[36:39], s53 offen offset:3072 sc1
    s_waitcnt vmcnt(0)
    s_branch F_GC1
F_GS1:
    s_sleep 4
F_GE1:
    buffer_load_dword v15, v208, s[36:39], s55 offen offset:1008 sc1
    s_add_u32 s58, s58, 1
    s_waitcnt vmcnt(0)
    ds_read_b32 v7, v211
    v_cmp_eq_u32 vcc, -1, v15
    s_waitcnt lgkmcnt(0)
    v_cmp_ne_u32 s[40:41], 1, v7
    s_or_b32 s45, s40, s41
    s_or_b32 s45, s45, vcc_lo
    s_lshr_b32 s40, s45, 1
    s_or_b32 s45, s45, s40
    s_lshr_b32 s40, s45, 2
    s_or_b32 s45, s45, s40
    s_cmp_gt_u32 s58, 400000
    s_cselect_b32 s45, 0, s45
    s_andn2_b32 s47, s46, s45
    s_cbranch_scc0 F_GS1
    s_and_b32 s45, s46, s47
    s_cselect_b32 s66, s38, 0
    s_ff1_i32_b32 s51, s45
    s_bitset0_b32 s46, s51
    s_lshl_b32 s53, s51, 10
    s_add_u32 s53, s53, s55
    buffer_load_dwordx4 v[112:115], v1, s[36:39], s53 offen offset:0 sc1
    buffer_load_dwordx4 v[116:119], v6, s[36:39], s53 offen offset:0 sc1
    buffer_load_dwordx4 v[120:123], v1, s[36:39], s53 offen offset:1024 sc1
    buffer_load_dwordx4 v[124:127], v6, s[36:39], s53 offen offset:1024 sc1
    buffer_load_dwordx4 v[128:131], v1, s[36:39], s53 offen offset:2048 sc1
    buffer_load_dwordx4 v[132:135], v6, s[36:39], s53 offen offset:2048 sc1
    buffer_load_dwordx4 v[136:139], v1, s[36:39], s53 offen offset:3072 sc1
    buffer_load_dwordx4 v[140:143], v6, s[36:39], s53 offen offset:3072 sc1
    s_lshr_b32 s48, s54, s51
    s_and_b32 s48, s48, 15
    s_lshl_b32 s48, s48, 14
    v_add_u32 v2, s48, v207
    v_xor_b32 v3, 32, v2
    v_xor_b32 v4, 64, v2
    v_xor_b32 v5, 96, v2
    ds_read_b64_tr_b16 v[48:49], v2 offset:0
    ds_read_b64_tr_b16 v[50:51], v2 offset:2048
    ds_read_b64_tr_b16 v[52:53], v3 offset:0
    ds_read_b64_tr_b16 v[54:55], v3 offset:2048
    ds_read_b64_tr_b16 v[56:57], v4 offset:0
    ds_read_b64_tr_b16 v[58:59], v4 offset:2048
    ds_read_b64_tr_b16 v[60:61], v5 offset:0
    ds_read_b64_tr_b16 v[62:63], v5 offset:2048
    s_cmp_lt_i32 s50, 0
    s_cbranch_scc0 F_GN1
    s_and_b32 s45, s46, s47
    s_cselect_b32 s66, s38, 0
    s_ff1_i32_b32 s50, s45
    s_bitset0_b32 s46, s50
    s_lshl_b32 s52, s50, 10
    s_add_u32 s52, s52, s55
    buffer_load_dwordx4 v[80:83], v1, s[64:67], s52 offen offset:0 sc1
    buffer_load_dwordx4 v[84:87], v6, s[64:67], s52 offen offset:0 sc1
    buffer_load_dwordx4 v[88:91], v1, s[64:67], s52 offen offset:1024 sc1
    buffer_load_dwordx4 v[92:95], v6, s[64:67], s52 offen offset:1024 sc1
    buffer_load_dwordx4 v[96:99], v1, s[64:67], s52 offen offset:2048 sc1
    buffer_load_dwordx4 v[100:103], v6, s[64:67], s52 offen offset:2048 sc1
    buffer_load_dwordx4 v[104:107], v1, s[64:67], s52 offen offset:3072 sc1
    buffer_load_dwordx4 v[108:111], v6, s[64:67], s52 offen offset:3072 sc1
    s_waitcnt vmcnt(8)
    s_branch F_GC1
F_GN1:
    s_waitcnt vmcnt(0)
    s_branch F_GC1
F_END:
    s_endpgm

.section .rodata,"a"
.p2align 6
.amdhsa_kernel concat_heads__linear_attn_block__ssm_conv_h3__prompt_kernel
  .amdhsa_next_free_vgpr 256
  .amdhsa_next_free_sgpr 102
  .amdhsa_accum_offset 256
  .amdhsa_group_segment_fixed_size 0
  .amdhsa_kernarg_size 96
  .amdhsa_user_sgpr_count 2
  .amdhsa_user_sgpr_kernarg_segment_ptr 1
  .amdhsa_system_sgpr_workgroup_id_x 1
  .amdhsa_float_denorm_mode_32 3
  .amdhsa_float_denorm_mode_16_64 3
.end_amdhsa_kernel
```

```asm
; @launch grid=(256,1,1) block=(512,1,1) lds=163840
.amdgcn_target "amdgcn-amd-amdhsa--gfx950"
.text
.globl concat_heads__linear_attn_block__ssm_conv_h3__prompt_kernel
.p2align 8
.type concat_heads__linear_attn_block__ssm_conv_h3__prompt_kernel,@function
concat_heads__linear_attn_block__ssm_conv_h3__prompt_kernel:
    s_load_dwordx16 s[4:19], s[0:1], 0
    s_cmp_ge_u32 s2, 256
    s_cbranch_scc1 F_END
    v_lshrrev_b32 v1, 6, v0
    v_and_b32 v0, 63, v0
    s_and_b32 s28, s2, 7
    s_lshr_b32 s29, s2, 3
    v_readfirstlane_b32 s3, v1
    s_and_b32 s30, s28, 1
    s_lshl_b32 s30, s30, 3
    s_and_b32 s31, s29, 7
    s_add_u32 s30, s30, s31
    s_lshr_b32 s31, s28, 1
    s_lshl_b32 s31, s31, 2
    s_lshr_b32 s32, s29, 3
    s_add_u32 s31, s31, s32
    s_cmp_lt_u32 s3, 4
    s_cbranch_scc1 F_C
    s_sub_u32 s34, s3, 4
    v_lshrrev_b32 v2, 3, v0
    v_and_b32 v4, 7, v0
    v_lshlrev_b32 v8, 11, v4
    v_and_b32 v9, 15, v0
    v_min_u32 v9, 11, v9
    v_lshrrev_b32 v7, 2, v9
    v_and_b32 v9, 3, v9
    v_lshlrev_b32 v9, 7, v9
    v_lshl_add_u32 v9, v7, 11, v9
    s_and_b32 s100, s28, 1
    s_lshr_b32 s101, s28, 1
    s_lshl_b32 s40, s100, 21
    s_lshl_b32 s41, s101, 19
    s_add_u32 s99, s40, s41
    s_lshl_b32 s40, s29, 14
    s_lshl_b32 s41, s34, 7
    s_add_u32 s42, s40, s41
    s_add_u32 s42, s42, s99
    s_mul_i32 s98, s100, 6144
    s_lshl_b32 s41, s101, 9
    s_add_u32 s98, s98, s41
    s_lshl_b32 s43, s29, 2
    s_add_u32 s43, s43, s34
    s_mul_i32 s43, s43, 12288
    s_add_u32 s43, s43, s98
    s_mov_b32 s46, 0x400000
    s_mov_b32 s47, 0x00020000
    s_mov_b32 s50, 0x600000
    s_mov_b32 s51, 0x00020000
    s_lshl_b32 s40, s34, 3
    v_add_u32 v3, s40, v2
    v_lshrrev_b32 v5, 4, v0
    s_and_b32 s40, s34, 1
    s_lshl_b32 s41, s40, 2
    v_add_u32 v6, s41, v5
    v_xor_b32 v6, v6, v4
    v_lshlrev_b32 v6, 4, v6
    v_lshl_add_u32 v10, v3, 11, v6
    v_and_b32 v6, 1, v5
    v_lshlrev_b32 v6, 1, v6
    v_or_b32 v6, s41, v6
    v_xor_b32 v6, v6, v4
    v_lshlrev_b32 v6, 4, v6
    v_mul_u32_u24 v11, 6144, v3
    v_add_u32 v11, v11, v6
    s_lshl_b32 s52, s30, 18
    s_add_u32 s53, s52, 64512
    s_add_u32 s54, s52, 129024
    s_add_u32 s55, s52, 193536
    s_lshl_b32 s56, s31, 7
    s_add_u32 s57, s56, 1024
    s_add_u32 s58, s56, 2048
    s_add_u32 s59, s56, 193536
    s_add_u32 s60, s56, 198656
    s_add_u32 s61, s56, 199680
    s_mul_i32 s62, s34, 10240
    s_mov_b32 s63, 393216
    s_waitcnt lgkmcnt(0)
    s_mov_b64 s[44:45], s[4:5]
    s_mov_b64 s[48:49], s[6:7]
    buffer_load_dword v250, v9, s[48:51], s43 offen
    buffer_load_dword v250, v8, s[44:47], s42 offen
    s_add_u32 m0, s62, 45056
    s_nop 0
    buffer_load_dwordx4 v11, s[48:51], s57 offen offset:1024 lds
    buffer_load_dwordx4 v11, s[48:51], s58 offen offset:2048 lds
    buffer_load_dwordx4 v11, s[48:51], s56 offen offset:0 lds
    buffer_load_dwordx4 v11, s[48:51], s59 offen offset:3072 lds
    s_add_u32 m0, s62, 40960
    s_nop 0
    buffer_load_dwordx4 v10, s[44:47], s52 offen offset:0 lds
    buffer_load_dwordx4 v10, s[44:47], s53 offen offset:1024 lds
    buffer_load_dwordx4 v10, s[44:47], s54 offen offset:2048 lds
    buffer_load_dwordx4 v10, s[44:47], s55 offen offset:3072 lds
    s_add_u32 m0, s62, 49152
    s_nop 0
    buffer_load_dwordx4 v11, s[48:51], s60 offen offset:0 lds
    buffer_load_dwordx4 v11, s[48:51], s61 offen offset:1024 lds
    v_add_u32 v10, 128, v10
    v_add_u32 v11, s63, v11
    s_add_u32 m0, s62, 86016
    s_nop 0
    buffer_load_dwordx4 v11, s[48:51], s57 offen offset:1024 lds
    buffer_load_dwordx4 v11, s[48:51], s58 offen offset:2048 lds
    buffer_load_dwordx4 v11, s[48:51], s56 offen offset:0 lds
    buffer_load_dwordx4 v11, s[48:51], s59 offen offset:3072 lds
    s_add_u32 m0, s62, 81920
    s_nop 0
    buffer_load_dwordx4 v10, s[44:47], s52 offen offset:0 lds
    buffer_load_dwordx4 v10, s[44:47], s53 offen offset:1024 lds
    buffer_load_dwordx4 v10, s[44:47], s54 offen offset:2048 lds
    buffer_load_dwordx4 v10, s[44:47], s55 offen offset:3072 lds
    s_add_u32 m0, s62, 90112
    s_nop 0
    buffer_load_dwordx4 v11, s[48:51], s60 offen offset:0 lds
    buffer_load_dwordx4 v11, s[48:51], s61 offen offset:1024 lds
    v_add_u32 v10, 128, v10
    v_add_u32 v11, s63, v11
    s_load_dwordx8 s[20:27], s[0:1], 64
    s_and_b32 s32, s29, 3
    s_lshr_b32 s33, s28, 1
    s_lshl_b32 s33, s33, 2
    s_add_u32 s32, s32, s33
    s_and_b32 s33, s28, 1
    s_lshl_b32 s33, s33, 3
    s_lshr_b32 s35, s29, 2
    s_add_u32 s33, s33, s35
    v_lshlrev_b32 v1, 4, v0
    v_lshlrev_b32 v6, 1, v5
    v_xor_b32 v6, v6, v4
    v_lshlrev_b32 v6, 4, v6
    v_lshl_add_u32 v12, v2, 11, v6
    v_mov_b32 v13, 0
    s_lshr_b32 s35, s29, 4
    s_lshl_b32 s35, s35, 3
    s_add_u32 s35, s35, s28
    s_lshl_b32 s35, s35, 4
    s_and_b32 s40, s29, 15
    s_add_u32 s35, s35, s40
    s_mov_b32 s35, s2
    s_lshl_b32 s35, s35, 2
    s_add_u32 s35, s35, s34
    s_and_b32 s96, s29, 3
    s_waitcnt lgkmcnt(0)
    s_mov_b32 s36, s26
    s_mov_b32 s37, s27
    s_mov_b32 s38, 0x10000000
    s_mov_b32 s39, 0x00020000
    s_mov_b32 s64, s24
    s_mov_b32 s65, s25
    s_mov_b32 s66, 0x100
    s_mov_b32 s67, 0x00020000
    s_lshr_b32 s69, s29, 2
    s_mul_i32 s40, s96, 3
    s_add_u32 s40, s40, 4
    s_add_u32 s41, s40, s34
    s_lshl_b32 s41, s41, 7
    s_add_u32 s99, s99, s41
    s_lshl_b32 s41, s69, 16
    s_add_u32 s99, s99, s41
    s_lshl_b32 s40, s40, 5
    s_mul_i32 s41, s69, 12
    s_add_u32 s40, s40, s41
    s_lshl_b32 s41, s34, 2
    s_add_u32 s40, s40, s41
    s_mul_i32 s40, s40, 12288
    s_add_u32 s98, s98, s40
    s_lshl_b32 s100, s100, 10
    s_lshl_b32 s101, s101, 19
    s_add_u32 s100, s100, s101
    s_lshl_b32 s41, s29, 14
    s_add_u32 s100, s100, s41
    v_and_b32 v16, 31, v0
    v_lshlrev_b32 v16, 11, v16
    v_mul_u32_u24 v17, 12288, v5
    v_add_u32 v17, v17, v9
    v_lshlrev_b32 v18, 7, v4
    v_lshl_add_u32 v18, v2, 11, v18
    s_add_u32 s40, s2, s34
    s_cmp_lg_u32 s40, 0
    s_cbranch_scc1 F_NOTOK
    s_memrealtime s[68:69]
    s_waitcnt lgkmcnt(0)
    s_or_b32 s68, s68, 1
    v_mov_b32 v14, s68
    s_mov_b64 exec, 1
    buffer_store_dword v14, v13, s[64:67], 0 offen sc1
    s_mov_b64 exec, -1
F_NOTOK:
    s_cmp_lg_u32 s96, 0
    s_cbranch_scc1 F_PF0X
    s_cmp_eq_u32 s34, 3
    s_cbranch_scc1 F_PF0X
    buffer_load_dword v250, v17, s[48:51], s98 offen
    buffer_load_dword v250, v16, s[44:47], s99 offen
F_PF0X:
    s_cmp_lg_u32 s96, 0
    s_cbranch_scc1 F_PW0X
    s_cmp_lg_u32 s34, 3
    s_cbranch_scc1 F_PW0X
    s_mov_b32 s40, s8
    s_mov_b32 s41, s9
    s_mov_b32 s42, 0x200000
    s_mov_b32 s43, 0x00020000
    buffer_load_dword v250, v18, s[40:43], s100 offen
F_PW0X:
    s_lshl_b32 s40, s34, 1
    v_xor_b32 v20, s40, v4
    v_lshlrev_b32 v20, 4, v20
    v_lshl_add_u32 v20, v2, 11, v20
    s_lshr_b32 s40, s2, 4
    s_lshl_b32 s40, s40, 18
    s_and_b32 s41, s2, 15
    s_lshl_b32 s41, s41, 7
    s_add_u32 s40, s40, s41
    v_xor_b32 v21, 6, v4
    v_lshlrev_b32 v21, 4, v21
    v_lshl_add_u32 v21, v2, 11, v21
    v_add_u32 v21, s40, v21
    v_subrev_u32 v21, 6144, v21
    s_lshl_b32 s41, s34, 15
    s_add_u32 s40, s40, s41
    v_add_u32 v20, s40, v20
    v_and_b32 v22, 3, v2
    v_xor_b32 v22, s34, v22
    v_lshlrev_b32 v22, 5, v22
    v_lshl_add_u32 v22, v4, 2, v22
    v_lshl_add_u32 v22, v2, 11, v22
    v_add_u32 v22, 123264, v22
    v_add_u32 v23, 3, v2
    v_and_b32 v23, 3, v23
    v_xor_b32 v23, s34, v23
    v_lshlrev_b32 v23, 5, v23
    v_lshl_add_u32 v23, v4, 2, v23
    v_lshl_add_u32 v23, v2, 11, v23
    v_add_u32 v23, 122880, v23
    s_and_b32 s40, s2, 15
    s_lshl_b32 s40, s40, 6
    s_lshl_b32 s41, s34, 4
    s_add_u32 s40, s40, s41
    v_lshlrev_b32 v24, 1, v4
    v_add_u32 v24, s40, v24
    v_mul_u32_u24 v25, 4224, v24
    v_lshlrev_b32 v24, 3, v24
    s_lshr_b32 s40, s2, 4
    s_lshl_b32 s40, s40, 3
    v_add_u32 v26, s40, v2
    v_lshl_add_u32 v25, v26, 4, v25
    s_lshr_b32 s40, s2, 4
    s_lshl_b32 s40, s40, 4
    s_lshl_b32 s41, s34, 3
    s_add_u32 s40, s40, s41
    v_add_u32 v28, s40, v2
    v_mul_u32_u24 v232, 33792, v4
    v_lshl_add_u32 v232, v28, 4, v232
    v_lshrrev_b32 v29, 6, v28
    v_lshlrev_b32 v29, 9, v29
    v_and_b32 v30, 15, v28
    v_lshl_add_u32 v29, v30, 4, v29
    v_bfe_u32 v30, v28, 4, 2
    v_lshl_add_u32 v29, v30, 2, v29
    v_lshlrev_b32 v30, 4, v4
    v_lshl_add_u32 v234, v29, 11, v30
    v_lshl_add_u32 v233, v29, 12, v30
    s_waitcnt vmcnt(10)
    s_barrier
    s_add_u32 m0, s62, 4096
    s_nop 0
    buffer_load_dwordx4 v11, s[48:51], s57 offen offset:1024 lds
    buffer_load_dwordx4 v11, s[48:51], s58 offen offset:2048 lds
    buffer_load_dwordx4 v11, s[48:51], s56 offen offset:0 lds
    buffer_load_dwordx4 v11, s[48:51], s59 offen offset:3072 lds
    s_add_u32 m0, s62, 0
    s_nop 0
    buffer_load_dwordx4 v10, s[44:47], s52 offen offset:0 lds
    buffer_load_dwordx4 v10, s[44:47], s53 offen offset:1024 lds
    buffer_load_dwordx4 v10, s[44:47], s54 offen offset:2048 lds
    buffer_load_dwordx4 v10, s[44:47], s55 offen offset:3072 lds
    s_add_u32 m0, s62, 8192
    s_nop 0
    buffer_load_dwordx4 v11, s[48:51], s60 offen offset:0 lds
    buffer_load_dwordx4 v11, s[48:51], s61 offen offset:1024 lds
    s_cmp_lg_u32 s96, 2
    s_cbranch_scc1 F_KV2X
    s_lshl_b32 s69, s34, 11
    s_mov_b32 s40, s12
    s_mov_b32 s41, s13
    s_mov_b32 s42, 0x400000
    s_mov_b32 s43, 0x00020000
    s_mov_b32 m0, 122880
    s_mov_b64 exec, 0xffffff
    buffer_load_dwordx4 v21, s[40:43], 0 offen nt lds
    s_mov_b64 exec, -1
    s_add_u32 m0, s69, 123264
    s_mov_b32 s97, 0
    buffer_load_dwordx4 v20, s[40:43], s97 offen nt lds
    s_mov_b32 s97, 15360
    buffer_load_dwordx4 v20, s[40:43], s97 offen offset:1024 nt lds
    s_add_u32 m0, s69, 131456
    s_mov_b32 s97, 131072
    buffer_load_dwordx4 v20, s[40:43], s97 offen nt lds
    s_mov_b32 s97, 146432
    buffer_load_dwordx4 v20, s[40:43], s97 offen offset:1024 nt lds
    s_mov_b32 s40, s14
    s_mov_b32 s41, s15
    s_mov_b32 s42, 0x400000
    s_mov_b32 s43, 0x00020000
    s_add_u32 m0, s69, 139648
    s_mov_b32 s97, 0
    buffer_load_dwordx4 v20, s[40:43], s97 offen nt lds
    s_mov_b32 s97, 15360
    buffer_load_dwordx4 v20, s[40:43], s97 offen offset:1024 nt lds
    s_add_u32 m0, s69, 147840
    s_mov_b32 s97, 131072
    buffer_load_dwordx4 v20, s[40:43], s97 offen nt lds
    s_mov_b32 s97, 146432
    buffer_load_dwordx4 v20, s[40:43], s97 offen offset:1024 nt lds
    s_mov_b32 s40, s16
    s_mov_b32 s41, s17
    s_mov_b32 s42, 0x2000
    s_mov_b32 s43, 0x00020000
    buffer_load_dwordx4 v[32:35], v24, s[40:43], 0 offen
F_KV2X:
    v_add_u32 v10, 128, v10
    v_add_u32 v11, s63, v11
    s_cmp_lg_u32 s96, 2
    s_cbranch_scc1 F_Q2X
    s_cmp_ge_u32 s34, 2
    s_cbranch_scc1 F_Q2X
    s_mov_b32 s40, s10
    s_mov_b32 s41, s11
    s_mov_b32 s42, 0x400000
    s_mov_b32 s43, 0x00020000
    s_and_b32 s69, s2, 15
    s_lshl_b32 s69, s69, 7
    s_add_u32 s97, s69, 0
    buffer_load_dwordx4 v[200:203], v234, s[40:43], s97 offen offset:0 nt
    s_add_u32 s97, s69, 0
    buffer_load_dwordx4 v[204:207], v234, s[40:43], s97 offen offset:2048 nt
    s_add_u32 s97, s69, 4096
    buffer_load_dwordx4 v[208:211], v234, s[40:43], s97 offen offset:0 nt
    s_add_u32 s97, s69, 4096
    buffer_load_dwordx4 v[212:215], v234, s[40:43], s97 offen offset:2048 nt
    s_add_u32 s97, s69, 524288
    buffer_load_dwordx4 v[216:219], v234, s[40:43], s97 offen offset:0 nt
    s_add_u32 s97, s69, 524288
    buffer_load_dwordx4 v[220:223], v234, s[40:43], s97 offen offset:2048 nt
    s_add_u32 s97, s69, 528384
    buffer_load_dwordx4 v[224:227], v234, s[40:43], s97 offen offset:0 nt
    s_add_u32 s97, s69, 528384
    buffer_load_dwordx4 v[228:231], v234, s[40:43], s97 offen offset:2048 nt
F_Q2X:
    s_waitcnt vmcnt(10)
    s_barrier
    s_add_u32 m0, s62, 45056
    s_nop 0
    buffer_load_dwordx4 v11, s[48:51], s57 offen offset:1024 lds
    buffer_load_dwordx4 v11, s[48:51], s58 offen offset:2048 lds
    buffer_load_dwordx4 v11, s[48:51], s56 offen offset:0 lds
    buffer_load_dwordx4 v11, s[48:51], s59 offen offset:3072 lds
    s_cmp_lg_u32 s96, 1
    s_cbranch_scc1 F_PF1X
    s_cmp_eq_u32 s34, 3
    s_cbranch_scc1 F_PF1X
    buffer_load_dword v250, v17, s[48:51], s98 offen
    buffer_load_dword v250, v16, s[44:47], s99 offen
F_PF1X:
    s_cmp_lg_u32 s96, 1
    s_cbranch_scc1 F_PW1X
    s_cmp_lg_u32 s34, 3
    s_cbranch_scc1 F_PW1X
    s_mov_b32 s40, s8
    s_mov_b32 s41, s9
    s_mov_b32 s42, 0x200000
    s_mov_b32 s43, 0x00020000
    buffer_load_dword v250, v18, s[40:43], s100 offen
F_PW1X:
    s_add_u32 m0, s62, 40960
    s_nop 0
    buffer_load_dwordx4 v10, s[44:47], s52 offen offset:0 lds
    buffer_load_dwordx4 v10, s[44:47], s53 offen offset:1024 lds
    buffer_load_dwordx4 v10, s[44:47], s54 offen offset:2048 lds
    buffer_load_dwordx4 v10, s[44:47], s55 offen offset:3072 lds
    s_and_b32 s40, s34, 1
    s_lshl_b32 s41, s31, 1
    s_add_u32 s40, s40, s41
    s_lshr_b32 s41, s34, 1
    s_lshl_b32 s6, s30, 1
    s_add_u32 s6, s6, s41
    s_mul_i32 s6, s6, 132
    s_add_u32 s6, s6, s40
    s_lshl_b32 s6, s6, 10
    s_add_u32 s6, s6, 0x200000
    s_lshl_b32 s4, s40, 15
    s_lshl_b32 s5, s41, 10
    s_add_u32 s7, s4, s5
    s_lshl_b32 s4, s30, 11
    s_add_u32 s4, s4, s7
    s_lshl_b32 s40, s40, 11
    s_add_u32 s69, s40, s5
    s_add_u32 s69, s69, 0x100000
    s_lshl_b32 s5, s30, 6
    s_add_u32 s5, s5, s69
    v_mov_b32 v112, -1
    s_add_u32 m0, s62, 49152
    s_nop 0
    buffer_load_dwordx4 v11, s[48:51], s60 offen offset:0 lds
    v_mov_b32 v113, -1
    v_mov_b32 v114, -1
    buffer_load_dwordx4 v11, s[48:51], s61 offen offset:1024 lds
    v_mov_b32 v115, -1
    v_lshlrev_b32 v27, 4, v5
    v_add_u32 v10, 128, v10
    v_add_u32 v11, s63, v11
    s_mov_b32 s7, 0xffff0000
    s_cmp_lg_u32 s96, 3
    s_cbranch_scc1 F_KV3X
    s_lshl_b32 s69, s34, 11
    s_mov_b32 s40, s12
    s_mov_b32 s41, s13
    s_mov_b32 s42, 0x400000
    s_mov_b32 s43, 0x00020000
    s_mov_b32 m0, 122880
    s_mov_b64 exec, 0xffffff
    buffer_load_dwordx4 v21, s[40:43], 0 offen nt lds
    s_mov_b64 exec, -1
    s_add_u32 m0, s69, 123264
    s_mov_b32 s97, 0
    buffer_load_dwordx4 v20, s[40:43], s97 offen nt lds
    s_mov_b32 s97, 15360
    buffer_load_dwordx4 v20, s[40:43], s97 offen offset:1024 nt lds
    s_add_u32 m0, s69, 131456
    s_mov_b32 s97, 131072
    buffer_load_dwordx4 v20, s[40:43], s97 offen nt lds
    s_mov_b32 s97, 146432
    buffer_load_dwordx4 v20, s[40:43], s97 offen offset:1024 nt lds
    s_mov_b32 s40, s14
    s_mov_b32 s41, s15
    s_mov_b32 s42, 0x400000
    s_mov_b32 s43, 0x00020000
    s_add_u32 m0, s69, 139648
    s_mov_b32 s97, 0
    buffer_load_dwordx4 v20, s[40:43], s97 offen nt lds
    s_mov_b32 s97, 15360
    buffer_load_dwordx4 v20, s[40:43], s97 offen offset:1024 nt lds
    s_add_u32 m0, s69, 147840
    s_mov_b32 s97, 131072
    buffer_load_dwordx4 v20, s[40:43], s97 offen nt lds
    s_mov_b32 s97, 146432
    buffer_load_dwordx4 v20, s[40:43], s97 offen offset:1024 nt lds
    s_mov_b32 s40, s16
    s_mov_b32 s41, s17
    s_mov_b32 s42, 0x2000
    s_mov_b32 s43, 0x00020000
    buffer_load_dwordx4 v[32:35], v24, s[40:43], 0 offen
F_KV3X:
    s_cmp_lg_u32 s96, 3
    s_cbranch_scc1 F_Q3X
    s_cmp_ge_u32 s34, 2
    s_cbranch_scc1 F_Q3X
    s_mov_b32 s40, s10
    s_mov_b32 s41, s11
    s_mov_b32 s42, 0x400000
    s_mov_b32 s43, 0x00020000
    s_and_b32 s69, s2, 15
    s_lshl_b32 s69, s69, 7
    s_add_u32 s97, s69, 0
    buffer_load_dwordx4 v[200:203], v234, s[40:43], s97 offen offset:0 nt
    s_add_u32 s97, s69, 0
    buffer_load_dwordx4 v[204:207], v234, s[40:43], s97 offen offset:2048 nt
    s_add_u32 s97, s69, 4096
    buffer_load_dwordx4 v[208:211], v234, s[40:43], s97 offen offset:0 nt
    s_add_u32 s97, s69, 4096
    buffer_load_dwordx4 v[212:215], v234, s[40:43], s97 offen offset:2048 nt
    s_add_u32 s97, s69, 524288
    buffer_load_dwordx4 v[216:219], v234, s[40:43], s97 offen offset:0 nt
    s_add_u32 s97, s69, 524288
    buffer_load_dwordx4 v[220:223], v234, s[40:43], s97 offen offset:2048 nt
    s_add_u32 s97, s69, 528384
    buffer_load_dwordx4 v[224:227], v234, s[40:43], s97 offen offset:0 nt
    s_add_u32 s97, s69, 528384
    buffer_load_dwordx4 v[228:231], v234, s[40:43], s97 offen offset:2048 nt
F_Q3X:
    s_waitcnt vmcnt(10)
    s_barrier
    s_add_u32 m0, s62, 86016
    s_nop 0
    buffer_load_dwordx4 v11, s[48:51], s57 offen offset:1024 lds
    buffer_load_dwordx4 v11, s[48:51], s58 offen offset:2048 lds
    buffer_load_dwordx4 v11, s[48:51], s56 offen offset:0 lds
    buffer_load_dwordx4 v11, s[48:51], s59 offen offset:3072 lds
    s_add_u32 m0, s62, 81920
    s_nop 0
    buffer_load_dwordx4 v10, s[44:47], s52 offen offset:0 lds
    buffer_load_dwordx4 v10, s[44:47], s53 offen offset:1024 lds
    buffer_load_dwordx4 v10, s[44:47], s54 offen offset:2048 lds
    buffer_load_dwordx4 v10, s[44:47], s55 offen offset:3072 lds
    s_cmp_lg_u32 s96, 0
    s_cbranch_scc1 F_KV0X
    s_lshl_b32 s69, s34, 11
    s_mov_b32 s40, s12
    s_mov_b32 s41, s13
    s_mov_b32 s42, 0x400000
    s_mov_b32 s43, 0x00020000
    s_mov_b32 m0, 122880
    s_mov_b64 exec, 0xffffff
    buffer_load_dwordx4 v21, s[40:43], 0 offen nt lds
    s_mov_b64 exec, -1
    s_add_u32 m0, s69, 123264
    s_mov_b32 s97, 0
    buffer_load_dwordx4 v20, s[40:43], s97 offen nt lds
    s_mov_b32 s97, 15360
    buffer_load_dwordx4 v20, s[40:43], s97 offen offset:1024 nt lds
    s_add_u32 m0, s69, 131456
    s_mov_b32 s97, 131072
    buffer_load_dwordx4 v20, s[40:43], s97 offen nt lds
    s_mov_b32 s97, 146432
    buffer_load_dwordx4 v20, s[40:43], s97 offen offset:1024 nt lds
    s_mov_b32 s40, s14
    s_mov_b32 s41, s15
    s_mov_b32 s42, 0x400000
    s_mov_b32 s43, 0x00020000
    s_add_u32 m0, s69, 139648
    s_mov_b32 s97, 0
    buffer_load_dwordx4 v20, s[40:43], s97 offen nt lds
    s_mov_b32 s97, 15360
    buffer_load_dwordx4 v20, s[40:43], s97 offen offset:1024 nt lds
    s_add_u32 m0, s69, 147840
    s_mov_b32 s97, 131072
    buffer_load_dwordx4 v20, s[40:43], s97 offen nt lds
    s_mov_b32 s97, 146432
    buffer_load_dwordx4 v20, s[40:43], s97 offen offset:1024 nt lds
    s_mov_b32 s40, s16
    s_mov_b32 s41, s17
    s_mov_b32 s42, 0x2000
    s_mov_b32 s43, 0x00020000
    buffer_load_dwordx4 v[32:35], v24, s[40:43], 0 offen
F_KV0X:
    s_add_u32 m0, s62, 90112
    s_nop 0
    buffer_load_dwordx4 v11, s[48:51], s60 offen offset:0 lds
    buffer_load_dwordx4 v11, s[48:51], s61 offen offset:1024 lds
    s_cmp_lg_u32 s96, 1
    s_cbranch_scc1 F_KV1X
    s_lshl_b32 s69, s34, 11
    s_mov_b32 s40, s12
    s_mov_b32 s41, s13
    s_mov_b32 s42, 0x400000
    s_mov_b32 s43, 0x00020000
    s_mov_b32 m0, 122880
    s_mov_b64 exec, 0xffffff
    buffer_load_dwordx4 v21, s[40:43], 0 offen nt lds
    s_mov_b64 exec, -1
    s_add_u32 m0, s69, 123264
    s_mov_b32 s97, 0
    buffer_load_dwordx4 v20, s[40:43], s97 offen nt lds
    s_mov_b32 s97, 15360
    buffer_load_dwordx4 v20, s[40:43], s97 offen offset:1024 nt lds
    s_add_u32 m0, s69, 131456
    s_mov_b32 s97, 131072
    buffer_load_dwordx4 v20, s[40:43], s97 offen nt lds
    s_mov_b32 s97, 146432
    buffer_load_dwordx4 v20, s[40:43], s97 offen offset:1024 nt lds
    s_mov_b32 s40, s14
    s_mov_b32 s41, s15
    s_mov_b32 s42, 0x400000
    s_mov_b32 s43, 0x00020000
    s_add_u32 m0, s69, 139648
    s_mov_b32 s97, 0
    buffer_load_dwordx4 v20, s[40:43], s97 offen nt lds
    s_mov_b32 s97, 15360
    buffer_load_dwordx4 v20, s[40:43], s97 offen offset:1024 nt lds
    s_add_u32 m0, s69, 147840
    s_mov_b32 s97, 131072
    buffer_load_dwordx4 v20, s[40:43], s97 offen nt lds
    s_mov_b32 s97, 146432
    buffer_load_dwordx4 v20, s[40:43], s97 offen offset:1024 nt lds
    s_mov_b32 s40, s16
    s_mov_b32 s41, s17
    s_mov_b32 s42, 0x2000
    s_mov_b32 s43, 0x00020000
    buffer_load_dwordx4 v[32:35], v24, s[40:43], 0 offen
F_KV1X:
    v_add_u32 v10, 128, v10
    v_add_u32 v11, s63, v11
    s_cmp_lg_u32 s96, 2
    s_cbranch_scc1 F_CL2X
    buffer_store_dwordx4 v[112:115], v1, s[36:39], s4 offen sc1
    s_mov_b32 exec_lo, 0x00010001
    s_mov_b32 exec_hi, 0x00010001
    buffer_store_dwordx4 v[112:115], v27, s[36:39], s5 offen sc1
    s_mov_b64 exec, -1
    buffer_store_dwordx4 v[112:115], v1, s[36:39], s6 offen sc1
    s_add_u32 s6, s6, 33792
    buffer_store_dwordx4 v[112:115], v1, s[36:39], s6 offen sc1
    s_add_u32 s6, s6, 33792
    buffer_store_dwordx4 v[112:115], v1, s[36:39], s6 offen sc1
    s_add_u32 s6, s6, 33792
    buffer_store_dwordx4 v[112:115], v1, s[36:39], s6 offen sc1
    s_mul_i32 s69, s35, 4224
    s_add_u32 s69, s69, 0xc00000
    buffer_store_dwordx4 v[112:115], v1, s[36:39], s69 offen offset:0 sc1
    buffer_store_dwordx4 v[112:115], v1, s[36:39], s69 offen offset:1024 sc1
    buffer_store_dwordx4 v[112:115], v1, s[36:39], s69 offen offset:2048 sc1
    buffer_store_dwordx4 v[112:115], v1, s[36:39], s69 offen offset:3072 sc1
F_CL2X:
    s_cmp_lg_u32 s96, 0
    s_cbranch_scc1 F_Q0X
    s_cmp_ge_u32 s34, 2
    s_cbranch_scc1 F_Q0X
    s_mov_b32 s40, s10
    s_mov_b32 s41, s11
    s_mov_b32 s42, 0x400000
    s_mov_b32 s43, 0x00020000
    s_and_b32 s69, s2, 15
    s_lshl_b32 s69, s69, 7
    s_add_u32 s97, s69, 0
    buffer_load_dwordx4 v[200:203], v234, s[40:43], s97 offen offset:0 nt
    s_add_u32 s97, s69, 0
    buffer_load_dwordx4 v[204:207], v234, s[40:43], s97 offen offset:2048 nt
    s_add_u32 s97, s69, 4096
    buffer_load_dwordx4 v[208:211], v234, s[40:43], s97 offen offset:0 nt
    s_add_u32 s97, s69, 4096
    buffer_load_dwordx4 v[212:215], v234, s[40:43], s97 offen offset:2048 nt
    s_add_u32 s97, s69, 524288
    buffer_load_dwordx4 v[216:219], v234, s[40:43], s97 offen offset:0 nt
    s_add_u32 s97, s69, 524288
    buffer_load_dwordx4 v[220:223], v234, s[40:43], s97 offen offset:2048 nt
    s_add_u32 s97, s69, 528384
    buffer_load_dwordx4 v[224:227], v234, s[40:43], s97 offen offset:0 nt
    s_add_u32 s97, s69, 528384
    buffer_load_dwordx4 v[228:231], v234, s[40:43], s97 offen offset:2048 nt
F_Q0X:
    s_cmp_lg_u32 s96, 1
    s_cbranch_scc1 F_Q1X
    s_cmp_ge_u32 s34, 2
    s_cbranch_scc1 F_Q1X
    s_mov_b32 s40, s10
    s_mov_b32 s41, s11
    s_mov_b32 s42, 0x400000
    s_mov_b32 s43, 0x00020000
    s_and_b32 s69, s2, 15
    s_lshl_b32 s69, s69, 7
    s_add_u32 s97, s69, 0
    buffer_load_dwordx4 v[200:203], v234, s[40:43], s97 offen offset:0 nt
    s_add_u32 s97, s69, 0
    buffer_load_dwordx4 v[204:207], v234, s[40:43], s97 offen offset:2048 nt
    s_add_u32 s97, s69, 4096
    buffer_load_dwordx4 v[208:211], v234, s[40:43], s97 offen offset:0 nt
    s_add_u32 s97, s69, 4096
    buffer_load_dwordx4 v[212:215], v234, s[40:43], s97 offen offset:2048 nt
    s_add_u32 s97, s69, 524288
    buffer_load_dwordx4 v[216:219], v234, s[40:43], s97 offen offset:0 nt
    s_add_u32 s97, s69, 524288
    buffer_load_dwordx4 v[220:223], v234, s[40:43], s97 offen offset:2048 nt
    s_add_u32 s97, s69, 528384
    buffer_load_dwordx4 v[224:227], v234, s[40:43], s97 offen offset:0 nt
    s_add_u32 s97, s69, 528384
    buffer_load_dwordx4 v[228:231], v234, s[40:43], s97 offen offset:2048 nt
F_Q1X:
    s_waitcnt vmcnt(10)
    s_barrier
    s_add_u32 m0, s62, 4096
    s_nop 0
    buffer_load_dwordx4 v11, s[48:51], s57 offen offset:1024 lds
    buffer_load_dword v14, v13, s[64:67], 0 offen sc1
    v_mov_b32 v44, 0
    v_mov_b32 v45, 0
    v_mov_b32 v46, 0
    buffer_load_dwordx4 v11, s[48:51], s58 offen offset:2048 lds
    v_mov_b32 v47, 0
    v_mov_b32 v48, 0
    v_mov_b32 v49, 0
    v_mov_b32 v50, 0
    buffer_load_dwordx4 v11, s[48:51], s56 offen offset:0 lds
    v_mov_b32 v51, 0
    v_mov_b32 v52, 0
    v_mov_b32 v53, 0
    v_mov_b32 v54, 0
    buffer_load_dwordx4 v11, s[48:51], s59 offen offset:3072 lds
    v_mov_b32 v55, 0
    v_mov_b32 v56, 0
    v_mov_b32 v57, 0
    v_mov_b32 v58, 0
    s_add_u32 m0, s62, 0
    s_nop 0
    buffer_load_dwordx4 v10, s[44:47], s52 offen offset:0 lds
    v_mov_b32 v59, 0
    v_mov_b32 v60, 0
    v_mov_b32 v61, 0
    v_mov_b32 v62, 0
    buffer_load_dwordx4 v10, s[44:47], s53 offen offset:1024 lds
    v_mov_b32 v63, 0
    v_mov_b32 v64, 0
    v_mov_b32 v65, 0
    v_mov_b32 v66, 0
    buffer_load_dwordx4 v10, s[44:47], s54 offen offset:2048 lds
    v_mov_b32 v67, 0
    v_mov_b32 v68, 0
    v_mov_b32 v69, 0
    v_mov_b32 v70, 0
    buffer_load_dwordx4 v10, s[44:47], s55 offen offset:3072 lds
    v_mov_b32 v71, 0
    v_mov_b32 v72, 0
    v_mov_b32 v73, 0
    v_mov_b32 v74, 0
    s_add_u32 m0, s62, 8192
    s_nop 0
    buffer_load_dwordx4 v11, s[48:51], s60 offen offset:0 lds
    v_mov_b32 v75, 0
    v_mov_b32 v76, 0
    v_mov_b32 v77, 0
    v_mov_b32 v78, 0
    buffer_load_dwordx4 v11, s[48:51], s61 offen offset:1024 lds
    v_mov_b32 v79, 0
    s_cmp_lg_u32 s96, 3
    s_cbranch_scc1 F_CL3X
    buffer_store_dwordx4 v[112:115], v1, s[36:39], s4 offen sc1
    s_mov_b32 exec_lo, 0x00010001
    s_mov_b32 exec_hi, 0x00010001
    buffer_store_dwordx4 v[112:115], v27, s[36:39], s5 offen sc1
    s_mov_b64 exec, -1
    buffer_store_dwordx4 v[112:115], v1, s[36:39], s6 offen sc1
    s_add_u32 s6, s6, 33792
    buffer_store_dwordx4 v[112:115], v1, s[36:39], s6 offen sc1
    s_add_u32 s6, s6, 33792
    buffer_store_dwordx4 v[112:115], v1, s[36:39], s6 offen sc1
    s_add_u32 s6, s6, 33792
    buffer_store_dwordx4 v[112:115], v1, s[36:39], s6 offen sc1
    s_mul_i32 s69, s35, 4224
    s_add_u32 s69, s69, 0xc00000
    buffer_store_dwordx4 v[112:115], v1, s[36:39], s69 offen offset:0 sc1
    buffer_store_dwordx4 v[112:115], v1, s[36:39], s69 offen offset:1024 sc1
    buffer_store_dwordx4 v[112:115], v1, s[36:39], s69 offen offset:2048 sc1
    buffer_store_dwordx4 v[112:115], v1, s[36:39], s69 offen offset:3072 sc1
F_CL3X:
    v_add_u32 v10, 128, v10
    v_add_u32 v11, s63, v11
    s_waitcnt vmcnt(11)
    s_barrier
    s_add_u32 m0, s62, 45056
    s_nop 0
    buffer_load_dwordx4 v11, s[48:51], s57 offen offset:1024 lds
    buffer_load_dwordx4 v11, s[48:51], s58 offen offset:2048 lds
    buffer_load_dwordx4 v11, s[48:51], s56 offen offset:0 lds
    buffer_load_dwordx4 v11, s[48:51], s59 offen offset:3072 lds
    s_cmp_lg_u32 s96, 2
    s_cbranch_scc1 F_PF2X
    s_cmp_eq_u32 s34, 3
    s_cbranch_scc1 F_PF2X
    buffer_load_dword v250, v17, s[48:51], s98 offen
    buffer_load_dword v250, v16, s[44:47], s99 offen
F_PF2X:
    s_add_u32 m0, s62, 40960
    s_nop 0
    buffer_load_dwordx4 v10, s[44:47], s52 offen offset:0 lds
    buffer_load_dwordx4 v10, s[44:47], s53 offen offset:1024 lds
    buffer_load_dwordx4 v10, s[44:47], s54 offen offset:2048 lds
    buffer_load_dwordx4 v10, s[44:47], s55 offen offset:3072 lds
    s_cmp_lg_u32 s96, 2
    s_cbranch_scc1 F_PW2X
    s_cmp_lg_u32 s34, 3
    s_cbranch_scc1 F_PW2X
    s_mov_b32 s40, s8
    s_mov_b32 s41, s9
    s_mov_b32 s42, 0x200000
    s_mov_b32 s43, 0x00020000
    buffer_load_dword v250, v18, s[40:43], s100 offen
F_PW2X:
    s_add_u32 m0, s62, 49152
    s_nop 0
    buffer_load_dwordx4 v11, s[48:51], s60 offen offset:0 lds
    buffer_load_dwordx4 v11, s[48:51], s61 offen offset:1024 lds
    v_add_u32 v10, 128, v10
    v_add_u32 v11, s63, v11
    s_cmp_lg_u32 s96, 0
    s_cbranch_scc1 F_CL0X
    buffer_store_dwordx4 v[112:115], v1, s[36:39], s4 offen sc1
    s_mov_b32 exec_lo, 0x00010001
    s_mov_b32 exec_hi, 0x00010001
    buffer_store_dwordx4 v[112:115], v27, s[36:39], s5 offen sc1
    s_mov_b64 exec, -1
    buffer_store_dwordx4 v[112:115], v1, s[36:39], s6 offen sc1
    s_add_u32 s6, s6, 33792
    buffer_store_dwordx4 v[112:115], v1, s[36:39], s6 offen sc1
    s_add_u32 s6, s6, 33792
    buffer_store_dwordx4 v[112:115], v1, s[36:39], s6 offen sc1
    s_add_u32 s6, s6, 33792
    buffer_store_dwordx4 v[112:115], v1, s[36:39], s6 offen sc1
    s_mul_i32 s69, s35, 4224
    s_add_u32 s69, s69, 0xc00000
    buffer_store_dwordx4 v[112:115], v1, s[36:39], s69 offen offset:0 sc1
    buffer_store_dwordx4 v[112:115], v1, s[36:39], s69 offen offset:1024 sc1
    buffer_store_dwordx4 v[112:115], v1, s[36:39], s69 offen offset:2048 sc1
    buffer_store_dwordx4 v[112:115], v1, s[36:39], s69 offen offset:3072 sc1
F_CL0X:
    s_waitcnt vmcnt(10)
    s_barrier
    s_add_u32 m0, s62, 86016
    s_nop 0
    buffer_load_dwordx4 v11, s[48:51], s57 offen offset:1024 lds
    buffer_load_dwordx4 v11, s[48:51], s58 offen offset:2048 lds
    buffer_load_dwordx4 v11, s[48:51], s56 offen offset:0 lds
    buffer_load_dwordx4 v11, s[48:51], s59 offen offset:3072 lds
    v_readfirstlane_b32 s68, v14
    s_mov_b32 s69, 0
F_TK:
    s_cmp_lg_u32 s68, 0
    s_cbranch_scc1 F_TKX
    buffer_load_dword v14, v13, s[64:67], 0 offen sc1
    s_waitcnt vmcnt(0)
    v_readfirstlane_b32 s68, v14
    s_add_u32 s69, s69, 1
    s_cmp_lt_u32 s69, 400000
    s_cbranch_scc1 F_TK
F_TKX:
    ds_read_u16_d16_hi v44, v23 offset:0
    ds_read_u16_d16_hi v45, v23 offset:128
    ds_read_u16_d16_hi v46, v23 offset:256
    ds_read_u16_d16_hi v47, v22 offset:0
    ds_read_u16_d16_hi v48, v22 offset:128
    s_add_u32 m0, s62, 81920
    s_nop 0
    buffer_load_dwordx4 v10, s[44:47], s52 offen offset:0 lds
    ds_read_u16_d16_hi v49, v22 offset:256
    ds_read_u16_d16_hi v50, v22 offset:384
    ds_read_u16_d16_hi v51, v22 offset:512
    ds_read_u16_d16_hi v52, v22 offset:640
    ds_read_u16_d16_hi v53, v22 offset:768
    ds_read_u16_d16_hi v54, v22 offset:896
    buffer_load_dwordx4 v10, s[44:47], s53 offen offset:1024 lds
    ds_read_u16_d16_hi v55, v22 offset:1024
    v_lshlrev_b32 v36, 16, v32
    v_and_b32 v37, s7, v32
    v_lshlrev_b32 v38, 16, v33
    v_and_b32 v39, s7, v33
    s_waitcnt lgkmcnt(4)
    v_mul_f32 v80, v39, v44
    buffer_load_dwordx4 v10, s[44:47], s54 offen offset:2048 lds
    ds_read_u16_d16_hi v56, v22 offset:1152
    v_mul_f32 v81, v39, v45
    ds_read_u16_d16_hi v57, v22 offset:1280
    v_mul_f32 v82, v39, v46
    ds_read_u16_d16_hi v58, v22 offset:1408
    v_mul_f32 v83, v39, v47
    buffer_load_dwordx4 v10, s[44:47], s55 offen offset:3072 lds
    ds_read_u16_d16_hi v59, v22 offset:1536
    v_mul_f32 v84, v39, v48
    ds_read_u16_d16_hi v60, v22 offset:1664
    v_mul_f32 v85, v39, v49
    ds_read_u16_d16_hi v61, v22 offset:1792
    v_mul_f32 v86, v39, v50
    s_add_u32 m0, s62, 90112
    s_nop 0
    buffer_load_dwordx4 v11, s[48:51], s60 offen offset:0 lds
    ds_read_u16_d16_hi v62, v22 offset:1920
    v_mul_f32 v87, v39, v51
    ds_read_u16_d16_hi v64, v22 offset:16384
    s_waitcnt lgkmcnt(4)
    v_mul_f32 v88, v39, v52
    ds_read_u16_d16_hi v65, v22 offset:16512
    v_mul_f32 v89, v39, v53
    buffer_load_dwordx4 v11, s[48:51], s61 offen offset:1024 lds
    ds_read_u16_d16_hi v66, v22 offset:16640
    v_mul_f32 v90, v39, v54
    ds_read_u16_d16_hi v67, v22 offset:16768
    v_mul_f32 v91, v39, v55
    ds_read_u16_d16_hi v68, v22 offset:16896
    v_mul_f32 v92, v39, v56
    v_add_u32 v10, 128, v10
    v_add_u32 v11, s63, v11
    ds_read_u16_d16_hi v69, v22 offset:17024
    v_mul_f32 v93, v39, v57
    ds_read_u16_d16_hi v70, v22 offset:17152
    v_mul_f32 v94, v39, v58
    ds_read_u16_d16_hi v71, v22 offset:17280
    v_mul_f32 v95, v39, v59
    ds_read_u16_d16_hi v72, v22 offset:17408
    s_waitcnt lgkmcnt(9)
    v_fmac_f32 v80, v38, v45
    ds_read_u16_d16_hi v73, v22 offset:17536
    v_fmac_f32 v81, v38, v46
    ds_read_u16_d16_hi v74, v22 offset:17664
    s_waitcnt vmcnt(10)
    s_barrier
    s_add_u32 m0, s62, 4096
    s_nop 0
    buffer_load_dwordx4 v11, s[48:51], s57 offen offset:1024 lds
    buffer_load_dwordx4 v11, s[48:51], s58 offen offset:2048 lds
    buffer_load_dwordx4 v11, s[48:51], s56 offen offset:0 lds
    buffer_load_dwordx4 v11, s[48:51], s59 offen offset:3072 lds
    s_cmp_lg_u32 s96, 1
    s_cbranch_scc1 F_CL1X
    buffer_store_dwordx4 v[112:115], v1, s[36:39], s4 offen sc1
    s_mov_b32 exec_lo, 0x00010001
    s_mov_b32 exec_hi, 0x00010001
    buffer_store_dwordx4 v[112:115], v27, s[36:39], s5 offen sc1
    s_mov_b64 exec, -1
    buffer_store_dwordx4 v[112:115], v1, s[36:39], s6 offen sc1
    s_add_u32 s6, s6, 33792
    buffer_store_dwordx4 v[112:115], v1, s[36:39], s6 offen sc1
    s_add_u32 s6, s6, 33792
    buffer_store_dwordx4 v[112:115], v1, s[36:39], s6 offen sc1
    s_add_u32 s6, s6, 33792
    buffer_store_dwordx4 v[112:115], v1, s[36:39], s6 offen sc1
    s_mul_i32 s69, s35, 4224
    s_add_u32 s69, s69, 0xc00000
    buffer_store_dwordx4 v[112:115], v1, s[36:39], s69 offen offset:0 sc1
    buffer_store_dwordx4 v[112:115], v1, s[36:39], s69 offen offset:1024 sc1
    buffer_store_dwordx4 v[112:115], v1, s[36:39], s69 offen offset:2048 sc1
    buffer_store_dwordx4 v[112:115], v1, s[36:39], s69 offen offset:3072 sc1
F_CL1X:
    v_fmac_f32 v82, v38, v47
    ds_read_u16_d16_hi v75, v22 offset:17792
    v_fmac_f32 v83, v38, v48
    s_add_u32 m0, s62, 0
    s_nop 0
    buffer_load_dwordx4 v10, s[44:47], s52 offen offset:0 lds
    ds_read_u16_d16_hi v76, v22 offset:17920
    v_fmac_f32 v84, v38, v49
    ds_read_u16_d16_hi v77, v22 offset:18048
    v_fmac_f32 v85, v38, v50
    ds_read_u16_d16_hi v78, v22 offset:18176
    v_fmac_f32 v86, v38, v51
    buffer_load_dwordx4 v10, s[44:47], s53 offen offset:1024 lds
    ds_read_u16_d16_hi v79, v22 offset:18304
    v_fmac_f32 v87, v38, v52
    v_fmac_f32 v88, v38, v53
    v_fmac_f32 v89, v38, v54
    v_fmac_f32 v90, v38, v55
    v_fmac_f32 v91, v38, v56
    buffer_load_dwordx4 v10, s[44:47], s54 offen offset:2048 lds
    v_fmac_f32 v92, v38, v57
    v_fmac_f32 v93, v38, v58
    v_fmac_f32 v94, v38, v59
    v_fmac_f32 v95, v38, v60
    v_fmac_f32 v80, v37, v46
    v_fmac_f32 v81, v37, v47
    buffer_load_dwordx4 v10, s[44:47], s55 offen offset:3072 lds
    v_fmac_f32 v82, v37, v48
    v_fmac_f32 v83, v37, v49
    v_fmac_f32 v84, v37, v50
    v_fmac_f32 v85, v37, v51
    v_fmac_f32 v86, v37, v52
    v_fmac_f32 v87, v37, v53
    s_add_u32 m0, s62, 8192
    s_nop 0
    buffer_load_dwordx4 v11, s[48:51], s60 offen offset:0 lds
    v_fmac_f32 v88, v37, v54
    v_fmac_f32 v89, v37, v55
    v_fmac_f32 v90, v37, v56
    v_fmac_f32 v91, v37, v57
    v_fmac_f32 v92, v37, v58
    v_fmac_f32 v93, v37, v59
    buffer_load_dwordx4 v11, s[48:51], s61 offen offset:1024 lds
    v_fmac_f32 v94, v37, v60
    v_fmac_f32 v95, v37, v61
    v_fmac_f32 v80, v36, v47
    v_fmac_f32 v81, v36, v48
    v_fmac_f32 v82, v36, v49
    v_fmac_f32 v83, v36, v50
    v_add_u32 v10, 128, v10
    v_add_u32 v11, s63, v11
    v_fmac_f32 v84, v36, v51
    v_fmac_f32 v85, v36, v52
    v_fmac_f32 v86, v36, v53
    v_fmac_f32 v87, v36, v54
    v_fmac_f32 v88, v36, v55
    v_fmac_f32 v89, v36, v56
    v_fmac_f32 v90, v36, v57
    v_fmac_f32 v91, v36, v58
    v_fmac_f32 v92, v36, v59
    v_fmac_f32 v93, v36, v60
    v_fmac_f32 v94, v36, v61
    v_fmac_f32 v95, v36, v62
    s_waitcnt lgkmcnt(0)
    v_mul_f32 v80, v80, v64
    s_waitcnt vmcnt(10)
    s_barrier
    s_add_u32 m0, s62, 45056
    s_nop 0
    buffer_load_dwordx4 v11, s[48:51], s57 offen offset:1024 lds
    buffer_load_dwordx4 v11, s[48:51], s58 offen offset:2048 lds
    buffer_load_dwordx4 v11, s[48:51], s56 offen offset:0 lds
    buffer_load_dwordx4 v11, s[48:51], s59 offen offset:3072 lds
    s_cmp_lg_u32 s96, 3
    s_cbranch_scc1 F_PF3X
    s_cmp_eq_u32 s34, 3
    s_cbranch_scc1 F_PF3X
    buffer_load_dword v250, v17, s[48:51], s98 offen
    buffer_load_dword v250, v16, s[44:47], s99 offen
F_PF3X:
    s_cmp_lg_u32 s96, 3
    s_cbranch_scc1 F_PW3X
    s_cmp_lg_u32 s34, 3
    s_cbranch_scc1 F_PW3X
    s_mov_b32 s40, s8
    s_mov_b32 s41, s9
    s_mov_b32 s42, 0x200000
    s_mov_b32 s43, 0x00020000
    buffer_load_dword v250, v18, s[40:43], s100 offen
F_PW3X:
    v_mul_f32 v81, v81, v65
    v_mul_f32 v82, v82, v66
    v_mul_f32 v83, v83, v67
    v_mul_f32 v84, v84, v68
    s_add_u32 m0, s62, 40960
    s_nop 0
    buffer_load_dwordx4 v10, s[44:47], s52 offen offset:0 lds
    v_mul_f32 v85, v85, v69
    v_mul_f32 v86, v86, v70
    v_mul_f32 v87, v87, v71
    v_mul_f32 v88, v88, v72
    v_mul_f32 v89, v89, v73
    v_mul_f32 v90, v90, v74
    buffer_load_dwordx4 v10, s[44:47], s53 offen offset:1024 lds
    v_mul_f32 v91, v91, v75
    v_mul_f32 v92, v92, v76
    v_mul_f32 v93, v93, v77
    v_mul_f32 v94, v94, v78
    v_mul_f32 v95, v95, v79
    v_cvt_pk_bf16_f32 v96, v92, v88
    buffer_load_dwordx4 v10, s[44:47], s54 offen offset:2048 lds
    v_cvt_pk_bf16_f32 v97, v84, v80
    v_cvt_pk_bf16_f32 v98, v94, v90
    v_cvt_pk_bf16_f32 v99, v86, v82
    v_cvt_pk_bf16_f32 v100, v93, v89
    v_cvt_pk_bf16_f32 v101, v85, v81
    v_cvt_pk_bf16_f32 v102, v95, v91
    buffer_load_dwordx4 v10, s[44:47], s55 offen offset:3072 lds
    v_cvt_pk_bf16_f32 v103, v87, v83
    ds_read_u16_d16_hi v44, v23 offset:2
    ds_read_u16_d16_hi v45, v23 offset:130
    ds_read_u16_d16_hi v46, v23 offset:258
    ds_read_u16_d16_hi v47, v22 offset:2
    ds_read_u16_d16_hi v48, v22 offset:130
    s_add_u32 m0, s62, 49152
    s_nop 0
    buffer_load_dwordx4 v11, s[48:51], s60 offen offset:0 lds
    ds_read_u16_d16_hi v49, v22 offset:258
    ds_read_u16_d16_hi v50, v22 offset:386
    ds_read_u16_d16_hi v51, v22 offset:514
    ds_read_u16_d16_hi v52, v22 offset:642
    ds_read_u16_d16_hi v53, v22 offset:770
    ds_read_u16_d16_hi v54, v22 offset:898
    buffer_load_dwordx4 v11, s[48:51], s61 offen offset:1024 lds
    ds_read_u16_d16_hi v55, v22 offset:1026
    v_lshlrev_b32 v36, 16, v34
    v_and_b32 v37, s7, v34
    v_lshlrev_b32 v38, 16, v35
    v_and_b32 v39, s7, v35
    s_waitcnt lgkmcnt(4)
    v_mul_f32 v80, v39, v44
    v_add_u32 v10, 128, v10
    v_add_u32 v11, s63, v11
    ds_read_u16_d16_hi v56, v22 offset:1154
    v_mul_f32 v81, v39, v45
    ds_read_u16_d16_hi v57, v22 offset:1282
    v_mul_f32 v82, v39, v46
    ds_read_u16_d16_hi v58, v22 offset:1410
    v_mul_f32 v83, v39, v47
    ds_read_u16_d16_hi v59, v22 offset:1538
    v_mul_f32 v84, v39, v48
    ds_read_u16_d16_hi v60, v22 offset:1666
    v_mul_f32 v85, v39, v49
    ds_read_u16_d16_hi v61, v22 offset:1794
    v_mul_f32 v86, v39, v50
    s_waitcnt vmcnt(10)
    s_barrier
    s_add_u32 m0, s62, 86016
    s_nop 0
    buffer_load_dwordx4 v11, s[48:51], s57 offen offset:1024 lds
    ds_read_u16_d16_hi v62, v22 offset:1922
    v_mul_f32 v87, v39, v51
    ds_read_u16_d16_hi v64, v22 offset:16386
    s_waitcnt lgkmcnt(4)
    v_mul_f32 v88, v39, v52
    ds_read_u16_d16_hi v65, v22 offset:16514
    v_mul_f32 v89, v39, v53
    buffer_load_dwordx4 v11, s[48:51], s58 offen offset:2048 lds
    ds_read_u16_d16_hi v66, v22 offset:16642
    v_mul_f32 v90, v39, v54
    ds_read_u16_d16_hi v67, v22 offset:16770
    v_mul_f32 v91, v39, v55
    ds_read_u16_d16_hi v68, v22 offset:16898
    v_mul_f32 v92, v39, v56
    buffer_load_dwordx4 v11, s[48:51], s56 offen offset:0 lds
    ds_read_u16_d16_hi v69, v22 offset:17026
    v_mul_f32 v93, v39, v57
    ds_read_u16_d16_hi v70, v22 offset:17154
    v_mul_f32 v94, v39, v58
    ds_read_u16_d16_hi v71, v22 offset:17282
    v_mul_f32 v95, v39, v59
    buffer_load_dwordx4 v11, s[48:51], s59 offen offset:3072 lds
    ds_read_u16_d16_hi v72, v22 offset:17410
    s_waitcnt lgkmcnt(9)
    v_fmac_f32 v80, v38, v45
    ds_read_u16_d16_hi v73, v22 offset:17538
    v_fmac_f32 v81, v38, v46
    ds_read_u16_d16_hi v74, v22 offset:17666
    v_fmac_f32 v82, v38, v47
    s_add_u32 m0, s62, 81920
    s_nop 0
    buffer_load_dwordx4 v10, s[44:47], s52 offen offset:0 lds
    ds_read_u16_d16_hi v75, v22 offset:17794
    v_fmac_f32 v83, v38, v48
    ds_read_u16_d16_hi v76, v22 offset:17922
    v_fmac_f32 v84, v38, v49
    ds_read_u16_d16_hi v77, v22 offset:18050
    v_fmac_f32 v85, v38, v50
    buffer_load_dwordx4 v10, s[44:47], s53 offen offset:1024 lds
    ds_read_u16_d16_hi v78, v22 offset:18178
    v_fmac_f32 v86, v38, v51
    ds_read_u16_d16_hi v79, v22 offset:18306
    v_fmac_f32 v87, v38, v52
    v_fmac_f32 v88, v38, v53
    v_fmac_f32 v89, v38, v54
    buffer_load_dwordx4 v10, s[44:47], s54 offen offset:2048 lds
    v_fmac_f32 v90, v38, v55
    v_fmac_f32 v91, v38, v56
    v_fmac_f32 v92, v38, v57
    v_fmac_f32 v93, v38, v58
    v_fmac_f32 v94, v38, v59
    v_fmac_f32 v95, v38, v60
    buffer_load_dwordx4 v10, s[44:47], s55 offen offset:3072 lds
    v_fmac_f32 v80, v37, v46
    v_fmac_f32 v81, v37, v47
    v_fmac_f32 v82, v37, v48
    v_fmac_f32 v83, v37, v49
    v_fmac_f32 v84, v37, v50
    v_fmac_f32 v85, v37, v51
    s_add_u32 m0, s62, 90112
    s_nop 0
    buffer_load_dwordx4 v11, s[48:51], s60 offen offset:0 lds
    v_fmac_f32 v86, v37, v52
    v_fmac_f32 v87, v37, v53
    v_fmac_f32 v88, v37, v54
    v_fmac_f32 v89, v37, v55
    buffer_load_dwordx4 v11, s[48:51], s61 offen offset:1024 lds
    v_add_u32 v10, 128, v10
    v_add_u32 v11, s63, v11
    s_waitcnt vmcnt(10)
    s_barrier
    s_add_u32 m0, s62, 4096
    s_nop 0
    buffer_load_dwordx4 v11, s[48:51], s57 offen offset:1024 lds
    buffer_load_dwordx4 v11, s[48:51], s58 offen offset:2048 lds
    buffer_load_dwordx4 v11, s[48:51], s56 offen offset:0 lds
    buffer_load_dwordx4 v11, s[48:51], s59 offen offset:3072 lds
    s_cmp_lg_u32 s34, 1
    s_cbranch_scc1 F_NOFC
    s_lshl_b32 s69, s2, 2
    s_add_u32 s69, s69, 0x110800
    v_mov_b32 v14, s68
    s_mov_b64 exec, 1
    buffer_store_dword v14, v13, s[36:39], s69 offen sc1
    s_mov_b64 exec, -1
F_NOFC:
    v_fmac_f32 v90, v37, v56
    v_fmac_f32 v91, v37, v57
    v_fmac_f32 v92, v37, v58
    v_fmac_f32 v93, v37, v59
    s_add_u32 m0, s62, 0
    s_nop 0
    buffer_load_dwordx4 v10, s[44:47], s52 offen offset:0 lds
    v_fmac_f32 v94, v37, v60
    v_fmac_f32 v95, v37, v61
    v_fmac_f32 v80, v36, v47
    v_fmac_f32 v81, v36, v48
    v_fmac_f32 v82, v36, v49
    buffer_load_dwordx4 v10, s[44:47], s53 offen offset:1024 lds
    v_fmac_f32 v83, v36, v50
    v_fmac_f32 v84, v36, v51
    v_fmac_f32 v85, v36, v52
    v_fmac_f32 v86, v36, v53
    v_fmac_f32 v87, v36, v54
    buffer_load_dwordx4 v10, s[44:47], s54 offen offset:2048 lds
    v_fmac_f32 v88, v36, v55
    v_fmac_f32 v89, v36, v56
    v_fmac_f32 v90, v36, v57
    v_fmac_f32 v91, v36, v58
    v_fmac_f32 v92, v36, v59
    buffer_load_dwordx4 v10, s[44:47], s55 offen offset:3072 lds
    v_fmac_f32 v93, v36, v60
    v_fmac_f32 v94, v36, v61
    v_fmac_f32 v95, v36, v62
    s_waitcnt lgkmcnt(0)
    v_mul_f32 v80, v80, v64
    v_mul_f32 v81, v81, v65
    s_add_u32 m0, s62, 8192
    s_nop 0
    buffer_load_dwordx4 v11, s[48:51], s60 offen offset:0 lds
    v_mul_f32 v82, v82, v66
    v_mul_f32 v83, v83, v67
    v_mul_f32 v84, v84, v68
    v_mul_f32 v85, v85, v69
    v_mul_f32 v86, v86, v70
    buffer_load_dwordx4 v11, s[48:51], s61 offen offset:1024 lds
    v_mul_f32 v87, v87, v71
    v_mul_f32 v88, v88, v72
    v_mul_f32 v89, v89, v73
    v_mul_f32 v90, v90, v74
    v_mul_f32 v91, v91, v75
    v_add_u32 v10, 128, v10
    v_add_u32 v11, s63, v11
    v_mul_f32 v92, v92, v76
    v_mul_f32 v93, v93, v77
    v_mul_f32 v94, v94, v78
    v_mul_f32 v95, v95, v79
    v_cvt_pk_bf16_f32 v104, v92, v88
    v_cvt_pk_bf16_f32 v105, v84, v80
    v_cvt_pk_bf16_f32 v106, v94, v90
    v_cvt_pk_bf16_f32 v107, v86, v82
    v_cvt_pk_bf16_f32 v108, v93, v89
    v_cvt_pk_bf16_f32 v109, v85, v81
    v_cvt_pk_bf16_f32 v110, v95, v91
    v_cvt_pk_bf16_f32 v111, v87, v83
    s_mov_b32 s69, 0x700000
    buffer_store_dwordx4 v[96:99], v25, s[36:39], s69 offen offset:0 sc1
    buffer_store_dwordx4 v[100:103], v25, s[36:39], s69 offen offset:2048 sc1
    s_mov_b32 s69, 0x701080
    buffer_store_dwordx4 v[104:107], v25, s[36:39], s69 offen offset:0 sc1
    buffer_store_dwordx4 v[108:111], v25, s[36:39], s69 offen offset:2048 sc1
    s_waitcnt vmcnt(14)
    s_barrier
    s_add_u32 m0, s62, 45056
    s_nop 0
    buffer_load_dwordx4 v11, s[48:51], s57 offen offset:1024 lds
    s_lshl_b32 s98, s35, 12
    buffer_load_dwordx4 v11, s[48:51], s58 offen offset:2048 lds
    s_mul_i32 s99, s34, 8320
    buffer_load_dwordx4 v11, s[48:51], s56 offen offset:0 lds
    s_add_u32 s99, s99, 122880
    buffer_load_dwordx4 v11, s[48:51], s59 offen offset:3072 lds
    s_add_u32 m0, s62, 40960
    s_nop 0
    buffer_load_dwordx4 v10, s[44:47], s52 offen offset:0 lds
    buffer_load_dwordx4 v10, s[44:47], s53 offen offset:1024 lds
    buffer_load_dwordx4 v10, s[44:47], s54 offen offset:2048 lds
    buffer_load_dwordx4 v10, s[44:47], s55 offen offset:3072 lds
    s_add_u32 m0, s62, 49152
    s_nop 0
    buffer_load_dwordx4 v11, s[48:51], s60 offen offset:0 lds
    buffer_load_dwordx4 v11, s[48:51], s61 offen offset:1024 lds
    s_cmp_lg_u32 s96, 0
    s_cbranch_scc1 F_H0X
    s_mov_b32 s40, s18
    s_mov_b32 s41, s19
    s_mov_b32 s42, 0x400000
    s_mov_b32 s43, 0x00020000
    s_add_u32 m0, s99, 32
    s_nop 0
    buffer_load_dwordx4 v1, s[40:43], s98 offen offset:0 lds
    s_add_u32 m0, s99, 4196
    s_nop 0
    buffer_load_dwordx4 v1, s[40:43], s98 offen offset:0 lds
    s_add_u32 m0, s99, 32
    s_nop 0
    buffer_load_dwordx4 v1, s[40:43], s98 offen offset:1024 lds
    s_add_u32 m0, s99, 4196
    s_nop 0
    buffer_load_dwordx4 v1, s[40:43], s98 offen offset:1024 lds
    s_add_u32 m0, s99, 32
    s_nop 0
    buffer_load_dwordx4 v1, s[40:43], s98 offen offset:2048 lds
    s_add_u32 m0, s99, 4196
    s_nop 0
    buffer_load_dwordx4 v1, s[40:43], s98 offen offset:2048 lds
    s_add_u32 m0, s99, 32
    s_nop 0
    buffer_load_dwordx4 v1, s[40:43], s98 offen offset:3072 lds
    s_add_u32 m0, s99, 4196
    s_nop 0
    buffer_load_dwordx4 v1, s[40:43], s98 offen offset:3072 lds
F_H0X:
    v_add_u32 v10, 128, v10
    v_add_u32 v11, s63, v11
    s_waitcnt vmcnt(10)
    s_barrier
    s_add_u32 m0, s62, 86016
    s_nop 0
    buffer_load_dwordx4 v11, s[48:51], s57 offen offset:1024 lds
    buffer_load_dwordx4 v11, s[48:51], s58 offen offset:2048 lds
    buffer_load_dwordx4 v11, s[48:51], s56 offen offset:0 lds
    buffer_load_dwordx4 v11, s[48:51], s59 offen offset:3072 lds
    s_cmp_lg_u32 s34, 0
    s_cbranch_scc1 F_NOFA
    s_and_b32 s69, s2, 15
    s_lshl_b32 s69, s69, 4
    s_lshr_b32 s97, s2, 4
    s_add_u32 s69, s69, s97
    s_lshl_b32 s69, s69, 2
    s_add_u32 s69, s69, 0x110000
    v_mov_b32 v14, s68
    s_mov_b64 exec, 1
    buffer_store_dword v14, v13, s[36:39], s69 offen sc1
    s_mov_b64 exec, -1
F_NOFA:
    s_add_u32 m0, s62, 81920
    s_nop 0
    buffer_load_dwordx4 v10, s[44:47], s52 offen offset:0 lds
    buffer_load_dwordx4 v10, s[44:47], s53 offen offset:1024 lds
    buffer_load_dwordx4 v10, s[44:47], s54 offen offset:2048 lds
    buffer_load_dwordx4 v10, s[44:47], s55 offen offset:3072 lds
    s_cmp_lg_u32 s96, 1
    s_cbranch_scc1 F_H1X
    s_mov_b32 s40, s18
    s_mov_b32 s41, s19
    s_mov_b32 s42, 0x400000
    s_mov_b32 s43, 0x00020000
    s_add_u32 m0, s99, 32
    s_nop 0
    buffer_load_dwordx4 v1, s[40:43], s98 offen offset:0 lds
    s_add_u32 m0, s99, 4196
    s_nop 0
    buffer_load_dwordx4 v1, s[40:43], s98 offen offset:0 lds
    s_add_u32 m0, s99, 32
    s_nop 0
    buffer_load_dwordx4 v1, s[40:43], s98 offen offset:1024 lds
    s_add_u32 m0, s99, 4196
    s_nop 0
    buffer_load_dwordx4 v1, s[40:43], s98 offen offset:1024 lds
    s_add_u32 m0, s99, 32
    s_nop 0
    buffer_load_dwordx4 v1, s[40:43], s98 offen offset:2048 lds
    s_add_u32 m0, s99, 4196
    s_nop 0
    buffer_load_dwordx4 v1, s[40:43], s98 offen offset:2048 lds
    s_add_u32 m0, s99, 32
    s_nop 0
    buffer_load_dwordx4 v1, s[40:43], s98 offen offset:3072 lds
    s_add_u32 m0, s99, 4196
    s_nop 0
    buffer_load_dwordx4 v1, s[40:43], s98 offen offset:3072 lds
F_H1X:
    v_mov_b32 v96, 0
    v_mov_b32 v97, 0
    s_add_u32 m0, s62, 90112
    s_nop 0
    buffer_load_dwordx4 v11, s[48:51], s60 offen offset:0 lds
    v_mov_b32 v98, 0
    v_mov_b32 v99, 0
    v_mov_b32 v100, 0
    buffer_load_dwordx4 v11, s[48:51], s61 offen offset:1024 lds
    v_mov_b32 v101, 0
    v_mov_b32 v102, 0
    v_mov_b32 v103, 0
    v_add_u32 v10, 128, v10
    v_add_u32 v11, s63, v11
    v_mov_b32 v104, 0
    v_mov_b32 v105, 0
    v_mov_b32 v106, 0
    v_mov_b32 v107, 0
    v_mov_b32 v108, 0
    v_mov_b32 v109, 0
    v_mov_b32 v110, 0
    v_mov_b32 v111, 0
    v_mov_b32 v112, 0
    v_mov_b32 v113, 0
    v_mov_b32 v114, 0
    v_mov_b32 v115, 0
    s_waitcnt vmcnt(10)
    s_barrier
    s_add_u32 m0, s62, 4096
    s_nop 0
    buffer_load_dwordx4 v11, s[48:51], s57 offen offset:1024 lds
    buffer_load_dwordx4 v11, s[48:51], s58 offen offset:2048 lds
    buffer_load_dwordx4 v11, s[48:51], s56 offen offset:0 lds
    buffer_load_dwordx4 v11, s[48:51], s59 offen offset:3072 lds
    s_cmp_lg_u32 s96, 2
    s_cbranch_scc1 F_H2X
    s_mov_b32 s40, s18
    s_mov_b32 s41, s19
    s_mov_b32 s42, 0x400000
    s_mov_b32 s43, 0x00020000
    s_add_u32 m0, s99, 32
    s_nop 0
    buffer_load_dwordx4 v1, s[40:43], s98 offen offset:0 lds
    s_add_u32 m0, s99, 4196
    s_nop 0
    buffer_load_dwordx4 v1, s[40:43], s98 offen offset:0 lds
    s_add_u32 m0, s99, 32
    s_nop 0
    buffer_load_dwordx4 v1, s[40:43], s98 offen offset:1024 lds
    s_add_u32 m0, s99, 4196
    s_nop 0
    buffer_load_dwordx4 v1, s[40:43], s98 offen offset:1024 lds
    s_add_u32 m0, s99, 32
    s_nop 0
    buffer_load_dwordx4 v1, s[40:43], s98 offen offset:2048 lds
    s_add_u32 m0, s99, 4196
    s_nop 0
    buffer_load_dwordx4 v1, s[40:43], s98 offen offset:2048 lds
    s_add_u32 m0, s99, 32
    s_nop 0
    buffer_load_dwordx4 v1, s[40:43], s98 offen offset:3072 lds
    s_add_u32 m0, s99, 4196
    s_nop 0
    buffer_load_dwordx4 v1, s[40:43], s98 offen offset:3072 lds
F_H2X:
    v_mov_b32 v116, 0
    v_mov_b32 v117, 0
    s_add_u32 m0, s62, 0
    s_nop 0
    buffer_load_dwordx4 v10, s[44:47], s52 offen offset:0 lds
    v_mov_b32 v118, 0
    v_mov_b32 v119, 0
    v_mov_b32 v120, 0
    v_mov_b32 v121, 0
    v_mov_b32 v122, 0
    buffer_load_dwordx4 v10, s[44:47], s53 offen offset:1024 lds
    v_mov_b32 v123, 0
    v_mov_b32 v124, 0
    v_mov_b32 v125, 0
    v_mov_b32 v126, 0
    v_mov_b32 v127, 0
    buffer_load_dwordx4 v10, s[44:47], s54 offen offset:2048 lds
    v_mov_b32 v128, 0
    v_mov_b32 v129, 0
    v_mov_b32 v130, 0
    v_mov_b32 v131, 0
    v_mov_b32 v132, 0
    buffer_load_dwordx4 v10, s[44:47], s55 offen offset:3072 lds
    v_mov_b32 v133, 0
    v_mov_b32 v134, 0
    v_mov_b32 v135, 0
    v_mov_b32 v136, 0
    v_mov_b32 v137, 0
    s_add_u32 m0, s62, 8192
    s_nop 0
    buffer_load_dwordx4 v11, s[48:51], s60 offen offset:0 lds
    v_mov_b32 v138, 0
    v_mov_b32 v139, 0
    v_mov_b32 v140, 0
    v_mov_b32 v141, 0
    v_mov_b32 v142, 0
    buffer_load_dwordx4 v11, s[48:51], s61 offen offset:1024 lds
    v_mov_b32 v143, 0
    v_mov_b32 v144, 0
    v_mov_b32 v145, 0
    v_mov_b32 v146, 0
    v_mov_b32 v147, 0
    v_add_u32 v10, 128, v10
    v_add_u32 v11, s63, v11
    v_mov_b32 v148, 0
    v_mov_b32 v149, 0
    v_mov_b32 v150, 0
    v_mov_b32 v151, 0
    v_mov_b32 v152, 0
    v_mov_b32 v153, 0
    v_mov_b32 v154, 0
    v_mov_b32 v155, 0
    v_mov_b32 v156, 0
    v_mov_b32 v157, 0
    v_mov_b32 v158, 0
    v_mov_b32 v159, 0
    s_waitcnt vmcnt(10)
    s_barrier
    s_add_u32 m0, s62, 45056
    s_nop 0
    buffer_load_dwordx4 v11, s[48:51], s57 offen offset:1024 lds
    buffer_load_dwordx4 v11, s[48:51], s58 offen offset:2048 lds
    buffer_load_dwordx4 v11, s[48:51], s56 offen offset:0 lds
    buffer_load_dwordx4 v11, s[48:51], s59 offen offset:3072 lds
    s_cmp_lg_u32 s96, 3
    s_cbranch_scc1 F_H3X
    s_mov_b32 s40, s18
    s_mov_b32 s41, s19
    s_mov_b32 s42, 0x400000
    s_mov_b32 s43, 0x00020000
    s_add_u32 m0, s99, 32
    s_nop 0
    buffer_load_dwordx4 v1, s[40:43], s98 offen offset:0 lds
    s_add_u32 m0, s99, 4196
    s_nop 0
    buffer_load_dwordx4 v1, s[40:43], s98 offen offset:0 lds
    s_add_u32 m0, s99, 32
    s_nop 0
    buffer_load_dwordx4 v1, s[40:43], s98 offen offset:1024 lds
    s_add_u32 m0, s99, 4196
    s_nop 0
    buffer_load_dwordx4 v1, s[40:43], s98 offen offset:1024 lds
    s_add_u32 m0, s99, 32
    s_nop 0
    buffer_load_dwordx4 v1, s[40:43], s98 offen offset:2048 lds
    s_add_u32 m0, s99, 4196
    s_nop 0
    buffer_load_dwordx4 v1, s[40:43], s98 offen offset:2048 lds
    s_add_u32 m0, s99, 32
    s_nop 0
    buffer_load_dwordx4 v1, s[40:43], s98 offen offset:3072 lds
    s_add_u32 m0, s99, 4196
    s_nop 0
    buffer_load_dwordx4 v1, s[40:43], s98 offen offset:3072 lds
F_H3X:
    s_add_u32 s4, s18, s98
    s_addc_u32 s5, s19, 0
    s_load_dword s6, s[4:5], 0
    s_lshl_b32 s7, s35, 1
    s_and_b32 s7, s7, 0xfffffffc
    s_add_u32 s4, s20, s7
    s_addc_u32 s5, s21, 0
    s_load_dword s7, s[4:5], 0
    s_mul_i32 s97, s34, 4608
    s_add_u32 s97, s97, 98304
    s_add_u32 m0, s62, 40960
    s_nop 0
    buffer_load_dwordx4 v10, s[44:47], s52 offen offset:0 lds
    v_add_u32 v32, s97, v1
    v_add_u32 v33, 2048, v32
    v_cmp_gt_u32 vcc, 16, v0
    v_and_b32 v34, 1, v0
    v_lshlrev_b32 v34, 4, v34
    v_cndmask_b32 v32, v33, v32, vcc
    buffer_load_dwordx4 v10, s[44:47], s53 offen offset:1024 lds
    v_bfe_u32 v35, v0, 1, 1
    v_mul_u32_u24 v35, 4160, v35
    v_cmp_gt_u32 vcc, 32, v0
    v_add3_u32 v34, v34, v35, s99
    v_mov_b32 v36, 0
    v_mov_b32 v37, 0
    buffer_load_dwordx4 v10, s[44:47], s54 offen offset:2048 lds
    v_mov_b32 v38, 0
    v_mov_b32 v39, 0
    v_cndmask_b32 v32, v34, v32, vcc
    v_and_b32 v34, 3, v0
    v_lshlrev_b32 v30, 2, v34
    v_add_u32 v30, 156160, v30
    buffer_load_dwordx4 v10, s[44:47], s55 offen offset:3072 lds
    v_bfe_u32 v35, v0, 2, 2
    v_add_u32 v34, v34, v35
    v_lshlrev_b32 v34, 3, v34
    v_lshl_add_u32 v34, v5, 5, v34
    s_add_u32 s69, s99, 8
    v_add_u32 v6, s69, v34
    s_add_u32 m0, s62, 49152
    s_nop 0
    buffer_load_dwordx4 v11, s[48:51], s60 offen offset:0 lds
    v_and_b32 v34, 15, v0
    v_sub_u32 v34, v34, v5
    v_lshlrev_b32 v34, 4, v34
    s_add_u32 s69, s97, 192
    v_add_u32 v7, s69, v34
    v_mov_b32 v5, s99
    buffer_load_dwordx4 v11, s[48:51], s61 offen offset:1024 lds
    v_subrev_u32 v8, 16, v0
    v_add_u32 v9, 47, v0
    v_cmp_gt_u32 vcc, 16, v0
    v_mov_b32 v34, 63
    s_lshl_b32 s69, s34, 2
    v_cndmask_b32 v8, v8, v9, vcc
    v_add_u32 v10, 128, v10
    v_add_u32 v11, s63, v11
    v_cmp_eq_u32 vcc, 0, v0
    s_add_u32 s69, s69, 156192
    v_mov_b32 v9, s69
    v_cndmask_b32 v8, v8, v34, vcc
    v_lshlrev_b32 v8, 2, v8
    s_waitcnt lgkmcnt(0)
    s_lshl_b32 s6, s6, 16
    s_and_b32 s69, s35, 1
    s_lshl_b32 s69, s69, 4
    s_lshr_b32 s7, s7, s69
    s_lshl_b32 s7, s7, 16
    v_mov_b32 v33, s6
    v_add_f32 v33, s7, v33
    v_cvt_pk_bf16_f32 v33, v33, v33
    s_waitcnt vmcnt(10)
    s_barrier
    s_lshl_b32 s97, s34, 2
    s_add_u32 s97, s97, 156288
    v_mov_b32 v28, s97
    v_mov_b32 v29, 1
    s_lshr_b32 s69, s35, 6
    s_lshl_b32 s69, s69, 6
    s_add_u32 s69, s69, 0x110000
    v_and_b32 v31, 15, v0
    v_lshlrev_b32 v31, 2, v31
    buffer_load_dword v20, v31, s[36:39], s69 offen sc1
    s_mov_b32 s97, 0x110800
    buffer_load_dwordx4 v[16:19], v1, s[36:39], s97 offen sc1
    s_waitcnt vmcnt(2)
    ds_write_b32 v28, v29
    s_mul_i32 s52, s34, 4608
    s_add_u32 s52, s52, 98304
    s_mul_i32 s63, s35, 4224
    s_add_u32 s53, s63, 0x700000
    s_mov_b32 s40, s8
    s_mov_b32 s41, s9
    s_mov_b32 s42, 0x200000
    s_mov_b32 s43, 0x00020000
    s_lshl_b32 s62, s34, 10
    s_lshl_b32 s100, s34, 14
    s_lshl_b32 s101, s33, 7
    s_add_u32 s100, s100, s101
    s_waitcnt vmcnt(1)
    v_cmp_ne_u32 vcc, s68, v20
    s_cbranch_vccz F_P1_X
    s_mov_b32 s101, 0
F_P1:
    buffer_load_dword v20, v31, s[36:39], s69 offen sc1
    s_waitcnt vmcnt(0)
    v_cmp_ne_u32 vcc, s68, v20
    s_cbranch_vccz F_P1_X
    s_sleep 8
    s_add_u32 s101, s101, 1
    s_cmp_lt_u32 s101, 400000
    s_cbranch_scc1 F_P1
F_P1_X:
    s_add_u32 m0, s52, 256
    ds_write_b128 v32, v[36:39]
    buffer_load_dwordx4 v1, s[36:39], s53 offen offset:0 sc1 lds
    buffer_load_dwordx4 v1, s[36:39], s53 offen offset:1024 sc1 lds
    s_add_u32 m0, s52, 512
    ds_write_b32 v5, v36 offset:4192
    buffer_load_dwordx4 v1, s[36:39], s53 offen offset:2048 sc1 lds
    buffer_load_dwordx4 v1, s[36:39], s53 offen offset:3072 sc1 lds
    ds_write_b16 v5, v33 offset:32
    ds_write_b16 v5, v33 offset:4196
    s_add_u32 m0, s62, 81920
    s_add_u32 s101, s100, 0
    buffer_load_dwordx4 v12, s[40:43], s101 offen lds
    s_add_u32 m0, s62, 86016
    s_add_u32 s101, s100, 65536
    buffer_load_dwordx4 v12, s[40:43], s101 offen lds
    s_add_u32 m0, s62, 90112
    s_add_u32 s101, s100, 131072
    buffer_load_dwordx4 v12, s[40:43], s101 offen lds
    s_add_u32 m0, s62, 94208
    s_add_u32 s101, s100, 196608
    buffer_load_dwordx4 v12, s[40:43], s101 offen lds
    s_waitcnt vmcnt(8)
    v_xor_b32 v16, s68, v16
    v_xor_b32 v17, s68, v17
    v_xor_b32 v18, s68, v18
    v_xor_b32 v19, s68, v19
    v_or3_b32 v16, v16, v17, v18
    v_or_b32 v16, v16, v19
    v_cmp_ne_u32 vcc, 0, v16
    s_cbranch_vccz F_P0_X
    s_mov_b32 s101, 0
F_P0:
    buffer_load_dwordx4 v[16:19], v1, s[36:39], s97 offen sc1
    s_waitcnt vmcnt(0)
    v_xor_b32 v16, s68, v16
    v_xor_b32 v17, s68, v17
    v_xor_b32 v18, s68, v18
    v_xor_b32 v19, s68, v19
    v_or3_b32 v16, v16, v17, v18
    v_or_b32 v16, v16, v19
    v_cmp_ne_u32 vcc, 0, v16
    s_cbranch_vccz F_P0_X
    s_sleep 16
    s_add_u32 s101, s101, 1
    s_cmp_lt_u32 s101, 400000
    s_cbranch_scc1 F_P0
F_P0_X:
    ds_write_b32 v28, v29 offset:48
F_WG14:
    ds_read_b32 v11, v30 offset:112
    s_waitcnt lgkmcnt(0)
    v_cmp_ne_u32 vcc, 1, v11
    s_cbranch_vccz F_WG14_X
    s_sleep 1
    s_branch F_WG14
F_WG14_X:
    s_add_u32 m0, s62, 0
    s_add_u32 s101, s100, 262144
    buffer_load_dwordx4 v12, s[40:43], s101 offen lds
    s_add_u32 m0, s62, 4096
    s_add_u32 s101, s100, 327680
    buffer_load_dwordx4 v12, s[40:43], s101 offen lds
    s_add_u32 m0, s62, 8192
    s_add_u32 s101, s100, 393216
    buffer_load_dwordx4 v12, s[40:43], s101 offen lds
    s_add_u32 m0, s62, 12288
    s_add_u32 s101, s100, 458752
    buffer_load_dwordx4 v12, s[40:43], s101 offen lds
    s_add_u32 m0, s62, 16384
    s_add_u32 s101, s100, 524288
    buffer_load_dwordx4 v12, s[40:43], s101 offen lds
    s_add_u32 m0, s62, 20480
    s_add_u32 s101, s100, 589824
    buffer_load_dwordx4 v12, s[40:43], s101 offen lds
    s_add_u32 m0, s62, 24576
    s_add_u32 s101, s100, 655360
    buffer_load_dwordx4 v12, s[40:43], s101 offen lds
    s_add_u32 m0, s62, 28672
    s_add_u32 s101, s100, 720896
    buffer_load_dwordx4 v12, s[40:43], s101 offen lds
    s_add_u32 m0, s62, 32768
    s_add_u32 s101, s100, 786432
    buffer_load_dwordx4 v12, s[40:43], s101 offen lds
    s_add_u32 m0, s62, 36864
    s_add_u32 s101, s100, 851968
    buffer_load_dwordx4 v12, s[40:43], s101 offen lds
F_WGDx:
    ds_read_b32 v11, v30 offset:80
    s_waitcnt lgkmcnt(0)
    v_cmp_ne_u32 vcc, 1, v11
    s_cbranch_vccz F_WGDx_X
    s_sleep 1
    s_branch F_WGDx
F_WGDx_X:
    s_sleep 24
    s_waitcnt vmcnt(14)
    ds_read_b128 v[76:79], v7 offset:1856
    ds_read_b64_tr_b16 v[16:17], v6 offset:0
    ds_read_b64_tr_b16 v[18:19], v6 offset:4160
    ds_read_b128 v[72:75], v7 offset:1600
    ds_read_b64_tr_b16 v[20:21], v6 offset:512
    ds_read_b64_tr_b16 v[22:23], v6 offset:4672
    ds_read_b128 v[68:71], v7 offset:1344
    ds_read_b64_tr_b16 v[24:25], v6 offset:1024
    ds_read_b64_tr_b16 v[26:27], v6 offset:5184
    ds_read_b128 v[64:67], v7 offset:1088
    ds_read_b64_tr_b16 v[28:29], v6 offset:1536
    ds_read_b64_tr_b16 v[30:31], v6 offset:5696
    ds_read_b128 v[60:63], v7 offset:832
    ds_read_b64_tr_b16 v[32:33], v6 offset:2048
    ds_read_b64_tr_b16 v[34:35], v6 offset:6208
    ds_read_b128 v[56:59], v7 offset:576
    ds_read_b64_tr_b16 v[36:37], v6 offset:2560
    ds_read_b64_tr_b16 v[38:39], v6 offset:6720
    ds_read_b128 v[52:55], v7 offset:320
    ds_read_b64_tr_b16 v[40:41], v6 offset:3072
    ds_read_b64_tr_b16 v[42:43], v6 offset:7232
    ds_read_b128 v[48:51], v7 offset:64
    ds_read_b64_tr_b16 v[44:45], v6 offset:3584
    ds_read_b64_tr_b16 v[46:47], v6 offset:7744
    v_mov_b32 v10, 1
    s_mov_b64 s[60:61], 1
    s_mov_b32 s58, 0
.p2align 6
F_VLOOP:
    s_waitcnt lgkmcnt(15)
    v_mfma_f32_16x16x32_bf16 v[124:127], v[16:19], v[76:79], v[124:127]
    ds_read_b128 v[80:83], v7 offset:2368
    ds_read_b128 v[76:79], v7 offset:4160
    v_mfma_f32_16x16x32_bf16 v[120:123], v[16:19], v[72:75], v[120:123]
    v_mfma_f32_16x16x32_bf16 v[124:127], v[20:23], v[72:75], v[124:127]
    ds_read_b128 v[72:75], v7 offset:3904
    v_mfma_f32_16x16x32_bf16 v[116:119], v[16:19], v[68:71], v[116:119]
    v_mfma_f32_16x16x32_bf16 v[120:123], v[20:23], v[68:71], v[120:123]
    s_waitcnt lgkmcnt(15)
    v_mfma_f32_16x16x32_bf16 v[124:127], v[24:27], v[68:71], v[124:127]
    ds_read_b128 v[68:71], v7 offset:3648
    s_waitcnt lgkmcnt(15)
    v_mfma_f32_16x16x32_bf16 v[112:115], v[16:19], v[64:67], v[112:115]
    v_mfma_f32_16x16x32_bf16 v[116:119], v[20:23], v[64:67], v[116:119]
    v_mfma_f32_16x16x32_bf16 v[120:123], v[24:27], v[64:67], v[120:123]
    v_mfma_f32_16x16x32_bf16 v[124:127], v[28:31], v[64:67], v[124:127]
    ds_read_b128 v[64:67], v7 offset:3392
    s_waitcnt lgkmcnt(15)
    v_mfma_f32_16x16x32_bf16 v[108:111], v[16:19], v[60:63], v[108:111]
    v_mfma_f32_16x16x32_bf16 v[112:115], v[20:23], v[60:63], v[112:115]
    v_mfma_f32_16x16x32_bf16 v[116:119], v[24:27], v[60:63], v[116:119]
    v_mfma_f32_16x16x32_bf16 v[120:123], v[28:31], v[60:63], v[120:123]
    s_waitcnt lgkmcnt(13)
    v_mfma_f32_16x16x32_bf16 v[124:127], v[32:35], v[60:63], v[124:127]
    ds_read_b128 v[60:63], v7 offset:3136
    s_waitcnt lgkmcnt(13)
    v_mfma_f32_16x16x32_bf16 v[104:107], v[16:19], v[56:59], v[104:107]
    v_mfma_f32_16x16x32_bf16 v[108:111], v[20:23], v[56:59], v[108:111]
    v_mfma_f32_16x16x32_bf16 v[112:115], v[24:27], v[56:59], v[112:115]
    v_mfma_f32_16x16x32_bf16 v[116:119], v[28:31], v[56:59], v[116:119]
    v_mfma_f32_16x16x32_bf16 v[120:123], v[32:35], v[56:59], v[120:123]
    s_waitcnt lgkmcnt(11)
    v_mfma_f32_16x16x32_bf16 v[124:127], v[36:39], v[56:59], v[124:127]
    ds_read_b128 v[56:59], v7 offset:2880
    s_waitcnt lgkmcnt(11)
    v_mfma_f32_16x16x32_bf16 v[100:103], v[16:19], v[52:55], v[100:103]
    v_mfma_f32_16x16x32_bf16 v[104:107], v[20:23], v[52:55], v[104:107]
    v_mfma_f32_16x16x32_bf16 v[108:111], v[24:27], v[52:55], v[108:111]
    v_mfma_f32_16x16x32_bf16 v[112:115], v[28:31], v[52:55], v[112:115]
    v_mfma_f32_16x16x32_bf16 v[116:119], v[32:35], v[52:55], v[116:119]
    v_mfma_f32_16x16x32_bf16 v[120:123], v[36:39], v[52:55], v[120:123]
    s_waitcnt lgkmcnt(9)
    v_mfma_f32_16x16x32_bf16 v[124:127], v[40:43], v[52:55], v[124:127]
    ds_read_b128 v[52:55], v7 offset:2624
    s_waitcnt lgkmcnt(10)
    v_mfma_f32_16x16x32_bf16 v[96:99], v[16:19], v[48:51], v[96:99]
    v_mfma_f32_16x16x32_bf16 v[100:103], v[20:23], v[48:51], v[100:103]
    v_mfma_f32_16x16x32_bf16 v[104:107], v[24:27], v[48:51], v[104:107]
    v_mfma_f32_16x16x32_bf16 v[108:111], v[28:31], v[48:51], v[108:111]
    v_mfma_f32_16x16x32_bf16 v[112:115], v[32:35], v[48:51], v[112:115]
    v_mfma_f32_16x16x32_bf16 v[116:119], v[36:39], v[48:51], v[116:119]
    v_mfma_f32_16x16x32_bf16 v[120:123], v[40:43], v[48:51], v[120:123]
    s_waitcnt lgkmcnt(8)
    v_mfma_f32_16x16x32_bf16 v[124:127], v[44:47], v[48:51], v[124:127]
    s_waitcnt lgkmcnt(6)
    v_mfma_f32_16x16x32_bf16 v[156:159], v[16:19], v[76:79], v[156:159]
    ds_read_b128 v[48:51], v7 offset:0
    ds_read_b128 v[76:79], v7 offset:1792
    s_waitcnt lgkmcnt(7)
    v_mfma_f32_16x16x32_bf16 v[152:155], v[16:19], v[72:75], v[152:155]
    s_waitcnt lgkmcnt(6)
    v_mfma_f32_16x16x32_bf16 v[148:151], v[16:19], v[68:71], v[148:151]
    s_waitcnt lgkmcnt(5)
    v_mfma_f32_16x16x32_bf16 v[144:147], v[16:19], v[64:67], v[144:147]
    s_waitcnt lgkmcnt(4)
    v_mfma_f32_16x16x32_bf16 v[140:143], v[16:19], v[60:63], v[140:143]
    s_waitcnt lgkmcnt(3)
    v_mfma_f32_16x16x32_bf16 v[136:139], v[16:19], v[56:59], v[136:139]
    s_waitcnt lgkmcnt(2)
    v_mfma_f32_16x16x32_bf16 v[132:135], v[16:19], v[52:55], v[132:135]
    v_mfma_f32_16x16x32_bf16 v[128:131], v[16:19], v[80:83], v[128:131]
    ds_read_b64_tr_b16 v[16:17], v6 offset:128
    ds_read_b64_tr_b16 v[18:19], v6 offset:4288
    v_mfma_f32_16x16x32_bf16 v[156:159], v[20:23], v[72:75], v[156:159]
    ds_read_b128 v[72:75], v7 offset:1536
    v_mfma_f32_16x16x32_bf16 v[152:155], v[20:23], v[68:71], v[152:155]
    v_mfma_f32_16x16x32_bf16 v[148:151], v[20:23], v[64:67], v[148:151]
    v_mfma_f32_16x16x32_bf16 v[144:147], v[20:23], v[60:63], v[144:147]
    v_mfma_f32_16x16x32_bf16 v[140:143], v[20:23], v[56:59], v[140:143]
    v_mfma_f32_16x16x32_bf16 v[136:139], v[20:23], v[52:55], v[136:139]
    v_mfma_f32_16x16x32_bf16 v[132:135], v[20:23], v[80:83], v[132:135]
    ds_read_b64_tr_b16 v[20:21], v6 offset:640
    ds_read_b64_tr_b16 v[22:23], v6 offset:4800
    v_mfma_f32_16x16x32_bf16 v[156:159], v[24:27], v[68:71], v[156:159]
    ds_read_b128 v[68:71], v7 offset:1280
    v_mfma_f32_16x16x32_bf16 v[152:155], v[24:27], v[64:67], v[152:155]
    v_mfma_f32_16x16x32_bf16 v[148:151], v[24:27], v[60:63], v[148:151]
    v_mfma_f32_16x16x32_bf16 v[144:147], v[24:27], v[56:59], v[144:147]
    v_mfma_f32_16x16x32_bf16 v[140:143], v[24:27], v[52:55], v[140:143]
    v_mfma_f32_16x16x32_bf16 v[136:139], v[24:27], v[80:83], v[136:139]
    ds_read_b64_tr_b16 v[24:25], v6 offset:1152
    ds_read_b64_tr_b16 v[26:27], v6 offset:5312
    v_mfma_f32_16x16x32_bf16 v[156:159], v[28:31], v[64:67], v[156:159]
    ds_read_b128 v[64:67], v7 offset:1024
    v_mfma_f32_16x16x32_bf16 v[152:155], v[28:31], v[60:63], v[152:155]
    v_mfma_f32_16x16x32_bf16 v[148:151], v[28:31], v[56:59], v[148:151]
    v_mfma_f32_16x16x32_bf16 v[144:147], v[28:31], v[52:55], v[144:147]
    v_mfma_f32_16x16x32_bf16 v[140:143], v[28:31], v[80:83], v[140:143]
    ds_read_b64_tr_b16 v[28:29], v6 offset:1664
    ds_read_b64_tr_b16 v[30:31], v6 offset:5824
    v_mfma_f32_16x16x32_bf16 v[156:159], v[32:35], v[60:63], v[156:159]
    ds_read_b128 v[60:63], v7 offset:768
    v_mfma_f32_16x16x32_bf16 v[152:155], v[32:35], v[56:59], v[152:155]
    v_mfma_f32_16x16x32_bf16 v[148:151], v[32:35], v[52:55], v[148:151]
    v_mfma_f32_16x16x32_bf16 v[144:147], v[32:35], v[80:83], v[144:147]
    ds_read_b64_tr_b16 v[32:33], v6 offset:2176
    ds_read_b64_tr_b16 v[34:35], v6 offset:6336
    v_mfma_f32_16x16x32_bf16 v[156:159], v[36:39], v[56:59], v[156:159]
    ds_read_b128 v[56:59], v7 offset:512
    v_mfma_f32_16x16x32_bf16 v[152:155], v[36:39], v[52:55], v[152:155]
    v_mfma_f32_16x16x32_bf16 v[148:151], v[36:39], v[80:83], v[148:151]
    ds_read_b64_tr_b16 v[36:37], v6 offset:2688
    ds_read_b64_tr_b16 v[38:39], v6 offset:6848
    v_mfma_f32_16x16x32_bf16 v[156:159], v[40:43], v[52:55], v[156:159]
    ds_read_b128 v[52:55], v7 offset:256
    v_mfma_f32_16x16x32_bf16 v[152:155], v[40:43], v[80:83], v[152:155]
    ds_read_b64_tr_b16 v[40:41], v6 offset:3200
    ds_read_b64_tr_b16 v[42:43], v6 offset:7360
    v_mfma_f32_16x16x32_bf16 v[156:159], v[44:47], v[80:83], v[156:159]
    ds_read_b64_tr_b16 v[44:45], v6 offset:3712
    ds_read_b64_tr_b16 v[46:47], v6 offset:7872
    s_waitcnt vmcnt(0)
    ds_write_b32 v9, v10 offset:112
    v_add_u32 v6, 128, v6
    v_subrev_u32 v7, 64, v7
    s_add_u32 s58, s58, 1
    s_cmp_lt_u32 s58, 4
    s_cbranch_scc1 F_VLOOP
    s_waitcnt lgkmcnt(0)
    ds_write_b32 v9, v10
    ds_bpermute_b32 v17, v8, v131
    ds_bpermute_b32 v18, v8, v135
    ds_bpermute_b32 v19, v8, v139
    ds_bpermute_b32 v20, v8, v143
    ds_bpermute_b32 v21, v8, v147
    ds_bpermute_b32 v22, v8, v151
    ds_bpermute_b32 v23, v8, v155
    ds_bpermute_b32 v24, v8, v159
    v_mov_b32 v16, 0
    v_add_f32 v97, v97, v128
    v_add_f32 v98, v98, v129
    v_add_f32 v99, v99, v130
    v_add_f32 v101, v101, v132
    v_add_f32 v102, v102, v133
    v_add_f32 v103, v103, v134
    v_add_f32 v105, v105, v136
    v_add_f32 v106, v106, v137
    v_add_f32 v107, v107, v138
    v_add_f32 v109, v109, v140
    v_add_f32 v110, v110, v141
    v_add_f32 v111, v111, v142
    v_add_f32 v113, v113, v144
    v_add_f32 v114, v114, v145
    v_add_f32 v115, v115, v146
    v_add_f32 v117, v117, v148
    v_add_f32 v118, v118, v149
    v_add_f32 v119, v119, v150
    v_add_f32 v121, v121, v152
    v_add_f32 v122, v122, v153
    v_add_f32 v123, v123, v154
    v_add_f32 v125, v125, v156
    v_add_f32 v126, v126, v157
    v_add_f32 v127, v127, v158
    s_waitcnt lgkmcnt(0)
    v_cndmask_b32 v28, v17, v16, s[60:61]
    v_cndmask_b32 v29, v18, v17, s[60:61]
    v_cndmask_b32 v30, v19, v18, s[60:61]
    v_cndmask_b32 v31, v20, v19, s[60:61]
    v_cndmask_b32 v32, v21, v20, s[60:61]
    v_cndmask_b32 v33, v22, v21, s[60:61]
    v_cndmask_b32 v34, v23, v22, s[60:61]
    v_cndmask_b32 v35, v24, v23, s[60:61]
    v_add_f32 v96, v96, v28
    v_add_f32 v100, v100, v29
    v_add_f32 v104, v104, v30
    v_add_f32 v108, v108, v31
    v_add_f32 v112, v112, v32
    v_add_f32 v116, v116, v33
    v_add_f32 v120, v120, v34
    v_add_f32 v124, v124, v35
    v_cvt_pk_bf16_f32 v48, v96, v97
    v_cvt_pk_bf16_f32 v49, v98, v99
    v_cvt_pk_bf16_f32 v50, v100, v101
    v_cvt_pk_bf16_f32 v51, v102, v103
    v_cvt_pk_bf16_f32 v52, v104, v105
    v_cvt_pk_bf16_f32 v53, v106, v107
    v_cvt_pk_bf16_f32 v54, v108, v109
    v_cvt_pk_bf16_f32 v55, v110, v111
    v_cvt_pk_bf16_f32 v56, v112, v113
    v_cvt_pk_bf16_f32 v57, v114, v115
    v_cvt_pk_bf16_f32 v58, v116, v117
    v_cvt_pk_bf16_f32 v59, v118, v119
    v_cvt_pk_bf16_f32 v60, v120, v121
    v_cvt_pk_bf16_f32 v61, v122, v123
    v_cvt_pk_bf16_f32 v62, v124, v125
    v_cvt_pk_bf16_f32 v63, v126, v127
    s_add_u32 s53, s63, 0xc00000
    buffer_store_dwordx4 v[48:51], v1, s[36:39], s53 offen offset:0 sc1
    buffer_store_dwordx4 v[52:55], v1, s[36:39], s53 offen offset:1024 sc1
    buffer_store_dwordx4 v[56:59], v1, s[36:39], s53 offen offset:2048 sc1
    buffer_store_dwordx4 v[60:63], v1, s[36:39], s53 offen offset:3072 sc1
    s_lshr_b32 s54, s35, 2
    s_lshl_b32 s54, s54, 7
    s_lshl_b32 s55, s34, 2
    s_add_u32 s54, s54, s55
    s_add_u32 s54, s54, 0x111000
    v_mov_b32 v14, s68
    s_cmp_ge_u32 s34, 2
    s_cbranch_scc0 F_POST
    v_and_b32 v9, 3, v0
    v_lshlrev_b32 v9, 2, v9
    v_and_b32 v11, 4, v0
    v_lshl_add_u32 v9, v11, 3, v9
    v_add_u32 v9, 156192, v9
F_WL:
    ds_read_b32 v11, v9 offset:0
    s_waitcnt lgkmcnt(0)
    v_cmp_ne_u32 vcc, 1, v11
    s_cbranch_vccz F_WL_X
    s_sleep 1
    s_branch F_WL
F_WL_X:
    s_add_u32 s62, s62, 96256
    s_add_u32 s100, s100, 1540096
    s_add_u32 m0, s62, 0
    s_add_u32 s101, s100, 0
    buffer_load_dwordx4 v12, s[40:43], s101 offen lds
    s_add_u32 m0, s62, 2048
    s_add_u32 s101, s100, 32768
    buffer_load_dwordx4 v12, s[40:43], s101 offen lds
    s_add_u32 m0, s62, 4096
    s_add_u32 s101, s100, 65536
    buffer_load_dwordx4 v12, s[40:43], s101 offen lds
    s_add_u32 m0, s62, 6144
    s_add_u32 s101, s100, 98304
    buffer_load_dwordx4 v12, s[40:43], s101 offen lds
    s_add_u32 m0, s62, 8192
    s_add_u32 s101, s100, 131072
    buffer_load_dwordx4 v12, s[40:43], s101 offen lds
    s_add_u32 m0, s62, 10240
    s_add_u32 s101, s100, 163840
    buffer_load_dwordx4 v12, s[40:43], s101 offen lds
    s_add_u32 m0, s62, 12288
    s_add_u32 s101, s100, 196608
    buffer_load_dwordx4 v12, s[40:43], s101 offen lds
    s_add_u32 m0, s62, 14336
    s_add_u32 s101, s100, 229376
    buffer_load_dwordx4 v12, s[40:43], s101 offen lds
    s_add_u32 m0, s62, 16384
    s_add_u32 s101, s100, 262144
    buffer_load_dwordx4 v12, s[40:43], s101 offen lds
    s_add_u32 m0, s62, 18432
    s_add_u32 s101, s100, 294912
    buffer_load_dwordx4 v12, s[40:43], s101 offen lds
    s_add_u32 m0, s62, 20480
    s_add_u32 s101, s100, 327680
    buffer_load_dwordx4 v12, s[40:43], s101 offen lds
    s_add_u32 m0, s62, 22528
    s_add_u32 s101, s100, 360448
    buffer_load_dwordx4 v12, s[40:43], s101 offen lds
    s_add_u32 m0, s62, 24576
    s_add_u32 s101, s100, 393216
    buffer_load_dwordx4 v12, s[40:43], s101 offen lds
    s_add_u32 m0, s62, 26624
    s_add_u32 s101, s100, 425984
    buffer_load_dwordx4 v12, s[40:43], s101 offen lds
    s_add_u32 m0, s62, 28672
    s_add_u32 s101, s100, 458752
    buffer_load_dwordx4 v12, s[40:43], s101 offen lds
    s_add_u32 m0, s62, 30720
    s_add_u32 s101, s100, 491520
    buffer_load_dwordx4 v12, s[40:43], s101 offen lds
    s_lshl_b32 s58, s34, 2
    s_add_u32 s58, s58, 156200
    v_mov_b32 v9, s58
    s_waitcnt vmcnt(0)
    ds_write_b32 v9, v10
    s_waitcnt lgkmcnt(0)
    s_endpgm
F_POST:
    s_and_b32 s52, s2, 15
    s_lshl_b32 s56, s52, 7
    s_mul_i32 s53, s52, 270336
    s_add_u32 s53, s53, 0xc00000
    s_mov_b32 s44, s22
    s_mov_b32 s45, s23
    s_mov_b32 s46, 0x800000
    s_mov_b32 s47, 0x00020000
    s_mov_b32 s55, 0xffff0000
    s_add_u32 s56, s56, 2048
    s_sleep 40
    s_mov_b32 s101, 0
F_P4:
    s_mov_b32 s54, s53
    buffer_load_dwordx4 v[48:51], v232, s[36:39], s54 offen sc1
    s_add_u32 s54, s54, 4224
    buffer_load_dwordx4 v[52:55], v232, s[36:39], s54 offen sc1
    s_add_u32 s54, s54, 4224
    buffer_load_dwordx4 v[56:59], v232, s[36:39], s54 offen sc1
    s_add_u32 s54, s54, 4224
    buffer_load_dwordx4 v[60:63], v232, s[36:39], s54 offen sc1
    s_add_u32 s54, s54, 4224
    buffer_load_dwordx4 v[64:67], v232, s[36:39], s54 offen sc1
    s_add_u32 s54, s54, 4224
    buffer_load_dwordx4 v[68:71], v232, s[36:39], s54 offen sc1
    s_add_u32 s54, s54, 4224
    buffer_load_dwordx4 v[72:75], v232, s[36:39], s54 offen sc1
    s_add_u32 s54, s54, 4224
    buffer_load_dwordx4 v[76:79], v232, s[36:39], s54 offen sc1
    s_waitcnt vmcnt(0)
    v_max3_u32 v9, v48, v52, v56
    v_max3_u32 v8, v60, v64, v68
    v_max3_u32 v9, v9, v72, v76
    v_max_u32 v9, v9, v8
    v_cmp_eq_u32 vcc, -1, v9
    s_cbranch_vccz F_P4_X
    s_sleep 24
    s_add_u32 s101, s101, 1
    s_cmp_lt_u32 s101, 400000
    s_cbranch_scc1 F_P4
F_P4_X:
    v_lshlrev_b32 v80, 16, v200
    v_lshlrev_b32 v88, 16, v48
    v_and_b32 v81, s55, v200
    v_lshlrev_b32 v89, 16, v52
    v_lshlrev_b32 v82, 16, v201
    v_lshlrev_b32 v90, 16, v56
    v_and_b32 v83, s55, v201
    v_lshlrev_b32 v91, 16, v60
    v_lshlrev_b32 v84, 16, v202
    v_lshlrev_b32 v92, 16, v64
    v_and_b32 v85, s55, v202
    v_lshlrev_b32 v93, 16, v68
    v_lshlrev_b32 v86, 16, v203
    v_lshlrev_b32 v94, 16, v72
    v_and_b32 v87, s55, v203
    v_lshlrev_b32 v95, 16, v76
    v_mul_f32 v80, v80, v88
    v_mul_f32 v81, v81, v89
    v_mul_f32 v82, v82, v90
    v_mul_f32 v83, v83, v91
    v_mul_f32 v84, v84, v92
    v_mul_f32 v85, v85, v93
    v_mul_f32 v86, v86, v94
    v_mul_f32 v87, v87, v95
    v_cvt_pk_bf16_f32 v100, v80, v81
    v_cvt_pk_bf16_f32 v101, v82, v83
    v_cvt_pk_bf16_f32 v102, v84, v85
    v_cvt_pk_bf16_f32 v103, v86, v87
    s_add_u32 s57, s56, 0
    buffer_store_dwordx4 v[100:103], v233, s[44:47], s57 offen sc1
    v_lshlrev_b32 v80, 16, v204
    v_and_b32 v88, s55, v48
    v_and_b32 v81, s55, v204
    v_and_b32 v89, s55, v52
    v_lshlrev_b32 v82, 16, v205
    v_and_b32 v90, s55, v56
    v_and_b32 v83, s55, v205
    v_and_b32 v91, s55, v60
    v_lshlrev_b32 v84, 16, v206
    v_and_b32 v92, s55, v64
    v_and_b32 v85, s55, v206
    v_and_b32 v93, s55, v68
    v_lshlrev_b32 v86, 16, v207
    v_and_b32 v94, s55, v72
    v_and_b32 v87, s55, v207
    v_and_b32 v95, s55, v76
    v_mul_f32 v80, v80, v88
    v_mul_f32 v81, v81, v89
    v_mul_f32 v82, v82, v90
    v_mul_f32 v83, v83, v91
    v_mul_f32 v84, v84, v92
    v_mul_f32 v85, v85, v93
    v_mul_f32 v86, v86, v94
    v_mul_f32 v87, v87, v95
    v_cvt_pk_bf16_f32 v104, v80, v81
    v_cvt_pk_bf16_f32 v105, v82, v83
    v_cvt_pk_bf16_f32 v106, v84, v85
    v_cvt_pk_bf16_f32 v107, v86, v87
    s_add_u32 s57, s56, 4096
    buffer_store_dwordx4 v[104:107], v233, s[44:47], s57 offen sc1
    v_lshlrev_b32 v80, 16, v208
    v_lshlrev_b32 v88, 16, v49
    v_and_b32 v81, s55, v208
    v_lshlrev_b32 v89, 16, v53
    v_lshlrev_b32 v82, 16, v209
    v_lshlrev_b32 v90, 16, v57
    v_and_b32 v83, s55, v209
    v_lshlrev_b32 v91, 16, v61
    v_lshlrev_b32 v84, 16, v210
    v_lshlrev_b32 v92, 16, v65
    v_and_b32 v85, s55, v210
    v_lshlrev_b32 v93, 16, v69
    v_lshlrev_b32 v86, 16, v211
    v_lshlrev_b32 v94, 16, v73
    v_and_b32 v87, s55, v211
    v_lshlrev_b32 v95, 16, v77
    v_mul_f32 v80, v80, v88
    v_mul_f32 v81, v81, v89
    v_mul_f32 v82, v82, v90
    v_mul_f32 v83, v83, v91
    v_mul_f32 v84, v84, v92
    v_mul_f32 v85, v85, v93
    v_mul_f32 v86, v86, v94
    v_mul_f32 v87, v87, v95
    v_cvt_pk_bf16_f32 v108, v80, v81
    v_cvt_pk_bf16_f32 v109, v82, v83
    v_cvt_pk_bf16_f32 v110, v84, v85
    v_cvt_pk_bf16_f32 v111, v86, v87
    s_add_u32 s57, s56, 8192
    buffer_store_dwordx4 v[108:111], v233, s[44:47], s57 offen sc1
    v_lshlrev_b32 v80, 16, v212
    v_and_b32 v88, s55, v49
    v_and_b32 v81, s55, v212
    v_and_b32 v89, s55, v53
    v_lshlrev_b32 v82, 16, v213
    v_and_b32 v90, s55, v57
    v_and_b32 v83, s55, v213
    v_and_b32 v91, s55, v61
    v_lshlrev_b32 v84, 16, v214
    v_and_b32 v92, s55, v65
    v_and_b32 v85, s55, v214
    v_and_b32 v93, s55, v69
    v_lshlrev_b32 v86, 16, v215
    v_and_b32 v94, s55, v73
    v_and_b32 v87, s55, v215
    v_and_b32 v95, s55, v77
    v_mul_f32 v80, v80, v88
    v_mul_f32 v81, v81, v89
    v_mul_f32 v82, v82, v90
    v_mul_f32 v83, v83, v91
    v_mul_f32 v84, v84, v92
    v_mul_f32 v85, v85, v93
    v_mul_f32 v86, v86, v94
    v_mul_f32 v87, v87, v95
    v_cvt_pk_bf16_f32 v112, v80, v81
    v_cvt_pk_bf16_f32 v113, v82, v83
    v_cvt_pk_bf16_f32 v114, v84, v85
    v_cvt_pk_bf16_f32 v115, v86, v87
    s_add_u32 s57, s56, 12288
    buffer_store_dwordx4 v[112:115], v233, s[44:47], s57 offen sc1
    v_lshlrev_b32 v80, 16, v216
    v_lshlrev_b32 v88, 16, v50
    v_and_b32 v81, s55, v216
    v_lshlrev_b32 v89, 16, v54
    v_lshlrev_b32 v82, 16, v217
    v_lshlrev_b32 v90, 16, v58
    v_and_b32 v83, s55, v217
    v_lshlrev_b32 v91, 16, v62
    v_lshlrev_b32 v84, 16, v218
    v_lshlrev_b32 v92, 16, v66
    v_and_b32 v85, s55, v218
    v_lshlrev_b32 v93, 16, v70
    v_lshlrev_b32 v86, 16, v219
    v_lshlrev_b32 v94, 16, v74
    v_and_b32 v87, s55, v219
    v_lshlrev_b32 v95, 16, v78
    v_mul_f32 v80, v80, v88
    v_mul_f32 v81, v81, v89
    v_mul_f32 v82, v82, v90
    v_mul_f32 v83, v83, v91
    v_mul_f32 v84, v84, v92
    v_mul_f32 v85, v85, v93
    v_mul_f32 v86, v86, v94
    v_mul_f32 v87, v87, v95
    v_cvt_pk_bf16_f32 v116, v80, v81
    v_cvt_pk_bf16_f32 v117, v82, v83
    v_cvt_pk_bf16_f32 v118, v84, v85
    v_cvt_pk_bf16_f32 v119, v86, v87
    s_add_u32 s57, s56, 1048576
    buffer_store_dwordx4 v[116:119], v233, s[44:47], s57 offen sc1
    v_lshlrev_b32 v80, 16, v220
    v_and_b32 v88, s55, v50
    v_and_b32 v81, s55, v220
    v_and_b32 v89, s55, v54
    v_lshlrev_b32 v82, 16, v221
    v_and_b32 v90, s55, v58
    v_and_b32 v83, s55, v221
    v_and_b32 v91, s55, v62
    v_lshlrev_b32 v84, 16, v222
    v_and_b32 v92, s55, v66
    v_and_b32 v85, s55, v222
    v_and_b32 v93, s55, v70
    v_lshlrev_b32 v86, 16, v223
    v_and_b32 v94, s55, v74
    v_and_b32 v87, s55, v223
    v_and_b32 v95, s55, v78
    v_mul_f32 v80, v80, v88
    v_mul_f32 v81, v81, v89
    v_mul_f32 v82, v82, v90
    v_mul_f32 v83, v83, v91
    v_mul_f32 v84, v84, v92
    v_mul_f32 v85, v85, v93
    v_mul_f32 v86, v86, v94
    v_mul_f32 v87, v87, v95
    v_cvt_pk_bf16_f32 v120, v80, v81
    v_cvt_pk_bf16_f32 v121, v82, v83
    v_cvt_pk_bf16_f32 v122, v84, v85
    v_cvt_pk_bf16_f32 v123, v86, v87
    s_add_u32 s57, s56, 1052672
    buffer_store_dwordx4 v[120:123], v233, s[44:47], s57 offen sc1
    v_lshlrev_b32 v80, 16, v224
    v_lshlrev_b32 v88, 16, v51
    v_and_b32 v81, s55, v224
    v_lshlrev_b32 v89, 16, v55
    v_lshlrev_b32 v82, 16, v225
    v_lshlrev_b32 v90, 16, v59
    v_and_b32 v83, s55, v225
    v_lshlrev_b32 v91, 16, v63
    v_lshlrev_b32 v84, 16, v226
    v_lshlrev_b32 v92, 16, v67
    v_and_b32 v85, s55, v226
    v_lshlrev_b32 v93, 16, v71
    v_lshlrev_b32 v86, 16, v227
    v_lshlrev_b32 v94, 16, v75
    v_and_b32 v87, s55, v227
    v_lshlrev_b32 v95, 16, v79
    v_mul_f32 v80, v80, v88
    v_mul_f32 v81, v81, v89
    v_mul_f32 v82, v82, v90
    v_mul_f32 v83, v83, v91
    v_mul_f32 v84, v84, v92
    v_mul_f32 v85, v85, v93
    v_mul_f32 v86, v86, v94
    v_mul_f32 v87, v87, v95
    v_cvt_pk_bf16_f32 v124, v80, v81
    v_cvt_pk_bf16_f32 v125, v82, v83
    v_cvt_pk_bf16_f32 v126, v84, v85
    v_cvt_pk_bf16_f32 v127, v86, v87
    s_add_u32 s57, s56, 1056768
    buffer_store_dwordx4 v[124:127], v233, s[44:47], s57 offen sc1
    v_lshlrev_b32 v80, 16, v228
    v_and_b32 v88, s55, v51
    v_and_b32 v81, s55, v228
    v_and_b32 v89, s55, v55
    v_lshlrev_b32 v82, 16, v229
    v_and_b32 v90, s55, v59
    v_and_b32 v83, s55, v229
    v_and_b32 v91, s55, v63
    v_lshlrev_b32 v84, 16, v230
    v_and_b32 v92, s55, v67
    v_and_b32 v85, s55, v230
    v_and_b32 v93, s55, v71
    v_lshlrev_b32 v86, 16, v231
    v_and_b32 v94, s55, v75
    v_and_b32 v87, s55, v231
    v_and_b32 v95, s55, v79
    v_mul_f32 v80, v80, v88
    v_mul_f32 v81, v81, v89
    v_mul_f32 v82, v82, v90
    v_mul_f32 v83, v83, v91
    v_mul_f32 v84, v84, v92
    v_mul_f32 v85, v85, v93
    v_mul_f32 v86, v86, v94
    v_mul_f32 v87, v87, v95
    v_cvt_pk_bf16_f32 v128, v80, v81
    v_cvt_pk_bf16_f32 v129, v82, v83
    v_cvt_pk_bf16_f32 v130, v84, v85
    v_cvt_pk_bf16_f32 v131, v86, v87
    s_add_u32 s57, s56, 1060864
    buffer_store_dwordx4 v[128:131], v233, s[44:47], s57 offen sc1
    s_endpgm
F_C:
    s_load_dwordx8 s[20:27], s[0:1], 64
    s_and_b32 s32, s29, 3
    s_lshr_b32 s33, s28, 1
    s_lshl_b32 s33, s33, 2
    s_add_u32 s32, s32, s33
    s_and_b32 s33, s28, 1
    s_lshl_b32 s33, s33, 3
    s_lshr_b32 s35, s29, 2
    s_add_u32 s33, s33, s35
    v_lshlrev_b32 v1, 4, v0
    s_lshr_b32 s34, s3, 1
    s_and_b32 s35, s3, 1
    v_and_b32 v16, 15, v0
    v_lshrrev_b32 v17, 4, v0
    v_lshrrev_b32 v18, 1, v16
    v_xor_b32 v18, v18, v17
    v_lshlrev_b32 v18, 4, v18
    v_and_b32 v19, 7, v0
    v_lshl_add_u32 v18, v19, 7, v18
    v_bfe_u32 v19, v0, 3, 1
    v_mul_u32_u24 v19, 10240, v19
    s_lshl_b32 s40, s34, 11
    s_add_u32 s40, s40, 40960
    v_add3_u32 v2, v18, v19, s40
    v_xor_b32 v3, 64, v2
    v_bfe_u32 v18, v0, 2, 2
    v_lshlrev_b32 v18, 7, v18
    v_and_b32 v19, 3, v0
    v_lshl_add_u32 v18, v19, 3, v18
    v_bfe_u32 v19, v0, 3, 2
    v_lshlrev_b32 v19, 5, v19
    v_lshl_add_u32 v207, v17, 9, v18
    v_add_u32 v207, v207, v19
    s_lshl_b32 s40, s35, 6
    s_lshl_b32 s41, s34, 5
    s_or_b32 s40, s40, s41
    v_xor_b32 v19, s40, v19
    v_mul_u32_u24 v20, 10240, v17
    v_add3_u32 v18, v18, v19, v20
    v_add_u32 v4, 45056, v18
    v_xor_b32 v5, 32, v4
    v_mov_b32 v18, 0
    v_lshlrev_b32 v19, 2, v0
    v_add_u32 v20, 156160, v19
    ds_write_b32 v20, v18
    s_mov_b32 s42, 0x358637bd
    s_mov_b32 s43, 0x3fb8aa3b
    s_mov_b32 s49, 0x3f803f80
    v_mov_b32 v104, s42
    v_mov_b32 v105, s42
    v_mov_b32 v106, s42
    v_mov_b32 v107, s42
    v_mov_b32 v108, s42
    v_mov_b32 v109, s42
    v_mov_b32 v110, s42
    v_mov_b32 v111, s42
    v_mov_b32 v112, s42
    v_mov_b32 v113, s42
    v_mov_b32 v114, s42
    v_mov_b32 v115, s42
    v_mov_b32 v116, s42
    v_mov_b32 v117, s42
    v_mov_b32 v118, s42
    v_mov_b32 v119, s42
    v_mov_b32 v120, s42
    v_mov_b32 v121, s42
    v_mov_b32 v122, s42
    v_mov_b32 v123, s42
    v_mov_b32 v124, s42
    v_mov_b32 v125, s42
    v_mov_b32 v126, s42
    v_mov_b32 v127, s42
    v_mov_b32 v128, s42
    v_mov_b32 v129, s42
    v_mov_b32 v130, s42
    v_mov_b32 v131, s42
    v_mov_b32 v132, s42
    v_mov_b32 v133, s42
    v_mov_b32 v134, s42
    v_mov_b32 v135, s42
    v_mov_b32 v136, 0
    v_mov_b32 v137, 0
    v_mov_b32 v138, 0
    v_mov_b32 v139, 0
    v_mov_b32 v140, 0
    v_mov_b32 v141, 0
    v_mov_b32 v142, 0
    v_mov_b32 v143, 0
    v_mov_b32 v144, 0
    v_mov_b32 v145, 0
    v_mov_b32 v146, 0
    v_mov_b32 v147, 0
    v_mov_b32 v148, 0
    v_mov_b32 v149, 0
    v_mov_b32 v150, 0
    v_mov_b32 v151, 0
    v_mov_b32 v152, 0
    v_mov_b32 v153, 0
    v_mov_b32 v154, 0
    v_mov_b32 v155, 0
    v_mov_b32 v156, 0
    v_mov_b32 v157, 0
    v_mov_b32 v158, 0
    v_mov_b32 v159, 0
    v_mov_b32 v160, 0
    v_mov_b32 v161, 0
    v_mov_b32 v162, 0
    v_mov_b32 v163, 0
    v_mov_b32 v164, 0
    v_mov_b32 v165, 0
    v_mov_b32 v166, 0
    v_mov_b32 v167, 0
    v_mov_b32 v168, s42
    v_mov_b32 v169, s42
    v_mov_b32 v170, s42
    v_mov_b32 v171, s42
    v_mov_b32 v172, s42
    v_mov_b32 v173, s42
    v_mov_b32 v174, s42
    v_mov_b32 v175, s42
    v_mov_b32 v176, s42
    v_mov_b32 v177, s42
    v_mov_b32 v178, s42
    v_mov_b32 v179, s42
    v_mov_b32 v180, s42
    v_mov_b32 v181, s42
    v_mov_b32 v182, s42
    v_mov_b32 v183, s42
    v_mov_b32 v184, s42
    v_mov_b32 v185, s42
    v_mov_b32 v186, s42
    v_mov_b32 v187, s42
    v_mov_b32 v188, s42
    v_mov_b32 v189, s42
    v_mov_b32 v190, s42
    v_mov_b32 v191, s42
    v_mov_b32 v192, s42
    v_mov_b32 v193, s42
    v_mov_b32 v194, s42
    v_mov_b32 v195, s42
    v_mov_b32 v196, s42
    v_mov_b32 v197, s42
    v_mov_b32 v198, s42
    v_mov_b32 v199, s42
    s_and_b32 s40, s3, 1
    s_lshl_b32 s41, s31, 1
    s_add_u32 s40, s40, s41
    s_lshr_b32 s41, s3, 1
    s_lshl_b32 s52, s30, 1
    s_add_u32 s52, s52, s41
    s_mul_i32 s52, s52, 132
    s_add_u32 s52, s52, s40
    s_lshl_b32 s52, s52, 10
    s_add_u32 s52, s52, 0x200000
    s_lshl_b32 s50, s40, 15
    s_lshl_b32 s51, s41, 10
    s_add_u32 s53, s50, s51
    s_lshl_b32 s50, s30, 11
    s_add_u32 s50, s50, s53
    s_lshl_b32 s40, s40, 11
    s_add_u32 s54, s40, s51
    s_add_u32 s54, s54, 0x100000
    s_lshl_b32 s51, s30, 6
    s_add_u32 s51, s51, s54
    s_mul_i32 s40, s35, 2304
    s_add_u32 s58, s40, 156416
    s_add_u32 s59, s40, 116736
    s_cmp_eq_u32 s34, 0
    s_cselect_b32 s40, s58, s59
    s_cselect_b32 s41, s59, s58
    v_lshlrev_b32 v12, 4, v17
    v_add_u32 v6, s40, v1
    v_add_u32 v7, s41, v1
    v_add_u32 v8, s40, v12
    v_add_u32 v9, s41, v12
    s_lshl_b32 s40, s3, 3
    s_add_u32 s41, s40, 156160
    v_mov_b32 v10, s41
    v_xor_b32 v11, 16, v10
    v_lshl_add_u32 v13, v16, 6, v12
    s_lshl_b32 s40, s34, 3
    s_add_u32 s41, s59, s40
    v_add_u32 v200, s41, v1
    v_xor_b32 v201, 8, v200
    s_add_u32 s41, s58, s40
    v_add_u32 v203, s41, v1
    v_xor_b32 v202, 8, v203
    s_lshl_b32 s40, s3, 2
    s_add_u32 s41, s40, 156240
    v_mov_b32 v204, s41
    s_add_u32 s41, s40, 156224
    v_mov_b32 v206, s41
    v_lshlrev_b32 v18, 1, v17
    v_and_b32 v20, 7, v0
    v_xor_b32 v18, v18, v20
    v_lshlrev_b32 v18, 4, v18
    v_lshrrev_b32 v20, 3, v0
    v_lshl_add_u32 v205, v20, 11, v18
    v_mov_b32 v14, 1
    v_and_b32 v18, 12, v19
    v_add_u32 v209, 156160, v18
    v_add_u32 v211, 144, v209
    v_add_u32 v20, 160, v209
    v_subrev_u32 v21, 12, v0
    v_cmp_gt_u32 vcc, 12, v21
    v_and_b32 v18, 4, v19
    v_add_u32 v18, 156208, v18
    v_cndmask_b32 v211, v211, v20, vcc
    v_and_b32 v21, 31, v0
    v_cmp_lt_u32 vcc, 23, v21
    s_nop 1
    v_cndmask_b32 v211, v211, v18, vcc
    s_lshl_b32 s55, s32, 2
    s_add_u32 s55, s55, s3
    s_lshl_b32 s56, s55, 17
    s_lshl_b32 s40, s33, 7
    s_add_u32 s56, s56, s40
    s_mul_i32 s55, s55, 67584
    s_add_u32 s55, s55, 0x200000
    v_and_b32 v18, 31, v0
    v_add_u32 v18, 33, v18
    v_lshlrev_b32 v208, 10, v18
    s_and_b32 s57, s33, 7
    s_mul_i32 s57, s57, 3
    s_lshr_b32 s57, s57, 2
    v_lshlrev_b32 v210, 12, v16
    v_bfe_u32 v18, v0, 4, 1
    v_lshl_add_u32 v210, v18, 5, v210
    v_lshrrev_b32 v18, 5, v0
    v_lshl_add_u32 v210, v18, 4, v210
    s_mov_b32 s44, 0
    s_mov_b32 s45, 1
    s_mov_b32 s46, 0xfffec000
    s_mov_b32 s47, 40960
    s_waitcnt lgkmcnt(0)
    s_mov_b32 s36, s26
    s_mov_b32 s37, s27
    s_mov_b32 s38, 0x10000000
    s_mov_b32 s39, 0x00020000
    s_mov_b32 s60, s22
    s_mov_b32 s61, s23
    s_mov_b32 s62, 0x800000
    s_mov_b32 s63, 0x00020000
    s_mov_b32 s64, s26
    s_mov_b32 s65, s27
    s_mov_b32 s66, 0x10000000
    s_mov_b32 s67, 0x00020000
    s_mov_b32 s4, s8
    s_mov_b32 s5, s9
    s_mov_b32 s6, 0x200000
    s_mov_b32 s7, 0x00020000
    s_lshl_b32 s68, s3, 10
    s_lshl_b32 s69, s3, 14
    s_lshl_b32 s40, s33, 7
    s_add_u32 s69, s69, s40
    s_barrier
    ds_read_b64_tr_b16 v[80:81], v4 offset:1024
    ds_read_b64_tr_b16 v[82:83], v4 offset:1536
    ds_read_b128 v[16:19], v2 offset:0
    ds_read_b64_tr_b16 v[84:85], v4 offset:4096
    ds_read_b64_tr_b16 v[86:87], v4 offset:4608
    ds_read_b128 v[20:23], v3 offset:0
    ds_read_b128 v[24:27], v2 offset:20480
    ds_read_b128 v[28:31], v3 offset:20480
    ds_read_b128 v[32:35], v2 offset:1024
    ds_read_b128 v[36:39], v3 offset:1024
    ds_read_b64_tr_b16 v[88:89], v5 offset:1024
    ds_read_b64_tr_b16 v[90:91], v5 offset:1536
    ds_read_b64_tr_b16 v[92:93], v5 offset:4096
    ds_read_b64_tr_b16 v[94:95], v5 offset:4608
    ds_read_b128 v[40:43], v2 offset:21504
    ds_read_b128 v[44:47], v3 offset:21504
.p2align 6
F_CLOOP:
    s_waitcnt lgkmcnt(8)
    v_mfma_f32_16x16x32_bf16 v[104:107], v[16:19], v[80:83], v[104:107]
    ds_read_b64_tr_b16 v[96:97], v4 offset:2048
    v_mfma_f32_16x16x32_bf16 v[104:107], v[20:23], v[84:87], v[104:107]
    ds_read_b64_tr_b16 v[98:99], v4 offset:2560
    v_mfma_f32_16x16x32_bf16 v[108:111], v[24:27], v[80:83], v[108:111]
    ds_read_b64_tr_b16 v[100:101], v4 offset:5120
    v_mfma_f32_16x16x32_bf16 v[108:111], v[28:31], v[84:87], v[108:111]
    ds_read_b64_tr_b16 v[102:103], v4 offset:5632
    s_waitcnt lgkmcnt(4)
    v_mfma_f32_16x16x32_bf16 v[112:115], v[32:35], v[80:83], v[112:115]
    v_mfma_f32_16x16x32_bf16 v[112:115], v[36:39], v[84:87], v[112:115]
    v_mfma_f32_16x16x32_bf16 v[116:119], v[40:43], v[80:83], v[116:119]
    v_mfma_f32_16x16x32_bf16 v[116:119], v[44:47], v[84:87], v[116:119]
    v_mfma_f32_16x16x32_bf16 v[120:123], v[16:19], v[88:91], v[120:123]
    ds_read_b64_tr_b16 v[80:81], v5 offset:2048
    v_mfma_f32_16x16x32_bf16 v[120:123], v[20:23], v[92:95], v[120:123]
    ds_read_b64_tr_b16 v[82:83], v5 offset:2560
    v_mfma_f32_16x16x32_bf16 v[124:127], v[24:27], v[88:91], v[124:127]
    ds_read_b64_tr_b16 v[84:85], v5 offset:5120
    v_mfma_f32_16x16x32_bf16 v[124:127], v[28:31], v[92:95], v[124:127]
    ds_read_b64_tr_b16 v[86:87], v5 offset:5632
    v_mfma_f32_16x16x32_bf16 v[128:131], v[32:35], v[88:91], v[128:131]
    v_mfma_f32_16x16x32_bf16 v[128:131], v[36:39], v[92:95], v[128:131]
    v_mfma_f32_16x16x32_bf16 v[132:135], v[40:43], v[88:91], v[132:135]
    v_mfma_f32_16x16x32_bf16 v[132:135], v[44:47], v[92:95], v[132:135]
    s_waitcnt lgkmcnt(4)
    v_mfma_f32_16x16x32_bf16 v[136:139], v[16:19], v[96:99], v[136:139]
    ds_read_b64_tr_b16 v[88:89], v4 offset:0
    v_mfma_f32_16x16x32_bf16 v[136:139], v[20:23], v[100:103], v[136:139]
    ds_read_b64_tr_b16 v[90:91], v4 offset:512
    v_mfma_f32_16x16x32_bf16 v[140:143], v[24:27], v[96:99], v[140:143]
    ds_read_b64_tr_b16 v[92:93], v4 offset:3072
    v_mfma_f32_16x16x32_bf16 v[140:143], v[28:31], v[100:103], v[140:143]
    ds_read_b64_tr_b16 v[94:95], v4 offset:3584
    v_mfma_f32_16x16x32_bf16 v[144:147], v[32:35], v[96:99], v[144:147]
    v_mfma_f32_16x16x32_bf16 v[144:147], v[36:39], v[100:103], v[144:147]
    s_add_u32 s44, s44, 1
    v_mfma_f32_16x16x32_bf16 v[148:151], v[40:43], v[96:99], v[148:151]
    v_mfma_f32_16x16x32_bf16 v[148:151], v[44:47], v[100:103], v[148:151]
    s_waitcnt lgkmcnt(4)
    v_mfma_f32_16x16x32_bf16 v[152:155], v[16:19], v[80:83], v[152:155]
    ds_read_b64_tr_b16 v[96:97], v5 offset:0
    v_mfma_f32_16x16x32_bf16 v[152:155], v[20:23], v[84:87], v[152:155]
    ds_read_b64_tr_b16 v[98:99], v5 offset:512
    v_mfma_f32_16x16x32_bf16 v[156:159], v[24:27], v[80:83], v[156:159]
    ds_read_b64_tr_b16 v[100:101], v5 offset:3072
    v_mfma_f32_16x16x32_bf16 v[156:159], v[28:31], v[84:87], v[156:159]
    ds_read_b64_tr_b16 v[102:103], v5 offset:3584
    v_mfma_f32_16x16x32_bf16 v[160:163], v[32:35], v[80:83], v[160:163]
    s_add_u32 s45, s45, 1
    s_cmp_eq_u32 s45, 3
    v_mfma_f32_16x16x32_bf16 v[160:163], v[36:39], v[84:87], v[160:163]
    s_cselect_b32 s48, s46, s47
    s_cselect_b32 s45, 0, s45
    v_mfma_f32_16x16x32_bf16 v[164:167], v[40:43], v[80:83], v[164:167]
    v_add_u32 v4, s48, v4
    v_add_u32 v2, s48, v2
    v_mfma_f32_16x16x32_bf16 v[164:167], v[44:47], v[84:87], v[164:167]
    v_add_u32 v3, s48, v3
    v_add_u32 v5, s48, v5
    s_waitcnt lgkmcnt(0)
    v_mfma_f32_16x16x32_bf16 v[168:171], v[88:91], v[16:19], v[168:171]
    s_cmp_lt_u32 s44, 8
    s_cbranch_scc0 F_CNB0
    s_barrier
F_CB0:
    v_mfma_f32_16x16x32_bf16 v[168:171], v[92:95], v[20:23], v[168:171]
    ds_read_b64_tr_b16 v[80:81], v4 offset:1024
    ds_read_b64_tr_b16 v[82:83], v4 offset:1536
    v_mfma_f32_16x16x32_bf16 v[172:175], v[88:91], v[24:27], v[172:175]
    ds_read_b128 v[48:51], v2 offset:0
    ds_read_b64_tr_b16 v[84:85], v4 offset:4096
    v_mfma_f32_16x16x32_bf16 v[172:175], v[92:95], v[28:31], v[172:175]
    ds_read_b64_tr_b16 v[86:87], v4 offset:4608
    v_mfma_f32_16x16x32_bf16 v[176:179], v[88:91], v[32:35], v[176:179]
    ds_read_b128 v[52:55], v3 offset:0
    v_mfma_f32_16x16x32_bf16 v[176:179], v[92:95], v[36:39], v[176:179]
    ds_read_b128 v[56:59], v2 offset:20480
    v_mfma_f32_16x16x32_bf16 v[180:183], v[88:91], v[40:43], v[180:183]
    ds_read_b128 v[60:63], v3 offset:20480
    v_mfma_f32_16x16x32_bf16 v[180:183], v[92:95], v[44:47], v[180:183]
    v_mfma_f32_16x16x32_bf16 v[184:187], v[96:99], v[16:19], v[184:187]
    ds_read_b128 v[64:67], v2 offset:1024
    ds_read_b128 v[68:71], v3 offset:1024
    v_mfma_f32_16x16x32_bf16 v[184:187], v[100:103], v[20:23], v[184:187]
    ds_read_b64_tr_b16 v[88:89], v5 offset:1024
    ds_read_b64_tr_b16 v[90:91], v5 offset:1536
    v_mfma_f32_16x16x32_bf16 v[188:191], v[96:99], v[24:27], v[188:191]
    ds_read_b64_tr_b16 v[92:93], v5 offset:4096
    ds_read_b64_tr_b16 v[94:95], v5 offset:4608
    v_mfma_f32_16x16x32_bf16 v[188:191], v[100:103], v[28:31], v[188:191]
    ds_read_b128 v[72:75], v2 offset:21504
    v_mfma_f32_16x16x32_bf16 v[192:195], v[96:99], v[32:35], v[192:195]
    ds_read_b128 v[76:79], v3 offset:21504
    v_mfma_f32_16x16x32_bf16 v[192:195], v[100:103], v[36:39], v[192:195]
    v_mfma_f32_16x16x32_bf16 v[196:199], v[96:99], v[40:43], v[196:199]
    v_mfma_f32_16x16x32_bf16 v[196:199], v[100:103], v[44:47], v[196:199]
    s_waitcnt lgkmcnt(8)
    v_mfma_f32_16x16x32_bf16 v[104:107], v[48:51], v[80:83], v[104:107]
    ds_read_b64_tr_b16 v[96:97], v4 offset:2048
    v_mfma_f32_16x16x32_bf16 v[104:107], v[52:55], v[84:87], v[104:107]
    ds_read_b64_tr_b16 v[98:99], v4 offset:2560
    v_mfma_f32_16x16x32_bf16 v[108:111], v[56:59], v[80:83], v[108:111]
    ds_read_b64_tr_b16 v[100:101], v4 offset:5120
    v_mfma_f32_16x16x32_bf16 v[108:111], v[60:63], v[84:87], v[108:111]
    ds_read_b64_tr_b16 v[102:103], v4 offset:5632
    s_waitcnt lgkmcnt(4)
    v_mfma_f32_16x16x32_bf16 v[112:115], v[64:67], v[80:83], v[112:115]
    v_mfma_f32_16x16x32_bf16 v[112:115], v[68:71], v[84:87], v[112:115]
    v_mfma_f32_16x16x32_bf16 v[116:119], v[72:75], v[80:83], v[116:119]
    v_mfma_f32_16x16x32_bf16 v[116:119], v[76:79], v[84:87], v[116:119]
    v_mfma_f32_16x16x32_bf16 v[120:123], v[48:51], v[88:91], v[120:123]
    ds_read_b64_tr_b16 v[80:81], v5 offset:2048
    v_mfma_f32_16x16x32_bf16 v[120:123], v[52:55], v[92:95], v[120:123]
    ds_read_b64_tr_b16 v[82:83], v5 offset:2560
    v_mfma_f32_16x16x32_bf16 v[124:127], v[56:59], v[88:91], v[124:127]
    ds_read_b64_tr_b16 v[84:85], v5 offset:5120
    v_mfma_f32_16x16x32_bf16 v[124:127], v[60:63], v[92:95], v[124:127]
    ds_read_b64_tr_b16 v[86:87], v5 offset:5632
    v_mfma_f32_16x16x32_bf16 v[128:131], v[64:67], v[88:91], v[128:131]
    v_mfma_f32_16x16x32_bf16 v[128:131], v[68:71], v[92:95], v[128:131]
    v_mfma_f32_16x16x32_bf16 v[132:135], v[72:75], v[88:91], v[132:135]
    v_mfma_f32_16x16x32_bf16 v[132:135], v[76:79], v[92:95], v[132:135]
    s_waitcnt lgkmcnt(4)
    v_mfma_f32_16x16x32_bf16 v[136:139], v[48:51], v[96:99], v[136:139]
    ds_read_b64_tr_b16 v[88:89], v4 offset:0
    v_mfma_f32_16x16x32_bf16 v[136:139], v[52:55], v[100:103], v[136:139]
    ds_read_b64_tr_b16 v[90:91], v4 offset:512
    v_mfma_f32_16x16x32_bf16 v[140:143], v[56:59], v[96:99], v[140:143]
    ds_read_b64_tr_b16 v[92:93], v4 offset:3072
    v_mfma_f32_16x16x32_bf16 v[140:143], v[60:63], v[100:103], v[140:143]
    ds_read_b64_tr_b16 v[94:95], v4 offset:3584
    v_mfma_f32_16x16x32_bf16 v[144:147], v[64:67], v[96:99], v[144:147]
    v_mfma_f32_16x16x32_bf16 v[144:147], v[68:71], v[100:103], v[144:147]
    v_mfma_f32_16x16x32_bf16 v[148:151], v[72:75], v[96:99], v[148:151]
    v_mfma_f32_16x16x32_bf16 v[148:151], v[76:79], v[100:103], v[148:151]
    s_waitcnt lgkmcnt(4)
    v_mfma_f32_16x16x32_bf16 v[152:155], v[48:51], v[80:83], v[152:155]
    ds_read_b64_tr_b16 v[96:97], v5 offset:0
    v_mfma_f32_16x16x32_bf16 v[152:155], v[52:55], v[84:87], v[152:155]
    ds_read_b64_tr_b16 v[98:99], v5 offset:512
    v_mfma_f32_16x16x32_bf16 v[156:159], v[56:59], v[80:83], v[156:159]
    ds_read_b64_tr_b16 v[100:101], v5 offset:3072
    v_mfma_f32_16x16x32_bf16 v[156:159], v[60:63], v[84:87], v[156:159]
    ds_read_b64_tr_b16 v[102:103], v5 offset:3584
    v_mfma_f32_16x16x32_bf16 v[160:163], v[64:67], v[80:83], v[160:163]
    s_add_u32 s45, s45, 1
    s_cmp_eq_u32 s45, 3
    v_mfma_f32_16x16x32_bf16 v[160:163], v[68:71], v[84:87], v[160:163]
    s_cselect_b32 s48, s46, s47
    s_cselect_b32 s45, 0, s45
    v_mfma_f32_16x16x32_bf16 v[164:167], v[72:75], v[80:83], v[164:167]
    v_add_u32 v4, s48, v4
    v_add_u32 v2, s48, v2
    v_mfma_f32_16x16x32_bf16 v[164:167], v[76:79], v[84:87], v[164:167]
    v_add_u32 v3, s48, v3
    v_add_u32 v5, s48, v5
    s_waitcnt lgkmcnt(0)
    v_mfma_f32_16x16x32_bf16 v[168:171], v[88:91], v[48:51], v[168:171]
    s_cmp_lt_u32 s44, 8
    s_cbranch_scc0 F_CNB1
    s_barrier
F_CB1:
    v_mfma_f32_16x16x32_bf16 v[168:171], v[92:95], v[52:55], v[168:171]
    ds_read_b64_tr_b16 v[80:81], v4 offset:1024
    ds_read_b64_tr_b16 v[82:83], v4 offset:1536
    v_mfma_f32_16x16x32_bf16 v[172:175], v[88:91], v[56:59], v[172:175]
    ds_read_b128 v[16:19], v2 offset:0
    ds_read_b64_tr_b16 v[84:85], v4 offset:4096
    v_mfma_f32_16x16x32_bf16 v[172:175], v[92:95], v[60:63], v[172:175]
    ds_read_b64_tr_b16 v[86:87], v4 offset:4608
    v_mfma_f32_16x16x32_bf16 v[176:179], v[88:91], v[64:67], v[176:179]
    ds_read_b128 v[20:23], v3 offset:0
    v_mfma_f32_16x16x32_bf16 v[176:179], v[92:95], v[68:71], v[176:179]
    ds_read_b128 v[24:27], v2 offset:20480
    v_mfma_f32_16x16x32_bf16 v[180:183], v[88:91], v[72:75], v[180:183]
    ds_read_b128 v[28:31], v3 offset:20480
    v_mfma_f32_16x16x32_bf16 v[180:183], v[92:95], v[76:79], v[180:183]
    v_mfma_f32_16x16x32_bf16 v[184:187], v[96:99], v[48:51], v[184:187]
    ds_read_b128 v[32:35], v2 offset:1024
    ds_read_b128 v[36:39], v3 offset:1024
    v_mfma_f32_16x16x32_bf16 v[184:187], v[100:103], v[52:55], v[184:187]
    ds_read_b64_tr_b16 v[88:89], v5 offset:1024
    ds_read_b64_tr_b16 v[90:91], v5 offset:1536
    v_mfma_f32_16x16x32_bf16 v[188:191], v[96:99], v[56:59], v[188:191]
    ds_read_b64_tr_b16 v[92:93], v5 offset:4096
    ds_read_b64_tr_b16 v[94:95], v5 offset:4608
    v_mfma_f32_16x16x32_bf16 v[188:191], v[100:103], v[60:63], v[188:191]
    ds_read_b128 v[40:43], v2 offset:21504
    v_mfma_f32_16x16x32_bf16 v[192:195], v[96:99], v[64:67], v[192:195]
    ds_read_b128 v[44:47], v3 offset:21504
    v_mfma_f32_16x16x32_bf16 v[192:195], v[100:103], v[68:71], v[192:195]
    v_mfma_f32_16x16x32_bf16 v[196:199], v[96:99], v[72:75], v[196:199]
    v_mfma_f32_16x16x32_bf16 v[196:199], v[100:103], v[76:79], v[196:199]
    s_cbranch_scc1 F_CLOOP
    s_setprio 3
    v_mul_f32 v244, s43, v104
    v_mul_f32 v245, s43, v105
    v_mul_f32 v246, s43, v106
    v_mul_f32 v247, s43, v107
    v_mul_f32 v248, s43, v108
    v_mul_f32 v249, s43, v109
    v_mul_f32 v250, s43, v110
    v_mul_f32 v251, s43, v111
    v_exp_f32 v244, v244 clamp
    v_exp_f32 v245, v245 clamp
    v_exp_f32 v246, v246 clamp
    v_exp_f32 v247, v247 clamp
    v_exp_f32 v248, v248 clamp
    v_exp_f32 v249, v249 clamp
    v_exp_f32 v250, v250 clamp
    v_exp_f32 v251, v251 clamp
    v_max_f32 v104, s42, v104
    v_max_f32 v105, s42, v105
    v_max_f32 v106, s42, v106
    v_max_f32 v107, s42, v107
    v_max_f32 v108, s42, v108
    v_max_f32 v109, s42, v109
    v_max_f32 v110, s42, v110
    v_max_f32 v111, s42, v111
    v_add_f32 v244, v244, v104
    v_add_f32 v245, v245, v105
    v_add_f32 v246, v246, v106
    v_add_f32 v247, v247, v107
    v_add_f32 v248, v248, v108
    v_add_f32 v249, v249, v109
    v_add_f32 v250, v250, v110
    v_add_f32 v251, v251, v111
    v_cvt_pk_bf16_f32 v212, v244, v245
    v_cvt_pk_bf16_f32 v213, v246, v247
    v_cvt_pk_bf16_f32 v214, v248, v249
    v_cvt_pk_bf16_f32 v215, v250, v251
    v_mov_b32 v252, s49
    v_mov_b32 v253, s49
    v_mov_b32 v254, s49
    v_mov_b32 v255, s49
    v_cvt_pk_bf16_f32 v228, v136, v137
    v_cvt_pk_bf16_f32 v229, v138, v139
    v_cvt_pk_bf16_f32 v230, v140, v141
    v_cvt_pk_bf16_f32 v231, v142, v143
    v_cvt_pk_bf16_f32 v232, v144, v145
    v_cvt_pk_bf16_f32 v233, v146, v147
    v_cvt_pk_bf16_f32 v234, v148, v149
    v_cvt_pk_bf16_f32 v235, v150, v151
    v_cvt_pk_bf16_f32 v236, v152, v153
    v_cvt_pk_bf16_f32 v237, v154, v155
    v_cvt_pk_bf16_f32 v238, v156, v157
    v_cvt_pk_bf16_f32 v239, v158, v159
    v_cvt_pk_bf16_f32 v240, v160, v161
    v_cvt_pk_bf16_f32 v241, v162, v163
    v_cvt_pk_bf16_f32 v242, v164, v165
    v_cvt_pk_bf16_f32 v243, v166, v167
    v_mfma_f32_16x16x32_bf16 v[140:143], v[212:215], v[236:239], 0
    v_mfma_f32_16x16x32_bf16 v[136:139], v[212:215], v[228:231], 0
    v_mfma_f32_16x16x32_bf16 v[152:155], v[212:215], v[252:255], 0
    v_mul_f32 v244, s43, v120
    v_mul_f32 v245, s43, v121
    v_mul_f32 v246, s43, v122
    v_mul_f32 v247, s43, v123
    v_mul_f32 v248, s43, v124
    v_mul_f32 v249, s43, v125
    v_mul_f32 v250, s43, v126
    v_mul_f32 v251, s43, v127
    v_exp_f32 v244, v244 clamp
    v_exp_f32 v245, v245 clamp
    v_exp_f32 v246, v246 clamp
    v_exp_f32 v247, v247 clamp
    v_exp_f32 v248, v248 clamp
    v_exp_f32 v249, v249 clamp
    v_exp_f32 v250, v250 clamp
    v_exp_f32 v251, v251 clamp
    v_max_f32 v120, s42, v120
    v_max_f32 v121, s42, v121
    v_max_f32 v122, s42, v122
    v_max_f32 v123, s42, v123
    v_max_f32 v124, s42, v124
    v_max_f32 v125, s42, v125
    v_max_f32 v126, s42, v126
    v_max_f32 v127, s42, v127
    v_add_f32 v244, v244, v120
    v_add_f32 v245, v245, v121
    v_add_f32 v246, v246, v122
    v_add_f32 v247, v247, v123
    v_add_f32 v248, v248, v124
    v_add_f32 v249, v249, v125
    v_add_f32 v250, v250, v126
    v_add_f32 v251, v251, v127
    v_cvt_pk_bf16_f32 v216, v244, v245
    v_cvt_pk_bf16_f32 v217, v246, v247
    v_cvt_pk_bf16_f32 v218, v248, v249
    v_cvt_pk_bf16_f32 v219, v250, v251
    s_nop 1
    v_mfma_f32_16x16x32_bf16 v[148:151], v[216:219], v[236:239], 0
    v_mfma_f32_16x16x32_bf16 v[144:147], v[216:219], v[228:231], 0
    v_mfma_f32_16x16x32_bf16 v[156:159], v[216:219], v[252:255], 0
    v_mul_f32 v244, s43, v112
    v_mul_f32 v245, s43, v113
    v_mul_f32 v246, s43, v114
    v_mul_f32 v247, s43, v115
    v_mul_f32 v248, s43, v116
    v_mul_f32 v249, s43, v117
    v_mul_f32 v250, s43, v118
    v_mul_f32 v251, s43, v119
    v_exp_f32 v244, v244 clamp
    v_exp_f32 v245, v245 clamp
    v_exp_f32 v246, v246 clamp
    v_exp_f32 v247, v247 clamp
    v_exp_f32 v248, v248 clamp
    v_exp_f32 v249, v249 clamp
    v_exp_f32 v250, v250 clamp
    v_exp_f32 v251, v251 clamp
    v_max_f32 v112, s42, v112
    v_max_f32 v113, s42, v113
    v_max_f32 v114, s42, v114
    v_max_f32 v115, s42, v115
    v_max_f32 v116, s42, v116
    v_max_f32 v117, s42, v117
    v_max_f32 v118, s42, v118
    v_max_f32 v119, s42, v119
    v_add_f32 v244, v244, v112
    v_add_f32 v245, v245, v113
    v_add_f32 v246, v246, v114
    v_add_f32 v247, v247, v115
    v_add_f32 v248, v248, v116
    v_add_f32 v249, v249, v117
    v_add_f32 v250, v250, v118
    v_add_f32 v251, v251, v119
    v_cvt_pk_bf16_f32 v212, v244, v245
    v_cvt_pk_bf16_f32 v213, v246, v247
    v_cvt_pk_bf16_f32 v214, v248, v249
    v_cvt_pk_bf16_f32 v215, v250, v251
    s_nop 1
    v_mfma_f32_16x16x32_bf16 v[140:143], v[212:215], v[240:243], v[140:143]
    v_mfma_f32_16x16x32_bf16 v[136:139], v[212:215], v[232:235], v[136:139]
    v_mfma_f32_16x16x32_bf16 v[152:155], v[212:215], v[252:255], v[152:155]
    v_mul_f32 v244, s43, v128
    v_mul_f32 v245, s43, v129
    v_mul_f32 v246, s43, v130
    v_mul_f32 v247, s43, v131
    v_mul_f32 v248, s43, v132
    v_mul_f32 v249, s43, v133
    v_mul_f32 v250, s43, v134
    v_mul_f32 v251, s43, v135
    v_exp_f32 v244, v244 clamp
    v_exp_f32 v245, v245 clamp
    v_exp_f32 v246, v246 clamp
    v_exp_f32 v247, v247 clamp
    v_exp_f32 v248, v248 clamp
    v_exp_f32 v249, v249 clamp
    v_exp_f32 v250, v250 clamp
    v_exp_f32 v251, v251 clamp
    v_max_f32 v128, s42, v128
    v_max_f32 v129, s42, v129
    v_max_f32 v130, s42, v130
    v_max_f32 v131, s42, v131
    v_max_f32 v132, s42, v132
    v_max_f32 v133, s42, v133
    v_max_f32 v134, s42, v134
    v_max_f32 v135, s42, v135
    v_add_f32 v244, v244, v128
    v_add_f32 v245, v245, v129
    v_add_f32 v246, v246, v130
    v_add_f32 v247, v247, v131
    v_add_f32 v248, v248, v132
    v_add_f32 v249, v249, v133
    v_add_f32 v250, v250, v134
    v_add_f32 v251, v251, v135
    v_cvt_pk_bf16_f32 v216, v244, v245
    v_cvt_pk_bf16_f32 v217, v246, v247
    v_cvt_pk_bf16_f32 v218, v248, v249
    v_cvt_pk_bf16_f32 v219, v250, v251
    s_nop 1
    v_mfma_f32_16x16x32_bf16 v[148:151], v[216:219], v[240:243], v[148:151]
    v_mfma_f32_16x16x32_bf16 v[144:147], v[216:219], v[232:235], v[144:147]
    v_mfma_f32_16x16x32_bf16 v[156:159], v[216:219], v[252:255], v[156:159]
    ds_write_b128 v6, v[140:143]
    s_nop 4
    ds_write_b128 v6, v[148:151] offset:1024
    s_nop 0
    ds_write_b128 v8, v[156:159] offset:2048
    ds_write_b32 v10, v14
F_XA:
    ds_read_b32 v15, v11
    ds_read_b128 v[212:215], v7 offset:1024
    ds_read_b128 v[216:219], v7
    ds_read_b128 v[220:223], v9 offset:2048
    s_waitcnt lgkmcnt(0)
    v_cmp_ne_u32 vcc, 1, v15
    s_cbranch_vccnz F_XA
    v_add_f32 v212, v212, v136
    v_add_f32 v213, v213, v137
    v_add_f32 v214, v214, v138
    v_add_f32 v215, v215, v139
    v_add_f32 v216, v216, v144
    v_add_f32 v217, v217, v145
    v_add_f32 v218, v218, v146
    v_add_f32 v219, v219, v147
    v_cvt_pk_bf16_f32 v224, v212, v213
    v_cvt_pk_bf16_f32 v225, v214, v215
    v_cvt_pk_bf16_f32 v226, v216, v217
    v_cvt_pk_bf16_f32 v227, v218, v219
    buffer_store_dwordx4 v[224:227], v1, s[36:39], s50 offen sc1
    v_add_f32 v220, v220, v152
    v_add_f32 v221, v221, v153
    v_add_f32 v222, v222, v154
    v_add_f32 v223, v223, v155
    s_mov_b32 exec_lo, 0x00010001
    s_mov_b32 exec_hi, 0x00010001
    buffer_store_dwordx4 v[220:223], v12, s[36:39], s51 offen sc1
    s_mov_b64 exec, -1
F_WGO:
    ds_read_b32 v15, v209 offset:176
    s_waitcnt lgkmcnt(0)
    v_cmp_ne_u32 vcc, 1, v15
    s_cbranch_vccz F_WGO_X
    s_sleep 1
    s_branch F_WGO
F_WGO_X:
F_WGD2:
    ds_read_b32 v15, v209 offset:80
    s_waitcnt lgkmcnt(0)
    v_cmp_ne_u32 vcc, 1, v15
    s_cbranch_vccz F_WGD2_X
    s_sleep 1
    s_branch F_WGD2
F_WGD2_X:
    buffer_load_dwordx4 v[100:103], v13, s[36:39], s54 offen sc1
    v_mul_f32 v244, s43, v168
    v_mul_f32 v245, s43, v169
    v_mul_f32 v246, s43, v170
    v_mul_f32 v247, s43, v171
    v_mul_f32 v248, s43, v184
    v_mul_f32 v249, s43, v185
    v_mul_f32 v250, s43, v186
    v_mul_f32 v251, s43, v187
    v_exp_f32 v244, v244 clamp
    v_exp_f32 v245, v245 clamp
    v_exp_f32 v246, v246 clamp
    v_exp_f32 v247, v247 clamp
    v_exp_f32 v248, v248 clamp
    v_exp_f32 v249, v249 clamp
    v_exp_f32 v250, v250 clamp
    v_exp_f32 v251, v251 clamp
    v_max_f32 v168, s42, v168
    v_max_f32 v169, s42, v169
    v_max_f32 v170, s42, v170
    v_max_f32 v171, s42, v171
    v_max_f32 v184, s42, v184
    v_max_f32 v185, s42, v185
    v_max_f32 v186, s42, v186
    v_max_f32 v187, s42, v187
    v_add_f32 v244, v244, v168
    v_add_f32 v245, v245, v169
    v_add_f32 v246, v246, v170
    v_add_f32 v247, v247, v171
    v_add_f32 v248, v248, v184
    v_add_f32 v249, v249, v185
    v_add_f32 v250, v250, v186
    v_add_f32 v251, v251, v187
    v_cvt_pk_bf16_f32 v84, v244, v245
    v_cvt_pk_bf16_f32 v85, v246, v247
    v_cvt_pk_bf16_f32 v86, v248, v249
    v_cvt_pk_bf16_f32 v87, v250, v251
    v_mul_f32 v244, s43, v172
    v_mul_f32 v245, s43, v173
    v_mul_f32 v246, s43, v174
    v_mul_f32 v247, s43, v175
    v_mul_f32 v248, s43, v188
    v_mul_f32 v249, s43, v189
    v_mul_f32 v250, s43, v190
    v_mul_f32 v251, s43, v191
    v_exp_f32 v244, v244 clamp
    v_exp_f32 v245, v245 clamp
    v_exp_f32 v246, v246 clamp
    v_exp_f32 v247, v247 clamp
    v_exp_f32 v248, v248 clamp
    v_exp_f32 v249, v249 clamp
    v_exp_f32 v250, v250 clamp
    v_exp_f32 v251, v251 clamp
    v_max_f32 v172, s42, v172
    v_max_f32 v173, s42, v173
    v_max_f32 v174, s42, v174
    v_max_f32 v175, s42, v175
    v_max_f32 v188, s42, v188
    v_max_f32 v189, s42, v189
    v_max_f32 v190, s42, v190
    v_max_f32 v191, s42, v191
    v_add_f32 v244, v244, v172
    v_add_f32 v245, v245, v173
    v_add_f32 v246, v246, v174
    v_add_f32 v247, v247, v175
    v_add_f32 v248, v248, v188
    v_add_f32 v249, v249, v189
    v_add_f32 v250, v250, v190
    v_add_f32 v251, v251, v191
    v_cvt_pk_bf16_f32 v88, v244, v245
    v_cvt_pk_bf16_f32 v89, v246, v247
    v_cvt_pk_bf16_f32 v90, v248, v249
    v_cvt_pk_bf16_f32 v91, v250, v251
    v_mul_f32 v244, s43, v176
    v_mul_f32 v245, s43, v177
    v_mul_f32 v246, s43, v178
    v_mul_f32 v247, s43, v179
    v_mul_f32 v248, s43, v192
    v_mul_f32 v249, s43, v193
    v_mul_f32 v250, s43, v194
    v_mul_f32 v251, s43, v195
    v_exp_f32 v244, v244 clamp
    v_exp_f32 v245, v245 clamp
    v_exp_f32 v246, v246 clamp
    v_exp_f32 v247, v247 clamp
    v_exp_f32 v248, v248 clamp
    v_exp_f32 v249, v249 clamp
    v_exp_f32 v250, v250 clamp
    v_exp_f32 v251, v251 clamp
    v_max_f32 v176, s42, v176
    v_max_f32 v177, s42, v177
    v_max_f32 v178, s42, v178
    v_max_f32 v179, s42, v179
    v_max_f32 v192, s42, v192
    v_max_f32 v193, s42, v193
    v_max_f32 v194, s42, v194
    v_max_f32 v195, s42, v195
    v_add_f32 v244, v244, v176
    v_add_f32 v245, v245, v177
    v_add_f32 v246, v246, v178
    v_add_f32 v247, v247, v179
    v_add_f32 v248, v248, v192
    v_add_f32 v249, v249, v193
    v_add_f32 v250, v250, v194
    v_add_f32 v251, v251, v195
    v_cvt_pk_bf16_f32 v92, v244, v245
    v_cvt_pk_bf16_f32 v93, v246, v247
    v_cvt_pk_bf16_f32 v94, v248, v249
    v_cvt_pk_bf16_f32 v95, v250, v251
    v_mul_f32 v244, s43, v180
    v_mul_f32 v245, s43, v181
    v_mul_f32 v246, s43, v182
    v_mul_f32 v247, s43, v183
    v_mul_f32 v248, s43, v196
    v_mul_f32 v249, s43, v197
    v_mul_f32 v250, s43, v198
    v_mul_f32 v251, s43, v199
    v_exp_f32 v244, v244 clamp
    v_exp_f32 v245, v245 clamp
    v_exp_f32 v246, v246 clamp
    v_exp_f32 v247, v247 clamp
    v_exp_f32 v248, v248 clamp
    v_exp_f32 v249, v249 clamp
    v_exp_f32 v250, v250 clamp
    v_exp_f32 v251, v251 clamp
    v_max_f32 v180, s42, v180
    v_max_f32 v181, s42, v181
    v_max_f32 v182, s42, v182
    v_max_f32 v183, s42, v183
    v_max_f32 v196, s42, v196
    v_max_f32 v197, s42, v197
    v_max_f32 v198, s42, v198
    v_max_f32 v199, s42, v199
    v_add_f32 v244, v244, v180
    v_add_f32 v245, v245, v181
    v_add_f32 v246, v246, v182
    v_add_f32 v247, v247, v183
    v_add_f32 v248, v248, v196
    v_add_f32 v249, v249, v197
    v_add_f32 v250, v250, v198
    v_add_f32 v251, v251, v199
    v_cvt_pk_bf16_f32 v96, v244, v245
    v_cvt_pk_bf16_f32 v97, v246, v247
    v_cvt_pk_bf16_f32 v98, v248, v249
    v_cvt_pk_bf16_f32 v99, v250, v251
    s_waitcnt vmcnt(0)
    v_cmp_eq_u32 s[40:41], -1, v100
    s_cmp_lg_u64 s[40:41], 0
    s_cbranch_scc1 F_K1N
    s_lshl_b32 s59, s30, 12
    s_and_b32 s59, s59, 0x7fff
    s_add_u32 s40, s59, s53
    buffer_load_dwordx4 v[16:19], v1, s[36:39], s40 offen offset:0 sc1
    buffer_load_dwordx4 v[20:23], v1, s[36:39], s40 offen offset:2048 sc1
    s_add_u32 s59, s59, 4096
    s_and_b32 s59, s59, 0x7fff
    s_add_u32 s40, s59, s53
    buffer_load_dwordx4 v[24:27], v1, s[36:39], s40 offen offset:0 sc1
    buffer_load_dwordx4 v[28:31], v1, s[36:39], s40 offen offset:2048 sc1
    s_add_u32 s59, s59, 4096
    s_and_b32 s59, s59, 0x7fff
    s_add_u32 s40, s59, s53
    buffer_load_dwordx4 v[32:35], v1, s[36:39], s40 offen offset:0 sc1
    buffer_load_dwordx4 v[36:39], v1, s[36:39], s40 offen offset:2048 sc1
    s_add_u32 s59, s59, 4096
    s_and_b32 s59, s59, 0x7fff
    s_add_u32 s40, s59, s53
    buffer_load_dwordx4 v[40:43], v1, s[36:39], s40 offen offset:0 sc1
    buffer_load_dwordx4 v[44:47], v1, s[36:39], s40 offen offset:2048 sc1
    s_add_u32 s59, s59, 4096
    s_and_b32 s59, s59, 0x7fff
    s_add_u32 s40, s59, s53
    buffer_load_dwordx4 v[48:51], v1, s[36:39], s40 offen offset:0 sc1
    buffer_load_dwordx4 v[52:55], v1, s[36:39], s40 offen offset:2048 sc1
    s_add_u32 s59, s59, 4096
    s_and_b32 s59, s59, 0x7fff
    s_add_u32 s40, s59, s53
    buffer_load_dwordx4 v[56:59], v1, s[36:39], s40 offen offset:0 sc1
    buffer_load_dwordx4 v[60:63], v1, s[36:39], s40 offen offset:2048 sc1
    s_add_u32 s59, s59, 4096
    s_and_b32 s59, s59, 0x7fff
    s_add_u32 s40, s59, s53
    buffer_load_dwordx4 v[64:67], v1, s[36:39], s40 offen offset:0 sc1
    buffer_load_dwordx4 v[68:71], v1, s[36:39], s40 offen offset:2048 sc1
    s_add_u32 s59, s59, 4096
    s_and_b32 s59, s59, 0x7fff
    s_add_u32 s40, s59, s53
    buffer_load_dwordx4 v[72:75], v1, s[36:39], s40 offen offset:0 sc1
    buffer_load_dwordx4 v[76:79], v1, s[36:39], s40 offen offset:2048 sc1
    s_mov_b32 s58, 1
    s_branch F_K1X
F_K1N:
    buffer_load_dwordx4 v[100:103], v13, s[36:39], s54 offen sc1
    s_mov_b32 s58, 0
F_K1X:
    v_mov_b32 v112, s42
    v_mov_b32 v113, s42
    v_mov_b32 v114, s42
    v_mov_b32 v115, s42
    v_bfe_u32 v116, v0, 2, 2
    v_lshrrev_b32 v117, 4, v0
    v_cmp_eq_u32 vcc, v116, v117
    v_and_b32 v116, 1, v0
    v_lshlrev_b32 v116, 4, v116
    v_mov_b32 v117, 0x3f80
    v_lshlrev_b32 v116, v116, v117
    v_cndmask_b32 v116, 0, v116, vcc
    v_and_b32 v117, 2, v0
    v_cmp_eq_u32 vcc, 0, v117
    v_mov_b32 v142, 0
    v_mov_b32 v143, 0
    v_mov_b32 v144, 0
    v_mov_b32 v145, 0
    v_cndmask_b32 v140, 0, v116, vcc
    v_cndmask_b32 v146, 0, v116, vcc
    v_cndmask_b32 v141, v116, v142, vcc
    v_cndmask_b32 v147, v116, v142, vcc
    s_cmp_eq_u32 s58, 1
    s_cbranch_scc1 F_K2
    s_waitcnt vmcnt(0)
    v_cmp_eq_u32 vcc, -1, v100
    s_cbranch_vccz F_P2_X
    s_mov_b32 s45, 0
F_P2:
    buffer_load_dwordx4 v[100:103], v13, s[36:39], s54 offen sc1
    s_waitcnt vmcnt(0)
    v_cmp_eq_u32 vcc, -1, v100
    s_cbranch_vccz F_P2_X
    s_sleep 1
    s_add_u32 s45, s45, 1
    s_cmp_lt_u32 s45, 400000
    s_cbranch_scc1 F_P2
F_P2_X:
    s_lshl_b32 s59, s30, 12
    s_and_b32 s59, s59, 0x7fff
    s_add_u32 s40, s59, s53
    buffer_load_dwordx4 v[16:19], v1, s[36:39], s40 offen offset:0 sc1
    buffer_load_dwordx4 v[20:23], v1, s[36:39], s40 offen offset:2048 sc1
    s_add_u32 s59, s59, 4096
    s_and_b32 s59, s59, 0x7fff
    s_add_u32 s40, s59, s53
    buffer_load_dwordx4 v[24:27], v1, s[36:39], s40 offen offset:0 sc1
    buffer_load_dwordx4 v[28:31], v1, s[36:39], s40 offen offset:2048 sc1
    s_add_u32 s59, s59, 4096
    s_and_b32 s59, s59, 0x7fff
    s_add_u32 s40, s59, s53
    buffer_load_dwordx4 v[32:35], v1, s[36:39], s40 offen offset:0 sc1
    buffer_load_dwordx4 v[36:39], v1, s[36:39], s40 offen offset:2048 sc1
    s_add_u32 s59, s59, 4096
    s_and_b32 s59, s59, 0x7fff
    s_add_u32 s40, s59, s53
    buffer_load_dwordx4 v[40:43], v1, s[36:39], s40 offen offset:0 sc1
    buffer_load_dwordx4 v[44:47], v1, s[36:39], s40 offen offset:2048 sc1
    s_add_u32 s59, s59, 4096
    s_and_b32 s59, s59, 0x7fff
    s_add_u32 s40, s59, s53
    buffer_load_dwordx4 v[48:51], v1, s[36:39], s40 offen offset:0 sc1
    buffer_load_dwordx4 v[52:55], v1, s[36:39], s40 offen offset:2048 sc1
    s_add_u32 s59, s59, 4096
    s_and_b32 s59, s59, 0x7fff
    s_add_u32 s40, s59, s53
    buffer_load_dwordx4 v[56:59], v1, s[36:39], s40 offen offset:0 sc1
    buffer_load_dwordx4 v[60:63], v1, s[36:39], s40 offen offset:2048 sc1
    s_add_u32 s59, s59, 4096
    s_and_b32 s59, s59, 0x7fff
    s_add_u32 s40, s59, s53
    buffer_load_dwordx4 v[64:67], v1, s[36:39], s40 offen offset:0 sc1
    buffer_load_dwordx4 v[68:71], v1, s[36:39], s40 offen offset:2048 sc1
    s_add_u32 s59, s59, 4096
    s_and_b32 s59, s59, 0x7fff
    s_add_u32 s40, s59, s53
    buffer_load_dwordx4 v[72:75], v1, s[36:39], s40 offen offset:0 sc1
    buffer_load_dwordx4 v[76:79], v1, s[36:39], s40 offen offset:2048 sc1
F_K2:
    v_add_f32_dpp v120, v100, v100 row_ror:8 row_mask:0xf bank_mask:0xf
    v_add_f32_dpp v121, v101, v101 row_ror:8 row_mask:0xf bank_mask:0xf
    v_add_f32_dpp v122, v102, v102 row_ror:8 row_mask:0xf bank_mask:0xf
    v_add_f32_dpp v123, v103, v103 row_ror:8 row_mask:0xf bank_mask:0xf
    v_add_f32_dpp v120, v120, v120 row_ror:4 row_mask:0xf bank_mask:0xf
    v_add_f32_dpp v121, v121, v121 row_ror:4 row_mask:0xf bank_mask:0xf
    v_add_f32_dpp v122, v122, v122 row_ror:4 row_mask:0xf bank_mask:0xf
    v_add_f32_dpp v123, v123, v123 row_ror:4 row_mask:0xf bank_mask:0xf
    v_add_f32_dpp v120, v120, v120 row_ror:2 row_mask:0xf bank_mask:0xf
    v_add_f32_dpp v121, v121, v121 row_ror:2 row_mask:0xf bank_mask:0xf
    v_add_f32_dpp v122, v122, v122 row_ror:2 row_mask:0xf bank_mask:0xf
    v_add_f32_dpp v123, v123, v123 row_ror:2 row_mask:0xf bank_mask:0xf
    v_add_f32_dpp v120, v120, v120 row_ror:1 row_mask:0xf bank_mask:0xf
    v_add_f32_dpp v121, v121, v121 row_ror:1 row_mask:0xf bank_mask:0xf
    v_add_f32_dpp v122, v122, v122 row_ror:1 row_mask:0xf bank_mask:0xf
    v_add_f32_dpp v123, v123, v123 row_ror:1 row_mask:0xf bank_mask:0xf
    v_cvt_pk_bf16_f32 v132, v120, v121
    v_cvt_pk_bf16_f32 v133, v122, v123
    v_mov_b32 v15, 0
    s_waitcnt vmcnt(14)
    v_mfma_f32_16x16x32_bf16 v[104:107], v[140:143], v[16:19], 0
    v_mfma_f32_16x16x32_bf16 v[108:111], v[144:147], v[16:19], 0
    v_max3_u32 v15, v15, v16, v20
    v_mfma_f32_16x16x32_bf16 v[104:107], v[140:143], v[20:23], v[104:107]
    v_mfma_f32_16x16x32_bf16 v[108:111], v[144:147], v[20:23], v[108:111]
    s_waitcnt vmcnt(12)
    v_mfma_f32_16x16x32_bf16 v[104:107], v[140:143], v[24:27], v[104:107]
    v_mfma_f32_16x16x32_bf16 v[108:111], v[144:147], v[24:27], v[108:111]
    v_max3_u32 v15, v15, v24, v28
    v_mfma_f32_16x16x32_bf16 v[104:107], v[140:143], v[28:31], v[104:107]
    v_mfma_f32_16x16x32_bf16 v[108:111], v[144:147], v[28:31], v[108:111]
    s_waitcnt vmcnt(10)
    v_mfma_f32_16x16x32_bf16 v[104:107], v[140:143], v[32:35], v[104:107]
    v_mfma_f32_16x16x32_bf16 v[108:111], v[144:147], v[32:35], v[108:111]
    v_max3_u32 v15, v15, v32, v36
    v_mfma_f32_16x16x32_bf16 v[104:107], v[140:143], v[36:39], v[104:107]
    v_mfma_f32_16x16x32_bf16 v[108:111], v[144:147], v[36:39], v[108:111]
    s_waitcnt vmcnt(8)
    v_mfma_f32_16x16x32_bf16 v[104:107], v[140:143], v[40:43], v[104:107]
    v_mfma_f32_16x16x32_bf16 v[108:111], v[144:147], v[40:43], v[108:111]
    v_max3_u32 v15, v15, v40, v44
    v_mfma_f32_16x16x32_bf16 v[104:107], v[140:143], v[44:47], v[104:107]
    v_mfma_f32_16x16x32_bf16 v[108:111], v[144:147], v[44:47], v[108:111]
    s_waitcnt vmcnt(6)
    v_mfma_f32_16x16x32_bf16 v[104:107], v[140:143], v[48:51], v[104:107]
    v_mfma_f32_16x16x32_bf16 v[108:111], v[144:147], v[48:51], v[108:111]
    v_max3_u32 v15, v15, v48, v52
    v_mfma_f32_16x16x32_bf16 v[104:107], v[140:143], v[52:55], v[104:107]
    v_mfma_f32_16x16x32_bf16 v[108:111], v[144:147], v[52:55], v[108:111]
    s_waitcnt vmcnt(4)
    v_mfma_f32_16x16x32_bf16 v[104:107], v[140:143], v[56:59], v[104:107]
    v_mfma_f32_16x16x32_bf16 v[108:111], v[144:147], v[56:59], v[108:111]
    v_max3_u32 v15, v15, v56, v60
    v_mfma_f32_16x16x32_bf16 v[104:107], v[140:143], v[60:63], v[104:107]
    v_mfma_f32_16x16x32_bf16 v[108:111], v[144:147], v[60:63], v[108:111]
    s_waitcnt vmcnt(2)
    v_mfma_f32_16x16x32_bf16 v[104:107], v[140:143], v[64:67], v[104:107]
    v_mfma_f32_16x16x32_bf16 v[108:111], v[144:147], v[64:67], v[108:111]
    v_max3_u32 v15, v15, v64, v68
    v_mfma_f32_16x16x32_bf16 v[104:107], v[140:143], v[68:71], v[104:107]
    v_mfma_f32_16x16x32_bf16 v[108:111], v[144:147], v[68:71], v[108:111]
    s_waitcnt vmcnt(0)
    v_mfma_f32_16x16x32_bf16 v[104:107], v[140:143], v[72:75], v[104:107]
    v_mfma_f32_16x16x32_bf16 v[108:111], v[144:147], v[72:75], v[108:111]
    v_max3_u32 v15, v15, v72, v76
    v_mfma_f32_16x16x32_bf16 v[104:107], v[140:143], v[76:79], v[104:107]
    v_mfma_f32_16x16x32_bf16 v[108:111], v[144:147], v[76:79], v[108:111]
    v_cmp_eq_u32 vcc, -1, v15
    s_cbranch_vccz F_K2X
    s_add_u32 s58, s58, 2
    s_cmp_gt_u32 s58, 400000
    s_cbranch_scc0 F_P2_X
F_K2X:
    s_nop 4
    v_cvt_pk_bf16_f32 v136, v104, v105
    v_cvt_pk_bf16_f32 v137, v106, v107
    v_cvt_pk_bf16_f32 v138, v108, v109
    v_cvt_pk_bf16_f32 v139, v110, v111
    ds_write_b128 v7, v[136:139]
    ds_write_b64 v9, v[132:133] offset:2048
    ds_write_b32 v10, v14 offset:4
    s_add_u32 m0, s68, 40960
    s_add_u32 s40, s69, 917504
    buffer_load_dwordx4 v205, s[4:7], s40 offen lds
    s_add_u32 m0, s68, 45056
    s_add_u32 s40, s69, 983040
    buffer_load_dwordx4 v205, s[4:7], s40 offen lds
    s_add_u32 m0, s68, 49152
    s_add_u32 s40, s69, 1048576
    buffer_load_dwordx4 v205, s[4:7], s40 offen lds
    s_add_u32 m0, s68, 53248
    s_add_u32 s40, s69, 1114112
    buffer_load_dwordx4 v205, s[4:7], s40 offen lds
    s_add_u32 m0, s68, 57344
    s_add_u32 s40, s69, 1179648
    buffer_load_dwordx4 v205, s[4:7], s40 offen lds
F_XB:
    ds_read_b32 v15, v11 offset:4
    ds_read_b64 v[134:135], v8 offset:2048
    ds_read_b64 v[124:125], v200
    ds_read_b64 v[126:127], v201
    ds_read_b64 v[128:129], v202
    ds_read_b64 v[130:131], v203
    s_waitcnt lgkmcnt(0)
    v_cmp_ne_u32 vcc, 1, v15
    s_cbranch_vccnz F_XB
    v_mfma_f32_16x16x32_bf16 v[140:143], v[132:135], v[84:87], v[112:115]
    v_mfma_f32_16x16x32_bf16 v[144:147], v[132:135], v[88:91], v[112:115]
    v_mfma_f32_16x16x32_bf16 v[148:151], v[132:135], v[92:95], v[112:115]
    v_mfma_f32_16x16x32_bf16 v[152:155], v[132:135], v[96:99], v[112:115]
    v_mfma_f32_16x16x32_bf16 v[156:159], v[124:127], v[84:87], 0
    v_mfma_f32_16x16x32_bf16 v[160:163], v[128:131], v[84:87], 0
    v_mfma_f32_16x16x32_bf16 v[164:167], v[124:127], v[88:91], 0
    v_mfma_f32_16x16x32_bf16 v[168:171], v[128:131], v[88:91], 0
    v_mfma_f32_16x16x32_bf16 v[172:175], v[124:127], v[92:95], 0
    v_mfma_f32_16x16x32_bf16 v[176:179], v[128:131], v[92:95], 0
    v_mfma_f32_16x16x32_bf16 v[180:183], v[124:127], v[96:99], 0
    v_mfma_f32_16x16x32_bf16 v[184:187], v[128:131], v[96:99], 0
    ds_write_b32 v206, v14
    s_add_u32 m0, s68, 61440
    s_add_u32 s40, s69, 1245184
    buffer_load_dwordx4 v205, s[4:7], s40 offen lds
    s_add_u32 m0, s68, 65536
    s_add_u32 s40, s69, 1310720
    buffer_load_dwordx4 v205, s[4:7], s40 offen lds
    s_add_u32 m0, s68, 69632
    s_add_u32 s40, s69, 1376256
    buffer_load_dwordx4 v205, s[4:7], s40 offen lds
    s_add_u32 m0, s68, 73728
    s_add_u32 s40, s69, 1441792
    buffer_load_dwordx4 v205, s[4:7], s40 offen lds
    s_add_u32 m0, s68, 77824
    s_add_u32 s40, s69, 1507328
    buffer_load_dwordx4 v205, s[4:7], s40 offen lds
    v_rcp_f32 v140, v140
    v_rcp_f32 v144, v144
    v_rcp_f32 v148, v148
    v_rcp_f32 v152, v152
    v_mul_f32 v156, v156, v140
    v_mul_f32 v157, v157, v140
    v_mul_f32 v158, v158, v140
    v_mul_f32 v159, v159, v140
    v_mul_f32 v160, v160, v140
    v_mul_f32 v161, v161, v140
    v_mul_f32 v162, v162, v140
    v_mul_f32 v163, v163, v140
    v_cvt_pk_bf16_f32 v212, v156, v157
    v_cvt_pk_bf16_f32 v213, v158, v159
    v_cvt_pk_bf16_f32 v214, v160, v161
    v_cvt_pk_bf16_f32 v215, v162, v163
    buffer_store_dwordx4 v[212:215], v1, s[36:39], s52 offen sc1
    s_add_u32 s52, s52, 33792
    v_mul_f32 v164, v164, v144
    v_mul_f32 v165, v165, v144
    v_mul_f32 v166, v166, v144
    v_mul_f32 v167, v167, v144
    v_mul_f32 v168, v168, v144
    v_mul_f32 v169, v169, v144
    v_mul_f32 v170, v170, v144
    v_mul_f32 v171, v171, v144
    v_cvt_pk_bf16_f32 v216, v164, v165
    v_cvt_pk_bf16_f32 v217, v166, v167
    v_cvt_pk_bf16_f32 v218, v168, v169
    v_cvt_pk_bf16_f32 v219, v170, v171
    buffer_store_dwordx4 v[216:219], v1, s[36:39], s52 offen sc1
    s_add_u32 s52, s52, 33792
    v_mul_f32 v172, v172, v148
    v_mul_f32 v173, v173, v148
    v_mul_f32 v174, v174, v148
    v_mul_f32 v175, v175, v148
    v_mul_f32 v176, v176, v148
    v_mul_f32 v177, v177, v148
    v_mul_f32 v178, v178, v148
    v_mul_f32 v179, v179, v148
    v_cvt_pk_bf16_f32 v220, v172, v173
    v_cvt_pk_bf16_f32 v221, v174, v175
    v_cvt_pk_bf16_f32 v222, v176, v177
    v_cvt_pk_bf16_f32 v223, v178, v179
    buffer_store_dwordx4 v[220:223], v1, s[36:39], s52 offen sc1
    s_add_u32 s52, s52, 33792
    v_mul_f32 v180, v180, v152
    v_mul_f32 v181, v181, v152
    v_mul_f32 v182, v182, v152
    v_mul_f32 v183, v183, v152
    v_mul_f32 v184, v184, v152
    v_mul_f32 v185, v185, v152
    v_mul_f32 v186, v186, v152
    v_mul_f32 v187, v187, v152
    v_cvt_pk_bf16_f32 v224, v180, v181
    v_cvt_pk_bf16_f32 v225, v182, v183
    v_cvt_pk_bf16_f32 v226, v184, v185
    v_cvt_pk_bf16_f32 v227, v186, v187
    buffer_store_dwordx4 v[224:227], v1, s[36:39], s52 offen sc1
    v_mov_b32 v16, 0
    v_mov_b32 v17, 0
    v_mov_b32 v18, 0
    v_mov_b32 v19, 0
    v_mov_b32 v20, 0
    v_mov_b32 v21, 0
    v_mov_b32 v22, 0
    v_mov_b32 v23, 0
    v_mov_b32 v24, 0
    v_mov_b32 v25, 0
    v_mov_b32 v26, 0
    v_mov_b32 v27, 0
    v_mov_b32 v28, 0
    v_mov_b32 v29, 0
    v_mov_b32 v30, 0
    v_mov_b32 v31, 0
    v_mov_b32 v32, 0
    v_mov_b32 v33, 0
    v_mov_b32 v34, 0
    v_mov_b32 v35, 0
    v_mov_b32 v36, 0
    v_mov_b32 v37, 0
    v_mov_b32 v38, 0
    v_mov_b32 v39, 0
    v_mov_b32 v40, 0
    v_mov_b32 v41, 0
    v_mov_b32 v42, 0
    v_mov_b32 v43, 0
    v_mov_b32 v44, 0
    v_mov_b32 v45, 0
    v_mov_b32 v46, 0
    v_mov_b32 v47, 0
    v_add_u32 v6, 33792, v1
    s_mov_b32 s46, 0x11111111
    s_mov_b32 s47, 0
    s_mov_b32 s50, -1
    s_mov_b32 s51, -1
    s_mov_b32 s54, 0x76432105
    s_mov_b32 s44, 0
    s_mov_b32 s58, 0
    v_mov_b32 v8, 0x80000000
    s_waitcnt vmcnt(4)
    ds_write_b32 v206, v14 offset:96
    v_mov_b32 v15, v188
.p2align 6
F_GLOOP:
    s_cmp_lt_i32 s50, 0
    s_cbranch_scc1 F_GE0
    s_waitcnt vmcnt(8)
F_GC0:
    v_max3_u32 v15, v80, v84, v88
    v_max3_u32 v7, v92, v96, v100
    v_max3_u32 v15, v15, v104, v108
    v_max_u32 v15, v15, v7
    v_cmp_eq_u32 vcc, -1, v15
    s_cbranch_vccnz F_GF0
F_GK0:
    s_waitcnt lgkmcnt(0)
    v_mfma_f32_16x16x32_bf16 v[16:19], v[48:51], v[80:83], v[16:19]
    ds_read_b64_tr_b16 v[64:65], v2 offset:4096
    ds_read_b64_tr_b16 v[66:67], v2 offset:6144
    v_mfma_f32_16x16x32_bf16 v[32:35], v[48:51], v[84:87], v[32:35]
    ds_read_b64_tr_b16 v[68:69], v3 offset:4096
    ds_read_b64_tr_b16 v[70:71], v3 offset:6144
    v_mfma_f32_16x16x32_bf16 v[20:23], v[52:55], v[80:83], v[20:23]
    ds_read_b64_tr_b16 v[72:73], v4 offset:4096
    ds_read_b64_tr_b16 v[74:75], v4 offset:6144
    v_mfma_f32_16x16x32_bf16 v[36:39], v[52:55], v[84:87], v[36:39]
    ds_read_b64_tr_b16 v[76:77], v5 offset:4096
    ds_read_b64_tr_b16 v[78:79], v5 offset:6144
    v_mfma_f32_16x16x32_bf16 v[24:27], v[56:59], v[80:83], v[24:27]
    v_cmp_eq_u32 vcc, -1, v9
    v_cmp_ne_u32 s[40:41], 1, v10
    s_ashr_i32 s45, s51, 31
    v_mfma_f32_16x16x32_bf16 v[40:43], v[56:59], v[84:87], v[40:43]
    s_or_b32 s45, s45, vcc_lo
    s_or_b32 s45, s45, s40
    s_or_b32 s45, s45, s41
    v_mfma_f32_16x16x32_bf16 v[28:31], v[60:63], v[80:83], v[28:31]
    s_lshr_b32 s40, s45, 1
    s_or_b32 s45, s45, s40
    s_lshr_b32 s40, s45, 2
    v_mfma_f32_16x16x32_bf16 v[44:47], v[60:63], v[84:87], v[44:47]
    s_or_b32 s45, s45, s40
    v_cndmask_b32 v11, v8, v208, vcc
    s_waitcnt lgkmcnt(0)
    v_mfma_f32_16x16x32_bf16 v[16:19], v[64:67], v[88:91], v[16:19]
    ds_read_b64_tr_b16 v[48:49], v2 offset:8192
    ds_read_b64_tr_b16 v[50:51], v2 offset:10240
    s_andn2_b32 s45, s46, s45
    v_mfma_f32_16x16x32_bf16 v[32:35], v[64:67], v[92:95], v[32:35]
    ds_read_b64_tr_b16 v[52:53], v3 offset:8192
    ds_read_b64_tr_b16 v[54:55], v3 offset:10240
    s_cselect_b32 s66, s38, 0
    v_mfma_f32_16x16x32_bf16 v[20:23], v[68:71], v[88:91], v[20:23]
    ds_read_b64_tr_b16 v[56:57], v4 offset:8192
    ds_read_b64_tr_b16 v[58:59], v4 offset:10240
    s_ff1_i32_b32 s50, s45
    v_mfma_f32_16x16x32_bf16 v[36:39], v[68:71], v[92:95], v[36:39]
    ds_read_b64_tr_b16 v[60:61], v5 offset:8192
    ds_read_b64_tr_b16 v[62:63], v5 offset:10240
    s_lshl_b32 s52, s50, 10
    v_mfma_f32_16x16x32_bf16 v[24:27], v[72:75], v[88:91], v[24:27]
    s_add_u32 s52, s52, s55
    s_bitset0_b32 s46, s50
    buffer_load_dword v9, v11, s[36:39], s55 offen offset:1008 sc1
    v_mfma_f32_16x16x32_bf16 v[40:43], v[72:75], v[92:95], v[40:43]
    buffer_load_dwordx4 v[80:83], v1, s[64:67], s52 offen offset:0 sc1
    s_lshr_b32 s48, s54, s51
    v_mfma_f32_16x16x32_bf16 v[28:31], v[76:79], v[88:91], v[28:31]
    buffer_load_dwordx4 v[84:87], v6, s[64:67], s52 offen offset:0 sc1
    s_and_b32 s48, s48, 15
    v_mfma_f32_16x16x32_bf16 v[44:47], v[76:79], v[92:95], v[44:47]
    s_lshl_b32 s48, s48, 14
    s_waitcnt lgkmcnt(0)
    v_mfma_f32_16x16x32_bf16 v[16:19], v[48:51], v[96:99], v[16:19]
    ds_read_b64_tr_b16 v[64:65], v2 offset:12288
    ds_read_b64_tr_b16 v[66:67], v2 offset:14336
    v_mfma_f32_16x16x32_bf16 v[32:35], v[48:51], v[100:103], v[32:35]
    ds_read_b64_tr_b16 v[68:69], v3 offset:12288
    ds_read_b64_tr_b16 v[70:71], v3 offset:14336
    v_mfma_f32_16x16x32_bf16 v[20:23], v[52:55], v[96:99], v[20:23]
    ds_read_b64_tr_b16 v[72:73], v4 offset:12288
    ds_read_b64_tr_b16 v[74:75], v4 offset:14336
    v_mfma_f32_16x16x32_bf16 v[36:39], v[52:55], v[100:103], v[36:39]
    ds_read_b64_tr_b16 v[76:77], v5 offset:12288
    ds_read_b64_tr_b16 v[78:79], v5 offset:14336
    v_mfma_f32_16x16x32_bf16 v[24:27], v[56:59], v[96:99], v[24:27]
    buffer_load_dwordx4 v[88:91], v1, s[64:67], s52 offen offset:1024 sc1
    v_add_u32 v2, s48, v207
    v_mfma_f32_16x16x32_bf16 v[40:43], v[56:59], v[100:103], v[40:43]
    buffer_load_dwordx4 v[92:95], v6, s[64:67], s52 offen offset:1024 sc1
    v_xor_b32 v3, 32, v2
    v_mfma_f32_16x16x32_bf16 v[28:31], v[60:63], v[96:99], v[28:31]
    v_xor_b32 v4, 64, v2
    v_xor_b32 v5, 96, v2
    v_mfma_f32_16x16x32_bf16 v[44:47], v[60:63], v[100:103], v[44:47]
    s_waitcnt lgkmcnt(0)
    v_mfma_f32_16x16x32_bf16 v[16:19], v[64:67], v[104:107], v[16:19]
    ds_read_b64_tr_b16 v[48:49], v2 offset:0
    ds_read_b64_tr_b16 v[50:51], v2 offset:2048
    v_mfma_f32_16x16x32_bf16 v[32:35], v[64:67], v[108:111], v[32:35]
    ds_read_b64_tr_b16 v[52:53], v3 offset:0
    ds_read_b64_tr_b16 v[54:55], v3 offset:2048
    v_mfma_f32_16x16x32_bf16 v[20:23], v[68:71], v[104:107], v[20:23]
    ds_read_b64_tr_b16 v[56:57], v4 offset:0
    ds_read_b64_tr_b16 v[58:59], v4 offset:2048
    v_mfma_f32_16x16x32_bf16 v[36:39], v[68:71], v[108:111], v[36:39]
    ds_read_b64_tr_b16 v[60:61], v5 offset:0
    ds_read_b64_tr_b16 v[62:63], v5 offset:2048
    v_mfma_f32_16x16x32_bf16 v[24:27], v[72:75], v[104:107], v[24:27]
    buffer_load_dwordx4 v[96:99], v1, s[64:67], s52 offen offset:2048 sc1
    ds_read_b32 v10, v211
    v_mfma_f32_16x16x32_bf16 v[40:43], v[72:75], v[108:111], v[40:43]
    buffer_load_dwordx4 v[100:103], v6, s[64:67], s52 offen offset:2048 sc1
    v_mfma_f32_16x16x32_bf16 v[28:31], v[76:79], v[104:107], v[28:31]
    v_mfma_f32_16x16x32_bf16 v[44:47], v[76:79], v[108:111], v[44:47]
    buffer_load_dwordx4 v[104:107], v1, s[64:67], s52 offen offset:3072 sc1
    buffer_load_dwordx4 v[108:111], v6, s[64:67], s52 offen offset:3072 sc1
    s_cmp_lt_i32 s51, 0
    s_cbranch_scc1 F_GE1
    s_waitcnt vmcnt(9)
F_GC1:
    v_max3_u32 v15, v112, v116, v120
    v_max3_u32 v7, v124, v128, v132
    v_max3_u32 v15, v15, v136, v140
    v_max_u32 v15, v15, v7
    v_cmp_eq_u32 vcc, -1, v15
    s_cbranch_vccnz F_GF1
F_GK1:
    s_waitcnt lgkmcnt(1)
    v_mfma_f32_16x16x32_bf16 v[16:19], v[48:51], v[112:115], v[16:19]
    ds_read_b64_tr_b16 v[64:65], v2 offset:4096
    ds_read_b64_tr_b16 v[66:67], v2 offset:6144
    v_mfma_f32_16x16x32_bf16 v[32:35], v[48:51], v[116:119], v[32:35]
    ds_read_b64_tr_b16 v[68:69], v3 offset:4096
    ds_read_b64_tr_b16 v[70:71], v3 offset:6144
    v_mfma_f32_16x16x32_bf16 v[20:23], v[52:55], v[112:115], v[20:23]
    ds_read_b64_tr_b16 v[72:73], v4 offset:4096
    ds_read_b64_tr_b16 v[74:75], v4 offset:6144
    v_mfma_f32_16x16x32_bf16 v[36:39], v[52:55], v[116:119], v[36:39]
    ds_read_b64_tr_b16 v[76:77], v5 offset:4096
    ds_read_b64_tr_b16 v[78:79], v5 offset:6144
    v_mfma_f32_16x16x32_bf16 v[24:27], v[56:59], v[112:115], v[24:27]
    s_waitcnt vmcnt(8) lgkmcnt(8)
    v_cmp_eq_u32 vcc, -1, v9
    v_cmp_ne_u32 s[40:41], 1, v10
    s_ashr_i32 s45, s50, 31
    v_mfma_f32_16x16x32_bf16 v[40:43], v[56:59], v[116:119], v[40:43]
    s_or_b32 s45, s45, vcc_lo
    s_or_b32 s45, s45, s40
    s_or_b32 s45, s45, s41
    v_mfma_f32_16x16x32_bf16 v[28:31], v[60:63], v[112:115], v[28:31]
    s_lshr_b32 s40, s45, 1
    s_or_b32 s45, s45, s40
    s_lshr_b32 s40, s45, 2
    v_mfma_f32_16x16x32_bf16 v[44:47], v[60:63], v[116:119], v[44:47]
    s_or_b32 s45, s45, s40
    v_cndmask_b32 v11, v8, v208, vcc
    s_waitcnt lgkmcnt(0)
    v_mfma_f32_16x16x32_bf16 v[16:19], v[64:67], v[120:123], v[16:19]
    ds_read_b64_tr_b16 v[48:49], v2 offset:8192
    ds_read_b64_tr_b16 v[50:51], v2 offset:10240
    s_andn2_b32 s45, s46, s45
    v_mfma_f32_16x16x32_bf16 v[32:35], v[64:67], v[124:127], v[32:35]
    ds_read_b64_tr_b16 v[52:53], v3 offset:8192
    ds_read_b64_tr_b16 v[54:55], v3 offset:10240
    s_cselect_b32 s66, s38, 0
    v_mfma_f32_16x16x32_bf16 v[20:23], v[68:71], v[120:123], v[20:23]
    ds_read_b64_tr_b16 v[56:57], v4 offset:8192
    ds_read_b64_tr_b16 v[58:59], v4 offset:10240
    s_ff1_i32_b32 s51, s45
    v_mfma_f32_16x16x32_bf16 v[36:39], v[68:71], v[124:127], v[36:39]
    ds_read_b64_tr_b16 v[60:61], v5 offset:8192
    ds_read_b64_tr_b16 v[62:63], v5 offset:10240
    s_lshl_b32 s53, s51, 10
    v_mfma_f32_16x16x32_bf16 v[24:27], v[72:75], v[120:123], v[24:27]
    s_add_u32 s53, s53, s55
    s_bitset0_b32 s46, s51
    buffer_load_dword v9, v11, s[36:39], s55 offen offset:1008 sc1
    v_mfma_f32_16x16x32_bf16 v[40:43], v[72:75], v[124:127], v[40:43]
    buffer_load_dwordx4 v[112:115], v1, s[64:67], s53 offen offset:0 sc1
    s_lshr_b32 s48, s54, s50
    v_mfma_f32_16x16x32_bf16 v[28:31], v[76:79], v[120:123], v[28:31]
    buffer_load_dwordx4 v[116:119], v6, s[64:67], s53 offen offset:0 sc1
    s_and_b32 s48, s48, 15
    v_mfma_f32_16x16x32_bf16 v[44:47], v[76:79], v[124:127], v[44:47]
    s_lshl_b32 s48, s48, 14
    s_waitcnt lgkmcnt(0)
    v_mfma_f32_16x16x32_bf16 v[16:19], v[48:51], v[128:131], v[16:19]
    ds_read_b64_tr_b16 v[64:65], v2 offset:12288
    ds_read_b64_tr_b16 v[66:67], v2 offset:14336
    v_mfma_f32_16x16x32_bf16 v[32:35], v[48:51], v[132:135], v[32:35]
    ds_read_b64_tr_b16 v[68:69], v3 offset:12288
    ds_read_b64_tr_b16 v[70:71], v3 offset:14336
    v_mfma_f32_16x16x32_bf16 v[20:23], v[52:55], v[128:131], v[20:23]
    ds_read_b64_tr_b16 v[72:73], v4 offset:12288
    ds_read_b64_tr_b16 v[74:75], v4 offset:14336
    v_mfma_f32_16x16x32_bf16 v[36:39], v[52:55], v[132:135], v[36:39]
    ds_read_b64_tr_b16 v[76:77], v5 offset:12288
    ds_read_b64_tr_b16 v[78:79], v5 offset:14336
    v_mfma_f32_16x16x32_bf16 v[24:27], v[56:59], v[128:131], v[24:27]
    buffer_load_dwordx4 v[120:123], v1, s[64:67], s53 offen offset:1024 sc1
    v_add_u32 v2, s48, v207
    v_mfma_f32_16x16x32_bf16 v[40:43], v[56:59], v[132:135], v[40:43]
    buffer_load_dwordx4 v[124:127], v6, s[64:67], s53 offen offset:1024 sc1
    v_xor_b32 v3, 32, v2
    v_mfma_f32_16x16x32_bf16 v[28:31], v[60:63], v[128:131], v[28:31]
    v_xor_b32 v4, 64, v2
    v_xor_b32 v5, 96, v2
    v_mfma_f32_16x16x32_bf16 v[44:47], v[60:63], v[132:135], v[44:47]
    s_waitcnt lgkmcnt(0)
    v_mfma_f32_16x16x32_bf16 v[16:19], v[64:67], v[136:139], v[16:19]
    ds_read_b64_tr_b16 v[48:49], v2 offset:0
    ds_read_b64_tr_b16 v[50:51], v2 offset:2048
    v_mfma_f32_16x16x32_bf16 v[32:35], v[64:67], v[140:143], v[32:35]
    ds_read_b64_tr_b16 v[52:53], v3 offset:0
    ds_read_b64_tr_b16 v[54:55], v3 offset:2048
    v_mfma_f32_16x16x32_bf16 v[20:23], v[68:71], v[136:139], v[20:23]
    ds_read_b64_tr_b16 v[56:57], v4 offset:0
    ds_read_b64_tr_b16 v[58:59], v4 offset:2048
    v_mfma_f32_16x16x32_bf16 v[36:39], v[68:71], v[140:143], v[36:39]
    ds_read_b64_tr_b16 v[60:61], v5 offset:0
    ds_read_b64_tr_b16 v[62:63], v5 offset:2048
    v_mfma_f32_16x16x32_bf16 v[24:27], v[72:75], v[136:139], v[24:27]
    buffer_load_dwordx4 v[128:131], v1, s[64:67], s53 offen offset:2048 sc1
    ds_read_b32 v10, v211
    v_mfma_f32_16x16x32_bf16 v[40:43], v[72:75], v[140:143], v[40:43]
    buffer_load_dwordx4 v[132:135], v6, s[64:67], s53 offen offset:2048 sc1
    v_mfma_f32_16x16x32_bf16 v[28:31], v[76:79], v[136:139], v[28:31]
    v_mfma_f32_16x16x32_bf16 v[44:47], v[76:79], v[140:143], v[44:47]
    buffer_load_dwordx4 v[136:139], v1, s[64:67], s53 offen offset:3072 sc1
    buffer_load_dwordx4 v[140:143], v6, s[64:67], s53 offen offset:3072 sc1
    s_add_u32 s44, s44, 1
    s_cmp_lt_u32 s44, 4
    s_cbranch_scc1 F_GLOOP
    s_add_u32 s57, s56, 65536
    s_waitcnt lgkmcnt(0)
    v_cvt_pk_bf16_f32 v48, v16, v17
    v_cvt_pk_bf16_f32 v49, v18, v19
    v_cvt_pk_bf16_f32 v50, v20, v21
    v_cvt_pk_bf16_f32 v51, v22, v23
    v_cvt_pk_bf16_f32 v52, v24, v25
    v_cvt_pk_bf16_f32 v53, v26, v27
    v_cvt_pk_bf16_f32 v54, v28, v29
    v_cvt_pk_bf16_f32 v55, v30, v31
    v_cvt_pk_bf16_f32 v56, v32, v33
    v_cvt_pk_bf16_f32 v57, v34, v35
    v_cvt_pk_bf16_f32 v58, v36, v37
    v_cvt_pk_bf16_f32 v59, v38, v39
    v_cvt_pk_bf16_f32 v60, v40, v41
    v_cvt_pk_bf16_f32 v61, v42, v43
    v_cvt_pk_bf16_f32 v62, v44, v45
    v_cvt_pk_bf16_f32 v63, v46, v47
    v_permlane16_swap_b32 v48, v50
    v_permlane16_swap_b32 v49, v51
    buffer_store_dwordx4 v[48:51], v210, s[60:63], s56 offen offset:0 sc1
    v_permlane16_swap_b32 v52, v54
    v_permlane16_swap_b32 v53, v55
    buffer_store_dwordx4 v[52:55], v210, s[60:63], s56 offen offset:64 sc1
    v_permlane16_swap_b32 v56, v58
    v_permlane16_swap_b32 v57, v59
    buffer_store_dwordx4 v[56:59], v210, s[60:63], s57 offen offset:0 sc1
    v_permlane16_swap_b32 v60, v62
    v_permlane16_swap_b32 v61, v63
    buffer_store_dwordx4 v[60:63], v210, s[60:63], s57 offen offset:64 sc1
    s_endpgm
F_CNB0:
    ds_write_b32 v204, v14 offset:32
F_WS15:
    ds_read_b32 v15, v209 offset:128
    s_waitcnt lgkmcnt(0)
    v_cmp_ne_u32 vcc, 1, v15
    s_cbranch_vccz F_WS15_X
    s_branch F_WS15
F_WS15_X:
    s_branch F_CB0
F_CNB1:
    ds_write_b32 v204, v14
    s_branch F_CB1
F_GF0:
    s_add_u32 s58, s58, 1
    s_cmp_gt_u32 s58, 400000
    s_cbranch_scc1 F_GK0
    buffer_load_dwordx4 v[80:83], v1, s[36:39], s52 offen offset:0 sc1
    buffer_load_dwordx4 v[84:87], v6, s[36:39], s52 offen offset:0 sc1
    buffer_load_dwordx4 v[88:91], v1, s[36:39], s52 offen offset:1024 sc1
    buffer_load_dwordx4 v[92:95], v6, s[36:39], s52 offen offset:1024 sc1
    buffer_load_dwordx4 v[96:99], v1, s[36:39], s52 offen offset:2048 sc1
    buffer_load_dwordx4 v[100:103], v6, s[36:39], s52 offen offset:2048 sc1
    buffer_load_dwordx4 v[104:107], v1, s[36:39], s52 offen offset:3072 sc1
    buffer_load_dwordx4 v[108:111], v6, s[36:39], s52 offen offset:3072 sc1
    s_waitcnt vmcnt(0)
    s_branch F_GC0
F_GS0:
    s_sleep 4
F_GE0:
    buffer_load_dword v15, v208, s[36:39], s55 offen offset:1008 sc1
    s_add_u32 s58, s58, 1
    s_waitcnt vmcnt(0)
F_GR0:
    ds_read_b32 v7, v211
    v_cmp_eq_u32 vcc, -1, v15
    v_mov_b32 v9, v15
    s_waitcnt lgkmcnt(0)
    v_cmp_ne_u32 s[40:41], 1, v7
    v_mov_b32 v10, v7
    s_or_b32 s45, s40, s41
    s_or_b32 s45, s45, vcc_lo
    s_lshr_b32 s40, s45, 1
    s_or_b32 s45, s45, s40
    s_lshr_b32 s40, s45, 2
    s_or_b32 s45, s45, s40
    s_cmp_gt_u32 s58, 400000
    s_cselect_b32 s45, 0, s45
    s_andn2_b32 s47, s46, s45
    s_cbranch_scc0 F_GS0
    s_and_b32 s45, s46, s47
    s_cselect_b32 s66, s38, 0
    s_ff1_i32_b32 s50, s45
    s_bitset0_b32 s46, s50
    s_lshl_b32 s52, s50, 10
    s_add_u32 s52, s52, s55
    buffer_load_dwordx4 v[80:83], v1, s[36:39], s52 offen offset:0 sc1
    buffer_load_dwordx4 v[84:87], v6, s[36:39], s52 offen offset:0 sc1
    buffer_load_dwordx4 v[88:91], v1, s[36:39], s52 offen offset:1024 sc1
    buffer_load_dwordx4 v[92:95], v6, s[36:39], s52 offen offset:1024 sc1
    buffer_load_dwordx4 v[96:99], v1, s[36:39], s52 offen offset:2048 sc1
    buffer_load_dwordx4 v[100:103], v6, s[36:39], s52 offen offset:2048 sc1
    buffer_load_dwordx4 v[104:107], v1, s[36:39], s52 offen offset:3072 sc1
    buffer_load_dwordx4 v[108:111], v6, s[36:39], s52 offen offset:3072 sc1
    s_lshr_b32 s48, s54, s50
    s_and_b32 s48, s48, 15
    s_lshl_b32 s48, s48, 14
    v_add_u32 v2, s48, v207
    v_xor_b32 v3, 32, v2
    v_xor_b32 v4, 64, v2
    v_xor_b32 v5, 96, v2
    ds_read_b64_tr_b16 v[48:49], v2 offset:0
    ds_read_b64_tr_b16 v[50:51], v2 offset:2048
    ds_read_b64_tr_b16 v[52:53], v3 offset:0
    ds_read_b64_tr_b16 v[54:55], v3 offset:2048
    ds_read_b64_tr_b16 v[56:57], v4 offset:0
    ds_read_b64_tr_b16 v[58:59], v4 offset:2048
    ds_read_b64_tr_b16 v[60:61], v5 offset:0
    ds_read_b64_tr_b16 v[62:63], v5 offset:2048
    s_cmp_lt_i32 s51, 0
    s_cbranch_scc0 F_GN0
    s_and_b32 s45, s46, s47
    s_cselect_b32 s66, s38, 0
    s_ff1_i32_b32 s51, s45
    s_bitset0_b32 s46, s51
    s_lshl_b32 s53, s51, 10
    s_add_u32 s53, s53, s55
    buffer_load_dwordx4 v[112:115], v1, s[64:67], s53 offen offset:0 sc1
    buffer_load_dwordx4 v[116:119], v6, s[64:67], s53 offen offset:0 sc1
    buffer_load_dwordx4 v[120:123], v1, s[64:67], s53 offen offset:1024 sc1
    buffer_load_dwordx4 v[124:127], v6, s[64:67], s53 offen offset:1024 sc1
    buffer_load_dwordx4 v[128:131], v1, s[64:67], s53 offen offset:2048 sc1
    buffer_load_dwordx4 v[132:135], v6, s[64:67], s53 offen offset:2048 sc1
    buffer_load_dwordx4 v[136:139], v1, s[64:67], s53 offen offset:3072 sc1
    buffer_load_dwordx4 v[140:143], v6, s[64:67], s53 offen offset:3072 sc1
    s_waitcnt vmcnt(8)
    s_branch F_GC0
F_GN0:
    s_waitcnt vmcnt(0)
    s_branch F_GC0
F_GF1:
    s_add_u32 s58, s58, 1
    s_cmp_gt_u32 s58, 400000
    s_cbranch_scc1 F_GK1
    buffer_load_dwordx4 v[112:115], v1, s[36:39], s53 offen offset:0 sc1
    buffer_load_dwordx4 v[116:119], v6, s[36:39], s53 offen offset:0 sc1
    buffer_load_dwordx4 v[120:123], v1, s[36:39], s53 offen offset:1024 sc1
    buffer_load_dwordx4 v[124:127], v6, s[36:39], s53 offen offset:1024 sc1
    buffer_load_dwordx4 v[128:131], v1, s[36:39], s53 offen offset:2048 sc1
    buffer_load_dwordx4 v[132:135], v6, s[36:39], s53 offen offset:2048 sc1
    buffer_load_dwordx4 v[136:139], v1, s[36:39], s53 offen offset:3072 sc1
    buffer_load_dwordx4 v[140:143], v6, s[36:39], s53 offen offset:3072 sc1
    s_waitcnt vmcnt(0)
    s_branch F_GC1
F_GS1:
    s_sleep 4
F_GE1:
    buffer_load_dword v15, v208, s[36:39], s55 offen offset:1008 sc1
    s_add_u32 s58, s58, 1
    s_waitcnt vmcnt(0)
F_GR1:
    ds_read_b32 v7, v211
    v_cmp_eq_u32 vcc, -1, v15
    v_mov_b32 v9, v15
    s_waitcnt lgkmcnt(0)
    v_cmp_ne_u32 s[40:41], 1, v7
    v_mov_b32 v10, v7
    s_or_b32 s45, s40, s41
    s_or_b32 s45, s45, vcc_lo
    s_lshr_b32 s40, s45, 1
    s_or_b32 s45, s45, s40
    s_lshr_b32 s40, s45, 2
    s_or_b32 s45, s45, s40
    s_cmp_gt_u32 s58, 400000
    s_cselect_b32 s45, 0, s45
    s_andn2_b32 s47, s46, s45
    s_cbranch_scc0 F_GS1
    s_and_b32 s45, s46, s47
    s_cselect_b32 s66, s38, 0
    s_ff1_i32_b32 s51, s45
    s_bitset0_b32 s46, s51
    s_lshl_b32 s53, s51, 10
    s_add_u32 s53, s53, s55
    buffer_load_dwordx4 v[112:115], v1, s[36:39], s53 offen offset:0 sc1
    buffer_load_dwordx4 v[116:119], v6, s[36:39], s53 offen offset:0 sc1
    buffer_load_dwordx4 v[120:123], v1, s[36:39], s53 offen offset:1024 sc1
    buffer_load_dwordx4 v[124:127], v6, s[36:39], s53 offen offset:1024 sc1
    buffer_load_dwordx4 v[128:131], v1, s[36:39], s53 offen offset:2048 sc1
    buffer_load_dwordx4 v[132:135], v6, s[36:39], s53 offen offset:2048 sc1
    buffer_load_dwordx4 v[136:139], v1, s[36:39], s53 offen offset:3072 sc1
    buffer_load_dwordx4 v[140:143], v6, s[36:39], s53 offen offset:3072 sc1
    s_lshr_b32 s48, s54, s51
    s_and_b32 s48, s48, 15
    s_lshl_b32 s48, s48, 14
    v_add_u32 v2, s48, v207
    v_xor_b32 v3, 32, v2
    v_xor_b32 v4, 64, v2
    v_xor_b32 v5, 96, v2
    ds_read_b64_tr_b16 v[48:49], v2 offset:0
    ds_read_b64_tr_b16 v[50:51], v2 offset:2048
    ds_read_b64_tr_b16 v[52:53], v3 offset:0
    ds_read_b64_tr_b16 v[54:55], v3 offset:2048
    ds_read_b64_tr_b16 v[56:57], v4 offset:0
    ds_read_b64_tr_b16 v[58:59], v4 offset:2048
    ds_read_b64_tr_b16 v[60:61], v5 offset:0
    ds_read_b64_tr_b16 v[62:63], v5 offset:2048
    s_cmp_lt_i32 s50, 0
    s_cbranch_scc0 F_GN1
    s_and_b32 s45, s46, s47
    s_cselect_b32 s66, s38, 0
    s_ff1_i32_b32 s50, s45
    s_bitset0_b32 s46, s50
    s_lshl_b32 s52, s50, 10
    s_add_u32 s52, s52, s55
    buffer_load_dwordx4 v[80:83], v1, s[64:67], s52 offen offset:0 sc1
    buffer_load_dwordx4 v[84:87], v6, s[64:67], s52 offen offset:0 sc1
    buffer_load_dwordx4 v[88:91], v1, s[64:67], s52 offen offset:1024 sc1
    buffer_load_dwordx4 v[92:95], v6, s[64:67], s52 offen offset:1024 sc1
    buffer_load_dwordx4 v[96:99], v1, s[64:67], s52 offen offset:2048 sc1
    buffer_load_dwordx4 v[100:103], v6, s[64:67], s52 offen offset:2048 sc1
    buffer_load_dwordx4 v[104:107], v1, s[64:67], s52 offen offset:3072 sc1
    buffer_load_dwordx4 v[108:111], v6, s[64:67], s52 offen offset:3072 sc1
    s_waitcnt vmcnt(8)
    s_branch F_GC1
F_GN1:
    s_waitcnt vmcnt(0)
    s_branch F_GC1
F_END:
    s_endpgm

.section .rodata,"a"
.p2align 6
.amdhsa_kernel concat_heads__linear_attn_block__ssm_conv_h3__prompt_kernel
  .amdhsa_next_free_vgpr 256
  .amdhsa_next_free_sgpr 102
  .amdhsa_accum_offset 256
  .amdhsa_group_segment_fixed_size 0
  .amdhsa_kernarg_size 96
  .amdhsa_user_sgpr_count 2
  .amdhsa_user_sgpr_kernarg_segment_ptr 1
  .amdhsa_system_sgpr_workgroup_id_x 1
  .amdhsa_float_denorm_mode_32 3
  .amdhsa_float_denorm_mode_16_64 3
.end_amdhsa_kernel
```

```asm
; @launch grid=(256,1,1) block=(512,1,1) lds=163840
.amdgcn_target "amdgcn-amd-amdhsa--gfx950"
.text
.globl concat_heads__linear_attn_block__ssm_conv_h3__prompt_kernel
.p2align 8
.type concat_heads__linear_attn_block__ssm_conv_h3__prompt_kernel,@function
concat_heads__linear_attn_block__ssm_conv_h3__prompt_kernel:
    s_load_dwordx16 s[4:19], s[0:1], 0
    s_cmp_ge_u32 s2, 256
    s_cbranch_scc1 F_END
    v_lshrrev_b32 v1, 6, v0
    v_and_b32 v0, 63, v0
    s_and_b32 s28, s2, 7
    s_lshr_b32 s29, s2, 3
    v_readfirstlane_b32 s3, v1
    s_and_b32 s30, s28, 1
    s_lshl_b32 s30, s30, 3
    s_and_b32 s31, s29, 7
    s_add_u32 s30, s30, s31
    s_lshr_b32 s31, s28, 1
    s_lshl_b32 s31, s31, 2
    s_lshr_b32 s32, s29, 3
    s_add_u32 s31, s31, s32
    s_lshr_b32 s30, s29, 1
    s_and_b32 s31, s29, 1
    s_lshl_b32 s32, s28, 1
    s_add_u32 s31, s31, s32
    s_cmp_lt_u32 s3, 4
    s_cbranch_scc1 F_C
    s_sub_u32 s34, s3, 4
    v_lshrrev_b32 v2, 3, v0
    v_and_b32 v4, 7, v0
    s_getpc_b64 s[66:67]
F_PC:
    s_lshl_b32 s40, s29, 10
    s_lshl_b32 s41, s34, 8
    s_add_u32 s40, s40, s41
    v_and_b32 v7, 1, v0
    v_lshlrev_b32 v7, 7, v7
    v_add_u32 v7, s40, v7
    v_min_u32 v7, F_END-F_PC, v7
    global_load_dword v250, v7, s[66:67]
    v_lshlrev_b32 v8, 11, v4
    v_and_b32 v9, 15, v0
    v_min_u32 v9, 11, v9
    v_lshrrev_b32 v7, 2, v9
    v_and_b32 v9, 3, v9
    v_lshlrev_b32 v9, 7, v9
    v_lshl_add_u32 v9, v7, 11, v9
    s_and_b32 s100, s28, 1
    s_lshr_b32 s101, s28, 1
    s_lshl_b32 s40, s100, 21
    s_lshl_b32 s41, s101, 19
    s_add_u32 s99, s40, s41
    s_lshl_b32 s40, s29, 14
    s_lshl_b32 s41, s34, 7
    s_add_u32 s42, s40, s41
    s_add_u32 s42, s42, s99
    s_mul_i32 s98, s100, 6144
    s_lshl_b32 s41, s101, 9
    s_add_u32 s98, s98, s41
    s_lshl_b32 s43, s29, 2
    s_add_u32 s43, s43, s34
    s_mul_i32 s43, s43, 12288
    s_add_u32 s43, s43, s98
    v_min_u32 v9, 5, v4
    v_lshrrev_b32 v7, 1, v9
    v_and_b32 v9, 1, v9
    v_lshlrev_b32 v9, 7, v9
    v_lshl_add_u32 v19, v7, 11, v9
    v_and_b32 v7, 1, v2
    v_mul_u32_u24 v7, 6144, v7
    v_add_u32 v9, v19, v7
    s_lshl_b32 s98, s28, 8
    s_lshl_b32 s43, s29, 2
    s_add_u32 s43, s43, s34
    s_mul_i32 s43, s43, 12288
    s_add_u32 s43, s43, s98
    s_mov_b32 s46, 0x400000
    s_mov_b32 s47, 0x00020000
    s_mov_b32 s50, 0x600000
    s_mov_b32 s51, 0x00020000
    s_lshl_b32 s40, s34, 3
    v_add_u32 v3, s40, v2
    v_lshrrev_b32 v5, 4, v0
    s_and_b32 s40, s34, 1
    s_lshl_b32 s41, s40, 2
    v_add_u32 v6, s41, v5
    v_xor_b32 v6, v6, v4
    v_lshlrev_b32 v6, 4, v6
    v_lshl_add_u32 v10, v3, 11, v6
    v_and_b32 v6, 1, v5
    v_lshlrev_b32 v6, 1, v6
    v_or_b32 v6, s41, v6
    v_xor_b32 v6, v6, v4
    v_lshlrev_b32 v6, 4, v6
    v_mul_u32_u24 v11, 6144, v3
    v_add_u32 v11, v11, v6
    s_lshl_b32 s52, s30, 18
    s_add_u32 s53, s52, 64512
    s_add_u32 s54, s52, 129024
    s_add_u32 s55, s52, 193536
    s_lshl_b32 s56, s31, 7
    s_add_u32 s57, s56, 1024
    s_add_u32 s58, s56, 2048
    s_add_u32 s59, s56, 193536
    s_add_u32 s60, s56, 198656
    s_add_u32 s61, s56, 199680
    s_mul_i32 s62, s34, 10240
    s_mov_b32 s63, 393216
    s_waitcnt lgkmcnt(0)
    s_mov_b64 s[44:45], s[4:5]
    s_mov_b64 s[48:49], s[6:7]
    buffer_load_dword v250, v9, s[48:51], s43 offen
    buffer_load_dword v250, v8, s[44:47], s42 offen
    s_add_u32 m0, s62, 45056
    s_nop 0
    buffer_load_dwordx4 v11, s[48:51], s57 offen offset:1024 lds
    buffer_load_dwordx4 v11, s[48:51], s58 offen offset:2048 lds
    buffer_load_dwordx4 v11, s[48:51], s56 offen offset:0 lds
    buffer_load_dwordx4 v11, s[48:51], s59 offen offset:3072 lds
    s_add_u32 m0, s62, 40960
    s_nop 0
    buffer_load_dwordx4 v10, s[44:47], s52 offen offset:0 lds
    buffer_load_dwordx4 v10, s[44:47], s53 offen offset:1024 lds
    buffer_load_dwordx4 v10, s[44:47], s54 offen offset:2048 lds
    buffer_load_dwordx4 v10, s[44:47], s55 offen offset:3072 lds
    s_add_u32 m0, s62, 49152
    s_nop 0
    buffer_load_dwordx4 v11, s[48:51], s60 offen offset:0 lds
    buffer_load_dwordx4 v11, s[48:51], s61 offen offset:1024 lds
    v_add_u32 v10, 128, v10
    v_add_u32 v11, s63, v11
    s_add_u32 m0, s62, 86016
    s_nop 0
    buffer_load_dwordx4 v11, s[48:51], s57 offen offset:1024 lds
    buffer_load_dwordx4 v11, s[48:51], s58 offen offset:2048 lds
    buffer_load_dwordx4 v11, s[48:51], s56 offen offset:0 lds
    buffer_load_dwordx4 v11, s[48:51], s59 offen offset:3072 lds
    s_add_u32 m0, s62, 81920
    s_nop 0
    buffer_load_dwordx4 v10, s[44:47], s52 offen offset:0 lds
    buffer_load_dwordx4 v10, s[44:47], s53 offen offset:1024 lds
    buffer_load_dwordx4 v10, s[44:47], s54 offen offset:2048 lds
    buffer_load_dwordx4 v10, s[44:47], s55 offen offset:3072 lds
    s_add_u32 m0, s62, 90112
    s_nop 0
    buffer_load_dwordx4 v11, s[48:51], s60 offen offset:0 lds
    buffer_load_dwordx4 v11, s[48:51], s61 offen offset:1024 lds
    v_add_u32 v10, 128, v10
    v_add_u32 v11, s63, v11
    s_load_dwordx8 s[20:27], s[0:1], 64
    s_and_b32 s32, s29, 3
    s_lshr_b32 s33, s28, 1
    s_lshl_b32 s33, s33, 2
    s_add_u32 s32, s32, s33
    s_and_b32 s33, s28, 1
    s_lshl_b32 s33, s33, 3
    s_lshr_b32 s35, s29, 2
    s_add_u32 s33, s33, s35
    v_lshlrev_b32 v1, 4, v0
    v_lshlrev_b32 v6, 1, v5
    v_xor_b32 v6, v6, v4
    v_lshlrev_b32 v6, 4, v6
    v_lshl_add_u32 v12, v2, 11, v6
    v_mov_b32 v13, 0
    s_lshr_b32 s35, s29, 4
    s_lshl_b32 s35, s35, 3
    s_add_u32 s35, s35, s28
    s_lshl_b32 s35, s35, 4
    s_and_b32 s40, s29, 15
    s_add_u32 s35, s35, s40
    s_mov_b32 s35, s2
    s_lshl_b32 s35, s35, 2
    s_add_u32 s35, s35, s34
    s_and_b32 s96, s29, 3
    s_waitcnt lgkmcnt(0)
    s_mov_b32 s36, s26
    s_mov_b32 s37, s27
    s_mov_b32 s38, 0x10000000
    s_mov_b32 s39, 0x00020000
    s_mov_b32 s64, s24
    s_mov_b32 s65, s25
    s_mov_b32 s66, 0x100
    s_mov_b32 s67, 0x00020000
    s_lshr_b32 s69, s29, 2
    s_mul_i32 s40, s96, 3
    s_add_u32 s40, s40, 4
    s_add_u32 s41, s40, s34
    s_lshl_b32 s41, s41, 7
    s_add_u32 s99, s99, s41
    s_lshl_b32 s41, s69, 16
    s_add_u32 s99, s99, s41
    s_lshl_b32 s40, s40, 5
    s_mul_i32 s41, s69, 12
    s_add_u32 s40, s40, s41
    s_lshl_b32 s41, s34, 2
    s_add_u32 s40, s40, s41
    s_mul_i32 s40, s40, 12288
    s_add_u32 s98, s98, s40
    s_lshl_b32 s100, s100, 10
    s_lshl_b32 s101, s101, 19
    s_add_u32 s100, s100, s101
    s_lshl_b32 s41, s29, 14
    s_add_u32 s100, s100, s41
    v_and_b32 v16, 31, v0
    v_lshlrev_b32 v16, 11, v16
    v_mul_u32_u24 v17, 6144, v2
    v_add_u32 v17, v17, v19
    v_lshlrev_b32 v18, 7, v4
    v_lshl_add_u32 v18, v2, 11, v18
    s_add_u32 s40, s2, s34
    s_cmp_lg_u32 s40, 0
    s_cbranch_scc1 F_NOTOK
    s_memrealtime s[68:69]
    s_waitcnt lgkmcnt(0)
    s_or_b32 s68, s68, 1
    v_mov_b32 v14, s68
    s_mov_b64 exec, 1
    buffer_store_dword v14, v13, s[64:67], 0 offen sc1
    s_mov_b64 exec, -1
F_NOTOK:
    s_cmp_lg_u32 s96, 0
    s_cbranch_scc1 F_PF0X
    s_cmp_eq_u32 s34, 3
    s_cbranch_scc1 F_PF0X
    buffer_load_dword v250, v17, s[48:51], s98 offen
    buffer_load_dword v250, v16, s[44:47], s99 offen
F_PF0X:
    s_cmp_lg_u32 s96, 0
    s_cbranch_scc1 F_PW0X
    s_cmp_lg_u32 s34, 3
    s_cbranch_scc1 F_PW0X
    s_mov_b32 s40, s8
    s_mov_b32 s41, s9
    s_mov_b32 s42, 0x200000
    s_mov_b32 s43, 0x00020000
    buffer_load_dword v250, v18, s[40:43], s100 offen
F_PW0X:
    s_lshl_b32 s40, s34, 1
    v_xor_b32 v20, s40, v4
    v_lshlrev_b32 v20, 4, v20
    v_lshl_add_u32 v20, v2, 11, v20
    s_lshr_b32 s40, s2, 4
    s_lshl_b32 s40, s40, 18
    s_and_b32 s41, s2, 15
    s_lshl_b32 s41, s41, 7
    s_add_u32 s40, s40, s41
    v_xor_b32 v21, 6, v4
    v_lshlrev_b32 v21, 4, v21
    v_lshl_add_u32 v21, v2, 11, v21
    v_add_u32 v21, s40, v21
    v_subrev_u32 v21, 6144, v21
    s_lshl_b32 s41, s34, 15
    s_add_u32 s40, s40, s41
    v_add_u32 v20, s40, v20
    v_and_b32 v22, 3, v2
    v_xor_b32 v22, s34, v22
    v_lshlrev_b32 v22, 5, v22
    v_lshl_add_u32 v22, v4, 2, v22
    v_lshl_add_u32 v22, v2, 11, v22
    v_add_u32 v22, 123264, v22
    v_add_u32 v23, 3, v2
    v_and_b32 v23, 3, v23
    v_xor_b32 v23, s34, v23
    v_lshlrev_b32 v23, 5, v23
    v_lshl_add_u32 v23, v4, 2, v23
    v_lshl_add_u32 v23, v2, 11, v23
    v_add_u32 v23, 122880, v23
    s_and_b32 s40, s2, 15
    s_lshl_b32 s40, s40, 6
    s_lshl_b32 s41, s34, 4
    s_add_u32 s40, s40, s41
    v_lshlrev_b32 v24, 1, v4
    v_add_u32 v24, s40, v24
    v_mul_u32_u24 v25, 4224, v24
    v_lshlrev_b32 v24, 3, v24
    s_lshr_b32 s40, s2, 4
    s_lshl_b32 s40, s40, 3
    v_add_u32 v26, s40, v2
    v_lshl_add_u32 v25, v26, 4, v25
    s_lshr_b32 s40, s2, 4
    s_lshl_b32 s40, s40, 4
    s_lshl_b32 s41, s34, 3
    s_add_u32 s40, s40, s41
    v_add_u32 v28, s40, v2
    v_mul_u32_u24 v232, 33792, v4
    v_lshl_add_u32 v232, v28, 4, v232
    v_lshrrev_b32 v29, 6, v28
    v_lshlrev_b32 v29, 9, v29
    v_and_b32 v30, 15, v28
    v_lshl_add_u32 v29, v30, 4, v29
    v_bfe_u32 v30, v28, 4, 2
    v_lshl_add_u32 v29, v30, 2, v29
    v_lshlrev_b32 v30, 4, v4
    v_lshl_add_u32 v234, v29, 11, v30
    v_lshl_add_u32 v233, v29, 12, v30
    s_waitcnt vmcnt(10)
    s_barrier
    s_add_u32 m0, s62, 4096
    s_nop 0
    buffer_load_dwordx4 v11, s[48:51], s57 offen offset:1024 lds
    buffer_load_dwordx4 v11, s[48:51], s58 offen offset:2048 lds
    buffer_load_dwordx4 v11, s[48:51], s56 offen offset:0 lds
    buffer_load_dwordx4 v11, s[48:51], s59 offen offset:3072 lds
    s_add_u32 m0, s62, 0
    s_nop 0
    buffer_load_dwordx4 v10, s[44:47], s52 offen offset:0 lds
    buffer_load_dwordx4 v10, s[44:47], s53 offen offset:1024 lds
    buffer_load_dwordx4 v10, s[44:47], s54 offen offset:2048 lds
    buffer_load_dwordx4 v10, s[44:47], s55 offen offset:3072 lds
    s_add_u32 m0, s62, 8192
    s_nop 0
    buffer_load_dwordx4 v11, s[48:51], s60 offen offset:0 lds
    buffer_load_dwordx4 v11, s[48:51], s61 offen offset:1024 lds
    s_cmp_lg_u32 s96, 2
    s_cbranch_scc1 F_KV2X
    s_lshl_b32 s69, s34, 11
    s_mov_b32 s40, s12
    s_mov_b32 s41, s13
    s_mov_b32 s42, 0x400000
    s_mov_b32 s43, 0x00020000
    s_mov_b32 m0, 122880
    s_mov_b64 exec, 0xffffff
    buffer_load_dwordx4 v21, s[40:43], 0 offen nt lds
    s_mov_b64 exec, -1
    s_add_u32 m0, s69, 123264
    s_mov_b32 s97, 0
    buffer_load_dwordx4 v20, s[40:43], s97 offen nt lds
    s_mov_b32 s97, 15360
    buffer_load_dwordx4 v20, s[40:43], s97 offen offset:1024 nt lds
    s_add_u32 m0, s69, 131456
    s_mov_b32 s97, 131072
    buffer_load_dwordx4 v20, s[40:43], s97 offen nt lds
    s_mov_b32 s97, 146432
    buffer_load_dwordx4 v20, s[40:43], s97 offen offset:1024 nt lds
    s_mov_b32 s40, s14
    s_mov_b32 s41, s15
    s_mov_b32 s42, 0x400000
    s_mov_b32 s43, 0x00020000
    s_add_u32 m0, s69, 139648
    s_mov_b32 s97, 0
    buffer_load_dwordx4 v20, s[40:43], s97 offen nt lds
    s_mov_b32 s97, 15360
    buffer_load_dwordx4 v20, s[40:43], s97 offen offset:1024 nt lds
    s_add_u32 m0, s69, 147840
    s_mov_b32 s97, 131072
    buffer_load_dwordx4 v20, s[40:43], s97 offen nt lds
    s_mov_b32 s97, 146432
    buffer_load_dwordx4 v20, s[40:43], s97 offen offset:1024 nt lds
    s_mov_b32 s40, s16
    s_mov_b32 s41, s17
    s_mov_b32 s42, 0x2000
    s_mov_b32 s43, 0x00020000
    buffer_load_dwordx4 v[32:35], v24, s[40:43], 0 offen
F_KV2X:
    v_add_u32 v10, 128, v10
    v_add_u32 v11, s63, v11
    s_cmp_lg_u32 s96, 2
    s_cbranch_scc1 F_Q2X
    s_cmp_ge_u32 s34, 2
    s_cbranch_scc1 F_Q2X
    s_mov_b32 s40, s10
    s_mov_b32 s41, s11
    s_mov_b32 s42, 0x400000
    s_mov_b32 s43, 0x00020000
    s_and_b32 s69, s2, 15
    s_lshl_b32 s69, s69, 7
    s_add_u32 s97, s69, 0
    buffer_load_dwordx4 v[200:203], v234, s[40:43], s97 offen offset:0 nt
    s_add_u32 s97, s69, 0
    buffer_load_dwordx4 v[204:207], v234, s[40:43], s97 offen offset:2048 nt
    s_add_u32 s97, s69, 4096
    buffer_load_dwordx4 v[208:211], v234, s[40:43], s97 offen offset:0 nt
    s_add_u32 s97, s69, 4096
    buffer_load_dwordx4 v[212:215], v234, s[40:43], s97 offen offset:2048 nt
    s_add_u32 s97, s69, 524288
    buffer_load_dwordx4 v[216:219], v234, s[40:43], s97 offen offset:0 nt
    s_add_u32 s97, s69, 524288
    buffer_load_dwordx4 v[220:223], v234, s[40:43], s97 offen offset:2048 nt
    s_add_u32 s97, s69, 528384
    buffer_load_dwordx4 v[224:227], v234, s[40:43], s97 offen offset:0 nt
    s_add_u32 s97, s69, 528384
    buffer_load_dwordx4 v[228:231], v234, s[40:43], s97 offen offset:2048 nt
F_Q2X:
    s_waitcnt vmcnt(10)
    s_barrier
    s_add_u32 m0, s62, 45056
    s_nop 0
    buffer_load_dwordx4 v11, s[48:51], s57 offen offset:1024 lds
    buffer_load_dwordx4 v11, s[48:51], s58 offen offset:2048 lds
    buffer_load_dwordx4 v11, s[48:51], s56 offen offset:0 lds
    buffer_load_dwordx4 v11, s[48:51], s59 offen offset:3072 lds
    s_cmp_lg_u32 s96, 1
    s_cbranch_scc1 F_PF1X
    s_cmp_eq_u32 s34, 3
    s_cbranch_scc1 F_PF1X
    buffer_load_dword v250, v17, s[48:51], s98 offen
    buffer_load_dword v250, v16, s[44:47], s99 offen
F_PF1X:
    s_cmp_lg_u32 s96, 1
    s_cbranch_scc1 F_PW1X
    s_cmp_lg_u32 s34, 3
    s_cbranch_scc1 F_PW1X
    s_mov_b32 s40, s8
    s_mov_b32 s41, s9
    s_mov_b32 s42, 0x200000
    s_mov_b32 s43, 0x00020000
    buffer_load_dword v250, v18, s[40:43], s100 offen
F_PW1X:
    s_add_u32 m0, s62, 40960
    s_nop 0
    buffer_load_dwordx4 v10, s[44:47], s52 offen offset:0 lds
    buffer_load_dwordx4 v10, s[44:47], s53 offen offset:1024 lds
    buffer_load_dwordx4 v10, s[44:47], s54 offen offset:2048 lds
    buffer_load_dwordx4 v10, s[44:47], s55 offen offset:3072 lds
    s_and_b32 s40, s34, 1
    s_lshl_b32 s41, s31, 1
    s_add_u32 s40, s40, s41
    s_lshr_b32 s41, s34, 1
    s_lshl_b32 s6, s30, 1
    s_add_u32 s6, s6, s41
    s_mul_i32 s6, s6, 132
    s_add_u32 s6, s6, s40
    s_lshl_b32 s6, s6, 10
    s_add_u32 s6, s6, 0x200000
    s_lshl_b32 s4, s40, 15
    s_lshl_b32 s5, s41, 10
    s_add_u32 s7, s4, s5
    s_lshl_b32 s4, s30, 11
    s_add_u32 s4, s4, s7
    s_lshl_b32 s40, s40, 11
    s_add_u32 s69, s40, s5
    s_add_u32 s69, s69, 0x100000
    s_lshl_b32 s5, s30, 6
    s_add_u32 s5, s5, s69
    v_mov_b32 v112, -1
    s_add_u32 m0, s62, 49152
    s_nop 0
    buffer_load_dwordx4 v11, s[48:51], s60 offen offset:0 lds
    v_mov_b32 v113, -1
    v_mov_b32 v114, -1
    buffer_load_dwordx4 v11, s[48:51], s61 offen offset:1024 lds
    v_mov_b32 v115, -1
    v_lshlrev_b32 v27, 4, v5
    v_add_u32 v10, 128, v10
    v_add_u32 v11, s63, v11
    s_mov_b32 s7, 0xffff0000
    s_cmp_lg_u32 s96, 3
    s_cbranch_scc1 F_KV3X
    s_lshl_b32 s69, s34, 11
    s_mov_b32 s40, s12
    s_mov_b32 s41, s13
    s_mov_b32 s42, 0x400000
    s_mov_b32 s43, 0x00020000
    s_mov_b32 m0, 122880
    s_mov_b64 exec, 0xffffff
    buffer_load_dwordx4 v21, s[40:43], 0 offen nt lds
    s_mov_b64 exec, -1
    s_add_u32 m0, s69, 123264
    s_mov_b32 s97, 0
    buffer_load_dwordx4 v20, s[40:43], s97 offen nt lds
    s_mov_b32 s97, 15360
    buffer_load_dwordx4 v20, s[40:43], s97 offen offset:1024 nt lds
    s_add_u32 m0, s69, 131456
    s_mov_b32 s97, 131072
    buffer_load_dwordx4 v20, s[40:43], s97 offen nt lds
    s_mov_b32 s97, 146432
    buffer_load_dwordx4 v20, s[40:43], s97 offen offset:1024 nt lds
    s_mov_b32 s40, s14
    s_mov_b32 s41, s15
    s_mov_b32 s42, 0x400000
    s_mov_b32 s43, 0x00020000
    s_add_u32 m0, s69, 139648
    s_mov_b32 s97, 0
    buffer_load_dwordx4 v20, s[40:43], s97 offen nt lds
    s_mov_b32 s97, 15360
    buffer_load_dwordx4 v20, s[40:43], s97 offen offset:1024 nt lds
    s_add_u32 m0, s69, 147840
    s_mov_b32 s97, 131072
    buffer_load_dwordx4 v20, s[40:43], s97 offen nt lds
    s_mov_b32 s97, 146432
    buffer_load_dwordx4 v20, s[40:43], s97 offen offset:1024 nt lds
    s_mov_b32 s40, s16
    s_mov_b32 s41, s17
    s_mov_b32 s42, 0x2000
    s_mov_b32 s43, 0x00020000
    buffer_load_dwordx4 v[32:35], v24, s[40:43], 0 offen
F_KV3X:
    s_cmp_lg_u32 s96, 3
    s_cbranch_scc1 F_Q3X
    s_cmp_ge_u32 s34, 2
    s_cbranch_scc1 F_Q3X
    s_mov_b32 s40, s10
    s_mov_b32 s41, s11
    s_mov_b32 s42, 0x400000
    s_mov_b32 s43, 0x00020000
    s_and_b32 s69, s2, 15
    s_lshl_b32 s69, s69, 7
    s_add_u32 s97, s69, 0
    buffer_load_dwordx4 v[200:203], v234, s[40:43], s97 offen offset:0 nt
    s_add_u32 s97, s69, 0
    buffer_load_dwordx4 v[204:207], v234, s[40:43], s97 offen offset:2048 nt
    s_add_u32 s97, s69, 4096
    buffer_load_dwordx4 v[208:211], v234, s[40:43], s97 offen offset:0 nt
    s_add_u32 s97, s69, 4096
    buffer_load_dwordx4 v[212:215], v234, s[40:43], s97 offen offset:2048 nt
    s_add_u32 s97, s69, 524288
    buffer_load_dwordx4 v[216:219], v234, s[40:43], s97 offen offset:0 nt
    s_add_u32 s97, s69, 524288
    buffer_load_dwordx4 v[220:223], v234, s[40:43], s97 offen offset:2048 nt
    s_add_u32 s97, s69, 528384
    buffer_load_dwordx4 v[224:227], v234, s[40:43], s97 offen offset:0 nt
    s_add_u32 s97, s69, 528384
    buffer_load_dwordx4 v[228:231], v234, s[40:43], s97 offen offset:2048 nt
F_Q3X:
    s_waitcnt vmcnt(10)
    s_barrier
    s_add_u32 m0, s62, 86016
    s_nop 0
    buffer_load_dwordx4 v11, s[48:51], s57 offen offset:1024 lds
    buffer_load_dwordx4 v11, s[48:51], s58 offen offset:2048 lds
    buffer_load_dwordx4 v11, s[48:51], s56 offen offset:0 lds
    buffer_load_dwordx4 v11, s[48:51], s59 offen offset:3072 lds
    s_add_u32 m0, s62, 81920
    s_nop 0
    buffer_load_dwordx4 v10, s[44:47], s52 offen offset:0 lds
    buffer_load_dwordx4 v10, s[44:47], s53 offen offset:1024 lds
    buffer_load_dwordx4 v10, s[44:47], s54 offen offset:2048 lds
    buffer_load_dwordx4 v10, s[44:47], s55 offen offset:3072 lds
    s_cmp_lg_u32 s96, 0
    s_cbranch_scc1 F_KV0X
    s_lshl_b32 s69, s34, 11
    s_mov_b32 s40, s12
    s_mov_b32 s41, s13
    s_mov_b32 s42, 0x400000
    s_mov_b32 s43, 0x00020000
    s_mov_b32 m0, 122880
    s_mov_b64 exec, 0xffffff
    buffer_load_dwordx4 v21, s[40:43], 0 offen nt lds
    s_mov_b64 exec, -1
    s_add_u32 m0, s69, 123264
    s_mov_b32 s97, 0
    buffer_load_dwordx4 v20, s[40:43], s97 offen nt lds
    s_mov_b32 s97, 15360
    buffer_load_dwordx4 v20, s[40:43], s97 offen offset:1024 nt lds
    s_add_u32 m0, s69, 131456
    s_mov_b32 s97, 131072
    buffer_load_dwordx4 v20, s[40:43], s97 offen nt lds
    s_mov_b32 s97, 146432
    buffer_load_dwordx4 v20, s[40:43], s97 offen offset:1024 nt lds
    s_mov_b32 s40, s14
    s_mov_b32 s41, s15
    s_mov_b32 s42, 0x400000
    s_mov_b32 s43, 0x00020000
    s_add_u32 m0, s69, 139648
    s_mov_b32 s97, 0
    buffer_load_dwordx4 v20, s[40:43], s97 offen nt lds
    s_mov_b32 s97, 15360
    buffer_load_dwordx4 v20, s[40:43], s97 offen offset:1024 nt lds
    s_add_u32 m0, s69, 147840
    s_mov_b32 s97, 131072
    buffer_load_dwordx4 v20, s[40:43], s97 offen nt lds
    s_mov_b32 s97, 146432
    buffer_load_dwordx4 v20, s[40:43], s97 offen offset:1024 nt lds
    s_mov_b32 s40, s16
    s_mov_b32 s41, s17
    s_mov_b32 s42, 0x2000
    s_mov_b32 s43, 0x00020000
    buffer_load_dwordx4 v[32:35], v24, s[40:43], 0 offen
F_KV0X:
    s_add_u32 m0, s62, 90112
    s_nop 0
    buffer_load_dwordx4 v11, s[48:51], s60 offen offset:0 lds
    buffer_load_dwordx4 v11, s[48:51], s61 offen offset:1024 lds
    s_cmp_lg_u32 s96, 1
    s_cbranch_scc1 F_KV1X
    s_lshl_b32 s69, s34, 11
    s_mov_b32 s40, s12
    s_mov_b32 s41, s13
    s_mov_b32 s42, 0x400000
    s_mov_b32 s43, 0x00020000
    s_mov_b32 m0, 122880
    s_mov_b64 exec, 0xffffff
    buffer_load_dwordx4 v21, s[40:43], 0 offen nt lds
    s_mov_b64 exec, -1
    s_add_u32 m0, s69, 123264
    s_mov_b32 s97, 0
    buffer_load_dwordx4 v20, s[40:43], s97 offen nt lds
    s_mov_b32 s97, 15360
    buffer_load_dwordx4 v20, s[40:43], s97 offen offset:1024 nt lds
    s_add_u32 m0, s69, 131456
    s_mov_b32 s97, 131072
    buffer_load_dwordx4 v20, s[40:43], s97 offen nt lds
    s_mov_b32 s97, 146432
    buffer_load_dwordx4 v20, s[40:43], s97 offen offset:1024 nt lds
    s_mov_b32 s40, s14
    s_mov_b32 s41, s15
    s_mov_b32 s42, 0x400000
    s_mov_b32 s43, 0x00020000
    s_add_u32 m0, s69, 139648
    s_mov_b32 s97, 0
    buffer_load_dwordx4 v20, s[40:43], s97 offen nt lds
    s_mov_b32 s97, 15360
    buffer_load_dwordx4 v20, s[40:43], s97 offen offset:1024 nt lds
    s_add_u32 m0, s69, 147840
    s_mov_b32 s97, 131072
    buffer_load_dwordx4 v20, s[40:43], s97 offen nt lds
    s_mov_b32 s97, 146432
    buffer_load_dwordx4 v20, s[40:43], s97 offen offset:1024 nt lds
    s_mov_b32 s40, s16
    s_mov_b32 s41, s17
    s_mov_b32 s42, 0x2000
    s_mov_b32 s43, 0x00020000
    buffer_load_dwordx4 v[32:35], v24, s[40:43], 0 offen
F_KV1X:
    v_add_u32 v10, 128, v10
    v_add_u32 v11, s63, v11
    s_cmp_lg_u32 s96, 2
    s_cbranch_scc1 F_CL2X
    buffer_store_dwordx4 v[112:115], v1, s[36:39], s4 offen sc1
    s_mov_b32 exec_lo, 0x00010001
    s_mov_b32 exec_hi, 0x00010001
    buffer_store_dwordx4 v[112:115], v27, s[36:39], s5 offen sc1
    s_mov_b64 exec, -1
    buffer_store_dwordx4 v[112:115], v1, s[36:39], s6 offen sc1
    s_add_u32 s6, s6, 33792
    buffer_store_dwordx4 v[112:115], v1, s[36:39], s6 offen sc1
    s_add_u32 s6, s6, 33792
    buffer_store_dwordx4 v[112:115], v1, s[36:39], s6 offen sc1
    s_add_u32 s6, s6, 33792
    buffer_store_dwordx4 v[112:115], v1, s[36:39], s6 offen sc1
    s_mul_i32 s69, s35, 4224
    s_add_u32 s69, s69, 0xc00000
    buffer_store_dwordx4 v[112:115], v1, s[36:39], s69 offen offset:0 sc1
    buffer_store_dwordx4 v[112:115], v1, s[36:39], s69 offen offset:1024 sc1
    buffer_store_dwordx4 v[112:115], v1, s[36:39], s69 offen offset:2048 sc1
    buffer_store_dwordx4 v[112:115], v1, s[36:39], s69 offen offset:3072 sc1
F_CL2X:
    s_cmp_lg_u32 s96, 0
    s_cbranch_scc1 F_Q0X
    s_cmp_ge_u32 s34, 2
    s_cbranch_scc1 F_Q0X
    s_mov_b32 s40, s10
    s_mov_b32 s41, s11
    s_mov_b32 s42, 0x400000
    s_mov_b32 s43, 0x00020000
    s_and_b32 s69, s2, 15
    s_lshl_b32 s69, s69, 7
    s_add_u32 s97, s69, 0
    buffer_load_dwordx4 v[200:203], v234, s[40:43], s97 offen offset:0 nt
    s_add_u32 s97, s69, 0
    buffer_load_dwordx4 v[204:207], v234, s[40:43], s97 offen offset:2048 nt
    s_add_u32 s97, s69, 4096
    buffer_load_dwordx4 v[208:211], v234, s[40:43], s97 offen offset:0 nt
    s_add_u32 s97, s69, 4096
    buffer_load_dwordx4 v[212:215], v234, s[40:43], s97 offen offset:2048 nt
    s_add_u32 s97, s69, 524288
    buffer_load_dwordx4 v[216:219], v234, s[40:43], s97 offen offset:0 nt
    s_add_u32 s97, s69, 524288
    buffer_load_dwordx4 v[220:223], v234, s[40:43], s97 offen offset:2048 nt
    s_add_u32 s97, s69, 528384
    buffer_load_dwordx4 v[224:227], v234, s[40:43], s97 offen offset:0 nt
    s_add_u32 s97, s69, 528384
    buffer_load_dwordx4 v[228:231], v234, s[40:43], s97 offen offset:2048 nt
F_Q0X:
    s_cmp_lg_u32 s96, 1
    s_cbranch_scc1 F_Q1X
    s_cmp_ge_u32 s34, 2
    s_cbranch_scc1 F_Q1X
    s_mov_b32 s40, s10
    s_mov_b32 s41, s11
    s_mov_b32 s42, 0x400000
    s_mov_b32 s43, 0x00020000
    s_and_b32 s69, s2, 15
    s_lshl_b32 s69, s69, 7
    s_add_u32 s97, s69, 0
    buffer_load_dwordx4 v[200:203], v234, s[40:43], s97 offen offset:0 nt
    s_add_u32 s97, s69, 0
    buffer_load_dwordx4 v[204:207], v234, s[40:43], s97 offen offset:2048 nt
    s_add_u32 s97, s69, 4096
    buffer_load_dwordx4 v[208:211], v234, s[40:43], s97 offen offset:0 nt
    s_add_u32 s97, s69, 4096
    buffer_load_dwordx4 v[212:215], v234, s[40:43], s97 offen offset:2048 nt
    s_add_u32 s97, s69, 524288
    buffer_load_dwordx4 v[216:219], v234, s[40:43], s97 offen offset:0 nt
    s_add_u32 s97, s69, 524288
    buffer_load_dwordx4 v[220:223], v234, s[40:43], s97 offen offset:2048 nt
    s_add_u32 s97, s69, 528384
    buffer_load_dwordx4 v[224:227], v234, s[40:43], s97 offen offset:0 nt
    s_add_u32 s97, s69, 528384
    buffer_load_dwordx4 v[228:231], v234, s[40:43], s97 offen offset:2048 nt
F_Q1X:
    s_waitcnt vmcnt(10)
    s_barrier
    s_add_u32 m0, s62, 4096
    s_nop 0
    buffer_load_dwordx4 v11, s[48:51], s57 offen offset:1024 lds
    buffer_load_dword v14, v13, s[64:67], 0 offen sc1
    v_mov_b32 v44, 0
    v_mov_b32 v45, 0
    v_mov_b32 v46, 0
    buffer_load_dwordx4 v11, s[48:51], s58 offen offset:2048 lds
    v_mov_b32 v47, 0
    v_mov_b32 v48, 0
    v_mov_b32 v49, 0
    v_mov_b32 v50, 0
    buffer_load_dwordx4 v11, s[48:51], s56 offen offset:0 lds
    v_mov_b32 v51, 0
    v_mov_b32 v52, 0
    v_mov_b32 v53, 0
    v_mov_b32 v54, 0
    buffer_load_dwordx4 v11, s[48:51], s59 offen offset:3072 lds
    v_mov_b32 v55, 0
    v_mov_b32 v56, 0
    v_mov_b32 v57, 0
    v_mov_b32 v58, 0
    s_add_u32 m0, s62, 0
    s_nop 0
    buffer_load_dwordx4 v10, s[44:47], s52 offen offset:0 lds
    v_mov_b32 v59, 0
    v_mov_b32 v60, 0
    v_mov_b32 v61, 0
    v_mov_b32 v62, 0
    buffer_load_dwordx4 v10, s[44:47], s53 offen offset:1024 lds
    v_mov_b32 v63, 0
    v_mov_b32 v64, 0
    v_mov_b32 v65, 0
    v_mov_b32 v66, 0
    buffer_load_dwordx4 v10, s[44:47], s54 offen offset:2048 lds
    v_mov_b32 v67, 0
    v_mov_b32 v68, 0
    v_mov_b32 v69, 0
    v_mov_b32 v70, 0
    buffer_load_dwordx4 v10, s[44:47], s55 offen offset:3072 lds
    v_mov_b32 v71, 0
    v_mov_b32 v72, 0
    v_mov_b32 v73, 0
    v_mov_b32 v74, 0
    s_add_u32 m0, s62, 8192
    s_nop 0
    buffer_load_dwordx4 v11, s[48:51], s60 offen offset:0 lds
    v_mov_b32 v75, 0
    v_mov_b32 v76, 0
    v_mov_b32 v77, 0
    v_mov_b32 v78, 0
    buffer_load_dwordx4 v11, s[48:51], s61 offen offset:1024 lds
    v_mov_b32 v79, 0
    s_cmp_lg_u32 s96, 3
    s_cbranch_scc1 F_CL3X
    buffer_store_dwordx4 v[112:115], v1, s[36:39], s4 offen sc1
    s_mov_b32 exec_lo, 0x00010001
    s_mov_b32 exec_hi, 0x00010001
    buffer_store_dwordx4 v[112:115], v27, s[36:39], s5 offen sc1
    s_mov_b64 exec, -1
    buffer_store_dwordx4 v[112:115], v1, s[36:39], s6 offen sc1
    s_add_u32 s6, s6, 33792
    buffer_store_dwordx4 v[112:115], v1, s[36:39], s6 offen sc1
    s_add_u32 s6, s6, 33792
    buffer_store_dwordx4 v[112:115], v1, s[36:39], s6 offen sc1
    s_add_u32 s6, s6, 33792
    buffer_store_dwordx4 v[112:115], v1, s[36:39], s6 offen sc1
    s_mul_i32 s69, s35, 4224
    s_add_u32 s69, s69, 0xc00000
    buffer_store_dwordx4 v[112:115], v1, s[36:39], s69 offen offset:0 sc1
    buffer_store_dwordx4 v[112:115], v1, s[36:39], s69 offen offset:1024 sc1
    buffer_store_dwordx4 v[112:115], v1, s[36:39], s69 offen offset:2048 sc1
    buffer_store_dwordx4 v[112:115], v1, s[36:39], s69 offen offset:3072 sc1
F_CL3X:
    v_add_u32 v10, 128, v10
    v_add_u32 v11, s63, v11
    s_waitcnt vmcnt(11)
    s_barrier
    s_add_u32 m0, s62, 45056
    s_nop 0
    buffer_load_dwordx4 v11, s[48:51], s57 offen offset:1024 lds
    buffer_load_dwordx4 v11, s[48:51], s58 offen offset:2048 lds
    buffer_load_dwordx4 v11, s[48:51], s56 offen offset:0 lds
    buffer_load_dwordx4 v11, s[48:51], s59 offen offset:3072 lds
    s_cmp_lg_u32 s96, 2
    s_cbranch_scc1 F_PF2X
    s_cmp_eq_u32 s34, 3
    s_cbranch_scc1 F_PF2X
    buffer_load_dword v250, v17, s[48:51], s98 offen
    buffer_load_dword v250, v16, s[44:47], s99 offen
F_PF2X:
    s_add_u32 m0, s62, 40960
    s_nop 0
    buffer_load_dwordx4 v10, s[44:47], s52 offen offset:0 lds
    buffer_load_dwordx4 v10, s[44:47], s53 offen offset:1024 lds
    buffer_load_dwordx4 v10, s[44:47], s54 offen offset:2048 lds
    buffer_load_dwordx4 v10, s[44:47], s55 offen offset:3072 lds
    s_cmp_lg_u32 s96, 2
    s_cbranch_scc1 F_PW2X
    s_cmp_lg_u32 s34, 3
    s_cbranch_scc1 F_PW2X
    s_mov_b32 s40, s8
    s_mov_b32 s41, s9
    s_mov_b32 s42, 0x200000
    s_mov_b32 s43, 0x00020000
    buffer_load_dword v250, v18, s[40:43], s100 offen
F_PW2X:
    s_add_u32 m0, s62, 49152
    s_nop 0
    buffer_load_dwordx4 v11, s[48:51], s60 offen offset:0 lds
    buffer_load_dwordx4 v11, s[48:51], s61 offen offset:1024 lds
    v_add_u32 v10, 128, v10
    v_add_u32 v11, s63, v11
    s_cmp_lg_u32 s96, 0
    s_cbranch_scc1 F_CL0X
    buffer_store_dwordx4 v[112:115], v1, s[36:39], s4 offen sc1
    s_mov_b32 exec_lo, 0x00010001
    s_mov_b32 exec_hi, 0x00010001
    buffer_store_dwordx4 v[112:115], v27, s[36:39], s5 offen sc1
    s_mov_b64 exec, -1
    buffer_store_dwordx4 v[112:115], v1, s[36:39], s6 offen sc1
    s_add_u32 s6, s6, 33792
    buffer_store_dwordx4 v[112:115], v1, s[36:39], s6 offen sc1
    s_add_u32 s6, s6, 33792
    buffer_store_dwordx4 v[112:115], v1, s[36:39], s6 offen sc1
    s_add_u32 s6, s6, 33792
    buffer_store_dwordx4 v[112:115], v1, s[36:39], s6 offen sc1
    s_mul_i32 s69, s35, 4224
    s_add_u32 s69, s69, 0xc00000
    buffer_store_dwordx4 v[112:115], v1, s[36:39], s69 offen offset:0 sc1
    buffer_store_dwordx4 v[112:115], v1, s[36:39], s69 offen offset:1024 sc1
    buffer_store_dwordx4 v[112:115], v1, s[36:39], s69 offen offset:2048 sc1
    buffer_store_dwordx4 v[112:115], v1, s[36:39], s69 offen offset:3072 sc1
F_CL0X:
    s_waitcnt vmcnt(10)
    s_barrier
    s_add_u32 m0, s62, 86016
    s_nop 0
    buffer_load_dwordx4 v11, s[48:51], s57 offen offset:1024 lds
    buffer_load_dwordx4 v11, s[48:51], s58 offen offset:2048 lds
    buffer_load_dwordx4 v11, s[48:51], s56 offen offset:0 lds
    buffer_load_dwordx4 v11, s[48:51], s59 offen offset:3072 lds
    v_readfirstlane_b32 s68, v14
    s_mov_b32 s69, 0
F_TK:
    s_cmp_lg_u32 s68, 0
    s_cbranch_scc1 F_TKX
    buffer_load_dword v14, v13, s[64:67], 0 offen sc1
    s_waitcnt vmcnt(0)
    v_readfirstlane_b32 s68, v14
    s_add_u32 s69, s69, 1
    s_cmp_lt_u32 s69, 400000
    s_cbranch_scc1 F_TK
F_TKX:
    ds_read_u16_d16_hi v44, v23 offset:0
    ds_read_u16_d16_hi v45, v23 offset:128
    ds_read_u16_d16_hi v46, v23 offset:256
    ds_read_u16_d16_hi v47, v22 offset:0
    ds_read_u16_d16_hi v48, v22 offset:128
    s_add_u32 m0, s62, 81920
    s_nop 0
    buffer_load_dwordx4 v10, s[44:47], s52 offen offset:0 lds
    ds_read_u16_d16_hi v49, v22 offset:256
    ds_read_u16_d16_hi v50, v22 offset:384
    ds_read_u16_d16_hi v51, v22 offset:512
    ds_read_u16_d16_hi v52, v22 offset:640
    ds_read_u16_d16_hi v53, v22 offset:768
    ds_read_u16_d16_hi v54, v22 offset:896
    buffer_load_dwordx4 v10, s[44:47], s53 offen offset:1024 lds
    ds_read_u16_d16_hi v55, v22 offset:1024
    v_lshlrev_b32 v36, 16, v32
    v_and_b32 v37, s7, v32
    v_lshlrev_b32 v38, 16, v33
    v_and_b32 v39, s7, v33
    s_waitcnt lgkmcnt(4)
    v_mul_f32 v80, v39, v44
    buffer_load_dwordx4 v10, s[44:47], s54 offen offset:2048 lds
    ds_read_u16_d16_hi v56, v22 offset:1152
    v_mul_f32 v81, v39, v45
    ds_read_u16_d16_hi v57, v22 offset:1280
    v_mul_f32 v82, v39, v46
    ds_read_u16_d16_hi v58, v22 offset:1408
    v_mul_f32 v83, v39, v47
    buffer_load_dwordx4 v10, s[44:47], s55 offen offset:3072 lds
    ds_read_u16_d16_hi v59, v22 offset:1536
    v_mul_f32 v84, v39, v48
    ds_read_u16_d16_hi v60, v22 offset:1664
    v_mul_f32 v85, v39, v49
    ds_read_u16_d16_hi v61, v22 offset:1792
    v_mul_f32 v86, v39, v50
    s_add_u32 m0, s62, 90112
    s_nop 0
    buffer_load_dwordx4 v11, s[48:51], s60 offen offset:0 lds
    ds_read_u16_d16_hi v62, v22 offset:1920
    v_mul_f32 v87, v39, v51
    ds_read_u16_d16_hi v64, v22 offset:16384
    s_waitcnt lgkmcnt(4)
    v_mul_f32 v88, v39, v52
    ds_read_u16_d16_hi v65, v22 offset:16512
    v_mul_f32 v89, v39, v53
    buffer_load_dwordx4 v11, s[48:51], s61 offen offset:1024 lds
    ds_read_u16_d16_hi v66, v22 offset:16640
    v_mul_f32 v90, v39, v54
    ds_read_u16_d16_hi v67, v22 offset:16768
    v_mul_f32 v91, v39, v55
    ds_read_u16_d16_hi v68, v22 offset:16896
    v_mul_f32 v92, v39, v56
    v_add_u32 v10, 128, v10
    v_add_u32 v11, s63, v11
    ds_read_u16_d16_hi v69, v22 offset:17024
    v_mul_f32 v93, v39, v57
    ds_read_u16_d16_hi v70, v22 offset:17152
    v_mul_f32 v94, v39, v58
    ds_read_u16_d16_hi v71, v22 offset:17280
    v_mul_f32 v95, v39, v59
    ds_read_u16_d16_hi v72, v22 offset:17408
    s_waitcnt lgkmcnt(9)
    v_fmac_f32 v80, v38, v45
    ds_read_u16_d16_hi v73, v22 offset:17536
    v_fmac_f32 v81, v38, v46
    ds_read_u16_d16_hi v74, v22 offset:17664
    s_waitcnt vmcnt(10)
    s_barrier
    s_add_u32 m0, s62, 4096
    s_nop 0
    buffer_load_dwordx4 v11, s[48:51], s57 offen offset:1024 lds
    buffer_load_dwordx4 v11, s[48:51], s58 offen offset:2048 lds
    buffer_load_dwordx4 v11, s[48:51], s56 offen offset:0 lds
    buffer_load_dwordx4 v11, s[48:51], s59 offen offset:3072 lds
    s_cmp_lg_u32 s96, 1
    s_cbranch_scc1 F_CL1X
    buffer_store_dwordx4 v[112:115], v1, s[36:39], s4 offen sc1
    s_mov_b32 exec_lo, 0x00010001
    s_mov_b32 exec_hi, 0x00010001
    buffer_store_dwordx4 v[112:115], v27, s[36:39], s5 offen sc1
    s_mov_b64 exec, -1
    buffer_store_dwordx4 v[112:115], v1, s[36:39], s6 offen sc1
    s_add_u32 s6, s6, 33792
    buffer_store_dwordx4 v[112:115], v1, s[36:39], s6 offen sc1
    s_add_u32 s6, s6, 33792
    buffer_store_dwordx4 v[112:115], v1, s[36:39], s6 offen sc1
    s_add_u32 s6, s6, 33792
    buffer_store_dwordx4 v[112:115], v1, s[36:39], s6 offen sc1
    s_mul_i32 s69, s35, 4224
    s_add_u32 s69, s69, 0xc00000
    buffer_store_dwordx4 v[112:115], v1, s[36:39], s69 offen offset:0 sc1
    buffer_store_dwordx4 v[112:115], v1, s[36:39], s69 offen offset:1024 sc1
    buffer_store_dwordx4 v[112:115], v1, s[36:39], s69 offen offset:2048 sc1
    buffer_store_dwordx4 v[112:115], v1, s[36:39], s69 offen offset:3072 sc1
F_CL1X:
    v_fmac_f32 v82, v38, v47
    ds_read_u16_d16_hi v75, v22 offset:17792
    v_fmac_f32 v83, v38, v48
    s_add_u32 m0, s62, 0
    s_nop 0
    buffer_load_dwordx4 v10, s[44:47], s52 offen offset:0 lds
    ds_read_u16_d16_hi v76, v22 offset:17920
    v_fmac_f32 v84, v38, v49
    ds_read_u16_d16_hi v77, v22 offset:18048
    v_fmac_f32 v85, v38, v50
    ds_read_u16_d16_hi v78, v22 offset:18176
    v_fmac_f32 v86, v38, v51
    buffer_load_dwordx4 v10, s[44:47], s53 offen offset:1024 lds
    ds_read_u16_d16_hi v79, v22 offset:18304
    v_fmac_f32 v87, v38, v52
    v_fmac_f32 v88, v38, v53
    v_fmac_f32 v89, v38, v54
    v_fmac_f32 v90, v38, v55
    v_fmac_f32 v91, v38, v56
    buffer_load_dwordx4 v10, s[44:47], s54 offen offset:2048 lds
    v_fmac_f32 v92, v38, v57
    v_fmac_f32 v93, v38, v58
    v_fmac_f32 v94, v38, v59
    v_fmac_f32 v95, v38, v60
    v_fmac_f32 v80, v37, v46
    v_fmac_f32 v81, v37, v47
    buffer_load_dwordx4 v10, s[44:47], s55 offen offset:3072 lds
    v_fmac_f32 v82, v37, v48
    v_fmac_f32 v83, v37, v49
    v_fmac_f32 v84, v37, v50
    v_fmac_f32 v85, v37, v51
    v_fmac_f32 v86, v37, v52
    v_fmac_f32 v87, v37, v53
    s_add_u32 m0, s62, 8192
    s_nop 0
    buffer_load_dwordx4 v11, s[48:51], s60 offen offset:0 lds
    v_fmac_f32 v88, v37, v54
    v_fmac_f32 v89, v37, v55
    v_fmac_f32 v90, v37, v56
    v_fmac_f32 v91, v37, v57
    v_fmac_f32 v92, v37, v58
    v_fmac_f32 v93, v37, v59
    buffer_load_dwordx4 v11, s[48:51], s61 offen offset:1024 lds
    v_fmac_f32 v94, v37, v60
    v_fmac_f32 v95, v37, v61
    v_fmac_f32 v80, v36, v47
    v_fmac_f32 v81, v36, v48
    v_fmac_f32 v82, v36, v49
    v_fmac_f32 v83, v36, v50
    v_add_u32 v10, 128, v10
    v_add_u32 v11, s63, v11
    v_fmac_f32 v84, v36, v51
    v_fmac_f32 v85, v36, v52
    v_fmac_f32 v86, v36, v53
    v_fmac_f32 v87, v36, v54
    v_fmac_f32 v88, v36, v55
    v_fmac_f32 v89, v36, v56
    v_fmac_f32 v90, v36, v57
    v_fmac_f32 v91, v36, v58
    v_fmac_f32 v92, v36, v59
    v_fmac_f32 v93, v36, v60
    v_fmac_f32 v94, v36, v61
    v_fmac_f32 v95, v36, v62
    s_waitcnt lgkmcnt(0)
    v_mul_f32 v80, v80, v64
    s_waitcnt vmcnt(10)
    s_barrier
    s_add_u32 m0, s62, 45056
    s_nop 0
    buffer_load_dwordx4 v11, s[48:51], s57 offen offset:1024 lds
    buffer_load_dwordx4 v11, s[48:51], s58 offen offset:2048 lds
    buffer_load_dwordx4 v11, s[48:51], s56 offen offset:0 lds
    buffer_load_dwordx4 v11, s[48:51], s59 offen offset:3072 lds
    s_cmp_lg_u32 s96, 3
    s_cbranch_scc1 F_PF3X
    s_cmp_eq_u32 s34, 3
    s_cbranch_scc1 F_PF3X
    buffer_load_dword v250, v17, s[48:51], s98 offen
    buffer_load_dword v250, v16, s[44:47], s99 offen
F_PF3X:
    s_cmp_lg_u32 s96, 3
    s_cbranch_scc1 F_PW3X
    s_cmp_lg_u32 s34, 3
    s_cbranch_scc1 F_PW3X
    s_mov_b32 s40, s8
    s_mov_b32 s41, s9
    s_mov_b32 s42, 0x200000
    s_mov_b32 s43, 0x00020000
    buffer_load_dword v250, v18, s[40:43], s100 offen
F_PW3X:
    v_mul_f32 v81, v81, v65
    v_mul_f32 v82, v82, v66
    v_mul_f32 v83, v83, v67
    v_mul_f32 v84, v84, v68
    s_add_u32 m0, s62, 40960
    s_nop 0
    buffer_load_dwordx4 v10, s[44:47], s52 offen offset:0 lds
    v_mul_f32 v85, v85, v69
    v_mul_f32 v86, v86, v70
    v_mul_f32 v87, v87, v71
    v_mul_f32 v88, v88, v72
    v_mul_f32 v89, v89, v73
    v_mul_f32 v90, v90, v74
    buffer_load_dwordx4 v10, s[44:47], s53 offen offset:1024 lds
    v_mul_f32 v91, v91, v75
    v_mul_f32 v92, v92, v76
    v_mul_f32 v93, v93, v77
    v_mul_f32 v94, v94, v78
    v_mul_f32 v95, v95, v79
    v_cvt_pk_bf16_f32 v96, v92, v88
    buffer_load_dwordx4 v10, s[44:47], s54 offen offset:2048 lds
    v_cvt_pk_bf16_f32 v97, v84, v80
    v_cvt_pk_bf16_f32 v98, v94, v90
    v_cvt_pk_bf16_f32 v99, v86, v82
    v_cvt_pk_bf16_f32 v100, v93, v89
    v_cvt_pk_bf16_f32 v101, v85, v81
    v_cvt_pk_bf16_f32 v102, v95, v91
    buffer_load_dwordx4 v10, s[44:47], s55 offen offset:3072 lds
    v_cvt_pk_bf16_f32 v103, v87, v83
    ds_read_u16_d16_hi v44, v23 offset:2
    ds_read_u16_d16_hi v45, v23 offset:130
    ds_read_u16_d16_hi v46, v23 offset:258
    ds_read_u16_d16_hi v47, v22 offset:2
    ds_read_u16_d16_hi v48, v22 offset:130
    s_add_u32 m0, s62, 49152
    s_nop 0
    buffer_load_dwordx4 v11, s[48:51], s60 offen offset:0 lds
    ds_read_u16_d16_hi v49, v22 offset:258
    ds_read_u16_d16_hi v50, v22 offset:386
    ds_read_u16_d16_hi v51, v22 offset:514
    ds_read_u16_d16_hi v52, v22 offset:642
    ds_read_u16_d16_hi v53, v22 offset:770
    ds_read_u16_d16_hi v54, v22 offset:898
    buffer_load_dwordx4 v11, s[48:51], s61 offen offset:1024 lds
    ds_read_u16_d16_hi v55, v22 offset:1026
    v_lshlrev_b32 v36, 16, v34
    v_and_b32 v37, s7, v34
    v_lshlrev_b32 v38, 16, v35
    v_and_b32 v39, s7, v35
    s_waitcnt lgkmcnt(4)
    v_mul_f32 v80, v39, v44
    v_add_u32 v10, 128, v10
    v_add_u32 v11, s63, v11
    ds_read_u16_d16_hi v56, v22 offset:1154
    v_mul_f32 v81, v39, v45
    ds_read_u16_d16_hi v57, v22 offset:1282
    v_mul_f32 v82, v39, v46
    ds_read_u16_d16_hi v58, v22 offset:1410
    v_mul_f32 v83, v39, v47
    ds_read_u16_d16_hi v59, v22 offset:1538
    v_mul_f32 v84, v39, v48
    ds_read_u16_d16_hi v60, v22 offset:1666
    v_mul_f32 v85, v39, v49
    ds_read_u16_d16_hi v61, v22 offset:1794
    v_mul_f32 v86, v39, v50
    s_waitcnt vmcnt(10)
    s_barrier
    s_add_u32 m0, s62, 86016
    s_nop 0
    buffer_load_dwordx4 v11, s[48:51], s57 offen offset:1024 lds
    ds_read_u16_d16_hi v62, v22 offset:1922
    v_mul_f32 v87, v39, v51
    ds_read_u16_d16_hi v64, v22 offset:16386
    s_waitcnt lgkmcnt(4)
    v_mul_f32 v88, v39, v52
    ds_read_u16_d16_hi v65, v22 offset:16514
    v_mul_f32 v89, v39, v53
    buffer_load_dwordx4 v11, s[48:51], s58 offen offset:2048 lds
    ds_read_u16_d16_hi v66, v22 offset:16642
    v_mul_f32 v90, v39, v54
    ds_read_u16_d16_hi v67, v22 offset:16770
    v_mul_f32 v91, v39, v55
    ds_read_u16_d16_hi v68, v22 offset:16898
    v_mul_f32 v92, v39, v56
    buffer_load_dwordx4 v11, s[48:51], s56 offen offset:0 lds
    ds_read_u16_d16_hi v69, v22 offset:17026
    v_mul_f32 v93, v39, v57
    ds_read_u16_d16_hi v70, v22 offset:17154
    v_mul_f32 v94, v39, v58
    ds_read_u16_d16_hi v71, v22 offset:17282
    v_mul_f32 v95, v39, v59
    buffer_load_dwordx4 v11, s[48:51], s59 offen offset:3072 lds
    ds_read_u16_d16_hi v72, v22 offset:17410
    s_waitcnt lgkmcnt(9)
    v_fmac_f32 v80, v38, v45
    ds_read_u16_d16_hi v73, v22 offset:17538
    v_fmac_f32 v81, v38, v46
    ds_read_u16_d16_hi v74, v22 offset:17666
    v_fmac_f32 v82, v38, v47
    s_add_u32 m0, s62, 81920
    s_nop 0
    buffer_load_dwordx4 v10, s[44:47], s52 offen offset:0 lds
    ds_read_u16_d16_hi v75, v22 offset:17794
    v_fmac_f32 v83, v38, v48
    ds_read_u16_d16_hi v76, v22 offset:17922
    v_fmac_f32 v84, v38, v49
    ds_read_u16_d16_hi v77, v22 offset:18050
    v_fmac_f32 v85, v38, v50
    buffer_load_dwordx4 v10, s[44:47], s53 offen offset:1024 lds
    ds_read_u16_d16_hi v78, v22 offset:18178
    v_fmac_f32 v86, v38, v51
    ds_read_u16_d16_hi v79, v22 offset:18306
    v_fmac_f32 v87, v38, v52
    v_fmac_f32 v88, v38, v53
    v_fmac_f32 v89, v38, v54
    buffer_load_dwordx4 v10, s[44:47], s54 offen offset:2048 lds
    v_fmac_f32 v90, v38, v55
    v_fmac_f32 v91, v38, v56
    v_fmac_f32 v92, v38, v57
    v_fmac_f32 v93, v38, v58
    v_fmac_f32 v94, v38, v59
    v_fmac_f32 v95, v38, v60
    buffer_load_dwordx4 v10, s[44:47], s55 offen offset:3072 lds
    v_fmac_f32 v80, v37, v46
    v_fmac_f32 v81, v37, v47
    v_fmac_f32 v82, v37, v48
    v_fmac_f32 v83, v37, v49
    v_fmac_f32 v84, v37, v50
    v_fmac_f32 v85, v37, v51
    s_add_u32 m0, s62, 90112
    s_nop 0
    buffer_load_dwordx4 v11, s[48:51], s60 offen offset:0 lds
    v_fmac_f32 v86, v37, v52
    v_fmac_f32 v87, v37, v53
    v_fmac_f32 v88, v37, v54
    v_fmac_f32 v89, v37, v55
    buffer_load_dwordx4 v11, s[48:51], s61 offen offset:1024 lds
    v_add_u32 v10, 128, v10
    v_add_u32 v11, s63, v11
    s_waitcnt vmcnt(10)
    s_barrier
    s_add_u32 m0, s62, 4096
    s_nop 0
    buffer_load_dwordx4 v11, s[48:51], s57 offen offset:1024 lds
    buffer_load_dwordx4 v11, s[48:51], s58 offen offset:2048 lds
    buffer_load_dwordx4 v11, s[48:51], s56 offen offset:0 lds
    buffer_load_dwordx4 v11, s[48:51], s59 offen offset:3072 lds
    s_cmp_lg_u32 s34, 1
    s_cbranch_scc1 F_NOFC
    s_lshl_b32 s69, s2, 2
    s_add_u32 s69, s69, 0x110800
    v_mov_b32 v14, s68
    s_mov_b64 exec, 1
    buffer_store_dword v14, v13, s[36:39], s69 offen sc1
    s_mov_b64 exec, -1
F_NOFC:
    v_fmac_f32 v90, v37, v56
    v_fmac_f32 v91, v37, v57
    v_fmac_f32 v92, v37, v58
    v_fmac_f32 v93, v37, v59
    s_add_u32 m0, s62, 0
    s_nop 0
    buffer_load_dwordx4 v10, s[44:47], s52 offen offset:0 lds
    v_fmac_f32 v94, v37, v60
    v_fmac_f32 v95, v37, v61
    v_fmac_f32 v80, v36, v47
    v_fmac_f32 v81, v36, v48
    v_fmac_f32 v82, v36, v49
    buffer_load_dwordx4 v10, s[44:47], s53 offen offset:1024 lds
    v_fmac_f32 v83, v36, v50
    v_fmac_f32 v84, v36, v51
    v_fmac_f32 v85, v36, v52
    v_fmac_f32 v86, v36, v53
    v_fmac_f32 v87, v36, v54
    buffer_load_dwordx4 v10, s[44:47], s54 offen offset:2048 lds
    v_fmac_f32 v88, v36, v55
    v_fmac_f32 v89, v36, v56
    v_fmac_f32 v90, v36, v57
    v_fmac_f32 v91, v36, v58
    v_fmac_f32 v92, v36, v59
    buffer_load_dwordx4 v10, s[44:47], s55 offen offset:3072 lds
    v_fmac_f32 v93, v36, v60
    v_fmac_f32 v94, v36, v61
    v_fmac_f32 v95, v36, v62
    s_waitcnt lgkmcnt(0)
    v_mul_f32 v80, v80, v64
    v_mul_f32 v81, v81, v65
    s_add_u32 m0, s62, 8192
    s_nop 0
    buffer_load_dwordx4 v11, s[48:51], s60 offen offset:0 lds
    v_mul_f32 v82, v82, v66
    v_mul_f32 v83, v83, v67
    v_mul_f32 v84, v84, v68
    v_mul_f32 v85, v85, v69
    v_mul_f32 v86, v86, v70
    buffer_load_dwordx4 v11, s[48:51], s61 offen offset:1024 lds
    v_mul_f32 v87, v87, v71
    v_mul_f32 v88, v88, v72
    v_mul_f32 v89, v89, v73
    v_mul_f32 v90, v90, v74
    v_mul_f32 v91, v91, v75
    v_add_u32 v10, 128, v10
    v_add_u32 v11, s63, v11
    v_mul_f32 v92, v92, v76
    v_mul_f32 v93, v93, v77
    v_mul_f32 v94, v94, v78
    v_mul_f32 v95, v95, v79
    v_cvt_pk_bf16_f32 v104, v92, v88
    v_cvt_pk_bf16_f32 v105, v84, v80
    v_cvt_pk_bf16_f32 v106, v94, v90
    v_cvt_pk_bf16_f32 v107, v86, v82
    v_cvt_pk_bf16_f32 v108, v93, v89
    v_cvt_pk_bf16_f32 v109, v85, v81
    v_cvt_pk_bf16_f32 v110, v95, v91
    v_cvt_pk_bf16_f32 v111, v87, v83
    s_mov_b32 s69, 0x700000
    buffer_store_dwordx4 v[96:99], v25, s[36:39], s69 offen offset:0 sc1
    buffer_store_dwordx4 v[100:103], v25, s[36:39], s69 offen offset:2048 sc1
    s_mov_b32 s69, 0x701080
    buffer_store_dwordx4 v[104:107], v25, s[36:39], s69 offen offset:0 sc1
    buffer_store_dwordx4 v[108:111], v25, s[36:39], s69 offen offset:2048 sc1
    s_waitcnt vmcnt(14)
    s_barrier
    s_add_u32 m0, s62, 45056
    s_nop 0
    buffer_load_dwordx4 v11, s[48:51], s57 offen offset:1024 lds
    s_lshl_b32 s98, s35, 12
    buffer_load_dwordx4 v11, s[48:51], s58 offen offset:2048 lds
    s_mul_i32 s99, s34, 8320
    buffer_load_dwordx4 v11, s[48:51], s56 offen offset:0 lds
    s_add_u32 s99, s99, 122880
    buffer_load_dwordx4 v11, s[48:51], s59 offen offset:3072 lds
    s_add_u32 m0, s62, 40960
    s_nop 0
    buffer_load_dwordx4 v10, s[44:47], s52 offen offset:0 lds
    buffer_load_dwordx4 v10, s[44:47], s53 offen offset:1024 lds
    buffer_load_dwordx4 v10, s[44:47], s54 offen offset:2048 lds
    buffer_load_dwordx4 v10, s[44:47], s55 offen offset:3072 lds
    s_add_u32 m0, s62, 49152
    s_nop 0
    buffer_load_dwordx4 v11, s[48:51], s60 offen offset:0 lds
    buffer_load_dwordx4 v11, s[48:51], s61 offen offset:1024 lds
    s_cmp_lg_u32 s96, 0
    s_cbranch_scc1 F_H0X
    s_mov_b32 s40, s18
    s_mov_b32 s41, s19
    s_mov_b32 s42, 0x400000
    s_mov_b32 s43, 0x00020000
    s_add_u32 m0, s99, 32
    s_nop 0
    buffer_load_dwordx4 v1, s[40:43], s98 offen offset:0 lds
    s_add_u32 m0, s99, 4196
    s_nop 0
    buffer_load_dwordx4 v1, s[40:43], s98 offen offset:0 lds
    s_add_u32 m0, s99, 32
    s_nop 0
    buffer_load_dwordx4 v1, s[40:43], s98 offen offset:1024 lds
    s_add_u32 m0, s99, 4196
    s_nop 0
    buffer_load_dwordx4 v1, s[40:43], s98 offen offset:1024 lds
    s_add_u32 m0, s99, 32
    s_nop 0
    buffer_load_dwordx4 v1, s[40:43], s98 offen offset:2048 lds
    s_add_u32 m0, s99, 4196
    s_nop 0
    buffer_load_dwordx4 v1, s[40:43], s98 offen offset:2048 lds
    s_add_u32 m0, s99, 32
    s_nop 0
    buffer_load_dwordx4 v1, s[40:43], s98 offen offset:3072 lds
    s_add_u32 m0, s99, 4196
    s_nop 0
    buffer_load_dwordx4 v1, s[40:43], s98 offen offset:3072 lds
F_H0X:
    v_add_u32 v10, 128, v10
    v_add_u32 v11, s63, v11
    s_waitcnt vmcnt(10)
    s_barrier
    s_add_u32 m0, s62, 86016
    s_nop 0
    buffer_load_dwordx4 v11, s[48:51], s57 offen offset:1024 lds
    buffer_load_dwordx4 v11, s[48:51], s58 offen offset:2048 lds
    buffer_load_dwordx4 v11, s[48:51], s56 offen offset:0 lds
    buffer_load_dwordx4 v11, s[48:51], s59 offen offset:3072 lds
    s_cmp_lg_u32 s34, 0
    s_cbranch_scc1 F_NOFA
    s_and_b32 s69, s2, 15
    s_lshl_b32 s69, s69, 4
    s_lshr_b32 s97, s2, 4
    s_add_u32 s69, s69, s97
    s_lshl_b32 s69, s69, 2
    s_add_u32 s69, s69, 0x110000
    v_mov_b32 v14, s68
    s_mov_b64 exec, 1
    buffer_store_dword v14, v13, s[36:39], s69 offen sc1
    s_mov_b64 exec, -1
F_NOFA:
    s_add_u32 m0, s62, 81920
    s_nop 0
    buffer_load_dwordx4 v10, s[44:47], s52 offen offset:0 lds
    buffer_load_dwordx4 v10, s[44:47], s53 offen offset:1024 lds
    buffer_load_dwordx4 v10, s[44:47], s54 offen offset:2048 lds
    buffer_load_dwordx4 v10, s[44:47], s55 offen offset:3072 lds
    s_cmp_lg_u32 s96, 1
    s_cbranch_scc1 F_H1X
    s_mov_b32 s40, s18
    s_mov_b32 s41, s19
    s_mov_b32 s42, 0x400000
    s_mov_b32 s43, 0x00020000
    s_add_u32 m0, s99, 32
    s_nop 0
    buffer_load_dwordx4 v1, s[40:43], s98 offen offset:0 lds
    s_add_u32 m0, s99, 4196
    s_nop 0
    buffer_load_dwordx4 v1, s[40:43], s98 offen offset:0 lds
    s_add_u32 m0, s99, 32
    s_nop 0
    buffer_load_dwordx4 v1, s[40:43], s98 offen offset:1024 lds
    s_add_u32 m0, s99, 4196
    s_nop 0
    buffer_load_dwordx4 v1, s[40:43], s98 offen offset:1024 lds
    s_add_u32 m0, s99, 32
    s_nop 0
    buffer_load_dwordx4 v1, s[40:43], s98 offen offset:2048 lds
    s_add_u32 m0, s99, 4196
    s_nop 0
    buffer_load_dwordx4 v1, s[40:43], s98 offen offset:2048 lds
    s_add_u32 m0, s99, 32
    s_nop 0
    buffer_load_dwordx4 v1, s[40:43], s98 offen offset:3072 lds
    s_add_u32 m0, s99, 4196
    s_nop 0
    buffer_load_dwordx4 v1, s[40:43], s98 offen offset:3072 lds
F_H1X:
    v_mov_b32 v96, 0
    v_mov_b32 v97, 0
    s_add_u32 m0, s62, 90112
    s_nop 0
    buffer_load_dwordx4 v11, s[48:51], s60 offen offset:0 lds
    v_mov_b32 v98, 0
    v_mov_b32 v99, 0
    v_mov_b32 v100, 0
    buffer_load_dwordx4 v11, s[48:51], s61 offen offset:1024 lds
    v_mov_b32 v101, 0
    v_mov_b32 v102, 0
    v_mov_b32 v103, 0
    v_add_u32 v10, 128, v10
    v_add_u32 v11, s63, v11
    v_mov_b32 v104, 0
    v_mov_b32 v105, 0
    v_mov_b32 v106, 0
    v_mov_b32 v107, 0
    v_mov_b32 v108, 0
    v_mov_b32 v109, 0
    v_mov_b32 v110, 0
    v_mov_b32 v111, 0
    v_mov_b32 v112, 0
    v_mov_b32 v113, 0
    v_mov_b32 v114, 0
    v_mov_b32 v115, 0
    s_waitcnt vmcnt(10)
    s_barrier
    s_add_u32 m0, s62, 4096
    s_nop 0
    buffer_load_dwordx4 v11, s[48:51], s57 offen offset:1024 lds
    buffer_load_dwordx4 v11, s[48:51], s58 offen offset:2048 lds
    buffer_load_dwordx4 v11, s[48:51], s56 offen offset:0 lds
    buffer_load_dwordx4 v11, s[48:51], s59 offen offset:3072 lds
    s_cmp_lg_u32 s96, 2
    s_cbranch_scc1 F_H2X
    s_mov_b32 s40, s18
    s_mov_b32 s41, s19
    s_mov_b32 s42, 0x400000
    s_mov_b32 s43, 0x00020000
    s_add_u32 m0, s99, 32
    s_nop 0
    buffer_load_dwordx4 v1, s[40:43], s98 offen offset:0 lds
    s_add_u32 m0, s99, 4196
    s_nop 0
    buffer_load_dwordx4 v1, s[40:43], s98 offen offset:0 lds
    s_add_u32 m0, s99, 32
    s_nop 0
    buffer_load_dwordx4 v1, s[40:43], s98 offen offset:1024 lds
    s_add_u32 m0, s99, 4196
    s_nop 0
    buffer_load_dwordx4 v1, s[40:43], s98 offen offset:1024 lds
    s_add_u32 m0, s99, 32
    s_nop 0
    buffer_load_dwordx4 v1, s[40:43], s98 offen offset:2048 lds
    s_add_u32 m0, s99, 4196
    s_nop 0
    buffer_load_dwordx4 v1, s[40:43], s98 offen offset:2048 lds
    s_add_u32 m0, s99, 32
    s_nop 0
    buffer_load_dwordx4 v1, s[40:43], s98 offen offset:3072 lds
    s_add_u32 m0, s99, 4196
    s_nop 0
    buffer_load_dwordx4 v1, s[40:43], s98 offen offset:3072 lds
F_H2X:
    v_mov_b32 v116, 0
    v_mov_b32 v117, 0
    s_add_u32 m0, s62, 0
    s_nop 0
    buffer_load_dwordx4 v10, s[44:47], s52 offen offset:0 lds
    v_mov_b32 v118, 0
    v_mov_b32 v119, 0
    v_mov_b32 v120, 0
    v_mov_b32 v121, 0
    v_mov_b32 v122, 0
    buffer_load_dwordx4 v10, s[44:47], s53 offen offset:1024 lds
    v_mov_b32 v123, 0
    v_mov_b32 v124, 0
    v_mov_b32 v125, 0
    v_mov_b32 v126, 0
    v_mov_b32 v127, 0
    buffer_load_dwordx4 v10, s[44:47], s54 offen offset:2048 lds
    v_mov_b32 v128, 0
    v_mov_b32 v129, 0
    v_mov_b32 v130, 0
    v_mov_b32 v131, 0
    v_mov_b32 v132, 0
    buffer_load_dwordx4 v10, s[44:47], s55 offen offset:3072 lds
    v_mov_b32 v133, 0
    v_mov_b32 v134, 0
    v_mov_b32 v135, 0
    v_mov_b32 v136, 0
    v_mov_b32 v137, 0
    s_add_u32 m0, s62, 8192
    s_nop 0
    buffer_load_dwordx4 v11, s[48:51], s60 offen offset:0 lds
    v_mov_b32 v138, 0
    v_mov_b32 v139, 0
    v_mov_b32 v140, 0
    v_mov_b32 v141, 0
    v_mov_b32 v142, 0
    buffer_load_dwordx4 v11, s[48:51], s61 offen offset:1024 lds
    v_mov_b32 v143, 0
    v_mov_b32 v144, 0
    v_mov_b32 v145, 0
    v_mov_b32 v146, 0
    v_mov_b32 v147, 0
    v_add_u32 v10, 128, v10
    v_add_u32 v11, s63, v11
    v_mov_b32 v148, 0
    v_mov_b32 v149, 0
    v_mov_b32 v150, 0
    v_mov_b32 v151, 0
    v_mov_b32 v152, 0
    v_mov_b32 v153, 0
    v_mov_b32 v154, 0
    v_mov_b32 v155, 0
    v_mov_b32 v156, 0
    v_mov_b32 v157, 0
    v_mov_b32 v158, 0
    v_mov_b32 v159, 0
    s_waitcnt vmcnt(10)
    s_barrier
    s_add_u32 m0, s62, 45056
    s_nop 0
    buffer_load_dwordx4 v11, s[48:51], s57 offen offset:1024 lds
    buffer_load_dwordx4 v11, s[48:51], s58 offen offset:2048 lds
    buffer_load_dwordx4 v11, s[48:51], s56 offen offset:0 lds
    buffer_load_dwordx4 v11, s[48:51], s59 offen offset:3072 lds
    s_cmp_lg_u32 s96, 3
    s_cbranch_scc1 F_H3X
    s_mov_b32 s40, s18
    s_mov_b32 s41, s19
    s_mov_b32 s42, 0x400000
    s_mov_b32 s43, 0x00020000
    s_add_u32 m0, s99, 32
    s_nop 0
    buffer_load_dwordx4 v1, s[40:43], s98 offen offset:0 lds
    s_add_u32 m0, s99, 4196
    s_nop 0
    buffer_load_dwordx4 v1, s[40:43], s98 offen offset:0 lds
    s_add_u32 m0, s99, 32
    s_nop 0
    buffer_load_dwordx4 v1, s[40:43], s98 offen offset:1024 lds
    s_add_u32 m0, s99, 4196
    s_nop 0
    buffer_load_dwordx4 v1, s[40:43], s98 offen offset:1024 lds
    s_add_u32 m0, s99, 32
    s_nop 0
    buffer_load_dwordx4 v1, s[40:43], s98 offen offset:2048 lds
    s_add_u32 m0, s99, 4196
    s_nop 0
    buffer_load_dwordx4 v1, s[40:43], s98 offen offset:2048 lds
    s_add_u32 m0, s99, 32
    s_nop 0
    buffer_load_dwordx4 v1, s[40:43], s98 offen offset:3072 lds
    s_add_u32 m0, s99, 4196
    s_nop 0
    buffer_load_dwordx4 v1, s[40:43], s98 offen offset:3072 lds
F_H3X:
    s_add_u32 s4, s18, s98
    s_addc_u32 s5, s19, 0
    s_load_dword s6, s[4:5], 0
    s_lshl_b32 s7, s35, 1
    s_and_b32 s7, s7, 0xfffffffc
    s_add_u32 s4, s20, s7
    s_addc_u32 s5, s21, 0
    s_load_dword s7, s[4:5], 0
    s_mul_i32 s97, s34, 4608
    s_add_u32 s97, s97, 98304
    s_add_u32 m0, s62, 40960
    s_nop 0
    buffer_load_dwordx4 v10, s[44:47], s52 offen offset:0 lds
    v_add_u32 v32, s97, v1
    v_add_u32 v33, 2048, v32
    v_cmp_gt_u32 vcc, 16, v0
    v_and_b32 v34, 1, v0
    v_lshlrev_b32 v34, 4, v34
    v_cndmask_b32 v32, v33, v32, vcc
    buffer_load_dwordx4 v10, s[44:47], s53 offen offset:1024 lds
    v_bfe_u32 v35, v0, 1, 1
    v_mul_u32_u24 v35, 4160, v35
    v_cmp_gt_u32 vcc, 32, v0
    v_add3_u32 v34, v34, v35, s99
    v_mov_b32 v36, 0
    v_mov_b32 v37, 0
    buffer_load_dwordx4 v10, s[44:47], s54 offen offset:2048 lds
    v_mov_b32 v38, 0
    v_mov_b32 v39, 0
    v_cndmask_b32 v32, v34, v32, vcc
    v_and_b32 v34, 3, v0
    v_lshlrev_b32 v30, 2, v34
    v_add_u32 v30, 156160, v30
    buffer_load_dwordx4 v10, s[44:47], s55 offen offset:3072 lds
    v_bfe_u32 v35, v0, 2, 2
    v_add_u32 v34, v34, v35
    v_lshlrev_b32 v34, 3, v34
    v_lshl_add_u32 v34, v5, 5, v34
    s_add_u32 s69, s99, 8
    v_add_u32 v6, s69, v34
    s_add_u32 m0, s62, 49152
    s_nop 0
    buffer_load_dwordx4 v11, s[48:51], s60 offen offset:0 lds
    v_and_b32 v34, 15, v0
    v_sub_u32 v34, v34, v5
    v_lshlrev_b32 v34, 4, v34
    s_add_u32 s69, s97, 192
    v_add_u32 v7, s69, v34
    v_mov_b32 v5, s99
    buffer_load_dwordx4 v11, s[48:51], s61 offen offset:1024 lds
    v_subrev_u32 v8, 16, v0
    v_add_u32 v9, 47, v0
    v_cmp_gt_u32 vcc, 16, v0
    v_mov_b32 v34, 63
    s_lshl_b32 s69, s34, 2
    v_cndmask_b32 v8, v8, v9, vcc
    v_add_u32 v10, 128, v10
    v_add_u32 v11, s63, v11
    v_cmp_eq_u32 vcc, 0, v0
    s_add_u32 s69, s69, 156192
    v_mov_b32 v9, s69
    v_cndmask_b32 v8, v8, v34, vcc
    v_lshlrev_b32 v8, 2, v8
    s_waitcnt lgkmcnt(0)
    s_lshl_b32 s6, s6, 16
    s_and_b32 s69, s35, 1
    s_lshl_b32 s69, s69, 4
    s_lshr_b32 s7, s7, s69
    s_lshl_b32 s7, s7, 16
    v_mov_b32 v33, s6
    v_add_f32 v33, s7, v33
    v_cvt_pk_bf16_f32 v33, v33, v33
    s_waitcnt vmcnt(10)
    s_barrier
    s_lshl_b32 s97, s34, 2
    s_add_u32 s97, s97, 156288
    v_mov_b32 v28, s97
    v_mov_b32 v29, 1
    s_lshr_b32 s69, s35, 6
    s_lshl_b32 s69, s69, 6
    s_add_u32 s69, s69, 0x110000
    v_and_b32 v31, 15, v0
    v_lshlrev_b32 v31, 2, v31
    buffer_load_dword v20, v31, s[36:39], s69 offen sc1
    s_mov_b32 s97, 0x110800
    buffer_load_dwordx4 v[16:19], v1, s[36:39], s97 offen sc1
    s_waitcnt vmcnt(2)
    ds_write_b32 v28, v29
    s_mul_i32 s52, s34, 4608
    s_add_u32 s52, s52, 98304
    s_mul_i32 s63, s35, 4224
    s_add_u32 s53, s63, 0x700000
    s_mov_b32 s40, s8
    s_mov_b32 s41, s9
    s_mov_b32 s42, 0x200000
    s_mov_b32 s43, 0x00020000
    s_lshl_b32 s62, s34, 10
    s_lshl_b32 s100, s34, 14
    s_lshl_b32 s101, s33, 7
    s_add_u32 s100, s100, s101
    s_waitcnt vmcnt(1)
    v_cmp_ne_u32 vcc, s68, v20
    s_cbranch_vccz F_P1_X
    s_mov_b32 s101, 0
F_P1:
    buffer_load_dword v20, v31, s[36:39], s69 offen sc1
    s_waitcnt vmcnt(0)
    v_cmp_ne_u32 vcc, s68, v20
    s_cbranch_vccz F_P1_X
    s_sleep 8
    s_add_u32 s101, s101, 1
    s_cmp_lt_u32 s101, 400000
    s_cbranch_scc1 F_P1
F_P1_X:
    s_add_u32 m0, s52, 256
    ds_write_b128 v32, v[36:39]
    buffer_load_dwordx4 v1, s[36:39], s53 offen offset:0 sc1 lds
    buffer_load_dwordx4 v1, s[36:39], s53 offen offset:1024 sc1 lds
    s_add_u32 m0, s52, 512
    ds_write_b32 v5, v36 offset:4192
    buffer_load_dwordx4 v1, s[36:39], s53 offen offset:2048 sc1 lds
    buffer_load_dwordx4 v1, s[36:39], s53 offen offset:3072 sc1 lds
    s_add_u32 m0, s62, 81920
    s_add_u32 s101, s100, 0
    buffer_load_dwordx4 v12, s[40:43], s101 offen lds
    s_add_u32 m0, s62, 86016
    s_add_u32 s101, s100, 65536
    buffer_load_dwordx4 v12, s[40:43], s101 offen lds
    s_add_u32 m0, s62, 90112
    s_add_u32 s101, s100, 131072
    buffer_load_dwordx4 v12, s[40:43], s101 offen lds
    s_add_u32 m0, s62, 94208
    s_add_u32 s101, s100, 196608
    buffer_load_dwordx4 v12, s[40:43], s101 offen lds
    s_waitcnt vmcnt(8)
    v_xor_b32 v16, s68, v16
    v_xor_b32 v17, s68, v17
    v_xor_b32 v18, s68, v18
    v_xor_b32 v19, s68, v19
    v_or3_b32 v16, v16, v17, v18
    v_or_b32 v16, v16, v19
    v_cmp_ne_u32 vcc, 0, v16
    s_cbranch_vccz F_P0_X
    s_mov_b32 s101, 0
F_P0:
    buffer_load_dwordx4 v[16:19], v1, s[36:39], s97 offen sc1
    s_waitcnt vmcnt(0)
    v_xor_b32 v16, s68, v16
    v_xor_b32 v17, s68, v17
    v_xor_b32 v18, s68, v18
    v_xor_b32 v19, s68, v19
    v_or3_b32 v16, v16, v17, v18
    v_or_b32 v16, v16, v19
    v_cmp_ne_u32 vcc, 0, v16
    s_cbranch_vccz F_P0_X
    s_sleep 16
    s_add_u32 s101, s101, 1
    s_cmp_lt_u32 s101, 400000
    s_cbranch_scc1 F_P0
F_P0_X:
    ds_write_b32 v28, v29 offset:48
    ds_write_b16 v5, v33 offset:32
    ds_write_b16 v5, v33 offset:4196
F_WG14:
    ds_read_b32 v11, v30 offset:112
    s_waitcnt lgkmcnt(0)
    v_cmp_ne_u32 vcc, 1, v11
    s_cbranch_vccz F_WG14_X
    s_sleep 1
    s_branch F_WG14
F_WG14_X:
    s_add_u32 m0, s62, 0
    s_add_u32 s101, s100, 262144
    buffer_load_dwordx4 v12, s[40:43], s101 offen lds
    s_add_u32 m0, s62, 4096
    s_add_u32 s101, s100, 327680
    buffer_load_dwordx4 v12, s[40:43], s101 offen lds
    s_add_u32 m0, s62, 8192
    s_add_u32 s101, s100, 393216
    buffer_load_dwordx4 v12, s[40:43], s101 offen lds
    s_add_u32 m0, s62, 12288
    s_add_u32 s101, s100, 458752
    buffer_load_dwordx4 v12, s[40:43], s101 offen lds
    s_add_u32 m0, s62, 16384
    s_add_u32 s101, s100, 524288
    buffer_load_dwordx4 v12, s[40:43], s101 offen lds
    s_add_u32 m0, s62, 20480
    s_add_u32 s101, s100, 589824
    buffer_load_dwordx4 v12, s[40:43], s101 offen lds
    s_add_u32 m0, s62, 24576
    s_add_u32 s101, s100, 655360
    buffer_load_dwordx4 v12, s[40:43], s101 offen lds
    s_add_u32 m0, s62, 28672
    s_add_u32 s101, s100, 720896
    buffer_load_dwordx4 v12, s[40:43], s101 offen lds
    s_add_u32 m0, s62, 32768
    s_add_u32 s101, s100, 786432
    buffer_load_dwordx4 v12, s[40:43], s101 offen lds
    s_add_u32 m0, s62, 36864
    s_add_u32 s101, s100, 851968
    buffer_load_dwordx4 v12, s[40:43], s101 offen lds
F_WGDx:
    ds_read_b32 v11, v30 offset:80
    s_waitcnt lgkmcnt(0)
    v_cmp_ne_u32 vcc, 1, v11
    s_cbranch_vccz F_WGDx_X
    s_sleep 1
    s_branch F_WGDx
F_WGDx_X:
    s_add_u32 m0, s62, 40960
    s_add_u32 s101, s100, 917504
    buffer_load_dwordx4 v12, s[40:43], s101 offen lds
    s_add_u32 m0, s62, 45056
    s_add_u32 s101, s100, 983040
    buffer_load_dwordx4 v12, s[40:43], s101 offen lds
    s_add_u32 m0, s62, 49152
    s_add_u32 s101, s100, 1048576
    buffer_load_dwordx4 v12, s[40:43], s101 offen lds
    s_add_u32 m0, s62, 53248
    s_add_u32 s101, s100, 1114112
    buffer_load_dwordx4 v12, s[40:43], s101 offen lds
    s_add_u32 m0, s62, 57344
    s_add_u32 s101, s100, 1179648
    buffer_load_dwordx4 v12, s[40:43], s101 offen lds
    s_add_u32 m0, s62, 61440
    s_add_u32 s101, s100, 1245184
    buffer_load_dwordx4 v12, s[40:43], s101 offen lds
    s_add_u32 m0, s62, 65536
    s_add_u32 s101, s100, 1310720
    buffer_load_dwordx4 v12, s[40:43], s101 offen lds
    s_add_u32 m0, s62, 69632
    s_add_u32 s101, s100, 1376256
    buffer_load_dwordx4 v12, s[40:43], s101 offen lds
    s_add_u32 m0, s62, 73728
    s_add_u32 s101, s100, 1441792
    buffer_load_dwordx4 v12, s[40:43], s101 offen lds
    s_add_u32 m0, s62, 77824
    s_add_u32 s101, s100, 1507328
    buffer_load_dwordx4 v12, s[40:43], s101 offen lds
    s_sleep 24
    s_waitcnt vmcnt(24)
    ds_read_b128 v[76:79], v7 offset:1856
    ds_read_b64_tr_b16 v[16:17], v6 offset:0
    ds_read_b64_tr_b16 v[18:19], v6 offset:4160
    ds_read_b128 v[72:75], v7 offset:1600
    ds_read_b64_tr_b16 v[20:21], v6 offset:512
    ds_read_b64_tr_b16 v[22:23], v6 offset:4672
    ds_read_b128 v[68:71], v7 offset:1344
    ds_read_b64_tr_b16 v[24:25], v6 offset:1024
    ds_read_b64_tr_b16 v[26:27], v6 offset:5184
    ds_read_b128 v[64:67], v7 offset:1088
    ds_read_b64_tr_b16 v[28:29], v6 offset:1536
    ds_read_b64_tr_b16 v[30:31], v6 offset:5696
    ds_read_b128 v[60:63], v7 offset:832
    ds_read_b64_tr_b16 v[32:33], v6 offset:2048
    ds_read_b64_tr_b16 v[34:35], v6 offset:6208
    ds_read_b128 v[56:59], v7 offset:576
    ds_read_b64_tr_b16 v[36:37], v6 offset:2560
    ds_read_b64_tr_b16 v[38:39], v6 offset:6720
    ds_read_b128 v[52:55], v7 offset:320
    ds_read_b64_tr_b16 v[40:41], v6 offset:3072
    ds_read_b64_tr_b16 v[42:43], v6 offset:7232
    ds_read_b128 v[48:51], v7 offset:64
    ds_read_b64_tr_b16 v[44:45], v6 offset:3584
    ds_read_b64_tr_b16 v[46:47], v6 offset:7744
    v_mov_b32 v10, 1
    s_mov_b64 s[60:61], 1
    s_mov_b32 s58, 0
.p2align 6
F_VLOOP:
    s_waitcnt lgkmcnt(15)
    v_mfma_f32_16x16x32_bf16 v[124:127], v[16:19], v[76:79], v[124:127]
    ds_read_b128 v[80:83], v7 offset:2368
    ds_read_b128 v[76:79], v7 offset:4160
    v_mfma_f32_16x16x32_bf16 v[120:123], v[16:19], v[72:75], v[120:123]
    v_mfma_f32_16x16x32_bf16 v[124:127], v[20:23], v[72:75], v[124:127]
    ds_read_b128 v[72:75], v7 offset:3904
    v_mfma_f32_16x16x32_bf16 v[116:119], v[16:19], v[68:71], v[116:119]
    v_mfma_f32_16x16x32_bf16 v[120:123], v[20:23], v[68:71], v[120:123]
    s_waitcnt lgkmcnt(15)
    v_mfma_f32_16x16x32_bf16 v[124:127], v[24:27], v[68:71], v[124:127]
    ds_read_b128 v[68:71], v7 offset:3648
    s_waitcnt lgkmcnt(15)
    v_mfma_f32_16x16x32_bf16 v[112:115], v[16:19], v[64:67], v[112:115]
    v_mfma_f32_16x16x32_bf16 v[116:119], v[20:23], v[64:67], v[116:119]
    v_mfma_f32_16x16x32_bf16 v[120:123], v[24:27], v[64:67], v[120:123]
    v_mfma_f32_16x16x32_bf16 v[124:127], v[28:31], v[64:67], v[124:127]
    ds_read_b128 v[64:67], v7 offset:3392
    s_waitcnt lgkmcnt(15)
    v_mfma_f32_16x16x32_bf16 v[108:111], v[16:19], v[60:63], v[108:111]
    v_mfma_f32_16x16x32_bf16 v[112:115], v[20:23], v[60:63], v[112:115]
    v_mfma_f32_16x16x32_bf16 v[116:119], v[24:27], v[60:63], v[116:119]
    v_mfma_f32_16x16x32_bf16 v[120:123], v[28:31], v[60:63], v[120:123]
    s_waitcnt lgkmcnt(13)
    v_mfma_f32_16x16x32_bf16 v[124:127], v[32:35], v[60:63], v[124:127]
    ds_read_b128 v[60:63], v7 offset:3136
    s_waitcnt lgkmcnt(13)
    v_mfma_f32_16x16x32_bf16 v[104:107], v[16:19], v[56:59], v[104:107]
    v_mfma_f32_16x16x32_bf16 v[108:111], v[20:23], v[56:59], v[108:111]
    v_mfma_f32_16x16x32_bf16 v[112:115], v[24:27], v[56:59], v[112:115]
    v_mfma_f32_16x16x32_bf16 v[116:119], v[28:31], v[56:59], v[116:119]
    v_mfma_f32_16x16x32_bf16 v[120:123], v[32:35], v[56:59], v[120:123]
    s_waitcnt lgkmcnt(11)
    v_mfma_f32_16x16x32_bf16 v[124:127], v[36:39], v[56:59], v[124:127]
    ds_read_b128 v[56:59], v7 offset:2880
    s_waitcnt lgkmcnt(11)
    v_mfma_f32_16x16x32_bf16 v[100:103], v[16:19], v[52:55], v[100:103]
    v_mfma_f32_16x16x32_bf16 v[104:107], v[20:23], v[52:55], v[104:107]
    v_mfma_f32_16x16x32_bf16 v[108:111], v[24:27], v[52:55], v[108:111]
    v_mfma_f32_16x16x32_bf16 v[112:115], v[28:31], v[52:55], v[112:115]
    v_mfma_f32_16x16x32_bf16 v[116:119], v[32:35], v[52:55], v[116:119]
    v_mfma_f32_16x16x32_bf16 v[120:123], v[36:39], v[52:55], v[120:123]
    s_waitcnt lgkmcnt(9)
    v_mfma_f32_16x16x32_bf16 v[124:127], v[40:43], v[52:55], v[124:127]
    ds_read_b128 v[52:55], v7 offset:2624
    s_waitcnt lgkmcnt(10)
    v_mfma_f32_16x16x32_bf16 v[96:99], v[16:19], v[48:51], v[96:99]
    v_mfma_f32_16x16x32_bf16 v[100:103], v[20:23], v[48:51], v[100:103]
    v_mfma_f32_16x16x32_bf16 v[104:107], v[24:27], v[48:51], v[104:107]
    v_mfma_f32_16x16x32_bf16 v[108:111], v[28:31], v[48:51], v[108:111]
    v_mfma_f32_16x16x32_bf16 v[112:115], v[32:35], v[48:51], v[112:115]
    v_mfma_f32_16x16x32_bf16 v[116:119], v[36:39], v[48:51], v[116:119]
    v_mfma_f32_16x16x32_bf16 v[120:123], v[40:43], v[48:51], v[120:123]
    s_waitcnt lgkmcnt(8)
    v_mfma_f32_16x16x32_bf16 v[124:127], v[44:47], v[48:51], v[124:127]
    s_waitcnt lgkmcnt(6)
    v_mfma_f32_16x16x32_bf16 v[156:159], v[16:19], v[76:79], v[156:159]
    ds_read_b128 v[48:51], v7 offset:0
    ds_read_b128 v[76:79], v7 offset:1792
    s_waitcnt lgkmcnt(7)
    v_mfma_f32_16x16x32_bf16 v[152:155], v[16:19], v[72:75], v[152:155]
    s_waitcnt lgkmcnt(6)
    v_mfma_f32_16x16x32_bf16 v[148:151], v[16:19], v[68:71], v[148:151]
    s_waitcnt lgkmcnt(5)
    v_mfma_f32_16x16x32_bf16 v[144:147], v[16:19], v[64:67], v[144:147]
    s_waitcnt lgkmcnt(4)
    v_mfma_f32_16x16x32_bf16 v[140:143], v[16:19], v[60:63], v[140:143]
    s_waitcnt lgkmcnt(3)
    v_mfma_f32_16x16x32_bf16 v[136:139], v[16:19], v[56:59], v[136:139]
    s_waitcnt lgkmcnt(2)
    v_mfma_f32_16x16x32_bf16 v[132:135], v[16:19], v[52:55], v[132:135]
    v_mfma_f32_16x16x32_bf16 v[128:131], v[16:19], v[80:83], v[128:131]
    ds_read_b64_tr_b16 v[16:17], v6 offset:128
    ds_read_b64_tr_b16 v[18:19], v6 offset:4288
    v_mfma_f32_16x16x32_bf16 v[156:159], v[20:23], v[72:75], v[156:159]
    ds_read_b128 v[72:75], v7 offset:1536
    v_mfma_f32_16x16x32_bf16 v[152:155], v[20:23], v[68:71], v[152:155]
    v_mfma_f32_16x16x32_bf16 v[148:151], v[20:23], v[64:67], v[148:151]
    v_mfma_f32_16x16x32_bf16 v[144:147], v[20:23], v[60:63], v[144:147]
    v_mfma_f32_16x16x32_bf16 v[140:143], v[20:23], v[56:59], v[140:143]
    v_mfma_f32_16x16x32_bf16 v[136:139], v[20:23], v[52:55], v[136:139]
    v_mfma_f32_16x16x32_bf16 v[132:135], v[20:23], v[80:83], v[132:135]
    ds_read_b64_tr_b16 v[20:21], v6 offset:640
    ds_read_b64_tr_b16 v[22:23], v6 offset:4800
    v_mfma_f32_16x16x32_bf16 v[156:159], v[24:27], v[68:71], v[156:159]
    ds_read_b128 v[68:71], v7 offset:1280
    v_mfma_f32_16x16x32_bf16 v[152:155], v[24:27], v[64:67], v[152:155]
    v_mfma_f32_16x16x32_bf16 v[148:151], v[24:27], v[60:63], v[148:151]
    v_mfma_f32_16x16x32_bf16 v[144:147], v[24:27], v[56:59], v[144:147]
    v_mfma_f32_16x16x32_bf16 v[140:143], v[24:27], v[52:55], v[140:143]
    v_mfma_f32_16x16x32_bf16 v[136:139], v[24:27], v[80:83], v[136:139]
    ds_read_b64_tr_b16 v[24:25], v6 offset:1152
    ds_read_b64_tr_b16 v[26:27], v6 offset:5312
    v_mfma_f32_16x16x32_bf16 v[156:159], v[28:31], v[64:67], v[156:159]
    ds_read_b128 v[64:67], v7 offset:1024
    v_mfma_f32_16x16x32_bf16 v[152:155], v[28:31], v[60:63], v[152:155]
    v_mfma_f32_16x16x32_bf16 v[148:151], v[28:31], v[56:59], v[148:151]
    v_mfma_f32_16x16x32_bf16 v[144:147], v[28:31], v[52:55], v[144:147]
    v_mfma_f32_16x16x32_bf16 v[140:143], v[28:31], v[80:83], v[140:143]
    ds_read_b64_tr_b16 v[28:29], v6 offset:1664
    ds_read_b64_tr_b16 v[30:31], v6 offset:5824
    v_mfma_f32_16x16x32_bf16 v[156:159], v[32:35], v[60:63], v[156:159]
    ds_read_b128 v[60:63], v7 offset:768
    v_mfma_f32_16x16x32_bf16 v[152:155], v[32:35], v[56:59], v[152:155]
    v_mfma_f32_16x16x32_bf16 v[148:151], v[32:35], v[52:55], v[148:151]
    v_mfma_f32_16x16x32_bf16 v[144:147], v[32:35], v[80:83], v[144:147]
    ds_read_b64_tr_b16 v[32:33], v6 offset:2176
    ds_read_b64_tr_b16 v[34:35], v6 offset:6336
    v_mfma_f32_16x16x32_bf16 v[156:159], v[36:39], v[56:59], v[156:159]
    ds_read_b128 v[56:59], v7 offset:512
    v_mfma_f32_16x16x32_bf16 v[152:155], v[36:39], v[52:55], v[152:155]
    v_mfma_f32_16x16x32_bf16 v[148:151], v[36:39], v[80:83], v[148:151]
    ds_read_b64_tr_b16 v[36:37], v6 offset:2688
    ds_read_b64_tr_b16 v[38:39], v6 offset:6848
    v_mfma_f32_16x16x32_bf16 v[156:159], v[40:43], v[52:55], v[156:159]
    ds_read_b128 v[52:55], v7 offset:256
    v_mfma_f32_16x16x32_bf16 v[152:155], v[40:43], v[80:83], v[152:155]
    ds_read_b64_tr_b16 v[40:41], v6 offset:3200
    ds_read_b64_tr_b16 v[42:43], v6 offset:7360
    v_mfma_f32_16x16x32_bf16 v[156:159], v[44:47], v[80:83], v[156:159]
    ds_read_b64_tr_b16 v[44:45], v6 offset:3712
    ds_read_b64_tr_b16 v[46:47], v6 offset:7872
    s_waitcnt vmcnt(0)
    ds_write_b32 v9, v10 offset:112
    v_add_u32 v6, 128, v6
    v_subrev_u32 v7, 64, v7
    s_add_u32 s58, s58, 1
    s_cmp_lt_u32 s58, 4
    s_cbranch_scc1 F_VLOOP
    s_waitcnt lgkmcnt(0)
    ds_write_b32 v9, v10
    ds_bpermute_b32 v17, v8, v131
    ds_bpermute_b32 v18, v8, v135
    ds_bpermute_b32 v19, v8, v139
    ds_bpermute_b32 v20, v8, v143
    ds_bpermute_b32 v21, v8, v147
    ds_bpermute_b32 v22, v8, v151
    ds_bpermute_b32 v23, v8, v155
    ds_bpermute_b32 v24, v8, v159
    v_mov_b32 v16, 0
    v_add_f32 v97, v97, v128
    v_add_f32 v98, v98, v129
    v_add_f32 v99, v99, v130
    v_add_f32 v101, v101, v132
    v_add_f32 v102, v102, v133
    v_add_f32 v103, v103, v134
    v_add_f32 v105, v105, v136
    v_add_f32 v106, v106, v137
    v_add_f32 v107, v107, v138
    v_add_f32 v109, v109, v140
    v_add_f32 v110, v110, v141
    v_add_f32 v111, v111, v142
    v_add_f32 v113, v113, v144
    v_add_f32 v114, v114, v145
    v_add_f32 v115, v115, v146
    v_add_f32 v117, v117, v148
    v_add_f32 v118, v118, v149
    v_add_f32 v119, v119, v150
    v_add_f32 v121, v121, v152
    v_add_f32 v122, v122, v153
    v_add_f32 v123, v123, v154
    v_add_f32 v125, v125, v156
    v_add_f32 v126, v126, v157
    v_add_f32 v127, v127, v158
    s_waitcnt lgkmcnt(0)
    v_cndmask_b32 v28, v17, v16, s[60:61]
    v_cndmask_b32 v29, v18, v17, s[60:61]
    v_cndmask_b32 v30, v19, v18, s[60:61]
    v_cndmask_b32 v31, v20, v19, s[60:61]
    v_cndmask_b32 v32, v21, v20, s[60:61]
    v_cndmask_b32 v33, v22, v21, s[60:61]
    v_cndmask_b32 v34, v23, v22, s[60:61]
    v_cndmask_b32 v35, v24, v23, s[60:61]
    v_add_f32 v96, v96, v28
    v_add_f32 v100, v100, v29
    v_add_f32 v104, v104, v30
    v_add_f32 v108, v108, v31
    v_add_f32 v112, v112, v32
    v_add_f32 v116, v116, v33
    v_add_f32 v120, v120, v34
    v_add_f32 v124, v124, v35
    v_cvt_pk_bf16_f32 v48, v96, v97
    v_cvt_pk_bf16_f32 v49, v98, v99
    v_cvt_pk_bf16_f32 v50, v100, v101
    v_cvt_pk_bf16_f32 v51, v102, v103
    v_cvt_pk_bf16_f32 v52, v104, v105
    v_cvt_pk_bf16_f32 v53, v106, v107
    v_cvt_pk_bf16_f32 v54, v108, v109
    v_cvt_pk_bf16_f32 v55, v110, v111
    v_cvt_pk_bf16_f32 v56, v112, v113
    v_cvt_pk_bf16_f32 v57, v114, v115
    v_cvt_pk_bf16_f32 v58, v116, v117
    v_cvt_pk_bf16_f32 v59, v118, v119
    v_cvt_pk_bf16_f32 v60, v120, v121
    v_cvt_pk_bf16_f32 v61, v122, v123
    v_cvt_pk_bf16_f32 v62, v124, v125
    v_cvt_pk_bf16_f32 v63, v126, v127
    s_add_u32 s53, s63, 0xc00000
    buffer_store_dwordx4 v[48:51], v1, s[36:39], s53 offen offset:0 sc1
    buffer_store_dwordx4 v[52:55], v1, s[36:39], s53 offen offset:1024 sc1
    buffer_store_dwordx4 v[56:59], v1, s[36:39], s53 offen offset:2048 sc1
    buffer_store_dwordx4 v[60:63], v1, s[36:39], s53 offen offset:3072 sc1
    s_lshr_b32 s54, s35, 2
    s_lshl_b32 s54, s54, 7
    s_lshl_b32 s55, s34, 2
    s_add_u32 s54, s54, s55
    s_add_u32 s54, s54, 0x111000
    v_mov_b32 v14, s68
    s_cmp_ge_u32 s34, 2
    s_cbranch_scc0 F_POST
    v_and_b32 v9, 3, v0
    v_lshlrev_b32 v9, 2, v9
    v_and_b32 v11, 4, v0
    v_lshl_add_u32 v9, v11, 3, v9
    v_add_u32 v9, 156192, v9
F_WL:
    ds_read_b32 v11, v9 offset:0
    s_waitcnt lgkmcnt(0)
    v_cmp_ne_u32 vcc, 1, v11
    s_cbranch_vccz F_WL_X
    s_sleep 1
    s_branch F_WL
F_WL_X:
    s_add_u32 s62, s62, 96256
    s_add_u32 s100, s100, 1540096
    s_add_u32 m0, s62, 0
    s_add_u32 s101, s100, 0
    buffer_load_dwordx4 v12, s[40:43], s101 offen lds
    s_add_u32 m0, s62, 2048
    s_add_u32 s101, s100, 32768
    buffer_load_dwordx4 v12, s[40:43], s101 offen lds
    s_add_u32 m0, s62, 4096
    s_add_u32 s101, s100, 65536
    buffer_load_dwordx4 v12, s[40:43], s101 offen lds
    s_add_u32 m0, s62, 6144
    s_add_u32 s101, s100, 98304
    buffer_load_dwordx4 v12, s[40:43], s101 offen lds
    s_add_u32 m0, s62, 8192
    s_add_u32 s101, s100, 131072
    buffer_load_dwordx4 v12, s[40:43], s101 offen lds
    s_add_u32 m0, s62, 10240
    s_add_u32 s101, s100, 163840
    buffer_load_dwordx4 v12, s[40:43], s101 offen lds
    s_add_u32 m0, s62, 12288
    s_add_u32 s101, s100, 196608
    buffer_load_dwordx4 v12, s[40:43], s101 offen lds
    s_add_u32 m0, s62, 14336
    s_add_u32 s101, s100, 229376
    buffer_load_dwordx4 v12, s[40:43], s101 offen lds
    s_add_u32 m0, s62, 16384
    s_add_u32 s101, s100, 262144
    buffer_load_dwordx4 v12, s[40:43], s101 offen lds
    s_add_u32 m0, s62, 18432
    s_add_u32 s101, s100, 294912
    buffer_load_dwordx4 v12, s[40:43], s101 offen lds
    s_add_u32 m0, s62, 20480
    s_add_u32 s101, s100, 327680
    buffer_load_dwordx4 v12, s[40:43], s101 offen lds
    s_add_u32 m0, s62, 22528
    s_add_u32 s101, s100, 360448
    buffer_load_dwordx4 v12, s[40:43], s101 offen lds
    s_add_u32 m0, s62, 24576
    s_add_u32 s101, s100, 393216
    buffer_load_dwordx4 v12, s[40:43], s101 offen lds
    s_add_u32 m0, s62, 26624
    s_add_u32 s101, s100, 425984
    buffer_load_dwordx4 v12, s[40:43], s101 offen lds
    s_add_u32 m0, s62, 28672
    s_add_u32 s101, s100, 458752
    buffer_load_dwordx4 v12, s[40:43], s101 offen lds
    s_add_u32 m0, s62, 30720
    s_add_u32 s101, s100, 491520
    buffer_load_dwordx4 v12, s[40:43], s101 offen lds
    s_lshl_b32 s58, s34, 2
    s_add_u32 s58, s58, 156200
    v_mov_b32 v9, s58
    s_waitcnt vmcnt(0)
    ds_write_b32 v9, v10
    s_waitcnt lgkmcnt(0)
    s_endpgm
F_POST:
    s_and_b32 s52, s2, 15
    s_lshl_b32 s56, s52, 7
    s_mul_i32 s53, s52, 270336
    s_add_u32 s53, s53, 0xc00000
    s_mov_b32 s44, s22
    s_mov_b32 s45, s23
    s_mov_b32 s46, 0x800000
    s_mov_b32 s47, 0x00020000
    s_mov_b32 s55, 0xffff0000
    s_add_u32 s56, s56, 2048
    s_sleep 40
    s_mov_b32 s101, 0
F_P4:
    s_mov_b32 s54, s53
    buffer_load_dwordx4 v[48:51], v232, s[36:39], s54 offen sc1
    s_add_u32 s54, s54, 4224
    buffer_load_dwordx4 v[52:55], v232, s[36:39], s54 offen sc1
    s_add_u32 s54, s54, 4224
    buffer_load_dwordx4 v[56:59], v232, s[36:39], s54 offen sc1
    s_add_u32 s54, s54, 4224
    buffer_load_dwordx4 v[60:63], v232, s[36:39], s54 offen sc1
    s_add_u32 s54, s54, 4224
    buffer_load_dwordx4 v[64:67], v232, s[36:39], s54 offen sc1
    s_add_u32 s54, s54, 4224
    buffer_load_dwordx4 v[68:71], v232, s[36:39], s54 offen sc1
    s_add_u32 s54, s54, 4224
    buffer_load_dwordx4 v[72:75], v232, s[36:39], s54 offen sc1
    s_add_u32 s54, s54, 4224
    buffer_load_dwordx4 v[76:79], v232, s[36:39], s54 offen sc1
    s_waitcnt vmcnt(0)
    v_max3_u32 v9, v48, v52, v56
    v_max3_u32 v8, v60, v64, v68
    v_max3_u32 v9, v9, v72, v76
    v_max_u32 v9, v9, v8
    v_cmp_eq_u32 vcc, -1, v9
    s_cbranch_vccz F_P4_X
    s_sleep 24
    s_add_u32 s101, s101, 1
    s_cmp_lt_u32 s101, 400000
    s_cbranch_scc1 F_P4
F_P4_X:
    v_lshlrev_b32 v80, 16, v200
    v_lshlrev_b32 v88, 16, v48
    v_and_b32 v81, s55, v200
    v_lshlrev_b32 v89, 16, v52
    v_lshlrev_b32 v82, 16, v201
    v_lshlrev_b32 v90, 16, v56
    v_and_b32 v83, s55, v201
    v_lshlrev_b32 v91, 16, v60
    v_lshlrev_b32 v84, 16, v202
    v_lshlrev_b32 v92, 16, v64
    v_and_b32 v85, s55, v202
    v_lshlrev_b32 v93, 16, v68
    v_lshlrev_b32 v86, 16, v203
    v_lshlrev_b32 v94, 16, v72
    v_and_b32 v87, s55, v203
    v_lshlrev_b32 v95, 16, v76
    v_mul_f32 v80, v80, v88
    v_mul_f32 v81, v81, v89
    v_mul_f32 v82, v82, v90
    v_mul_f32 v83, v83, v91
    v_mul_f32 v84, v84, v92
    v_mul_f32 v85, v85, v93
    v_mul_f32 v86, v86, v94
    v_mul_f32 v87, v87, v95
    v_cvt_pk_bf16_f32 v100, v80, v81
    v_cvt_pk_bf16_f32 v101, v82, v83
    v_cvt_pk_bf16_f32 v102, v84, v85
    v_cvt_pk_bf16_f32 v103, v86, v87
    s_add_u32 s57, s56, 0
    buffer_store_dwordx4 v[100:103], v233, s[44:47], s57 offen sc1
    v_lshlrev_b32 v80, 16, v204
    v_and_b32 v88, s55, v48
    v_and_b32 v81, s55, v204
    v_and_b32 v89, s55, v52
    v_lshlrev_b32 v82, 16, v205
    v_and_b32 v90, s55, v56
    v_and_b32 v83, s55, v205
    v_and_b32 v91, s55, v60
    v_lshlrev_b32 v84, 16, v206
    v_and_b32 v92, s55, v64
    v_and_b32 v85, s55, v206
    v_and_b32 v93, s55, v68
    v_lshlrev_b32 v86, 16, v207
    v_and_b32 v94, s55, v72
    v_and_b32 v87, s55, v207
    v_and_b32 v95, s55, v76
    v_mul_f32 v80, v80, v88
    v_mul_f32 v81, v81, v89
    v_mul_f32 v82, v82, v90
    v_mul_f32 v83, v83, v91
    v_mul_f32 v84, v84, v92
    v_mul_f32 v85, v85, v93
    v_mul_f32 v86, v86, v94
    v_mul_f32 v87, v87, v95
    v_cvt_pk_bf16_f32 v104, v80, v81
    v_cvt_pk_bf16_f32 v105, v82, v83
    v_cvt_pk_bf16_f32 v106, v84, v85
    v_cvt_pk_bf16_f32 v107, v86, v87
    s_add_u32 s57, s56, 4096
    buffer_store_dwordx4 v[104:107], v233, s[44:47], s57 offen sc1
    v_lshlrev_b32 v80, 16, v208
    v_lshlrev_b32 v88, 16, v49
    v_and_b32 v81, s55, v208
    v_lshlrev_b32 v89, 16, v53
    v_lshlrev_b32 v82, 16, v209
    v_lshlrev_b32 v90, 16, v57
    v_and_b32 v83, s55, v209
    v_lshlrev_b32 v91, 16, v61
    v_lshlrev_b32 v84, 16, v210
    v_lshlrev_b32 v92, 16, v65
    v_and_b32 v85, s55, v210
    v_lshlrev_b32 v93, 16, v69
    v_lshlrev_b32 v86, 16, v211
    v_lshlrev_b32 v94, 16, v73
    v_and_b32 v87, s55, v211
    v_lshlrev_b32 v95, 16, v77
    v_mul_f32 v80, v80, v88
    v_mul_f32 v81, v81, v89
    v_mul_f32 v82, v82, v90
    v_mul_f32 v83, v83, v91
    v_mul_f32 v84, v84, v92
    v_mul_f32 v85, v85, v93
    v_mul_f32 v86, v86, v94
    v_mul_f32 v87, v87, v95
    v_cvt_pk_bf16_f32 v108, v80, v81
    v_cvt_pk_bf16_f32 v109, v82, v83
    v_cvt_pk_bf16_f32 v110, v84, v85
    v_cvt_pk_bf16_f32 v111, v86, v87
    s_add_u32 s57, s56, 8192
    buffer_store_dwordx4 v[108:111], v233, s[44:47], s57 offen sc1
    v_lshlrev_b32 v80, 16, v212
    v_and_b32 v88, s55, v49
    v_and_b32 v81, s55, v212
    v_and_b32 v89, s55, v53
    v_lshlrev_b32 v82, 16, v213
    v_and_b32 v90, s55, v57
    v_and_b32 v83, s55, v213
    v_and_b32 v91, s55, v61
    v_lshlrev_b32 v84, 16, v214
    v_and_b32 v92, s55, v65
    v_and_b32 v85, s55, v214
    v_and_b32 v93, s55, v69
    v_lshlrev_b32 v86, 16, v215
    v_and_b32 v94, s55, v73
    v_and_b32 v87, s55, v215
    v_and_b32 v95, s55, v77
    v_mul_f32 v80, v80, v88
    v_mul_f32 v81, v81, v89
    v_mul_f32 v82, v82, v90
    v_mul_f32 v83, v83, v91
    v_mul_f32 v84, v84, v92
    v_mul_f32 v85, v85, v93
    v_mul_f32 v86, v86, v94
    v_mul_f32 v87, v87, v95
    v_cvt_pk_bf16_f32 v112, v80, v81
    v_cvt_pk_bf16_f32 v113, v82, v83
    v_cvt_pk_bf16_f32 v114, v84, v85
    v_cvt_pk_bf16_f32 v115, v86, v87
    s_add_u32 s57, s56, 12288
    buffer_store_dwordx4 v[112:115], v233, s[44:47], s57 offen sc1
    v_lshlrev_b32 v80, 16, v216
    v_lshlrev_b32 v88, 16, v50
    v_and_b32 v81, s55, v216
    v_lshlrev_b32 v89, 16, v54
    v_lshlrev_b32 v82, 16, v217
    v_lshlrev_b32 v90, 16, v58
    v_and_b32 v83, s55, v217
    v_lshlrev_b32 v91, 16, v62
    v_lshlrev_b32 v84, 16, v218
    v_lshlrev_b32 v92, 16, v66
    v_and_b32 v85, s55, v218
    v_lshlrev_b32 v93, 16, v70
    v_lshlrev_b32 v86, 16, v219
    v_lshlrev_b32 v94, 16, v74
    v_and_b32 v87, s55, v219
    v_lshlrev_b32 v95, 16, v78
    v_mul_f32 v80, v80, v88
    v_mul_f32 v81, v81, v89
    v_mul_f32 v82, v82, v90
    v_mul_f32 v83, v83, v91
    v_mul_f32 v84, v84, v92
    v_mul_f32 v85, v85, v93
    v_mul_f32 v86, v86, v94
    v_mul_f32 v87, v87, v95
    v_cvt_pk_bf16_f32 v116, v80, v81
    v_cvt_pk_bf16_f32 v117, v82, v83
    v_cvt_pk_bf16_f32 v118, v84, v85
    v_cvt_pk_bf16_f32 v119, v86, v87
    s_add_u32 s57, s56, 1048576
    buffer_store_dwordx4 v[116:119], v233, s[44:47], s57 offen sc1
    v_lshlrev_b32 v80, 16, v220
    v_and_b32 v88, s55, v50
    v_and_b32 v81, s55, v220
    v_and_b32 v89, s55, v54
    v_lshlrev_b32 v82, 16, v221
    v_and_b32 v90, s55, v58
    v_and_b32 v83, s55, v221
    v_and_b32 v91, s55, v62
    v_lshlrev_b32 v84, 16, v222
    v_and_b32 v92, s55, v66
    v_and_b32 v85, s55, v222
    v_and_b32 v93, s55, v70
    v_lshlrev_b32 v86, 16, v223
    v_and_b32 v94, s55, v74
    v_and_b32 v87, s55, v223
    v_and_b32 v95, s55, v78
    v_mul_f32 v80, v80, v88
    v_mul_f32 v81, v81, v89
    v_mul_f32 v82, v82, v90
    v_mul_f32 v83, v83, v91
    v_mul_f32 v84, v84, v92
    v_mul_f32 v85, v85, v93
    v_mul_f32 v86, v86, v94
    v_mul_f32 v87, v87, v95
    v_cvt_pk_bf16_f32 v120, v80, v81
    v_cvt_pk_bf16_f32 v121, v82, v83
    v_cvt_pk_bf16_f32 v122, v84, v85
    v_cvt_pk_bf16_f32 v123, v86, v87
    s_add_u32 s57, s56, 1052672
    buffer_store_dwordx4 v[120:123], v233, s[44:47], s57 offen sc1
    v_lshlrev_b32 v80, 16, v224
    v_lshlrev_b32 v88, 16, v51
    v_and_b32 v81, s55, v224
    v_lshlrev_b32 v89, 16, v55
    v_lshlrev_b32 v82, 16, v225
    v_lshlrev_b32 v90, 16, v59
    v_and_b32 v83, s55, v225
    v_lshlrev_b32 v91, 16, v63
    v_lshlrev_b32 v84, 16, v226
    v_lshlrev_b32 v92, 16, v67
    v_and_b32 v85, s55, v226
    v_lshlrev_b32 v93, 16, v71
    v_lshlrev_b32 v86, 16, v227
    v_lshlrev_b32 v94, 16, v75
    v_and_b32 v87, s55, v227
    v_lshlrev_b32 v95, 16, v79
    v_mul_f32 v80, v80, v88
    v_mul_f32 v81, v81, v89
    v_mul_f32 v82, v82, v90
    v_mul_f32 v83, v83, v91
    v_mul_f32 v84, v84, v92
    v_mul_f32 v85, v85, v93
    v_mul_f32 v86, v86, v94
    v_mul_f32 v87, v87, v95
    v_cvt_pk_bf16_f32 v124, v80, v81
    v_cvt_pk_bf16_f32 v125, v82, v83
    v_cvt_pk_bf16_f32 v126, v84, v85
    v_cvt_pk_bf16_f32 v127, v86, v87
    s_add_u32 s57, s56, 1056768
    buffer_store_dwordx4 v[124:127], v233, s[44:47], s57 offen sc1
    v_lshlrev_b32 v80, 16, v228
    v_and_b32 v88, s55, v51
    v_and_b32 v81, s55, v228
    v_and_b32 v89, s55, v55
    v_lshlrev_b32 v82, 16, v229
    v_and_b32 v90, s55, v59
    v_and_b32 v83, s55, v229
    v_and_b32 v91, s55, v63
    v_lshlrev_b32 v84, 16, v230
    v_and_b32 v92, s55, v67
    v_and_b32 v85, s55, v230
    v_and_b32 v93, s55, v71
    v_lshlrev_b32 v86, 16, v231
    v_and_b32 v94, s55, v75
    v_and_b32 v87, s55, v231
    v_and_b32 v95, s55, v79
    v_mul_f32 v80, v80, v88
    v_mul_f32 v81, v81, v89
    v_mul_f32 v82, v82, v90
    v_mul_f32 v83, v83, v91
    v_mul_f32 v84, v84, v92
    v_mul_f32 v85, v85, v93
    v_mul_f32 v86, v86, v94
    v_mul_f32 v87, v87, v95
    v_cvt_pk_bf16_f32 v128, v80, v81
    v_cvt_pk_bf16_f32 v129, v82, v83
    v_cvt_pk_bf16_f32 v130, v84, v85
    v_cvt_pk_bf16_f32 v131, v86, v87
    s_add_u32 s57, s56, 1060864
    buffer_store_dwordx4 v[128:131], v233, s[44:47], s57 offen sc1
    s_endpgm
F_C:
    s_load_dwordx8 s[20:27], s[0:1], 64
    s_and_b32 s32, s29, 3
    s_lshr_b32 s33, s28, 1
    s_lshl_b32 s33, s33, 2
    s_add_u32 s32, s32, s33
    s_and_b32 s33, s28, 1
    s_lshl_b32 s33, s33, 3
    s_lshr_b32 s35, s29, 2
    s_add_u32 s33, s33, s35
    v_lshlrev_b32 v1, 4, v0
    s_lshr_b32 s34, s3, 1
    s_and_b32 s35, s3, 1
    v_and_b32 v16, 15, v0
    v_lshrrev_b32 v17, 4, v0
    v_lshrrev_b32 v18, 1, v16
    v_xor_b32 v18, v18, v17
    v_lshlrev_b32 v18, 4, v18
    v_and_b32 v19, 7, v0
    v_lshl_add_u32 v18, v19, 7, v18
    v_bfe_u32 v19, v0, 3, 1
    v_mul_u32_u24 v19, 10240, v19
    s_lshl_b32 s40, s34, 11
    s_add_u32 s40, s40, 40960
    v_add3_u32 v2, v18, v19, s40
    v_xor_b32 v3, 64, v2
    v_bfe_u32 v18, v0, 2, 2
    v_lshlrev_b32 v18, 7, v18
    v_and_b32 v19, 3, v0
    v_lshl_add_u32 v18, v19, 3, v18
    v_bfe_u32 v19, v0, 3, 2
    v_lshlrev_b32 v19, 5, v19
    v_lshl_add_u32 v207, v17, 9, v18
    v_add_u32 v207, v207, v19
    s_lshl_b32 s40, s35, 6
    s_lshl_b32 s41, s34, 5
    s_or_b32 s40, s40, s41
    v_xor_b32 v19, s40, v19
    v_mul_u32_u24 v20, 10240, v17
    v_add3_u32 v18, v18, v19, v20
    v_add_u32 v4, 45056, v18
    v_xor_b32 v5, 32, v4
    v_mov_b32 v18, 0
    v_lshlrev_b32 v19, 2, v0
    v_add_u32 v20, 156160, v19
    ds_write_b32 v20, v18
    s_mov_b32 s42, 0x358637bd
    s_mov_b32 s43, 0x3fb8aa3b
    s_mov_b32 s49, 0x3f803f80
    v_mov_b32 v104, s42
    v_mov_b32 v105, s42
    v_mov_b32 v106, s42
    v_mov_b32 v107, s42
    v_mov_b32 v108, s42
    v_mov_b32 v109, s42
    v_mov_b32 v110, s42
    v_mov_b32 v111, s42
    v_mov_b32 v112, s42
    v_mov_b32 v113, s42
    v_mov_b32 v114, s42
    v_mov_b32 v115, s42
    v_mov_b32 v116, s42
    v_mov_b32 v117, s42
    v_mov_b32 v118, s42
    v_mov_b32 v119, s42
    v_mov_b32 v120, s42
    v_mov_b32 v121, s42
    v_mov_b32 v122, s42
    v_mov_b32 v123, s42
    v_mov_b32 v124, s42
    v_mov_b32 v125, s42
    v_mov_b32 v126, s42
    v_mov_b32 v127, s42
    v_mov_b32 v128, s42
    v_mov_b32 v129, s42
    v_mov_b32 v130, s42
    v_mov_b32 v131, s42
    v_mov_b32 v132, s42
    v_mov_b32 v133, s42
    v_mov_b32 v134, s42
    v_mov_b32 v135, s42
    v_mov_b32 v136, 0
    v_mov_b32 v137, 0
    v_mov_b32 v138, 0
    v_mov_b32 v139, 0
    v_mov_b32 v140, 0
    v_mov_b32 v141, 0
    v_mov_b32 v142, 0
    v_mov_b32 v143, 0
    v_mov_b32 v144, 0
    v_mov_b32 v145, 0
    v_mov_b32 v146, 0
    v_mov_b32 v147, 0
    v_mov_b32 v148, 0
    v_mov_b32 v149, 0
    v_mov_b32 v150, 0
    v_mov_b32 v151, 0
    v_mov_b32 v152, 0
    v_mov_b32 v153, 0
    v_mov_b32 v154, 0
    v_mov_b32 v155, 0
    v_mov_b32 v156, 0
    v_mov_b32 v157, 0
    v_mov_b32 v158, 0
    v_mov_b32 v159, 0
    v_mov_b32 v160, 0
    v_mov_b32 v161, 0
    v_mov_b32 v162, 0
    v_mov_b32 v163, 0
    v_mov_b32 v164, 0
    v_mov_b32 v165, 0
    v_mov_b32 v166, 0
    v_mov_b32 v167, 0
    v_mov_b32 v168, s42
    v_mov_b32 v169, s42
    v_mov_b32 v170, s42
    v_mov_b32 v171, s42
    v_mov_b32 v172, s42
    v_mov_b32 v173, s42
    v_mov_b32 v174, s42
    v_mov_b32 v175, s42
    v_mov_b32 v176, s42
    v_mov_b32 v177, s42
    v_mov_b32 v178, s42
    v_mov_b32 v179, s42
    v_mov_b32 v180, s42
    v_mov_b32 v181, s42
    v_mov_b32 v182, s42
    v_mov_b32 v183, s42
    v_mov_b32 v184, s42
    v_mov_b32 v185, s42
    v_mov_b32 v186, s42
    v_mov_b32 v187, s42
    v_mov_b32 v188, s42
    v_mov_b32 v189, s42
    v_mov_b32 v190, s42
    v_mov_b32 v191, s42
    v_mov_b32 v192, s42
    v_mov_b32 v193, s42
    v_mov_b32 v194, s42
    v_mov_b32 v195, s42
    v_mov_b32 v196, s42
    v_mov_b32 v197, s42
    v_mov_b32 v198, s42
    v_mov_b32 v199, s42
    s_and_b32 s40, s3, 1
    s_lshl_b32 s41, s31, 1
    s_add_u32 s40, s40, s41
    s_lshr_b32 s41, s3, 1
    s_lshl_b32 s52, s30, 1
    s_add_u32 s52, s52, s41
    s_mul_i32 s52, s52, 132
    s_add_u32 s52, s52, s40
    s_lshl_b32 s52, s52, 10
    s_add_u32 s52, s52, 0x200000
    s_lshl_b32 s50, s40, 15
    s_lshl_b32 s51, s41, 10
    s_add_u32 s53, s50, s51
    s_lshl_b32 s50, s30, 11
    s_add_u32 s50, s50, s53
    s_lshl_b32 s40, s40, 11
    s_add_u32 s54, s40, s51
    s_add_u32 s54, s54, 0x100000
    s_lshl_b32 s51, s30, 6
    s_add_u32 s51, s51, s54
    s_mul_i32 s40, s35, 2304
    s_add_u32 s58, s40, 156416
    s_add_u32 s59, s40, 116736
    s_cmp_eq_u32 s34, 0
    s_cselect_b32 s40, s58, s59
    s_cselect_b32 s41, s59, s58
    v_lshlrev_b32 v12, 4, v17
    v_add_u32 v6, s40, v1
    v_add_u32 v7, s41, v1
    v_add_u32 v8, s40, v12
    v_add_u32 v9, s41, v12
    s_lshl_b32 s40, s3, 3
    s_add_u32 s41, s40, 156160
    v_mov_b32 v10, s41
    v_xor_b32 v11, 16, v10
    v_lshl_add_u32 v13, v16, 6, v12
    s_lshl_b32 s40, s34, 3
    s_add_u32 s41, s59, s40
    v_add_u32 v200, s41, v1
    v_xor_b32 v201, 8, v200
    s_add_u32 s41, s58, s40
    v_add_u32 v203, s41, v1
    v_xor_b32 v202, 8, v203
    s_lshl_b32 s40, s3, 2
    s_add_u32 s41, s40, 156240
    v_mov_b32 v204, s41
    s_add_u32 s41, s40, 156224
    v_mov_b32 v206, s41
    v_lshlrev_b32 v18, 1, v17
    v_and_b32 v20, 7, v0
    v_xor_b32 v18, v18, v20
    v_lshlrev_b32 v18, 4, v18
    v_lshrrev_b32 v20, 3, v0
    v_lshl_add_u32 v205, v20, 11, v18
    v_mov_b32 v14, 1
    v_and_b32 v18, 12, v19
    v_add_u32 v209, 156160, v18
    v_add_u32 v211, 144, v209
    v_add_u32 v20, 160, v209
    v_subrev_u32 v21, 12, v0
    v_cmp_gt_u32 vcc, 12, v21
    v_and_b32 v18, 4, v19
    v_add_u32 v18, 156208, v18
    v_cndmask_b32 v211, v211, v20, vcc
    v_and_b32 v21, 31, v0
    v_cmp_lt_u32 vcc, 23, v21
    s_nop 1
    v_cndmask_b32 v211, v211, v18, vcc
    s_lshl_b32 s55, s32, 2
    s_add_u32 s55, s55, s3
    s_lshl_b32 s56, s55, 17
    s_lshl_b32 s40, s33, 7
    s_add_u32 s56, s56, s40
    s_mul_i32 s55, s55, 67584
    s_add_u32 s55, s55, 0x200000
    v_and_b32 v18, 31, v0
    v_add_u32 v18, 33, v18
    s_xor_b32 s40, s35, 1
    s_mul_i32 s40, s40, 66
    v_add_u32 v18, s40, v18
    v_lshlrev_b32 v208, 10, v18
    s_and_b32 s57, s33, 7
    s_mul_i32 s57, s57, 3
    s_lshr_b32 s57, s57, 2
    v_lshlrev_b32 v210, 12, v16
    v_bfe_u32 v18, v0, 4, 1
    v_lshl_add_u32 v210, v18, 5, v210
    v_lshrrev_b32 v18, 5, v0
    v_lshl_add_u32 v210, v18, 4, v210
    s_mov_b32 s44, 0
    s_mov_b32 s45, 1
    s_mov_b32 s46, 0xfffec000
    s_mov_b32 s47, 40960
    s_waitcnt lgkmcnt(0)
    s_mov_b32 s36, s26
    s_mov_b32 s37, s27
    s_mov_b32 s38, 0x10000000
    s_mov_b32 s39, 0x00020000
    s_mov_b32 s60, s22
    s_mov_b32 s61, s23
    s_mov_b32 s62, 0x800000
    s_mov_b32 s63, 0x00020000
    s_mov_b32 s64, s26
    s_mov_b32 s65, s27
    s_mov_b32 s66, 0x10000000
    s_mov_b32 s67, 0x00020000
    s_mov_b32 s4, s8
    s_mov_b32 s5, s9
    s_mov_b32 s6, 0x200000
    s_mov_b32 s7, 0x00020000
    s_lshl_b32 s68, s3, 10
    s_lshl_b32 s69, s3, 14
    s_lshl_b32 s40, s33, 7
    s_add_u32 s69, s69, s40
    s_barrier
    ds_read_b64_tr_b16 v[80:81], v4 offset:1024
    ds_read_b64_tr_b16 v[82:83], v4 offset:1536
    ds_read_b128 v[16:19], v2 offset:0
    ds_read_b64_tr_b16 v[84:85], v4 offset:4096
    ds_read_b64_tr_b16 v[86:87], v4 offset:4608
    ds_read_b128 v[20:23], v3 offset:0
    ds_read_b128 v[24:27], v2 offset:20480
    ds_read_b128 v[28:31], v3 offset:20480
    ds_read_b128 v[32:35], v2 offset:1024
    ds_read_b128 v[36:39], v3 offset:1024
    ds_read_b64_tr_b16 v[88:89], v5 offset:1024
    ds_read_b64_tr_b16 v[90:91], v5 offset:1536
    ds_read_b64_tr_b16 v[92:93], v5 offset:4096
    ds_read_b64_tr_b16 v[94:95], v5 offset:4608
    ds_read_b128 v[40:43], v2 offset:21504
    ds_read_b128 v[44:47], v3 offset:21504
.p2align 6
F_CLOOP:
    s_waitcnt lgkmcnt(8)
    v_mfma_f32_16x16x32_bf16 v[104:107], v[16:19], v[80:83], v[104:107]
    ds_read_b64_tr_b16 v[96:97], v4 offset:2048
    v_mfma_f32_16x16x32_bf16 v[104:107], v[20:23], v[84:87], v[104:107]
    ds_read_b64_tr_b16 v[98:99], v4 offset:2560
    v_mfma_f32_16x16x32_bf16 v[108:111], v[24:27], v[80:83], v[108:111]
    ds_read_b64_tr_b16 v[100:101], v4 offset:5120
    v_mfma_f32_16x16x32_bf16 v[108:111], v[28:31], v[84:87], v[108:111]
    ds_read_b64_tr_b16 v[102:103], v4 offset:5632
    s_waitcnt lgkmcnt(4)
    v_mfma_f32_16x16x32_bf16 v[112:115], v[32:35], v[80:83], v[112:115]
    v_mfma_f32_16x16x32_bf16 v[112:115], v[36:39], v[84:87], v[112:115]
    v_mfma_f32_16x16x32_bf16 v[116:119], v[40:43], v[80:83], v[116:119]
    v_mfma_f32_16x16x32_bf16 v[116:119], v[44:47], v[84:87], v[116:119]
    v_mfma_f32_16x16x32_bf16 v[120:123], v[16:19], v[88:91], v[120:123]
    ds_read_b64_tr_b16 v[80:81], v5 offset:2048
    v_mfma_f32_16x16x32_bf16 v[120:123], v[20:23], v[92:95], v[120:123]
    ds_read_b64_tr_b16 v[82:83], v5 offset:2560
    v_mfma_f32_16x16x32_bf16 v[124:127], v[24:27], v[88:91], v[124:127]
    ds_read_b64_tr_b16 v[84:85], v5 offset:5120
    v_mfma_f32_16x16x32_bf16 v[124:127], v[28:31], v[92:95], v[124:127]
    ds_read_b64_tr_b16 v[86:87], v5 offset:5632
    v_mfma_f32_16x16x32_bf16 v[128:131], v[32:35], v[88:91], v[128:131]
    v_mfma_f32_16x16x32_bf16 v[128:131], v[36:39], v[92:95], v[128:131]
    v_mfma_f32_16x16x32_bf16 v[132:135], v[40:43], v[88:91], v[132:135]
    v_mfma_f32_16x16x32_bf16 v[132:135], v[44:47], v[92:95], v[132:135]
    s_waitcnt lgkmcnt(4)
    v_mfma_f32_16x16x32_bf16 v[136:139], v[16:19], v[96:99], v[136:139]
    ds_read_b64_tr_b16 v[88:89], v4 offset:0
    v_mfma_f32_16x16x32_bf16 v[136:139], v[20:23], v[100:103], v[136:139]
    ds_read_b64_tr_b16 v[90:91], v4 offset:512
    v_mfma_f32_16x16x32_bf16 v[140:143], v[24:27], v[96:99], v[140:143]
    ds_read_b64_tr_b16 v[92:93], v4 offset:3072
    v_mfma_f32_16x16x32_bf16 v[140:143], v[28:31], v[100:103], v[140:143]
    ds_read_b64_tr_b16 v[94:95], v4 offset:3584
    v_mfma_f32_16x16x32_bf16 v[144:147], v[32:35], v[96:99], v[144:147]
    v_mfma_f32_16x16x32_bf16 v[144:147], v[36:39], v[100:103], v[144:147]
    s_add_u32 s44, s44, 1
    v_mfma_f32_16x16x32_bf16 v[148:151], v[40:43], v[96:99], v[148:151]
    v_mfma_f32_16x16x32_bf16 v[148:151], v[44:47], v[100:103], v[148:151]
    s_waitcnt lgkmcnt(4)
    v_mfma_f32_16x16x32_bf16 v[152:155], v[16:19], v[80:83], v[152:155]
    ds_read_b64_tr_b16 v[96:97], v5 offset:0
    v_mfma_f32_16x16x32_bf16 v[152:155], v[20:23], v[84:87], v[152:155]
    ds_read_b64_tr_b16 v[98:99], v5 offset:512
    v_mfma_f32_16x16x32_bf16 v[156:159], v[24:27], v[80:83], v[156:159]
    ds_read_b64_tr_b16 v[100:101], v5 offset:3072
    v_mfma_f32_16x16x32_bf16 v[156:159], v[28:31], v[84:87], v[156:159]
    ds_read_b64_tr_b16 v[102:103], v5 offset:3584
    v_mfma_f32_16x16x32_bf16 v[160:163], v[32:35], v[80:83], v[160:163]
    s_add_u32 s45, s45, 1
    s_cmp_eq_u32 s45, 3
    v_mfma_f32_16x16x32_bf16 v[160:163], v[36:39], v[84:87], v[160:163]
    s_cselect_b32 s48, s46, s47
    s_cselect_b32 s45, 0, s45
    v_mfma_f32_16x16x32_bf16 v[164:167], v[40:43], v[80:83], v[164:167]
    v_add_u32 v4, s48, v4
    v_add_u32 v2, s48, v2
    v_mfma_f32_16x16x32_bf16 v[164:167], v[44:47], v[84:87], v[164:167]
    v_add_u32 v3, s48, v3
    v_add_u32 v5, s48, v5
    s_waitcnt lgkmcnt(0)
    v_mfma_f32_16x16x32_bf16 v[168:171], v[88:91], v[16:19], v[168:171]
    s_cmp_lt_u32 s44, 8
    s_cbranch_scc0 F_CNB0
    s_barrier
F_CB0:
    v_mfma_f32_16x16x32_bf16 v[168:171], v[92:95], v[20:23], v[168:171]
    ds_read_b64_tr_b16 v[80:81], v4 offset:1024
    ds_read_b64_tr_b16 v[82:83], v4 offset:1536
    v_mfma_f32_16x16x32_bf16 v[172:175], v[88:91], v[24:27], v[172:175]
    ds_read_b128 v[48:51], v2 offset:0
    ds_read_b64_tr_b16 v[84:85], v4 offset:4096
    v_mfma_f32_16x16x32_bf16 v[172:175], v[92:95], v[28:31], v[172:175]
    ds_read_b64_tr_b16 v[86:87], v4 offset:4608
    v_mfma_f32_16x16x32_bf16 v[176:179], v[88:91], v[32:35], v[176:179]
    ds_read_b128 v[52:55], v3 offset:0
    v_mfma_f32_16x16x32_bf16 v[176:179], v[92:95], v[36:39], v[176:179]
    ds_read_b128 v[56:59], v2 offset:20480
    v_mfma_f32_16x16x32_bf16 v[180:183], v[88:91], v[40:43], v[180:183]
    ds_read_b128 v[60:63], v3 offset:20480
    v_mfma_f32_16x16x32_bf16 v[180:183], v[92:95], v[44:47], v[180:183]
    v_mfma_f32_16x16x32_bf16 v[184:187], v[96:99], v[16:19], v[184:187]
    ds_read_b128 v[64:67], v2 offset:1024
    ds_read_b128 v[68:71], v3 offset:1024
    v_mfma_f32_16x16x32_bf16 v[184:187], v[100:103], v[20:23], v[184:187]
    ds_read_b64_tr_b16 v[88:89], v5 offset:1024
    ds_read_b64_tr_b16 v[90:91], v5 offset:1536
    v_mfma_f32_16x16x32_bf16 v[188:191], v[96:99], v[24:27], v[188:191]
    ds_read_b64_tr_b16 v[92:93], v5 offset:4096
    ds_read_b64_tr_b16 v[94:95], v5 offset:4608
    v_mfma_f32_16x16x32_bf16 v[188:191], v[100:103], v[28:31], v[188:191]
    ds_read_b128 v[72:75], v2 offset:21504
    v_mfma_f32_16x16x32_bf16 v[192:195], v[96:99], v[32:35], v[192:195]
    ds_read_b128 v[76:79], v3 offset:21504
    v_mfma_f32_16x16x32_bf16 v[192:195], v[100:103], v[36:39], v[192:195]
    v_mfma_f32_16x16x32_bf16 v[196:199], v[96:99], v[40:43], v[196:199]
    v_mfma_f32_16x16x32_bf16 v[196:199], v[100:103], v[44:47], v[196:199]
    s_waitcnt lgkmcnt(8)
    v_mfma_f32_16x16x32_bf16 v[104:107], v[48:51], v[80:83], v[104:107]
    ds_read_b64_tr_b16 v[96:97], v4 offset:2048
    v_mfma_f32_16x16x32_bf16 v[104:107], v[52:55], v[84:87], v[104:107]
    ds_read_b64_tr_b16 v[98:99], v4 offset:2560
    v_mfma_f32_16x16x32_bf16 v[108:111], v[56:59], v[80:83], v[108:111]
    ds_read_b64_tr_b16 v[100:101], v4 offset:5120
    v_mfma_f32_16x16x32_bf16 v[108:111], v[60:63], v[84:87], v[108:111]
    ds_read_b64_tr_b16 v[102:103], v4 offset:5632
    s_waitcnt lgkmcnt(4)
    v_mfma_f32_16x16x32_bf16 v[112:115], v[64:67], v[80:83], v[112:115]
    v_mfma_f32_16x16x32_bf16 v[112:115], v[68:71], v[84:87], v[112:115]
    v_mfma_f32_16x16x32_bf16 v[116:119], v[72:75], v[80:83], v[116:119]
    v_mfma_f32_16x16x32_bf16 v[116:119], v[76:79], v[84:87], v[116:119]
    v_mfma_f32_16x16x32_bf16 v[120:123], v[48:51], v[88:91], v[120:123]
    ds_read_b64_tr_b16 v[80:81], v5 offset:2048
    v_mfma_f32_16x16x32_bf16 v[120:123], v[52:55], v[92:95], v[120:123]
    ds_read_b64_tr_b16 v[82:83], v5 offset:2560
    v_mfma_f32_16x16x32_bf16 v[124:127], v[56:59], v[88:91], v[124:127]
    ds_read_b64_tr_b16 v[84:85], v5 offset:5120
    v_mfma_f32_16x16x32_bf16 v[124:127], v[60:63], v[92:95], v[124:127]
    ds_read_b64_tr_b16 v[86:87], v5 offset:5632
    v_mfma_f32_16x16x32_bf16 v[128:131], v[64:67], v[88:91], v[128:131]
    v_mfma_f32_16x16x32_bf16 v[128:131], v[68:71], v[92:95], v[128:131]
    v_mfma_f32_16x16x32_bf16 v[132:135], v[72:75], v[88:91], v[132:135]
    v_mfma_f32_16x16x32_bf16 v[132:135], v[76:79], v[92:95], v[132:135]
    s_waitcnt lgkmcnt(4)
    v_mfma_f32_16x16x32_bf16 v[136:139], v[48:51], v[96:99], v[136:139]
    ds_read_b64_tr_b16 v[88:89], v4 offset:0
    v_mfma_f32_16x16x32_bf16 v[136:139], v[52:55], v[100:103], v[136:139]
    ds_read_b64_tr_b16 v[90:91], v4 offset:512
    v_mfma_f32_16x16x32_bf16 v[140:143], v[56:59], v[96:99], v[140:143]
    ds_read_b64_tr_b16 v[92:93], v4 offset:3072
    v_mfma_f32_16x16x32_bf16 v[140:143], v[60:63], v[100:103], v[140:143]
    ds_read_b64_tr_b16 v[94:95], v4 offset:3584
    v_mfma_f32_16x16x32_bf16 v[144:147], v[64:67], v[96:99], v[144:147]
    v_mfma_f32_16x16x32_bf16 v[144:147], v[68:71], v[100:103], v[144:147]
    v_mfma_f32_16x16x32_bf16 v[148:151], v[72:75], v[96:99], v[148:151]
    v_mfma_f32_16x16x32_bf16 v[148:151], v[76:79], v[100:103], v[148:151]
    s_waitcnt lgkmcnt(4)
    v_mfma_f32_16x16x32_bf16 v[152:155], v[48:51], v[80:83], v[152:155]
    ds_read_b64_tr_b16 v[96:97], v5 offset:0
    v_mfma_f32_16x16x32_bf16 v[152:155], v[52:55], v[84:87], v[152:155]
    ds_read_b64_tr_b16 v[98:99], v5 offset:512
    v_mfma_f32_16x16x32_bf16 v[156:159], v[56:59], v[80:83], v[156:159]
    ds_read_b64_tr_b16 v[100:101], v5 offset:3072
    v_mfma_f32_16x16x32_bf16 v[156:159], v[60:63], v[84:87], v[156:159]
    ds_read_b64_tr_b16 v[102:103], v5 offset:3584
    v_mfma_f32_16x16x32_bf16 v[160:163], v[64:67], v[80:83], v[160:163]
    s_add_u32 s45, s45, 1
    s_cmp_eq_u32 s45, 3
    v_mfma_f32_16x16x32_bf16 v[160:163], v[68:71], v[84:87], v[160:163]
    s_cselect_b32 s48, s46, s47
    s_cselect_b32 s45, 0, s45
    v_mfma_f32_16x16x32_bf16 v[164:167], v[72:75], v[80:83], v[164:167]
    v_add_u32 v4, s48, v4
    v_add_u32 v2, s48, v2
    v_mfma_f32_16x16x32_bf16 v[164:167], v[76:79], v[84:87], v[164:167]
    v_add_u32 v3, s48, v3
    v_add_u32 v5, s48, v5
    s_waitcnt lgkmcnt(0)
    v_mfma_f32_16x16x32_bf16 v[168:171], v[88:91], v[48:51], v[168:171]
    s_cmp_lt_u32 s44, 8
    s_cbranch_scc0 F_CNB1
    s_barrier
F_CB1:
    v_mfma_f32_16x16x32_bf16 v[168:171], v[92:95], v[52:55], v[168:171]
    ds_read_b64_tr_b16 v[80:81], v4 offset:1024
    ds_read_b64_tr_b16 v[82:83], v4 offset:1536
    v_mfma_f32_16x16x32_bf16 v[172:175], v[88:91], v[56:59], v[172:175]
    ds_read_b128 v[16:19], v2 offset:0
    ds_read_b64_tr_b16 v[84:85], v4 offset:4096
    v_mfma_f32_16x16x32_bf16 v[172:175], v[92:95], v[60:63], v[172:175]
    ds_read_b64_tr_b16 v[86:87], v4 offset:4608
    v_mfma_f32_16x16x32_bf16 v[176:179], v[88:91], v[64:67], v[176:179]
    ds_read_b128 v[20:23], v3 offset:0
    v_mfma_f32_16x16x32_bf16 v[176:179], v[92:95], v[68:71], v[176:179]
    ds_read_b128 v[24:27], v2 offset:20480
    v_mfma_f32_16x16x32_bf16 v[180:183], v[88:91], v[72:75], v[180:183]
    ds_read_b128 v[28:31], v3 offset:20480
    v_mfma_f32_16x16x32_bf16 v[180:183], v[92:95], v[76:79], v[180:183]
    v_mfma_f32_16x16x32_bf16 v[184:187], v[96:99], v[48:51], v[184:187]
    ds_read_b128 v[32:35], v2 offset:1024
    ds_read_b128 v[36:39], v3 offset:1024
    v_mfma_f32_16x16x32_bf16 v[184:187], v[100:103], v[52:55], v[184:187]
    ds_read_b64_tr_b16 v[88:89], v5 offset:1024
    ds_read_b64_tr_b16 v[90:91], v5 offset:1536
    v_mfma_f32_16x16x32_bf16 v[188:191], v[96:99], v[56:59], v[188:191]
    ds_read_b64_tr_b16 v[92:93], v5 offset:4096
    ds_read_b64_tr_b16 v[94:95], v5 offset:4608
    v_mfma_f32_16x16x32_bf16 v[188:191], v[100:103], v[60:63], v[188:191]
    ds_read_b128 v[40:43], v2 offset:21504
    v_mfma_f32_16x16x32_bf16 v[192:195], v[96:99], v[64:67], v[192:195]
    ds_read_b128 v[44:47], v3 offset:21504
    v_mfma_f32_16x16x32_bf16 v[192:195], v[100:103], v[68:71], v[192:195]
    v_mfma_f32_16x16x32_bf16 v[196:199], v[96:99], v[72:75], v[196:199]
    v_mfma_f32_16x16x32_bf16 v[196:199], v[100:103], v[76:79], v[196:199]
    s_cbranch_scc1 F_CLOOP
    s_setprio 3
    s_mov_b32 s46, s43
    s_mov_b32 s47, s43
    v_mul_f32 v244, s43, v104
    v_mul_f32 v245, s43, v105
    v_mul_f32 v246, s43, v106
    v_mul_f32 v247, s43, v107
    v_mul_f32 v248, s43, v108
    v_mul_f32 v249, s43, v109
    v_mul_f32 v250, s43, v110
    v_mul_f32 v251, s43, v111
    v_exp_f32 v244, v244 clamp
    v_max_f32 v104, s42, v104
    v_exp_f32 v245, v245 clamp
    v_max_f32 v105, s42, v105
    v_exp_f32 v246, v246 clamp
    v_max_f32 v106, s42, v106
    v_exp_f32 v247, v247 clamp
    v_max_f32 v107, s42, v107
    v_exp_f32 v248, v248 clamp
    v_max_f32 v108, s42, v108
    v_exp_f32 v249, v249 clamp
    v_max_f32 v109, s42, v109
    v_exp_f32 v250, v250 clamp
    v_max_f32 v110, s42, v110
    v_exp_f32 v251, v251 clamp
    v_max_f32 v111, s42, v111
    v_add_f32 v244, v244, v104
    v_add_f32 v245, v245, v105
    v_add_f32 v246, v246, v106
    v_add_f32 v247, v247, v107
    v_add_f32 v248, v248, v108
    v_add_f32 v249, v249, v109
    v_add_f32 v250, v250, v110
    v_add_f32 v251, v251, v111
    v_cvt_pk_bf16_f32 v212, v244, v245
    v_cvt_pk_bf16_f32 v213, v246, v247
    v_cvt_pk_bf16_f32 v214, v248, v249
    v_cvt_pk_bf16_f32 v215, v250, v251
    v_mov_b32 v252, s49
    v_mov_b32 v253, s49
    v_mov_b32 v254, s49
    v_mov_b32 v255, s49
    v_cvt_pk_bf16_f32 v228, v136, v137
    v_cvt_pk_bf16_f32 v229, v138, v139
    v_cvt_pk_bf16_f32 v230, v140, v141
    v_cvt_pk_bf16_f32 v231, v142, v143
    v_cvt_pk_bf16_f32 v232, v144, v145
    v_cvt_pk_bf16_f32 v233, v146, v147
    v_cvt_pk_bf16_f32 v234, v148, v149
    v_cvt_pk_bf16_f32 v235, v150, v151
    v_cvt_pk_bf16_f32 v236, v152, v153
    v_cvt_pk_bf16_f32 v237, v154, v155
    v_cvt_pk_bf16_f32 v238, v156, v157
    v_cvt_pk_bf16_f32 v239, v158, v159
    v_cvt_pk_bf16_f32 v240, v160, v161
    v_cvt_pk_bf16_f32 v241, v162, v163
    v_cvt_pk_bf16_f32 v242, v164, v165
    v_cvt_pk_bf16_f32 v243, v166, v167
    v_mfma_f32_16x16x32_bf16 v[140:143], v[212:215], v[236:239], 0
    v_mfma_f32_16x16x32_bf16 v[136:139], v[212:215], v[228:231], 0
    v_mfma_f32_16x16x32_bf16 v[152:155], v[212:215], v[252:255], 0
    v_mul_f32 v244, s43, v120
    v_mul_f32 v245, s43, v121
    v_mul_f32 v246, s43, v122
    v_mul_f32 v247, s43, v123
    v_mul_f32 v248, s43, v124
    v_mul_f32 v249, s43, v125
    v_mul_f32 v250, s43, v126
    v_mul_f32 v251, s43, v127
    v_exp_f32 v244, v244 clamp
    v_max_f32 v120, s42, v120
    v_exp_f32 v245, v245 clamp
    v_max_f32 v121, s42, v121
    v_exp_f32 v246, v246 clamp
    v_max_f32 v122, s42, v122
    v_exp_f32 v247, v247 clamp
    v_max_f32 v123, s42, v123
    v_exp_f32 v248, v248 clamp
    v_max_f32 v124, s42, v124
    v_exp_f32 v249, v249 clamp
    v_max_f32 v125, s42, v125
    v_exp_f32 v250, v250 clamp
    v_max_f32 v126, s42, v126
    v_exp_f32 v251, v251 clamp
    v_max_f32 v127, s42, v127
    v_add_f32 v244, v244, v120
    v_add_f32 v245, v245, v121
    v_add_f32 v246, v246, v122
    v_add_f32 v247, v247, v123
    v_add_f32 v248, v248, v124
    v_add_f32 v249, v249, v125
    v_add_f32 v250, v250, v126
    v_add_f32 v251, v251, v127
    v_cvt_pk_bf16_f32 v216, v244, v245
    v_cvt_pk_bf16_f32 v217, v246, v247
    v_cvt_pk_bf16_f32 v218, v248, v249
    v_cvt_pk_bf16_f32 v219, v250, v251
    s_nop 1
    v_mfma_f32_16x16x32_bf16 v[148:151], v[216:219], v[236:239], 0
    v_mfma_f32_16x16x32_bf16 v[144:147], v[216:219], v[228:231], 0
    v_mfma_f32_16x16x32_bf16 v[156:159], v[216:219], v[252:255], 0
    v_mul_f32 v244, s43, v112
    v_mul_f32 v245, s43, v113
    v_mul_f32 v246, s43, v114
    v_mul_f32 v247, s43, v115
    v_mul_f32 v248, s43, v116
    v_mul_f32 v249, s43, v117
    v_mul_f32 v250, s43, v118
    v_mul_f32 v251, s43, v119
    v_exp_f32 v244, v244 clamp
    v_max_f32 v112, s42, v112
    v_exp_f32 v245, v245 clamp
    v_max_f32 v113, s42, v113
    v_exp_f32 v246, v246 clamp
    v_max_f32 v114, s42, v114
    v_exp_f32 v247, v247 clamp
    v_max_f32 v115, s42, v115
    v_exp_f32 v248, v248 clamp
    v_max_f32 v116, s42, v116
    v_exp_f32 v249, v249 clamp
    v_max_f32 v117, s42, v117
    v_exp_f32 v250, v250 clamp
    v_max_f32 v118, s42, v118
    v_exp_f32 v251, v251 clamp
    v_max_f32 v119, s42, v119
    v_add_f32 v244, v244, v112
    v_add_f32 v245, v245, v113
    v_add_f32 v246, v246, v114
    v_add_f32 v247, v247, v115
    v_add_f32 v248, v248, v116
    v_add_f32 v249, v249, v117
    v_add_f32 v250, v250, v118
    v_add_f32 v251, v251, v119
    v_cvt_pk_bf16_f32 v212, v244, v245
    v_cvt_pk_bf16_f32 v213, v246, v247
    v_cvt_pk_bf16_f32 v214, v248, v249
    v_cvt_pk_bf16_f32 v215, v250, v251
    s_nop 1
    v_mfma_f32_16x16x32_bf16 v[140:143], v[212:215], v[240:243], v[140:143]
    v_mfma_f32_16x16x32_bf16 v[136:139], v[212:215], v[232:235], v[136:139]
    v_mfma_f32_16x16x32_bf16 v[152:155], v[212:215], v[252:255], v[152:155]
    v_mul_f32 v244, s43, v128
    v_mul_f32 v245, s43, v129
    v_mul_f32 v246, s43, v130
    v_mul_f32 v247, s43, v131
    v_mul_f32 v248, s43, v132
    v_mul_f32 v249, s43, v133
    v_mul_f32 v250, s43, v134
    v_mul_f32 v251, s43, v135
    v_exp_f32 v244, v244 clamp
    v_max_f32 v128, s42, v128
    v_exp_f32 v245, v245 clamp
    v_max_f32 v129, s42, v129
    v_exp_f32 v246, v246 clamp
    v_max_f32 v130, s42, v130
    v_exp_f32 v247, v247 clamp
    v_max_f32 v131, s42, v131
    v_exp_f32 v248, v248 clamp
    v_max_f32 v132, s42, v132
    v_exp_f32 v249, v249 clamp
    v_max_f32 v133, s42, v133
    v_exp_f32 v250, v250 clamp
    v_max_f32 v134, s42, v134
    v_exp_f32 v251, v251 clamp
    v_max_f32 v135, s42, v135
    v_add_f32 v244, v244, v128
    v_add_f32 v245, v245, v129
    v_add_f32 v246, v246, v130
    v_add_f32 v247, v247, v131
    v_add_f32 v248, v248, v132
    v_add_f32 v249, v249, v133
    v_add_f32 v250, v250, v134
    v_add_f32 v251, v251, v135
    v_cvt_pk_bf16_f32 v216, v244, v245
    v_cvt_pk_bf16_f32 v217, v246, v247
    v_cvt_pk_bf16_f32 v218, v248, v249
    v_cvt_pk_bf16_f32 v219, v250, v251
    s_nop 1
    v_mfma_f32_16x16x32_bf16 v[148:151], v[216:219], v[240:243], v[148:151]
    v_mfma_f32_16x16x32_bf16 v[144:147], v[216:219], v[232:235], v[144:147]
    v_mfma_f32_16x16x32_bf16 v[156:159], v[216:219], v[252:255], v[156:159]
    ds_write_b128 v6, v[140:143]
    s_nop 4
    ds_write_b128 v6, v[148:151] offset:1024
    s_nop 0
    ds_write_b128 v8, v[156:159] offset:2048
    ds_write_b32 v10, v14
F_XA:
    ds_read_b32 v15, v11
    ds_read_b128 v[212:215], v7 offset:1024
    ds_read_b128 v[216:219], v7
    ds_read_b128 v[220:223], v9 offset:2048
    ds_read_b32 v233, v209 offset:176
    s_waitcnt lgkmcnt(0)
    v_cmp_ne_u32 vcc, 1, v15
    s_cbranch_vccnz F_XA
    v_add_f32 v212, v212, v136
    v_add_f32 v213, v213, v137
    v_add_f32 v214, v214, v138
    v_add_f32 v215, v215, v139
    v_add_f32 v216, v216, v144
    v_add_f32 v217, v217, v145
    v_add_f32 v218, v218, v146
    v_add_f32 v219, v219, v147
    v_cvt_pk_bf16_f32 v224, v212, v213
    v_cvt_pk_bf16_f32 v225, v214, v215
    v_cvt_pk_bf16_f32 v226, v216, v217
    v_cvt_pk_bf16_f32 v227, v218, v219
    buffer_store_dwordx4 v[224:227], v1, s[36:39], s50 offen sc1
    v_add_f32 v220, v220, v152
    v_add_f32 v221, v221, v153
    v_add_f32 v222, v222, v154
    v_add_f32 v223, v223, v155
    s_mov_b32 exec_lo, 0x00010001
    s_mov_b32 exec_hi, 0x00010001
    buffer_store_dwordx4 v[220:223], v12, s[36:39], s51 offen sc1
    s_mov_b64 exec, -1
    v_cmp_ne_u32 vcc, 1, v233
    s_cbranch_vccz F_WGO_X
F_WGO:
    ds_read_b32 v15, v209 offset:176
    s_waitcnt lgkmcnt(0)
    v_cmp_ne_u32 vcc, 1, v15
    s_cbranch_vccz F_WGO_X
    s_sleep 1
    s_branch F_WGO
F_WGO_X:
    buffer_load_dwordx4 v[100:103], v13, s[36:39], s54 offen sc1
    v_mov_b32 v112, s42
    v_mov_b32 v113, s42
    v_mov_b32 v114, s42
    v_mov_b32 v115, s42
    v_bfe_u32 v116, v0, 2, 2
    v_lshrrev_b32 v117, 4, v0
    v_cmp_eq_u32 vcc, v116, v117
    v_and_b32 v116, 1, v0
    v_lshlrev_b32 v116, 4, v116
    v_mov_b32 v117, 0x3f80
    v_lshlrev_b32 v116, v116, v117
    v_cndmask_b32 v116, 0, v116, vcc
    v_and_b32 v117, 2, v0
    v_cmp_eq_u32 vcc, 0, v117
    v_mov_b32 v142, 0
    v_mov_b32 v143, 0
    v_mov_b32 v144, 0
    v_mov_b32 v145, 0
    v_cndmask_b32 v140, 0, v116, vcc
    v_cndmask_b32 v146, 0, v116, vcc
    v_cndmask_b32 v141, v116, v142, vcc
    v_cndmask_b32 v147, v116, v142, vcc
    v_mul_f32 v244, s43, v168
    v_mul_f32 v245, s43, v169
    v_mul_f32 v246, s43, v170
    v_mul_f32 v247, s43, v171
    v_mul_f32 v248, s43, v184
    v_mul_f32 v249, s43, v185
    v_mul_f32 v250, s43, v186
    v_mul_f32 v251, s43, v187
    v_exp_f32 v244, v244 clamp
    v_max_f32 v168, s42, v168
    v_exp_f32 v245, v245 clamp
    v_max_f32 v169, s42, v169
    v_exp_f32 v246, v246 clamp
    v_max_f32 v170, s42, v170
    v_exp_f32 v247, v247 clamp
    v_max_f32 v171, s42, v171
    v_exp_f32 v248, v248 clamp
    v_max_f32 v184, s42, v184
    v_exp_f32 v249, v249 clamp
    v_max_f32 v185, s42, v185
    v_exp_f32 v250, v250 clamp
    v_max_f32 v186, s42, v186
    v_exp_f32 v251, v251 clamp
    v_max_f32 v187, s42, v187
    v_add_f32 v244, v244, v168
    v_add_f32 v245, v245, v169
    v_add_f32 v246, v246, v170
    v_add_f32 v247, v247, v171
    v_add_f32 v248, v248, v184
    v_add_f32 v249, v249, v185
    v_add_f32 v250, v250, v186
    v_add_f32 v251, v251, v187
    v_cvt_pk_bf16_f32 v84, v244, v245
    v_cvt_pk_bf16_f32 v85, v246, v247
    v_cvt_pk_bf16_f32 v86, v248, v249
    v_cvt_pk_bf16_f32 v87, v250, v251
    v_mul_f32 v244, s43, v172
    v_mul_f32 v245, s43, v173
    v_mul_f32 v246, s43, v174
    v_mul_f32 v247, s43, v175
    v_mul_f32 v248, s43, v188
    v_mul_f32 v249, s43, v189
    v_mul_f32 v250, s43, v190
    v_mul_f32 v251, s43, v191
    v_exp_f32 v244, v244 clamp
    v_max_f32 v172, s42, v172
    v_exp_f32 v245, v245 clamp
    v_max_f32 v173, s42, v173
    v_exp_f32 v246, v246 clamp
    v_max_f32 v174, s42, v174
    v_exp_f32 v247, v247 clamp
    v_max_f32 v175, s42, v175
    v_exp_f32 v248, v248 clamp
    v_max_f32 v188, s42, v188
    v_exp_f32 v249, v249 clamp
    v_max_f32 v189, s42, v189
    v_exp_f32 v250, v250 clamp
    v_max_f32 v190, s42, v190
    v_exp_f32 v251, v251 clamp
    v_max_f32 v191, s42, v191
    v_add_f32 v244, v244, v172
    v_add_f32 v245, v245, v173
    v_add_f32 v246, v246, v174
    v_add_f32 v247, v247, v175
    v_add_f32 v248, v248, v188
    v_add_f32 v249, v249, v189
    v_add_f32 v250, v250, v190
    v_add_f32 v251, v251, v191
    v_cvt_pk_bf16_f32 v88, v244, v245
    v_cvt_pk_bf16_f32 v89, v246, v247
    v_cvt_pk_bf16_f32 v90, v248, v249
    v_cvt_pk_bf16_f32 v91, v250, v251
    s_mov_b32 s58, 0
    s_waitcnt vmcnt(0)
    v_cmp_eq_u32 vcc, -1, v100
    s_cbranch_vccnz F_K1N
    s_lshl_b32 s59, s30, 12
    s_and_b32 s59, s59, 0x7fff
    s_add_u32 s40, s59, s53
    buffer_load_dwordx4 v[16:19], v1, s[36:39], s40 offen offset:0 sc1
    v_add_f32_dpp v120, v100, v100 row_ror:8 row_mask:0xf bank_mask:0xf
    v_add_f32_dpp v121, v101, v101 row_ror:8 row_mask:0xf bank_mask:0xf
    buffer_load_dwordx4 v[20:23], v1, s[36:39], s40 offen offset:2048 sc1
    v_add_f32_dpp v122, v102, v102 row_ror:8 row_mask:0xf bank_mask:0xf
    v_add_f32_dpp v123, v103, v103 row_ror:8 row_mask:0xf bank_mask:0xf
    s_add_u32 s59, s59, 4096
    s_and_b32 s59, s59, 0x7fff
    s_add_u32 s40, s59, s53
    buffer_load_dwordx4 v[24:27], v1, s[36:39], s40 offen offset:0 sc1
    v_add_f32_dpp v120, v120, v120 row_ror:4 row_mask:0xf bank_mask:0xf
    v_add_f32_dpp v121, v121, v121 row_ror:4 row_mask:0xf bank_mask:0xf
    buffer_load_dwordx4 v[28:31], v1, s[36:39], s40 offen offset:2048 sc1
    v_add_f32_dpp v122, v122, v122 row_ror:4 row_mask:0xf bank_mask:0xf
    v_add_f32_dpp v123, v123, v123 row_ror:4 row_mask:0xf bank_mask:0xf
    s_add_u32 s59, s59, 4096
    s_and_b32 s59, s59, 0x7fff
    s_add_u32 s40, s59, s53
    buffer_load_dwordx4 v[32:35], v1, s[36:39], s40 offen offset:0 sc1
    v_add_f32_dpp v120, v120, v120 row_ror:2 row_mask:0xf bank_mask:0xf
    v_add_f32_dpp v121, v121, v121 row_ror:2 row_mask:0xf bank_mask:0xf
    buffer_load_dwordx4 v[36:39], v1, s[36:39], s40 offen offset:2048 sc1
    v_add_f32_dpp v122, v122, v122 row_ror:2 row_mask:0xf bank_mask:0xf
    v_add_f32_dpp v123, v123, v123 row_ror:2 row_mask:0xf bank_mask:0xf
    s_add_u32 s59, s59, 4096
    s_and_b32 s59, s59, 0x7fff
    s_add_u32 s40, s59, s53
    buffer_load_dwordx4 v[40:43], v1, s[36:39], s40 offen offset:0 sc1
    v_add_f32_dpp v120, v120, v120 row_ror:1 row_mask:0xf bank_mask:0xf
    v_add_f32_dpp v121, v121, v121 row_ror:1 row_mask:0xf bank_mask:0xf
    buffer_load_dwordx4 v[44:47], v1, s[36:39], s40 offen offset:2048 sc1
    v_add_f32_dpp v122, v122, v122 row_ror:1 row_mask:0xf bank_mask:0xf
    v_add_f32_dpp v123, v123, v123 row_ror:1 row_mask:0xf bank_mask:0xf
    s_add_u32 s59, s59, 4096
    s_and_b32 s59, s59, 0x7fff
    s_add_u32 s40, s59, s53
    buffer_load_dwordx4 v[48:51], v1, s[36:39], s40 offen offset:0 sc1
    v_cvt_pk_bf16_f32 v132, v120, v121
    v_cvt_pk_bf16_f32 v133, v122, v123
    buffer_load_dwordx4 v[52:55], v1, s[36:39], s40 offen offset:2048 sc1
    v_mov_b32 v15, 0
    v_mul_f32 v244, s43, v176
    s_add_u32 s59, s59, 4096
    s_and_b32 s59, s59, 0x7fff
    s_add_u32 s40, s59, s53
    buffer_load_dwordx4 v[56:59], v1, s[36:39], s40 offen offset:0 sc1
    v_mul_f32 v245, s43, v177
    v_mul_f32 v246, s43, v178
    buffer_load_dwordx4 v[60:63], v1, s[36:39], s40 offen offset:2048 sc1
    v_mul_f32 v247, s43, v179
    v_mul_f32 v248, s43, v192
    s_add_u32 s59, s59, 4096
    s_and_b32 s59, s59, 0x7fff
    s_add_u32 s40, s59, s53
    buffer_load_dwordx4 v[64:67], v1, s[36:39], s40 offen offset:0 sc1
    v_mul_f32 v249, s43, v193
    v_mul_f32 v250, s43, v194
    buffer_load_dwordx4 v[68:71], v1, s[36:39], s40 offen offset:2048 sc1
    v_mul_f32 v251, s43, v195
    v_exp_f32 v244, v244 clamp
    s_add_u32 s59, s59, 4096
    s_and_b32 s59, s59, 0x7fff
    s_add_u32 s40, s59, s53
    buffer_load_dwordx4 v[72:75], v1, s[36:39], s40 offen offset:0 sc1
    v_max_f32 v176, s42, v176
    v_exp_f32 v245, v245 clamp
    buffer_load_dwordx4 v[76:79], v1, s[36:39], s40 offen offset:2048 sc1
    v_max_f32 v177, s42, v177
    v_exp_f32 v246, v246 clamp
    v_max_f32 v178, s42, v178
    v_exp_f32 v247, v247 clamp
    v_max_f32 v179, s42, v179
    v_exp_f32 v248, v248 clamp
    s_waitcnt vmcnt(14)
    v_mfma_f32_16x16x32_bf16 v[104:107], v[140:143], v[16:19], 0
    v_mfma_f32_16x16x32_bf16 v[108:111], v[144:147], v[16:19], 0
    v_max3_u32 v15, v15, v16, v20
    v_max_f32 v192, s42, v192
    v_exp_f32 v249, v249 clamp
    v_max_f32 v193, s42, v193
    v_exp_f32 v250, v250 clamp
    v_mfma_f32_16x16x32_bf16 v[104:107], v[140:143], v[20:23], v[104:107]
    v_mfma_f32_16x16x32_bf16 v[108:111], v[144:147], v[20:23], v[108:111]
    v_max_f32 v194, s42, v194
    v_exp_f32 v251, v251 clamp
    v_max_f32 v195, s42, v195
    v_add_f32 v244, v244, v176
    s_waitcnt vmcnt(12)
    v_mfma_f32_16x16x32_bf16 v[104:107], v[140:143], v[24:27], v[104:107]
    v_mfma_f32_16x16x32_bf16 v[108:111], v[144:147], v[24:27], v[108:111]
    v_max3_u32 v15, v15, v24, v28
    v_add_f32 v245, v245, v177
    v_add_f32 v246, v246, v178
    v_add_f32 v247, v247, v179
    v_add_f32 v248, v248, v192
    v_mfma_f32_16x16x32_bf16 v[104:107], v[140:143], v[28:31], v[104:107]
    v_mfma_f32_16x16x32_bf16 v[108:111], v[144:147], v[28:31], v[108:111]
    v_add_f32 v249, v249, v193
    v_add_f32 v250, v250, v194
    v_add_f32 v251, v251, v195
    v_cvt_pk_bf16_f32 v92, v244, v245
    s_waitcnt vmcnt(10)
    v_mfma_f32_16x16x32_bf16 v[104:107], v[140:143], v[32:35], v[104:107]
    v_mfma_f32_16x16x32_bf16 v[108:111], v[144:147], v[32:35], v[108:111]
    v_max3_u32 v15, v15, v32, v36
    v_cvt_pk_bf16_f32 v93, v246, v247
    v_cvt_pk_bf16_f32 v94, v248, v249
    v_cvt_pk_bf16_f32 v95, v250, v251
    v_mul_f32 v244, s43, v180
    v_mfma_f32_16x16x32_bf16 v[104:107], v[140:143], v[36:39], v[104:107]
    v_mfma_f32_16x16x32_bf16 v[108:111], v[144:147], v[36:39], v[108:111]
    v_mul_f32 v245, s43, v181
    v_mul_f32 v246, s43, v182
    v_mul_f32 v247, s43, v183
    v_mul_f32 v248, s43, v196
    s_waitcnt vmcnt(8)
    v_mfma_f32_16x16x32_bf16 v[104:107], v[140:143], v[40:43], v[104:107]
    v_mfma_f32_16x16x32_bf16 v[108:111], v[144:147], v[40:43], v[108:111]
    v_max3_u32 v15, v15, v40, v44
    v_mul_f32 v249, s43, v197
    v_mul_f32 v250, s43, v198
    v_mul_f32 v251, s43, v199
    v_exp_f32 v244, v244 clamp
    v_mfma_f32_16x16x32_bf16 v[104:107], v[140:143], v[44:47], v[104:107]
    v_mfma_f32_16x16x32_bf16 v[108:111], v[144:147], v[44:47], v[108:111]
    v_max_f32 v180, s42, v180
    v_exp_f32 v245, v245 clamp
    v_max_f32 v181, s42, v181
    v_exp_f32 v246, v246 clamp
    s_waitcnt vmcnt(6)
    v_mfma_f32_16x16x32_bf16 v[104:107], v[140:143], v[48:51], v[104:107]
    v_mfma_f32_16x16x32_bf16 v[108:111], v[144:147], v[48:51], v[108:111]
    v_max3_u32 v15, v15, v48, v52
    v_max_f32 v182, s42, v182
    v_exp_f32 v247, v247 clamp
    v_max_f32 v183, s42, v183
    v_exp_f32 v248, v248 clamp
    v_mfma_f32_16x16x32_bf16 v[104:107], v[140:143], v[52:55], v[104:107]
    v_mfma_f32_16x16x32_bf16 v[108:111], v[144:147], v[52:55], v[108:111]
    v_max_f32 v196, s42, v196
    v_exp_f32 v249, v249 clamp
    v_max_f32 v197, s42, v197
    v_exp_f32 v250, v250 clamp
    s_waitcnt vmcnt(4)
    v_mfma_f32_16x16x32_bf16 v[104:107], v[140:143], v[56:59], v[104:107]
    v_mfma_f32_16x16x32_bf16 v[108:111], v[144:147], v[56:59], v[108:111]
    v_max3_u32 v15, v15, v56, v60
    v_max_f32 v198, s42, v198
    v_exp_f32 v251, v251 clamp
    v_max_f32 v199, s42, v199
    v_add_f32 v244, v244, v180
    v_mfma_f32_16x16x32_bf16 v[104:107], v[140:143], v[60:63], v[104:107]
    v_mfma_f32_16x16x32_bf16 v[108:111], v[144:147], v[60:63], v[108:111]
    v_add_f32 v245, v245, v181
    v_add_f32 v246, v246, v182
    v_add_f32 v247, v247, v183
    v_add_f32 v248, v248, v196
    s_waitcnt vmcnt(2)
    v_mfma_f32_16x16x32_bf16 v[104:107], v[140:143], v[64:67], v[104:107]
    v_mfma_f32_16x16x32_bf16 v[108:111], v[144:147], v[64:67], v[108:111]
    v_max3_u32 v15, v15, v64, v68
    v_add_f32 v249, v249, v197
    v_add_f32 v250, v250, v198
    v_add_f32 v251, v251, v199
    v_cvt_pk_bf16_f32 v96, v244, v245
    v_mfma_f32_16x16x32_bf16 v[104:107], v[140:143], v[68:71], v[104:107]
    v_mfma_f32_16x16x32_bf16 v[108:111], v[144:147], v[68:71], v[108:111]
    v_cvt_pk_bf16_f32 v97, v246, v247
    v_cvt_pk_bf16_f32 v98, v248, v249
    v_cvt_pk_bf16_f32 v99, v250, v251
    s_waitcnt vmcnt(0)
    v_mfma_f32_16x16x32_bf16 v[104:107], v[140:143], v[72:75], v[104:107]
    v_mfma_f32_16x16x32_bf16 v[108:111], v[144:147], v[72:75], v[108:111]
    v_max3_u32 v15, v15, v72, v76
    v_mfma_f32_16x16x32_bf16 v[104:107], v[140:143], v[76:79], v[104:107]
    v_mfma_f32_16x16x32_bf16 v[108:111], v[144:147], v[76:79], v[108:111]
    v_cmp_eq_u32 vcc, -1, v15
    s_cbranch_vccz F_K2X
    s_branch F_P2_X
F_K1N:
    buffer_load_dwordx4 v[100:103], v13, s[36:39], s54 offen sc1
    v_mul_f32 v244, s43, v176
    v_mul_f32 v245, s43, v177
    v_mul_f32 v246, s43, v178
    v_mul_f32 v247, s43, v179
    v_mul_f32 v248, s43, v192
    v_mul_f32 v249, s43, v193
    v_mul_f32 v250, s43, v194
    v_mul_f32 v251, s43, v195
    v_exp_f32 v244, v244 clamp
    v_max_f32 v176, s42, v176
    v_exp_f32 v245, v245 clamp
    v_max_f32 v177, s42, v177
    v_exp_f32 v246, v246 clamp
    v_max_f32 v178, s42, v178
    v_exp_f32 v247, v247 clamp
    v_max_f32 v179, s42, v179
    v_exp_f32 v248, v248 clamp
    v_max_f32 v192, s42, v192
    v_exp_f32 v249, v249 clamp
    v_max_f32 v193, s42, v193
    v_exp_f32 v250, v250 clamp
    v_max_f32 v194, s42, v194
    v_exp_f32 v251, v251 clamp
    v_max_f32 v195, s42, v195
    v_add_f32 v244, v244, v176
    v_add_f32 v245, v245, v177
    v_add_f32 v246, v246, v178
    v_add_f32 v247, v247, v179
    v_add_f32 v248, v248, v192
    v_add_f32 v249, v249, v193
    v_add_f32 v250, v250, v194
    v_add_f32 v251, v251, v195
    v_cvt_pk_bf16_f32 v92, v244, v245
    v_cvt_pk_bf16_f32 v93, v246, v247
    v_cvt_pk_bf16_f32 v94, v248, v249
    v_cvt_pk_bf16_f32 v95, v250, v251
    v_mul_f32 v244, s43, v180
    v_mul_f32 v245, s43, v181
    v_mul_f32 v246, s43, v182
    v_mul_f32 v247, s43, v183
    v_mul_f32 v248, s43, v196
    v_mul_f32 v249, s43, v197
    v_mul_f32 v250, s43, v198
    v_mul_f32 v251, s43, v199
    v_exp_f32 v244, v244 clamp
    v_max_f32 v180, s42, v180
    v_exp_f32 v245, v245 clamp
    v_max_f32 v181, s42, v181
    v_exp_f32 v246, v246 clamp
    v_max_f32 v182, s42, v182
    v_exp_f32 v247, v247 clamp
    v_max_f32 v183, s42, v183
    v_exp_f32 v248, v248 clamp
    v_max_f32 v196, s42, v196
    v_exp_f32 v249, v249 clamp
    v_max_f32 v197, s42, v197
    v_exp_f32 v250, v250 clamp
    v_max_f32 v198, s42, v198
    v_exp_f32 v251, v251 clamp
    v_max_f32 v199, s42, v199
    v_add_f32 v244, v244, v180
    v_add_f32 v245, v245, v181
    v_add_f32 v246, v246, v182
    v_add_f32 v247, v247, v183
    v_add_f32 v248, v248, v196
    v_add_f32 v249, v249, v197
    v_add_f32 v250, v250, v198
    v_add_f32 v251, v251, v199
    v_cvt_pk_bf16_f32 v96, v244, v245
    v_cvt_pk_bf16_f32 v97, v246, v247
    v_cvt_pk_bf16_f32 v98, v248, v249
    v_cvt_pk_bf16_f32 v99, v250, v251
    s_waitcnt vmcnt(0)
    v_cmp_eq_u32 vcc, -1, v100
    s_cbranch_vccz F_P2_X
    s_mov_b32 s45, 0
F_P2:
    buffer_load_dwordx4 v[100:103], v13, s[36:39], s54 offen sc1
    s_waitcnt vmcnt(0)
    v_cmp_eq_u32 vcc, -1, v100
    s_cbranch_vccz F_P2_X
    s_sleep 1
    s_add_u32 s45, s45, 1
    s_cmp_lt_u32 s45, 400000
    s_cbranch_scc1 F_P2
F_P2_X:
    s_lshl_b32 s59, s30, 12
    s_and_b32 s59, s59, 0x7fff
    s_add_u32 s40, s59, s53
    buffer_load_dwordx4 v[16:19], v1, s[36:39], s40 offen offset:0 sc1
    v_add_f32_dpp v120, v100, v100 row_ror:8 row_mask:0xf bank_mask:0xf
    v_add_f32_dpp v121, v101, v101 row_ror:8 row_mask:0xf bank_mask:0xf
    buffer_load_dwordx4 v[20:23], v1, s[36:39], s40 offen offset:2048 sc1
    v_add_f32_dpp v122, v102, v102 row_ror:8 row_mask:0xf bank_mask:0xf
    v_add_f32_dpp v123, v103, v103 row_ror:8 row_mask:0xf bank_mask:0xf
    s_add_u32 s59, s59, 4096
    s_and_b32 s59, s59, 0x7fff
    s_add_u32 s40, s59, s53
    buffer_load_dwordx4 v[24:27], v1, s[36:39], s40 offen offset:0 sc1
    v_add_f32_dpp v120, v120, v120 row_ror:4 row_mask:0xf bank_mask:0xf
    v_add_f32_dpp v121, v121, v121 row_ror:4 row_mask:0xf bank_mask:0xf
    buffer_load_dwordx4 v[28:31], v1, s[36:39], s40 offen offset:2048 sc1
    v_add_f32_dpp v122, v122, v122 row_ror:4 row_mask:0xf bank_mask:0xf
    v_add_f32_dpp v123, v123, v123 row_ror:4 row_mask:0xf bank_mask:0xf
    s_add_u32 s59, s59, 4096
    s_and_b32 s59, s59, 0x7fff
    s_add_u32 s40, s59, s53
    buffer_load_dwordx4 v[32:35], v1, s[36:39], s40 offen offset:0 sc1
    v_add_f32_dpp v120, v120, v120 row_ror:2 row_mask:0xf bank_mask:0xf
    v_add_f32_dpp v121, v121, v121 row_ror:2 row_mask:0xf bank_mask:0xf
    buffer_load_dwordx4 v[36:39], v1, s[36:39], s40 offen offset:2048 sc1
    v_add_f32_dpp v122, v122, v122 row_ror:2 row_mask:0xf bank_mask:0xf
    v_add_f32_dpp v123, v123, v123 row_ror:2 row_mask:0xf bank_mask:0xf
    s_add_u32 s59, s59, 4096
    s_and_b32 s59, s59, 0x7fff
    s_add_u32 s40, s59, s53
    buffer_load_dwordx4 v[40:43], v1, s[36:39], s40 offen offset:0 sc1
    v_add_f32_dpp v120, v120, v120 row_ror:1 row_mask:0xf bank_mask:0xf
    v_add_f32_dpp v121, v121, v121 row_ror:1 row_mask:0xf bank_mask:0xf
    buffer_load_dwordx4 v[44:47], v1, s[36:39], s40 offen offset:2048 sc1
    v_add_f32_dpp v122, v122, v122 row_ror:1 row_mask:0xf bank_mask:0xf
    v_add_f32_dpp v123, v123, v123 row_ror:1 row_mask:0xf bank_mask:0xf
    s_add_u32 s59, s59, 4096
    s_and_b32 s59, s59, 0x7fff
    s_add_u32 s40, s59, s53
    buffer_load_dwordx4 v[48:51], v1, s[36:39], s40 offen offset:0 sc1
    v_cvt_pk_bf16_f32 v132, v120, v121
    v_cvt_pk_bf16_f32 v133, v122, v123
    buffer_load_dwordx4 v[52:55], v1, s[36:39], s40 offen offset:2048 sc1
    v_mov_b32 v15, 0
    s_add_u32 s59, s59, 4096
    s_and_b32 s59, s59, 0x7fff
    s_add_u32 s40, s59, s53
    buffer_load_dwordx4 v[56:59], v1, s[36:39], s40 offen offset:0 sc1
    buffer_load_dwordx4 v[60:63], v1, s[36:39], s40 offen offset:2048 sc1
    s_add_u32 s59, s59, 4096
    s_and_b32 s59, s59, 0x7fff
    s_add_u32 s40, s59, s53
    buffer_load_dwordx4 v[64:67], v1, s[36:39], s40 offen offset:0 sc1
    buffer_load_dwordx4 v[68:71], v1, s[36:39], s40 offen offset:2048 sc1
    s_add_u32 s59, s59, 4096
    s_and_b32 s59, s59, 0x7fff
    s_add_u32 s40, s59, s53
    buffer_load_dwordx4 v[72:75], v1, s[36:39], s40 offen offset:0 sc1
    buffer_load_dwordx4 v[76:79], v1, s[36:39], s40 offen offset:2048 sc1
    s_waitcnt vmcnt(14)
    v_mfma_f32_16x16x32_bf16 v[104:107], v[140:143], v[16:19], 0
    v_mfma_f32_16x16x32_bf16 v[108:111], v[144:147], v[16:19], 0
    v_max3_u32 v15, v15, v16, v20
    v_mfma_f32_16x16x32_bf16 v[104:107], v[140:143], v[20:23], v[104:107]
    v_mfma_f32_16x16x32_bf16 v[108:111], v[144:147], v[20:23], v[108:111]
    s_waitcnt vmcnt(12)
    v_mfma_f32_16x16x32_bf16 v[104:107], v[140:143], v[24:27], v[104:107]
    v_mfma_f32_16x16x32_bf16 v[108:111], v[144:147], v[24:27], v[108:111]
    v_max3_u32 v15, v15, v24, v28
    v_mfma_f32_16x16x32_bf16 v[104:107], v[140:143], v[28:31], v[104:107]
    v_mfma_f32_16x16x32_bf16 v[108:111], v[144:147], v[28:31], v[108:111]
    s_waitcnt vmcnt(10)
    v_mfma_f32_16x16x32_bf16 v[104:107], v[140:143], v[32:35], v[104:107]
    v_mfma_f32_16x16x32_bf16 v[108:111], v[144:147], v[32:35], v[108:111]
    v_max3_u32 v15, v15, v32, v36
    v_mfma_f32_16x16x32_bf16 v[104:107], v[140:143], v[36:39], v[104:107]
    v_mfma_f32_16x16x32_bf16 v[108:111], v[144:147], v[36:39], v[108:111]
    s_waitcnt vmcnt(8)
    v_mfma_f32_16x16x32_bf16 v[104:107], v[140:143], v[40:43], v[104:107]
    v_mfma_f32_16x16x32_bf16 v[108:111], v[144:147], v[40:43], v[108:111]
    v_max3_u32 v15, v15, v40, v44
    v_mfma_f32_16x16x32_bf16 v[104:107], v[140:143], v[44:47], v[104:107]
    v_mfma_f32_16x16x32_bf16 v[108:111], v[144:147], v[44:47], v[108:111]
    s_waitcnt vmcnt(6)
    v_mfma_f32_16x16x32_bf16 v[104:107], v[140:143], v[48:51], v[104:107]
    v_mfma_f32_16x16x32_bf16 v[108:111], v[144:147], v[48:51], v[108:111]
    v_max3_u32 v15, v15, v48, v52
    v_mfma_f32_16x16x32_bf16 v[104:107], v[140:143], v[52:55], v[104:107]
    v_mfma_f32_16x16x32_bf16 v[108:111], v[144:147], v[52:55], v[108:111]
    s_waitcnt vmcnt(4)
    v_mfma_f32_16x16x32_bf16 v[104:107], v[140:143], v[56:59], v[104:107]
    v_mfma_f32_16x16x32_bf16 v[108:111], v[144:147], v[56:59], v[108:111]
    v_max3_u32 v15, v15, v56, v60
    v_mfma_f32_16x16x32_bf16 v[104:107], v[140:143], v[60:63], v[104:107]
    v_mfma_f32_16x16x32_bf16 v[108:111], v[144:147], v[60:63], v[108:111]
    s_waitcnt vmcnt(2)
    v_mfma_f32_16x16x32_bf16 v[104:107], v[140:143], v[64:67], v[104:107]
    v_mfma_f32_16x16x32_bf16 v[108:111], v[144:147], v[64:67], v[108:111]
    v_max3_u32 v15, v15, v64, v68
    v_mfma_f32_16x16x32_bf16 v[104:107], v[140:143], v[68:71], v[104:107]
    v_mfma_f32_16x16x32_bf16 v[108:111], v[144:147], v[68:71], v[108:111]
    s_waitcnt vmcnt(0)
    v_mfma_f32_16x16x32_bf16 v[104:107], v[140:143], v[72:75], v[104:107]
    v_mfma_f32_16x16x32_bf16 v[108:111], v[144:147], v[72:75], v[108:111]
    v_max3_u32 v15, v15, v72, v76
    v_mfma_f32_16x16x32_bf16 v[104:107], v[140:143], v[76:79], v[104:107]
    v_mfma_f32_16x16x32_bf16 v[108:111], v[144:147], v[76:79], v[108:111]
    v_cmp_eq_u32 vcc, -1, v15
    s_cbranch_vccz F_K2X
    s_add_u32 s58, s58, 1
    s_cmp_gt_u32 s58, 400000
    s_cbranch_scc0 F_P2_X
F_K2X:
    s_nop 4
    v_cvt_pk_bf16_f32 v136, v104, v105
    v_cvt_pk_bf16_f32 v137, v106, v107
    v_cvt_pk_bf16_f32 v138, v108, v109
    v_cvt_pk_bf16_f32 v139, v110, v111
    ds_write_b128 v7, v[136:139]
    ds_write_b64 v9, v[132:133] offset:2048
    ds_write_b32 v10, v14 offset:4
F_XB:
    ds_read_b32 v15, v11 offset:4
    ds_read_b64 v[134:135], v8 offset:2048
    ds_read_b64 v[124:125], v200
    ds_read_b64 v[126:127], v201
    ds_read_b64 v[128:129], v202
    ds_read_b64 v[130:131], v203
    s_waitcnt lgkmcnt(0)
    v_cmp_ne_u32 vcc, 1, v15
    s_cbranch_vccnz F_XB
    v_mfma_f32_16x16x32_bf16 v[140:143], v[132:135], v[84:87], v[112:115]
    v_mfma_f32_16x16x32_bf16 v[144:147], v[132:135], v[88:91], v[112:115]
    v_mfma_f32_16x16x32_bf16 v[148:151], v[132:135], v[92:95], v[112:115]
    v_mfma_f32_16x16x32_bf16 v[152:155], v[132:135], v[96:99], v[112:115]
    v_mfma_f32_16x16x32_bf16 v[156:159], v[124:127], v[84:87], 0
    v_mfma_f32_16x16x32_bf16 v[160:163], v[128:131], v[84:87], 0
    v_mfma_f32_16x16x32_bf16 v[164:167], v[124:127], v[88:91], 0
    v_mfma_f32_16x16x32_bf16 v[168:171], v[128:131], v[88:91], 0
    v_mfma_f32_16x16x32_bf16 v[172:175], v[124:127], v[92:95], 0
    v_mfma_f32_16x16x32_bf16 v[176:179], v[128:131], v[92:95], 0
    v_mfma_f32_16x16x32_bf16 v[180:183], v[124:127], v[96:99], 0
    v_mfma_f32_16x16x32_bf16 v[184:187], v[128:131], v[96:99], 0
    ds_write_b32 v206, v14
    v_rcp_f32 v140, v140
    v_rcp_f32 v144, v144
    v_rcp_f32 v148, v148
    v_rcp_f32 v152, v152
    v_mul_f32 v156, v156, v140
    v_mul_f32 v157, v157, v140
    v_mul_f32 v158, v158, v140
    v_mul_f32 v159, v159, v140
    v_mul_f32 v160, v160, v140
    v_mul_f32 v161, v161, v140
    v_mul_f32 v162, v162, v140
    v_mul_f32 v163, v163, v140
    v_cvt_pk_bf16_f32 v212, v156, v157
    v_cvt_pk_bf16_f32 v213, v158, v159
    v_cvt_pk_bf16_f32 v214, v160, v161
    v_cvt_pk_bf16_f32 v215, v162, v163
    buffer_store_dwordx4 v[212:215], v1, s[36:39], s52 offen sc1
    s_add_u32 s52, s52, 33792
    v_mul_f32 v164, v164, v144
    v_mul_f32 v165, v165, v144
    v_mul_f32 v166, v166, v144
    v_mul_f32 v167, v167, v144
    v_mul_f32 v168, v168, v144
    v_mul_f32 v169, v169, v144
    v_mul_f32 v170, v170, v144
    v_mul_f32 v171, v171, v144
    v_cvt_pk_bf16_f32 v216, v164, v165
    v_cvt_pk_bf16_f32 v217, v166, v167
    v_cvt_pk_bf16_f32 v218, v168, v169
    v_cvt_pk_bf16_f32 v219, v170, v171
    buffer_store_dwordx4 v[216:219], v1, s[36:39], s52 offen sc1
    s_add_u32 s52, s52, 33792
    v_mul_f32 v172, v172, v148
    v_mul_f32 v173, v173, v148
    v_mul_f32 v174, v174, v148
    v_mul_f32 v175, v175, v148
    v_mul_f32 v176, v176, v148
    v_mul_f32 v177, v177, v148
    v_mul_f32 v178, v178, v148
    v_mul_f32 v179, v179, v148
    v_cvt_pk_bf16_f32 v220, v172, v173
    v_cvt_pk_bf16_f32 v221, v174, v175
    v_cvt_pk_bf16_f32 v222, v176, v177
    v_cvt_pk_bf16_f32 v223, v178, v179
    buffer_store_dwordx4 v[220:223], v1, s[36:39], s52 offen sc1
    s_add_u32 s52, s52, 33792
    v_mul_f32 v180, v180, v152
    v_mul_f32 v181, v181, v152
    v_mul_f32 v182, v182, v152
    v_mul_f32 v183, v183, v152
    v_mul_f32 v184, v184, v152
    v_mul_f32 v185, v185, v152
    v_mul_f32 v186, v186, v152
    v_mul_f32 v187, v187, v152
    v_cvt_pk_bf16_f32 v224, v180, v181
    v_cvt_pk_bf16_f32 v225, v182, v183
    v_cvt_pk_bf16_f32 v226, v184, v185
    v_cvt_pk_bf16_f32 v227, v186, v187
    buffer_store_dwordx4 v[224:227], v1, s[36:39], s52 offen sc1
    v_add_u32 v6, 33792, v1
    s_mov_b32 s46, 0x11111111
    s_mov_b32 s50, -1
    s_mov_b32 s51, -1
    v_mov_b32 v16, 0
    v_mov_b32 v17, 0
    v_mov_b32 v18, 0
    v_mov_b32 v19, 0
    v_mov_b32 v20, 0
    v_mov_b32 v21, 0
    v_mov_b32 v22, 0
    v_mov_b32 v23, 0
    v_mov_b32 v24, 0
    v_mov_b32 v25, 0
    v_mov_b32 v26, 0
    v_mov_b32 v27, 0
    v_mov_b32 v28, 0
    v_mov_b32 v29, 0
    v_mov_b32 v30, 0
    v_mov_b32 v31, 0
    v_mov_b32 v32, 0
    v_mov_b32 v33, 0
    v_mov_b32 v34, 0
    v_mov_b32 v35, 0
    v_mov_b32 v36, 0
    v_mov_b32 v37, 0
    v_mov_b32 v38, 0
    v_mov_b32 v39, 0
    v_mov_b32 v40, 0
    v_mov_b32 v41, 0
    v_mov_b32 v42, 0
    v_mov_b32 v43, 0
    v_mov_b32 v44, 0
    v_mov_b32 v45, 0
    v_mov_b32 v46, 0
    v_mov_b32 v47, 0
    s_mov_b32 s47, 0
    s_mov_b32 s54, 0x76432105
    s_mov_b32 s44, 0
    s_mov_b32 s58, 0
    v_mov_b32 v8, 0x80000000
    ds_write_b32 v206, v14 offset:96
    s_sleep 16
.p2align 6
F_GLOOP:
    s_cmp_lt_i32 s50, 0
    s_cbranch_scc1 F_GE0
    s_waitcnt vmcnt(8)
F_GC0:
    v_max3_u32 v15, v80, v84, v88
    v_max3_u32 v7, v92, v96, v100
    v_max3_u32 v15, v15, v104, v108
    v_max_u32 v15, v15, v7
    v_cmp_eq_u32 vcc, -1, v15
    s_cbranch_vccnz F_GF0
F_GK0:
    s_waitcnt lgkmcnt(0)
    v_mfma_f32_16x16x32_bf16 v[16:19], v[48:51], v[80:83], v[16:19]
    ds_read_b64_tr_b16 v[64:65], v2 offset:4096
    ds_read_b64_tr_b16 v[66:67], v2 offset:6144
    v_mfma_f32_16x16x32_bf16 v[32:35], v[48:51], v[84:87], v[32:35]
    ds_read_b64_tr_b16 v[68:69], v3 offset:4096
    ds_read_b64_tr_b16 v[70:71], v3 offset:6144
    v_mfma_f32_16x16x32_bf16 v[20:23], v[52:55], v[80:83], v[20:23]
    ds_read_b64_tr_b16 v[72:73], v4 offset:4096
    ds_read_b64_tr_b16 v[74:75], v4 offset:6144
    v_mfma_f32_16x16x32_bf16 v[36:39], v[52:55], v[84:87], v[36:39]
    ds_read_b64_tr_b16 v[76:77], v5 offset:4096
    ds_read_b64_tr_b16 v[78:79], v5 offset:6144
    v_mfma_f32_16x16x32_bf16 v[24:27], v[56:59], v[80:83], v[24:27]
    v_cmp_eq_u32 vcc, -1, v9
    v_cmp_ne_u32 s[40:41], 1, v10
    s_ashr_i32 s45, s51, 31
    v_mfma_f32_16x16x32_bf16 v[40:43], v[56:59], v[84:87], v[40:43]
    s_or_b32 s45, s45, vcc_lo
    s_or_b32 s45, s45, s40
    s_or_b32 s45, s45, s41
    v_mfma_f32_16x16x32_bf16 v[28:31], v[60:63], v[80:83], v[28:31]
    s_lshr_b32 s40, s45, 1
    s_or_b32 s45, s45, s40
    s_lshr_b32 s40, s45, 2
    v_mfma_f32_16x16x32_bf16 v[44:47], v[60:63], v[84:87], v[44:47]
    s_or_b32 s45, s45, s40
    v_cndmask_b32 v11, v8, v208, vcc
    s_waitcnt lgkmcnt(0)
    v_mfma_f32_16x16x32_bf16 v[16:19], v[64:67], v[88:91], v[16:19]
    ds_read_b64_tr_b16 v[48:49], v2 offset:8192
    ds_read_b64_tr_b16 v[50:51], v2 offset:10240
    s_andn2_b32 s45, s46, s45
    v_mfma_f32_16x16x32_bf16 v[32:35], v[64:67], v[92:95], v[32:35]
    ds_read_b64_tr_b16 v[52:53], v3 offset:8192
    ds_read_b64_tr_b16 v[54:55], v3 offset:10240
    s_cselect_b32 s66, s38, 0
    v_mfma_f32_16x16x32_bf16 v[20:23], v[68:71], v[88:91], v[20:23]
    ds_read_b64_tr_b16 v[56:57], v4 offset:8192
    ds_read_b64_tr_b16 v[58:59], v4 offset:10240
    s_ff1_i32_b32 s50, s45
    v_mfma_f32_16x16x32_bf16 v[36:39], v[68:71], v[92:95], v[36:39]
    ds_read_b64_tr_b16 v[60:61], v5 offset:8192
    ds_read_b64_tr_b16 v[62:63], v5 offset:10240
    s_lshl_b32 s52, s50, 10
    v_mfma_f32_16x16x32_bf16 v[24:27], v[72:75], v[88:91], v[24:27]
    s_add_u32 s52, s52, s55
    s_bitset0_b32 s46, s50
    buffer_load_dword v9, v11, s[36:39], s55 offen offset:1008 sc1
    v_mfma_f32_16x16x32_bf16 v[40:43], v[72:75], v[92:95], v[40:43]
    buffer_load_dwordx4 v[80:83], v1, s[64:67], s52 offen offset:0 sc1
    s_lshr_b32 s48, s54, s51
    v_mfma_f32_16x16x32_bf16 v[28:31], v[76:79], v[88:91], v[28:31]
    buffer_load_dwordx4 v[84:87], v6, s[64:67], s52 offen offset:0 sc1
    s_and_b32 s48, s48, 15
    v_mfma_f32_16x16x32_bf16 v[44:47], v[76:79], v[92:95], v[44:47]
    s_lshl_b32 s48, s48, 14
    s_waitcnt lgkmcnt(0)
    v_mfma_f32_16x16x32_bf16 v[16:19], v[48:51], v[96:99], v[16:19]
    ds_read_b64_tr_b16 v[64:65], v2 offset:12288
    ds_read_b64_tr_b16 v[66:67], v2 offset:14336
    v_mfma_f32_16x16x32_bf16 v[32:35], v[48:51], v[100:103], v[32:35]
    ds_read_b64_tr_b16 v[68:69], v3 offset:12288
    ds_read_b64_tr_b16 v[70:71], v3 offset:14336
    v_mfma_f32_16x16x32_bf16 v[20:23], v[52:55], v[96:99], v[20:23]
    ds_read_b64_tr_b16 v[72:73], v4 offset:12288
    ds_read_b64_tr_b16 v[74:75], v4 offset:14336
    v_mfma_f32_16x16x32_bf16 v[36:39], v[52:55], v[100:103], v[36:39]
    ds_read_b64_tr_b16 v[76:77], v5 offset:12288
    ds_read_b64_tr_b16 v[78:79], v5 offset:14336
    v_mfma_f32_16x16x32_bf16 v[24:27], v[56:59], v[96:99], v[24:27]
    buffer_load_dwordx4 v[88:91], v1, s[64:67], s52 offen offset:1024 sc1
    v_add_u32 v2, s48, v207
    v_mfma_f32_16x16x32_bf16 v[40:43], v[56:59], v[100:103], v[40:43]
    buffer_load_dwordx4 v[92:95], v6, s[64:67], s52 offen offset:1024 sc1
    v_xor_b32 v3, 32, v2
    v_mfma_f32_16x16x32_bf16 v[28:31], v[60:63], v[96:99], v[28:31]
    v_xor_b32 v4, 64, v2
    v_xor_b32 v5, 96, v2
    v_mfma_f32_16x16x32_bf16 v[44:47], v[60:63], v[100:103], v[44:47]
    s_waitcnt lgkmcnt(0)
    v_mfma_f32_16x16x32_bf16 v[16:19], v[64:67], v[104:107], v[16:19]
    ds_read_b64_tr_b16 v[48:49], v2 offset:0
    ds_read_b64_tr_b16 v[50:51], v2 offset:2048
    v_mfma_f32_16x16x32_bf16 v[32:35], v[64:67], v[108:111], v[32:35]
    ds_read_b64_tr_b16 v[52:53], v3 offset:0
    ds_read_b64_tr_b16 v[54:55], v3 offset:2048
    v_mfma_f32_16x16x32_bf16 v[20:23], v[68:71], v[104:107], v[20:23]
    ds_read_b64_tr_b16 v[56:57], v4 offset:0
    ds_read_b64_tr_b16 v[58:59], v4 offset:2048
    v_mfma_f32_16x16x32_bf16 v[36:39], v[68:71], v[108:111], v[36:39]
    ds_read_b64_tr_b16 v[60:61], v5 offset:0
    ds_read_b64_tr_b16 v[62:63], v5 offset:2048
    v_mfma_f32_16x16x32_bf16 v[24:27], v[72:75], v[104:107], v[24:27]
    buffer_load_dwordx4 v[96:99], v1, s[64:67], s52 offen offset:2048 sc1
    ds_read_b32 v10, v211
    v_mfma_f32_16x16x32_bf16 v[40:43], v[72:75], v[108:111], v[40:43]
    buffer_load_dwordx4 v[100:103], v6, s[64:67], s52 offen offset:2048 sc1
    v_mfma_f32_16x16x32_bf16 v[28:31], v[76:79], v[104:107], v[28:31]
    v_mfma_f32_16x16x32_bf16 v[44:47], v[76:79], v[108:111], v[44:47]
    buffer_load_dwordx4 v[104:107], v1, s[64:67], s52 offen offset:3072 sc1
    buffer_load_dwordx4 v[108:111], v6, s[64:67], s52 offen offset:3072 sc1
    s_cmp_lt_i32 s51, 0
    s_cbranch_scc1 F_GE1
    s_waitcnt vmcnt(9)
F_GC1:
    v_max3_u32 v15, v112, v116, v120
    v_max3_u32 v7, v124, v128, v132
    v_max3_u32 v15, v15, v136, v140
    v_max_u32 v15, v15, v7
    v_cmp_eq_u32 vcc, -1, v15
    s_cbranch_vccnz F_GF1
F_GK1:
    s_waitcnt lgkmcnt(1)
    v_mfma_f32_16x16x32_bf16 v[16:19], v[48:51], v[112:115], v[16:19]
    ds_read_b64_tr_b16 v[64:65], v2 offset:4096
    ds_read_b64_tr_b16 v[66:67], v2 offset:6144
    v_mfma_f32_16x16x32_bf16 v[32:35], v[48:51], v[116:119], v[32:35]
    ds_read_b64_tr_b16 v[68:69], v3 offset:4096
    ds_read_b64_tr_b16 v[70:71], v3 offset:6144
    v_mfma_f32_16x16x32_bf16 v[20:23], v[52:55], v[112:115], v[20:23]
    ds_read_b64_tr_b16 v[72:73], v4 offset:4096
    ds_read_b64_tr_b16 v[74:75], v4 offset:6144
    v_mfma_f32_16x16x32_bf16 v[36:39], v[52:55], v[116:119], v[36:39]
    ds_read_b64_tr_b16 v[76:77], v5 offset:4096
    ds_read_b64_tr_b16 v[78:79], v5 offset:6144
    v_mfma_f32_16x16x32_bf16 v[24:27], v[56:59], v[112:115], v[24:27]
    s_waitcnt vmcnt(8) lgkmcnt(8)
    v_cmp_eq_u32 vcc, -1, v9
    v_cmp_ne_u32 s[40:41], 1, v10
    s_ashr_i32 s45, s50, 31
    v_mfma_f32_16x16x32_bf16 v[40:43], v[56:59], v[116:119], v[40:43]
    s_or_b32 s45, s45, vcc_lo
    s_or_b32 s45, s45, s40
    s_or_b32 s45, s45, s41
    v_mfma_f32_16x16x32_bf16 v[28:31], v[60:63], v[112:115], v[28:31]
    s_lshr_b32 s40, s45, 1
    s_or_b32 s45, s45, s40
    s_lshr_b32 s40, s45, 2
    v_mfma_f32_16x16x32_bf16 v[44:47], v[60:63], v[116:119], v[44:47]
    s_or_b32 s45, s45, s40
    v_cndmask_b32 v11, v8, v208, vcc
    s_waitcnt lgkmcnt(0)
    v_mfma_f32_16x16x32_bf16 v[16:19], v[64:67], v[120:123], v[16:19]
    ds_read_b64_tr_b16 v[48:49], v2 offset:8192
    ds_read_b64_tr_b16 v[50:51], v2 offset:10240
    s_andn2_b32 s45, s46, s45
    v_mfma_f32_16x16x32_bf16 v[32:35], v[64:67], v[124:127], v[32:35]
    ds_read_b64_tr_b16 v[52:53], v3 offset:8192
    ds_read_b64_tr_b16 v[54:55], v3 offset:10240
    s_cselect_b32 s66, s38, 0
    v_mfma_f32_16x16x32_bf16 v[20:23], v[68:71], v[120:123], v[20:23]
    ds_read_b64_tr_b16 v[56:57], v4 offset:8192
    ds_read_b64_tr_b16 v[58:59], v4 offset:10240
    s_ff1_i32_b32 s51, s45
    v_mfma_f32_16x16x32_bf16 v[36:39], v[68:71], v[124:127], v[36:39]
    ds_read_b64_tr_b16 v[60:61], v5 offset:8192
    ds_read_b64_tr_b16 v[62:63], v5 offset:10240
    s_lshl_b32 s53, s51, 10
    v_mfma_f32_16x16x32_bf16 v[24:27], v[72:75], v[120:123], v[24:27]
    s_add_u32 s53, s53, s55
    s_bitset0_b32 s46, s51
    buffer_load_dword v9, v11, s[36:39], s55 offen offset:1008 sc1
    v_mfma_f32_16x16x32_bf16 v[40:43], v[72:75], v[124:127], v[40:43]
    buffer_load_dwordx4 v[112:115], v1, s[64:67], s53 offen offset:0 sc1
    s_lshr_b32 s48, s54, s50
    v_mfma_f32_16x16x32_bf16 v[28:31], v[76:79], v[120:123], v[28:31]
    buffer_load_dwordx4 v[116:119], v6, s[64:67], s53 offen offset:0 sc1
    s_and_b32 s48, s48, 15
    v_mfma_f32_16x16x32_bf16 v[44:47], v[76:79], v[124:127], v[44:47]
    s_lshl_b32 s48, s48, 14
    s_waitcnt lgkmcnt(0)
    v_mfma_f32_16x16x32_bf16 v[16:19], v[48:51], v[128:131], v[16:19]
    ds_read_b64_tr_b16 v[64:65], v2 offset:12288
    ds_read_b64_tr_b16 v[66:67], v2 offset:14336
    v_mfma_f32_16x16x32_bf16 v[32:35], v[48:51], v[132:135], v[32:35]
    ds_read_b64_tr_b16 v[68:69], v3 offset:12288
    ds_read_b64_tr_b16 v[70:71], v3 offset:14336
    v_mfma_f32_16x16x32_bf16 v[20:23], v[52:55], v[128:131], v[20:23]
    ds_read_b64_tr_b16 v[72:73], v4 offset:12288
    ds_read_b64_tr_b16 v[74:75], v4 offset:14336
    v_mfma_f32_16x16x32_bf16 v[36:39], v[52:55], v[132:135], v[36:39]
    ds_read_b64_tr_b16 v[76:77], v5 offset:12288
    ds_read_b64_tr_b16 v[78:79], v5 offset:14336
    v_mfma_f32_16x16x32_bf16 v[24:27], v[56:59], v[128:131], v[24:27]
    buffer_load_dwordx4 v[120:123], v1, s[64:67], s53 offen offset:1024 sc1
    v_add_u32 v2, s48, v207
    v_mfma_f32_16x16x32_bf16 v[40:43], v[56:59], v[132:135], v[40:43]
    buffer_load_dwordx4 v[124:127], v6, s[64:67], s53 offen offset:1024 sc1
    v_xor_b32 v3, 32, v2
    v_mfma_f32_16x16x32_bf16 v[28:31], v[60:63], v[128:131], v[28:31]
    v_xor_b32 v4, 64, v2
    v_xor_b32 v5, 96, v2
    v_mfma_f32_16x16x32_bf16 v[44:47], v[60:63], v[132:135], v[44:47]
    s_waitcnt lgkmcnt(0)
    v_mfma_f32_16x16x32_bf16 v[16:19], v[64:67], v[136:139], v[16:19]
    ds_read_b64_tr_b16 v[48:49], v2 offset:0
    ds_read_b64_tr_b16 v[50:51], v2 offset:2048
    v_mfma_f32_16x16x32_bf16 v[32:35], v[64:67], v[140:143], v[32:35]
    ds_read_b64_tr_b16 v[52:53], v3 offset:0
    ds_read_b64_tr_b16 v[54:55], v3 offset:2048
    v_mfma_f32_16x16x32_bf16 v[20:23], v[68:71], v[136:139], v[20:23]
    ds_read_b64_tr_b16 v[56:57], v4 offset:0
    ds_read_b64_tr_b16 v[58:59], v4 offset:2048
    v_mfma_f32_16x16x32_bf16 v[36:39], v[68:71], v[140:143], v[36:39]
    ds_read_b64_tr_b16 v[60:61], v5 offset:0
    ds_read_b64_tr_b16 v[62:63], v5 offset:2048
    v_mfma_f32_16x16x32_bf16 v[24:27], v[72:75], v[136:139], v[24:27]
    buffer_load_dwordx4 v[128:131], v1, s[64:67], s53 offen offset:2048 sc1
    ds_read_b32 v10, v211
    v_mfma_f32_16x16x32_bf16 v[40:43], v[72:75], v[140:143], v[40:43]
    buffer_load_dwordx4 v[132:135], v6, s[64:67], s53 offen offset:2048 sc1
    v_mfma_f32_16x16x32_bf16 v[28:31], v[76:79], v[136:139], v[28:31]
    v_mfma_f32_16x16x32_bf16 v[44:47], v[76:79], v[140:143], v[44:47]
    buffer_load_dwordx4 v[136:139], v1, s[64:67], s53 offen offset:3072 sc1
    buffer_load_dwordx4 v[140:143], v6, s[64:67], s53 offen offset:3072 sc1
    s_add_u32 s44, s44, 1
    s_cmp_lt_u32 s44, 4
    s_cbranch_scc1 F_GLOOP
    s_add_u32 s57, s56, 65536
    s_waitcnt lgkmcnt(0)
    v_cvt_pk_bf16_f32 v48, v16, v17
    v_cvt_pk_bf16_f32 v49, v18, v19
    v_cvt_pk_bf16_f32 v50, v20, v21
    v_cvt_pk_bf16_f32 v51, v22, v23
    v_cvt_pk_bf16_f32 v52, v24, v25
    v_cvt_pk_bf16_f32 v53, v26, v27
    v_cvt_pk_bf16_f32 v54, v28, v29
    v_cvt_pk_bf16_f32 v55, v30, v31
    v_cvt_pk_bf16_f32 v56, v32, v33
    v_cvt_pk_bf16_f32 v57, v34, v35
    v_cvt_pk_bf16_f32 v58, v36, v37
    v_cvt_pk_bf16_f32 v59, v38, v39
    v_cvt_pk_bf16_f32 v60, v40, v41
    v_cvt_pk_bf16_f32 v61, v42, v43
    v_cvt_pk_bf16_f32 v62, v44, v45
    v_cvt_pk_bf16_f32 v63, v46, v47
    v_permlane16_swap_b32 v48, v50
    v_permlane16_swap_b32 v49, v51
    buffer_store_dwordx4 v[48:51], v210, s[60:63], s56 offen offset:0 sc1
    v_permlane16_swap_b32 v52, v54
    v_permlane16_swap_b32 v53, v55
    buffer_store_dwordx4 v[52:55], v210, s[60:63], s56 offen offset:64 sc1
    v_permlane16_swap_b32 v56, v58
    v_permlane16_swap_b32 v57, v59
    buffer_store_dwordx4 v[56:59], v210, s[60:63], s57 offen offset:0 sc1
    v_permlane16_swap_b32 v60, v62
    v_permlane16_swap_b32 v61, v63
    buffer_store_dwordx4 v[60:63], v210, s[60:63], s57 offen offset:64 sc1
    s_endpgm
F_CNB0:
    ds_write_b32 v204, v14 offset:32
F_WS15:
    ds_read_b32 v15, v209 offset:128
    s_waitcnt lgkmcnt(0)
    v_cmp_ne_u32 vcc, 1, v15
    s_cbranch_vccz F_WS15_X
    s_branch F_WS15
F_WS15_X:
    s_branch F_CB0
F_CNB1:
    ds_write_b32 v204, v14
    s_branch F_CB1
F_GF0:
    s_add_u32 s58, s58, 1
    s_cmp_gt_u32 s58, 400000
    s_cbranch_scc1 F_GK0
    s_bitset1_b32 s46, s50
    s_branch F_GE0
F_GS0:
    s_sleep 12
F_GE0:
    buffer_load_dword v15, v208, s[36:39], s55 offen offset:1008 sc1
    s_add_u32 s58, s58, 1
    s_waitcnt vmcnt(0)
F_GR0:
    ds_read_b32 v7, v211
    v_cmp_eq_u32 vcc, -1, v15
    v_mov_b32 v9, v15
    s_waitcnt lgkmcnt(0)
    v_cmp_ne_u32 s[40:41], 1, v7
    v_mov_b32 v10, v7
    s_or_b32 s45, s40, s41
    s_or_b32 s45, s45, vcc_lo
    s_lshr_b32 s40, s45, 1
    s_or_b32 s45, s45, s40
    s_lshr_b32 s40, s45, 2
    s_or_b32 s45, s45, s40
    s_cmp_gt_u32 s58, 400000
    s_cselect_b32 s45, 0, s45
    s_andn2_b32 s47, s46, s45
    s_cbranch_scc0 F_GS0
    s_and_b32 s45, s46, s47
    s_cselect_b32 s66, s38, 0
    s_ff1_i32_b32 s50, s45
    s_bitset0_b32 s46, s50
    s_lshl_b32 s52, s50, 10
    s_add_u32 s52, s52, s55
    buffer_load_dwordx4 v[80:83], v1, s[36:39], s52 offen offset:0 sc1
    buffer_load_dwordx4 v[84:87], v6, s[36:39], s52 offen offset:0 sc1
    buffer_load_dwordx4 v[88:91], v1, s[36:39], s52 offen offset:1024 sc1
    buffer_load_dwordx4 v[92:95], v6, s[36:39], s52 offen offset:1024 sc1
    buffer_load_dwordx4 v[96:99], v1, s[36:39], s52 offen offset:2048 sc1
    buffer_load_dwordx4 v[100:103], v6, s[36:39], s52 offen offset:2048 sc1
    buffer_load_dwordx4 v[104:107], v1, s[36:39], s52 offen offset:3072 sc1
    buffer_load_dwordx4 v[108:111], v6, s[36:39], s52 offen offset:3072 sc1
    s_lshr_b32 s48, s54, s50
    s_and_b32 s48, s48, 15
    s_lshl_b32 s48, s48, 14
    v_add_u32 v2, s48, v207
    v_xor_b32 v3, 32, v2
    v_xor_b32 v4, 64, v2
    v_xor_b32 v5, 96, v2
    ds_read_b64_tr_b16 v[48:49], v2 offset:0
    ds_read_b64_tr_b16 v[50:51], v2 offset:2048
    ds_read_b64_tr_b16 v[52:53], v3 offset:0
    ds_read_b64_tr_b16 v[54:55], v3 offset:2048
    ds_read_b64_tr_b16 v[56:57], v4 offset:0
    ds_read_b64_tr_b16 v[58:59], v4 offset:2048
    ds_read_b64_tr_b16 v[60:61], v5 offset:0
    ds_read_b64_tr_b16 v[62:63], v5 offset:2048
    s_cmp_lt_i32 s51, 0
    s_cbranch_scc0 F_GN0
    s_and_b32 s45, s46, s47
    s_cselect_b32 s66, s38, 0
    s_ff1_i32_b32 s51, s45
    s_bitset0_b32 s46, s51
    s_lshl_b32 s53, s51, 10
    s_add_u32 s53, s53, s55
    buffer_load_dwordx4 v[112:115], v1, s[64:67], s53 offen offset:0 sc1
    buffer_load_dwordx4 v[116:119], v6, s[64:67], s53 offen offset:0 sc1
    buffer_load_dwordx4 v[120:123], v1, s[64:67], s53 offen offset:1024 sc1
    buffer_load_dwordx4 v[124:127], v6, s[64:67], s53 offen offset:1024 sc1
    buffer_load_dwordx4 v[128:131], v1, s[64:67], s53 offen offset:2048 sc1
    buffer_load_dwordx4 v[132:135], v6, s[64:67], s53 offen offset:2048 sc1
    buffer_load_dwordx4 v[136:139], v1, s[64:67], s53 offen offset:3072 sc1
    buffer_load_dwordx4 v[140:143], v6, s[64:67], s53 offen offset:3072 sc1
    s_waitcnt vmcnt(8)
    s_branch F_GC0
F_GN0:
    s_waitcnt vmcnt(0)
    s_branch F_GC0
F_GF1:
    s_add_u32 s58, s58, 1
    s_cmp_gt_u32 s58, 400000
    s_cbranch_scc1 F_GK1
    s_bitset1_b32 s46, s51
    s_branch F_GE1
F_GS1:
    s_sleep 12
F_GE1:
    buffer_load_dword v15, v208, s[36:39], s55 offen offset:1008 sc1
    s_add_u32 s58, s58, 1
    s_waitcnt vmcnt(0)
F_GR1:
    ds_read_b32 v7, v211
    v_cmp_eq_u32 vcc, -1, v15
    v_mov_b32 v9, v15
    s_waitcnt lgkmcnt(0)
    v_cmp_ne_u32 s[40:41], 1, v7
    v_mov_b32 v10, v7
    s_or_b32 s45, s40, s41
    s_or_b32 s45, s45, vcc_lo
    s_lshr_b32 s40, s45, 1
    s_or_b32 s45, s45, s40
    s_lshr_b32 s40, s45, 2
    s_or_b32 s45, s45, s40
    s_cmp_gt_u32 s58, 400000
    s_cselect_b32 s45, 0, s45
    s_andn2_b32 s47, s46, s45
    s_cbranch_scc0 F_GS1
    s_and_b32 s45, s46, s47
    s_cselect_b32 s66, s38, 0
    s_ff1_i32_b32 s51, s45
    s_bitset0_b32 s46, s51
    s_lshl_b32 s53, s51, 10
    s_add_u32 s53, s53, s55
    buffer_load_dwordx4 v[112:115], v1, s[36:39], s53 offen offset:0 sc1
    buffer_load_dwordx4 v[116:119], v6, s[36:39], s53 offen offset:0 sc1
    buffer_load_dwordx4 v[120:123], v1, s[36:39], s53 offen offset:1024 sc1
    buffer_load_dwordx4 v[124:127], v6, s[36:39], s53 offen offset:1024 sc1
    buffer_load_dwordx4 v[128:131], v1, s[36:39], s53 offen offset:2048 sc1
    buffer_load_dwordx4 v[132:135], v6, s[36:39], s53 offen offset:2048 sc1
    buffer_load_dwordx4 v[136:139], v1, s[36:39], s53 offen offset:3072 sc1
    buffer_load_dwordx4 v[140:143], v6, s[36:39], s53 offen offset:3072 sc1
    s_lshr_b32 s48, s54, s51
    s_and_b32 s48, s48, 15
    s_lshl_b32 s48, s48, 14
    v_add_u32 v2, s48, v207
    v_xor_b32 v3, 32, v2
    v_xor_b32 v4, 64, v2
    v_xor_b32 v5, 96, v2
    ds_read_b64_tr_b16 v[48:49], v2 offset:0
    ds_read_b64_tr_b16 v[50:51], v2 offset:2048
    ds_read_b64_tr_b16 v[52:53], v3 offset:0
    ds_read_b64_tr_b16 v[54:55], v3 offset:2048
    ds_read_b64_tr_b16 v[56:57], v4 offset:0
    ds_read_b64_tr_b16 v[58:59], v4 offset:2048
    ds_read_b64_tr_b16 v[60:61], v5 offset:0
    ds_read_b64_tr_b16 v[62:63], v5 offset:2048
    s_cmp_lt_i32 s50, 0
    s_cbranch_scc0 F_GN1
    s_and_b32 s45, s46, s47
    s_cselect_b32 s66, s38, 0
    s_ff1_i32_b32 s50, s45
    s_bitset0_b32 s46, s50
    s_lshl_b32 s52, s50, 10
    s_add_u32 s52, s52, s55
    buffer_load_dwordx4 v[80:83], v1, s[64:67], s52 offen offset:0 sc1
    buffer_load_dwordx4 v[84:87], v6, s[64:67], s52 offen offset:0 sc1
    buffer_load_dwordx4 v[88:91], v1, s[64:67], s52 offen offset:1024 sc1
    buffer_load_dwordx4 v[92:95], v6, s[64:67], s52 offen offset:1024 sc1
    buffer_load_dwordx4 v[96:99], v1, s[64:67], s52 offen offset:2048 sc1
    buffer_load_dwordx4 v[100:103], v6, s[64:67], s52 offen offset:2048 sc1
    buffer_load_dwordx4 v[104:107], v1, s[64:67], s52 offen offset:3072 sc1
    buffer_load_dwordx4 v[108:111], v6, s[64:67], s52 offen offset:3072 sc1
    s_waitcnt vmcnt(8)
    s_branch F_GC1
F_GN1:
    s_waitcnt vmcnt(0)
    s_branch F_GC1
F_END:
    s_endpgm

.section .rodata,"a"
.p2align 6
.amdhsa_kernel concat_heads__linear_attn_block__ssm_conv_h3__prompt_kernel
  .amdhsa_next_free_vgpr 256
  .amdhsa_next_free_sgpr 102
  .amdhsa_accum_offset 256
  .amdhsa_group_segment_fixed_size 0
  .amdhsa_kernarg_size 96
  .amdhsa_user_sgpr_count 2
  .amdhsa_user_sgpr_kernarg_segment_ptr 1
  .amdhsa_system_sgpr_workgroup_id_x 1
  .amdhsa_float_denorm_mode_32 3
  .amdhsa_float_denorm_mode_16_64 3
.end_amdhsa_kernel
```

```asm
; @launch grid=(256,1,1) block=(512,1,1) lds=163840
.amdgcn_target "amdgcn-amd-amdhsa--gfx950"
.text
.globl concat_heads__linear_attn_block__ssm_conv_h3__prompt_kernel
.p2align 8
.type concat_heads__linear_attn_block__ssm_conv_h3__prompt_kernel,@function
concat_heads__linear_attn_block__ssm_conv_h3__prompt_kernel:
    s_load_dwordx16 s[4:19], s[0:1], 0
    s_cmp_ge_u32 s2, 256
    s_cbranch_scc1 F_END
    v_lshrrev_b32 v1, 6, v0
    v_and_b32 v0, 63, v0
    s_and_b32 s28, s2, 7
    s_lshr_b32 s29, s2, 3
    v_readfirstlane_b32 s3, v1
    s_and_b32 s30, s28, 1
    s_lshl_b32 s30, s30, 3
    s_and_b32 s31, s29, 7
    s_add_u32 s30, s30, s31
    s_lshr_b32 s31, s28, 1
    s_lshl_b32 s31, s31, 2
    s_lshr_b32 s32, s29, 3
    s_add_u32 s31, s31, s32
    s_lshr_b32 s30, s29, 1
    s_and_b32 s31, s29, 1
    s_lshl_b32 s32, s28, 1
    s_add_u32 s31, s31, s32
    s_cmp_lt_u32 s3, 4
    s_cbranch_scc1 F_C
    s_sub_u32 s34, s3, 4
    v_lshrrev_b32 v2, 3, v0
    v_and_b32 v4, 7, v0
    s_getpc_b64 s[66:67]
F_PC:
    s_lshl_b32 s40, s29, 10
    s_lshl_b32 s41, s34, 8
    s_add_u32 s40, s40, s41
    v_and_b32 v7, 1, v0
    v_lshlrev_b32 v7, 7, v7
    v_add_u32 v7, s40, v7
    v_min_u32 v7, F_END-F_PC, v7
    global_load_dword v250, v7, s[66:67]
    v_lshlrev_b32 v8, 11, v4
    v_and_b32 v9, 15, v0
    v_min_u32 v9, 11, v9
    v_lshrrev_b32 v7, 2, v9
    v_and_b32 v9, 3, v9
    v_lshlrev_b32 v9, 7, v9
    v_lshl_add_u32 v9, v7, 11, v9
    s_and_b32 s100, s28, 1
    s_lshr_b32 s101, s28, 1
    s_lshl_b32 s40, s100, 21
    s_lshl_b32 s41, s101, 19
    s_add_u32 s99, s40, s41
    s_lshl_b32 s40, s29, 14
    s_lshl_b32 s41, s34, 7
    s_add_u32 s42, s40, s41
    s_add_u32 s42, s42, s99
    s_mul_i32 s98, s100, 6144
    s_lshl_b32 s41, s101, 9
    s_add_u32 s98, s98, s41
    s_lshl_b32 s43, s29, 2
    s_add_u32 s43, s43, s34
    s_mul_i32 s43, s43, 12288
    s_add_u32 s43, s43, s98
    v_min_u32 v9, 5, v4
    v_lshrrev_b32 v7, 1, v9
    v_and_b32 v9, 1, v9
    v_lshlrev_b32 v9, 7, v9
    v_lshl_add_u32 v19, v7, 11, v9
    v_and_b32 v7, 1, v2
    v_mul_u32_u24 v7, 6144, v7
    v_add_u32 v9, v19, v7
    s_lshl_b32 s98, s28, 8
    s_lshl_b32 s43, s29, 2
    s_add_u32 s43, s43, s34
    s_mul_i32 s43, s43, 12288
    s_add_u32 s43, s43, s98
    s_mov_b32 s46, 0x400000
    s_mov_b32 s47, 0x00020000
    s_mov_b32 s50, 0x600000
    s_mov_b32 s51, 0x00020000
    s_lshl_b32 s40, s34, 3
    v_add_u32 v3, s40, v2
    v_lshrrev_b32 v5, 4, v0
    s_and_b32 s40, s34, 1
    s_lshl_b32 s41, s40, 2
    v_add_u32 v6, s41, v5
    v_xor_b32 v6, v6, v4
    v_lshlrev_b32 v6, 4, v6
    v_lshl_add_u32 v10, v3, 11, v6
    v_and_b32 v6, 1, v5
    v_lshlrev_b32 v6, 1, v6
    v_or_b32 v6, s41, v6
    v_xor_b32 v6, v6, v4
    v_lshlrev_b32 v6, 4, v6
    v_mul_u32_u24 v11, 6144, v3
    v_add_u32 v11, v11, v6
    s_lshl_b32 s52, s30, 18
    s_add_u32 s53, s52, 64512
    s_add_u32 s54, s52, 129024
    s_add_u32 s55, s52, 193536
    s_lshl_b32 s56, s31, 7
    s_add_u32 s57, s56, 1024
    s_add_u32 s58, s56, 2048
    s_add_u32 s59, s56, 193536
    s_add_u32 s60, s56, 198656
    s_add_u32 s61, s56, 199680
    s_mul_i32 s62, s34, 10240
    s_mov_b32 s63, 393216
    s_waitcnt lgkmcnt(0)
    s_mov_b64 s[44:45], s[4:5]
    s_mov_b64 s[48:49], s[6:7]
    buffer_load_dword v250, v9, s[48:51], s43 offen
    buffer_load_dword v250, v8, s[44:47], s42 offen
    s_add_u32 m0, s62, 45056
    s_nop 0
    buffer_load_dwordx4 v11, s[48:51], s57 offen offset:1024 lds
    buffer_load_dwordx4 v11, s[48:51], s58 offen offset:2048 lds
    buffer_load_dwordx4 v11, s[48:51], s56 offen offset:0 lds
    buffer_load_dwordx4 v11, s[48:51], s59 offen offset:3072 lds
    s_add_u32 m0, s62, 40960
    s_nop 0
    buffer_load_dwordx4 v10, s[44:47], s52 offen offset:0 lds
    buffer_load_dwordx4 v10, s[44:47], s53 offen offset:1024 lds
    buffer_load_dwordx4 v10, s[44:47], s54 offen offset:2048 lds
    buffer_load_dwordx4 v10, s[44:47], s55 offen offset:3072 lds
    s_add_u32 m0, s62, 49152
    s_nop 0
    buffer_load_dwordx4 v11, s[48:51], s60 offen offset:0 lds
    buffer_load_dwordx4 v11, s[48:51], s61 offen offset:1024 lds
    v_add_u32 v10, 128, v10
    v_add_u32 v11, s63, v11
    s_add_u32 m0, s62, 86016
    s_nop 0
    buffer_load_dwordx4 v11, s[48:51], s57 offen offset:1024 lds
    buffer_load_dwordx4 v11, s[48:51], s58 offen offset:2048 lds
    buffer_load_dwordx4 v11, s[48:51], s56 offen offset:0 lds
    buffer_load_dwordx4 v11, s[48:51], s59 offen offset:3072 lds
    s_add_u32 m0, s62, 81920
    s_nop 0
    buffer_load_dwordx4 v10, s[44:47], s52 offen offset:0 lds
    buffer_load_dwordx4 v10, s[44:47], s53 offen offset:1024 lds
    buffer_load_dwordx4 v10, s[44:47], s54 offen offset:2048 lds
    buffer_load_dwordx4 v10, s[44:47], s55 offen offset:3072 lds
    s_add_u32 m0, s62, 90112
    s_nop 0
    buffer_load_dwordx4 v11, s[48:51], s60 offen offset:0 lds
    buffer_load_dwordx4 v11, s[48:51], s61 offen offset:1024 lds
    v_add_u32 v10, 128, v10
    v_add_u32 v11, s63, v11
    s_load_dwordx8 s[20:27], s[0:1], 64
    s_and_b32 s32, s29, 3
    s_lshr_b32 s33, s28, 1
    s_lshl_b32 s33, s33, 2
    s_add_u32 s32, s32, s33
    s_and_b32 s33, s28, 1
    s_lshl_b32 s33, s33, 3
    s_lshr_b32 s35, s29, 2
    s_add_u32 s33, s33, s35
    v_lshlrev_b32 v1, 4, v0
    v_lshlrev_b32 v6, 1, v5
    v_xor_b32 v6, v6, v4
    v_lshlrev_b32 v6, 4, v6
    v_lshl_add_u32 v12, v2, 11, v6
    v_mov_b32 v13, 0
    s_lshr_b32 s35, s29, 4
    s_lshl_b32 s35, s35, 3
    s_add_u32 s35, s35, s28
    s_lshl_b32 s35, s35, 4
    s_and_b32 s40, s29, 15
    s_add_u32 s35, s35, s40
    s_mov_b32 s35, s2
    s_lshl_b32 s35, s35, 2
    s_add_u32 s35, s35, s34
    s_and_b32 s96, s29, 3
    s_waitcnt lgkmcnt(0)
    s_mov_b32 s36, s26
    s_mov_b32 s37, s27
    s_mov_b32 s38, 0x10000000
    s_mov_b32 s39, 0x00020000
    s_mov_b32 s64, s24
    s_mov_b32 s65, s25
    s_mov_b32 s66, 0x100
    s_mov_b32 s67, 0x00020000
    s_lshr_b32 s69, s29, 2
    s_mul_i32 s40, s96, 3
    s_add_u32 s40, s40, 4
    s_add_u32 s41, s40, s34
    s_lshl_b32 s41, s41, 7
    s_add_u32 s99, s99, s41
    s_lshl_b32 s41, s69, 16
    s_add_u32 s99, s99, s41
    s_lshl_b32 s40, s40, 5
    s_mul_i32 s41, s69, 12
    s_add_u32 s40, s40, s41
    s_lshl_b32 s41, s34, 2
    s_add_u32 s40, s40, s41
    s_mul_i32 s40, s40, 12288
    s_add_u32 s98, s98, s40
    s_lshl_b32 s100, s100, 10
    s_lshl_b32 s101, s101, 19
    s_add_u32 s100, s100, s101
    s_lshl_b32 s41, s29, 14
    s_add_u32 s100, s100, s41
    v_and_b32 v16, 31, v0
    v_lshlrev_b32 v16, 11, v16
    v_mul_u32_u24 v17, 6144, v2
    v_add_u32 v17, v17, v19
    v_lshlrev_b32 v18, 7, v4
    v_lshl_add_u32 v18, v2, 11, v18
    s_cmp_lg_u32 s96, 0
    s_cbranch_scc1 F_PF0X
    s_cmp_eq_u32 s34, 3
    s_cbranch_scc1 F_PF0X
    buffer_load_dword v250, v17, s[48:51], s98 offen
    buffer_load_dword v250, v16, s[44:47], s99 offen
F_PF0X:
    s_cmp_lg_u32 s96, 0
    s_cbranch_scc1 F_PW0X
    s_cmp_lg_u32 s34, 3
    s_cbranch_scc1 F_PW0X
    s_mov_b32 s40, s8
    s_mov_b32 s41, s9
    s_mov_b32 s42, 0x200000
    s_mov_b32 s43, 0x00020000
    buffer_load_dword v250, v18, s[40:43], s100 offen
F_PW0X:
    s_lshl_b32 s40, s34, 1
    v_xor_b32 v20, s40, v4
    v_lshlrev_b32 v20, 4, v20
    v_lshl_add_u32 v20, v2, 11, v20
    s_lshr_b32 s40, s2, 4
    s_lshl_b32 s40, s40, 18
    s_and_b32 s41, s2, 15
    s_lshl_b32 s41, s41, 7
    s_add_u32 s40, s40, s41
    v_xor_b32 v21, 6, v4
    v_lshlrev_b32 v21, 4, v21
    v_lshl_add_u32 v21, v2, 11, v21
    v_add_u32 v21, s40, v21
    v_subrev_u32 v21, 6144, v21
    s_lshl_b32 s41, s34, 15
    s_add_u32 s40, s40, s41
    v_add_u32 v20, s40, v20
    v_and_b32 v22, 3, v2
    v_xor_b32 v22, s34, v22
    v_lshlrev_b32 v22, 5, v22
    v_lshl_add_u32 v22, v4, 2, v22
    v_lshl_add_u32 v22, v2, 11, v22
    v_add_u32 v22, 123264, v22
    v_add_u32 v23, 3, v2
    v_and_b32 v23, 3, v23
    v_xor_b32 v23, s34, v23
    v_lshlrev_b32 v23, 5, v23
    v_lshl_add_u32 v23, v4, 2, v23
    v_lshl_add_u32 v23, v2, 11, v23
    v_add_u32 v23, 122880, v23
    s_and_b32 s40, s2, 15
    s_lshl_b32 s40, s40, 6
    s_lshl_b32 s41, s34, 4
    s_add_u32 s40, s40, s41
    v_lshlrev_b32 v24, 1, v4
    v_add_u32 v24, s40, v24
    v_mul_u32_u24 v25, 4224, v24
    v_lshlrev_b32 v24, 3, v24
    s_lshr_b32 s40, s2, 4
    s_lshl_b32 s40, s40, 3
    v_add_u32 v26, s40, v2
    v_lshl_add_u32 v25, v26, 4, v25
    s_lshr_b32 s40, s2, 4
    s_lshl_b32 s40, s40, 4
    s_lshl_b32 s41, s34, 3
    s_add_u32 s40, s40, s41
    v_add_u32 v28, s40, v2
    v_mul_u32_u24 v232, 33792, v4
    v_lshl_add_u32 v232, v28, 4, v232
    v_lshrrev_b32 v29, 6, v28
    v_lshlrev_b32 v29, 9, v29
    v_and_b32 v30, 15, v28
    v_lshl_add_u32 v29, v30, 4, v29
    v_bfe_u32 v30, v28, 4, 2
    v_lshl_add_u32 v29, v30, 2, v29
    v_lshlrev_b32 v30, 4, v4
    v_lshl_add_u32 v234, v29, 11, v30
    v_lshl_add_u32 v233, v29, 12, v30
    s_waitcnt vmcnt(10)
    s_barrier
    s_add_u32 m0, s62, 4096
    s_nop 0
    buffer_load_dwordx4 v11, s[48:51], s57 offen offset:1024 lds
    buffer_load_dwordx4 v11, s[48:51], s58 offen offset:2048 lds
    buffer_load_dwordx4 v11, s[48:51], s56 offen offset:0 lds
    buffer_load_dwordx4 v11, s[48:51], s59 offen offset:3072 lds
    s_add_u32 m0, s62, 0
    s_nop 0
    buffer_load_dwordx4 v10, s[44:47], s52 offen offset:0 lds
    buffer_load_dwordx4 v10, s[44:47], s53 offen offset:1024 lds
    buffer_load_dwordx4 v10, s[44:47], s54 offen offset:2048 lds
    buffer_load_dwordx4 v10, s[44:47], s55 offen offset:3072 lds
    s_add_u32 m0, s62, 8192
    s_nop 0
    buffer_load_dwordx4 v11, s[48:51], s60 offen offset:0 lds
    buffer_load_dwordx4 v11, s[48:51], s61 offen offset:1024 lds
    s_cmp_lg_u32 s96, 2
    s_cbranch_scc1 F_KV2X
    s_lshl_b32 s69, s34, 11
    s_mov_b32 s40, s12
    s_mov_b32 s41, s13
    s_mov_b32 s42, 0x400000
    s_mov_b32 s43, 0x00020000
    s_mov_b32 m0, 122880
    s_mov_b64 exec, 0xffffff
    buffer_load_dwordx4 v21, s[40:43], 0 offen nt lds
    s_mov_b64 exec, -1
    s_add_u32 m0, s69, 123264
    s_mov_b32 s97, 0
    buffer_load_dwordx4 v20, s[40:43], s97 offen nt lds
    s_mov_b32 s97, 15360
    buffer_load_dwordx4 v20, s[40:43], s97 offen offset:1024 nt lds
    s_add_u32 m0, s69, 131456
    s_mov_b32 s97, 131072
    buffer_load_dwordx4 v20, s[40:43], s97 offen nt lds
    s_mov_b32 s97, 146432
    buffer_load_dwordx4 v20, s[40:43], s97 offen offset:1024 nt lds
    s_mov_b32 s40, s14
    s_mov_b32 s41, s15
    s_mov_b32 s42, 0x400000
    s_mov_b32 s43, 0x00020000
    s_add_u32 m0, s69, 139648
    s_mov_b32 s97, 0
    buffer_load_dwordx4 v20, s[40:43], s97 offen nt lds
    s_mov_b32 s97, 15360
    buffer_load_dwordx4 v20, s[40:43], s97 offen offset:1024 nt lds
    s_add_u32 m0, s69, 147840
    s_mov_b32 s97, 131072
    buffer_load_dwordx4 v20, s[40:43], s97 offen nt lds
    s_mov_b32 s97, 146432
    buffer_load_dwordx4 v20, s[40:43], s97 offen offset:1024 nt lds
    s_mov_b32 s40, s16
    s_mov_b32 s41, s17
    s_mov_b32 s42, 0x2000
    s_mov_b32 s43, 0x00020000
    buffer_load_dwordx4 v[32:35], v24, s[40:43], 0 offen
F_KV2X:
    v_add_u32 v10, 128, v10
    v_add_u32 v11, s63, v11
    s_waitcnt vmcnt(10)
    s_barrier
    s_add_u32 m0, s62, 45056
    s_nop 0
    buffer_load_dwordx4 v11, s[48:51], s57 offen offset:1024 lds
    buffer_load_dwordx4 v11, s[48:51], s58 offen offset:2048 lds
    buffer_load_dwordx4 v11, s[48:51], s56 offen offset:0 lds
    buffer_load_dwordx4 v11, s[48:51], s59 offen offset:3072 lds
    s_cmp_lg_u32 s96, 1
    s_cbranch_scc1 F_PF1X
    s_cmp_eq_u32 s34, 3
    s_cbranch_scc1 F_PF1X
    buffer_load_dword v250, v17, s[48:51], s98 offen
    buffer_load_dword v250, v16, s[44:47], s99 offen
F_PF1X:
    s_add_u32 m0, s62, 40960
    s_nop 0
    buffer_load_dwordx4 v10, s[44:47], s52 offen offset:0 lds
    buffer_load_dwordx4 v10, s[44:47], s53 offen offset:1024 lds
    buffer_load_dwordx4 v10, s[44:47], s54 offen offset:2048 lds
    buffer_load_dwordx4 v10, s[44:47], s55 offen offset:3072 lds
    s_cmp_lg_u32 s96, 1
    s_cbranch_scc1 F_PW1X
    s_cmp_lg_u32 s34, 3
    s_cbranch_scc1 F_PW1X
    s_mov_b32 s40, s8
    s_mov_b32 s41, s9
    s_mov_b32 s42, 0x200000
    s_mov_b32 s43, 0x00020000
    buffer_load_dword v250, v18, s[40:43], s100 offen
F_PW1X:
    s_add_u32 m0, s62, 49152
    s_nop 0
    buffer_load_dwordx4 v11, s[48:51], s60 offen offset:0 lds
    s_mov_b32 s7, 0xffff0000
    buffer_load_dwordx4 v11, s[48:51], s61 offen offset:1024 lds
    v_add_u32 v10, 128, v10
    v_add_u32 v11, s63, v11
    s_cmp_lg_u32 s96, 3
    s_cbranch_scc1 F_KV3X
    s_lshl_b32 s69, s34, 11
    s_mov_b32 s40, s12
    s_mov_b32 s41, s13
    s_mov_b32 s42, 0x400000
    s_mov_b32 s43, 0x00020000
    s_mov_b32 m0, 122880
    s_mov_b64 exec, 0xffffff
    buffer_load_dwordx4 v21, s[40:43], 0 offen nt lds
    s_mov_b64 exec, -1
    s_add_u32 m0, s69, 123264
    s_mov_b32 s97, 0
    buffer_load_dwordx4 v20, s[40:43], s97 offen nt lds
    s_mov_b32 s97, 15360
    buffer_load_dwordx4 v20, s[40:43], s97 offen offset:1024 nt lds
    s_add_u32 m0, s69, 131456
    s_mov_b32 s97, 131072
    buffer_load_dwordx4 v20, s[40:43], s97 offen nt lds
    s_mov_b32 s97, 146432
    buffer_load_dwordx4 v20, s[40:43], s97 offen offset:1024 nt lds
    s_mov_b32 s40, s14
    s_mov_b32 s41, s15
    s_mov_b32 s42, 0x400000
    s_mov_b32 s43, 0x00020000
    s_add_u32 m0, s69, 139648
    s_mov_b32 s97, 0
    buffer_load_dwordx4 v20, s[40:43], s97 offen nt lds
    s_mov_b32 s97, 15360
    buffer_load_dwordx4 v20, s[40:43], s97 offen offset:1024 nt lds
    s_add_u32 m0, s69, 147840
    s_mov_b32 s97, 131072
    buffer_load_dwordx4 v20, s[40:43], s97 offen nt lds
    s_mov_b32 s97, 146432
    buffer_load_dwordx4 v20, s[40:43], s97 offen offset:1024 nt lds
    s_mov_b32 s40, s16
    s_mov_b32 s41, s17
    s_mov_b32 s42, 0x2000
    s_mov_b32 s43, 0x00020000
    buffer_load_dwordx4 v[32:35], v24, s[40:43], 0 offen
F_KV3X:
    s_waitcnt vmcnt(10)
    s_barrier
    s_add_u32 m0, s62, 86016
    s_nop 0
    buffer_load_dwordx4 v11, s[48:51], s57 offen offset:1024 lds
    buffer_load_dwordx4 v11, s[48:51], s58 offen offset:2048 lds
    buffer_load_dwordx4 v11, s[48:51], s56 offen offset:0 lds
    buffer_load_dwordx4 v11, s[48:51], s59 offen offset:3072 lds
    s_add_u32 m0, s62, 81920
    s_nop 0
    buffer_load_dwordx4 v10, s[44:47], s52 offen offset:0 lds
    buffer_load_dwordx4 v10, s[44:47], s53 offen offset:1024 lds
    buffer_load_dwordx4 v10, s[44:47], s54 offen offset:2048 lds
    buffer_load_dwordx4 v10, s[44:47], s55 offen offset:3072 lds
    s_add_u32 m0, s62, 90112
    s_nop 0
    buffer_load_dwordx4 v11, s[48:51], s60 offen offset:0 lds
    buffer_load_dwordx4 v11, s[48:51], s61 offen offset:1024 lds
    s_cmp_lg_u32 s96, 0
    s_cbranch_scc1 F_KV0X
    s_lshl_b32 s69, s34, 11
    s_mov_b32 s40, s12
    s_mov_b32 s41, s13
    s_mov_b32 s42, 0x400000
    s_mov_b32 s43, 0x00020000
    s_mov_b32 m0, 122880
    s_mov_b64 exec, 0xffffff
    buffer_load_dwordx4 v21, s[40:43], 0 offen nt lds
    s_mov_b64 exec, -1
    s_add_u32 m0, s69, 123264
    s_mov_b32 s97, 0
    buffer_load_dwordx4 v20, s[40:43], s97 offen nt lds
    s_mov_b32 s97, 15360
    buffer_load_dwordx4 v20, s[40:43], s97 offen offset:1024 nt lds
    s_add_u32 m0, s69, 131456
    s_mov_b32 s97, 131072
    buffer_load_dwordx4 v20, s[40:43], s97 offen nt lds
    s_mov_b32 s97, 146432
    buffer_load_dwordx4 v20, s[40:43], s97 offen offset:1024 nt lds
    s_mov_b32 s40, s14
    s_mov_b32 s41, s15
    s_mov_b32 s42, 0x400000
    s_mov_b32 s43, 0x00020000
    s_add_u32 m0, s69, 139648
    s_mov_b32 s97, 0
    buffer_load_dwordx4 v20, s[40:43], s97 offen nt lds
    s_mov_b32 s97, 15360
    buffer_load_dwordx4 v20, s[40:43], s97 offen offset:1024 nt lds
    s_add_u32 m0, s69, 147840
    s_mov_b32 s97, 131072
    buffer_load_dwordx4 v20, s[40:43], s97 offen nt lds
    s_mov_b32 s97, 146432
    buffer_load_dwordx4 v20, s[40:43], s97 offen offset:1024 nt lds
    s_mov_b32 s40, s16
    s_mov_b32 s41, s17
    s_mov_b32 s42, 0x2000
    s_mov_b32 s43, 0x00020000
    buffer_load_dwordx4 v[32:35], v24, s[40:43], 0 offen
F_KV0X:
    v_add_u32 v10, 128, v10
    v_add_u32 v11, s63, v11
    s_cmp_lg_u32 s96, 1
    s_cbranch_scc1 F_KV1X
    s_lshl_b32 s69, s34, 11
    s_mov_b32 s40, s12
    s_mov_b32 s41, s13
    s_mov_b32 s42, 0x400000
    s_mov_b32 s43, 0x00020000
    s_mov_b32 m0, 122880
    s_mov_b64 exec, 0xffffff
    buffer_load_dwordx4 v21, s[40:43], 0 offen nt lds
    s_mov_b64 exec, -1
    s_add_u32 m0, s69, 123264
    s_mov_b32 s97, 0
    buffer_load_dwordx4 v20, s[40:43], s97 offen nt lds
    s_mov_b32 s97, 15360
    buffer_load_dwordx4 v20, s[40:43], s97 offen offset:1024 nt lds
    s_add_u32 m0, s69, 131456
    s_mov_b32 s97, 131072
    buffer_load_dwordx4 v20, s[40:43], s97 offen nt lds
    s_mov_b32 s97, 146432
    buffer_load_dwordx4 v20, s[40:43], s97 offen offset:1024 nt lds
    s_mov_b32 s40, s14
    s_mov_b32 s41, s15
    s_mov_b32 s42, 0x400000
    s_mov_b32 s43, 0x00020000
    s_add_u32 m0, s69, 139648
    s_mov_b32 s97, 0
    buffer_load_dwordx4 v20, s[40:43], s97 offen nt lds
    s_mov_b32 s97, 15360
    buffer_load_dwordx4 v20, s[40:43], s97 offen offset:1024 nt lds
    s_add_u32 m0, s69, 147840
    s_mov_b32 s97, 131072
    buffer_load_dwordx4 v20, s[40:43], s97 offen nt lds
    s_mov_b32 s97, 146432
    buffer_load_dwordx4 v20, s[40:43], s97 offen offset:1024 nt lds
    s_mov_b32 s40, s16
    s_mov_b32 s41, s17
    s_mov_b32 s42, 0x2000
    s_mov_b32 s43, 0x00020000
    buffer_load_dwordx4 v[32:35], v24, s[40:43], 0 offen
F_KV1X:
    s_waitcnt vmcnt(10)
    s_barrier
    s_add_u32 m0, s62, 4096
    s_nop 0
    buffer_load_dwordx4 v11, s[48:51], s57 offen offset:1024 lds
    v_mov_b32 v44, 0
    v_mov_b32 v45, 0
    v_mov_b32 v46, 0
    v_mov_b32 v47, 0
    buffer_load_dwordx4 v11, s[48:51], s58 offen offset:2048 lds
    v_mov_b32 v48, 0
    v_mov_b32 v49, 0
    v_mov_b32 v50, 0
    v_mov_b32 v51, 0
    buffer_load_dwordx4 v11, s[48:51], s56 offen offset:0 lds
    v_mov_b32 v52, 0
    v_mov_b32 v53, 0
    v_mov_b32 v54, 0
    v_mov_b32 v55, 0
    buffer_load_dwordx4 v11, s[48:51], s59 offen offset:3072 lds
    v_mov_b32 v56, 0
    v_mov_b32 v57, 0
    v_mov_b32 v58, 0
    v_mov_b32 v59, 0
    s_add_u32 m0, s62, 0
    s_nop 0
    buffer_load_dwordx4 v10, s[44:47], s52 offen offset:0 lds
    v_mov_b32 v60, 0
    v_mov_b32 v61, 0
    v_mov_b32 v62, 0
    v_mov_b32 v63, 0
    buffer_load_dwordx4 v10, s[44:47], s53 offen offset:1024 lds
    v_mov_b32 v64, 0
    v_mov_b32 v65, 0
    v_mov_b32 v66, 0
    v_mov_b32 v67, 0
    buffer_load_dwordx4 v10, s[44:47], s54 offen offset:2048 lds
    v_mov_b32 v68, 0
    v_mov_b32 v69, 0
    v_mov_b32 v70, 0
    v_mov_b32 v71, 0
    buffer_load_dwordx4 v10, s[44:47], s55 offen offset:3072 lds
    v_mov_b32 v72, 0
    v_mov_b32 v73, 0
    v_mov_b32 v74, 0
    v_mov_b32 v75, 0
    s_add_u32 m0, s62, 8192
    s_nop 0
    buffer_load_dwordx4 v11, s[48:51], s60 offen offset:0 lds
    v_mov_b32 v76, 0
    v_mov_b32 v77, 0
    v_mov_b32 v78, 0
    v_mov_b32 v79, 0
    buffer_load_dwordx4 v11, s[48:51], s61 offen offset:1024 lds
    v_add_u32 v10, 128, v10
    v_add_u32 v11, s63, v11
    s_waitcnt vmcnt(10)
    s_barrier
    s_add_u32 m0, s62, 45056
    s_nop 0
    buffer_load_dwordx4 v11, s[48:51], s57 offen offset:1024 lds
    buffer_load_dwordx4 v11, s[48:51], s58 offen offset:2048 lds
    buffer_load_dwordx4 v11, s[48:51], s56 offen offset:0 lds
    buffer_load_dwordx4 v11, s[48:51], s59 offen offset:3072 lds
    s_cmp_lg_u32 s96, 2
    s_cbranch_scc1 F_PF2X
    s_cmp_eq_u32 s34, 3
    s_cbranch_scc1 F_PF2X
    buffer_load_dword v250, v17, s[48:51], s98 offen
    buffer_load_dword v250, v16, s[44:47], s99 offen
F_PF2X:
    s_add_u32 m0, s62, 40960
    s_nop 0
    buffer_load_dwordx4 v10, s[44:47], s52 offen offset:0 lds
    buffer_load_dwordx4 v10, s[44:47], s53 offen offset:1024 lds
    buffer_load_dwordx4 v10, s[44:47], s54 offen offset:2048 lds
    buffer_load_dwordx4 v10, s[44:47], s55 offen offset:3072 lds
    s_cmp_lg_u32 s96, 2
    s_cbranch_scc1 F_PW2X
    s_cmp_lg_u32 s34, 3
    s_cbranch_scc1 F_PW2X
    s_mov_b32 s40, s8
    s_mov_b32 s41, s9
    s_mov_b32 s42, 0x200000
    s_mov_b32 s43, 0x00020000
    buffer_load_dword v250, v18, s[40:43], s100 offen
F_PW2X:
    s_add_u32 m0, s62, 49152
    s_nop 0
    buffer_load_dwordx4 v11, s[48:51], s60 offen offset:0 lds
    buffer_load_dwordx4 v11, s[48:51], s61 offen offset:1024 lds
    v_add_u32 v10, 128, v10
    v_add_u32 v11, s63, v11
    s_waitcnt vmcnt(10)
    s_barrier
    s_add_u32 m0, s62, 86016
    s_nop 0
    buffer_load_dwordx4 v11, s[48:51], s57 offen offset:1024 lds
    ds_read_u16_d16_hi v44, v23 offset:0
    ds_read_u16_d16_hi v45, v23 offset:128
    ds_read_u16_d16_hi v46, v23 offset:256
    ds_read_u16_d16_hi v47, v22 offset:0
    ds_read_u16_d16_hi v48, v22 offset:128
    ds_read_u16_d16_hi v49, v22 offset:256
    buffer_load_dwordx4 v11, s[48:51], s58 offen offset:2048 lds
    ds_read_u16_d16_hi v50, v22 offset:384
    ds_read_u16_d16_hi v51, v22 offset:512
    ds_read_u16_d16_hi v52, v22 offset:640
    ds_read_u16_d16_hi v53, v22 offset:768
    ds_read_u16_d16_hi v54, v22 offset:896
    ds_read_u16_d16_hi v55, v22 offset:1024
    buffer_load_dwordx4 v11, s[48:51], s56 offen offset:0 lds
    v_lshlrev_b32 v36, 16, v32
    v_and_b32 v37, s7, v32
    v_lshlrev_b32 v38, 16, v33
    v_and_b32 v39, s7, v33
    s_waitcnt lgkmcnt(4)
    v_mul_f32 v80, v39, v44
    ds_read_u16_d16_hi v56, v22 offset:1152
    buffer_load_dwordx4 v11, s[48:51], s59 offen offset:3072 lds
    v_mul_f32 v81, v39, v45
    ds_read_u16_d16_hi v57, v22 offset:1280
    v_mul_f32 v82, v39, v46
    ds_read_u16_d16_hi v58, v22 offset:1408
    v_mul_f32 v83, v39, v47
    ds_read_u16_d16_hi v59, v22 offset:1536
    s_add_u32 m0, s62, 81920
    s_nop 0
    buffer_load_dwordx4 v10, s[44:47], s52 offen offset:0 lds
    v_mul_f32 v84, v39, v48
    ds_read_u16_d16_hi v60, v22 offset:1664
    v_mul_f32 v85, v39, v49
    ds_read_u16_d16_hi v61, v22 offset:1792
    v_mul_f32 v86, v39, v50
    ds_read_u16_d16_hi v62, v22 offset:1920
    buffer_load_dwordx4 v10, s[44:47], s53 offen offset:1024 lds
    v_mul_f32 v87, v39, v51
    ds_read_u16_d16_hi v64, v22 offset:16384
    s_waitcnt lgkmcnt(4)
    v_mul_f32 v88, v39, v52
    ds_read_u16_d16_hi v65, v22 offset:16512
    v_mul_f32 v89, v39, v53
    ds_read_u16_d16_hi v66, v22 offset:16640
    buffer_load_dwordx4 v10, s[44:47], s54 offen offset:2048 lds
    v_mul_f32 v90, v39, v54
    ds_read_u16_d16_hi v67, v22 offset:16768
    v_mul_f32 v91, v39, v55
    ds_read_u16_d16_hi v68, v22 offset:16896
    v_mul_f32 v92, v39, v56
    ds_read_u16_d16_hi v69, v22 offset:17024
    buffer_load_dwordx4 v10, s[44:47], s55 offen offset:3072 lds
    v_mul_f32 v93, v39, v57
    ds_read_u16_d16_hi v70, v22 offset:17152
    v_mul_f32 v94, v39, v58
    ds_read_u16_d16_hi v71, v22 offset:17280
    v_mul_f32 v95, v39, v59
    ds_read_u16_d16_hi v72, v22 offset:17408
    s_add_u32 m0, s62, 90112
    s_nop 0
    buffer_load_dwordx4 v11, s[48:51], s60 offen offset:0 lds
    s_waitcnt lgkmcnt(9)
    v_fmac_f32 v80, v38, v45
    ds_read_u16_d16_hi v73, v22 offset:17536
    v_fmac_f32 v81, v38, v46
    ds_read_u16_d16_hi v74, v22 offset:17664
    buffer_load_dwordx4 v11, s[48:51], s61 offen offset:1024 lds
    v_add_u32 v10, 128, v10
    v_add_u32 v11, s63, v11
    s_waitcnt vmcnt(10)
    s_barrier
    s_add_u32 m0, s62, 4096
    s_nop 0
    buffer_load_dwordx4 v11, s[48:51], s57 offen offset:1024 lds
    buffer_load_dword v14, v13, s[64:67], 0 offen sc1
    v_fmac_f32 v82, v38, v47
    ds_read_u16_d16_hi v75, v22 offset:17792
    v_fmac_f32 v83, v38, v48
    ds_read_u16_d16_hi v76, v22 offset:17920
    v_fmac_f32 v84, v38, v49
    buffer_load_dwordx4 v11, s[48:51], s58 offen offset:2048 lds
    ds_read_u16_d16_hi v77, v22 offset:18048
    v_fmac_f32 v85, v38, v50
    ds_read_u16_d16_hi v78, v22 offset:18176
    v_fmac_f32 v86, v38, v51
    ds_read_u16_d16_hi v79, v22 offset:18304
    v_fmac_f32 v87, v38, v52
    buffer_load_dwordx4 v11, s[48:51], s56 offen offset:0 lds
    v_fmac_f32 v88, v38, v53
    v_fmac_f32 v89, v38, v54
    v_fmac_f32 v90, v38, v55
    v_fmac_f32 v91, v38, v56
    v_fmac_f32 v92, v38, v57
    v_fmac_f32 v93, v38, v58
    buffer_load_dwordx4 v11, s[48:51], s59 offen offset:3072 lds
    v_fmac_f32 v94, v38, v59
    v_fmac_f32 v95, v38, v60
    v_fmac_f32 v80, v37, v46
    v_fmac_f32 v81, v37, v47
    v_fmac_f32 v82, v37, v48
    v_fmac_f32 v83, v37, v49
    s_add_u32 m0, s62, 0
    s_nop 0
    buffer_load_dwordx4 v10, s[44:47], s52 offen offset:0 lds
    v_fmac_f32 v84, v37, v50
    v_fmac_f32 v85, v37, v51
    v_fmac_f32 v86, v37, v52
    v_fmac_f32 v87, v37, v53
    v_fmac_f32 v88, v37, v54
    v_fmac_f32 v89, v37, v55
    buffer_load_dwordx4 v10, s[44:47], s53 offen offset:1024 lds
    v_fmac_f32 v90, v37, v56
    v_fmac_f32 v91, v37, v57
    v_fmac_f32 v92, v37, v58
    v_fmac_f32 v93, v37, v59
    v_fmac_f32 v94, v37, v60
    v_fmac_f32 v95, v37, v61
    buffer_load_dwordx4 v10, s[44:47], s54 offen offset:2048 lds
    v_fmac_f32 v80, v36, v47
    v_fmac_f32 v81, v36, v48
    v_fmac_f32 v82, v36, v49
    v_fmac_f32 v83, v36, v50
    v_fmac_f32 v84, v36, v51
    v_fmac_f32 v85, v36, v52
    buffer_load_dwordx4 v10, s[44:47], s55 offen offset:3072 lds
    v_fmac_f32 v86, v36, v53
    v_fmac_f32 v87, v36, v54
    v_fmac_f32 v88, v36, v55
    v_fmac_f32 v89, v36, v56
    v_fmac_f32 v90, v36, v57
    v_fmac_f32 v91, v36, v58
    s_add_u32 m0, s62, 8192
    s_nop 0
    buffer_load_dwordx4 v11, s[48:51], s60 offen offset:0 lds
    v_fmac_f32 v92, v36, v59
    v_fmac_f32 v93, v36, v60
    v_fmac_f32 v94, v36, v61
    v_fmac_f32 v95, v36, v62
    s_waitcnt lgkmcnt(0)
    v_mul_f32 v80, v80, v64
    buffer_load_dwordx4 v11, s[48:51], s61 offen offset:1024 lds
    v_add_u32 v10, 128, v10
    v_add_u32 v11, s63, v11
    s_waitcnt vmcnt(11)
    s_barrier
    s_add_u32 m0, s62, 45056
    s_nop 0
    buffer_load_dwordx4 v11, s[48:51], s57 offen offset:1024 lds
    buffer_load_dwordx4 v11, s[48:51], s58 offen offset:2048 lds
    buffer_load_dwordx4 v11, s[48:51], s56 offen offset:0 lds
    buffer_load_dwordx4 v11, s[48:51], s59 offen offset:3072 lds
    s_cmp_lg_u32 s96, 3
    s_cbranch_scc1 F_PF3X
    s_cmp_eq_u32 s34, 3
    s_cbranch_scc1 F_PF3X
    buffer_load_dword v250, v17, s[48:51], s98 offen
    buffer_load_dword v250, v16, s[44:47], s99 offen
F_PF3X:
    s_cmp_lg_u32 s96, 3
    s_cbranch_scc1 F_PW3X
    s_cmp_lg_u32 s34, 3
    s_cbranch_scc1 F_PW3X
    s_mov_b32 s40, s8
    s_mov_b32 s41, s9
    s_mov_b32 s42, 0x200000
    s_mov_b32 s43, 0x00020000
    buffer_load_dword v250, v18, s[40:43], s100 offen
F_PW3X:
    v_mul_f32 v81, v81, v65
    v_mul_f32 v82, v82, v66
    v_mul_f32 v83, v83, v67
    v_mul_f32 v84, v84, v68
    s_add_u32 m0, s62, 40960
    s_nop 0
    buffer_load_dwordx4 v10, s[44:47], s52 offen offset:0 lds
    v_mul_f32 v85, v85, v69
    v_mul_f32 v86, v86, v70
    v_mul_f32 v87, v87, v71
    v_mul_f32 v88, v88, v72
    v_mul_f32 v89, v89, v73
    v_mul_f32 v90, v90, v74
    buffer_load_dwordx4 v10, s[44:47], s53 offen offset:1024 lds
    v_mul_f32 v91, v91, v75
    v_mul_f32 v92, v92, v76
    v_mul_f32 v93, v93, v77
    v_mul_f32 v94, v94, v78
    v_mul_f32 v95, v95, v79
    v_cvt_pk_bf16_f32 v96, v92, v88
    buffer_load_dwordx4 v10, s[44:47], s54 offen offset:2048 lds
    v_cvt_pk_bf16_f32 v97, v84, v80
    v_cvt_pk_bf16_f32 v98, v94, v90
    v_cvt_pk_bf16_f32 v99, v86, v82
    v_cvt_pk_bf16_f32 v100, v93, v89
    v_cvt_pk_bf16_f32 v101, v85, v81
    v_cvt_pk_bf16_f32 v102, v95, v91
    buffer_load_dwordx4 v10, s[44:47], s55 offen offset:3072 lds
    v_cvt_pk_bf16_f32 v103, v87, v83
    ds_read_u16_d16_hi v44, v23 offset:2
    ds_read_u16_d16_hi v45, v23 offset:130
    ds_read_u16_d16_hi v46, v23 offset:258
    ds_read_u16_d16_hi v47, v22 offset:2
    ds_read_u16_d16_hi v48, v22 offset:130
    s_add_u32 m0, s62, 49152
    s_nop 0
    buffer_load_dwordx4 v11, s[48:51], s60 offen offset:0 lds
    ds_read_u16_d16_hi v49, v22 offset:258
    ds_read_u16_d16_hi v50, v22 offset:386
    ds_read_u16_d16_hi v51, v22 offset:514
    ds_read_u16_d16_hi v52, v22 offset:642
    ds_read_u16_d16_hi v53, v22 offset:770
    ds_read_u16_d16_hi v54, v22 offset:898
    buffer_load_dwordx4 v11, s[48:51], s61 offen offset:1024 lds
    ds_read_u16_d16_hi v55, v22 offset:1026
    v_lshlrev_b32 v36, 16, v34
    v_and_b32 v37, s7, v34
    v_lshlrev_b32 v38, 16, v35
    v_and_b32 v39, s7, v35
    s_waitcnt lgkmcnt(4)
    v_mul_f32 v80, v39, v44
    v_add_u32 v10, 128, v10
    v_add_u32 v11, s63, v11
    ds_read_u16_d16_hi v56, v22 offset:1154
    v_mul_f32 v81, v39, v45
    ds_read_u16_d16_hi v57, v22 offset:1282
    v_mul_f32 v82, v39, v46
    ds_read_u16_d16_hi v58, v22 offset:1410
    v_mul_f32 v83, v39, v47
    ds_read_u16_d16_hi v59, v22 offset:1538
    v_mul_f32 v84, v39, v48
    ds_read_u16_d16_hi v60, v22 offset:1666
    v_mul_f32 v85, v39, v49
    ds_read_u16_d16_hi v61, v22 offset:1794
    v_mul_f32 v86, v39, v50
    s_waitcnt vmcnt(10)
    s_barrier
    s_add_u32 m0, s62, 86016
    s_nop 0
    buffer_load_dwordx4 v11, s[48:51], s57 offen offset:1024 lds
    buffer_load_dwordx4 v11, s[48:51], s58 offen offset:2048 lds
    buffer_load_dwordx4 v11, s[48:51], s56 offen offset:0 lds
    buffer_load_dwordx4 v11, s[48:51], s59 offen offset:3072 lds
    v_readfirstlane_b32 s68, v14
    s_mov_b32 s69, 0
F_TK:
    s_cmp_ge_u32 s68, 4
    s_cbranch_scc1 F_TKX
    s_sleep 8
    buffer_load_dword v14, v13, s[64:67], 0 offen sc1
    s_waitcnt vmcnt(0)
    v_readfirstlane_b32 s68, v14
    s_add_u32 s69, s69, 1
    s_cmp_lt_u32 s69, 400000
    s_cbranch_scc1 F_TK
F_TKX:
    ds_read_u16_d16_hi v62, v22 offset:1922
    v_mul_f32 v87, v39, v51
    ds_read_u16_d16_hi v64, v22 offset:16386
    s_waitcnt lgkmcnt(4)
    v_mul_f32 v88, v39, v52
    ds_read_u16_d16_hi v65, v22 offset:16514
    s_add_u32 m0, s62, 81920
    s_nop 0
    buffer_load_dwordx4 v10, s[44:47], s52 offen offset:0 lds
    v_mul_f32 v89, v39, v53
    ds_read_u16_d16_hi v66, v22 offset:16642
    v_mul_f32 v90, v39, v54
    ds_read_u16_d16_hi v67, v22 offset:16770
    v_mul_f32 v91, v39, v55
    ds_read_u16_d16_hi v68, v22 offset:16898
    buffer_load_dwordx4 v10, s[44:47], s53 offen offset:1024 lds
    v_mul_f32 v92, v39, v56
    ds_read_u16_d16_hi v69, v22 offset:17026
    v_mul_f32 v93, v39, v57
    ds_read_u16_d16_hi v70, v22 offset:17154
    v_mul_f32 v94, v39, v58
    ds_read_u16_d16_hi v71, v22 offset:17282
    buffer_load_dwordx4 v10, s[44:47], s54 offen offset:2048 lds
    v_mul_f32 v95, v39, v59
    ds_read_u16_d16_hi v72, v22 offset:17410
    s_waitcnt lgkmcnt(9)
    v_fmac_f32 v80, v38, v45
    ds_read_u16_d16_hi v73, v22 offset:17538
    v_fmac_f32 v81, v38, v46
    ds_read_u16_d16_hi v74, v22 offset:17666
    buffer_load_dwordx4 v10, s[44:47], s55 offen offset:3072 lds
    v_fmac_f32 v82, v38, v47
    ds_read_u16_d16_hi v75, v22 offset:17794
    v_fmac_f32 v83, v38, v48
    ds_read_u16_d16_hi v76, v22 offset:17922
    v_fmac_f32 v84, v38, v49
    ds_read_u16_d16_hi v77, v22 offset:18050
    s_add_u32 m0, s62, 90112
    s_nop 0
    buffer_load_dwordx4 v11, s[48:51], s60 offen offset:0 lds
    v_fmac_f32 v85, v38, v50
    ds_read_u16_d16_hi v78, v22 offset:18178
    v_fmac_f32 v86, v38, v51
    ds_read_u16_d16_hi v79, v22 offset:18306
    v_fmac_f32 v87, v38, v52
    v_fmac_f32 v88, v38, v53
    buffer_load_dwordx4 v11, s[48:51], s61 offen offset:1024 lds
    v_fmac_f32 v89, v38, v54
    v_fmac_f32 v90, v38, v55
    v_fmac_f32 v91, v38, v56
    v_fmac_f32 v92, v38, v57
    v_fmac_f32 v93, v38, v58
    v_fmac_f32 v94, v38, v59
    v_add_u32 v10, 128, v10
    v_add_u32 v11, s63, v11
    v_fmac_f32 v95, v38, v60
    v_fmac_f32 v80, v37, v46
    v_fmac_f32 v81, v37, v47
    v_fmac_f32 v82, v37, v48
    v_fmac_f32 v83, v37, v49
    v_fmac_f32 v84, v37, v50
    v_fmac_f32 v85, v37, v51
    v_fmac_f32 v86, v37, v52
    v_fmac_f32 v87, v37, v53
    v_fmac_f32 v88, v37, v54
    v_fmac_f32 v89, v37, v55
    s_waitcnt vmcnt(10)
    s_barrier
    s_add_u32 m0, s62, 4096
    s_nop 0
    buffer_load_dwordx4 v11, s[48:51], s57 offen offset:1024 lds
    v_fmac_f32 v90, v37, v56
    v_fmac_f32 v91, v37, v57
    v_fmac_f32 v92, v37, v58
    v_fmac_f32 v93, v37, v59
    v_fmac_f32 v94, v37, v60
    buffer_load_dwordx4 v11, s[48:51], s58 offen offset:2048 lds
    v_fmac_f32 v95, v37, v61
    v_fmac_f32 v80, v36, v47
    v_fmac_f32 v81, v36, v48
    v_fmac_f32 v82, v36, v49
    v_fmac_f32 v83, v36, v50
    buffer_load_dwordx4 v11, s[48:51], s56 offen offset:0 lds
    v_fmac_f32 v84, v36, v51
    v_fmac_f32 v85, v36, v52
    v_fmac_f32 v86, v36, v53
    v_fmac_f32 v87, v36, v54
    v_fmac_f32 v88, v36, v55
    buffer_load_dwordx4 v11, s[48:51], s59 offen offset:3072 lds
    v_fmac_f32 v89, v36, v56
    v_fmac_f32 v90, v36, v57
    v_fmac_f32 v91, v36, v58
    v_fmac_f32 v92, v36, v59
    v_fmac_f32 v93, v36, v60
    s_add_u32 m0, s62, 0
    s_nop 0
    buffer_load_dwordx4 v10, s[44:47], s52 offen offset:0 lds
    v_fmac_f32 v94, v36, v61
    v_fmac_f32 v95, v36, v62
    s_waitcnt lgkmcnt(0)
    v_mul_f32 v80, v80, v64
    v_mul_f32 v81, v81, v65
    v_mul_f32 v82, v82, v66
    buffer_load_dwordx4 v10, s[44:47], s53 offen offset:1024 lds
    v_mul_f32 v83, v83, v67
    v_mul_f32 v84, v84, v68
    v_mul_f32 v85, v85, v69
    v_mul_f32 v86, v86, v70
    v_mul_f32 v87, v87, v71
    buffer_load_dwordx4 v10, s[44:47], s54 offen offset:2048 lds
    v_mul_f32 v88, v88, v72
    v_mul_f32 v89, v89, v73
    v_mul_f32 v90, v90, v74
    v_mul_f32 v91, v91, v75
    v_mul_f32 v92, v92, v76
    buffer_load_dwordx4 v10, s[44:47], s55 offen offset:3072 lds
    v_mul_f32 v93, v93, v77
    v_mul_f32 v94, v94, v78
    v_mul_f32 v95, v95, v79
    v_cvt_pk_bf16_f32 v104, v92, v88
    v_cvt_pk_bf16_f32 v105, v84, v80
    s_add_u32 m0, s62, 8192
    s_nop 0
    buffer_load_dwordx4 v11, s[48:51], s60 offen offset:0 lds
    v_cvt_pk_bf16_f32 v106, v94, v90
    v_cvt_pk_bf16_f32 v107, v86, v82
    v_cvt_pk_bf16_f32 v108, v93, v89
    v_cvt_pk_bf16_f32 v109, v85, v81
    v_cvt_pk_bf16_f32 v110, v95, v91
    buffer_load_dwordx4 v11, s[48:51], s61 offen offset:1024 lds
    v_cvt_pk_bf16_f32 v111, v87, v83
    s_mov_b32 s69, 0x700000
    buffer_store_dwordx4 v[96:99], v25, s[36:39], s69 offen offset:0 sc1
    buffer_store_dwordx4 v[100:103], v25, s[36:39], s69 offen offset:2048 sc1
    s_mov_b32 s69, 0x701080
    buffer_store_dwordx4 v[104:107], v25, s[36:39], s69 offen offset:0 sc1
    buffer_store_dwordx4 v[108:111], v25, s[36:39], s69 offen offset:2048 sc1
    v_add_u32 v10, 128, v10
    v_add_u32 v11, s63, v11
    s_waitcnt vmcnt(14)
    s_barrier
    s_add_u32 m0, s62, 45056
    s_nop 0
    buffer_load_dwordx4 v11, s[48:51], s57 offen offset:1024 lds
    s_lshl_b32 s98, s35, 12
    buffer_load_dwordx4 v11, s[48:51], s58 offen offset:2048 lds
    s_mul_i32 s99, s34, 8320
    buffer_load_dwordx4 v11, s[48:51], s56 offen offset:0 lds
    s_add_u32 s99, s99, 122880
    buffer_load_dwordx4 v11, s[48:51], s59 offen offset:3072 lds
    s_add_u32 m0, s62, 40960
    s_nop 0
    buffer_load_dwordx4 v10, s[44:47], s52 offen offset:0 lds
    buffer_load_dwordx4 v10, s[44:47], s53 offen offset:1024 lds
    buffer_load_dwordx4 v10, s[44:47], s54 offen offset:2048 lds
    buffer_load_dwordx4 v10, s[44:47], s55 offen offset:3072 lds
    s_add_u32 m0, s62, 49152
    s_nop 0
    buffer_load_dwordx4 v11, s[48:51], s60 offen offset:0 lds
    buffer_load_dwordx4 v11, s[48:51], s61 offen offset:1024 lds
    v_add_u32 v10, 128, v10
    v_add_u32 v11, s63, v11
    s_waitcnt vmcnt(14)
    s_barrier
    s_add_u32 m0, s62, 86016
    s_nop 0
    buffer_load_dwordx4 v11, s[48:51], s57 offen offset:1024 lds
    buffer_load_dwordx4 v11, s[48:51], s58 offen offset:2048 lds
    buffer_load_dwordx4 v11, s[48:51], s56 offen offset:0 lds
    buffer_load_dwordx4 v11, s[48:51], s59 offen offset:3072 lds
    s_and_b32 s69, s2, 15
    s_lshl_b32 s69, s69, 2
    s_add_u32 s69, s69, s34
    s_lshl_b32 s4, s69, 7
    s_add_u32 s4, s4, 0x120000
    s_add_u32 s4, s4, s26
    s_addc_u32 s5, s27, 0
    s_mov_b32 s6, 1
    s_waitcnt vmcnt(14)
    s_atomic_add s6, s[4:5], 0
    v_mov_b32 v96, 0
    v_mov_b32 v97, 0
    s_add_u32 m0, s62, 81920
    s_nop 0
    buffer_load_dwordx4 v10, s[44:47], s52 offen offset:0 lds
    v_mov_b32 v98, 0
    v_mov_b32 v99, 0
    v_mov_b32 v100, 0
    buffer_load_dwordx4 v10, s[44:47], s53 offen offset:1024 lds
    v_mov_b32 v101, 0
    v_mov_b32 v102, 0
    v_mov_b32 v103, 0
    buffer_load_dwordx4 v10, s[44:47], s54 offen offset:2048 lds
    v_mov_b32 v104, 0
    v_mov_b32 v105, 0
    v_mov_b32 v106, 0
    buffer_load_dwordx4 v10, s[44:47], s55 offen offset:3072 lds
    v_mov_b32 v107, 0
    v_mov_b32 v108, 0
    v_mov_b32 v109, 0
    s_add_u32 m0, s62, 90112
    s_nop 0
    buffer_load_dwordx4 v11, s[48:51], s60 offen offset:0 lds
    v_mov_b32 v110, 0
    v_mov_b32 v111, 0
    v_mov_b32 v112, 0
    buffer_load_dwordx4 v11, s[48:51], s61 offen offset:1024 lds
    v_mov_b32 v113, 0
    v_mov_b32 v114, 0
    v_mov_b32 v115, 0
    v_add_u32 v10, 128, v10
    v_add_u32 v11, s63, v11
    s_waitcnt vmcnt(10)
    s_barrier
    s_add_u32 m0, s62, 4096
    s_nop 0
    buffer_load_dwordx4 v11, s[48:51], s57 offen offset:1024 lds
    v_mov_b32 v116, 0
    v_mov_b32 v117, 0
    v_mov_b32 v118, 0
    v_mov_b32 v119, 0
    v_mov_b32 v120, 0
    buffer_load_dwordx4 v11, s[48:51], s58 offen offset:2048 lds
    v_mov_b32 v121, 0
    v_mov_b32 v122, 0
    v_mov_b32 v123, 0
    v_mov_b32 v124, 0
    v_mov_b32 v125, 0
    buffer_load_dwordx4 v11, s[48:51], s56 offen offset:0 lds
    v_mov_b32 v126, 0
    v_mov_b32 v127, 0
    v_mov_b32 v128, 0
    v_mov_b32 v129, 0
    v_mov_b32 v130, 0
    buffer_load_dwordx4 v11, s[48:51], s59 offen offset:3072 lds
    v_mov_b32 v131, 0
    v_mov_b32 v132, 0
    v_mov_b32 v133, 0
    v_mov_b32 v134, 0
    v_mov_b32 v135, 0
    s_add_u32 m0, s62, 0
    s_nop 0
    buffer_load_dwordx4 v10, s[44:47], s52 offen offset:0 lds
    v_mov_b32 v136, 0
    v_mov_b32 v137, 0
    v_mov_b32 v138, 0
    v_mov_b32 v139, 0
    v_mov_b32 v140, 0
    buffer_load_dwordx4 v10, s[44:47], s53 offen offset:1024 lds
    v_mov_b32 v141, 0
    v_mov_b32 v142, 0
    v_mov_b32 v143, 0
    v_mov_b32 v144, 0
    v_mov_b32 v145, 0
    buffer_load_dwordx4 v10, s[44:47], s54 offen offset:2048 lds
    v_mov_b32 v146, 0
    v_mov_b32 v147, 0
    v_mov_b32 v148, 0
    v_mov_b32 v149, 0
    v_mov_b32 v150, 0
    buffer_load_dwordx4 v10, s[44:47], s55 offen offset:3072 lds
    v_mov_b32 v151, 0
    v_mov_b32 v152, 0
    v_mov_b32 v153, 0
    v_mov_b32 v154, 0
    v_mov_b32 v155, 0
    s_add_u32 m0, s62, 8192
    s_nop 0
    buffer_load_dwordx4 v11, s[48:51], s60 offen offset:0 lds
    v_mov_b32 v156, 0
    v_mov_b32 v157, 0
    v_mov_b32 v158, 0
    v_mov_b32 v159, 0
    buffer_load_dwordx4 v11, s[48:51], s61 offen offset:1024 lds
    v_add_u32 v10, 128, v10
    v_add_u32 v11, s63, v11
    s_waitcnt vmcnt(10)
    s_barrier
    s_add_u32 m0, s62, 45056
    s_nop 0
    buffer_load_dwordx4 v11, s[48:51], s57 offen offset:1024 lds
    buffer_load_dwordx4 v11, s[48:51], s58 offen offset:2048 lds
    buffer_load_dwordx4 v11, s[48:51], s56 offen offset:0 lds
    buffer_load_dwordx4 v11, s[48:51], s59 offen offset:3072 lds
    s_add_u32 s4, s18, s98
    s_addc_u32 s5, s19, 0
    s_load_dword s6, s[4:5], 0
    s_lshl_b32 s7, s35, 1
    s_and_b32 s7, s7, 0xfffffffc
    s_add_u32 s4, s20, s7
    s_addc_u32 s5, s21, 0
    s_load_dword s7, s[4:5], 0
    s_mul_i32 s97, s34, 4608
    s_add_u32 s97, s97, 98304
    v_add_u32 v32, s97, v1
    v_add_u32 v33, 2048, v32
    v_cmp_gt_u32 vcc, 16, v0
    s_add_u32 m0, s62, 40960
    s_nop 0
    buffer_load_dwordx4 v10, s[44:47], s52 offen offset:0 lds
    v_and_b32 v34, 1, v0
    v_lshlrev_b32 v34, 4, v34
    v_cndmask_b32 v32, v33, v32, vcc
    v_bfe_u32 v35, v0, 1, 1
    v_mul_u32_u24 v35, 4160, v35
    v_cmp_gt_u32 vcc, 32, v0
    buffer_load_dwordx4 v10, s[44:47], s53 offen offset:1024 lds
    v_add3_u32 v34, v34, v35, s99
    v_mov_b32 v36, 0
    v_mov_b32 v37, 0
    v_mov_b32 v38, 0
    v_mov_b32 v39, 0
    v_cndmask_b32 v32, v34, v32, vcc
    buffer_load_dwordx4 v10, s[44:47], s54 offen offset:2048 lds
    v_and_b32 v34, 3, v0
    v_lshlrev_b32 v30, 2, v34
    v_add_u32 v30, 156160, v30
    v_bfe_u32 v35, v0, 2, 2
    v_add_u32 v34, v34, v35
    v_lshlrev_b32 v34, 3, v34
    buffer_load_dwordx4 v10, s[44:47], s55 offen offset:3072 lds
    v_lshl_add_u32 v34, v5, 5, v34
    s_add_u32 s69, s99, 8
    v_add_u32 v6, s69, v34
    v_and_b32 v34, 15, v0
    v_sub_u32 v34, v34, v5
    v_lshlrev_b32 v34, 4, v34
    s_add_u32 m0, s62, 49152
    s_nop 0
    buffer_load_dwordx4 v11, s[48:51], s60 offen offset:0 lds
    s_add_u32 s69, s97, 192
    v_add_u32 v7, s69, v34
    v_mov_b32 v5, s99
    v_subrev_u32 v8, 16, v0
    v_add_u32 v9, 47, v0
    v_cmp_gt_u32 vcc, 16, v0
    buffer_load_dwordx4 v11, s[48:51], s61 offen offset:1024 lds
    v_mov_b32 v34, 63
    s_lshl_b32 s69, s34, 2
    v_cndmask_b32 v8, v8, v9, vcc
    v_cmp_eq_u32 vcc, 0, v0
    s_add_u32 s69, s69, 156192
    v_mov_b32 v9, s69
    v_add_u32 v10, 128, v10
    v_add_u32 v11, s63, v11
    v_cndmask_b32 v8, v8, v34, vcc
    v_lshlrev_b32 v8, 2, v8
    s_waitcnt lgkmcnt(0)
    s_lshl_b32 s6, s6, 16
    s_and_b32 s69, s35, 1
    s_lshl_b32 s69, s69, 4
    s_lshr_b32 s7, s7, s69
    s_lshl_b32 s7, s7, 16
    v_mov_b32 v33, s6
    v_add_f32 v33, s7, v33
    v_cvt_pk_bf16_f32 v33, v33, v33
    s_waitcnt vmcnt(10)
    s_barrier
    s_lshl_b32 s97, s34, 2
    s_add_u32 s97, s97, 156288
    v_mov_b32 v28, s97
    v_mov_b32 v29, 1
    s_waitcnt vmcnt(0)
    ds_write_b32 v28, v29
    s_mov_b32 s40, s18
    s_mov_b32 s41, s19
    s_mov_b32 s42, 0x400000
    s_mov_b32 s43, 0x00020000
    s_add_u32 m0, s99, 32
    s_nop 0
    buffer_load_dwordx4 v1, s[40:43], s98 offen offset:0 lds
    s_add_u32 m0, s99, 4196
    s_nop 0
    buffer_load_dwordx4 v1, s[40:43], s98 offen offset:0 lds
    s_add_u32 m0, s99, 32
    s_nop 0
    buffer_load_dwordx4 v1, s[40:43], s98 offen offset:1024 lds
    s_add_u32 m0, s99, 4196
    s_nop 0
    buffer_load_dwordx4 v1, s[40:43], s98 offen offset:1024 lds
    s_add_u32 m0, s99, 32
    s_nop 0
    buffer_load_dwordx4 v1, s[40:43], s98 offen offset:2048 lds
    s_add_u32 m0, s99, 4196
    s_nop 0
    buffer_load_dwordx4 v1, s[40:43], s98 offen offset:2048 lds
    s_add_u32 m0, s99, 32
    s_nop 0
    buffer_load_dwordx4 v1, s[40:43], s98 offen offset:3072 lds
    s_add_u32 m0, s99, 4196
    s_nop 0
    buffer_load_dwordx4 v1, s[40:43], s98 offen offset:3072 lds
    s_mul_i32 s52, s34, 4608
    s_add_u32 s52, s52, 98304
    s_mul_i32 s63, s35, 4224
    s_add_u32 s53, s63, 0x700000
    s_mov_b32 s40, s8
    s_mov_b32 s41, s9
    s_mov_b32 s42, 0x200000
    s_mov_b32 s43, 0x00020000
    s_lshl_b32 s62, s34, 10
    s_lshl_b32 s100, s34, 14
    s_lshl_b32 s101, s33, 7
    s_add_u32 s100, s100, s101
    s_lshr_b32 s69, s35, 4
    s_lshl_b32 s4, s69, 7
    s_add_u32 s4, s4, 0x120000
    s_add_u32 s4, s4, s26
    s_addc_u32 s5, s27, 0
    s_mov_b32 s101, 0
F_P1:
    s_mov_b32 s69, 0
    s_atomic_add s69, s[4:5], 0 glc
    s_waitcnt lgkmcnt(0)
    s_cmp_ge_u32 s69, 16
    s_cbranch_scc1 F_P1_X
    s_sleep 4
    s_add_u32 s101, s101, 1
    s_cmp_lt_u32 s101, 400000
    s_cbranch_scc1 F_P1
F_P1_X:
    s_add_u32 m0, s52, 256
    ds_write_b128 v32, v[36:39]
    buffer_load_dwordx4 v1, s[36:39], s53 offen offset:0 sc1 lds
    buffer_load_dwordx4 v1, s[36:39], s53 offen offset:1024 sc1 lds
    s_add_u32 m0, s52, 512
    ds_write_b32 v5, v36 offset:4192
    buffer_load_dwordx4 v1, s[36:39], s53 offen offset:2048 sc1 lds
    buffer_load_dwordx4 v1, s[36:39], s53 offen offset:3072 sc1 lds
    s_add_u32 m0, s62, 81920
    s_add_u32 s101, s100, 0
    buffer_load_dwordx4 v12, s[40:43], s101 offen lds
    s_add_u32 m0, s62, 86016
    s_add_u32 s101, s100, 65536
    buffer_load_dwordx4 v12, s[40:43], s101 offen lds
    s_add_u32 m0, s62, 90112
    s_add_u32 s101, s100, 131072
    buffer_load_dwordx4 v12, s[40:43], s101 offen lds
    s_add_u32 m0, s62, 94208
    s_add_u32 s101, s100, 196608
    buffer_load_dwordx4 v12, s[40:43], s101 offen lds
    s_waitcnt vmcnt(8)
    ds_write_b16 v5, v33 offset:32
    ds_write_b16 v5, v33 offset:4196
F_WG14:
    ds_read_b32 v11, v30 offset:112
    s_waitcnt lgkmcnt(0)
    v_cmp_ne_u32 vcc, 1, v11
    s_cbranch_vccz F_WG14_X
    s_sleep 1
    s_branch F_WG14
F_WG14_X:
    s_add_u32 m0, s62, 0
    s_add_u32 s101, s100, 262144
    buffer_load_dwordx4 v12, s[40:43], s101 offen lds
    s_add_u32 m0, s62, 4096
    s_add_u32 s101, s100, 327680
    buffer_load_dwordx4 v12, s[40:43], s101 offen lds
    s_add_u32 m0, s62, 8192
    s_add_u32 s101, s100, 393216
    buffer_load_dwordx4 v12, s[40:43], s101 offen lds
    s_add_u32 m0, s62, 12288
    s_add_u32 s101, s100, 458752
    buffer_load_dwordx4 v12, s[40:43], s101 offen lds
    s_add_u32 m0, s62, 16384
    s_add_u32 s101, s100, 524288
    buffer_load_dwordx4 v12, s[40:43], s101 offen lds
    s_add_u32 m0, s62, 20480
    s_add_u32 s101, s100, 589824
    buffer_load_dwordx4 v12, s[40:43], s101 offen lds
    s_add_u32 m0, s62, 24576
    s_add_u32 s101, s100, 655360
    buffer_load_dwordx4 v12, s[40:43], s101 offen lds
    s_add_u32 m0, s62, 28672
    s_add_u32 s101, s100, 720896
    buffer_load_dwordx4 v12, s[40:43], s101 offen lds
    s_add_u32 m0, s62, 32768
    s_add_u32 s101, s100, 786432
    buffer_load_dwordx4 v12, s[40:43], s101 offen lds
    s_add_u32 m0, s62, 36864
    s_add_u32 s101, s100, 851968
    buffer_load_dwordx4 v12, s[40:43], s101 offen lds
F_WGDx:
    ds_read_b32 v11, v30 offset:80
    s_waitcnt lgkmcnt(0)
    v_cmp_ne_u32 vcc, 1, v11
    s_cbranch_vccz F_WGDx_X
    s_sleep 1
    s_branch F_WGDx
F_WGDx_X:
    s_add_u32 m0, s62, 40960
    s_add_u32 s101, s100, 917504
    buffer_load_dwordx4 v12, s[40:43], s101 offen lds
    s_add_u32 m0, s62, 45056
    s_add_u32 s101, s100, 983040
    buffer_load_dwordx4 v12, s[40:43], s101 offen lds
    s_add_u32 m0, s62, 49152
    s_add_u32 s101, s100, 1048576
    buffer_load_dwordx4 v12, s[40:43], s101 offen lds
    s_add_u32 m0, s62, 53248
    s_add_u32 s101, s100, 1114112
    buffer_load_dwordx4 v12, s[40:43], s101 offen lds
    s_add_u32 m0, s62, 57344
    s_add_u32 s101, s100, 1179648
    buffer_load_dwordx4 v12, s[40:43], s101 offen lds
    s_add_u32 m0, s62, 61440
    s_add_u32 s101, s100, 1245184
    buffer_load_dwordx4 v12, s[40:43], s101 offen lds
    s_add_u32 m0, s62, 65536
    s_add_u32 s101, s100, 1310720
    buffer_load_dwordx4 v12, s[40:43], s101 offen lds
    s_add_u32 m0, s62, 69632
    s_add_u32 s101, s100, 1376256
    buffer_load_dwordx4 v12, s[40:43], s101 offen lds
    s_add_u32 m0, s62, 73728
    s_add_u32 s101, s100, 1441792
    buffer_load_dwordx4 v12, s[40:43], s101 offen lds
    s_add_u32 m0, s62, 77824
    s_add_u32 s101, s100, 1507328
    buffer_load_dwordx4 v12, s[40:43], s101 offen lds
    s_sleep 8
    s_waitcnt vmcnt(24)
    s_cmp_ge_u32 s34, 2
    s_cbranch_scc1 F_QLX
    s_mov_b32 s44, s10
    s_mov_b32 s45, s11
    s_mov_b32 s46, 0x400000
    s_mov_b32 s47, 0x00020000
    s_and_b32 s69, s2, 15
    s_lshl_b32 s69, s69, 7
    s_add_u32 s97, s69, 0
    buffer_load_dwordx4 v[200:203], v234, s[44:47], s97 offen offset:0 nt
    s_add_u32 s97, s69, 0
    buffer_load_dwordx4 v[204:207], v234, s[44:47], s97 offen offset:2048 nt
    s_add_u32 s97, s69, 4096
    buffer_load_dwordx4 v[208:211], v234, s[44:47], s97 offen offset:0 nt
    s_add_u32 s97, s69, 4096
    buffer_load_dwordx4 v[212:215], v234, s[44:47], s97 offen offset:2048 nt
    s_add_u32 s97, s69, 524288
    buffer_load_dwordx4 v[216:219], v234, s[44:47], s97 offen offset:0 nt
    s_add_u32 s97, s69, 524288
    buffer_load_dwordx4 v[220:223], v234, s[44:47], s97 offen offset:2048 nt
    s_add_u32 s97, s69, 528384
    buffer_load_dwordx4 v[224:227], v234, s[44:47], s97 offen offset:0 nt
    s_add_u32 s97, s69, 528384
    buffer_load_dwordx4 v[228:231], v234, s[44:47], s97 offen offset:2048 nt
F_QLX:
    ds_read_b128 v[76:79], v7 offset:1856
    ds_read_b64_tr_b16 v[16:17], v6 offset:0
    ds_read_b64_tr_b16 v[18:19], v6 offset:4160
    ds_read_b128 v[72:75], v7 offset:1600
    ds_read_b64_tr_b16 v[20:21], v6 offset:512
    ds_read_b64_tr_b16 v[22:23], v6 offset:4672
    ds_read_b128 v[68:71], v7 offset:1344
    ds_read_b64_tr_b16 v[24:25], v6 offset:1024
    ds_read_b64_tr_b16 v[26:27], v6 offset:5184
    ds_read_b128 v[64:67], v7 offset:1088
    ds_read_b64_tr_b16 v[28:29], v6 offset:1536
    ds_read_b64_tr_b16 v[30:31], v6 offset:5696
    ds_read_b128 v[60:63], v7 offset:832
    ds_read_b64_tr_b16 v[32:33], v6 offset:2048
    ds_read_b64_tr_b16 v[34:35], v6 offset:6208
    ds_read_b128 v[56:59], v7 offset:576
    ds_read_b64_tr_b16 v[36:37], v6 offset:2560
    ds_read_b64_tr_b16 v[38:39], v6 offset:6720
    ds_read_b128 v[52:55], v7 offset:320
    ds_read_b64_tr_b16 v[40:41], v6 offset:3072
    ds_read_b64_tr_b16 v[42:43], v6 offset:7232
    ds_read_b128 v[48:51], v7 offset:64
    ds_read_b64_tr_b16 v[44:45], v6 offset:3584
    ds_read_b64_tr_b16 v[46:47], v6 offset:7744
    v_mov_b32 v10, 1
    s_mov_b64 s[60:61], 1
    s_mov_b32 s58, 0
.p2align 6
F_VLOOP:
    s_waitcnt lgkmcnt(15)
    v_mfma_f32_16x16x32_bf16 v[124:127], v[16:19], v[76:79], v[124:127]
    ds_read_b128 v[80:83], v7 offset:2368
    ds_read_b128 v[76:79], v7 offset:4160
    v_mfma_f32_16x16x32_bf16 v[120:123], v[16:19], v[72:75], v[120:123]
    v_mfma_f32_16x16x32_bf16 v[124:127], v[20:23], v[72:75], v[124:127]
    ds_read_b128 v[72:75], v7 offset:3904
    v_mfma_f32_16x16x32_bf16 v[116:119], v[16:19], v[68:71], v[116:119]
    v_mfma_f32_16x16x32_bf16 v[120:123], v[20:23], v[68:71], v[120:123]
    s_waitcnt lgkmcnt(15)
    v_mfma_f32_16x16x32_bf16 v[124:127], v[24:27], v[68:71], v[124:127]
    ds_read_b128 v[68:71], v7 offset:3648
    s_waitcnt lgkmcnt(15)
    v_mfma_f32_16x16x32_bf16 v[112:115], v[16:19], v[64:67], v[112:115]
    v_mfma_f32_16x16x32_bf16 v[116:119], v[20:23], v[64:67], v[116:119]
    v_mfma_f32_16x16x32_bf16 v[120:123], v[24:27], v[64:67], v[120:123]
    v_mfma_f32_16x16x32_bf16 v[124:127], v[28:31], v[64:67], v[124:127]
    ds_read_b128 v[64:67], v7 offset:3392
    s_waitcnt lgkmcnt(15)
    v_mfma_f32_16x16x32_bf16 v[108:111], v[16:19], v[60:63], v[108:111]
    v_mfma_f32_16x16x32_bf16 v[112:115], v[20:23], v[60:63], v[112:115]
    v_mfma_f32_16x16x32_bf16 v[116:119], v[24:27], v[60:63], v[116:119]
    v_mfma_f32_16x16x32_bf16 v[120:123], v[28:31], v[60:63], v[120:123]
    s_waitcnt lgkmcnt(13)
    v_mfma_f32_16x16x32_bf16 v[124:127], v[32:35], v[60:63], v[124:127]
    ds_read_b128 v[60:63], v7 offset:3136
    s_waitcnt lgkmcnt(13)
    v_mfma_f32_16x16x32_bf16 v[104:107], v[16:19], v[56:59], v[104:107]
    v_mfma_f32_16x16x32_bf16 v[108:111], v[20:23], v[56:59], v[108:111]
    v_mfma_f32_16x16x32_bf16 v[112:115], v[24:27], v[56:59], v[112:115]
    v_mfma_f32_16x16x32_bf16 v[116:119], v[28:31], v[56:59], v[116:119]
    v_mfma_f32_16x16x32_bf16 v[120:123], v[32:35], v[56:59], v[120:123]
    s_waitcnt lgkmcnt(11)
    v_mfma_f32_16x16x32_bf16 v[124:127], v[36:39], v[56:59], v[124:127]
    ds_read_b128 v[56:59], v7 offset:2880
    s_waitcnt lgkmcnt(11)
    v_mfma_f32_16x16x32_bf16 v[100:103], v[16:19], v[52:55], v[100:103]
    v_mfma_f32_16x16x32_bf16 v[104:107], v[20:23], v[52:55], v[104:107]
    v_mfma_f32_16x16x32_bf16 v[108:111], v[24:27], v[52:55], v[108:111]
    v_mfma_f32_16x16x32_bf16 v[112:115], v[28:31], v[52:55], v[112:115]
    v_mfma_f32_16x16x32_bf16 v[116:119], v[32:35], v[52:55], v[116:119]
    v_mfma_f32_16x16x32_bf16 v[120:123], v[36:39], v[52:55], v[120:123]
    s_waitcnt lgkmcnt(9)
    v_mfma_f32_16x16x32_bf16 v[124:127], v[40:43], v[52:55], v[124:127]
    ds_read_b128 v[52:55], v7 offset:2624
    s_waitcnt lgkmcnt(10)
    v_mfma_f32_16x16x32_bf16 v[96:99], v[16:19], v[48:51], v[96:99]
    v_mfma_f32_16x16x32_bf16 v[100:103], v[20:23], v[48:51], v[100:103]
    v_mfma_f32_16x16x32_bf16 v[104:107], v[24:27], v[48:51], v[104:107]
    v_mfma_f32_16x16x32_bf16 v[108:111], v[28:31], v[48:51], v[108:111]
    v_mfma_f32_16x16x32_bf16 v[112:115], v[32:35], v[48:51], v[112:115]
    v_mfma_f32_16x16x32_bf16 v[116:119], v[36:39], v[48:51], v[116:119]
    v_mfma_f32_16x16x32_bf16 v[120:123], v[40:43], v[48:51], v[120:123]
    s_waitcnt lgkmcnt(8)
    v_mfma_f32_16x16x32_bf16 v[124:127], v[44:47], v[48:51], v[124:127]
    s_waitcnt lgkmcnt(6)
    v_mfma_f32_16x16x32_bf16 v[156:159], v[16:19], v[76:79], v[156:159]
    ds_read_b128 v[48:51], v7 offset:0
    ds_read_b128 v[76:79], v7 offset:1792
    s_waitcnt lgkmcnt(7)
    v_mfma_f32_16x16x32_bf16 v[152:155], v[16:19], v[72:75], v[152:155]
    s_waitcnt lgkmcnt(6)
    v_mfma_f32_16x16x32_bf16 v[148:151], v[16:19], v[68:71], v[148:151]
    s_waitcnt lgkmcnt(5)
    v_mfma_f32_16x16x32_bf16 v[144:147], v[16:19], v[64:67], v[144:147]
    s_waitcnt lgkmcnt(4)
    v_mfma_f32_16x16x32_bf16 v[140:143], v[16:19], v[60:63], v[140:143]
    s_waitcnt lgkmcnt(3)
    v_mfma_f32_16x16x32_bf16 v[136:139], v[16:19], v[56:59], v[136:139]
    s_waitcnt lgkmcnt(2)
    v_mfma_f32_16x16x32_bf16 v[132:135], v[16:19], v[52:55], v[132:135]
    v_mfma_f32_16x16x32_bf16 v[128:131], v[16:19], v[80:83], v[128:131]
    ds_read_b64_tr_b16 v[16:17], v6 offset:128
    ds_read_b64_tr_b16 v[18:19], v6 offset:4288
    v_mfma_f32_16x16x32_bf16 v[156:159], v[20:23], v[72:75], v[156:159]
    ds_read_b128 v[72:75], v7 offset:1536
    v_mfma_f32_16x16x32_bf16 v[152:155], v[20:23], v[68:71], v[152:155]
    v_mfma_f32_16x16x32_bf16 v[148:151], v[20:23], v[64:67], v[148:151]
    v_mfma_f32_16x16x32_bf16 v[144:147], v[20:23], v[60:63], v[144:147]
    v_mfma_f32_16x16x32_bf16 v[140:143], v[20:23], v[56:59], v[140:143]
    v_mfma_f32_16x16x32_bf16 v[136:139], v[20:23], v[52:55], v[136:139]
    v_mfma_f32_16x16x32_bf16 v[132:135], v[20:23], v[80:83], v[132:135]
    ds_read_b64_tr_b16 v[20:21], v6 offset:640
    ds_read_b64_tr_b16 v[22:23], v6 offset:4800
    v_mfma_f32_16x16x32_bf16 v[156:159], v[24:27], v[68:71], v[156:159]
    ds_read_b128 v[68:71], v7 offset:1280
    v_mfma_f32_16x16x32_bf16 v[152:155], v[24:27], v[64:67], v[152:155]
    v_mfma_f32_16x16x32_bf16 v[148:151], v[24:27], v[60:63], v[148:151]
    v_mfma_f32_16x16x32_bf16 v[144:147], v[24:27], v[56:59], v[144:147]
    v_mfma_f32_16x16x32_bf16 v[140:143], v[24:27], v[52:55], v[140:143]
    v_mfma_f32_16x16x32_bf16 v[136:139], v[24:27], v[80:83], v[136:139]
    ds_read_b64_tr_b16 v[24:25], v6 offset:1152
    ds_read_b64_tr_b16 v[26:27], v6 offset:5312
    v_mfma_f32_16x16x32_bf16 v[156:159], v[28:31], v[64:67], v[156:159]
    ds_read_b128 v[64:67], v7 offset:1024
    v_mfma_f32_16x16x32_bf16 v[152:155], v[28:31], v[60:63], v[152:155]
    v_mfma_f32_16x16x32_bf16 v[148:151], v[28:31], v[56:59], v[148:151]
    v_mfma_f32_16x16x32_bf16 v[144:147], v[28:31], v[52:55], v[144:147]
    v_mfma_f32_16x16x32_bf16 v[140:143], v[28:31], v[80:83], v[140:143]
    ds_read_b64_tr_b16 v[28:29], v6 offset:1664
    ds_read_b64_tr_b16 v[30:31], v6 offset:5824
    v_mfma_f32_16x16x32_bf16 v[156:159], v[32:35], v[60:63], v[156:159]
    ds_read_b128 v[60:63], v7 offset:768
    v_mfma_f32_16x16x32_bf16 v[152:155], v[32:35], v[56:59], v[152:155]
    v_mfma_f32_16x16x32_bf16 v[148:151], v[32:35], v[52:55], v[148:151]
    v_mfma_f32_16x16x32_bf16 v[144:147], v[32:35], v[80:83], v[144:147]
    ds_read_b64_tr_b16 v[32:33], v6 offset:2176
    ds_read_b64_tr_b16 v[34:35], v6 offset:6336
    v_mfma_f32_16x16x32_bf16 v[156:159], v[36:39], v[56:59], v[156:159]
    ds_read_b128 v[56:59], v7 offset:512
    v_mfma_f32_16x16x32_bf16 v[152:155], v[36:39], v[52:55], v[152:155]
    v_mfma_f32_16x16x32_bf16 v[148:151], v[36:39], v[80:83], v[148:151]
    ds_read_b64_tr_b16 v[36:37], v6 offset:2688
    ds_read_b64_tr_b16 v[38:39], v6 offset:6848
    v_mfma_f32_16x16x32_bf16 v[156:159], v[40:43], v[52:55], v[156:159]
    ds_read_b128 v[52:55], v7 offset:256
    v_mfma_f32_16x16x32_bf16 v[152:155], v[40:43], v[80:83], v[152:155]
    ds_read_b64_tr_b16 v[40:41], v6 offset:3200
    ds_read_b64_tr_b16 v[42:43], v6 offset:7360
    v_mfma_f32_16x16x32_bf16 v[156:159], v[44:47], v[80:83], v[156:159]
    ds_read_b64_tr_b16 v[44:45], v6 offset:3712
    ds_read_b64_tr_b16 v[46:47], v6 offset:7872
    s_waitcnt vmcnt(0)
    ds_write_b32 v9, v10 offset:112
    v_add_u32 v6, 128, v6
    v_subrev_u32 v7, 64, v7
    s_add_u32 s58, s58, 1
    s_cmp_lt_u32 s58, 4
    s_cbranch_scc1 F_VLOOP
    s_waitcnt lgkmcnt(0)
    ds_write_b32 v9, v10
    ds_bpermute_b32 v17, v8, v131
    ds_bpermute_b32 v18, v8, v135
    ds_bpermute_b32 v19, v8, v139
    ds_bpermute_b32 v20, v8, v143
    ds_bpermute_b32 v21, v8, v147
    ds_bpermute_b32 v22, v8, v151
    ds_bpermute_b32 v23, v8, v155
    ds_bpermute_b32 v24, v8, v159
    v_mov_b32 v16, 0
    v_add_f32 v97, v97, v128
    v_add_f32 v98, v98, v129
    v_add_f32 v99, v99, v130
    v_add_f32 v101, v101, v132
    v_add_f32 v102, v102, v133
    v_add_f32 v103, v103, v134
    v_add_f32 v105, v105, v136
    v_add_f32 v106, v106, v137
    v_add_f32 v107, v107, v138
    v_add_f32 v109, v109, v140
    v_add_f32 v110, v110, v141
    v_add_f32 v111, v111, v142
    v_add_f32 v113, v113, v144
    v_add_f32 v114, v114, v145
    v_add_f32 v115, v115, v146
    v_add_f32 v117, v117, v148
    v_add_f32 v118, v118, v149
    v_add_f32 v119, v119, v150
    v_add_f32 v121, v121, v152
    v_add_f32 v122, v122, v153
    v_add_f32 v123, v123, v154
    v_add_f32 v125, v125, v156
    v_add_f32 v126, v126, v157
    v_add_f32 v127, v127, v158
    s_waitcnt lgkmcnt(0)
    v_cndmask_b32 v28, v17, v16, s[60:61]
    v_cndmask_b32 v29, v18, v17, s[60:61]
    v_cndmask_b32 v30, v19, v18, s[60:61]
    v_cndmask_b32 v31, v20, v19, s[60:61]
    v_cndmask_b32 v32, v21, v20, s[60:61]
    v_cndmask_b32 v33, v22, v21, s[60:61]
    v_cndmask_b32 v34, v23, v22, s[60:61]
    v_cndmask_b32 v35, v24, v23, s[60:61]
    v_add_f32 v96, v96, v28
    v_add_f32 v100, v100, v29
    v_add_f32 v104, v104, v30
    v_add_f32 v108, v108, v31
    v_add_f32 v112, v112, v32
    v_add_f32 v116, v116, v33
    v_add_f32 v120, v120, v34
    v_add_f32 v124, v124, v35
    v_cvt_pk_bf16_f32 v48, v96, v97
    v_cvt_pk_bf16_f32 v49, v98, v99
    v_cvt_pk_bf16_f32 v50, v100, v101
    v_cvt_pk_bf16_f32 v51, v102, v103
    v_cvt_pk_bf16_f32 v52, v104, v105
    v_cvt_pk_bf16_f32 v53, v106, v107
    v_cvt_pk_bf16_f32 v54, v108, v109
    v_cvt_pk_bf16_f32 v55, v110, v111
    v_cvt_pk_bf16_f32 v56, v112, v113
    v_cvt_pk_bf16_f32 v57, v114, v115
    v_cvt_pk_bf16_f32 v58, v116, v117
    v_cvt_pk_bf16_f32 v59, v118, v119
    v_cvt_pk_bf16_f32 v60, v120, v121
    v_cvt_pk_bf16_f32 v61, v122, v123
    v_cvt_pk_bf16_f32 v62, v124, v125
    v_cvt_pk_bf16_f32 v63, v126, v127
    s_add_u32 s53, s63, 0xc00000
    buffer_store_dwordx4 v[48:51], v1, s[36:39], s53 offen offset:0 sc1
    buffer_store_dwordx4 v[52:55], v1, s[36:39], s53 offen offset:1024 sc1
    buffer_store_dwordx4 v[56:59], v1, s[36:39], s53 offen offset:2048 sc1
    buffer_store_dwordx4 v[60:63], v1, s[36:39], s53 offen offset:3072 sc1
    s_lshr_b32 s69, s35, 6
    s_lshl_b32 s4, s69, 7
    s_add_u32 s4, s4, 0x125000
    s_add_u32 s4, s4, s26
    s_addc_u32 s5, s27, 0
    s_mov_b32 s69, 1
    s_cmp_ge_u32 s34, 2
    s_cbranch_scc0 F_POST
    v_and_b32 v9, 3, v0
    v_lshlrev_b32 v9, 2, v9
    v_and_b32 v11, 4, v0
    v_lshl_add_u32 v9, v11, 3, v9
    v_add_u32 v9, 156192, v9
F_WL:
    ds_read_b32 v11, v9 offset:0
    s_waitcnt lgkmcnt(0)
    v_cmp_ne_u32 vcc, 1, v11
    s_cbranch_vccz F_WL_X
    s_sleep 1
    s_branch F_WL
F_WL_X:
    s_add_u32 s62, s62, 96256
    s_add_u32 s100, s100, 1540096
    s_add_u32 m0, s62, 0
    s_add_u32 s101, s100, 0
    buffer_load_dwordx4 v12, s[40:43], s101 offen lds
    s_add_u32 m0, s62, 2048
    s_add_u32 s101, s100, 32768
    buffer_load_dwordx4 v12, s[40:43], s101 offen lds
    s_add_u32 m0, s62, 4096
    s_add_u32 s101, s100, 65536
    buffer_load_dwordx4 v12, s[40:43], s101 offen lds
    s_add_u32 m0, s62, 6144
    s_add_u32 s101, s100, 98304
    buffer_load_dwordx4 v12, s[40:43], s101 offen lds
    s_add_u32 m0, s62, 8192
    s_add_u32 s101, s100, 131072
    buffer_load_dwordx4 v12, s[40:43], s101 offen lds
    s_add_u32 m0, s62, 10240
    s_add_u32 s101, s100, 163840
    buffer_load_dwordx4 v12, s[40:43], s101 offen lds
    s_add_u32 m0, s62, 12288
    s_add_u32 s101, s100, 196608
    buffer_load_dwordx4 v12, s[40:43], s101 offen lds
    s_add_u32 m0, s62, 14336
    s_add_u32 s101, s100, 229376
    buffer_load_dwordx4 v12, s[40:43], s101 offen lds
    s_add_u32 m0, s62, 16384
    s_add_u32 s101, s100, 262144
    buffer_load_dwordx4 v12, s[40:43], s101 offen lds
    s_add_u32 m0, s62, 18432
    s_add_u32 s101, s100, 294912
    buffer_load_dwordx4 v12, s[40:43], s101 offen lds
    s_add_u32 m0, s62, 20480
    s_add_u32 s101, s100, 327680
    buffer_load_dwordx4 v12, s[40:43], s101 offen lds
    s_add_u32 m0, s62, 22528
    s_add_u32 s101, s100, 360448
    buffer_load_dwordx4 v12, s[40:43], s101 offen lds
    s_add_u32 m0, s62, 24576
    s_add_u32 s101, s100, 393216
    buffer_load_dwordx4 v12, s[40:43], s101 offen lds
    s_add_u32 m0, s62, 26624
    s_add_u32 s101, s100, 425984
    buffer_load_dwordx4 v12, s[40:43], s101 offen lds
    s_add_u32 m0, s62, 28672
    s_add_u32 s101, s100, 458752
    buffer_load_dwordx4 v12, s[40:43], s101 offen lds
    s_add_u32 m0, s62, 30720
    s_add_u32 s101, s100, 491520
    buffer_load_dwordx4 v12, s[40:43], s101 offen lds
    s_waitcnt vmcnt(16)
    s_atomic_add s69, s[4:5], 0
    s_lshl_b32 s58, s34, 2
    s_add_u32 s58, s58, 156200
    v_mov_b32 v9, s58
    s_waitcnt vmcnt(0)
    ds_write_b32 v9, v10
    s_waitcnt lgkmcnt(0)
    s_endpgm
F_POST:
    s_and_b32 s52, s2, 15
    s_lshl_b32 s56, s52, 7
    s_mul_i32 s53, s52, 270336
    s_add_u32 s53, s53, 0xc00000
    s_mov_b32 s44, s22
    s_mov_b32 s45, s23
    s_mov_b32 s46, 0x800000
    s_mov_b32 s47, 0x00020000
    s_mov_b32 s55, 0xffff0000
    s_add_u32 s56, s56, 2048
    s_waitcnt vmcnt(0)
    s_atomic_add s69, s[4:5], 0
    s_lshl_b32 s6, s52, 7
    s_add_u32 s6, s6, 0x125000
    s_add_u32 s6, s6, s26
    s_addc_u32 s7, s27, 0
    s_mov_b32 s101, 0
F_P4:
    s_mov_b32 s54, 0
    s_atomic_add s54, s[6:7], 0 glc
    s_waitcnt lgkmcnt(0)
    s_cmp_ge_u32 s54, 64
    s_cbranch_scc1 F_P4_X
    s_sleep 16
    s_add_u32 s101, s101, 1
    s_cmp_lt_u32 s101, 400000
    s_cbranch_scc1 F_P4
F_P4_X:
    buffer_load_dwordx4 v[48:51], v232, s[36:39], s53 offen sc1
    s_add_u32 s53, s53, 4224
    buffer_load_dwordx4 v[52:55], v232, s[36:39], s53 offen sc1
    s_add_u32 s53, s53, 4224
    buffer_load_dwordx4 v[56:59], v232, s[36:39], s53 offen sc1
    s_add_u32 s53, s53, 4224
    buffer_load_dwordx4 v[60:63], v232, s[36:39], s53 offen sc1
    s_add_u32 s53, s53, 4224
    buffer_load_dwordx4 v[64:67], v232, s[36:39], s53 offen sc1
    s_add_u32 s53, s53, 4224
    buffer_load_dwordx4 v[68:71], v232, s[36:39], s53 offen sc1
    s_add_u32 s53, s53, 4224
    buffer_load_dwordx4 v[72:75], v232, s[36:39], s53 offen sc1
    s_add_u32 s53, s53, 4224
    buffer_load_dwordx4 v[76:79], v232, s[36:39], s53 offen sc1
    s_waitcnt vmcnt(0)
    v_lshlrev_b32 v80, 16, v200
    v_lshlrev_b32 v88, 16, v48
    v_and_b32 v81, s55, v200
    v_lshlrev_b32 v89, 16, v52
    v_lshlrev_b32 v82, 16, v201
    v_lshlrev_b32 v90, 16, v56
    v_and_b32 v83, s55, v201
    v_lshlrev_b32 v91, 16, v60
    v_lshlrev_b32 v84, 16, v202
    v_lshlrev_b32 v92, 16, v64
    v_and_b32 v85, s55, v202
    v_lshlrev_b32 v93, 16, v68
    v_lshlrev_b32 v86, 16, v203
    v_lshlrev_b32 v94, 16, v72
    v_and_b32 v87, s55, v203
    v_lshlrev_b32 v95, 16, v76
    v_mul_f32 v80, v80, v88
    v_mul_f32 v81, v81, v89
    v_mul_f32 v82, v82, v90
    v_mul_f32 v83, v83, v91
    v_mul_f32 v84, v84, v92
    v_mul_f32 v85, v85, v93
    v_mul_f32 v86, v86, v94
    v_mul_f32 v87, v87, v95
    v_cvt_pk_bf16_f32 v100, v80, v81
    v_cvt_pk_bf16_f32 v101, v82, v83
    v_cvt_pk_bf16_f32 v102, v84, v85
    v_cvt_pk_bf16_f32 v103, v86, v87
    s_add_u32 s57, s56, 0
    buffer_store_dwordx4 v[100:103], v233, s[44:47], s57 offen sc1
    v_lshlrev_b32 v80, 16, v204
    v_and_b32 v88, s55, v48
    v_and_b32 v81, s55, v204
    v_and_b32 v89, s55, v52
    v_lshlrev_b32 v82, 16, v205
    v_and_b32 v90, s55, v56
    v_and_b32 v83, s55, v205
    v_and_b32 v91, s55, v60
    v_lshlrev_b32 v84, 16, v206
    v_and_b32 v92, s55, v64
    v_and_b32 v85, s55, v206
    v_and_b32 v93, s55, v68
    v_lshlrev_b32 v86, 16, v207
    v_and_b32 v94, s55, v72
    v_and_b32 v87, s55, v207
    v_and_b32 v95, s55, v76
    v_mul_f32 v80, v80, v88
    v_mul_f32 v81, v81, v89
    v_mul_f32 v82, v82, v90
    v_mul_f32 v83, v83, v91
    v_mul_f32 v84, v84, v92
    v_mul_f32 v85, v85, v93
    v_mul_f32 v86, v86, v94
    v_mul_f32 v87, v87, v95
    v_cvt_pk_bf16_f32 v104, v80, v81
    v_cvt_pk_bf16_f32 v105, v82, v83
    v_cvt_pk_bf16_f32 v106, v84, v85
    v_cvt_pk_bf16_f32 v107, v86, v87
    s_add_u32 s57, s56, 4096
    buffer_store_dwordx4 v[104:107], v233, s[44:47], s57 offen sc1
    v_lshlrev_b32 v80, 16, v208
    v_lshlrev_b32 v88, 16, v49
    v_and_b32 v81, s55, v208
    v_lshlrev_b32 v89, 16, v53
    v_lshlrev_b32 v82, 16, v209
    v_lshlrev_b32 v90, 16, v57
    v_and_b32 v83, s55, v209
    v_lshlrev_b32 v91, 16, v61
    v_lshlrev_b32 v84, 16, v210
    v_lshlrev_b32 v92, 16, v65
    v_and_b32 v85, s55, v210
    v_lshlrev_b32 v93, 16, v69
    v_lshlrev_b32 v86, 16, v211
    v_lshlrev_b32 v94, 16, v73
    v_and_b32 v87, s55, v211
    v_lshlrev_b32 v95, 16, v77
    v_mul_f32 v80, v80, v88
    v_mul_f32 v81, v81, v89
    v_mul_f32 v82, v82, v90
    v_mul_f32 v83, v83, v91
    v_mul_f32 v84, v84, v92
    v_mul_f32 v85, v85, v93
    v_mul_f32 v86, v86, v94
    v_mul_f32 v87, v87, v95
    v_cvt_pk_bf16_f32 v108, v80, v81
    v_cvt_pk_bf16_f32 v109, v82, v83
    v_cvt_pk_bf16_f32 v110, v84, v85
    v_cvt_pk_bf16_f32 v111, v86, v87
    s_add_u32 s57, s56, 8192
    buffer_store_dwordx4 v[108:111], v233, s[44:47], s57 offen sc1
    v_lshlrev_b32 v80, 16, v212
    v_and_b32 v88, s55, v49
    v_and_b32 v81, s55, v212
    v_and_b32 v89, s55, v53
    v_lshlrev_b32 v82, 16, v213
    v_and_b32 v90, s55, v57
    v_and_b32 v83, s55, v213
    v_and_b32 v91, s55, v61
    v_lshlrev_b32 v84, 16, v214
    v_and_b32 v92, s55, v65
    v_and_b32 v85, s55, v214
    v_and_b32 v93, s55, v69
    v_lshlrev_b32 v86, 16, v215
    v_and_b32 v94, s55, v73
    v_and_b32 v87, s55, v215
    v_and_b32 v95, s55, v77
    v_mul_f32 v80, v80, v88
    v_mul_f32 v81, v81, v89
    v_mul_f32 v82, v82, v90
    v_mul_f32 v83, v83, v91
    v_mul_f32 v84, v84, v92
    v_mul_f32 v85, v85, v93
    v_mul_f32 v86, v86, v94
    v_mul_f32 v87, v87, v95
    v_cvt_pk_bf16_f32 v112, v80, v81
    v_cvt_pk_bf16_f32 v113, v82, v83
    v_cvt_pk_bf16_f32 v114, v84, v85
    v_cvt_pk_bf16_f32 v115, v86, v87
    s_add_u32 s57, s56, 12288
    buffer_store_dwordx4 v[112:115], v233, s[44:47], s57 offen sc1
    v_lshlrev_b32 v80, 16, v216
    v_lshlrev_b32 v88, 16, v50
    v_and_b32 v81, s55, v216
    v_lshlrev_b32 v89, 16, v54
    v_lshlrev_b32 v82, 16, v217
    v_lshlrev_b32 v90, 16, v58
    v_and_b32 v83, s55, v217
    v_lshlrev_b32 v91, 16, v62
    v_lshlrev_b32 v84, 16, v218
    v_lshlrev_b32 v92, 16, v66
    v_and_b32 v85, s55, v218
    v_lshlrev_b32 v93, 16, v70
    v_lshlrev_b32 v86, 16, v219
    v_lshlrev_b32 v94, 16, v74
    v_and_b32 v87, s55, v219
    v_lshlrev_b32 v95, 16, v78
    v_mul_f32 v80, v80, v88
    v_mul_f32 v81, v81, v89
    v_mul_f32 v82, v82, v90
    v_mul_f32 v83, v83, v91
    v_mul_f32 v84, v84, v92
    v_mul_f32 v85, v85, v93
    v_mul_f32 v86, v86, v94
    v_mul_f32 v87, v87, v95
    v_cvt_pk_bf16_f32 v116, v80, v81
    v_cvt_pk_bf16_f32 v117, v82, v83
    v_cvt_pk_bf16_f32 v118, v84, v85
    v_cvt_pk_bf16_f32 v119, v86, v87
    s_add_u32 s57, s56, 1048576
    buffer_store_dwordx4 v[116:119], v233, s[44:47], s57 offen sc1
    v_lshlrev_b32 v80, 16, v220
    v_and_b32 v88, s55, v50
    v_and_b32 v81, s55, v220
    v_and_b32 v89, s55, v54
    v_lshlrev_b32 v82, 16, v221
    v_and_b32 v90, s55, v58
    v_and_b32 v83, s55, v221
    v_and_b32 v91, s55, v62
    v_lshlrev_b32 v84, 16, v222
    v_and_b32 v92, s55, v66
    v_and_b32 v85, s55, v222
    v_and_b32 v93, s55, v70
    v_lshlrev_b32 v86, 16, v223
    v_and_b32 v94, s55, v74
    v_and_b32 v87, s55, v223
    v_and_b32 v95, s55, v78
    v_mul_f32 v80, v80, v88
    v_mul_f32 v81, v81, v89
    v_mul_f32 v82, v82, v90
    v_mul_f32 v83, v83, v91
    v_mul_f32 v84, v84, v92
    v_mul_f32 v85, v85, v93
    v_mul_f32 v86, v86, v94
    v_mul_f32 v87, v87, v95
    v_cvt_pk_bf16_f32 v120, v80, v81
    v_cvt_pk_bf16_f32 v121, v82, v83
    v_cvt_pk_bf16_f32 v122, v84, v85
    v_cvt_pk_bf16_f32 v123, v86, v87
    s_add_u32 s57, s56, 1052672
    buffer_store_dwordx4 v[120:123], v233, s[44:47], s57 offen sc1
    v_lshlrev_b32 v80, 16, v224
    v_lshlrev_b32 v88, 16, v51
    v_and_b32 v81, s55, v224
    v_lshlrev_b32 v89, 16, v55
    v_lshlrev_b32 v82, 16, v225
    v_lshlrev_b32 v90, 16, v59
    v_and_b32 v83, s55, v225
    v_lshlrev_b32 v91, 16, v63
    v_lshlrev_b32 v84, 16, v226
    v_lshlrev_b32 v92, 16, v67
    v_and_b32 v85, s55, v226
    v_lshlrev_b32 v93, 16, v71
    v_lshlrev_b32 v86, 16, v227
    v_lshlrev_b32 v94, 16, v75
    v_and_b32 v87, s55, v227
    v_lshlrev_b32 v95, 16, v79
    v_mul_f32 v80, v80, v88
    v_mul_f32 v81, v81, v89
    v_mul_f32 v82, v82, v90
    v_mul_f32 v83, v83, v91
    v_mul_f32 v84, v84, v92
    v_mul_f32 v85, v85, v93
    v_mul_f32 v86, v86, v94
    v_mul_f32 v87, v87, v95
    v_cvt_pk_bf16_f32 v124, v80, v81
    v_cvt_pk_bf16_f32 v125, v82, v83
    v_cvt_pk_bf16_f32 v126, v84, v85
    v_cvt_pk_bf16_f32 v127, v86, v87
    s_add_u32 s57, s56, 1056768
    buffer_store_dwordx4 v[124:127], v233, s[44:47], s57 offen sc1
    v_lshlrev_b32 v80, 16, v228
    v_and_b32 v88, s55, v51
    v_and_b32 v81, s55, v228
    v_and_b32 v89, s55, v55
    v_lshlrev_b32 v82, 16, v229
    v_and_b32 v90, s55, v59
    v_and_b32 v83, s55, v229
    v_and_b32 v91, s55, v63
    v_lshlrev_b32 v84, 16, v230
    v_and_b32 v92, s55, v67
    v_and_b32 v85, s55, v230
    v_and_b32 v93, s55, v71
    v_lshlrev_b32 v86, 16, v231
    v_and_b32 v94, s55, v75
    v_and_b32 v87, s55, v231
    v_and_b32 v95, s55, v79
    v_mul_f32 v80, v80, v88
    v_mul_f32 v81, v81, v89
    v_mul_f32 v82, v82, v90
    v_mul_f32 v83, v83, v91
    v_mul_f32 v84, v84, v92
    v_mul_f32 v85, v85, v93
    v_mul_f32 v86, v86, v94
    v_mul_f32 v87, v87, v95
    v_cvt_pk_bf16_f32 v128, v80, v81
    v_cvt_pk_bf16_f32 v129, v82, v83
    v_cvt_pk_bf16_f32 v130, v84, v85
    v_cvt_pk_bf16_f32 v131, v86, v87
    s_add_u32 s57, s56, 1060864
    buffer_store_dwordx4 v[128:131], v233, s[44:47], s57 offen sc1
    s_endpgm
F_C:
    s_load_dwordx8 s[20:27], s[0:1], 64
    s_and_b32 s32, s29, 3
    s_lshr_b32 s33, s28, 1
    s_lshl_b32 s33, s33, 2
    s_add_u32 s32, s32, s33
    s_and_b32 s33, s28, 1
    s_lshl_b32 s33, s33, 3
    s_lshr_b32 s35, s29, 2
    s_add_u32 s33, s33, s35
    v_lshlrev_b32 v1, 4, v0
    s_lshr_b32 s34, s3, 1
    s_and_b32 s35, s3, 1
    v_and_b32 v16, 15, v0
    v_lshrrev_b32 v17, 4, v0
    v_lshrrev_b32 v18, 1, v16
    v_xor_b32 v18, v18, v17
    v_lshlrev_b32 v18, 4, v18
    v_and_b32 v19, 7, v0
    v_lshl_add_u32 v18, v19, 7, v18
    v_bfe_u32 v19, v0, 3, 1
    v_mul_u32_u24 v19, 10240, v19
    s_lshl_b32 s40, s34, 11
    s_add_u32 s40, s40, 40960
    v_add3_u32 v2, v18, v19, s40
    v_xor_b32 v3, 64, v2
    v_bfe_u32 v18, v0, 2, 2
    v_lshlrev_b32 v18, 7, v18
    v_and_b32 v19, 3, v0
    v_lshl_add_u32 v18, v19, 3, v18
    v_bfe_u32 v19, v0, 3, 2
    v_lshlrev_b32 v19, 5, v19
    v_lshl_add_u32 v207, v17, 9, v18
    v_add_u32 v207, v207, v19
    s_lshl_b32 s40, s35, 6
    s_lshl_b32 s41, s34, 5
    s_or_b32 s40, s40, s41
    v_xor_b32 v19, s40, v19
    v_mul_u32_u24 v20, 10240, v17
    v_add3_u32 v18, v18, v19, v20
    v_add_u32 v4, 45056, v18
    v_xor_b32 v5, 32, v4
    v_mov_b32 v18, 0
    v_lshlrev_b32 v19, 2, v0
    v_add_u32 v20, 156160, v19
    ds_write_b32 v20, v18
    s_mov_b32 s42, 0x358637bd
    s_mov_b32 s43, 0x3fb8aa3b
    s_mov_b32 s49, 0x3f803f80
    v_mov_b32 v104, s42
    v_mov_b32 v105, s42
    v_mov_b32 v106, s42
    v_mov_b32 v107, s42
    v_mov_b32 v108, s42
    v_mov_b32 v109, s42
    v_mov_b32 v110, s42
    v_mov_b32 v111, s42
    v_mov_b32 v112, s42
    v_mov_b32 v113, s42
    v_mov_b32 v114, s42
    v_mov_b32 v115, s42
    v_mov_b32 v116, s42
    v_mov_b32 v117, s42
    v_mov_b32 v118, s42
    v_mov_b32 v119, s42
    v_mov_b32 v120, s42
    v_mov_b32 v121, s42
    v_mov_b32 v122, s42
    v_mov_b32 v123, s42
    v_mov_b32 v124, s42
    v_mov_b32 v125, s42
    v_mov_b32 v126, s42
    v_mov_b32 v127, s42
    v_mov_b32 v128, s42
    v_mov_b32 v129, s42
    v_mov_b32 v130, s42
    v_mov_b32 v131, s42
    v_mov_b32 v132, s42
    v_mov_b32 v133, s42
    v_mov_b32 v134, s42
    v_mov_b32 v135, s42
    v_mov_b32 v136, 0
    v_mov_b32 v137, 0
    v_mov_b32 v138, 0
    v_mov_b32 v139, 0
    v_mov_b32 v140, 0
    v_mov_b32 v141, 0
    v_mov_b32 v142, 0
    v_mov_b32 v143, 0
    v_mov_b32 v144, 0
    v_mov_b32 v145, 0
    v_mov_b32 v146, 0
    v_mov_b32 v147, 0
    v_mov_b32 v148, 0
    v_mov_b32 v149, 0
    v_mov_b32 v150, 0
    v_mov_b32 v151, 0
    v_mov_b32 v152, 0
    v_mov_b32 v153, 0
    v_mov_b32 v154, 0
    v_mov_b32 v155, 0
    v_mov_b32 v156, 0
    v_mov_b32 v157, 0
    v_mov_b32 v158, 0
    v_mov_b32 v159, 0
    v_mov_b32 v160, 0
    v_mov_b32 v161, 0
    v_mov_b32 v162, 0
    v_mov_b32 v163, 0
    v_mov_b32 v164, 0
    v_mov_b32 v165, 0
    v_mov_b32 v166, 0
    v_mov_b32 v167, 0
    v_mov_b32 v168, s42
    v_mov_b32 v169, s42
    v_mov_b32 v170, s42
    v_mov_b32 v171, s42
    v_mov_b32 v172, s42
    v_mov_b32 v173, s42
    v_mov_b32 v174, s42
    v_mov_b32 v175, s42
    v_mov_b32 v176, s42
    v_mov_b32 v177, s42
    v_mov_b32 v178, s42
    v_mov_b32 v179, s42
    v_mov_b32 v180, s42
    v_mov_b32 v181, s42
    v_mov_b32 v182, s42
    v_mov_b32 v183, s42
    v_mov_b32 v184, s42
    v_mov_b32 v185, s42
    v_mov_b32 v186, s42
    v_mov_b32 v187, s42
    v_mov_b32 v188, s42
    v_mov_b32 v189, s42
    v_mov_b32 v190, s42
    v_mov_b32 v191, s42
    v_mov_b32 v192, s42
    v_mov_b32 v193, s42
    v_mov_b32 v194, s42
    v_mov_b32 v195, s42
    v_mov_b32 v196, s42
    v_mov_b32 v197, s42
    v_mov_b32 v198, s42
    v_mov_b32 v199, s42
    s_and_b32 s40, s3, 1
    s_lshl_b32 s41, s31, 1
    s_add_u32 s40, s40, s41
    s_lshr_b32 s41, s3, 1
    s_lshl_b32 s52, s30, 1
    s_add_u32 s52, s52, s41
    s_mul_i32 s52, s52, 132
    s_add_u32 s52, s52, s40
    s_lshl_b32 s52, s52, 10
    s_add_u32 s52, s52, 0x200000
    s_lshl_b32 s50, s40, 15
    s_lshl_b32 s51, s41, 10
    s_add_u32 s53, s50, s51
    s_lshl_b32 s50, s30, 11
    s_add_u32 s50, s50, s53
    s_lshl_b32 s40, s40, 11
    s_add_u32 s54, s40, s51
    s_add_u32 s54, s54, 0x100000
    s_lshl_b32 s51, s30, 6
    s_add_u32 s51, s51, s54
    s_mul_i32 s40, s35, 2304
    s_add_u32 s58, s40, 156416
    s_add_u32 s59, s40, 116736
    s_cmp_eq_u32 s34, 0
    s_cselect_b32 s40, s58, s59
    s_cselect_b32 s41, s59, s58
    v_lshlrev_b32 v12, 4, v17
    v_add_u32 v6, s40, v1
    v_add_u32 v7, s41, v1
    v_add_u32 v8, s40, v12
    v_add_u32 v9, s41, v12
    s_lshl_b32 s40, s3, 3
    s_add_u32 s41, s40, 156160
    v_mov_b32 v10, s41
    v_xor_b32 v11, 16, v10
    v_lshl_add_u32 v13, v16, 6, v12
    s_lshl_b32 s40, s34, 3
    s_add_u32 s41, s59, s40
    v_add_u32 v200, s41, v1
    v_xor_b32 v201, 8, v200
    s_add_u32 s41, s58, s40
    v_add_u32 v203, s41, v1
    v_xor_b32 v202, 8, v203
    s_lshl_b32 s40, s3, 2
    s_add_u32 s41, s40, 156240
    v_mov_b32 v204, s41
    s_add_u32 s41, s40, 156224
    v_mov_b32 v206, s41
    v_lshlrev_b32 v18, 1, v17
    v_and_b32 v20, 7, v0
    v_xor_b32 v18, v18, v20
    v_lshlrev_b32 v18, 4, v18
    v_lshrrev_b32 v20, 3, v0
    v_lshl_add_u32 v205, v20, 11, v18
    v_mov_b32 v14, 1
    v_and_b32 v18, 12, v19
    v_add_u32 v209, 156160, v18
    v_add_u32 v211, 144, v209
    v_add_u32 v20, 144, v209
    v_subrev_u32 v21, 12, v0
    v_cmp_gt_u32 vcc, 12, v21
    v_and_b32 v18, 4, v19
    v_add_u32 v18, 156208, v18
    v_cndmask_b32 v211, v211, v20, vcc
    v_and_b32 v21, 31, v0
    v_cmp_lt_u32 vcc, 23, v21
    s_nop 1
    v_cndmask_b32 v211, v211, v18, vcc
    s_lshl_b32 s55, s32, 2
    s_add_u32 s55, s55, s3
    s_lshl_b32 s56, s55, 17
    s_lshl_b32 s40, s33, 7
    s_add_u32 s56, s56, s40
    s_mul_i32 s55, s55, 67584
    s_add_u32 s55, s55, 0x200000
    v_and_b32 v18, 31, v0
    v_add_u32 v18, 33, v18
    s_xor_b32 s40, s35, 1
    s_mul_i32 s40, s40, 66
    v_add_u32 v18, s40, v18
    v_lshlrev_b32 v208, 10, v18
    s_and_b32 s57, s33, 7
    s_mul_i32 s57, s57, 3
    s_lshr_b32 s57, s57, 2
    v_lshlrev_b32 v210, 12, v16
    v_bfe_u32 v18, v0, 4, 1
    v_lshl_add_u32 v210, v18, 5, v210
    v_lshrrev_b32 v18, 5, v0
    v_lshl_add_u32 v210, v18, 4, v210
    s_mov_b32 s44, 0
    s_mov_b32 s45, 1
    s_mov_b32 s46, 0xfffec000
    s_mov_b32 s47, 40960
    s_waitcnt lgkmcnt(0)
    s_mov_b32 s36, s26
    s_mov_b32 s37, s27
    s_mov_b32 s38, 0x10000000
    s_mov_b32 s39, 0x00020000
    s_mov_b32 s60, s22
    s_mov_b32 s61, s23
    s_mov_b32 s62, 0x800000
    s_mov_b32 s63, 0x00020000
    s_mov_b32 s64, s26
    s_mov_b32 s65, s27
    s_mov_b32 s66, 0x10000000
    s_mov_b32 s67, 0x00020000
    s_cmp_lg_u32 s2, 0
    s_cbranch_scc1 F_NOINIT
    v_mov_b32 v20, 0
    v_mov_b32 v21, 0
    v_mov_b32 v22, 0
    v_mov_b32 v23, 0
    s_mul_i32 s40, s3, 6144
    s_add_u32 s40, s40, 0x120000
    s_add_u32 s41, s40, 4096
    buffer_store_dwordx4 v[20:23], v1, s[36:39], s40 offen offset:0 sc1
    buffer_store_dwordx4 v[20:23], v1, s[36:39], s40 offen offset:1024 sc1
    buffer_store_dwordx4 v[20:23], v1, s[36:39], s40 offen offset:2048 sc1
    buffer_store_dwordx4 v[20:23], v1, s[36:39], s40 offen offset:3072 sc1
    buffer_store_dwordx4 v[20:23], v1, s[36:39], s41 offen offset:0 sc1
    buffer_store_dwordx4 v[20:23], v1, s[36:39], s41 offen offset:1024 sc1
    s_mov_b32 s40, 1
    s_waitcnt vmcnt(0)
    s_atomic_add s40, s[24:25], 0
    s_waitcnt lgkmcnt(0)
F_NOINIT:
    s_lshl_b32 s40, s31, 2
    s_lshl_b32 s41, s35, 1
    s_add_u32 s40, s40, s41
    s_add_u32 s40, s40, s34
    s_lshl_b32 s10, s40, 7
    s_add_u32 s10, s10, 0x122000
    s_add_u32 s10, s10, s26
    s_addc_u32 s11, s27, 0
    s_lshl_b32 s40, s30, 1
    s_add_u32 s40, s40, s34
    s_lshl_b32 s12, s40, 7
    s_add_u32 s12, s12, 0x124000
    s_add_u32 s12, s12, s26
    s_addc_u32 s13, s27, 0
    s_lshl_b32 s40, s32, 1
    s_add_u32 s40, s40, s34
    s_lshl_b32 s14, s40, 7
    s_add_u32 s14, s14, 0x124000
    s_add_u32 s14, s14, s26
    s_addc_u32 s15, s27, 0
    s_lshr_b32 s40, s31, 1
    s_lshl_b32 s40, s40, 2
    s_lshl_b32 s16, 1, s40
    s_mov_b32 s4, s8
    s_mov_b32 s5, s9
    s_mov_b32 s6, 0x200000
    s_mov_b32 s7, 0x00020000
    s_lshl_b32 s68, s3, 10
    s_lshl_b32 s69, s3, 14
    s_lshl_b32 s40, s33, 7
    s_add_u32 s69, s69, s40
    s_barrier
    ds_read_b64_tr_b16 v[80:81], v4 offset:1024
    ds_read_b64_tr_b16 v[82:83], v4 offset:1536
    ds_read_b128 v[16:19], v2 offset:0
    ds_read_b64_tr_b16 v[84:85], v4 offset:4096
    ds_read_b64_tr_b16 v[86:87], v4 offset:4608
    ds_read_b128 v[20:23], v3 offset:0
    ds_read_b128 v[24:27], v2 offset:20480
    ds_read_b128 v[28:31], v3 offset:20480
    ds_read_b128 v[32:35], v2 offset:1024
    ds_read_b128 v[36:39], v3 offset:1024
    ds_read_b64_tr_b16 v[88:89], v5 offset:1024
    ds_read_b64_tr_b16 v[90:91], v5 offset:1536
    ds_read_b64_tr_b16 v[92:93], v5 offset:4096
    ds_read_b64_tr_b16 v[94:95], v5 offset:4608
    ds_read_b128 v[40:43], v2 offset:21504
    ds_read_b128 v[44:47], v3 offset:21504
.p2align 6
F_CLOOP:
    s_waitcnt lgkmcnt(8)
    v_mfma_f32_16x16x32_bf16 v[104:107], v[16:19], v[80:83], v[104:107]
    ds_read_b64_tr_b16 v[96:97], v4 offset:2048
    v_mfma_f32_16x16x32_bf16 v[104:107], v[20:23], v[84:87], v[104:107]
    ds_read_b64_tr_b16 v[98:99], v4 offset:2560
    v_mfma_f32_16x16x32_bf16 v[108:111], v[24:27], v[80:83], v[108:111]
    ds_read_b64_tr_b16 v[100:101], v4 offset:5120
    v_mfma_f32_16x16x32_bf16 v[108:111], v[28:31], v[84:87], v[108:111]
    ds_read_b64_tr_b16 v[102:103], v4 offset:5632
    s_waitcnt lgkmcnt(4)
    v_mfma_f32_16x16x32_bf16 v[112:115], v[32:35], v[80:83], v[112:115]
    v_mfma_f32_16x16x32_bf16 v[112:115], v[36:39], v[84:87], v[112:115]
    v_mfma_f32_16x16x32_bf16 v[116:119], v[40:43], v[80:83], v[116:119]
    v_mfma_f32_16x16x32_bf16 v[116:119], v[44:47], v[84:87], v[116:119]
    v_mfma_f32_16x16x32_bf16 v[120:123], v[16:19], v[88:91], v[120:123]
    ds_read_b64_tr_b16 v[80:81], v5 offset:2048
    v_mfma_f32_16x16x32_bf16 v[120:123], v[20:23], v[92:95], v[120:123]
    ds_read_b64_tr_b16 v[82:83], v5 offset:2560
    v_mfma_f32_16x16x32_bf16 v[124:127], v[24:27], v[88:91], v[124:127]
    ds_read_b64_tr_b16 v[84:85], v5 offset:5120
    v_mfma_f32_16x16x32_bf16 v[124:127], v[28:31], v[92:95], v[124:127]
    ds_read_b64_tr_b16 v[86:87], v5 offset:5632
    v_mfma_f32_16x16x32_bf16 v[128:131], v[32:35], v[88:91], v[128:131]
    v_mfma_f32_16x16x32_bf16 v[128:131], v[36:39], v[92:95], v[128:131]
    v_mfma_f32_16x16x32_bf16 v[132:135], v[40:43], v[88:91], v[132:135]
    v_mfma_f32_16x16x32_bf16 v[132:135], v[44:47], v[92:95], v[132:135]
    s_waitcnt lgkmcnt(4)
    v_mfma_f32_16x16x32_bf16 v[136:139], v[16:19], v[96:99], v[136:139]
    ds_read_b64_tr_b16 v[88:89], v4 offset:0
    v_mfma_f32_16x16x32_bf16 v[136:139], v[20:23], v[100:103], v[136:139]
    ds_read_b64_tr_b16 v[90:91], v4 offset:512
    v_mfma_f32_16x16x32_bf16 v[140:143], v[24:27], v[96:99], v[140:143]
    ds_read_b64_tr_b16 v[92:93], v4 offset:3072
    v_mfma_f32_16x16x32_bf16 v[140:143], v[28:31], v[100:103], v[140:143]
    ds_read_b64_tr_b16 v[94:95], v4 offset:3584
    v_mfma_f32_16x16x32_bf16 v[144:147], v[32:35], v[96:99], v[144:147]
    v_mfma_f32_16x16x32_bf16 v[144:147], v[36:39], v[100:103], v[144:147]
    s_add_u32 s44, s44, 1
    v_mfma_f32_16x16x32_bf16 v[148:151], v[40:43], v[96:99], v[148:151]
    v_mfma_f32_16x16x32_bf16 v[148:151], v[44:47], v[100:103], v[148:151]
    s_waitcnt lgkmcnt(4)
    v_mfma_f32_16x16x32_bf16 v[152:155], v[16:19], v[80:83], v[152:155]
    ds_read_b64_tr_b16 v[96:97], v5 offset:0
    v_mfma_f32_16x16x32_bf16 v[152:155], v[20:23], v[84:87], v[152:155]
    ds_read_b64_tr_b16 v[98:99], v5 offset:512
    v_mfma_f32_16x16x32_bf16 v[156:159], v[24:27], v[80:83], v[156:159]
    ds_read_b64_tr_b16 v[100:101], v5 offset:3072
    v_mfma_f32_16x16x32_bf16 v[156:159], v[28:31], v[84:87], v[156:159]
    ds_read_b64_tr_b16 v[102:103], v5 offset:3584
    v_mfma_f32_16x16x32_bf16 v[160:163], v[32:35], v[80:83], v[160:163]
    s_add_u32 s45, s45, 1
    s_cmp_eq_u32 s45, 3
    v_mfma_f32_16x16x32_bf16 v[160:163], v[36:39], v[84:87], v[160:163]
    s_cselect_b32 s48, s46, s47
    s_cselect_b32 s45, 0, s45
    v_mfma_f32_16x16x32_bf16 v[164:167], v[40:43], v[80:83], v[164:167]
    v_add_u32 v4, s48, v4
    v_add_u32 v2, s48, v2
    v_mfma_f32_16x16x32_bf16 v[164:167], v[44:47], v[84:87], v[164:167]
    v_add_u32 v3, s48, v3
    v_add_u32 v5, s48, v5
    s_waitcnt lgkmcnt(0)
    v_mfma_f32_16x16x32_bf16 v[168:171], v[88:91], v[16:19], v[168:171]
    s_cmp_lt_u32 s44, 8
    s_cbranch_scc0 F_CNB0
    s_barrier
F_CB0:
    v_mfma_f32_16x16x32_bf16 v[168:171], v[92:95], v[20:23], v[168:171]
    ds_read_b64_tr_b16 v[80:81], v4 offset:1024
    ds_read_b64_tr_b16 v[82:83], v4 offset:1536
    v_mfma_f32_16x16x32_bf16 v[172:175], v[88:91], v[24:27], v[172:175]
    ds_read_b128 v[48:51], v2 offset:0
    ds_read_b64_tr_b16 v[84:85], v4 offset:4096
    v_mfma_f32_16x16x32_bf16 v[172:175], v[92:95], v[28:31], v[172:175]
    ds_read_b64_tr_b16 v[86:87], v4 offset:4608
    v_mfma_f32_16x16x32_bf16 v[176:179], v[88:91], v[32:35], v[176:179]
    ds_read_b128 v[52:55], v3 offset:0
    v_mfma_f32_16x16x32_bf16 v[176:179], v[92:95], v[36:39], v[176:179]
    ds_read_b128 v[56:59], v2 offset:20480
    v_mfma_f32_16x16x32_bf16 v[180:183], v[88:91], v[40:43], v[180:183]
    ds_read_b128 v[60:63], v3 offset:20480
    v_mfma_f32_16x16x32_bf16 v[180:183], v[92:95], v[44:47], v[180:183]
    v_mfma_f32_16x16x32_bf16 v[184:187], v[96:99], v[16:19], v[184:187]
    ds_read_b128 v[64:67], v2 offset:1024
    ds_read_b128 v[68:71], v3 offset:1024
    v_mfma_f32_16x16x32_bf16 v[184:187], v[100:103], v[20:23], v[184:187]
    ds_read_b64_tr_b16 v[88:89], v5 offset:1024
    ds_read_b64_tr_b16 v[90:91], v5 offset:1536
    v_mfma_f32_16x16x32_bf16 v[188:191], v[96:99], v[24:27], v[188:191]
    ds_read_b64_tr_b16 v[92:93], v5 offset:4096
    ds_read_b64_tr_b16 v[94:95], v5 offset:4608
    v_mfma_f32_16x16x32_bf16 v[188:191], v[100:103], v[28:31], v[188:191]
    ds_read_b128 v[72:75], v2 offset:21504
    v_mfma_f32_16x16x32_bf16 v[192:195], v[96:99], v[32:35], v[192:195]
    ds_read_b128 v[76:79], v3 offset:21504
    v_mfma_f32_16x16x32_bf16 v[192:195], v[100:103], v[36:39], v[192:195]
    v_mfma_f32_16x16x32_bf16 v[196:199], v[96:99], v[40:43], v[196:199]
    v_mfma_f32_16x16x32_bf16 v[196:199], v[100:103], v[44:47], v[196:199]
    s_waitcnt lgkmcnt(8)
    v_mfma_f32_16x16x32_bf16 v[104:107], v[48:51], v[80:83], v[104:107]
    ds_read_b64_tr_b16 v[96:97], v4 offset:2048
    v_mfma_f32_16x16x32_bf16 v[104:107], v[52:55], v[84:87], v[104:107]
    ds_read_b64_tr_b16 v[98:99], v4 offset:2560
    v_mfma_f32_16x16x32_bf16 v[108:111], v[56:59], v[80:83], v[108:111]
    ds_read_b64_tr_b16 v[100:101], v4 offset:5120
    v_mfma_f32_16x16x32_bf16 v[108:111], v[60:63], v[84:87], v[108:111]
    ds_read_b64_tr_b16 v[102:103], v4 offset:5632
    s_waitcnt lgkmcnt(4)
    v_mfma_f32_16x16x32_bf16 v[112:115], v[64:67], v[80:83], v[112:115]
    v_mfma_f32_16x16x32_bf16 v[112:115], v[68:71], v[84:87], v[112:115]
    v_mfma_f32_16x16x32_bf16 v[116:119], v[72:75], v[80:83], v[116:119]
    v_mfma_f32_16x16x32_bf16 v[116:119], v[76:79], v[84:87], v[116:119]
    v_mfma_f32_16x16x32_bf16 v[120:123], v[48:51], v[88:91], v[120:123]
    ds_read_b64_tr_b16 v[80:81], v5 offset:2048
    v_mfma_f32_16x16x32_bf16 v[120:123], v[52:55], v[92:95], v[120:123]
    ds_read_b64_tr_b16 v[82:83], v5 offset:2560
    v_mfma_f32_16x16x32_bf16 v[124:127], v[56:59], v[88:91], v[124:127]
    ds_read_b64_tr_b16 v[84:85], v5 offset:5120
    v_mfma_f32_16x16x32_bf16 v[124:127], v[60:63], v[92:95], v[124:127]
    ds_read_b64_tr_b16 v[86:87], v5 offset:5632
    v_mfma_f32_16x16x32_bf16 v[128:131], v[64:67], v[88:91], v[128:131]
    v_mfma_f32_16x16x32_bf16 v[128:131], v[68:71], v[92:95], v[128:131]
    v_mfma_f32_16x16x32_bf16 v[132:135], v[72:75], v[88:91], v[132:135]
    v_mfma_f32_16x16x32_bf16 v[132:135], v[76:79], v[92:95], v[132:135]
    s_waitcnt lgkmcnt(4)
    v_mfma_f32_16x16x32_bf16 v[136:139], v[48:51], v[96:99], v[136:139]
    ds_read_b64_tr_b16 v[88:89], v4 offset:0
    v_mfma_f32_16x16x32_bf16 v[136:139], v[52:55], v[100:103], v[136:139]
    ds_read_b64_tr_b16 v[90:91], v4 offset:512
    v_mfma_f32_16x16x32_bf16 v[140:143], v[56:59], v[96:99], v[140:143]
    ds_read_b64_tr_b16 v[92:93], v4 offset:3072
    v_mfma_f32_16x16x32_bf16 v[140:143], v[60:63], v[100:103], v[140:143]
    ds_read_b64_tr_b16 v[94:95], v4 offset:3584
    v_mfma_f32_16x16x32_bf16 v[144:147], v[64:67], v[96:99], v[144:147]
    v_mfma_f32_16x16x32_bf16 v[144:147], v[68:71], v[100:103], v[144:147]
    v_mfma_f32_16x16x32_bf16 v[148:151], v[72:75], v[96:99], v[148:151]
    v_mfma_f32_16x16x32_bf16 v[148:151], v[76:79], v[100:103], v[148:151]
    s_waitcnt lgkmcnt(4)
    v_mfma_f32_16x16x32_bf16 v[152:155], v[48:51], v[80:83], v[152:155]
    ds_read_b64_tr_b16 v[96:97], v5 offset:0
    v_mfma_f32_16x16x32_bf16 v[152:155], v[52:55], v[84:87], v[152:155]
    ds_read_b64_tr_b16 v[98:99], v5 offset:512
    v_mfma_f32_16x16x32_bf16 v[156:159], v[56:59], v[80:83], v[156:159]
    ds_read_b64_tr_b16 v[100:101], v5 offset:3072
    v_mfma_f32_16x16x32_bf16 v[156:159], v[60:63], v[84:87], v[156:159]
    ds_read_b64_tr_b16 v[102:103], v5 offset:3584
    v_mfma_f32_16x16x32_bf16 v[160:163], v[64:67], v[80:83], v[160:163]
    s_add_u32 s45, s45, 1
    s_cmp_eq_u32 s45, 3
    v_mfma_f32_16x16x32_bf16 v[160:163], v[68:71], v[84:87], v[160:163]
    s_cselect_b32 s48, s46, s47
    s_cselect_b32 s45, 0, s45
    v_mfma_f32_16x16x32_bf16 v[164:167], v[72:75], v[80:83], v[164:167]
    v_add_u32 v4, s48, v4
    v_add_u32 v2, s48, v2
    v_mfma_f32_16x16x32_bf16 v[164:167], v[76:79], v[84:87], v[164:167]
    v_add_u32 v3, s48, v3
    v_add_u32 v5, s48, v5
    s_waitcnt lgkmcnt(0)
    v_mfma_f32_16x16x32_bf16 v[168:171], v[88:91], v[48:51], v[168:171]
    s_cmp_lt_u32 s44, 8
    s_cbranch_scc0 F_CNB1
    s_barrier
F_CB1:
    v_mfma_f32_16x16x32_bf16 v[168:171], v[92:95], v[52:55], v[168:171]
    ds_read_b64_tr_b16 v[80:81], v4 offset:1024
    ds_read_b64_tr_b16 v[82:83], v4 offset:1536
    v_mfma_f32_16x16x32_bf16 v[172:175], v[88:91], v[56:59], v[172:175]
    ds_read_b128 v[16:19], v2 offset:0
    ds_read_b64_tr_b16 v[84:85], v4 offset:4096
    v_mfma_f32_16x16x32_bf16 v[172:175], v[92:95], v[60:63], v[172:175]
    ds_read_b64_tr_b16 v[86:87], v4 offset:4608
    v_mfma_f32_16x16x32_bf16 v[176:179], v[88:91], v[64:67], v[176:179]
    ds_read_b128 v[20:23], v3 offset:0
    v_mfma_f32_16x16x32_bf16 v[176:179], v[92:95], v[68:71], v[176:179]
    ds_read_b128 v[24:27], v2 offset:20480
    v_mfma_f32_16x16x32_bf16 v[180:183], v[88:91], v[72:75], v[180:183]
    ds_read_b128 v[28:31], v3 offset:20480
    v_mfma_f32_16x16x32_bf16 v[180:183], v[92:95], v[76:79], v[180:183]
    v_mfma_f32_16x16x32_bf16 v[184:187], v[96:99], v[48:51], v[184:187]
    ds_read_b128 v[32:35], v2 offset:1024
    ds_read_b128 v[36:39], v3 offset:1024
    v_mfma_f32_16x16x32_bf16 v[184:187], v[100:103], v[52:55], v[184:187]
    ds_read_b64_tr_b16 v[88:89], v5 offset:1024
    ds_read_b64_tr_b16 v[90:91], v5 offset:1536
    v_mfma_f32_16x16x32_bf16 v[188:191], v[96:99], v[56:59], v[188:191]
    ds_read_b64_tr_b16 v[92:93], v5 offset:4096
    ds_read_b64_tr_b16 v[94:95], v5 offset:4608
    v_mfma_f32_16x16x32_bf16 v[188:191], v[100:103], v[60:63], v[188:191]
    ds_read_b128 v[40:43], v2 offset:21504
    v_mfma_f32_16x16x32_bf16 v[192:195], v[96:99], v[64:67], v[192:195]
    ds_read_b128 v[44:47], v3 offset:21504
    v_mfma_f32_16x16x32_bf16 v[192:195], v[100:103], v[68:71], v[192:195]
    v_mfma_f32_16x16x32_bf16 v[196:199], v[96:99], v[72:75], v[196:199]
    v_mfma_f32_16x16x32_bf16 v[196:199], v[100:103], v[76:79], v[196:199]
    s_cbranch_scc1 F_CLOOP
    s_setprio 3
    s_mov_b32 s46, s43
    s_mov_b32 s47, s43
    v_mul_f32 v244, s43, v104
    v_mul_f32 v245, s43, v105
    v_mul_f32 v246, s43, v106
    v_mul_f32 v247, s43, v107
    v_mul_f32 v248, s43, v108
    v_mul_f32 v249, s43, v109
    v_mul_f32 v250, s43, v110
    v_mul_f32 v251, s43, v111
    v_exp_f32 v244, v244 clamp
    v_max_f32 v104, s42, v104
    v_exp_f32 v245, v245 clamp
    v_max_f32 v105, s42, v105
    v_exp_f32 v246, v246 clamp
    v_max_f32 v106, s42, v106
    v_exp_f32 v247, v247 clamp
    v_max_f32 v107, s42, v107
    v_exp_f32 v248, v248 clamp
    v_max_f32 v108, s42, v108
    v_exp_f32 v249, v249 clamp
    v_max_f32 v109, s42, v109
    v_exp_f32 v250, v250 clamp
    v_max_f32 v110, s42, v110
    v_exp_f32 v251, v251 clamp
    v_max_f32 v111, s42, v111
    v_add_f32 v244, v244, v104
    v_add_f32 v245, v245, v105
    v_add_f32 v246, v246, v106
    v_add_f32 v247, v247, v107
    v_add_f32 v248, v248, v108
    v_add_f32 v249, v249, v109
    v_add_f32 v250, v250, v110
    v_add_f32 v251, v251, v111
    v_cvt_pk_bf16_f32 v212, v244, v245
    v_cvt_pk_bf16_f32 v213, v246, v247
    v_cvt_pk_bf16_f32 v214, v248, v249
    v_cvt_pk_bf16_f32 v215, v250, v251
    v_mov_b32 v252, s49
    v_mov_b32 v253, s49
    v_mov_b32 v254, s49
    v_mov_b32 v255, s49
    v_cvt_pk_bf16_f32 v228, v136, v137
    v_cvt_pk_bf16_f32 v229, v138, v139
    v_cvt_pk_bf16_f32 v230, v140, v141
    v_cvt_pk_bf16_f32 v231, v142, v143
    v_cvt_pk_bf16_f32 v232, v144, v145
    v_cvt_pk_bf16_f32 v233, v146, v147
    v_cvt_pk_bf16_f32 v234, v148, v149
    v_cvt_pk_bf16_f32 v235, v150, v151
    v_cvt_pk_bf16_f32 v236, v152, v153
    v_cvt_pk_bf16_f32 v237, v154, v155
    v_cvt_pk_bf16_f32 v238, v156, v157
    v_cvt_pk_bf16_f32 v239, v158, v159
    v_cvt_pk_bf16_f32 v240, v160, v161
    v_cvt_pk_bf16_f32 v241, v162, v163
    v_cvt_pk_bf16_f32 v242, v164, v165
    v_cvt_pk_bf16_f32 v243, v166, v167
    v_mfma_f32_16x16x32_bf16 v[140:143], v[212:215], v[236:239], 0
    v_mfma_f32_16x16x32_bf16 v[136:139], v[212:215], v[228:231], 0
    v_mfma_f32_16x16x32_bf16 v[152:155], v[212:215], v[252:255], 0
    v_mul_f32 v244, s43, v120
    v_mul_f32 v245, s43, v121
    v_mul_f32 v246, s43, v122
    v_mul_f32 v247, s43, v123
    v_mul_f32 v248, s43, v124
    v_mul_f32 v249, s43, v125
    v_mul_f32 v250, s43, v126
    v_mul_f32 v251, s43, v127
    v_exp_f32 v244, v244 clamp
    v_max_f32 v120, s42, v120
    v_exp_f32 v245, v245 clamp
    v_max_f32 v121, s42, v121
    v_exp_f32 v246, v246 clamp
    v_max_f32 v122, s42, v122
    v_exp_f32 v247, v247 clamp
    v_max_f32 v123, s42, v123
    v_exp_f32 v248, v248 clamp
    v_max_f32 v124, s42, v124
    v_exp_f32 v249, v249 clamp
    v_max_f32 v125, s42, v125
    v_exp_f32 v250, v250 clamp
    v_max_f32 v126, s42, v126
    v_exp_f32 v251, v251 clamp
    v_max_f32 v127, s42, v127
    v_add_f32 v244, v244, v120
    v_add_f32 v245, v245, v121
    v_add_f32 v246, v246, v122
    v_add_f32 v247, v247, v123
    v_add_f32 v248, v248, v124
    v_add_f32 v249, v249, v125
    v_add_f32 v250, v250, v126
    v_add_f32 v251, v251, v127
    v_cvt_pk_bf16_f32 v216, v244, v245
    v_cvt_pk_bf16_f32 v217, v246, v247
    v_cvt_pk_bf16_f32 v218, v248, v249
    v_cvt_pk_bf16_f32 v219, v250, v251
    s_nop 1
    v_mfma_f32_16x16x32_bf16 v[148:151], v[216:219], v[236:239], 0
    v_mfma_f32_16x16x32_bf16 v[144:147], v[216:219], v[228:231], 0
    v_mfma_f32_16x16x32_bf16 v[156:159], v[216:219], v[252:255], 0
    v_mul_f32 v244, s43, v112
    v_mul_f32 v245, s43, v113
    v_mul_f32 v246, s43, v114
    v_mul_f32 v247, s43, v115
    v_mul_f32 v248, s43, v116
    v_mul_f32 v249, s43, v117
    v_mul_f32 v250, s43, v118
    v_mul_f32 v251, s43, v119
    v_exp_f32 v244, v244 clamp
    v_max_f32 v112, s42, v112
    v_exp_f32 v245, v245 clamp
    v_max_f32 v113, s42, v113
    v_exp_f32 v246, v246 clamp
    v_max_f32 v114, s42, v114
    v_exp_f32 v247, v247 clamp
    v_max_f32 v115, s42, v115
    v_exp_f32 v248, v248 clamp
    v_max_f32 v116, s42, v116
    v_exp_f32 v249, v249 clamp
    v_max_f32 v117, s42, v117
    v_exp_f32 v250, v250 clamp
    v_max_f32 v118, s42, v118
    v_exp_f32 v251, v251 clamp
    v_max_f32 v119, s42, v119
    v_add_f32 v244, v244, v112
    v_add_f32 v245, v245, v113
    v_add_f32 v246, v246, v114
    v_add_f32 v247, v247, v115
    v_add_f32 v248, v248, v116
    v_add_f32 v249, v249, v117
    v_add_f32 v250, v250, v118
    v_add_f32 v251, v251, v119
    v_cvt_pk_bf16_f32 v212, v244, v245
    v_cvt_pk_bf16_f32 v213, v246, v247
    v_cvt_pk_bf16_f32 v214, v248, v249
    v_cvt_pk_bf16_f32 v215, v250, v251
    s_nop 1
    v_mfma_f32_16x16x32_bf16 v[140:143], v[212:215], v[240:243], v[140:143]
    v_mfma_f32_16x16x32_bf16 v[136:139], v[212:215], v[232:235], v[136:139]
    v_mfma_f32_16x16x32_bf16 v[152:155], v[212:215], v[252:255], v[152:155]
    v_mul_f32 v244, s43, v128
    v_mul_f32 v245, s43, v129
    v_mul_f32 v246, s43, v130
    v_mul_f32 v247, s43, v131
    v_mul_f32 v248, s43, v132
    v_mul_f32 v249, s43, v133
    v_mul_f32 v250, s43, v134
    v_mul_f32 v251, s43, v135
    v_exp_f32 v244, v244 clamp
    v_max_f32 v128, s42, v128
    v_exp_f32 v245, v245 clamp
    v_max_f32 v129, s42, v129
    v_exp_f32 v246, v246 clamp
    v_max_f32 v130, s42, v130
    v_exp_f32 v247, v247 clamp
    v_max_f32 v131, s42, v131
    v_exp_f32 v248, v248 clamp
    v_max_f32 v132, s42, v132
    v_exp_f32 v249, v249 clamp
    v_max_f32 v133, s42, v133
    v_exp_f32 v250, v250 clamp
    v_max_f32 v134, s42, v134
    v_exp_f32 v251, v251 clamp
    v_max_f32 v135, s42, v135
    v_add_f32 v244, v244, v128
    v_add_f32 v245, v245, v129
    v_add_f32 v246, v246, v130
    v_add_f32 v247, v247, v131
    v_add_f32 v248, v248, v132
    v_add_f32 v249, v249, v133
    v_add_f32 v250, v250, v134
    v_add_f32 v251, v251, v135
    v_cvt_pk_bf16_f32 v216, v244, v245
    v_cvt_pk_bf16_f32 v217, v246, v247
    v_cvt_pk_bf16_f32 v218, v248, v249
    v_cvt_pk_bf16_f32 v219, v250, v251
    s_nop 1
    v_mfma_f32_16x16x32_bf16 v[148:151], v[216:219], v[240:243], v[148:151]
    v_mfma_f32_16x16x32_bf16 v[144:147], v[216:219], v[232:235], v[144:147]
    v_mfma_f32_16x16x32_bf16 v[156:159], v[216:219], v[252:255], v[156:159]
    ds_write_b128 v6, v[140:143]
    s_nop 4
    ds_write_b128 v6, v[148:151] offset:1024
    s_nop 0
    ds_write_b128 v8, v[156:159] offset:2048
    ds_write_b32 v10, v14
F_XA:
    ds_read_b32 v15, v11
    ds_read_b128 v[212:215], v7 offset:1024
    ds_read_b128 v[216:219], v7
    ds_read_b128 v[220:223], v9 offset:2048
    s_waitcnt lgkmcnt(0)
    v_cmp_ne_u32 vcc, 1, v15
    s_cbranch_vccnz F_XA
    v_add_f32 v212, v212, v136
    v_add_f32 v213, v213, v137
    v_add_f32 v214, v214, v138
    v_add_f32 v215, v215, v139
    v_add_f32 v216, v216, v144
    v_add_f32 v217, v217, v145
    v_add_f32 v218, v218, v146
    v_add_f32 v219, v219, v147
    v_cvt_pk_bf16_f32 v224, v212, v213
    v_cvt_pk_bf16_f32 v225, v214, v215
    v_cvt_pk_bf16_f32 v226, v216, v217
    v_cvt_pk_bf16_f32 v227, v218, v219
    buffer_store_dwordx4 v[224:227], v1, s[36:39], s50 offen sc1
    v_add_f32 v220, v220, v152
    v_add_f32 v221, v221, v153
    v_add_f32 v222, v222, v154
    v_add_f32 v223, v223, v155
    s_mov_b32 exec_lo, 0x00010001
    s_mov_b32 exec_hi, 0x00010001
    buffer_store_dwordx4 v[220:223], v12, s[36:39], s51 offen sc1
    s_mov_b64 exec, -1
    v_mov_b32 v112, s42
    v_mov_b32 v113, s42
    v_mov_b32 v114, s42
    v_mov_b32 v115, s42
    v_bfe_u32 v116, v0, 2, 2
    v_lshrrev_b32 v117, 4, v0
    v_cmp_eq_u32 vcc, v116, v117
    v_and_b32 v116, 1, v0
    v_lshlrev_b32 v116, 4, v116
    v_mov_b32 v117, 0x3f80
    v_lshlrev_b32 v116, v116, v117
    v_cndmask_b32 v116, 0, v116, vcc
    v_and_b32 v117, 2, v0
    v_cmp_eq_u32 vcc, 0, v117
    v_mov_b32 v142, 0
    v_mov_b32 v143, 0
    v_mov_b32 v144, 0
    v_mov_b32 v145, 0
    v_cndmask_b32 v140, 0, v116, vcc
    v_cndmask_b32 v146, 0, v116, vcc
    v_cndmask_b32 v141, v116, v142, vcc
    v_cndmask_b32 v147, v116, v142, vcc
    v_mul_f32 v244, s43, v168
    v_mul_f32 v245, s43, v169
    v_mul_f32 v246, s43, v170
    v_mul_f32 v247, s43, v171
    v_mul_f32 v248, s43, v184
    v_mul_f32 v249, s43, v185
    v_mul_f32 v250, s43, v186
    v_mul_f32 v251, s43, v187
    v_exp_f32 v244, v244 clamp
    v_max_f32 v168, s42, v168
    v_exp_f32 v245, v245 clamp
    v_max_f32 v169, s42, v169
    v_exp_f32 v246, v246 clamp
    v_max_f32 v170, s42, v170
    v_exp_f32 v247, v247 clamp
    v_max_f32 v171, s42, v171
    v_exp_f32 v248, v248 clamp
    v_max_f32 v184, s42, v184
    v_exp_f32 v249, v249 clamp
    v_max_f32 v185, s42, v185
    v_exp_f32 v250, v250 clamp
    v_max_f32 v186, s42, v186
    v_exp_f32 v251, v251 clamp
    v_max_f32 v187, s42, v187
    v_add_f32 v244, v244, v168
    v_add_f32 v245, v245, v169
    v_add_f32 v246, v246, v170
    v_add_f32 v247, v247, v171
    v_add_f32 v248, v248, v184
    v_add_f32 v249, v249, v185
    v_add_f32 v250, v250, v186
    v_add_f32 v251, v251, v187
    v_cvt_pk_bf16_f32 v84, v244, v245
    v_cvt_pk_bf16_f32 v85, v246, v247
    v_cvt_pk_bf16_f32 v86, v248, v249
    v_cvt_pk_bf16_f32 v87, v250, v251
    s_mov_b32 s17, 1
    s_waitcnt vmcnt(0)
    s_atomic_add s17, s[10:11], 0 glc
    v_mul_f32 v244, s43, v172
    v_mul_f32 v245, s43, v173
    v_mul_f32 v246, s43, v174
    v_mul_f32 v247, s43, v175
    v_mul_f32 v248, s43, v188
    v_mul_f32 v249, s43, v189
    v_mul_f32 v250, s43, v190
    v_mul_f32 v251, s43, v191
    v_exp_f32 v244, v244 clamp
    v_max_f32 v172, s42, v172
    v_exp_f32 v245, v245 clamp
    v_max_f32 v173, s42, v173
    v_exp_f32 v246, v246 clamp
    v_max_f32 v174, s42, v174
    v_exp_f32 v247, v247 clamp
    v_max_f32 v175, s42, v175
    v_exp_f32 v248, v248 clamp
    v_max_f32 v188, s42, v188
    v_exp_f32 v249, v249 clamp
    v_max_f32 v189, s42, v189
    v_exp_f32 v250, v250 clamp
    v_max_f32 v190, s42, v190
    v_exp_f32 v251, v251 clamp
    v_max_f32 v191, s42, v191
    v_add_f32 v244, v244, v172
    v_add_f32 v245, v245, v173
    v_add_f32 v246, v246, v174
    v_add_f32 v247, v247, v175
    v_add_f32 v248, v248, v188
    v_add_f32 v249, v249, v189
    v_add_f32 v250, v250, v190
    v_add_f32 v251, v251, v191
    v_cvt_pk_bf16_f32 v88, v244, v245
    v_cvt_pk_bf16_f32 v89, v246, v247
    v_cvt_pk_bf16_f32 v90, v248, v249
    v_cvt_pk_bf16_f32 v91, v250, v251
    s_waitcnt lgkmcnt(0)
    s_cmp_lt_u32 s17, 15
    s_cbranch_scc1 F_K1N
    buffer_load_dwordx4 v[100:103], v13, s[36:39], s54 offen sc1
    s_lshl_b32 s59, s30, 12
    s_and_b32 s59, s59, 0x7fff
    s_add_u32 s40, s59, s53
    buffer_load_dwordx4 v[16:19], v1, s[36:39], s40 offen offset:0 sc1
    v_mul_f32 v244, s43, v176
    v_mul_f32 v245, s43, v177
    buffer_load_dwordx4 v[20:23], v1, s[36:39], s40 offen offset:2048 sc1
    v_mul_f32 v246, s43, v178
    v_mul_f32 v247, s43, v179
    s_add_u32 s59, s59, 4096
    s_and_b32 s59, s59, 0x7fff
    s_add_u32 s40, s59, s53
    buffer_load_dwordx4 v[24:27], v1, s[36:39], s40 offen offset:0 sc1
    v_mul_f32 v248, s43, v192
    v_mul_f32 v249, s43, v193
    buffer_load_dwordx4 v[28:31], v1, s[36:39], s40 offen offset:2048 sc1
    v_mul_f32 v250, s43, v194
    v_mul_f32 v251, s43, v195
    s_add_u32 s59, s59, 4096
    s_and_b32 s59, s59, 0x7fff
    s_add_u32 s40, s59, s53
    buffer_load_dwordx4 v[32:35], v1, s[36:39], s40 offen offset:0 sc1
    v_exp_f32 v244, v244 clamp
    v_max_f32 v176, s42, v176
    buffer_load_dwordx4 v[36:39], v1, s[36:39], s40 offen offset:2048 sc1
    v_exp_f32 v245, v245 clamp
    v_max_f32 v177, s42, v177
    s_add_u32 s59, s59, 4096
    s_and_b32 s59, s59, 0x7fff
    s_add_u32 s40, s59, s53
    buffer_load_dwordx4 v[40:43], v1, s[36:39], s40 offen offset:0 sc1
    v_exp_f32 v246, v246 clamp
    v_max_f32 v178, s42, v178
    buffer_load_dwordx4 v[44:47], v1, s[36:39], s40 offen offset:2048 sc1
    v_exp_f32 v247, v247 clamp
    v_max_f32 v179, s42, v179
    s_add_u32 s59, s59, 4096
    s_and_b32 s59, s59, 0x7fff
    s_add_u32 s40, s59, s53
    buffer_load_dwordx4 v[48:51], v1, s[36:39], s40 offen offset:0 sc1
    v_exp_f32 v248, v248 clamp
    v_max_f32 v192, s42, v192
    buffer_load_dwordx4 v[52:55], v1, s[36:39], s40 offen offset:2048 sc1
    v_exp_f32 v249, v249 clamp
    v_max_f32 v193, s42, v193
    s_add_u32 s59, s59, 4096
    s_and_b32 s59, s59, 0x7fff
    s_add_u32 s40, s59, s53
    buffer_load_dwordx4 v[56:59], v1, s[36:39], s40 offen offset:0 sc1
    v_exp_f32 v250, v250 clamp
    v_max_f32 v194, s42, v194
    buffer_load_dwordx4 v[60:63], v1, s[36:39], s40 offen offset:2048 sc1
    v_exp_f32 v251, v251 clamp
    v_max_f32 v195, s42, v195
    s_add_u32 s59, s59, 4096
    s_and_b32 s59, s59, 0x7fff
    s_add_u32 s40, s59, s53
    buffer_load_dwordx4 v[64:67], v1, s[36:39], s40 offen offset:0 sc1
    v_add_f32 v244, v244, v176
    v_add_f32 v245, v245, v177
    buffer_load_dwordx4 v[68:71], v1, s[36:39], s40 offen offset:2048 sc1
    v_add_f32 v246, v246, v178
    v_add_f32 v247, v247, v179
    s_add_u32 s59, s59, 4096
    s_and_b32 s59, s59, 0x7fff
    s_add_u32 s40, s59, s53
    buffer_load_dwordx4 v[72:75], v1, s[36:39], s40 offen offset:0 sc1
    v_add_f32 v248, v248, v192
    v_add_f32 v249, v249, v193
    buffer_load_dwordx4 v[76:79], v1, s[36:39], s40 offen offset:2048 sc1
    v_add_f32 v250, v250, v194
    v_add_f32 v251, v251, v195
    v_cvt_pk_bf16_f32 v92, v244, v245
    v_cvt_pk_bf16_f32 v93, v246, v247
    v_cvt_pk_bf16_f32 v94, v248, v249
    v_cvt_pk_bf16_f32 v95, v250, v251
    s_waitcnt vmcnt(14)
    v_mfma_f32_16x16x32_bf16 v[104:107], v[140:143], v[16:19], 0
    v_mfma_f32_16x16x32_bf16 v[108:111], v[144:147], v[16:19], 0
    v_mul_f32 v244, s43, v180
    v_mul_f32 v245, s43, v181
    v_mul_f32 v246, s43, v182
    v_mul_f32 v247, s43, v183
    v_mfma_f32_16x16x32_bf16 v[104:107], v[140:143], v[20:23], v[104:107]
    v_mfma_f32_16x16x32_bf16 v[108:111], v[144:147], v[20:23], v[108:111]
    v_mul_f32 v248, s43, v196
    v_mul_f32 v249, s43, v197
    v_mul_f32 v250, s43, v198
    v_mul_f32 v251, s43, v199
    s_waitcnt vmcnt(12)
    v_mfma_f32_16x16x32_bf16 v[104:107], v[140:143], v[24:27], v[104:107]
    v_mfma_f32_16x16x32_bf16 v[108:111], v[144:147], v[24:27], v[108:111]
    v_exp_f32 v244, v244 clamp
    v_max_f32 v180, s42, v180
    v_exp_f32 v245, v245 clamp
    v_max_f32 v181, s42, v181
    v_mfma_f32_16x16x32_bf16 v[104:107], v[140:143], v[28:31], v[104:107]
    v_mfma_f32_16x16x32_bf16 v[108:111], v[144:147], v[28:31], v[108:111]
    v_exp_f32 v246, v246 clamp
    v_max_f32 v182, s42, v182
    v_exp_f32 v247, v247 clamp
    v_max_f32 v183, s42, v183
    s_waitcnt vmcnt(10)
    v_mfma_f32_16x16x32_bf16 v[104:107], v[140:143], v[32:35], v[104:107]
    v_mfma_f32_16x16x32_bf16 v[108:111], v[144:147], v[32:35], v[108:111]
    v_exp_f32 v248, v248 clamp
    v_max_f32 v196, s42, v196
    v_exp_f32 v249, v249 clamp
    v_max_f32 v197, s42, v197
    v_mfma_f32_16x16x32_bf16 v[104:107], v[140:143], v[36:39], v[104:107]
    v_mfma_f32_16x16x32_bf16 v[108:111], v[144:147], v[36:39], v[108:111]
    v_exp_f32 v250, v250 clamp
    v_max_f32 v198, s42, v198
    v_exp_f32 v251, v251 clamp
    v_max_f32 v199, s42, v199
    s_waitcnt vmcnt(8)
    v_mfma_f32_16x16x32_bf16 v[104:107], v[140:143], v[40:43], v[104:107]
    v_mfma_f32_16x16x32_bf16 v[108:111], v[144:147], v[40:43], v[108:111]
    v_add_f32 v244, v244, v180
    v_add_f32 v245, v245, v181
    v_add_f32 v246, v246, v182
    v_add_f32 v247, v247, v183
    v_mfma_f32_16x16x32_bf16 v[104:107], v[140:143], v[44:47], v[104:107]
    v_mfma_f32_16x16x32_bf16 v[108:111], v[144:147], v[44:47], v[108:111]
    v_add_f32 v248, v248, v196
    v_add_f32 v249, v249, v197
    v_add_f32 v250, v250, v198
    v_add_f32 v251, v251, v199
    s_waitcnt vmcnt(6)
    v_mfma_f32_16x16x32_bf16 v[104:107], v[140:143], v[48:51], v[104:107]
    v_mfma_f32_16x16x32_bf16 v[108:111], v[144:147], v[48:51], v[108:111]
    v_cvt_pk_bf16_f32 v96, v244, v245
    v_cvt_pk_bf16_f32 v97, v246, v247
    v_cvt_pk_bf16_f32 v98, v248, v249
    v_cvt_pk_bf16_f32 v99, v250, v251
    v_mfma_f32_16x16x32_bf16 v[104:107], v[140:143], v[52:55], v[104:107]
    v_mfma_f32_16x16x32_bf16 v[108:111], v[144:147], v[52:55], v[108:111]
    s_waitcnt vmcnt(16)
    v_add_f32_dpp v120, v100, v100 row_ror:8 row_mask:0xf bank_mask:0xf
    v_add_f32_dpp v121, v101, v101 row_ror:8 row_mask:0xf bank_mask:0xf
    v_add_f32_dpp v122, v102, v102 row_ror:8 row_mask:0xf bank_mask:0xf
    s_waitcnt vmcnt(4)
    v_mfma_f32_16x16x32_bf16 v[104:107], v[140:143], v[56:59], v[104:107]
    v_mfma_f32_16x16x32_bf16 v[108:111], v[144:147], v[56:59], v[108:111]
    v_add_f32_dpp v123, v103, v103 row_ror:8 row_mask:0xf bank_mask:0xf
    v_add_f32_dpp v120, v120, v120 row_ror:4 row_mask:0xf bank_mask:0xf
    v_add_f32_dpp v121, v121, v121 row_ror:4 row_mask:0xf bank_mask:0xf
    v_add_f32_dpp v122, v122, v122 row_ror:4 row_mask:0xf bank_mask:0xf
    v_mfma_f32_16x16x32_bf16 v[104:107], v[140:143], v[60:63], v[104:107]
    v_mfma_f32_16x16x32_bf16 v[108:111], v[144:147], v[60:63], v[108:111]
    v_add_f32_dpp v123, v123, v123 row_ror:4 row_mask:0xf bank_mask:0xf
    v_add_f32_dpp v120, v120, v120 row_ror:2 row_mask:0xf bank_mask:0xf
    v_add_f32_dpp v121, v121, v121 row_ror:2 row_mask:0xf bank_mask:0xf
    v_add_f32_dpp v122, v122, v122 row_ror:2 row_mask:0xf bank_mask:0xf
    s_waitcnt vmcnt(2)
    v_mfma_f32_16x16x32_bf16 v[104:107], v[140:143], v[64:67], v[104:107]
    v_mfma_f32_16x16x32_bf16 v[108:111], v[144:147], v[64:67], v[108:111]
    v_add_f32_dpp v123, v123, v123 row_ror:2 row_mask:0xf bank_mask:0xf
    v_add_f32_dpp v120, v120, v120 row_ror:1 row_mask:0xf bank_mask:0xf
    v_add_f32_dpp v121, v121, v121 row_ror:1 row_mask:0xf bank_mask:0xf
    v_add_f32_dpp v122, v122, v122 row_ror:1 row_mask:0xf bank_mask:0xf
    v_mfma_f32_16x16x32_bf16 v[104:107], v[140:143], v[68:71], v[104:107]
    v_mfma_f32_16x16x32_bf16 v[108:111], v[144:147], v[68:71], v[108:111]
    v_add_f32_dpp v123, v123, v123 row_ror:1 row_mask:0xf bank_mask:0xf
    v_cvt_pk_bf16_f32 v132, v120, v121
    v_cvt_pk_bf16_f32 v133, v122, v123
    s_waitcnt vmcnt(0)
    v_mfma_f32_16x16x32_bf16 v[104:107], v[140:143], v[72:75], v[104:107]
    v_mfma_f32_16x16x32_bf16 v[108:111], v[144:147], v[72:75], v[108:111]
    v_mfma_f32_16x16x32_bf16 v[104:107], v[140:143], v[76:79], v[104:107]
    v_mfma_f32_16x16x32_bf16 v[108:111], v[144:147], v[76:79], v[108:111]
    s_branch F_K2X
F_K1N:
    v_mul_f32 v244, s43, v176
    v_mul_f32 v245, s43, v177
    v_mul_f32 v246, s43, v178
    v_mul_f32 v247, s43, v179
    v_mul_f32 v248, s43, v192
    v_mul_f32 v249, s43, v193
    v_mul_f32 v250, s43, v194
    v_mul_f32 v251, s43, v195
    v_exp_f32 v244, v244 clamp
    v_max_f32 v176, s42, v176
    v_exp_f32 v245, v245 clamp
    v_max_f32 v177, s42, v177
    v_exp_f32 v246, v246 clamp
    v_max_f32 v178, s42, v178
    v_exp_f32 v247, v247 clamp
    v_max_f32 v179, s42, v179
    v_exp_f32 v248, v248 clamp
    v_max_f32 v192, s42, v192
    v_exp_f32 v249, v249 clamp
    v_max_f32 v193, s42, v193
    v_exp_f32 v250, v250 clamp
    v_max_f32 v194, s42, v194
    v_exp_f32 v251, v251 clamp
    v_max_f32 v195, s42, v195
    v_add_f32 v244, v244, v176
    v_add_f32 v245, v245, v177
    v_add_f32 v246, v246, v178
    v_add_f32 v247, v247, v179
    v_add_f32 v248, v248, v192
    v_add_f32 v249, v249, v193
    v_add_f32 v250, v250, v194
    v_add_f32 v251, v251, v195
    v_cvt_pk_bf16_f32 v92, v244, v245
    v_cvt_pk_bf16_f32 v93, v246, v247
    v_cvt_pk_bf16_f32 v94, v248, v249
    v_cvt_pk_bf16_f32 v95, v250, v251
    v_mul_f32 v244, s43, v180
    v_mul_f32 v245, s43, v181
    v_mul_f32 v246, s43, v182
    v_mul_f32 v247, s43, v183
    v_mul_f32 v248, s43, v196
    v_mul_f32 v249, s43, v197
    v_mul_f32 v250, s43, v198
    v_mul_f32 v251, s43, v199
    v_exp_f32 v244, v244 clamp
    v_max_f32 v180, s42, v180
    v_exp_f32 v245, v245 clamp
    v_max_f32 v181, s42, v181
    v_exp_f32 v246, v246 clamp
    v_max_f32 v182, s42, v182
    v_exp_f32 v247, v247 clamp
    v_max_f32 v183, s42, v183
    v_exp_f32 v248, v248 clamp
    v_max_f32 v196, s42, v196
    v_exp_f32 v249, v249 clamp
    v_max_f32 v197, s42, v197
    v_exp_f32 v250, v250 clamp
    v_max_f32 v198, s42, v198
    v_exp_f32 v251, v251 clamp
    v_max_f32 v199, s42, v199
    v_add_f32 v244, v244, v180
    v_add_f32 v245, v245, v181
    v_add_f32 v246, v246, v182
    v_add_f32 v247, v247, v183
    v_add_f32 v248, v248, v196
    v_add_f32 v249, v249, v197
    v_add_f32 v250, v250, v198
    v_add_f32 v251, v251, v199
    v_cvt_pk_bf16_f32 v96, v244, v245
    v_cvt_pk_bf16_f32 v97, v246, v247
    v_cvt_pk_bf16_f32 v98, v248, v249
    v_cvt_pk_bf16_f32 v99, v250, v251
    s_mov_b32 s45, 0
F_P2:
    s_mov_b32 s17, 0
    s_atomic_add s17, s[10:11], 0 glc
    s_waitcnt lgkmcnt(0)
    s_cmp_ge_u32 s17, 16
    s_cbranch_scc1 F_P2_X
    s_sleep 3
    s_add_u32 s45, s45, 1
    s_cmp_lt_u32 s45, 400000
    s_cbranch_scc1 F_P2
F_P2_X:
    buffer_load_dwordx4 v[100:103], v13, s[36:39], s54 offen sc1
    s_lshl_b32 s59, s30, 12
    s_and_b32 s59, s59, 0x7fff
    s_add_u32 s40, s59, s53
    buffer_load_dwordx4 v[16:19], v1, s[36:39], s40 offen offset:0 sc1
    buffer_load_dwordx4 v[20:23], v1, s[36:39], s40 offen offset:2048 sc1
    s_add_u32 s59, s59, 4096
    s_and_b32 s59, s59, 0x7fff
    s_add_u32 s40, s59, s53
    buffer_load_dwordx4 v[24:27], v1, s[36:39], s40 offen offset:0 sc1
    buffer_load_dwordx4 v[28:31], v1, s[36:39], s40 offen offset:2048 sc1
    s_add_u32 s59, s59, 4096
    s_and_b32 s59, s59, 0x7fff
    s_add_u32 s40, s59, s53
    buffer_load_dwordx4 v[32:35], v1, s[36:39], s40 offen offset:0 sc1
    buffer_load_dwordx4 v[36:39], v1, s[36:39], s40 offen offset:2048 sc1
    s_add_u32 s59, s59, 4096
    s_and_b32 s59, s59, 0x7fff
    s_add_u32 s40, s59, s53
    buffer_load_dwordx4 v[40:43], v1, s[36:39], s40 offen offset:0 sc1
    buffer_load_dwordx4 v[44:47], v1, s[36:39], s40 offen offset:2048 sc1
    s_add_u32 s59, s59, 4096
    s_and_b32 s59, s59, 0x7fff
    s_add_u32 s40, s59, s53
    buffer_load_dwordx4 v[48:51], v1, s[36:39], s40 offen offset:0 sc1
    buffer_load_dwordx4 v[52:55], v1, s[36:39], s40 offen offset:2048 sc1
    s_add_u32 s59, s59, 4096
    s_and_b32 s59, s59, 0x7fff
    s_add_u32 s40, s59, s53
    buffer_load_dwordx4 v[56:59], v1, s[36:39], s40 offen offset:0 sc1
    buffer_load_dwordx4 v[60:63], v1, s[36:39], s40 offen offset:2048 sc1
    s_add_u32 s59, s59, 4096
    s_and_b32 s59, s59, 0x7fff
    s_add_u32 s40, s59, s53
    buffer_load_dwordx4 v[64:67], v1, s[36:39], s40 offen offset:0 sc1
    buffer_load_dwordx4 v[68:71], v1, s[36:39], s40 offen offset:2048 sc1
    s_add_u32 s59, s59, 4096
    s_and_b32 s59, s59, 0x7fff
    s_add_u32 s40, s59, s53
    buffer_load_dwordx4 v[72:75], v1, s[36:39], s40 offen offset:0 sc1
    buffer_load_dwordx4 v[76:79], v1, s[36:39], s40 offen offset:2048 sc1
    s_waitcnt vmcnt(16)
    v_add_f32_dpp v120, v100, v100 row_ror:8 row_mask:0xf bank_mask:0xf
    v_add_f32_dpp v121, v101, v101 row_ror:8 row_mask:0xf bank_mask:0xf
    v_add_f32_dpp v122, v102, v102 row_ror:8 row_mask:0xf bank_mask:0xf
    v_add_f32_dpp v123, v103, v103 row_ror:8 row_mask:0xf bank_mask:0xf
    v_add_f32_dpp v120, v120, v120 row_ror:4 row_mask:0xf bank_mask:0xf
    v_add_f32_dpp v121, v121, v121 row_ror:4 row_mask:0xf bank_mask:0xf
    v_add_f32_dpp v122, v122, v122 row_ror:4 row_mask:0xf bank_mask:0xf
    v_add_f32_dpp v123, v123, v123 row_ror:4 row_mask:0xf bank_mask:0xf
    v_add_f32_dpp v120, v120, v120 row_ror:2 row_mask:0xf bank_mask:0xf
    v_add_f32_dpp v121, v121, v121 row_ror:2 row_mask:0xf bank_mask:0xf
    v_add_f32_dpp v122, v122, v122 row_ror:2 row_mask:0xf bank_mask:0xf
    v_add_f32_dpp v123, v123, v123 row_ror:2 row_mask:0xf bank_mask:0xf
    v_add_f32_dpp v120, v120, v120 row_ror:1 row_mask:0xf bank_mask:0xf
    v_add_f32_dpp v121, v121, v121 row_ror:1 row_mask:0xf bank_mask:0xf
    v_add_f32_dpp v122, v122, v122 row_ror:1 row_mask:0xf bank_mask:0xf
    v_add_f32_dpp v123, v123, v123 row_ror:1 row_mask:0xf bank_mask:0xf
    v_cvt_pk_bf16_f32 v132, v120, v121
    v_cvt_pk_bf16_f32 v133, v122, v123
    s_waitcnt vmcnt(14)
    v_mfma_f32_16x16x32_bf16 v[104:107], v[140:143], v[16:19], 0
    v_mfma_f32_16x16x32_bf16 v[108:111], v[144:147], v[16:19], 0
    v_mfma_f32_16x16x32_bf16 v[104:107], v[140:143], v[20:23], v[104:107]
    v_mfma_f32_16x16x32_bf16 v[108:111], v[144:147], v[20:23], v[108:111]
    s_waitcnt vmcnt(12)
    v_mfma_f32_16x16x32_bf16 v[104:107], v[140:143], v[24:27], v[104:107]
    v_mfma_f32_16x16x32_bf16 v[108:111], v[144:147], v[24:27], v[108:111]
    v_mfma_f32_16x16x32_bf16 v[104:107], v[140:143], v[28:31], v[104:107]
    v_mfma_f32_16x16x32_bf16 v[108:111], v[144:147], v[28:31], v[108:111]
    s_waitcnt vmcnt(10)
    v_mfma_f32_16x16x32_bf16 v[104:107], v[140:143], v[32:35], v[104:107]
    v_mfma_f32_16x16x32_bf16 v[108:111], v[144:147], v[32:35], v[108:111]
    v_mfma_f32_16x16x32_bf16 v[104:107], v[140:143], v[36:39], v[104:107]
    v_mfma_f32_16x16x32_bf16 v[108:111], v[144:147], v[36:39], v[108:111]
    s_waitcnt vmcnt(8)
    v_mfma_f32_16x16x32_bf16 v[104:107], v[140:143], v[40:43], v[104:107]
    v_mfma_f32_16x16x32_bf16 v[108:111], v[144:147], v[40:43], v[108:111]
    v_mfma_f32_16x16x32_bf16 v[104:107], v[140:143], v[44:47], v[104:107]
    v_mfma_f32_16x16x32_bf16 v[108:111], v[144:147], v[44:47], v[108:111]
    s_waitcnt vmcnt(6)
    v_mfma_f32_16x16x32_bf16 v[104:107], v[140:143], v[48:51], v[104:107]
    v_mfma_f32_16x16x32_bf16 v[108:111], v[144:147], v[48:51], v[108:111]
    v_mfma_f32_16x16x32_bf16 v[104:107], v[140:143], v[52:55], v[104:107]
    v_mfma_f32_16x16x32_bf16 v[108:111], v[144:147], v[52:55], v[108:111]
    s_waitcnt vmcnt(4)
    v_mfma_f32_16x16x32_bf16 v[104:107], v[140:143], v[56:59], v[104:107]
    v_mfma_f32_16x16x32_bf16 v[108:111], v[144:147], v[56:59], v[108:111]
    v_mfma_f32_16x16x32_bf16 v[104:107], v[140:143], v[60:63], v[104:107]
    v_mfma_f32_16x16x32_bf16 v[108:111], v[144:147], v[60:63], v[108:111]
    s_waitcnt vmcnt(2)
    v_mfma_f32_16x16x32_bf16 v[104:107], v[140:143], v[64:67], v[104:107]
    v_mfma_f32_16x16x32_bf16 v[108:111], v[144:147], v[64:67], v[108:111]
    v_mfma_f32_16x16x32_bf16 v[104:107], v[140:143], v[68:71], v[104:107]
    v_mfma_f32_16x16x32_bf16 v[108:111], v[144:147], v[68:71], v[108:111]
    s_waitcnt vmcnt(0)
    v_mfma_f32_16x16x32_bf16 v[104:107], v[140:143], v[72:75], v[104:107]
    v_mfma_f32_16x16x32_bf16 v[108:111], v[144:147], v[72:75], v[108:111]
    v_mfma_f32_16x16x32_bf16 v[104:107], v[140:143], v[76:79], v[104:107]
    v_mfma_f32_16x16x32_bf16 v[108:111], v[144:147], v[76:79], v[108:111]
F_K2X:
    s_nop 6
    v_cvt_pk_bf16_f32 v136, v104, v105
    v_cvt_pk_bf16_f32 v137, v106, v107
    v_cvt_pk_bf16_f32 v138, v108, v109
    v_cvt_pk_bf16_f32 v139, v110, v111
    ds_write_b128 v7, v[136:139]
    ds_write_b64 v9, v[132:133] offset:2048
    ds_write_b32 v10, v14 offset:4
F_XB:
    ds_read_b32 v15, v11 offset:4
    ds_read_b64 v[134:135], v8 offset:2048
    ds_read_b64 v[124:125], v200
    ds_read_b64 v[126:127], v201
    ds_read_b64 v[128:129], v202
    ds_read_b64 v[130:131], v203
    s_waitcnt lgkmcnt(0)
    v_cmp_ne_u32 vcc, 1, v15
    s_cbranch_vccnz F_XB
    v_mfma_f32_16x16x32_bf16 v[140:143], v[132:135], v[84:87], v[112:115]
    v_mfma_f32_16x16x32_bf16 v[144:147], v[132:135], v[88:91], v[112:115]
    v_mfma_f32_16x16x32_bf16 v[148:151], v[132:135], v[92:95], v[112:115]
    v_mfma_f32_16x16x32_bf16 v[152:155], v[132:135], v[96:99], v[112:115]
    v_mfma_f32_16x16x32_bf16 v[156:159], v[124:127], v[84:87], 0
    v_mfma_f32_16x16x32_bf16 v[160:163], v[128:131], v[84:87], 0
    v_mfma_f32_16x16x32_bf16 v[164:167], v[124:127], v[88:91], 0
    v_mfma_f32_16x16x32_bf16 v[168:171], v[128:131], v[88:91], 0
    v_mfma_f32_16x16x32_bf16 v[172:175], v[124:127], v[92:95], 0
    v_mfma_f32_16x16x32_bf16 v[176:179], v[128:131], v[92:95], 0
    v_mfma_f32_16x16x32_bf16 v[180:183], v[124:127], v[96:99], 0
    v_mfma_f32_16x16x32_bf16 v[184:187], v[128:131], v[96:99], 0
    ds_write_b32 v206, v14
    s_mov_b32 s17, 0
    s_atomic_add s17, s[14:15], 0 glc
    ds_read_b32 v10, v211
    v_rcp_f32 v140, v140
    v_rcp_f32 v144, v144
    v_rcp_f32 v148, v148
    v_rcp_f32 v152, v152
    v_mul_f32 v156, v156, v140
    v_mul_f32 v157, v157, v140
    v_mul_f32 v158, v158, v140
    v_mul_f32 v159, v159, v140
    v_mul_f32 v160, v160, v140
    v_mul_f32 v161, v161, v140
    v_mul_f32 v162, v162, v140
    v_mul_f32 v163, v163, v140
    v_cvt_pk_bf16_f32 v212, v156, v157
    v_cvt_pk_bf16_f32 v213, v158, v159
    v_cvt_pk_bf16_f32 v214, v160, v161
    v_cvt_pk_bf16_f32 v215, v162, v163
    buffer_store_dwordx4 v[212:215], v1, s[36:39], s52 offen sc1
    s_add_u32 s52, s52, 33792
    v_mul_f32 v164, v164, v144
    v_mul_f32 v165, v165, v144
    v_mul_f32 v166, v166, v144
    v_mul_f32 v167, v167, v144
    v_mul_f32 v168, v168, v144
    v_mul_f32 v169, v169, v144
    v_mul_f32 v170, v170, v144
    v_mul_f32 v171, v171, v144
    v_cvt_pk_bf16_f32 v216, v164, v165
    v_cvt_pk_bf16_f32 v217, v166, v167
    v_cvt_pk_bf16_f32 v218, v168, v169
    v_cvt_pk_bf16_f32 v219, v170, v171
    buffer_store_dwordx4 v[216:219], v1, s[36:39], s52 offen sc1
    s_add_u32 s52, s52, 33792
    v_mul_f32 v172, v172, v148
    v_mul_f32 v173, v173, v148
    v_mul_f32 v174, v174, v148
    v_mul_f32 v175, v175, v148
    v_mul_f32 v176, v176, v148
    v_mul_f32 v177, v177, v148
    v_mul_f32 v178, v178, v148
    v_mul_f32 v179, v179, v148
    v_cvt_pk_bf16_f32 v220, v172, v173
    v_cvt_pk_bf16_f32 v221, v174, v175
    v_cvt_pk_bf16_f32 v222, v176, v177
    v_cvt_pk_bf16_f32 v223, v178, v179
    buffer_store_dwordx4 v[220:223], v1, s[36:39], s52 offen sc1
    s_add_u32 s52, s52, 33792
    v_mul_f32 v180, v180, v152
    v_mul_f32 v181, v181, v152
    v_mul_f32 v182, v182, v152
    v_mul_f32 v183, v183, v152
    v_mul_f32 v184, v184, v152
    v_mul_f32 v185, v185, v152
    v_mul_f32 v186, v186, v152
    v_mul_f32 v187, v187, v152
    v_cvt_pk_bf16_f32 v224, v180, v181
    v_cvt_pk_bf16_f32 v225, v182, v183
    v_cvt_pk_bf16_f32 v226, v184, v185
    v_cvt_pk_bf16_f32 v227, v186, v187
    buffer_store_dwordx4 v[224:227], v1, s[36:39], s52 offen sc1
    v_add_u32 v6, 33792, v1
    s_mov_b32 s46, 0x11111111
    s_mov_b32 s50, -1
    s_mov_b32 s51, -1
    v_mov_b32 v16, 0
    v_mov_b32 v17, 0
    v_mov_b32 v18, 0
    v_mov_b32 v19, 0
    v_mov_b32 v20, 0
    v_mov_b32 v21, 0
    v_mov_b32 v22, 0
    v_mov_b32 v23, 0
    v_mov_b32 v24, 0
    v_mov_b32 v25, 0
    v_mov_b32 v26, 0
    v_mov_b32 v27, 0
    v_mov_b32 v28, 0
    v_mov_b32 v29, 0
    v_mov_b32 v30, 0
    v_mov_b32 v31, 0
    v_mov_b32 v32, 0
    v_mov_b32 v33, 0
    v_mov_b32 v34, 0
    v_mov_b32 v35, 0
    v_mov_b32 v36, 0
    v_mov_b32 v37, 0
    v_mov_b32 v38, 0
    v_mov_b32 v39, 0
    v_mov_b32 v40, 0
    v_mov_b32 v41, 0
    v_mov_b32 v42, 0
    v_mov_b32 v43, 0
    v_mov_b32 v44, 0
    v_mov_b32 v45, 0
    v_mov_b32 v46, 0
    v_mov_b32 v47, 0
    s_mov_b32 s47, 0
    s_mov_b32 s54, 0x76432105
    s_mov_b32 s44, 0
    s_mov_b32 s58, 0
    s_mov_b32 s18, 1
    s_branch F_GR0
.p2align 6
F_GLOOP:
    s_cmp_lt_i32 s50, 0
    s_cbranch_scc1 F_GE0
    s_waitcnt vmcnt(8)
F_GC0:
F_GK0:
    s_waitcnt lgkmcnt(0)
    v_mfma_f32_16x16x32_bf16 v[16:19], v[48:51], v[80:83], v[16:19]
    ds_read_b64_tr_b16 v[64:65], v2 offset:4096
    ds_read_b64_tr_b16 v[66:67], v2 offset:6144
    v_mfma_f32_16x16x32_bf16 v[32:35], v[48:51], v[84:87], v[32:35]
    ds_read_b64_tr_b16 v[68:69], v3 offset:4096
    ds_read_b64_tr_b16 v[70:71], v3 offset:6144
    v_mfma_f32_16x16x32_bf16 v[20:23], v[52:55], v[80:83], v[20:23]
    ds_read_b64_tr_b16 v[72:73], v4 offset:4096
    ds_read_b64_tr_b16 v[74:75], v4 offset:6144
    v_mfma_f32_16x16x32_bf16 v[36:39], v[52:55], v[84:87], v[36:39]
    ds_read_b64_tr_b16 v[76:77], v5 offset:4096
    ds_read_b64_tr_b16 v[78:79], v5 offset:6144
    v_mfma_f32_16x16x32_bf16 v[24:27], v[56:59], v[80:83], v[24:27]
    v_mfma_f32_16x16x32_bf16 v[40:43], v[56:59], v[84:87], v[40:43]
    v_mfma_f32_16x16x32_bf16 v[28:31], v[60:63], v[80:83], v[28:31]
    v_mfma_f32_16x16x32_bf16 v[44:47], v[60:63], v[84:87], v[44:47]
    s_and_b32 s45, s46, s47
    s_cbranch_scc0 F_GP0
F_GQ0:
    s_waitcnt lgkmcnt(0)
    v_mfma_f32_16x16x32_bf16 v[16:19], v[64:67], v[88:91], v[16:19]
    ds_read_b64_tr_b16 v[48:49], v2 offset:8192
    ds_read_b64_tr_b16 v[50:51], v2 offset:10240
    s_and_b32 s45, s46, s47
    v_mfma_f32_16x16x32_bf16 v[32:35], v[64:67], v[92:95], v[32:35]
    ds_read_b64_tr_b16 v[52:53], v3 offset:8192
    ds_read_b64_tr_b16 v[54:55], v3 offset:10240
    s_cselect_b32 s66, s38, 0
    v_mfma_f32_16x16x32_bf16 v[20:23], v[68:71], v[88:91], v[20:23]
    ds_read_b64_tr_b16 v[56:57], v4 offset:8192
    ds_read_b64_tr_b16 v[58:59], v4 offset:10240
    s_ff1_i32_b32 s50, s45
    v_mfma_f32_16x16x32_bf16 v[36:39], v[68:71], v[92:95], v[36:39]
    ds_read_b64_tr_b16 v[60:61], v5 offset:8192
    ds_read_b64_tr_b16 v[62:63], v5 offset:10240
    s_lshl_b32 s52, s50, 10
    v_mfma_f32_16x16x32_bf16 v[24:27], v[72:75], v[88:91], v[24:27]
    s_add_u32 s52, s52, s55
    s_bitset0_b32 s46, s50
    v_mfma_f32_16x16x32_bf16 v[40:43], v[72:75], v[92:95], v[40:43]
    buffer_load_dwordx4 v[80:83], v1, s[64:67], s52 offen offset:0 sc1
    s_lshr_b32 s48, s54, s51
    v_mfma_f32_16x16x32_bf16 v[28:31], v[76:79], v[88:91], v[28:31]
    buffer_load_dwordx4 v[84:87], v6, s[64:67], s52 offen offset:0 sc1
    s_and_b32 s48, s48, 15
    v_mfma_f32_16x16x32_bf16 v[44:47], v[76:79], v[92:95], v[44:47]
    s_lshl_b32 s48, s48, 14
    s_waitcnt lgkmcnt(0)
    v_mfma_f32_16x16x32_bf16 v[16:19], v[48:51], v[96:99], v[16:19]
    ds_read_b64_tr_b16 v[64:65], v2 offset:12288
    ds_read_b64_tr_b16 v[66:67], v2 offset:14336
    v_mfma_f32_16x16x32_bf16 v[32:35], v[48:51], v[100:103], v[32:35]
    ds_read_b64_tr_b16 v[68:69], v3 offset:12288
    ds_read_b64_tr_b16 v[70:71], v3 offset:14336
    v_mfma_f32_16x16x32_bf16 v[20:23], v[52:55], v[96:99], v[20:23]
    ds_read_b64_tr_b16 v[72:73], v4 offset:12288
    ds_read_b64_tr_b16 v[74:75], v4 offset:14336
    v_mfma_f32_16x16x32_bf16 v[36:39], v[52:55], v[100:103], v[36:39]
    ds_read_b64_tr_b16 v[76:77], v5 offset:12288
    ds_read_b64_tr_b16 v[78:79], v5 offset:14336
    v_mfma_f32_16x16x32_bf16 v[24:27], v[56:59], v[96:99], v[24:27]
    buffer_load_dwordx4 v[88:91], v1, s[64:67], s52 offen offset:1024 sc1
    v_add_u32 v2, s48, v207
    v_mfma_f32_16x16x32_bf16 v[40:43], v[56:59], v[100:103], v[40:43]
    buffer_load_dwordx4 v[92:95], v6, s[64:67], s52 offen offset:1024 sc1
    v_xor_b32 v3, 32, v2
    v_mfma_f32_16x16x32_bf16 v[28:31], v[60:63], v[96:99], v[28:31]
    v_xor_b32 v4, 64, v2
    v_xor_b32 v5, 96, v2
    v_mfma_f32_16x16x32_bf16 v[44:47], v[60:63], v[100:103], v[44:47]
    s_waitcnt lgkmcnt(0)
    v_mfma_f32_16x16x32_bf16 v[16:19], v[64:67], v[104:107], v[16:19]
    ds_read_b64_tr_b16 v[48:49], v2 offset:0
    ds_read_b64_tr_b16 v[50:51], v2 offset:2048
    v_mfma_f32_16x16x32_bf16 v[32:35], v[64:67], v[108:111], v[32:35]
    ds_read_b64_tr_b16 v[52:53], v3 offset:0
    ds_read_b64_tr_b16 v[54:55], v3 offset:2048
    v_mfma_f32_16x16x32_bf16 v[20:23], v[68:71], v[104:107], v[20:23]
    ds_read_b64_tr_b16 v[56:57], v4 offset:0
    ds_read_b64_tr_b16 v[58:59], v4 offset:2048
    v_mfma_f32_16x16x32_bf16 v[36:39], v[68:71], v[108:111], v[36:39]
    ds_read_b64_tr_b16 v[60:61], v5 offset:0
    ds_read_b64_tr_b16 v[62:63], v5 offset:2048
    v_mfma_f32_16x16x32_bf16 v[24:27], v[72:75], v[104:107], v[24:27]
    buffer_load_dwordx4 v[96:99], v1, s[64:67], s52 offen offset:2048 sc1
    v_mfma_f32_16x16x32_bf16 v[40:43], v[72:75], v[108:111], v[40:43]
    buffer_load_dwordx4 v[100:103], v6, s[64:67], s52 offen offset:2048 sc1
    v_mfma_f32_16x16x32_bf16 v[28:31], v[76:79], v[104:107], v[28:31]
    v_mfma_f32_16x16x32_bf16 v[44:47], v[76:79], v[108:111], v[44:47]
    buffer_load_dwordx4 v[104:107], v1, s[64:67], s52 offen offset:3072 sc1
    buffer_load_dwordx4 v[108:111], v6, s[64:67], s52 offen offset:3072 sc1
    s_cmp_lt_i32 s51, 0
    s_cbranch_scc1 F_GE1
    s_waitcnt vmcnt(8)
F_GC1:
F_GK1:
    s_waitcnt lgkmcnt(0)
    v_mfma_f32_16x16x32_bf16 v[16:19], v[48:51], v[112:115], v[16:19]
    ds_read_b64_tr_b16 v[64:65], v2 offset:4096
    ds_read_b64_tr_b16 v[66:67], v2 offset:6144
    v_mfma_f32_16x16x32_bf16 v[32:35], v[48:51], v[116:119], v[32:35]
    ds_read_b64_tr_b16 v[68:69], v3 offset:4096
    ds_read_b64_tr_b16 v[70:71], v3 offset:6144
    v_mfma_f32_16x16x32_bf16 v[20:23], v[52:55], v[112:115], v[20:23]
    ds_read_b64_tr_b16 v[72:73], v4 offset:4096
    ds_read_b64_tr_b16 v[74:75], v4 offset:6144
    v_mfma_f32_16x16x32_bf16 v[36:39], v[52:55], v[116:119], v[36:39]
    ds_read_b64_tr_b16 v[76:77], v5 offset:4096
    ds_read_b64_tr_b16 v[78:79], v5 offset:6144
    v_mfma_f32_16x16x32_bf16 v[24:27], v[56:59], v[112:115], v[24:27]
    v_mfma_f32_16x16x32_bf16 v[40:43], v[56:59], v[116:119], v[40:43]
    v_mfma_f32_16x16x32_bf16 v[28:31], v[60:63], v[112:115], v[28:31]
    v_mfma_f32_16x16x32_bf16 v[44:47], v[60:63], v[116:119], v[44:47]
    s_and_b32 s45, s46, s47
    s_cbranch_scc0 F_GP1
F_GQ1:
    s_waitcnt lgkmcnt(0)
    v_mfma_f32_16x16x32_bf16 v[16:19], v[64:67], v[120:123], v[16:19]
    ds_read_b64_tr_b16 v[48:49], v2 offset:8192
    ds_read_b64_tr_b16 v[50:51], v2 offset:10240
    s_and_b32 s45, s46, s47
    v_mfma_f32_16x16x32_bf16 v[32:35], v[64:67], v[124:127], v[32:35]
    ds_read_b64_tr_b16 v[52:53], v3 offset:8192
    ds_read_b64_tr_b16 v[54:55], v3 offset:10240
    s_cselect_b32 s66, s38, 0
    v_mfma_f32_16x16x32_bf16 v[20:23], v[68:71], v[120:123], v[20:23]
    ds_read_b64_tr_b16 v[56:57], v4 offset:8192
    ds_read_b64_tr_b16 v[58:59], v4 offset:10240
    s_ff1_i32_b32 s51, s45
    v_mfma_f32_16x16x32_bf16 v[36:39], v[68:71], v[124:127], v[36:39]
    ds_read_b64_tr_b16 v[60:61], v5 offset:8192
    ds_read_b64_tr_b16 v[62:63], v5 offset:10240
    s_lshl_b32 s53, s51, 10
    v_mfma_f32_16x16x32_bf16 v[24:27], v[72:75], v[120:123], v[24:27]
    s_add_u32 s53, s53, s55
    s_bitset0_b32 s46, s51
    v_mfma_f32_16x16x32_bf16 v[40:43], v[72:75], v[124:127], v[40:43]
    buffer_load_dwordx4 v[112:115], v1, s[64:67], s53 offen offset:0 sc1
    s_lshr_b32 s48, s54, s50
    v_mfma_f32_16x16x32_bf16 v[28:31], v[76:79], v[120:123], v[28:31]
    buffer_load_dwordx4 v[116:119], v6, s[64:67], s53 offen offset:0 sc1
    s_and_b32 s48, s48, 15
    v_mfma_f32_16x16x32_bf16 v[44:47], v[76:79], v[124:127], v[44:47]
    s_lshl_b32 s48, s48, 14
    s_waitcnt lgkmcnt(0)
    v_mfma_f32_16x16x32_bf16 v[16:19], v[48:51], v[128:131], v[16:19]
    ds_read_b64_tr_b16 v[64:65], v2 offset:12288
    ds_read_b64_tr_b16 v[66:67], v2 offset:14336
    v_mfma_f32_16x16x32_bf16 v[32:35], v[48:51], v[132:135], v[32:35]
    ds_read_b64_tr_b16 v[68:69], v3 offset:12288
    ds_read_b64_tr_b16 v[70:71], v3 offset:14336
    v_mfma_f32_16x16x32_bf16 v[20:23], v[52:55], v[128:131], v[20:23]
    ds_read_b64_tr_b16 v[72:73], v4 offset:12288
    ds_read_b64_tr_b16 v[74:75], v4 offset:14336
    v_mfma_f32_16x16x32_bf16 v[36:39], v[52:55], v[132:135], v[36:39]
    ds_read_b64_tr_b16 v[76:77], v5 offset:12288
    ds_read_b64_tr_b16 v[78:79], v5 offset:14336
    v_mfma_f32_16x16x32_bf16 v[24:27], v[56:59], v[128:131], v[24:27]
    buffer_load_dwordx4 v[120:123], v1, s[64:67], s53 offen offset:1024 sc1
    v_add_u32 v2, s48, v207
    v_mfma_f32_16x16x32_bf16 v[40:43], v[56:59], v[132:135], v[40:43]
    buffer_load_dwordx4 v[124:127], v6, s[64:67], s53 offen offset:1024 sc1
    v_xor_b32 v3, 32, v2
    v_mfma_f32_16x16x32_bf16 v[28:31], v[60:63], v[128:131], v[28:31]
    v_xor_b32 v4, 64, v2
    v_xor_b32 v5, 96, v2
    v_mfma_f32_16x16x32_bf16 v[44:47], v[60:63], v[132:135], v[44:47]
    s_waitcnt lgkmcnt(0)
    v_mfma_f32_16x16x32_bf16 v[16:19], v[64:67], v[136:139], v[16:19]
    ds_read_b64_tr_b16 v[48:49], v2 offset:0
    ds_read_b64_tr_b16 v[50:51], v2 offset:2048
    v_mfma_f32_16x16x32_bf16 v[32:35], v[64:67], v[140:143], v[32:35]
    ds_read_b64_tr_b16 v[52:53], v3 offset:0
    ds_read_b64_tr_b16 v[54:55], v3 offset:2048
    v_mfma_f32_16x16x32_bf16 v[20:23], v[68:71], v[136:139], v[20:23]
    ds_read_b64_tr_b16 v[56:57], v4 offset:0
    ds_read_b64_tr_b16 v[58:59], v4 offset:2048
    v_mfma_f32_16x16x32_bf16 v[36:39], v[68:71], v[140:143], v[36:39]
    ds_read_b64_tr_b16 v[60:61], v5 offset:0
    ds_read_b64_tr_b16 v[62:63], v5 offset:2048
    v_mfma_f32_16x16x32_bf16 v[24:27], v[72:75], v[136:139], v[24:27]
    buffer_load_dwordx4 v[128:131], v1, s[64:67], s53 offen offset:2048 sc1
    v_mfma_f32_16x16x32_bf16 v[40:43], v[72:75], v[140:143], v[40:43]
    buffer_load_dwordx4 v[132:135], v6, s[64:67], s53 offen offset:2048 sc1
    v_mfma_f32_16x16x32_bf16 v[28:31], v[76:79], v[136:139], v[28:31]
    v_mfma_f32_16x16x32_bf16 v[44:47], v[76:79], v[140:143], v[44:47]
    buffer_load_dwordx4 v[136:139], v1, s[64:67], s53 offen offset:3072 sc1
    buffer_load_dwordx4 v[140:143], v6, s[64:67], s53 offen offset:3072 sc1
    s_add_u32 s44, s44, 1
    s_cmp_lt_u32 s44, 4
    s_cbranch_scc1 F_GLOOP
    s_add_u32 s57, s56, 65536
    s_waitcnt lgkmcnt(0)
    v_cvt_pk_bf16_f32 v48, v16, v17
    v_cvt_pk_bf16_f32 v49, v18, v19
    v_cvt_pk_bf16_f32 v50, v20, v21
    v_cvt_pk_bf16_f32 v51, v22, v23
    v_cvt_pk_bf16_f32 v52, v24, v25
    v_cvt_pk_bf16_f32 v53, v26, v27
    v_cvt_pk_bf16_f32 v54, v28, v29
    v_cvt_pk_bf16_f32 v55, v30, v31
    v_cvt_pk_bf16_f32 v56, v32, v33
    v_cvt_pk_bf16_f32 v57, v34, v35
    v_cvt_pk_bf16_f32 v58, v36, v37
    v_cvt_pk_bf16_f32 v59, v38, v39
    v_cvt_pk_bf16_f32 v60, v40, v41
    v_cvt_pk_bf16_f32 v61, v42, v43
    v_cvt_pk_bf16_f32 v62, v44, v45
    v_cvt_pk_bf16_f32 v63, v46, v47
    v_permlane16_swap_b32 v48, v50
    v_permlane16_swap_b32 v49, v51
    buffer_store_dwordx4 v[48:51], v210, s[60:63], s56 offen offset:0 sc1
    v_permlane16_swap_b32 v52, v54
    v_permlane16_swap_b32 v53, v55
    buffer_store_dwordx4 v[52:55], v210, s[60:63], s56 offen offset:64 sc1
    v_permlane16_swap_b32 v56, v58
    v_permlane16_swap_b32 v57, v59
    buffer_store_dwordx4 v[56:59], v210, s[60:63], s57 offen offset:0 sc1
    v_permlane16_swap_b32 v60, v62
    v_permlane16_swap_b32 v61, v63
    buffer_store_dwordx4 v[60:63], v210, s[60:63], s57 offen offset:64 sc1
    s_endpgm
F_CNB0:
    ds_write_b32 v204, v14 offset:32
F_WS15:
    ds_read_b32 v15, v209 offset:128
    s_waitcnt lgkmcnt(0)
    v_cmp_ne_u32 vcc, 1, v15
    s_cbranch_vccz F_WS15_X
    s_branch F_WS15
F_WS15_X:
    s_branch F_CB0
F_CNB1:
    ds_write_b32 v204, v14
    s_branch F_CB1
F_GP0:
    s_cmp_eq_u32 s46, 0
    s_cbranch_scc1 F_GQ0
    s_cmp_lt_i32 s51, 0
    s_cbranch_scc1 F_GQ0
    s_mov_b32 s17, 0
    s_atomic_add s17, s[14:15], 0 glc
    ds_read_b32 v10, v211
    s_waitcnt lgkmcnt(0)
    v_cmp_ne_u32 s[40:41], 1, v10
    s_lshr_b32 s17, s17, 2
    s_or_b32 s45, s40, s41
    s_lshr_b32 s40, s45, 1
    s_or_b32 s45, s45, s40
    s_lshr_b32 s40, s45, 2
    s_or_b32 s45, s45, s40
    s_andn2_b32 s47, s17, s45
    s_cmp_gt_u32 s58, 400000
    s_cselect_b32 s47, -1, s47
    s_and_b32 s47, s47, s46
    s_branch F_GQ0
F_GS0:
    s_cmp_eq_u32 s18, 0
    s_cbranch_scc1 F_GT0
    s_waitcnt vmcnt(0)
    s_atomic_add s16, s[12:13], 0
    s_mov_b32 s18, 0
F_GT0:
    s_sleep 6
F_GE0:
    s_add_u32 s58, s58, 1
    s_mov_b32 s17, 0
    s_atomic_add s17, s[14:15], 0 glc
    ds_read_b32 v10, v211
F_GR0:
    s_waitcnt lgkmcnt(0)
    v_cmp_ne_u32 s[40:41], 1, v10
    s_lshr_b32 s17, s17, 2
    s_or_b32 s45, s40, s41
    s_lshr_b32 s40, s45, 1
    s_or_b32 s45, s45, s40
    s_lshr_b32 s40, s45, 2
    s_or_b32 s45, s45, s40
    s_andn2_b32 s47, s17, s45
    s_cmp_gt_u32 s58, 400000
    s_cselect_b32 s47, -1, s47
    s_and_b32 s47, s47, s46
    s_cbranch_scc0 F_GS0
    s_and_b32 s45, s46, s47
    s_cselect_b32 s66, s38, 0
    s_ff1_i32_b32 s50, s45
    s_bitset0_b32 s46, s50
    s_lshl_b32 s52, s50, 10
    s_add_u32 s52, s52, s55
    buffer_load_dwordx4 v[80:83], v1, s[36:39], s52 offen offset:0 sc1
    buffer_load_dwordx4 v[84:87], v6, s[36:39], s52 offen offset:0 sc1
    buffer_load_dwordx4 v[88:91], v1, s[36:39], s52 offen offset:1024 sc1
    buffer_load_dwordx4 v[92:95], v6, s[36:39], s52 offen offset:1024 sc1
    buffer_load_dwordx4 v[96:99], v1, s[36:39], s52 offen offset:2048 sc1
    buffer_load_dwordx4 v[100:103], v6, s[36:39], s52 offen offset:2048 sc1
    buffer_load_dwordx4 v[104:107], v1, s[36:39], s52 offen offset:3072 sc1
    buffer_load_dwordx4 v[108:111], v6, s[36:39], s52 offen offset:3072 sc1
    s_cmp_eq_u32 s18, 0
    s_cbranch_scc1 F_GU
    s_waitcnt vmcnt(8)
    s_atomic_add s16, s[12:13], 0
    s_mov_b32 s18, 0
F_GU:
    s_lshr_b32 s48, s54, s50
    s_and_b32 s48, s48, 15
    s_lshl_b32 s48, s48, 14
    v_add_u32 v2, s48, v207
    v_xor_b32 v3, 32, v2
    v_xor_b32 v4, 64, v2
    v_xor_b32 v5, 96, v2
    ds_read_b64_tr_b16 v[48:49], v2 offset:0
    ds_read_b64_tr_b16 v[50:51], v2 offset:2048
    ds_read_b64_tr_b16 v[52:53], v3 offset:0
    ds_read_b64_tr_b16 v[54:55], v3 offset:2048
    ds_read_b64_tr_b16 v[56:57], v4 offset:0
    ds_read_b64_tr_b16 v[58:59], v4 offset:2048
    ds_read_b64_tr_b16 v[60:61], v5 offset:0
    ds_read_b64_tr_b16 v[62:63], v5 offset:2048
    s_cmp_lt_i32 s51, 0
    s_cbranch_scc0 F_GN0
    s_and_b32 s45, s46, s47
    s_cselect_b32 s66, s38, 0
    s_ff1_i32_b32 s51, s45
    s_bitset0_b32 s46, s51
    s_lshl_b32 s53, s51, 10
    s_add_u32 s53, s53, s55
    buffer_load_dwordx4 v[112:115], v1, s[64:67], s53 offen offset:0 sc1
    buffer_load_dwordx4 v[116:119], v6, s[64:67], s53 offen offset:0 sc1
    buffer_load_dwordx4 v[120:123], v1, s[64:67], s53 offen offset:1024 sc1
    buffer_load_dwordx4 v[124:127], v6, s[64:67], s53 offen offset:1024 sc1
    buffer_load_dwordx4 v[128:131], v1, s[64:67], s53 offen offset:2048 sc1
    buffer_load_dwordx4 v[132:135], v6, s[64:67], s53 offen offset:2048 sc1
    buffer_load_dwordx4 v[136:139], v1, s[64:67], s53 offen offset:3072 sc1
    buffer_load_dwordx4 v[140:143], v6, s[64:67], s53 offen offset:3072 sc1
    s_waitcnt vmcnt(8)
    s_branch F_GC0
F_GN0:
    s_waitcnt vmcnt(0)
    s_branch F_GC0
F_GP1:
    s_cmp_eq_u32 s46, 0
    s_cbranch_scc1 F_GQ1
    s_cmp_lt_i32 s50, 0
    s_cbranch_scc1 F_GQ1
    s_mov_b32 s17, 0
    s_atomic_add s17, s[14:15], 0 glc
    ds_read_b32 v10, v211
    s_waitcnt lgkmcnt(0)
    v_cmp_ne_u32 s[40:41], 1, v10
    s_lshr_b32 s17, s17, 2
    s_or_b32 s45, s40, s41
    s_lshr_b32 s40, s45, 1
    s_or_b32 s45, s45, s40
    s_lshr_b32 s40, s45, 2
    s_or_b32 s45, s45, s40
    s_andn2_b32 s47, s17, s45
    s_cmp_gt_u32 s58, 400000
    s_cselect_b32 s47, -1, s47
    s_and_b32 s47, s47, s46
    s_branch F_GQ1
F_GS1:
    s_cmp_eq_u32 s18, 0
    s_cbranch_scc1 F_GT1
    s_waitcnt vmcnt(0)
    s_atomic_add s16, s[12:13], 0
    s_mov_b32 s18, 0
F_GT1:
    s_sleep 6
F_GE1:
    s_add_u32 s58, s58, 1
    s_mov_b32 s17, 0
    s_atomic_add s17, s[14:15], 0 glc
    ds_read_b32 v10, v211
F_GR1:
    s_waitcnt lgkmcnt(0)
    v_cmp_ne_u32 s[40:41], 1, v10
    s_lshr_b32 s17, s17, 2
    s_or_b32 s45, s40, s41
    s_lshr_b32 s40, s45, 1
    s_or_b32 s45, s45, s40
    s_lshr_b32 s40, s45, 2
    s_or_b32 s45, s45, s40
    s_andn2_b32 s47, s17, s45
    s_cmp_gt_u32 s58, 400000
    s_cselect_b32 s47, -1, s47
    s_and_b32 s47, s47, s46
    s_cbranch_scc0 F_GS1
    s_and_b32 s45, s46, s47
    s_cselect_b32 s66, s38, 0
    s_ff1_i32_b32 s51, s45
    s_bitset0_b32 s46, s51
    s_lshl_b32 s53, s51, 10
    s_add_u32 s53, s53, s55
    buffer_load_dwordx4 v[112:115], v1, s[36:39], s53 offen offset:0 sc1
    buffer_load_dwordx4 v[116:119], v6, s[36:39], s53 offen offset:0 sc1
    buffer_load_dwordx4 v[120:123], v1, s[36:39], s53 offen offset:1024 sc1
    buffer_load_dwordx4 v[124:127], v6, s[36:39], s53 offen offset:1024 sc1
    buffer_load_dwordx4 v[128:131], v1, s[36:39], s53 offen offset:2048 sc1
    buffer_load_dwordx4 v[132:135], v6, s[36:39], s53 offen offset:2048 sc1
    buffer_load_dwordx4 v[136:139], v1, s[36:39], s53 offen offset:3072 sc1
    buffer_load_dwordx4 v[140:143], v6, s[36:39], s53 offen offset:3072 sc1
    s_lshr_b32 s48, s54, s51
    s_and_b32 s48, s48, 15
    s_lshl_b32 s48, s48, 14
    v_add_u32 v2, s48, v207
    v_xor_b32 v3, 32, v2
    v_xor_b32 v4, 64, v2
    v_xor_b32 v5, 96, v2
    ds_read_b64_tr_b16 v[48:49], v2 offset:0
    ds_read_b64_tr_b16 v[50:51], v2 offset:2048
    ds_read_b64_tr_b16 v[52:53], v3 offset:0
    ds_read_b64_tr_b16 v[54:55], v3 offset:2048
    ds_read_b64_tr_b16 v[56:57], v4 offset:0
    ds_read_b64_tr_b16 v[58:59], v4 offset:2048
    ds_read_b64_tr_b16 v[60:61], v5 offset:0
    ds_read_b64_tr_b16 v[62:63], v5 offset:2048
    s_cmp_lt_i32 s50, 0
    s_cbranch_scc0 F_GN1
    s_and_b32 s45, s46, s47
    s_cselect_b32 s66, s38, 0
    s_ff1_i32_b32 s50, s45
    s_bitset0_b32 s46, s50
    s_lshl_b32 s52, s50, 10
    s_add_u32 s52, s52, s55
    buffer_load_dwordx4 v[80:83], v1, s[64:67], s52 offen offset:0 sc1
    buffer_load_dwordx4 v[84:87], v6, s[64:67], s52 offen offset:0 sc1
    buffer_load_dwordx4 v[88:91], v1, s[64:67], s52 offen offset:1024 sc1
    buffer_load_dwordx4 v[92:95], v6, s[64:67], s52 offen offset:1024 sc1
    buffer_load_dwordx4 v[96:99], v1, s[64:67], s52 offen offset:2048 sc1
    buffer_load_dwordx4 v[100:103], v6, s[64:67], s52 offen offset:2048 sc1
    buffer_load_dwordx4 v[104:107], v1, s[64:67], s52 offen offset:3072 sc1
    buffer_load_dwordx4 v[108:111], v6, s[64:67], s52 offen offset:3072 sc1
    s_waitcnt vmcnt(8)
    s_branch F_GC1
F_GN1:
    s_waitcnt vmcnt(0)
    s_branch F_GC1
F_END:
    s_endpgm

.section .rodata,"a"
.p2align 6
.amdhsa_kernel concat_heads__linear_attn_block__ssm_conv_h3__prompt_kernel
  .amdhsa_next_free_vgpr 256
  .amdhsa_next_free_sgpr 102
  .amdhsa_accum_offset 256
  .amdhsa_group_segment_fixed_size 0
  .amdhsa_kernarg_size 96
  .amdhsa_user_sgpr_count 2
  .amdhsa_user_sgpr_kernarg_segment_ptr 1
  .amdhsa_system_sgpr_workgroup_id_x 1
  .amdhsa_float_denorm_mode_32 3
  .amdhsa_float_denorm_mode_16_64 3
.end_amdhsa_kernel
```

```asm
; @launch grid=(256,1,1) block=(512,1,1) lds=163840
.amdgcn_target "amdgcn-amd-amdhsa--gfx950"
.text
.globl concat_heads__linear_attn_block__ssm_conv_h3__prompt_kernel
.p2align 8
.type concat_heads__linear_attn_block__ssm_conv_h3__prompt_kernel,@function
concat_heads__linear_attn_block__ssm_conv_h3__prompt_kernel:
    s_load_dwordx16 s[4:19], s[0:1], 0
    s_cmp_ge_u32 s2, 256
    s_cbranch_scc1 F_END
    v_lshrrev_b32 v1, 6, v0
    v_and_b32 v0, 63, v0
    s_and_b32 s28, s2, 7
    s_lshr_b32 s29, s2, 3
    v_readfirstlane_b32 s3, v1
    s_and_b32 s30, s28, 1
    s_lshl_b32 s30, s30, 3
    s_and_b32 s31, s29, 7
    s_add_u32 s30, s30, s31
    s_lshr_b32 s31, s28, 1
    s_lshl_b32 s31, s31, 2
    s_lshr_b32 s32, s29, 3
    s_add_u32 s31, s31, s32
    s_lshr_b32 s30, s29, 1
    s_and_b32 s31, s29, 1
    s_lshl_b32 s32, s28, 1
    s_add_u32 s31, s31, s32
    s_cmp_lt_u32 s3, 4
    s_cbranch_scc1 F_C
    s_sub_u32 s34, s3, 4
    v_lshrrev_b32 v2, 3, v0
    v_and_b32 v4, 7, v0
    s_getpc_b64 s[66:67]
F_PC:
    s_lshl_b32 s40, s29, 10
    s_lshl_b32 s41, s34, 8
    s_add_u32 s40, s40, s41
    v_and_b32 v7, 1, v0
    v_lshlrev_b32 v7, 7, v7
    v_add_u32 v7, s40, v7
    v_min_u32 v7, F_END-F_PC, v7
    global_load_dword v250, v7, s[66:67]
    v_lshlrev_b32 v8, 11, v4
    v_and_b32 v9, 15, v0
    v_min_u32 v9, 11, v9
    v_lshrrev_b32 v7, 2, v9
    v_and_b32 v9, 3, v9
    v_lshlrev_b32 v9, 7, v9
    v_lshl_add_u32 v9, v7, 11, v9
    s_and_b32 s100, s28, 1
    s_lshr_b32 s101, s28, 1
    s_lshl_b32 s40, s100, 21
    s_lshl_b32 s41, s101, 19
    s_add_u32 s99, s40, s41
    s_lshl_b32 s40, s29, 14
    s_lshl_b32 s41, s34, 7
    s_add_u32 s42, s40, s41
    s_add_u32 s42, s42, s99
    s_mul_i32 s98, s100, 6144
    s_lshl_b32 s41, s101, 9
    s_add_u32 s98, s98, s41
    s_lshl_b32 s43, s29, 2
    s_add_u32 s43, s43, s34
    s_mul_i32 s43, s43, 12288
    s_add_u32 s43, s43, s98
    v_min_u32 v9, 5, v4
    v_lshrrev_b32 v7, 1, v9
    v_and_b32 v9, 1, v9
    v_lshlrev_b32 v9, 7, v9
    v_lshl_add_u32 v19, v7, 11, v9
    v_and_b32 v7, 1, v2
    v_mul_u32_u24 v7, 6144, v7
    v_add_u32 v9, v19, v7
    s_lshl_b32 s98, s28, 8
    s_lshl_b32 s43, s29, 2
    s_add_u32 s43, s43, s34
    s_mul_i32 s43, s43, 12288
    s_add_u32 s43, s43, s98
    s_mov_b32 s46, 0x400000
    s_mov_b32 s47, 0x00020000
    s_mov_b32 s50, 0x600000
    s_mov_b32 s51, 0x00020000
    s_lshl_b32 s40, s34, 3
    v_add_u32 v3, s40, v2
    v_lshrrev_b32 v5, 4, v0
    s_and_b32 s40, s34, 1
    s_lshl_b32 s41, s40, 2
    v_add_u32 v6, s41, v5
    v_xor_b32 v6, v6, v4
    v_lshlrev_b32 v6, 4, v6
    v_lshl_add_u32 v10, v3, 11, v6
    v_and_b32 v6, 1, v5
    v_lshlrev_b32 v6, 1, v6
    v_or_b32 v6, s41, v6
    v_xor_b32 v6, v6, v4
    v_lshlrev_b32 v6, 4, v6
    v_mul_u32_u24 v11, 6144, v3
    v_add_u32 v11, v11, v6
    s_lshl_b32 s52, s30, 18
    s_add_u32 s53, s52, 64512
    s_add_u32 s54, s52, 129024
    s_add_u32 s55, s52, 193536
    s_lshl_b32 s56, s31, 7
    s_add_u32 s57, s56, 1024
    s_add_u32 s58, s56, 2048
    s_add_u32 s59, s56, 193536
    s_add_u32 s60, s56, 198656
    s_add_u32 s61, s56, 199680
    s_mul_i32 s62, s34, 10240
    s_mov_b32 s63, 393216
    s_waitcnt lgkmcnt(0)
    s_mov_b64 s[44:45], s[4:5]
    s_mov_b64 s[48:49], s[6:7]
    buffer_load_dword v250, v9, s[48:51], s43 offen
    buffer_load_dword v250, v8, s[44:47], s42 offen
    s_add_u32 m0, s62, 45056
    s_nop 0
    buffer_load_dwordx4 v11, s[48:51], s57 offen offset:1024 lds
    buffer_load_dwordx4 v11, s[48:51], s58 offen offset:2048 lds
    buffer_load_dwordx4 v11, s[48:51], s56 offen offset:0 lds
    buffer_load_dwordx4 v11, s[48:51], s59 offen offset:3072 lds
    s_add_u32 m0, s62, 40960
    s_nop 0
    buffer_load_dwordx4 v10, s[44:47], s52 offen offset:0 lds
    buffer_load_dwordx4 v10, s[44:47], s53 offen offset:1024 lds
    buffer_load_dwordx4 v10, s[44:47], s54 offen offset:2048 lds
    buffer_load_dwordx4 v10, s[44:47], s55 offen offset:3072 lds
    s_add_u32 m0, s62, 49152
    s_nop 0
    buffer_load_dwordx4 v11, s[48:51], s60 offen offset:0 lds
    buffer_load_dwordx4 v11, s[48:51], s61 offen offset:1024 lds
    v_add_u32 v10, 128, v10
    v_add_u32 v11, s63, v11
    s_add_u32 m0, s62, 86016
    s_nop 0
    buffer_load_dwordx4 v11, s[48:51], s57 offen offset:1024 lds
    buffer_load_dwordx4 v11, s[48:51], s58 offen offset:2048 lds
    buffer_load_dwordx4 v11, s[48:51], s56 offen offset:0 lds
    buffer_load_dwordx4 v11, s[48:51], s59 offen offset:3072 lds
    s_add_u32 m0, s62, 81920
    s_nop 0
    buffer_load_dwordx4 v10, s[44:47], s52 offen offset:0 lds
    buffer_load_dwordx4 v10, s[44:47], s53 offen offset:1024 lds
    buffer_load_dwordx4 v10, s[44:47], s54 offen offset:2048 lds
    buffer_load_dwordx4 v10, s[44:47], s55 offen offset:3072 lds
    s_add_u32 m0, s62, 90112
    s_nop 0
    buffer_load_dwordx4 v11, s[48:51], s60 offen offset:0 lds
    buffer_load_dwordx4 v11, s[48:51], s61 offen offset:1024 lds
    v_add_u32 v10, 128, v10
    v_add_u32 v11, s63, v11
    s_load_dwordx8 s[20:27], s[0:1], 64
    s_and_b32 s32, s29, 3
    s_lshr_b32 s33, s28, 1
    s_lshl_b32 s33, s33, 2
    s_add_u32 s32, s32, s33
    s_and_b32 s33, s28, 1
    s_lshl_b32 s33, s33, 3
    s_lshr_b32 s35, s29, 2
    s_add_u32 s33, s33, s35
    v_lshlrev_b32 v1, 4, v0
    v_lshlrev_b32 v6, 1, v5
    v_xor_b32 v6, v6, v4
    v_lshlrev_b32 v6, 4, v6
    v_lshl_add_u32 v12, v2, 11, v6
    v_mov_b32 v13, 0
    s_lshr_b32 s35, s29, 4
    s_lshl_b32 s35, s35, 3
    s_add_u32 s35, s35, s28
    s_lshl_b32 s35, s35, 4
    s_and_b32 s40, s29, 15
    s_add_u32 s35, s35, s40
    s_mov_b32 s35, s2
    s_lshl_b32 s35, s35, 2
    s_add_u32 s35, s35, s34
    s_and_b32 s96, s29, 3
    s_waitcnt lgkmcnt(0)
    s_mov_b32 s36, s26
    s_mov_b32 s37, s27
    s_mov_b32 s38, 0x10000000
    s_mov_b32 s39, 0x00020000
    s_mov_b32 s64, s24
    s_mov_b32 s65, s25
    s_mov_b32 s66, 0x100
    s_mov_b32 s67, 0x00020000
    s_lshr_b32 s69, s29, 2
    s_mul_i32 s40, s96, 3
    s_add_u32 s40, s40, 4
    s_add_u32 s41, s40, s34
    s_lshl_b32 s41, s41, 7
    s_add_u32 s99, s99, s41
    s_lshl_b32 s41, s69, 16
    s_add_u32 s99, s99, s41
    s_lshl_b32 s40, s40, 5
    s_mul_i32 s41, s69, 12
    s_add_u32 s40, s40, s41
    s_lshl_b32 s41, s34, 2
    s_add_u32 s40, s40, s41
    s_mul_i32 s40, s40, 12288
    s_add_u32 s98, s98, s40
    s_lshl_b32 s100, s100, 10
    s_lshl_b32 s101, s101, 19
    s_add_u32 s100, s100, s101
    s_lshl_b32 s41, s29, 14
    s_add_u32 s100, s100, s41
    v_and_b32 v16, 31, v0
    v_lshlrev_b32 v16, 11, v16
    v_mul_u32_u24 v17, 6144, v2
    v_add_u32 v17, v17, v19
    v_lshlrev_b32 v18, 7, v4
    v_lshl_add_u32 v18, v2, 11, v18
    s_cmp_lg_u32 s96, 0
    s_cbranch_scc1 F_PF0X
    s_cmp_eq_u32 s34, 3
    s_cbranch_scc1 F_PF0X
    buffer_load_dword v250, v17, s[48:51], s98 offen
    buffer_load_dword v250, v16, s[44:47], s99 offen
F_PF0X:
    s_cmp_lg_u32 s96, 0
    s_cbranch_scc1 F_PW0X
    s_cmp_lg_u32 s34, 3
    s_cbranch_scc1 F_PW0X
    s_mov_b32 s40, s8
    s_mov_b32 s41, s9
    s_mov_b32 s42, 0x200000
    s_mov_b32 s43, 0x00020000
    buffer_load_dword v250, v18, s[40:43], s100 offen
F_PW0X:
    s_lshl_b32 s40, s34, 1
    v_xor_b32 v20, s40, v4
    v_lshlrev_b32 v20, 4, v20
    v_lshl_add_u32 v20, v2, 11, v20
    s_lshr_b32 s40, s2, 4
    s_lshl_b32 s40, s40, 18
    s_and_b32 s41, s2, 15
    s_lshl_b32 s41, s41, 7
    s_add_u32 s40, s40, s41
    v_xor_b32 v21, 6, v4
    v_lshlrev_b32 v21, 4, v21
    v_lshl_add_u32 v21, v2, 11, v21
    v_add_u32 v21, s40, v21
    v_subrev_u32 v21, 6144, v21
    s_lshl_b32 s41, s34, 15
    s_add_u32 s40, s40, s41
    v_add_u32 v20, s40, v20
    v_and_b32 v22, 3, v2
    v_xor_b32 v22, s34, v22
    v_lshlrev_b32 v22, 5, v22
    v_lshl_add_u32 v22, v4, 2, v22
    v_lshl_add_u32 v22, v2, 11, v22
    v_add_u32 v22, 123264, v22
    v_add_u32 v23, 3, v2
    v_and_b32 v23, 3, v23
    v_xor_b32 v23, s34, v23
    v_lshlrev_b32 v23, 5, v23
    v_lshl_add_u32 v23, v4, 2, v23
    v_lshl_add_u32 v23, v2, 11, v23
    v_add_u32 v23, 122880, v23
    s_and_b32 s40, s2, 15
    s_lshl_b32 s40, s40, 6
    s_lshl_b32 s41, s34, 4
    s_add_u32 s40, s40, s41
    v_lshlrev_b32 v24, 1, v4
    v_add_u32 v24, s40, v24
    v_mul_u32_u24 v25, 4224, v24
    v_lshlrev_b32 v24, 3, v24
    s_lshr_b32 s40, s2, 4
    s_lshl_b32 s40, s40, 3
    v_add_u32 v26, s40, v2
    v_lshl_add_u32 v25, v26, 4, v25
    s_lshr_b32 s40, s2, 4
    s_lshl_b32 s40, s40, 4
    s_lshl_b32 s41, s34, 3
    s_add_u32 s40, s40, s41
    v_add_u32 v28, s40, v2
    v_mul_u32_u24 v232, 33792, v4
    v_lshl_add_u32 v232, v28, 4, v232
    v_lshrrev_b32 v29, 6, v28
    v_lshlrev_b32 v29, 9, v29
    v_and_b32 v30, 15, v28
    v_lshl_add_u32 v29, v30, 4, v29
    v_bfe_u32 v30, v28, 4, 2
    v_lshl_add_u32 v29, v30, 2, v29
    v_lshlrev_b32 v30, 4, v4
    v_lshl_add_u32 v234, v29, 11, v30
    v_lshl_add_u32 v233, v29, 12, v30
    s_waitcnt vmcnt(10)
    s_barrier
    s_add_u32 m0, s62, 4096
    s_nop 0
    buffer_load_dwordx4 v11, s[48:51], s57 offen offset:1024 lds
    buffer_load_dwordx4 v11, s[48:51], s58 offen offset:2048 lds
    buffer_load_dwordx4 v11, s[48:51], s56 offen offset:0 lds
    buffer_load_dwordx4 v11, s[48:51], s59 offen offset:3072 lds
    s_cmp_lg_u32 s96, 1
    s_cbranch_scc1 F_PF1X
    s_cmp_eq_u32 s34, 3
    s_cbranch_scc1 F_PF1X
    buffer_load_dword v250, v17, s[48:51], s98 offen
    buffer_load_dword v250, v16, s[44:47], s99 offen
F_PF1X:
    s_add_u32 m0, s62, 0
    s_nop 0
    buffer_load_dwordx4 v10, s[44:47], s52 offen offset:0 lds
    buffer_load_dwordx4 v10, s[44:47], s53 offen offset:1024 lds
    buffer_load_dwordx4 v10, s[44:47], s54 offen offset:2048 lds
    buffer_load_dwordx4 v10, s[44:47], s55 offen offset:3072 lds
    s_cmp_lg_u32 s96, 1
    s_cbranch_scc1 F_PW1X
    s_cmp_lg_u32 s34, 3
    s_cbranch_scc1 F_PW1X
    s_mov_b32 s40, s8
    s_mov_b32 s41, s9
    s_mov_b32 s42, 0x200000
    s_mov_b32 s43, 0x00020000
    buffer_load_dword v250, v18, s[40:43], s100 offen
F_PW1X:
    s_add_u32 m0, s62, 8192
    s_nop 0
    buffer_load_dwordx4 v11, s[48:51], s60 offen offset:0 lds
    buffer_load_dwordx4 v11, s[48:51], s61 offen offset:1024 lds
    v_add_u32 v10, 128, v10
    v_add_u32 v11, s63, v11
    s_cmp_lg_u32 s96, 2
    s_cbranch_scc1 F_KV2X
    s_lshl_b32 s69, s34, 11
    s_mov_b32 s40, s12
    s_mov_b32 s41, s13
    s_mov_b32 s42, 0x400000
    s_mov_b32 s43, 0x00020000
    s_mov_b32 m0, 122880
    s_mov_b64 exec, 0xffffff
    buffer_load_dwordx4 v21, s[40:43], 0 offen nt lds
    s_mov_b64 exec, -1
    s_add_u32 m0, s69, 123264
    s_mov_b32 s97, 0
    buffer_load_dwordx4 v20, s[40:43], s97 offen nt lds
    s_mov_b32 s97, 15360
    buffer_load_dwordx4 v20, s[40:43], s97 offen offset:1024 nt lds
    s_add_u32 m0, s69, 131456
    s_mov_b32 s97, 131072
    buffer_load_dwordx4 v20, s[40:43], s97 offen nt lds
    s_mov_b32 s97, 146432
    buffer_load_dwordx4 v20, s[40:43], s97 offen offset:1024 nt lds
    s_mov_b32 s40, s14
    s_mov_b32 s41, s15
    s_mov_b32 s42, 0x400000
    s_mov_b32 s43, 0x00020000
    s_add_u32 m0, s69, 139648
    s_mov_b32 s97, 0
    buffer_load_dwordx4 v20, s[40:43], s97 offen nt lds
    s_mov_b32 s97, 15360
    buffer_load_dwordx4 v20, s[40:43], s97 offen offset:1024 nt lds
    s_add_u32 m0, s69, 147840
    s_mov_b32 s97, 131072
    buffer_load_dwordx4 v20, s[40:43], s97 offen nt lds
    s_mov_b32 s97, 146432
    buffer_load_dwordx4 v20, s[40:43], s97 offen offset:1024 nt lds
    s_mov_b32 s40, s16
    s_mov_b32 s41, s17
    s_mov_b32 s42, 0x2000
    s_mov_b32 s43, 0x00020000
    buffer_load_dwordx4 v[32:35], v24, s[40:43], 0 offen
F_KV2X:
    s_waitcnt vmcnt(10)
    s_barrier
    s_add_u32 m0, s62, 45056
    s_nop 0
    buffer_load_dwordx4 v11, s[48:51], s57 offen offset:1024 lds
    s_mov_b32 s7, 0xffff0000
    buffer_load_dwordx4 v11, s[48:51], s58 offen offset:2048 lds
    buffer_load_dwordx4 v11, s[48:51], s56 offen offset:0 lds
    buffer_load_dwordx4 v11, s[48:51], s59 offen offset:3072 lds
    s_add_u32 m0, s62, 40960
    s_nop 0
    buffer_load_dwordx4 v10, s[44:47], s52 offen offset:0 lds
    buffer_load_dwordx4 v10, s[44:47], s53 offen offset:1024 lds
    buffer_load_dwordx4 v10, s[44:47], s54 offen offset:2048 lds
    buffer_load_dwordx4 v10, s[44:47], s55 offen offset:3072 lds
    s_add_u32 m0, s62, 49152
    s_nop 0
    buffer_load_dwordx4 v11, s[48:51], s60 offen offset:0 lds
    buffer_load_dwordx4 v11, s[48:51], s61 offen offset:1024 lds
    s_cmp_lg_u32 s96, 0
    s_cbranch_scc1 F_KV0X
    s_lshl_b32 s69, s34, 11
    s_mov_b32 s40, s12
    s_mov_b32 s41, s13
    s_mov_b32 s42, 0x400000
    s_mov_b32 s43, 0x00020000
    s_mov_b32 m0, 122880
    s_mov_b64 exec, 0xffffff
    buffer_load_dwordx4 v21, s[40:43], 0 offen nt lds
    s_mov_b64 exec, -1
    s_add_u32 m0, s69, 123264
    s_mov_b32 s97, 0
    buffer_load_dwordx4 v20, s[40:43], s97 offen nt lds
    s_mov_b32 s97, 15360
    buffer_load_dwordx4 v20, s[40:43], s97 offen offset:1024 nt lds
    s_add_u32 m0, s69, 131456
    s_mov_b32 s97, 131072
    buffer_load_dwordx4 v20, s[40:43], s97 offen nt lds
    s_mov_b32 s97, 146432
    buffer_load_dwordx4 v20, s[40:43], s97 offen offset:1024 nt lds
    s_mov_b32 s40, s14
    s_mov_b32 s41, s15
    s_mov_b32 s42, 0x400000
    s_mov_b32 s43, 0x00020000
    s_add_u32 m0, s69, 139648
    s_mov_b32 s97, 0
    buffer_load_dwordx4 v20, s[40:43], s97 offen nt lds
    s_mov_b32 s97, 15360
    buffer_load_dwordx4 v20, s[40:43], s97 offen offset:1024 nt lds
    s_add_u32 m0, s69, 147840
    s_mov_b32 s97, 131072
    buffer_load_dwordx4 v20, s[40:43], s97 offen nt lds
    s_mov_b32 s97, 146432
    buffer_load_dwordx4 v20, s[40:43], s97 offen offset:1024 nt lds
    s_mov_b32 s40, s16
    s_mov_b32 s41, s17
    s_mov_b32 s42, 0x2000
    s_mov_b32 s43, 0x00020000
    buffer_load_dwordx4 v[32:35], v24, s[40:43], 0 offen
F_KV0X:
    v_add_u32 v10, 128, v10
    v_add_u32 v11, s63, v11
    s_waitcnt vmcnt(10)
    s_barrier
    s_add_u32 m0, s62, 86016
    s_nop 0
    buffer_load_dwordx4 v11, s[48:51], s57 offen offset:1024 lds
    buffer_load_dwordx4 v11, s[48:51], s58 offen offset:2048 lds
    buffer_load_dwordx4 v11, s[48:51], s56 offen offset:0 lds
    buffer_load_dwordx4 v11, s[48:51], s59 offen offset:3072 lds
    s_add_u32 m0, s62, 81920
    s_nop 0
    buffer_load_dwordx4 v10, s[44:47], s52 offen offset:0 lds
    buffer_load_dwordx4 v10, s[44:47], s53 offen offset:1024 lds
    buffer_load_dwordx4 v10, s[44:47], s54 offen offset:2048 lds
    buffer_load_dwordx4 v10, s[44:47], s55 offen offset:3072 lds
    s_add_u32 m0, s62, 90112
    s_nop 0
    buffer_load_dwordx4 v11, s[48:51], s60 offen offset:0 lds
    buffer_load_dwordx4 v11, s[48:51], s61 offen offset:1024 lds
    s_cmp_lg_u32 s96, 1
    s_cbranch_scc1 F_KV1X
    s_lshl_b32 s69, s34, 11
    s_mov_b32 s40, s12
    s_mov_b32 s41, s13
    s_mov_b32 s42, 0x400000
    s_mov_b32 s43, 0x00020000
    s_mov_b32 m0, 122880
    s_mov_b64 exec, 0xffffff
    buffer_load_dwordx4 v21, s[40:43], 0 offen nt lds
    s_mov_b64 exec, -1
    s_add_u32 m0, s69, 123264
    s_mov_b32 s97, 0
    buffer_load_dwordx4 v20, s[40:43], s97 offen nt lds
    s_mov_b32 s97, 15360
    buffer_load_dwordx4 v20, s[40:43], s97 offen offset:1024 nt lds
    s_add_u32 m0, s69, 131456
    s_mov_b32 s97, 131072
    buffer_load_dwordx4 v20, s[40:43], s97 offen nt lds
    s_mov_b32 s97, 146432
    buffer_load_dwordx4 v20, s[40:43], s97 offen offset:1024 nt lds
    s_mov_b32 s40, s14
    s_mov_b32 s41, s15
    s_mov_b32 s42, 0x400000
    s_mov_b32 s43, 0x00020000
    s_add_u32 m0, s69, 139648
    s_mov_b32 s97, 0
    buffer_load_dwordx4 v20, s[40:43], s97 offen nt lds
    s_mov_b32 s97, 15360
    buffer_load_dwordx4 v20, s[40:43], s97 offen offset:1024 nt lds
    s_add_u32 m0, s69, 147840
    s_mov_b32 s97, 131072
    buffer_load_dwordx4 v20, s[40:43], s97 offen nt lds
    s_mov_b32 s97, 146432
    buffer_load_dwordx4 v20, s[40:43], s97 offen offset:1024 nt lds
    s_mov_b32 s40, s16
    s_mov_b32 s41, s17
    s_mov_b32 s42, 0x2000
    s_mov_b32 s43, 0x00020000
    buffer_load_dwordx4 v[32:35], v24, s[40:43], 0 offen
F_KV1X:
    v_add_u32 v10, 128, v10
    v_add_u32 v11, s63, v11
    s_cmp_lg_u32 s96, 3
    s_cbranch_scc1 F_KV3X
    s_lshl_b32 s69, s34, 11
    s_mov_b32 s40, s12
    s_mov_b32 s41, s13
    s_mov_b32 s42, 0x400000
    s_mov_b32 s43, 0x00020000
    s_mov_b32 m0, 122880
    s_mov_b64 exec, 0xffffff
    buffer_load_dwordx4 v21, s[40:43], 0 offen nt lds
    s_mov_b64 exec, -1
    s_add_u32 m0, s69, 123264
    s_mov_b32 s97, 0
    buffer_load_dwordx4 v20, s[40:43], s97 offen nt lds
    s_mov_b32 s97, 15360
    buffer_load_dwordx4 v20, s[40:43], s97 offen offset:1024 nt lds
    s_add_u32 m0, s69, 131456
    s_mov_b32 s97, 131072
    buffer_load_dwordx4 v20, s[40:43], s97 offen nt lds
    s_mov_b32 s97, 146432
    buffer_load_dwordx4 v20, s[40:43], s97 offen offset:1024 nt lds
    s_mov_b32 s40, s14
    s_mov_b32 s41, s15
    s_mov_b32 s42, 0x400000
    s_mov_b32 s43, 0x00020000
    s_add_u32 m0, s69, 139648
    s_mov_b32 s97, 0
    buffer_load_dwordx4 v20, s[40:43], s97 offen nt lds
    s_mov_b32 s97, 15360
    buffer_load_dwordx4 v20, s[40:43], s97 offen offset:1024 nt lds
    s_add_u32 m0, s69, 147840
    s_mov_b32 s97, 131072
    buffer_load_dwordx4 v20, s[40:43], s97 offen nt lds
    s_mov_b32 s97, 146432
    buffer_load_dwordx4 v20, s[40:43], s97 offen offset:1024 nt lds
    s_mov_b32 s40, s16
    s_mov_b32 s41, s17
    s_mov_b32 s42, 0x2000
    s_mov_b32 s43, 0x00020000
    buffer_load_dwordx4 v[32:35], v24, s[40:43], 0 offen
F_KV3X:
    s_waitcnt vmcnt(10)
    s_barrier
    s_add_u32 m0, s62, 4096
    s_nop 0
    buffer_load_dwordx4 v11, s[48:51], s57 offen offset:1024 lds
    v_mov_b32 v44, 0
    v_mov_b32 v45, 0
    v_mov_b32 v46, 0
    v_mov_b32 v47, 0
    buffer_load_dwordx4 v11, s[48:51], s58 offen offset:2048 lds
    v_mov_b32 v48, 0
    v_mov_b32 v49, 0
    v_mov_b32 v50, 0
    v_mov_b32 v51, 0
    buffer_load_dwordx4 v11, s[48:51], s56 offen offset:0 lds
    v_mov_b32 v52, 0
    v_mov_b32 v53, 0
    v_mov_b32 v54, 0
    v_mov_b32 v55, 0
    buffer_load_dwordx4 v11, s[48:51], s59 offen offset:3072 lds
    v_mov_b32 v56, 0
    v_mov_b32 v57, 0
    v_mov_b32 v58, 0
    v_mov_b32 v59, 0
    s_add_u32 m0, s62, 0
    s_nop 0
    buffer_load_dwordx4 v10, s[44:47], s52 offen offset:0 lds
    v_mov_b32 v60, 0
    v_mov_b32 v61, 0
    v_mov_b32 v62, 0
    v_mov_b32 v63, 0
    buffer_load_dwordx4 v10, s[44:47], s53 offen offset:1024 lds
    v_mov_b32 v64, 0
    v_mov_b32 v65, 0
    v_mov_b32 v66, 0
    v_mov_b32 v67, 0
    buffer_load_dwordx4 v10, s[44:47], s54 offen offset:2048 lds
    v_mov_b32 v68, 0
    v_mov_b32 v69, 0
    v_mov_b32 v70, 0
    v_mov_b32 v71, 0
    buffer_load_dwordx4 v10, s[44:47], s55 offen offset:3072 lds
    v_mov_b32 v72, 0
    v_mov_b32 v73, 0
    v_mov_b32 v74, 0
    v_mov_b32 v75, 0
    s_add_u32 m0, s62, 8192
    s_nop 0
    buffer_load_dwordx4 v11, s[48:51], s60 offen offset:0 lds
    v_mov_b32 v76, 0
    v_mov_b32 v77, 0
    v_mov_b32 v78, 0
    v_mov_b32 v79, 0
    buffer_load_dwordx4 v11, s[48:51], s61 offen offset:1024 lds
    v_add_u32 v10, 128, v10
    v_add_u32 v11, s63, v11
    s_waitcnt vmcnt(10)
    s_barrier
    s_add_u32 m0, s62, 45056
    s_nop 0
    buffer_load_dwordx4 v11, s[48:51], s57 offen offset:1024 lds
    buffer_load_dwordx4 v11, s[48:51], s58 offen offset:2048 lds
    buffer_load_dwordx4 v11, s[48:51], s56 offen offset:0 lds
    buffer_load_dwordx4 v11, s[48:51], s59 offen offset:3072 lds
    s_cmp_lg_u32 s96, 2
    s_cbranch_scc1 F_PF2X
    s_cmp_eq_u32 s34, 3
    s_cbranch_scc1 F_PF2X
    buffer_load_dword v250, v17, s[48:51], s98 offen
    buffer_load_dword v250, v16, s[44:47], s99 offen
F_PF2X:
    s_add_u32 m0, s62, 40960
    s_nop 0
    buffer_load_dwordx4 v10, s[44:47], s52 offen offset:0 lds
    buffer_load_dwordx4 v10, s[44:47], s53 offen offset:1024 lds
    buffer_load_dwordx4 v10, s[44:47], s54 offen offset:2048 lds
    buffer_load_dwordx4 v10, s[44:47], s55 offen offset:3072 lds
    s_cmp_lg_u32 s96, 2
    s_cbranch_scc1 F_PW2X
    s_cmp_lg_u32 s34, 3
    s_cbranch_scc1 F_PW2X
    s_mov_b32 s40, s8
    s_mov_b32 s41, s9
    s_mov_b32 s42, 0x200000
    s_mov_b32 s43, 0x00020000
    buffer_load_dword v250, v18, s[40:43], s100 offen
F_PW2X:
    s_add_u32 m0, s62, 49152
    s_nop 0
    buffer_load_dwordx4 v11, s[48:51], s60 offen offset:0 lds
    buffer_load_dwordx4 v11, s[48:51], s61 offen offset:1024 lds
    v_add_u32 v10, 128, v10
    v_add_u32 v11, s63, v11
    s_waitcnt vmcnt(10)
    s_barrier
    s_add_u32 m0, s62, 86016
    s_nop 0
    buffer_load_dwordx4 v11, s[48:51], s57 offen offset:1024 lds
    ds_read_u16_d16_hi v44, v23 offset:0
    ds_read_u16_d16_hi v45, v23 offset:128
    ds_read_u16_d16_hi v46, v23 offset:256
    ds_read_u16_d16_hi v47, v22 offset:0
    ds_read_u16_d16_hi v48, v22 offset:128
    ds_read_u16_d16_hi v49, v22 offset:256
    buffer_load_dwordx4 v11, s[48:51], s58 offen offset:2048 lds
    ds_read_u16_d16_hi v50, v22 offset:384
    ds_read_u16_d16_hi v51, v22 offset:512
    ds_read_u16_d16_hi v52, v22 offset:640
    ds_read_u16_d16_hi v53, v22 offset:768
    ds_read_u16_d16_hi v54, v22 offset:896
    ds_read_u16_d16_hi v55, v22 offset:1024
    buffer_load_dwordx4 v11, s[48:51], s56 offen offset:0 lds
    v_lshlrev_b32 v36, 16, v32
    v_and_b32 v37, s7, v32
    v_lshlrev_b32 v38, 16, v33
    v_and_b32 v39, s7, v33
    s_waitcnt lgkmcnt(4)
    v_mul_f32 v80, v39, v44
    ds_read_u16_d16_hi v56, v22 offset:1152
    buffer_load_dwordx4 v11, s[48:51], s59 offen offset:3072 lds
    v_mul_f32 v81, v39, v45
    ds_read_u16_d16_hi v57, v22 offset:1280
    v_mul_f32 v82, v39, v46
    ds_read_u16_d16_hi v58, v22 offset:1408
    v_mul_f32 v83, v39, v47
    ds_read_u16_d16_hi v59, v22 offset:1536
    s_add_u32 m0, s62, 81920
    s_nop 0
    buffer_load_dwordx4 v10, s[44:47], s52 offen offset:0 lds
    v_mul_f32 v84, v39, v48
    ds_read_u16_d16_hi v60, v22 offset:1664
    v_mul_f32 v85, v39, v49
    ds_read_u16_d16_hi v61, v22 offset:1792
    v_mul_f32 v86, v39, v50
    ds_read_u16_d16_hi v62, v22 offset:1920
    buffer_load_dwordx4 v10, s[44:47], s53 offen offset:1024 lds
    v_mul_f32 v87, v39, v51
    ds_read_u16_d16_hi v64, v22 offset:16384
    s_waitcnt lgkmcnt(4)
    v_mul_f32 v88, v39, v52
    ds_read_u16_d16_hi v65, v22 offset:16512
    v_mul_f32 v89, v39, v53
    ds_read_u16_d16_hi v66, v22 offset:16640
    buffer_load_dwordx4 v10, s[44:47], s54 offen offset:2048 lds
    v_mul_f32 v90, v39, v54
    ds_read_u16_d16_hi v67, v22 offset:16768
    v_mul_f32 v91, v39, v55
    ds_read_u16_d16_hi v68, v22 offset:16896
    v_mul_f32 v92, v39, v56
    ds_read_u16_d16_hi v69, v22 offset:17024
    buffer_load_dwordx4 v10, s[44:47], s55 offen offset:3072 lds
    v_mul_f32 v93, v39, v57
    ds_read_u16_d16_hi v70, v22 offset:17152
    v_mul_f32 v94, v39, v58
    ds_read_u16_d16_hi v71, v22 offset:17280
    v_mul_f32 v95, v39, v59
    ds_read_u16_d16_hi v72, v22 offset:17408
    s_add_u32 m0, s62, 90112
    s_nop 0
    buffer_load_dwordx4 v11, s[48:51], s60 offen offset:0 lds
    s_waitcnt lgkmcnt(9)
    v_fmac_f32 v80, v38, v45
    ds_read_u16_d16_hi v73, v22 offset:17536
    v_fmac_f32 v81, v38, v46
    ds_read_u16_d16_hi v74, v22 offset:17664
    buffer_load_dwordx4 v11, s[48:51], s61 offen offset:1024 lds
    v_add_u32 v10, 128, v10
    v_add_u32 v11, s63, v11
    s_waitcnt vmcnt(10)
    s_barrier
    s_add_u32 m0, s62, 4096
    s_nop 0
    buffer_load_dwordx4 v11, s[48:51], s57 offen offset:1024 lds
    buffer_load_dword v14, v13, s[64:67], 0 offen sc1
    v_fmac_f32 v82, v38, v47
    ds_read_u16_d16_hi v75, v22 offset:17792
    v_fmac_f32 v83, v38, v48
    ds_read_u16_d16_hi v76, v22 offset:17920
    v_fmac_f32 v84, v38, v49
    buffer_load_dwordx4 v11, s[48:51], s58 offen offset:2048 lds
    ds_read_u16_d16_hi v77, v22 offset:18048
    v_fmac_f32 v85, v38, v50
    ds_read_u16_d16_hi v78, v22 offset:18176
    v_fmac_f32 v86, v38, v51
    ds_read_u16_d16_hi v79, v22 offset:18304
    v_fmac_f32 v87, v38, v52
    buffer_load_dwordx4 v11, s[48:51], s56 offen offset:0 lds
    v_fmac_f32 v88, v38, v53
    v_fmac_f32 v89, v38, v54
    v_fmac_f32 v90, v38, v55
    v_fmac_f32 v91, v38, v56
    v_fmac_f32 v92, v38, v57
    v_fmac_f32 v93, v38, v58
    buffer_load_dwordx4 v11, s[48:51], s59 offen offset:3072 lds
    v_fmac_f32 v94, v38, v59
    v_fmac_f32 v95, v38, v60
    v_fmac_f32 v80, v37, v46
    v_fmac_f32 v81, v37, v47
    v_fmac_f32 v82, v37, v48
    v_fmac_f32 v83, v37, v49
    s_add_u32 m0, s62, 0
    s_nop 0
    buffer_load_dwordx4 v10, s[44:47], s52 offen offset:0 lds
    v_fmac_f32 v84, v37, v50
    v_fmac_f32 v85, v37, v51
    v_fmac_f32 v86, v37, v52
    v_fmac_f32 v87, v37, v53
    v_fmac_f32 v88, v37, v54
    v_fmac_f32 v89, v37, v55
    buffer_load_dwordx4 v10, s[44:47], s53 offen offset:1024 lds
    v_fmac_f32 v90, v37, v56
    v_fmac_f32 v91, v37, v57
    v_fmac_f32 v92, v37, v58
    v_fmac_f32 v93, v37, v59
    v_fmac_f32 v94, v37, v60
    v_fmac_f32 v95, v37, v61
    buffer_load_dwordx4 v10, s[44:47], s54 offen offset:2048 lds
    v_fmac_f32 v80, v36, v47
    v_fmac_f32 v81, v36, v48
    v_fmac_f32 v82, v36, v49
    v_fmac_f32 v83, v36, v50
    v_fmac_f32 v84, v36, v51
    v_fmac_f32 v85, v36, v52
    buffer_load_dwordx4 v10, s[44:47], s55 offen offset:3072 lds
    v_fmac_f32 v86, v36, v53
    v_fmac_f32 v87, v36, v54
    v_fmac_f32 v88, v36, v55
    v_fmac_f32 v89, v36, v56
    v_fmac_f32 v90, v36, v57
    v_fmac_f32 v91, v36, v58
    s_add_u32 m0, s62, 8192
    s_nop 0
    buffer_load_dwordx4 v11, s[48:51], s60 offen offset:0 lds
    v_fmac_f32 v92, v36, v59
    v_fmac_f32 v93, v36, v60
    v_fmac_f32 v94, v36, v61
    v_fmac_f32 v95, v36, v62
    s_waitcnt lgkmcnt(0)
    v_mul_f32 v80, v80, v64
    buffer_load_dwordx4 v11, s[48:51], s61 offen offset:1024 lds
    v_add_u32 v10, 128, v10
    v_add_u32 v11, s63, v11
    s_waitcnt vmcnt(11)
    s_barrier
    s_add_u32 m0, s62, 45056
    s_nop 0
    buffer_load_dwordx4 v11, s[48:51], s57 offen offset:1024 lds
    buffer_load_dwordx4 v11, s[48:51], s58 offen offset:2048 lds
    buffer_load_dwordx4 v11, s[48:51], s56 offen offset:0 lds
    buffer_load_dwordx4 v11, s[48:51], s59 offen offset:3072 lds
    s_cmp_lg_u32 s96, 3
    s_cbranch_scc1 F_PF3X
    s_cmp_eq_u32 s34, 3
    s_cbranch_scc1 F_PF3X
    buffer_load_dword v250, v17, s[48:51], s98 offen
    buffer_load_dword v250, v16, s[44:47], s99 offen
F_PF3X:
    s_cmp_lg_u32 s96, 3
    s_cbranch_scc1 F_PW3X
    s_cmp_lg_u32 s34, 3
    s_cbranch_scc1 F_PW3X
    s_mov_b32 s40, s8
    s_mov_b32 s41, s9
    s_mov_b32 s42, 0x200000
    s_mov_b32 s43, 0x00020000
    buffer_load_dword v250, v18, s[40:43], s100 offen
F_PW3X:
    v_mul_f32 v81, v81, v65
    v_mul_f32 v82, v82, v66
    v_mul_f32 v83, v83, v67
    v_mul_f32 v84, v84, v68
    s_add_u32 m0, s62, 40960
    s_nop 0
    buffer_load_dwordx4 v10, s[44:47], s52 offen offset:0 lds
    v_mul_f32 v85, v85, v69
    v_mul_f32 v86, v86, v70
    v_mul_f32 v87, v87, v71
    v_mul_f32 v88, v88, v72
    v_mul_f32 v89, v89, v73
    v_mul_f32 v90, v90, v74
    buffer_load_dwordx4 v10, s[44:47], s53 offen offset:1024 lds
    v_mul_f32 v91, v91, v75
    v_mul_f32 v92, v92, v76
    v_mul_f32 v93, v93, v77
    v_mul_f32 v94, v94, v78
    v_mul_f32 v95, v95, v79
    v_cvt_pk_bf16_f32 v96, v92, v88
    buffer_load_dwordx4 v10, s[44:47], s54 offen offset:2048 lds
    v_cvt_pk_bf16_f32 v97, v84, v80
    v_cvt_pk_bf16_f32 v98, v94, v90
    v_cvt_pk_bf16_f32 v99, v86, v82
    v_cvt_pk_bf16_f32 v100, v93, v89
    v_cvt_pk_bf16_f32 v101, v85, v81
    v_cvt_pk_bf16_f32 v102, v95, v91
    buffer_load_dwordx4 v10, s[44:47], s55 offen offset:3072 lds
    v_cvt_pk_bf16_f32 v103, v87, v83
    ds_read_u16_d16_hi v44, v23 offset:2
    ds_read_u16_d16_hi v45, v23 offset:130
    ds_read_u16_d16_hi v46, v23 offset:258
    ds_read_u16_d16_hi v47, v22 offset:2
    ds_read_u16_d16_hi v48, v22 offset:130
    s_add_u32 m0, s62, 49152
    s_nop 0
    buffer_load_dwordx4 v11, s[48:51], s60 offen offset:0 lds
    ds_read_u16_d16_hi v49, v22 offset:258
    ds_read_u16_d16_hi v50, v22 offset:386
    ds_read_u16_d16_hi v51, v22 offset:514
    ds_read_u16_d16_hi v52, v22 offset:642
    ds_read_u16_d16_hi v53, v22 offset:770
    ds_read_u16_d16_hi v54, v22 offset:898
    buffer_load_dwordx4 v11, s[48:51], s61 offen offset:1024 lds
    ds_read_u16_d16_hi v55, v22 offset:1026
    v_lshlrev_b32 v36, 16, v34
    v_and_b32 v37, s7, v34
    v_lshlrev_b32 v38, 16, v35
    v_and_b32 v39, s7, v35
    s_waitcnt lgkmcnt(4)
    v_mul_f32 v80, v39, v44
    v_add_u32 v10, 128, v10
    v_add_u32 v11, s63, v11
    ds_read_u16_d16_hi v56, v22 offset:1154
    v_mul_f32 v81, v39, v45
    ds_read_u16_d16_hi v57, v22 offset:1282
    v_mul_f32 v82, v39, v46
    ds_read_u16_d16_hi v58, v22 offset:1410
    v_mul_f32 v83, v39, v47
    ds_read_u16_d16_hi v59, v22 offset:1538
    v_mul_f32 v84, v39, v48
    ds_read_u16_d16_hi v60, v22 offset:1666
    v_mul_f32 v85, v39, v49
    ds_read_u16_d16_hi v61, v22 offset:1794
    v_mul_f32 v86, v39, v50
    s_waitcnt vmcnt(10)
    s_barrier
    s_add_u32 m0, s62, 86016
    s_nop 0
    buffer_load_dwordx4 v11, s[48:51], s57 offen offset:1024 lds
    buffer_load_dwordx4 v11, s[48:51], s58 offen offset:2048 lds
    buffer_load_dwordx4 v11, s[48:51], s56 offen offset:0 lds
    buffer_load_dwordx4 v11, s[48:51], s59 offen offset:3072 lds
    v_readfirstlane_b32 s68, v14
    s_mov_b32 s69, 0
F_TK:
    s_cmp_ge_u32 s68, 4
    s_cbranch_scc1 F_TKX
    s_sleep 8
    buffer_load_dword v14, v13, s[64:67], 0 offen sc1
    s_waitcnt vmcnt(0)
    v_readfirstlane_b32 s68, v14
    s_add_u32 s69, s69, 1
    s_cmp_lt_u32 s69, 400000
    s_cbranch_scc1 F_TK
F_TKX:
    ds_read_u16_d16_hi v62, v22 offset:1922
    v_mul_f32 v87, v39, v51
    ds_read_u16_d16_hi v64, v22 offset:16386
    s_waitcnt lgkmcnt(4)
    v_mul_f32 v88, v39, v52
    ds_read_u16_d16_hi v65, v22 offset:16514
    s_add_u32 m0, s62, 81920
    s_nop 0
    buffer_load_dwordx4 v10, s[44:47], s52 offen offset:0 lds
    v_mul_f32 v89, v39, v53
    ds_read_u16_d16_hi v66, v22 offset:16642
    v_mul_f32 v90, v39, v54
    ds_read_u16_d16_hi v67, v22 offset:16770
    v_mul_f32 v91, v39, v55
    ds_read_u16_d16_hi v68, v22 offset:16898
    buffer_load_dwordx4 v10, s[44:47], s53 offen offset:1024 lds
    v_mul_f32 v92, v39, v56
    ds_read_u16_d16_hi v69, v22 offset:17026
    v_mul_f32 v93, v39, v57
    ds_read_u16_d16_hi v70, v22 offset:17154
    v_mul_f32 v94, v39, v58
    ds_read_u16_d16_hi v71, v22 offset:17282
    buffer_load_dwordx4 v10, s[44:47], s54 offen offset:2048 lds
    v_mul_f32 v95, v39, v59
    ds_read_u16_d16_hi v72, v22 offset:17410
    s_waitcnt lgkmcnt(9)
    v_fmac_f32 v80, v38, v45
    ds_read_u16_d16_hi v73, v22 offset:17538
    v_fmac_f32 v81, v38, v46
    ds_read_u16_d16_hi v74, v22 offset:17666
    buffer_load_dwordx4 v10, s[44:47], s55 offen offset:3072 lds
    v_fmac_f32 v82, v38, v47
    ds_read_u16_d16_hi v75, v22 offset:17794
    v_fmac_f32 v83, v38, v48
    ds_read_u16_d16_hi v76, v22 offset:17922
    v_fmac_f32 v84, v38, v49
    ds_read_u16_d16_hi v77, v22 offset:18050
    s_add_u32 m0, s62, 90112
    s_nop 0
    buffer_load_dwordx4 v11, s[48:51], s60 offen offset:0 lds
    v_fmac_f32 v85, v38, v50
    ds_read_u16_d16_hi v78, v22 offset:18178
    v_fmac_f32 v86, v38, v51
    ds_read_u16_d16_hi v79, v22 offset:18306
    v_fmac_f32 v87, v38, v52
    v_fmac_f32 v88, v38, v53
    buffer_load_dwordx4 v11, s[48:51], s61 offen offset:1024 lds
    v_fmac_f32 v89, v38, v54
    v_fmac_f32 v90, v38, v55
    v_fmac_f32 v91, v38, v56
    v_fmac_f32 v92, v38, v57
    v_fmac_f32 v93, v38, v58
    v_fmac_f32 v94, v38, v59
    v_add_u32 v10, 128, v10
    v_add_u32 v11, s63, v11
    v_fmac_f32 v95, v38, v60
    v_fmac_f32 v80, v37, v46
    v_fmac_f32 v81, v37, v47
    v_fmac_f32 v82, v37, v48
    v_fmac_f32 v83, v37, v49
    v_fmac_f32 v84, v37, v50
    v_fmac_f32 v85, v37, v51
    v_fmac_f32 v86, v37, v52
    v_fmac_f32 v87, v37, v53
    v_fmac_f32 v88, v37, v54
    v_fmac_f32 v89, v37, v55
    s_waitcnt vmcnt(10)
    s_barrier
    s_add_u32 m0, s62, 4096
    s_nop 0
    buffer_load_dwordx4 v11, s[48:51], s57 offen offset:1024 lds
    v_fmac_f32 v90, v37, v56
    v_fmac_f32 v91, v37, v57
    v_fmac_f32 v92, v37, v58
    v_fmac_f32 v93, v37, v59
    v_fmac_f32 v94, v37, v60
    buffer_load_dwordx4 v11, s[48:51], s58 offen offset:2048 lds
    v_fmac_f32 v95, v37, v61
    v_fmac_f32 v80, v36, v47
    v_fmac_f32 v81, v36, v48
    v_fmac_f32 v82, v36, v49
    v_fmac_f32 v83, v36, v50
    buffer_load_dwordx4 v11, s[48:51], s56 offen offset:0 lds
    v_fmac_f32 v84, v36, v51
    v_fmac_f32 v85, v36, v52
    v_fmac_f32 v86, v36, v53
    v_fmac_f32 v87, v36, v54
    v_fmac_f32 v88, v36, v55
    buffer_load_dwordx4 v11, s[48:51], s59 offen offset:3072 lds
    v_fmac_f32 v89, v36, v56
    v_fmac_f32 v90, v36, v57
    v_fmac_f32 v91, v36, v58
    v_fmac_f32 v92, v36, v59
    v_fmac_f32 v93, v36, v60
    s_add_u32 m0, s62, 0
    s_nop 0
    buffer_load_dwordx4 v10, s[44:47], s52 offen offset:0 lds
    v_fmac_f32 v94, v36, v61
    v_fmac_f32 v95, v36, v62
    s_waitcnt lgkmcnt(0)
    v_mul_f32 v80, v80, v64
    v_mul_f32 v81, v81, v65
    v_mul_f32 v82, v82, v66
    buffer_load_dwordx4 v10, s[44:47], s53 offen offset:1024 lds
    v_mul_f32 v83, v83, v67
    v_mul_f32 v84, v84, v68
    v_mul_f32 v85, v85, v69
    v_mul_f32 v86, v86, v70
    v_mul_f32 v87, v87, v71
    buffer_load_dwordx4 v10, s[44:47], s54 offen offset:2048 lds
    v_mul_f32 v88, v88, v72
    v_mul_f32 v89, v89, v73
    v_mul_f32 v90, v90, v74
    v_mul_f32 v91, v91, v75
    v_mul_f32 v92, v92, v76
    buffer_load_dwordx4 v10, s[44:47], s55 offen offset:3072 lds
    v_mul_f32 v93, v93, v77
    v_mul_f32 v94, v94, v78
    v_mul_f32 v95, v95, v79
    v_cvt_pk_bf16_f32 v104, v92, v88
    v_cvt_pk_bf16_f32 v105, v84, v80
    s_add_u32 m0, s62, 8192
    s_nop 0
    buffer_load_dwordx4 v11, s[48:51], s60 offen offset:0 lds
    v_cvt_pk_bf16_f32 v106, v94, v90
    v_cvt_pk_bf16_f32 v107, v86, v82
    v_cvt_pk_bf16_f32 v108, v93, v89
    v_cvt_pk_bf16_f32 v109, v85, v81
    v_cvt_pk_bf16_f32 v110, v95, v91
    buffer_load_dwordx4 v11, s[48:51], s61 offen offset:1024 lds
    v_cvt_pk_bf16_f32 v111, v87, v83
    s_mov_b32 s69, 0x700000
    buffer_store_dwordx4 v[96:99], v25, s[36:39], s69 offen offset:0 sc1
    buffer_store_dwordx4 v[100:103], v25, s[36:39], s69 offen offset:2048 sc1
    s_mov_b32 s69, 0x701080
    buffer_store_dwordx4 v[104:107], v25, s[36:39], s69 offen offset:0 sc1
    buffer_store_dwordx4 v[108:111], v25, s[36:39], s69 offen offset:2048 sc1
    v_add_u32 v10, 128, v10
    v_add_u32 v11, s63, v11
    s_waitcnt vmcnt(14)
    s_barrier
    s_add_u32 m0, s62, 45056
    s_nop 0
    buffer_load_dwordx4 v11, s[48:51], s57 offen offset:1024 lds
    s_lshl_b32 s98, s35, 12
    buffer_load_dwordx4 v11, s[48:51], s58 offen offset:2048 lds
    s_mul_i32 s99, s34, 8320
    buffer_load_dwordx4 v11, s[48:51], s56 offen offset:0 lds
    s_add_u32 s99, s99, 122880
    buffer_load_dwordx4 v11, s[48:51], s59 offen offset:3072 lds
    s_add_u32 m0, s62, 40960
    s_nop 0
    buffer_load_dwordx4 v10, s[44:47], s52 offen offset:0 lds
    buffer_load_dwordx4 v10, s[44:47], s53 offen offset:1024 lds
    buffer_load_dwordx4 v10, s[44:47], s54 offen offset:2048 lds
    buffer_load_dwordx4 v10, s[44:47], s55 offen offset:3072 lds
    s_add_u32 m0, s62, 49152
    s_nop 0
    buffer_load_dwordx4 v11, s[48:51], s60 offen offset:0 lds
    buffer_load_dwordx4 v11, s[48:51], s61 offen offset:1024 lds
    v_add_u32 v10, 128, v10
    v_add_u32 v11, s63, v11
    s_waitcnt vmcnt(14)
    s_barrier
    s_add_u32 m0, s62, 86016
    s_nop 0
    buffer_load_dwordx4 v11, s[48:51], s57 offen offset:1024 lds
    buffer_load_dwordx4 v11, s[48:51], s58 offen offset:2048 lds
    buffer_load_dwordx4 v11, s[48:51], s56 offen offset:0 lds
    buffer_load_dwordx4 v11, s[48:51], s59 offen offset:3072 lds
    s_and_b32 s69, s2, 15
    s_lshl_b32 s69, s69, 2
    s_add_u32 s69, s69, s34
    s_lshl_b32 s4, s69, 7
    s_add_u32 s4, s4, 0x120000
    s_add_u32 s4, s4, s26
    s_addc_u32 s5, s27, 0
    s_mov_b32 s6, 1
    s_waitcnt vmcnt(14)
    s_atomic_add s6, s[4:5], 0
    v_mov_b32 v96, 0
    v_mov_b32 v97, 0
    s_add_u32 m0, s62, 81920
    s_nop 0
    buffer_load_dwordx4 v10, s[44:47], s52 offen offset:0 lds
    v_mov_b32 v98, 0
    v_mov_b32 v99, 0
    v_mov_b32 v100, 0
    buffer_load_dwordx4 v10, s[44:47], s53 offen offset:1024 lds
    v_mov_b32 v101, 0
    v_mov_b32 v102, 0
    v_mov_b32 v103, 0
    buffer_load_dwordx4 v10, s[44:47], s54 offen offset:2048 lds
    v_mov_b32 v104, 0
    v_mov_b32 v105, 0
    v_mov_b32 v106, 0
    buffer_load_dwordx4 v10, s[44:47], s55 offen offset:3072 lds
    v_mov_b32 v107, 0
    v_mov_b32 v108, 0
    v_mov_b32 v109, 0
    s_add_u32 m0, s62, 90112
    s_nop 0
    buffer_load_dwordx4 v11, s[48:51], s60 offen offset:0 lds
    v_mov_b32 v110, 0
    v_mov_b32 v111, 0
    v_mov_b32 v112, 0
    buffer_load_dwordx4 v11, s[48:51], s61 offen offset:1024 lds
    v_mov_b32 v113, 0
    v_mov_b32 v114, 0
    v_mov_b32 v115, 0
    v_add_u32 v10, 128, v10
    v_add_u32 v11, s63, v11
    s_waitcnt vmcnt(10)
    s_barrier
    s_add_u32 m0, s62, 4096
    s_nop 0
    buffer_load_dwordx4 v11, s[48:51], s57 offen offset:1024 lds
    v_mov_b32 v116, 0
    v_mov_b32 v117, 0
    v_mov_b32 v118, 0
    v_mov_b32 v119, 0
    v_mov_b32 v120, 0
    buffer_load_dwordx4 v11, s[48:51], s58 offen offset:2048 lds
    v_mov_b32 v121, 0
    v_mov_b32 v122, 0
    v_mov_b32 v123, 0
    v_mov_b32 v124, 0
    v_mov_b32 v125, 0
    buffer_load_dwordx4 v11, s[48:51], s56 offen offset:0 lds
    v_mov_b32 v126, 0
    v_mov_b32 v127, 0
    v_mov_b32 v128, 0
    v_mov_b32 v129, 0
    v_mov_b32 v130, 0
    buffer_load_dwordx4 v11, s[48:51], s59 offen offset:3072 lds
    v_mov_b32 v131, 0
    v_mov_b32 v132, 0
    v_mov_b32 v133, 0
    v_mov_b32 v134, 0
    v_mov_b32 v135, 0
    s_add_u32 m0, s62, 0
    s_nop 0
    buffer_load_dwordx4 v10, s[44:47], s52 offen offset:0 lds
    v_mov_b32 v136, 0
    v_mov_b32 v137, 0
    v_mov_b32 v138, 0
    v_mov_b32 v139, 0
    v_mov_b32 v140, 0
    buffer_load_dwordx4 v10, s[44:47], s53 offen offset:1024 lds
    v_mov_b32 v141, 0
    v_mov_b32 v142, 0
    v_mov_b32 v143, 0
    v_mov_b32 v144, 0
    v_mov_b32 v145, 0
    buffer_load_dwordx4 v10, s[44:47], s54 offen offset:2048 lds
    v_mov_b32 v146, 0
    v_mov_b32 v147, 0
    v_mov_b32 v148, 0
    v_mov_b32 v149, 0
    v_mov_b32 v150, 0
    buffer_load_dwordx4 v10, s[44:47], s55 offen offset:3072 lds
    v_mov_b32 v151, 0
    v_mov_b32 v152, 0
    v_mov_b32 v153, 0
    v_mov_b32 v154, 0
    v_mov_b32 v155, 0
    s_add_u32 m0, s62, 8192
    s_nop 0
    buffer_load_dwordx4 v11, s[48:51], s60 offen offset:0 lds
    v_mov_b32 v156, 0
    v_mov_b32 v157, 0
    v_mov_b32 v158, 0
    v_mov_b32 v159, 0
    buffer_load_dwordx4 v11, s[48:51], s61 offen offset:1024 lds
    v_add_u32 v10, 128, v10
    v_add_u32 v11, s63, v11
    s_waitcnt vmcnt(10)
    s_barrier
    s_add_u32 m0, s62, 45056
    s_nop 0
    buffer_load_dwordx4 v11, s[48:51], s57 offen offset:1024 lds
    buffer_load_dwordx4 v11, s[48:51], s58 offen offset:2048 lds
    buffer_load_dwordx4 v11, s[48:51], s56 offen offset:0 lds
    buffer_load_dwordx4 v11, s[48:51], s59 offen offset:3072 lds
    s_add_u32 s4, s18, s98
    s_addc_u32 s5, s19, 0
    s_load_dword s6, s[4:5], 0
    s_lshl_b32 s7, s35, 1
    s_and_b32 s7, s7, 0xfffffffc
    s_add_u32 s4, s20, s7
    s_addc_u32 s5, s21, 0
    s_load_dword s7, s[4:5], 0
    s_mul_i32 s97, s34, 4608
    s_add_u32 s97, s97, 98304
    v_add_u32 v32, s97, v1
    v_add_u32 v33, 2048, v32
    v_cmp_gt_u32 vcc, 16, v0
    s_add_u32 m0, s62, 40960
    s_nop 0
    buffer_load_dwordx4 v10, s[44:47], s52 offen offset:0 lds
    v_and_b32 v34, 1, v0
    v_lshlrev_b32 v34, 4, v34
    v_cndmask_b32 v32, v33, v32, vcc
    v_bfe_u32 v35, v0, 1, 1
    v_mul_u32_u24 v35, 4160, v35
    v_cmp_gt_u32 vcc, 32, v0
    buffer_load_dwordx4 v10, s[44:47], s53 offen offset:1024 lds
    v_add3_u32 v34, v34, v35, s99
    v_mov_b32 v36, 0
    v_mov_b32 v37, 0
    v_mov_b32 v38, 0
    v_mov_b32 v39, 0
    v_cndmask_b32 v32, v34, v32, vcc
    buffer_load_dwordx4 v10, s[44:47], s54 offen offset:2048 lds
    v_and_b32 v34, 3, v0
    v_lshlrev_b32 v30, 2, v34
    v_add_u32 v30, 156160, v30
    v_bfe_u32 v35, v0, 2, 2
    v_add_u32 v34, v34, v35
    v_lshlrev_b32 v34, 3, v34
    buffer_load_dwordx4 v10, s[44:47], s55 offen offset:3072 lds
    v_lshl_add_u32 v34, v5, 5, v34
    s_add_u32 s69, s99, 8
    v_add_u32 v6, s69, v34
    v_and_b32 v34, 15, v0
    v_sub_u32 v34, v34, v5
    v_lshlrev_b32 v34, 4, v34
    s_add_u32 m0, s62, 49152
    s_nop 0
    buffer_load_dwordx4 v11, s[48:51], s60 offen offset:0 lds
    s_add_u32 s69, s97, 192
    v_add_u32 v7, s69, v34
    v_mov_b32 v5, s99
    v_subrev_u32 v8, 16, v0
    v_add_u32 v9, 47, v0
    v_cmp_gt_u32 vcc, 16, v0
    buffer_load_dwordx4 v11, s[48:51], s61 offen offset:1024 lds
    v_mov_b32 v34, 63
    s_lshl_b32 s69, s34, 2
    v_cndmask_b32 v8, v8, v9, vcc
    v_cmp_eq_u32 vcc, 0, v0
    s_add_u32 s69, s69, 156192
    v_mov_b32 v9, s69
    v_add_u32 v10, 128, v10
    v_add_u32 v11, s63, v11
    v_cndmask_b32 v8, v8, v34, vcc
    v_lshlrev_b32 v8, 2, v8
    s_waitcnt lgkmcnt(0)
    s_lshl_b32 s6, s6, 16
    s_and_b32 s69, s35, 1
    s_lshl_b32 s69, s69, 4
    s_lshr_b32 s7, s7, s69
    s_lshl_b32 s7, s7, 16
    v_mov_b32 v33, s6
    v_add_f32 v33, s7, v33
    v_cvt_pk_bf16_f32 v33, v33, v33
    s_waitcnt vmcnt(10)
    s_barrier
    s_lshl_b32 s97, s34, 2
    s_add_u32 s97, s97, 156288
    v_mov_b32 v28, s97
    v_mov_b32 v29, 1
    s_waitcnt vmcnt(0)
    ds_write_b32 v28, v29
    s_mov_b32 s40, s18
    s_mov_b32 s41, s19
    s_mov_b32 s42, 0x400000
    s_mov_b32 s43, 0x00020000
    s_add_u32 m0, s99, 32
    s_nop 0
    buffer_load_dwordx4 v1, s[40:43], s98 offen offset:0 lds
    s_add_u32 m0, s99, 4196
    s_nop 0
    buffer_load_dwordx4 v1, s[40:43], s98 offen offset:0 lds
    s_add_u32 m0, s99, 32
    s_nop 0
    buffer_load_dwordx4 v1, s[40:43], s98 offen offset:1024 lds
    s_add_u32 m0, s99, 4196
    s_nop 0
    buffer_load_dwordx4 v1, s[40:43], s98 offen offset:1024 lds
    s_add_u32 m0, s99, 32
    s_nop 0
    buffer_load_dwordx4 v1, s[40:43], s98 offen offset:2048 lds
    s_add_u32 m0, s99, 4196
    s_nop 0
    buffer_load_dwordx4 v1, s[40:43], s98 offen offset:2048 lds
    s_add_u32 m0, s99, 32
    s_nop 0
    buffer_load_dwordx4 v1, s[40:43], s98 offen offset:3072 lds
    s_add_u32 m0, s99, 4196
    s_nop 0
    buffer_load_dwordx4 v1, s[40:43], s98 offen offset:3072 lds
    s_cmp_ge_u32 s34, 2
    s_cbranch_scc1 F_QL2
    s_mov_b32 s40, s10
    s_mov_b32 s41, s11
    s_mov_b32 s42, 0x400000
    s_mov_b32 s43, 0x00020000
    s_and_b32 s69, s2, 15
    s_lshl_b32 s69, s69, 7
    s_add_u32 s97, s69, 0
    buffer_load_dwordx4 v[200:203], v234, s[40:43], s97 offen offset:0 nt
    s_add_u32 s97, s69, 0
    buffer_load_dwordx4 v[204:207], v234, s[40:43], s97 offen offset:2048 nt
    s_add_u32 s97, s69, 4096
    buffer_load_dwordx4 v[208:211], v234, s[40:43], s97 offen offset:0 nt
    s_add_u32 s97, s69, 4096
    buffer_load_dwordx4 v[212:215], v234, s[40:43], s97 offen offset:2048 nt
    s_add_u32 s97, s69, 524288
    buffer_load_dwordx4 v[216:219], v234, s[40:43], s97 offen offset:0 nt
    s_add_u32 s97, s69, 524288
    buffer_load_dwordx4 v[220:223], v234, s[40:43], s97 offen offset:2048 nt
    s_add_u32 s97, s69, 528384
    buffer_load_dwordx4 v[224:227], v234, s[40:43], s97 offen offset:0 nt
    s_add_u32 s97, s69, 528384
    buffer_load_dwordx4 v[228:231], v234, s[40:43], s97 offen offset:2048 nt
F_QL2:
    s_mul_i32 s52, s34, 4608
    s_add_u32 s52, s52, 98304
    s_mul_i32 s63, s35, 4224
    s_add_u32 s53, s63, 0x700000
    s_mov_b32 s40, s8
    s_mov_b32 s41, s9
    s_mov_b32 s42, 0x200000
    s_mov_b32 s43, 0x00020000
    s_lshl_b32 s62, s34, 10
    s_lshl_b32 s100, s34, 14
    s_lshl_b32 s101, s33, 7
    s_add_u32 s100, s100, s101
    s_lshr_b32 s69, s35, 4
    s_lshl_b32 s54, s69, 7
    s_add_u32 s54, s54, 0x120000
    s_add_u32 s54, s54, s26
    s_addc_u32 s55, s27, 0
    s_mov_b32 s101, 0
F_P1:
    s_mov_b32 s69, 0
    s_atomic_add s69, s[54:55], 0 glc
    s_waitcnt lgkmcnt(0)
    s_cmp_ge_u32 s69, 16
    s_cbranch_scc1 F_P1_X
    s_sleep 4
    s_add_u32 s101, s101, 1
    s_cmp_lt_u32 s101, 400000
    s_cbranch_scc1 F_P1
F_P1_X:
    s_add_u32 m0, s52, 256
    s_nop 0
    buffer_load_dwordx4 v1, s[36:39], s53 offen offset:0 sc1 lds
    buffer_load_dwordx4 v1, s[36:39], s53 offen offset:1024 sc1 lds
    s_add_u32 m0, s52, 512
    s_nop 0
    buffer_load_dwordx4 v1, s[36:39], s53 offen offset:2048 sc1 lds
    buffer_load_dwordx4 v1, s[36:39], s53 offen offset:3072 sc1 lds
    ds_write_b128 v32, v[36:39]
    ds_write_b32 v5, v36 offset:4192
    s_add_u32 m0, s62, 81920
    s_add_u32 s101, s100, 0
    buffer_load_dwordx4 v12, s[40:43], s101 offen lds
    s_add_u32 m0, s62, 86016
    s_add_u32 s101, s100, 65536
    buffer_load_dwordx4 v12, s[40:43], s101 offen lds
    s_add_u32 m0, s62, 90112
    s_add_u32 s101, s100, 131072
    buffer_load_dwordx4 v12, s[40:43], s101 offen lds
    s_add_u32 m0, s62, 94208
    s_add_u32 s101, s100, 196608
    buffer_load_dwordx4 v12, s[40:43], s101 offen lds
F_WG14:
    ds_read_b32 v11, v30 offset:112
    s_waitcnt lgkmcnt(0)
    v_cmp_ne_u32 vcc, 1, v11
    s_cbranch_vccz F_WG14_X
    s_sleep 1
    s_branch F_WG14
F_WG14_X:
    s_add_u32 m0, s62, 0
    s_add_u32 s101, s100, 262144
    buffer_load_dwordx4 v12, s[40:43], s101 offen lds
    s_add_u32 m0, s62, 4096
    s_add_u32 s101, s100, 327680
    buffer_load_dwordx4 v12, s[40:43], s101 offen lds
    s_add_u32 m0, s62, 8192
    s_add_u32 s101, s100, 393216
    buffer_load_dwordx4 v12, s[40:43], s101 offen lds
    s_add_u32 m0, s62, 12288
    s_add_u32 s101, s100, 458752
    buffer_load_dwordx4 v12, s[40:43], s101 offen lds
    s_add_u32 m0, s62, 16384
    s_add_u32 s101, s100, 524288
    buffer_load_dwordx4 v12, s[40:43], s101 offen lds
    s_add_u32 m0, s62, 20480
    s_add_u32 s101, s100, 589824
    buffer_load_dwordx4 v12, s[40:43], s101 offen lds
    s_add_u32 m0, s62, 24576
    s_add_u32 s101, s100, 655360
    buffer_load_dwordx4 v12, s[40:43], s101 offen lds
    s_add_u32 m0, s62, 28672
    s_add_u32 s101, s100, 720896
    buffer_load_dwordx4 v12, s[40:43], s101 offen lds
    s_add_u32 m0, s62, 32768
    s_add_u32 s101, s100, 786432
    buffer_load_dwordx4 v12, s[40:43], s101 offen lds
    s_add_u32 m0, s62, 36864
    s_add_u32 s101, s100, 851968
    buffer_load_dwordx4 v12, s[40:43], s101 offen lds
F_WGDx:
    ds_read_b32 v11, v30 offset:80
    s_waitcnt lgkmcnt(0)
    v_cmp_ne_u32 vcc, 1, v11
    s_cbranch_vccz F_WGDx_X
    s_sleep 1
    s_branch F_WGDx
F_WGDx_X:
    s_add_u32 m0, s62, 40960
    s_add_u32 s101, s100, 917504
    buffer_load_dwordx4 v12, s[40:43], s101 offen lds
    s_add_u32 m0, s62, 45056
    s_add_u32 s101, s100, 983040
    buffer_load_dwordx4 v12, s[40:43], s101 offen lds
    s_add_u32 m0, s62, 49152
    s_add_u32 s101, s100, 1048576
    buffer_load_dwordx4 v12, s[40:43], s101 offen lds
    s_add_u32 m0, s62, 53248
    s_add_u32 s101, s100, 1114112
    buffer_load_dwordx4 v12, s[40:43], s101 offen lds
    s_add_u32 m0, s62, 57344
    s_add_u32 s101, s100, 1179648
    buffer_load_dwordx4 v12, s[40:43], s101 offen lds
    s_add_u32 m0, s62, 61440
    s_add_u32 s101, s100, 1245184
    buffer_load_dwordx4 v12, s[40:43], s101 offen lds
    s_add_u32 m0, s62, 65536
    s_add_u32 s101, s100, 1310720
    buffer_load_dwordx4 v12, s[40:43], s101 offen lds
    s_add_u32 m0, s62, 69632
    s_add_u32 s101, s100, 1376256
    buffer_load_dwordx4 v12, s[40:43], s101 offen lds
    s_add_u32 m0, s62, 73728
    s_add_u32 s101, s100, 1441792
    buffer_load_dwordx4 v12, s[40:43], s101 offen lds
    s_add_u32 m0, s62, 77824
    s_add_u32 s101, s100, 1507328
    buffer_load_dwordx4 v12, s[40:43], s101 offen lds
    s_waitcnt vmcnt(24)
    ds_write_b16 v5, v33 offset:32
    ds_write_b16 v5, v33 offset:4196
    ds_read_b128 v[76:79], v7 offset:1856
    ds_read_b64_tr_b16 v[16:17], v6 offset:0
    ds_read_b64_tr_b16 v[18:19], v6 offset:4160
    ds_read_b128 v[72:75], v7 offset:1600
    ds_read_b64_tr_b16 v[20:21], v6 offset:512
    ds_read_b64_tr_b16 v[22:23], v6 offset:4672
    ds_read_b128 v[68:71], v7 offset:1344
    ds_read_b64_tr_b16 v[24:25], v6 offset:1024
    ds_read_b64_tr_b16 v[26:27], v6 offset:5184
    ds_read_b128 v[64:67], v7 offset:1088
    ds_read_b64_tr_b16 v[28:29], v6 offset:1536
    ds_read_b64_tr_b16 v[30:31], v6 offset:5696
    ds_read_b128 v[60:63], v7 offset:832
    ds_read_b64_tr_b16 v[32:33], v6 offset:2048
    ds_read_b64_tr_b16 v[34:35], v6 offset:6208
    ds_read_b128 v[56:59], v7 offset:576
    ds_read_b64_tr_b16 v[36:37], v6 offset:2560
    ds_read_b64_tr_b16 v[38:39], v6 offset:6720
    ds_read_b128 v[52:55], v7 offset:320
    ds_read_b64_tr_b16 v[40:41], v6 offset:3072
    ds_read_b64_tr_b16 v[42:43], v6 offset:7232
    ds_read_b128 v[48:51], v7 offset:64
    ds_read_b64_tr_b16 v[44:45], v6 offset:3584
    ds_read_b64_tr_b16 v[46:47], v6 offset:7744
    v_mov_b32 v10, 1
    s_mov_b64 s[60:61], 1
    s_mov_b32 s58, 0
.p2align 6
F_VLOOP:
    s_waitcnt lgkmcnt(15)
    v_mfma_f32_16x16x32_bf16 v[124:127], v[16:19], v[76:79], v[124:127]
    ds_read_b128 v[80:83], v7 offset:2368
    ds_read_b128 v[76:79], v7 offset:4160
    v_mfma_f32_16x16x32_bf16 v[120:123], v[16:19], v[72:75], v[120:123]
    v_mfma_f32_16x16x32_bf16 v[124:127], v[20:23], v[72:75], v[124:127]
    ds_read_b128 v[72:75], v7 offset:3904
    v_mfma_f32_16x16x32_bf16 v[116:119], v[16:19], v[68:71], v[116:119]
    v_mfma_f32_16x16x32_bf16 v[120:123], v[20:23], v[68:71], v[120:123]
    s_waitcnt lgkmcnt(15)
    v_mfma_f32_16x16x32_bf16 v[124:127], v[24:27], v[68:71], v[124:127]
    ds_read_b128 v[68:71], v7 offset:3648
    s_waitcnt lgkmcnt(15)
    v_mfma_f32_16x16x32_bf16 v[112:115], v[16:19], v[64:67], v[112:115]
    v_mfma_f32_16x16x32_bf16 v[116:119], v[20:23], v[64:67], v[116:119]
    v_mfma_f32_16x16x32_bf16 v[120:123], v[24:27], v[64:67], v[120:123]
    v_mfma_f32_16x16x32_bf16 v[124:127], v[28:31], v[64:67], v[124:127]
    ds_read_b128 v[64:67], v7 offset:3392
    s_waitcnt lgkmcnt(15)
    v_mfma_f32_16x16x32_bf16 v[108:111], v[16:19], v[60:63], v[108:111]
    v_mfma_f32_16x16x32_bf16 v[112:115], v[20:23], v[60:63], v[112:115]
    v_mfma_f32_16x16x32_bf16 v[116:119], v[24:27], v[60:63], v[116:119]
    v_mfma_f32_16x16x32_bf16 v[120:123], v[28:31], v[60:63], v[120:123]
    s_waitcnt lgkmcnt(13)
    v_mfma_f32_16x16x32_bf16 v[124:127], v[32:35], v[60:63], v[124:127]
    ds_read_b128 v[60:63], v7 offset:3136
    s_waitcnt lgkmcnt(13)
    v_mfma_f32_16x16x32_bf16 v[104:107], v[16:19], v[56:59], v[104:107]
    v_mfma_f32_16x16x32_bf16 v[108:111], v[20:23], v[56:59], v[108:111]
    v_mfma_f32_16x16x32_bf16 v[112:115], v[24:27], v[56:59], v[112:115]
    v_mfma_f32_16x16x32_bf16 v[116:119], v[28:31], v[56:59], v[116:119]
    v_mfma_f32_16x16x32_bf16 v[120:123], v[32:35], v[56:59], v[120:123]
    s_waitcnt lgkmcnt(11)
    v_mfma_f32_16x16x32_bf16 v[124:127], v[36:39], v[56:59], v[124:127]
    ds_read_b128 v[56:59], v7 offset:2880
    s_waitcnt lgkmcnt(11)
    v_mfma_f32_16x16x32_bf16 v[100:103], v[16:19], v[52:55], v[100:103]
    v_mfma_f32_16x16x32_bf16 v[104:107], v[20:23], v[52:55], v[104:107]
    v_mfma_f32_16x16x32_bf16 v[108:111], v[24:27], v[52:55], v[108:111]
    v_mfma_f32_16x16x32_bf16 v[112:115], v[28:31], v[52:55], v[112:115]
    v_mfma_f32_16x16x32_bf16 v[116:119], v[32:35], v[52:55], v[116:119]
    v_mfma_f32_16x16x32_bf16 v[120:123], v[36:39], v[52:55], v[120:123]
    s_waitcnt lgkmcnt(9)
    v_mfma_f32_16x16x32_bf16 v[124:127], v[40:43], v[52:55], v[124:127]
    ds_read_b128 v[52:55], v7 offset:2624
    s_waitcnt lgkmcnt(10)
    v_mfma_f32_16x16x32_bf16 v[96:99], v[16:19], v[48:51], v[96:99]
    v_mfma_f32_16x16x32_bf16 v[100:103], v[20:23], v[48:51], v[100:103]
    v_mfma_f32_16x16x32_bf16 v[104:107], v[24:27], v[48:51], v[104:107]
    v_mfma_f32_16x16x32_bf16 v[108:111], v[28:31], v[48:51], v[108:111]
    v_mfma_f32_16x16x32_bf16 v[112:115], v[32:35], v[48:51], v[112:115]
    v_mfma_f32_16x16x32_bf16 v[116:119], v[36:39], v[48:51], v[116:119]
    v_mfma_f32_16x16x32_bf16 v[120:123], v[40:43], v[48:51], v[120:123]
    s_waitcnt lgkmcnt(8)
    v_mfma_f32_16x16x32_bf16 v[124:127], v[44:47], v[48:51], v[124:127]
    s_waitcnt lgkmcnt(6)
    v_mfma_f32_16x16x32_bf16 v[156:159], v[16:19], v[76:79], v[156:159]
    ds_read_b128 v[48:51], v7 offset:0
    ds_read_b128 v[76:79], v7 offset:1792
    s_waitcnt lgkmcnt(7)
    v_mfma_f32_16x16x32_bf16 v[152:155], v[16:19], v[72:75], v[152:155]
    s_waitcnt lgkmcnt(6)
    v_mfma_f32_16x16x32_bf16 v[148:151], v[16:19], v[68:71], v[148:151]
    s_waitcnt lgkmcnt(5)
    v_mfma_f32_16x16x32_bf16 v[144:147], v[16:19], v[64:67], v[144:147]
    s_waitcnt lgkmcnt(4)
    v_mfma_f32_16x16x32_bf16 v[140:143], v[16:19], v[60:63], v[140:143]
    s_waitcnt lgkmcnt(3)
    v_mfma_f32_16x16x32_bf16 v[136:139], v[16:19], v[56:59], v[136:139]
    s_waitcnt lgkmcnt(2)
    v_mfma_f32_16x16x32_bf16 v[132:135], v[16:19], v[52:55], v[132:135]
    v_mfma_f32_16x16x32_bf16 v[128:131], v[16:19], v[80:83], v[128:131]
    ds_read_b64_tr_b16 v[16:17], v6 offset:128
    ds_read_b64_tr_b16 v[18:19], v6 offset:4288
    v_mfma_f32_16x16x32_bf16 v[156:159], v[20:23], v[72:75], v[156:159]
    ds_read_b128 v[72:75], v7 offset:1536
    v_mfma_f32_16x16x32_bf16 v[152:155], v[20:23], v[68:71], v[152:155]
    v_mfma_f32_16x16x32_bf16 v[148:151], v[20:23], v[64:67], v[148:151]
    v_mfma_f32_16x16x32_bf16 v[144:147], v[20:23], v[60:63], v[144:147]
    v_mfma_f32_16x16x32_bf16 v[140:143], v[20:23], v[56:59], v[140:143]
    v_mfma_f32_16x16x32_bf16 v[136:139], v[20:23], v[52:55], v[136:139]
    v_mfma_f32_16x16x32_bf16 v[132:135], v[20:23], v[80:83], v[132:135]
    ds_read_b64_tr_b16 v[20:21], v6 offset:640
    ds_read_b64_tr_b16 v[22:23], v6 offset:4800
    v_mfma_f32_16x16x32_bf16 v[156:159], v[24:27], v[68:71], v[156:159]
    ds_read_b128 v[68:71], v7 offset:1280
    v_mfma_f32_16x16x32_bf16 v[152:155], v[24:27], v[64:67], v[152:155]
    v_mfma_f32_16x16x32_bf16 v[148:151], v[24:27], v[60:63], v[148:151]
    v_mfma_f32_16x16x32_bf16 v[144:147], v[24:27], v[56:59], v[144:147]
    v_mfma_f32_16x16x32_bf16 v[140:143], v[24:27], v[52:55], v[140:143]
    v_mfma_f32_16x16x32_bf16 v[136:139], v[24:27], v[80:83], v[136:139]
    ds_read_b64_tr_b16 v[24:25], v6 offset:1152
    ds_read_b64_tr_b16 v[26:27], v6 offset:5312
    v_mfma_f32_16x16x32_bf16 v[156:159], v[28:31], v[64:67], v[156:159]
    ds_read_b128 v[64:67], v7 offset:1024
    v_mfma_f32_16x16x32_bf16 v[152:155], v[28:31], v[60:63], v[152:155]
    v_mfma_f32_16x16x32_bf16 v[148:151], v[28:31], v[56:59], v[148:151]
    v_mfma_f32_16x16x32_bf16 v[144:147], v[28:31], v[52:55], v[144:147]
    v_mfma_f32_16x16x32_bf16 v[140:143], v[28:31], v[80:83], v[140:143]
    ds_read_b64_tr_b16 v[28:29], v6 offset:1664
    ds_read_b64_tr_b16 v[30:31], v6 offset:5824
    v_mfma_f32_16x16x32_bf16 v[156:159], v[32:35], v[60:63], v[156:159]
    ds_read_b128 v[60:63], v7 offset:768
    v_mfma_f32_16x16x32_bf16 v[152:155], v[32:35], v[56:59], v[152:155]
    v_mfma_f32_16x16x32_bf16 v[148:151], v[32:35], v[52:55], v[148:151]
    v_mfma_f32_16x16x32_bf16 v[144:147], v[32:35], v[80:83], v[144:147]
    ds_read_b64_tr_b16 v[32:33], v6 offset:2176
    ds_read_b64_tr_b16 v[34:35], v6 offset:6336
    v_mfma_f32_16x16x32_bf16 v[156:159], v[36:39], v[56:59], v[156:159]
    ds_read_b128 v[56:59], v7 offset:512
    v_mfma_f32_16x16x32_bf16 v[152:155], v[36:39], v[52:55], v[152:155]
    v_mfma_f32_16x16x32_bf16 v[148:151], v[36:39], v[80:83], v[148:151]
    ds_read_b64_tr_b16 v[36:37], v6 offset:2688
    ds_read_b64_tr_b16 v[38:39], v6 offset:6848
    v_mfma_f32_16x16x32_bf16 v[156:159], v[40:43], v[52:55], v[156:159]
    ds_read_b128 v[52:55], v7 offset:256
    v_mfma_f32_16x16x32_bf16 v[152:155], v[40:43], v[80:83], v[152:155]
    ds_read_b64_tr_b16 v[40:41], v6 offset:3200
    ds_read_b64_tr_b16 v[42:43], v6 offset:7360
    v_mfma_f32_16x16x32_bf16 v[156:159], v[44:47], v[80:83], v[156:159]
    ds_read_b64_tr_b16 v[44:45], v6 offset:3712
    ds_read_b64_tr_b16 v[46:47], v6 offset:7872
    s_waitcnt vmcnt(0)
    ds_write_b32 v9, v10 offset:112
    v_add_u32 v6, 128, v6
    v_subrev_u32 v7, 64, v7
    s_add_u32 s58, s58, 1
    s_cmp_lt_u32 s58, 4
    s_cbranch_scc1 F_VLOOP
    s_waitcnt lgkmcnt(0)
    ds_write_b32 v9, v10
    ds_bpermute_b32 v17, v8, v131
    ds_bpermute_b32 v18, v8, v135
    ds_bpermute_b32 v19, v8, v139
    ds_bpermute_b32 v20, v8, v143
    ds_bpermute_b32 v21, v8, v147
    ds_bpermute_b32 v22, v8, v151
    ds_bpermute_b32 v23, v8, v155
    ds_bpermute_b32 v24, v8, v159
    v_mov_b32 v16, 0
    v_add_f32 v97, v97, v128
    v_add_f32 v98, v98, v129
    v_add_f32 v99, v99, v130
    v_add_f32 v101, v101, v132
    v_add_f32 v102, v102, v133
    v_add_f32 v103, v103, v134
    v_add_f32 v105, v105, v136
    v_add_f32 v106, v106, v137
    v_add_f32 v107, v107, v138
    v_add_f32 v109, v109, v140
    v_add_f32 v110, v110, v141
    v_add_f32 v111, v111, v142
    v_add_f32 v113, v113, v144
    v_add_f32 v114, v114, v145
    v_add_f32 v115, v115, v146
    v_add_f32 v117, v117, v148
    v_add_f32 v118, v118, v149
    v_add_f32 v119, v119, v150
    v_add_f32 v121, v121, v152
    v_add_f32 v122, v122, v153
    v_add_f32 v123, v123, v154
    v_add_f32 v125, v125, v156
    v_add_f32 v126, v126, v157
    v_add_f32 v127, v127, v158
    s_waitcnt lgkmcnt(0)
    v_cndmask_b32 v28, v17, v16, s[60:61]
    v_cndmask_b32 v29, v18, v17, s[60:61]
    v_cndmask_b32 v30, v19, v18, s[60:61]
    v_cndmask_b32 v31, v20, v19, s[60:61]
    v_cndmask_b32 v32, v21, v20, s[60:61]
    v_cndmask_b32 v33, v22, v21, s[60:61]
    v_cndmask_b32 v34, v23, v22, s[60:61]
    v_cndmask_b32 v35, v24, v23, s[60:61]
    v_add_f32 v96, v96, v28
    v_add_f32 v100, v100, v29
    v_add_f32 v104, v104, v30
    v_add_f32 v108, v108, v31
    v_add_f32 v112, v112, v32
    v_add_f32 v116, v116, v33
    v_add_f32 v120, v120, v34
    v_add_f32 v124, v124, v35
    v_cvt_pk_bf16_f32 v48, v96, v97
    v_cvt_pk_bf16_f32 v49, v98, v99
    v_cvt_pk_bf16_f32 v50, v100, v101
    v_cvt_pk_bf16_f32 v51, v102, v103
    v_cvt_pk_bf16_f32 v52, v104, v105
    v_cvt_pk_bf16_f32 v53, v106, v107
    v_cvt_pk_bf16_f32 v54, v108, v109
    v_cvt_pk_bf16_f32 v55, v110, v111
    v_cvt_pk_bf16_f32 v56, v112, v113
    v_cvt_pk_bf16_f32 v57, v114, v115
    v_cvt_pk_bf16_f32 v58, v116, v117
    v_cvt_pk_bf16_f32 v59, v118, v119
    v_cvt_pk_bf16_f32 v60, v120, v121
    v_cvt_pk_bf16_f32 v61, v122, v123
    v_cvt_pk_bf16_f32 v62, v124, v125
    v_cvt_pk_bf16_f32 v63, v126, v127
    s_add_u32 s53, s63, 0xc00000
    buffer_store_dwordx4 v[48:51], v1, s[36:39], s53 offen offset:0 sc1
    buffer_store_dwordx4 v[52:55], v1, s[36:39], s53 offen offset:1024 sc1
    buffer_store_dwordx4 v[56:59], v1, s[36:39], s53 offen offset:2048 sc1
    buffer_store_dwordx4 v[60:63], v1, s[36:39], s53 offen offset:3072 sc1
    s_lshr_b32 s69, s35, 6
    s_lshl_b32 s4, s69, 7
    s_add_u32 s4, s4, 0x125000
    s_add_u32 s4, s4, s26
    s_addc_u32 s5, s27, 0
    s_mov_b32 s69, 1
    s_cmp_ge_u32 s34, 2
    s_cbranch_scc0 F_POST
    v_and_b32 v9, 3, v0
    v_lshlrev_b32 v9, 2, v9
    v_and_b32 v11, 4, v0
    v_lshl_add_u32 v9, v11, 3, v9
    v_add_u32 v9, 156192, v9
F_WL:
    ds_read_b32 v11, v9 offset:0
    s_waitcnt lgkmcnt(0)
    v_cmp_ne_u32 vcc, 1, v11
    s_cbranch_vccz F_WL_X
    s_sleep 1
    s_branch F_WL
F_WL_X:
    s_add_u32 s62, s62, 96256
    s_add_u32 s100, s100, 1540096
    s_add_u32 m0, s62, 0
    s_add_u32 s101, s100, 0
    buffer_load_dwordx4 v12, s[40:43], s101 offen lds
    s_add_u32 m0, s62, 2048
    s_add_u32 s101, s100, 32768
    buffer_load_dwordx4 v12, s[40:43], s101 offen lds
    s_add_u32 m0, s62, 4096
    s_add_u32 s101, s100, 65536
    buffer_load_dwordx4 v12, s[40:43], s101 offen lds
    s_add_u32 m0, s62, 6144
    s_add_u32 s101, s100, 98304
    buffer_load_dwordx4 v12, s[40:43], s101 offen lds
    s_add_u32 m0, s62, 8192
    s_add_u32 s101, s100, 131072
    buffer_load_dwordx4 v12, s[40:43], s101 offen lds
    s_add_u32 m0, s62, 10240
    s_add_u32 s101, s100, 163840
    buffer_load_dwordx4 v12, s[40:43], s101 offen lds
    s_add_u32 m0, s62, 12288
    s_add_u32 s101, s100, 196608
    buffer_load_dwordx4 v12, s[40:43], s101 offen lds
    s_add_u32 m0, s62, 14336
    s_add_u32 s101, s100, 229376
    buffer_load_dwordx4 v12, s[40:43], s101 offen lds
    s_add_u32 m0, s62, 16384
    s_add_u32 s101, s100, 262144
    buffer_load_dwordx4 v12, s[40:43], s101 offen lds
    s_add_u32 m0, s62, 18432
    s_add_u32 s101, s100, 294912
    buffer_load_dwordx4 v12, s[40:43], s101 offen lds
    s_add_u32 m0, s62, 20480
    s_add_u32 s101, s100, 327680
    buffer_load_dwordx4 v12, s[40:43], s101 offen lds
    s_add_u32 m0, s62, 22528
    s_add_u32 s101, s100, 360448
    buffer_load_dwordx4 v12, s[40:43], s101 offen lds
    s_add_u32 m0, s62, 24576
    s_add_u32 s101, s100, 393216
    buffer_load_dwordx4 v12, s[40:43], s101 offen lds
    s_add_u32 m0, s62, 26624
    s_add_u32 s101, s100, 425984
    buffer_load_dwordx4 v12, s[40:43], s101 offen lds
    s_add_u32 m0, s62, 28672
    s_add_u32 s101, s100, 458752
    buffer_load_dwordx4 v12, s[40:43], s101 offen lds
    s_add_u32 m0, s62, 30720
    s_add_u32 s101, s100, 491520
    buffer_load_dwordx4 v12, s[40:43], s101 offen lds
    s_waitcnt vmcnt(16)
    s_atomic_add s69, s[4:5], 0
    s_lshl_b32 s58, s34, 2
    s_add_u32 s58, s58, 156200
    v_mov_b32 v9, s58
    s_waitcnt vmcnt(0)
    ds_write_b32 v9, v10
    s_waitcnt lgkmcnt(0)
    s_endpgm
F_POST:
    s_and_b32 s52, s2, 15
    s_lshl_b32 s56, s52, 7
    s_mul_i32 s53, s52, 270336
    s_add_u32 s53, s53, 0xc00000
    s_mov_b32 s44, s22
    s_mov_b32 s45, s23
    s_mov_b32 s46, 0x800000
    s_mov_b32 s47, 0x00020000
    s_mov_b32 s55, 0xffff0000
    s_add_u32 s56, s56, 2048
    s_waitcnt vmcnt(0)
    s_atomic_add s69, s[4:5], 0
    s_lshl_b32 s6, s52, 7
    s_add_u32 s6, s6, 0x125000
    s_add_u32 s6, s6, s26
    s_addc_u32 s7, s27, 0
    s_mov_b32 s101, 0
F_P4:
    s_mov_b32 s54, 0
    s_atomic_add s54, s[6:7], 0 glc
    s_waitcnt lgkmcnt(0)
    s_cmp_ge_u32 s54, 64
    s_cbranch_scc1 F_P4_X
    s_sleep 16
    s_add_u32 s101, s101, 1
    s_cmp_lt_u32 s101, 400000
    s_cbranch_scc1 F_P4
F_P4_X:
    buffer_load_dwordx4 v[48:51], v232, s[36:39], s53 offen sc1
    s_add_u32 s53, s53, 4224
    buffer_load_dwordx4 v[52:55], v232, s[36:39], s53 offen sc1
    s_add_u32 s53, s53, 4224
    buffer_load_dwordx4 v[56:59], v232, s[36:39], s53 offen sc1
    s_add_u32 s53, s53, 4224
    buffer_load_dwordx4 v[60:63], v232, s[36:39], s53 offen sc1
    s_add_u32 s53, s53, 4224
    buffer_load_dwordx4 v[64:67], v232, s[36:39], s53 offen sc1
    s_add_u32 s53, s53, 4224
    buffer_load_dwordx4 v[68:71], v232, s[36:39], s53 offen sc1
    s_add_u32 s53, s53, 4224
    buffer_load_dwordx4 v[72:75], v232, s[36:39], s53 offen sc1
    s_add_u32 s53, s53, 4224
    buffer_load_dwordx4 v[76:79], v232, s[36:39], s53 offen sc1
    s_waitcnt vmcnt(0)
    v_lshlrev_b32 v80, 16, v200
    v_lshlrev_b32 v88, 16, v48
    v_and_b32 v81, s55, v200
    v_lshlrev_b32 v89, 16, v52
    v_lshlrev_b32 v82, 16, v201
    v_lshlrev_b32 v90, 16, v56
    v_and_b32 v83, s55, v201
    v_lshlrev_b32 v91, 16, v60
    v_lshlrev_b32 v84, 16, v202
    v_lshlrev_b32 v92, 16, v64
    v_and_b32 v85, s55, v202
    v_lshlrev_b32 v93, 16, v68
    v_lshlrev_b32 v86, 16, v203
    v_lshlrev_b32 v94, 16, v72
    v_and_b32 v87, s55, v203
    v_lshlrev_b32 v95, 16, v76
    v_mul_f32 v80, v80, v88
    v_mul_f32 v81, v81, v89
    v_mul_f32 v82, v82, v90
    v_mul_f32 v83, v83, v91
    v_mul_f32 v84, v84, v92
    v_mul_f32 v85, v85, v93
    v_mul_f32 v86, v86, v94
    v_mul_f32 v87, v87, v95
    v_cvt_pk_bf16_f32 v100, v80, v81
    v_cvt_pk_bf16_f32 v101, v82, v83
    v_cvt_pk_bf16_f32 v102, v84, v85
    v_cvt_pk_bf16_f32 v103, v86, v87
    s_add_u32 s57, s56, 0
    buffer_store_dwordx4 v[100:103], v233, s[44:47], s57 offen sc1
    v_lshlrev_b32 v80, 16, v204
    v_and_b32 v88, s55, v48
    v_and_b32 v81, s55, v204
    v_and_b32 v89, s55, v52
    v_lshlrev_b32 v82, 16, v205
    v_and_b32 v90, s55, v56
    v_and_b32 v83, s55, v205
    v_and_b32 v91, s55, v60
    v_lshlrev_b32 v84, 16, v206
    v_and_b32 v92, s55, v64
    v_and_b32 v85, s55, v206
    v_and_b32 v93, s55, v68
    v_lshlrev_b32 v86, 16, v207
    v_and_b32 v94, s55, v72
    v_and_b32 v87, s55, v207
    v_and_b32 v95, s55, v76
    v_mul_f32 v80, v80, v88
    v_mul_f32 v81, v81, v89
    v_mul_f32 v82, v82, v90
    v_mul_f32 v83, v83, v91
    v_mul_f32 v84, v84, v92
    v_mul_f32 v85, v85, v93
    v_mul_f32 v86, v86, v94
    v_mul_f32 v87, v87, v95
    v_cvt_pk_bf16_f32 v104, v80, v81
    v_cvt_pk_bf16_f32 v105, v82, v83
    v_cvt_pk_bf16_f32 v106, v84, v85
    v_cvt_pk_bf16_f32 v107, v86, v87
    s_add_u32 s57, s56, 4096
    buffer_store_dwordx4 v[104:107], v233, s[44:47], s57 offen sc1
    v_lshlrev_b32 v80, 16, v208
    v_lshlrev_b32 v88, 16, v49
    v_and_b32 v81, s55, v208
    v_lshlrev_b32 v89, 16, v53
    v_lshlrev_b32 v82, 16, v209
    v_lshlrev_b32 v90, 16, v57
    v_and_b32 v83, s55, v209
    v_lshlrev_b32 v91, 16, v61
    v_lshlrev_b32 v84, 16, v210
    v_lshlrev_b32 v92, 16, v65
    v_and_b32 v85, s55, v210
    v_lshlrev_b32 v93, 16, v69
    v_lshlrev_b32 v86, 16, v211
    v_lshlrev_b32 v94, 16, v73
    v_and_b32 v87, s55, v211
    v_lshlrev_b32 v95, 16, v77
    v_mul_f32 v80, v80, v88
    v_mul_f32 v81, v81, v89
    v_mul_f32 v82, v82, v90
    v_mul_f32 v83, v83, v91
    v_mul_f32 v84, v84, v92
    v_mul_f32 v85, v85, v93
    v_mul_f32 v86, v86, v94
    v_mul_f32 v87, v87, v95
    v_cvt_pk_bf16_f32 v108, v80, v81
    v_cvt_pk_bf16_f32 v109, v82, v83
    v_cvt_pk_bf16_f32 v110, v84, v85
    v_cvt_pk_bf16_f32 v111, v86, v87
    s_add_u32 s57, s56, 8192
    buffer_store_dwordx4 v[108:111], v233, s[44:47], s57 offen sc1
    v_lshlrev_b32 v80, 16, v212
    v_and_b32 v88, s55, v49
    v_and_b32 v81, s55, v212
    v_and_b32 v89, s55, v53
    v_lshlrev_b32 v82, 16, v213
    v_and_b32 v90, s55, v57
    v_and_b32 v83, s55, v213
    v_and_b32 v91, s55, v61
    v_lshlrev_b32 v84, 16, v214
    v_and_b32 v92, s55, v65
    v_and_b32 v85, s55, v214
    v_and_b32 v93, s55, v69
    v_lshlrev_b32 v86, 16, v215
    v_and_b32 v94, s55, v73
    v_and_b32 v87, s55, v215
    v_and_b32 v95, s55, v77
    v_mul_f32 v80, v80, v88
    v_mul_f32 v81, v81, v89
    v_mul_f32 v82, v82, v90
    v_mul_f32 v83, v83, v91
    v_mul_f32 v84, v84, v92
    v_mul_f32 v85, v85, v93
    v_mul_f32 v86, v86, v94
    v_mul_f32 v87, v87, v95
    v_cvt_pk_bf16_f32 v112, v80, v81
    v_cvt_pk_bf16_f32 v113, v82, v83
    v_cvt_pk_bf16_f32 v114, v84, v85
    v_cvt_pk_bf16_f32 v115, v86, v87
    s_add_u32 s57, s56, 12288
    buffer_store_dwordx4 v[112:115], v233, s[44:47], s57 offen sc1
    v_lshlrev_b32 v80, 16, v216
    v_lshlrev_b32 v88, 16, v50
    v_and_b32 v81, s55, v216
    v_lshlrev_b32 v89, 16, v54
    v_lshlrev_b32 v82, 16, v217
    v_lshlrev_b32 v90, 16, v58
    v_and_b32 v83, s55, v217
    v_lshlrev_b32 v91, 16, v62
    v_lshlrev_b32 v84, 16, v218
    v_lshlrev_b32 v92, 16, v66
    v_and_b32 v85, s55, v218
    v_lshlrev_b32 v93, 16, v70
    v_lshlrev_b32 v86, 16, v219
    v_lshlrev_b32 v94, 16, v74
    v_and_b32 v87, s55, v219
    v_lshlrev_b32 v95, 16, v78
    v_mul_f32 v80, v80, v88
    v_mul_f32 v81, v81, v89
    v_mul_f32 v82, v82, v90
    v_mul_f32 v83, v83, v91
    v_mul_f32 v84, v84, v92
    v_mul_f32 v85, v85, v93
    v_mul_f32 v86, v86, v94
    v_mul_f32 v87, v87, v95
    v_cvt_pk_bf16_f32 v116, v80, v81
    v_cvt_pk_bf16_f32 v117, v82, v83
    v_cvt_pk_bf16_f32 v118, v84, v85
    v_cvt_pk_bf16_f32 v119, v86, v87
    s_add_u32 s57, s56, 1048576
    buffer_store_dwordx4 v[116:119], v233, s[44:47], s57 offen sc1
    v_lshlrev_b32 v80, 16, v220
    v_and_b32 v88, s55, v50
    v_and_b32 v81, s55, v220
    v_and_b32 v89, s55, v54
    v_lshlrev_b32 v82, 16, v221
    v_and_b32 v90, s55, v58
    v_and_b32 v83, s55, v221
    v_and_b32 v91, s55, v62
    v_lshlrev_b32 v84, 16, v222
    v_and_b32 v92, s55, v66
    v_and_b32 v85, s55, v222
    v_and_b32 v93, s55, v70
    v_lshlrev_b32 v86, 16, v223
    v_and_b32 v94, s55, v74
    v_and_b32 v87, s55, v223
    v_and_b32 v95, s55, v78
    v_mul_f32 v80, v80, v88
    v_mul_f32 v81, v81, v89
    v_mul_f32 v82, v82, v90
    v_mul_f32 v83, v83, v91
    v_mul_f32 v84, v84, v92
    v_mul_f32 v85, v85, v93
    v_mul_f32 v86, v86, v94
    v_mul_f32 v87, v87, v95
    v_cvt_pk_bf16_f32 v120, v80, v81
    v_cvt_pk_bf16_f32 v121, v82, v83
    v_cvt_pk_bf16_f32 v122, v84, v85
    v_cvt_pk_bf16_f32 v123, v86, v87
    s_add_u32 s57, s56, 1052672
    buffer_store_dwordx4 v[120:123], v233, s[44:47], s57 offen sc1
    v_lshlrev_b32 v80, 16, v224
    v_lshlrev_b32 v88, 16, v51
    v_and_b32 v81, s55, v224
    v_lshlrev_b32 v89, 16, v55
    v_lshlrev_b32 v82, 16, v225
    v_lshlrev_b32 v90, 16, v59
    v_and_b32 v83, s55, v225
    v_lshlrev_b32 v91, 16, v63
    v_lshlrev_b32 v84, 16, v226
    v_lshlrev_b32 v92, 16, v67
    v_and_b32 v85, s55, v226
    v_lshlrev_b32 v93, 16, v71
    v_lshlrev_b32 v86, 16, v227
    v_lshlrev_b32 v94, 16, v75
    v_and_b32 v87, s55, v227
    v_lshlrev_b32 v95, 16, v79
    v_mul_f32 v80, v80, v88
    v_mul_f32 v81, v81, v89
    v_mul_f32 v82, v82, v90
    v_mul_f32 v83, v83, v91
    v_mul_f32 v84, v84, v92
    v_mul_f32 v85, v85, v93
    v_mul_f32 v86, v86, v94
    v_mul_f32 v87, v87, v95
    v_cvt_pk_bf16_f32 v124, v80, v81
    v_cvt_pk_bf16_f32 v125, v82, v83
    v_cvt_pk_bf16_f32 v126, v84, v85
    v_cvt_pk_bf16_f32 v127, v86, v87
    s_add_u32 s57, s56, 1056768
    buffer_store_dwordx4 v[124:127], v233, s[44:47], s57 offen sc1
    v_lshlrev_b32 v80, 16, v228
    v_and_b32 v88, s55, v51
    v_and_b32 v81, s55, v228
    v_and_b32 v89, s55, v55
    v_lshlrev_b32 v82, 16, v229
    v_and_b32 v90, s55, v59
    v_and_b32 v83, s55, v229
    v_and_b32 v91, s55, v63
    v_lshlrev_b32 v84, 16, v230
    v_and_b32 v92, s55, v67
    v_and_b32 v85, s55, v230
    v_and_b32 v93, s55, v71
    v_lshlrev_b32 v86, 16, v231
    v_and_b32 v94, s55, v75
    v_and_b32 v87, s55, v231
    v_and_b32 v95, s55, v79
    v_mul_f32 v80, v80, v88
    v_mul_f32 v81, v81, v89
    v_mul_f32 v82, v82, v90
    v_mul_f32 v83, v83, v91
    v_mul_f32 v84, v84, v92
    v_mul_f32 v85, v85, v93
    v_mul_f32 v86, v86, v94
    v_mul_f32 v87, v87, v95
    v_cvt_pk_bf16_f32 v128, v80, v81
    v_cvt_pk_bf16_f32 v129, v82, v83
    v_cvt_pk_bf16_f32 v130, v84, v85
    v_cvt_pk_bf16_f32 v131, v86, v87
    s_add_u32 s57, s56, 1060864
    buffer_store_dwordx4 v[128:131], v233, s[44:47], s57 offen sc1
    s_endpgm
F_C:
    s_load_dwordx8 s[20:27], s[0:1], 64
    s_and_b32 s32, s29, 3
    s_lshr_b32 s33, s28, 1
    s_lshl_b32 s33, s33, 2
    s_add_u32 s32, s32, s33
    s_and_b32 s33, s28, 1
    s_lshl_b32 s33, s33, 3
    s_lshr_b32 s35, s29, 2
    s_add_u32 s33, s33, s35
    v_lshlrev_b32 v1, 4, v0
    s_lshr_b32 s34, s3, 1
    s_and_b32 s35, s3, 1
    v_and_b32 v16, 15, v0
    v_lshrrev_b32 v17, 4, v0
    v_lshrrev_b32 v18, 1, v16
    v_xor_b32 v18, v18, v17
    v_lshlrev_b32 v18, 4, v18
    v_and_b32 v19, 7, v0
    v_lshl_add_u32 v18, v19, 7, v18
    v_bfe_u32 v19, v0, 3, 1
    v_mul_u32_u24 v19, 10240, v19
    s_lshl_b32 s40, s34, 11
    s_add_u32 s40, s40, 40960
    v_add3_u32 v2, v18, v19, s40
    v_xor_b32 v3, 64, v2
    v_bfe_u32 v18, v0, 2, 2
    v_lshlrev_b32 v18, 7, v18
    v_and_b32 v19, 3, v0
    v_lshl_add_u32 v18, v19, 3, v18
    v_bfe_u32 v19, v0, 3, 2
    v_lshlrev_b32 v19, 5, v19
    v_lshl_add_u32 v207, v17, 9, v18
    v_add_u32 v207, v207, v19
    s_lshl_b32 s40, s35, 6
    s_lshl_b32 s41, s34, 5
    s_or_b32 s40, s40, s41
    v_xor_b32 v19, s40, v19
    v_mul_u32_u24 v20, 10240, v17
    v_add3_u32 v18, v18, v19, v20
    v_add_u32 v4, 45056, v18
    v_xor_b32 v5, 32, v4
    v_mov_b32 v18, 0
    v_lshlrev_b32 v19, 2, v0
    v_add_u32 v20, 156160, v19
    ds_write_b32 v20, v18
    s_mov_b32 s42, 0x358637bd
    s_mov_b32 s43, 0x3fb8aa3b
    s_mov_b32 s49, 0x3f803f80
    v_mov_b32 v104, s42
    v_mov_b32 v105, s42
    v_mov_b32 v106, s42
    v_mov_b32 v107, s42
    v_mov_b32 v108, s42
    v_mov_b32 v109, s42
    v_mov_b32 v110, s42
    v_mov_b32 v111, s42
    v_mov_b32 v112, s42
    v_mov_b32 v113, s42
    v_mov_b32 v114, s42
    v_mov_b32 v115, s42
    v_mov_b32 v116, s42
    v_mov_b32 v117, s42
    v_mov_b32 v118, s42
    v_mov_b32 v119, s42
    v_mov_b32 v120, s42
    v_mov_b32 v121, s42
    v_mov_b32 v122, s42
    v_mov_b32 v123, s42
    v_mov_b32 v124, s42
    v_mov_b32 v125, s42
    v_mov_b32 v126, s42
    v_mov_b32 v127, s42
    v_mov_b32 v128, s42
    v_mov_b32 v129, s42
    v_mov_b32 v130, s42
    v_mov_b32 v131, s42
    v_mov_b32 v132, s42
    v_mov_b32 v133, s42
    v_mov_b32 v134, s42
    v_mov_b32 v135, s42
    v_mov_b32 v136, 0
    v_mov_b32 v137, 0
    v_mov_b32 v138, 0
    v_mov_b32 v139, 0
    v_mov_b32 v140, 0
    v_mov_b32 v141, 0
    v_mov_b32 v142, 0
    v_mov_b32 v143, 0
    v_mov_b32 v144, 0
    v_mov_b32 v145, 0
    v_mov_b32 v146, 0
    v_mov_b32 v147, 0
    v_mov_b32 v148, 0
    v_mov_b32 v149, 0
    v_mov_b32 v150, 0
    v_mov_b32 v151, 0
    v_mov_b32 v152, 0
    v_mov_b32 v153, 0
    v_mov_b32 v154, 0
    v_mov_b32 v155, 0
    v_mov_b32 v156, 0
    v_mov_b32 v157, 0
    v_mov_b32 v158, 0
    v_mov_b32 v159, 0
    v_mov_b32 v160, 0
    v_mov_b32 v161, 0
    v_mov_b32 v162, 0
    v_mov_b32 v163, 0
    v_mov_b32 v164, 0
    v_mov_b32 v165, 0
    v_mov_b32 v166, 0
    v_mov_b32 v167, 0
    v_mov_b32 v168, s42
    v_mov_b32 v169, s42
    v_mov_b32 v170, s42
    v_mov_b32 v171, s42
    v_mov_b32 v172, s42
    v_mov_b32 v173, s42
    v_mov_b32 v174, s42
    v_mov_b32 v175, s42
    v_mov_b32 v176, s42
    v_mov_b32 v177, s42
    v_mov_b32 v178, s42
    v_mov_b32 v179, s42
    v_mov_b32 v180, s42
    v_mov_b32 v181, s42
    v_mov_b32 v182, s42
    v_mov_b32 v183, s42
    v_mov_b32 v184, s42
    v_mov_b32 v185, s42
    v_mov_b32 v186, s42
    v_mov_b32 v187, s42
    v_mov_b32 v188, s42
    v_mov_b32 v189, s42
    v_mov_b32 v190, s42
    v_mov_b32 v191, s42
    v_mov_b32 v192, s42
    v_mov_b32 v193, s42
    v_mov_b32 v194, s42
    v_mov_b32 v195, s42
    v_mov_b32 v196, s42
    v_mov_b32 v197, s42
    v_mov_b32 v198, s42
    v_mov_b32 v199, s42
    s_and_b32 s40, s3, 1
    s_lshl_b32 s41, s31, 1
    s_add_u32 s40, s40, s41
    s_lshr_b32 s41, s3, 1
    s_lshl_b32 s52, s30, 1
    s_add_u32 s52, s52, s41
    s_mul_i32 s52, s52, 132
    s_add_u32 s52, s52, s40
    s_lshl_b32 s52, s52, 10
    s_add_u32 s52, s52, 0x200000
    s_lshl_b32 s50, s40, 15
    s_lshl_b32 s51, s41, 10
    s_add_u32 s53, s50, s51
    s_lshl_b32 s50, s30, 11
    s_add_u32 s50, s50, s53
    s_lshl_b32 s40, s40, 11
    s_add_u32 s54, s40, s51
    s_add_u32 s54, s54, 0x100000
    s_lshl_b32 s51, s30, 6
    s_add_u32 s51, s51, s54
    s_mul_i32 s40, s35, 2304
    s_add_u32 s58, s40, 156416
    s_add_u32 s59, s40, 116736
    s_cmp_eq_u32 s34, 0
    s_cselect_b32 s40, s58, s59
    s_cselect_b32 s41, s59, s58
    v_lshlrev_b32 v12, 4, v17
    v_add_u32 v6, s40, v1
    v_add_u32 v7, s41, v1
    v_add_u32 v8, s40, v12
    v_add_u32 v9, s41, v12
    s_lshl_b32 s40, s3, 3
    s_add_u32 s41, s40, 156160
    v_mov_b32 v10, s41
    v_xor_b32 v11, 16, v10
    v_lshl_add_u32 v13, v16, 6, v12
    s_lshl_b32 s40, s34, 3
    s_add_u32 s41, s59, s40
    v_add_u32 v200, s41, v1
    v_xor_b32 v201, 8, v200
    s_add_u32 s41, s58, s40
    v_add_u32 v203, s41, v1
    v_xor_b32 v202, 8, v203
    s_lshl_b32 s40, s3, 2
    s_add_u32 s41, s40, 156240
    v_mov_b32 v204, s41
    s_add_u32 s41, s40, 156224
    v_mov_b32 v206, s41
    v_lshlrev_b32 v18, 1, v17
    v_and_b32 v20, 7, v0
    v_xor_b32 v18, v18, v20
    v_lshlrev_b32 v18, 4, v18
    v_lshrrev_b32 v20, 3, v0
    v_lshl_add_u32 v205, v20, 11, v18
    v_mov_b32 v14, 1
    v_and_b32 v18, 12, v19
    v_add_u32 v209, 156160, v18
    v_add_u32 v211, 144, v209
    v_add_u32 v20, 144, v209
    v_subrev_u32 v21, 12, v0
    v_cmp_gt_u32 vcc, 12, v21
    v_and_b32 v18, 4, v19
    v_add_u32 v18, 156208, v18
    v_cndmask_b32 v211, v211, v20, vcc
    v_and_b32 v21, 31, v0
    v_cmp_lt_u32 vcc, 23, v21
    s_nop 1
    v_cndmask_b32 v211, v211, v18, vcc
    s_lshl_b32 s55, s32, 2
    s_add_u32 s55, s55, s3
    s_lshl_b32 s56, s55, 17
    s_lshl_b32 s40, s33, 7
    s_add_u32 s56, s56, s40
    s_mul_i32 s55, s55, 67584
    s_add_u32 s55, s55, 0x200000
    v_and_b32 v18, 31, v0
    v_add_u32 v18, 33, v18
    s_xor_b32 s40, s35, 1
    s_mul_i32 s40, s40, 66
    v_add_u32 v18, s40, v18
    v_lshlrev_b32 v208, 10, v18
    s_and_b32 s57, s33, 7
    s_mul_i32 s57, s57, 3
    s_lshr_b32 s57, s57, 2
    v_lshlrev_b32 v210, 12, v16
    v_bfe_u32 v18, v0, 4, 1
    v_lshl_add_u32 v210, v18, 5, v210
    v_lshrrev_b32 v18, 5, v0
    v_lshl_add_u32 v210, v18, 4, v210
    s_mov_b32 s44, 0
    s_mov_b32 s45, 1
    s_mov_b32 s46, 0xfffec000
    s_mov_b32 s47, 40960
    s_waitcnt lgkmcnt(0)
    s_mov_b32 s36, s26
    s_mov_b32 s37, s27
    s_mov_b32 s38, 0x10000000
    s_mov_b32 s39, 0x00020000
    s_mov_b32 s60, s22
    s_mov_b32 s61, s23
    s_mov_b32 s62, 0x800000
    s_mov_b32 s63, 0x00020000
    s_mov_b32 s64, s26
    s_mov_b32 s65, s27
    s_mov_b32 s66, 0x10000000
    s_mov_b32 s67, 0x00020000
    s_cmp_lg_u32 s2, 0
    s_cbranch_scc1 F_NOINIT
    v_mov_b32 v20, 0
    v_mov_b32 v21, 0
    v_mov_b32 v22, 0
    v_mov_b32 v23, 0
    s_mul_i32 s40, s3, 6144
    s_add_u32 s40, s40, 0x120000
    s_add_u32 s41, s40, 4096
    buffer_store_dwordx4 v[20:23], v1, s[36:39], s40 offen offset:0 sc1
    buffer_store_dwordx4 v[20:23], v1, s[36:39], s40 offen offset:1024 sc1
    buffer_store_dwordx4 v[20:23], v1, s[36:39], s40 offen offset:2048 sc1
    buffer_store_dwordx4 v[20:23], v1, s[36:39], s40 offen offset:3072 sc1
    buffer_store_dwordx4 v[20:23], v1, s[36:39], s41 offen offset:0 sc1
    buffer_store_dwordx4 v[20:23], v1, s[36:39], s41 offen offset:1024 sc1
    s_mov_b32 s40, 1
    s_waitcnt vmcnt(0)
    s_atomic_add s40, s[24:25], 0
    s_waitcnt lgkmcnt(0)
F_NOINIT:
    s_lshl_b32 s40, s31, 2
    s_lshl_b32 s41, s35, 1
    s_add_u32 s40, s40, s41
    s_add_u32 s40, s40, s34
    s_lshl_b32 s10, s40, 7
    s_add_u32 s10, s10, 0x122000
    s_add_u32 s10, s10, s26
    s_addc_u32 s11, s27, 0
    s_lshl_b32 s40, s30, 1
    s_add_u32 s40, s40, s34
    s_lshl_b32 s12, s40, 7
    s_add_u32 s12, s12, 0x124000
    s_add_u32 s12, s12, s26
    s_addc_u32 s13, s27, 0
    s_lshl_b32 s40, s32, 1
    s_add_u32 s40, s40, s34
    s_lshl_b32 s14, s40, 7
    s_add_u32 s14, s14, 0x124000
    s_add_u32 s14, s14, s26
    s_addc_u32 s15, s27, 0
    s_lshr_b32 s40, s31, 1
    s_lshl_b32 s40, s40, 2
    s_lshl_b32 s16, 1, s40
    s_mov_b32 s4, s8
    s_mov_b32 s5, s9
    s_mov_b32 s6, 0x200000
    s_mov_b32 s7, 0x00020000
    s_lshl_b32 s68, s3, 10
    s_lshl_b32 s69, s3, 14
    s_lshl_b32 s40, s33, 7
    s_add_u32 s69, s69, s40
    s_barrier
    ds_read_b64_tr_b16 v[80:81], v4 offset:1024
    ds_read_b64_tr_b16 v[82:83], v4 offset:1536
    ds_read_b128 v[16:19], v2 offset:0
    ds_read_b64_tr_b16 v[84:85], v4 offset:4096
    ds_read_b64_tr_b16 v[86:87], v4 offset:4608
    ds_read_b128 v[20:23], v3 offset:0
    ds_read_b128 v[24:27], v2 offset:20480
    ds_read_b128 v[28:31], v3 offset:20480
    ds_read_b128 v[32:35], v2 offset:1024
    ds_read_b128 v[36:39], v3 offset:1024
    ds_read_b64_tr_b16 v[88:89], v5 offset:1024
    ds_read_b64_tr_b16 v[90:91], v5 offset:1536
    ds_read_b64_tr_b16 v[92:93], v5 offset:4096
    ds_read_b64_tr_b16 v[94:95], v5 offset:4608
    ds_read_b128 v[40:43], v2 offset:21504
    ds_read_b128 v[44:47], v3 offset:21504
.p2align 6
F_CLOOP:
    s_waitcnt lgkmcnt(8)
    v_mfma_f32_16x16x32_bf16 v[104:107], v[16:19], v[80:83], v[104:107]
    ds_read_b64_tr_b16 v[96:97], v4 offset:2048
    v_mfma_f32_16x16x32_bf16 v[104:107], v[20:23], v[84:87], v[104:107]
    ds_read_b64_tr_b16 v[98:99], v4 offset:2560
    v_mfma_f32_16x16x32_bf16 v[108:111], v[24:27], v[80:83], v[108:111]
    ds_read_b64_tr_b16 v[100:101], v4 offset:5120
    v_mfma_f32_16x16x32_bf16 v[108:111], v[28:31], v[84:87], v[108:111]
    ds_read_b64_tr_b16 v[102:103], v4 offset:5632
    s_waitcnt lgkmcnt(4)
    v_mfma_f32_16x16x32_bf16 v[112:115], v[32:35], v[80:83], v[112:115]
    v_mfma_f32_16x16x32_bf16 v[112:115], v[36:39], v[84:87], v[112:115]
    v_mfma_f32_16x16x32_bf16 v[116:119], v[40:43], v[80:83], v[116:119]
    v_mfma_f32_16x16x32_bf16 v[116:119], v[44:47], v[84:87], v[116:119]
    v_mfma_f32_16x16x32_bf16 v[120:123], v[16:19], v[88:91], v[120:123]
    ds_read_b64_tr_b16 v[80:81], v5 offset:2048
    v_mfma_f32_16x16x32_bf16 v[120:123], v[20:23], v[92:95], v[120:123]
    ds_read_b64_tr_b16 v[82:83], v5 offset:2560
    v_mfma_f32_16x16x32_bf16 v[124:127], v[24:27], v[88:91], v[124:127]
    ds_read_b64_tr_b16 v[84:85], v5 offset:5120
    v_mfma_f32_16x16x32_bf16 v[124:127], v[28:31], v[92:95], v[124:127]
    ds_read_b64_tr_b16 v[86:87], v5 offset:5632
    v_mfma_f32_16x16x32_bf16 v[128:131], v[32:35], v[88:91], v[128:131]
    v_mfma_f32_16x16x32_bf16 v[128:131], v[36:39], v[92:95], v[128:131]
    v_mfma_f32_16x16x32_bf16 v[132:135], v[40:43], v[88:91], v[132:135]
    v_mfma_f32_16x16x32_bf16 v[132:135], v[44:47], v[92:95], v[132:135]
    s_waitcnt lgkmcnt(4)
    v_mfma_f32_16x16x32_bf16 v[136:139], v[16:19], v[96:99], v[136:139]
    ds_read_b64_tr_b16 v[88:89], v4 offset:0
    v_mfma_f32_16x16x32_bf16 v[136:139], v[20:23], v[100:103], v[136:139]
    ds_read_b64_tr_b16 v[90:91], v4 offset:512
    v_mfma_f32_16x16x32_bf16 v[140:143], v[24:27], v[96:99], v[140:143]
    ds_read_b64_tr_b16 v[92:93], v4 offset:3072
    v_mfma_f32_16x16x32_bf16 v[140:143], v[28:31], v[100:103], v[140:143]
    ds_read_b64_tr_b16 v[94:95], v4 offset:3584
    v_mfma_f32_16x16x32_bf16 v[144:147], v[32:35], v[96:99], v[144:147]
    v_mfma_f32_16x16x32_bf16 v[144:147], v[36:39], v[100:103], v[144:147]
    s_add_u32 s44, s44, 1
    v_mfma_f32_16x16x32_bf16 v[148:151], v[40:43], v[96:99], v[148:151]
    v_mfma_f32_16x16x32_bf16 v[148:151], v[44:47], v[100:103], v[148:151]
    s_waitcnt lgkmcnt(4)
    v_mfma_f32_16x16x32_bf16 v[152:155], v[16:19], v[80:83], v[152:155]
    ds_read_b64_tr_b16 v[96:97], v5 offset:0
    v_mfma_f32_16x16x32_bf16 v[152:155], v[20:23], v[84:87], v[152:155]
    ds_read_b64_tr_b16 v[98:99], v5 offset:512
    v_mfma_f32_16x16x32_bf16 v[156:159], v[24:27], v[80:83], v[156:159]
    ds_read_b64_tr_b16 v[100:101], v5 offset:3072
    v_mfma_f32_16x16x32_bf16 v[156:159], v[28:31], v[84:87], v[156:159]
    ds_read_b64_tr_b16 v[102:103], v5 offset:3584
    v_mfma_f32_16x16x32_bf16 v[160:163], v[32:35], v[80:83], v[160:163]
    s_add_u32 s45, s45, 1
    s_cmp_eq_u32 s45, 3
    v_mfma_f32_16x16x32_bf16 v[160:163], v[36:39], v[84:87], v[160:163]
    s_cselect_b32 s48, s46, s47
    s_cselect_b32 s45, 0, s45
    v_mfma_f32_16x16x32_bf16 v[164:167], v[40:43], v[80:83], v[164:167]
    v_add_u32 v4, s48, v4
    v_add_u32 v2, s48, v2
    v_mfma_f32_16x16x32_bf16 v[164:167], v[44:47], v[84:87], v[164:167]
    v_add_u32 v3, s48, v3
    v_add_u32 v5, s48, v5
    s_waitcnt lgkmcnt(0)
    v_mfma_f32_16x16x32_bf16 v[168:171], v[88:91], v[16:19], v[168:171]
    s_cmp_lt_u32 s44, 8
    s_cbranch_scc0 F_CNB0
    s_barrier
F_CB0:
    v_mfma_f32_16x16x32_bf16 v[168:171], v[92:95], v[20:23], v[168:171]
    ds_read_b64_tr_b16 v[80:81], v4 offset:1024
    ds_read_b64_tr_b16 v[82:83], v4 offset:1536
    v_mfma_f32_16x16x32_bf16 v[172:175], v[88:91], v[24:27], v[172:175]
    ds_read_b128 v[48:51], v2 offset:0
    ds_read_b64_tr_b16 v[84:85], v4 offset:4096
    v_mfma_f32_16x16x32_bf16 v[172:175], v[92:95], v[28:31], v[172:175]
    ds_read_b64_tr_b16 v[86:87], v4 offset:4608
    v_mfma_f32_16x16x32_bf16 v[176:179], v[88:91], v[32:35], v[176:179]
    ds_read_b128 v[52:55], v3 offset:0
    v_mfma_f32_16x16x32_bf16 v[176:179], v[92:95], v[36:39], v[176:179]
    ds_read_b128 v[56:59], v2 offset:20480
    v_mfma_f32_16x16x32_bf16 v[180:183], v[88:91], v[40:43], v[180:183]
    ds_read_b128 v[60:63], v3 offset:20480
    v_mfma_f32_16x16x32_bf16 v[180:183], v[92:95], v[44:47], v[180:183]
    v_mfma_f32_16x16x32_bf16 v[184:187], v[96:99], v[16:19], v[184:187]
    ds_read_b128 v[64:67], v2 offset:1024
    ds_read_b128 v[68:71], v3 offset:1024
    v_mfma_f32_16x16x32_bf16 v[184:187], v[100:103], v[20:23], v[184:187]
    ds_read_b64_tr_b16 v[88:89], v5 offset:1024
    ds_read_b64_tr_b16 v[90:91], v5 offset:1536
    v_mfma_f32_16x16x32_bf16 v[188:191], v[96:99], v[24:27], v[188:191]
    ds_read_b64_tr_b16 v[92:93], v5 offset:4096
    ds_read_b64_tr_b16 v[94:95], v5 offset:4608
    v_mfma_f32_16x16x32_bf16 v[188:191], v[100:103], v[28:31], v[188:191]
    ds_read_b128 v[72:75], v2 offset:21504
    v_mfma_f32_16x16x32_bf16 v[192:195], v[96:99], v[32:35], v[192:195]
    ds_read_b128 v[76:79], v3 offset:21504
    v_mfma_f32_16x16x32_bf16 v[192:195], v[100:103], v[36:39], v[192:195]
    v_mfma_f32_16x16x32_bf16 v[196:199], v[96:99], v[40:43], v[196:199]
    v_mfma_f32_16x16x32_bf16 v[196:199], v[100:103], v[44:47], v[196:199]
    s_waitcnt lgkmcnt(8)
    v_mfma_f32_16x16x32_bf16 v[104:107], v[48:51], v[80:83], v[104:107]
    ds_read_b64_tr_b16 v[96:97], v4 offset:2048
    v_mfma_f32_16x16x32_bf16 v[104:107], v[52:55], v[84:87], v[104:107]
    ds_read_b64_tr_b16 v[98:99], v4 offset:2560
    v_mfma_f32_16x16x32_bf16 v[108:111], v[56:59], v[80:83], v[108:111]
    ds_read_b64_tr_b16 v[100:101], v4 offset:5120
    v_mfma_f32_16x16x32_bf16 v[108:111], v[60:63], v[84:87], v[108:111]
    ds_read_b64_tr_b16 v[102:103], v4 offset:5632
    s_waitcnt lgkmcnt(4)
    v_mfma_f32_16x16x32_bf16 v[112:115], v[64:67], v[80:83], v[112:115]
    v_mfma_f32_16x16x32_bf16 v[112:115], v[68:71], v[84:87], v[112:115]
    v_mfma_f32_16x16x32_bf16 v[116:119], v[72:75], v[80:83], v[116:119]
    v_mfma_f32_16x16x32_bf16 v[116:119], v[76:79], v[84:87], v[116:119]
    v_mfma_f32_16x16x32_bf16 v[120:123], v[48:51], v[88:91], v[120:123]
    ds_read_b64_tr_b16 v[80:81], v5 offset:2048
    v_mfma_f32_16x16x32_bf16 v[120:123], v[52:55], v[92:95], v[120:123]
    ds_read_b64_tr_b16 v[82:83], v5 offset:2560
    v_mfma_f32_16x16x32_bf16 v[124:127], v[56:59], v[88:91], v[124:127]
    ds_read_b64_tr_b16 v[84:85], v5 offset:5120
    v_mfma_f32_16x16x32_bf16 v[124:127], v[60:63], v[92:95], v[124:127]
    ds_read_b64_tr_b16 v[86:87], v5 offset:5632
    v_mfma_f32_16x16x32_bf16 v[128:131], v[64:67], v[88:91], v[128:131]
    v_mfma_f32_16x16x32_bf16 v[128:131], v[68:71], v[92:95], v[128:131]
    v_mfma_f32_16x16x32_bf16 v[132:135], v[72:75], v[88:91], v[132:135]
    v_mfma_f32_16x16x32_bf16 v[132:135], v[76:79], v[92:95], v[132:135]
    s_waitcnt lgkmcnt(4)
    v_mfma_f32_16x16x32_bf16 v[136:139], v[48:51], v[96:99], v[136:139]
    ds_read_b64_tr_b16 v[88:89], v4 offset:0
    v_mfma_f32_16x16x32_bf16 v[136:139], v[52:55], v[100:103], v[136:139]
    ds_read_b64_tr_b16 v[90:91], v4 offset:512
    v_mfma_f32_16x16x32_bf16 v[140:143], v[56:59], v[96:99], v[140:143]
    ds_read_b64_tr_b16 v[92:93], v4 offset:3072
    v_mfma_f32_16x16x32_bf16 v[140:143], v[60:63], v[100:103], v[140:143]
    ds_read_b64_tr_b16 v[94:95], v4 offset:3584
    v_mfma_f32_16x16x32_bf16 v[144:147], v[64:67], v[96:99], v[144:147]
    v_mfma_f32_16x16x32_bf16 v[144:147], v[68:71], v[100:103], v[144:147]
    v_mfma_f32_16x16x32_bf16 v[148:151], v[72:75], v[96:99], v[148:151]
    v_mfma_f32_16x16x32_bf16 v[148:151], v[76:79], v[100:103], v[148:151]
    s_waitcnt lgkmcnt(4)
    v_mfma_f32_16x16x32_bf16 v[152:155], v[48:51], v[80:83], v[152:155]
    ds_read_b64_tr_b16 v[96:97], v5 offset:0
    v_mfma_f32_16x16x32_bf16 v[152:155], v[52:55], v[84:87], v[152:155]
    ds_read_b64_tr_b16 v[98:99], v5 offset:512
    v_mfma_f32_16x16x32_bf16 v[156:159], v[56:59], v[80:83], v[156:159]
    ds_read_b64_tr_b16 v[100:101], v5 offset:3072
    v_mfma_f32_16x16x32_bf16 v[156:159], v[60:63], v[84:87], v[156:159]
    ds_read_b64_tr_b16 v[102:103], v5 offset:3584
    v_mfma_f32_16x16x32_bf16 v[160:163], v[64:67], v[80:83], v[160:163]
    s_add_u32 s45, s45, 1
    s_cmp_eq_u32 s45, 3
    v_mfma_f32_16x16x32_bf16 v[160:163], v[68:71], v[84:87], v[160:163]
    s_cselect_b32 s48, s46, s47
    s_cselect_b32 s45, 0, s45
    v_mfma_f32_16x16x32_bf16 v[164:167], v[72:75], v[80:83], v[164:167]
    v_add_u32 v4, s48, v4
    v_add_u32 v2, s48, v2
    v_mfma_f32_16x16x32_bf16 v[164:167], v[76:79], v[84:87], v[164:167]
    v_add_u32 v3, s48, v3
    v_add_u32 v5, s48, v5
    s_waitcnt lgkmcnt(0)
    v_mfma_f32_16x16x32_bf16 v[168:171], v[88:91], v[48:51], v[168:171]
    s_cmp_lt_u32 s44, 8
    s_cbranch_scc0 F_CNB1
    s_barrier
F_CB1:
    v_mfma_f32_16x16x32_bf16 v[168:171], v[92:95], v[52:55], v[168:171]
    ds_read_b64_tr_b16 v[80:81], v4 offset:1024
    ds_read_b64_tr_b16 v[82:83], v4 offset:1536
    v_mfma_f32_16x16x32_bf16 v[172:175], v[88:91], v[56:59], v[172:175]
    ds_read_b128 v[16:19], v2 offset:0
    ds_read_b64_tr_b16 v[84:85], v4 offset:4096
    v_mfma_f32_16x16x32_bf16 v[172:175], v[92:95], v[60:63], v[172:175]
    ds_read_b64_tr_b16 v[86:87], v4 offset:4608
    v_mfma_f32_16x16x32_bf16 v[176:179], v[88:91], v[64:67], v[176:179]
    ds_read_b128 v[20:23], v3 offset:0
    v_mfma_f32_16x16x32_bf16 v[176:179], v[92:95], v[68:71], v[176:179]
    ds_read_b128 v[24:27], v2 offset:20480
    v_mfma_f32_16x16x32_bf16 v[180:183], v[88:91], v[72:75], v[180:183]
    ds_read_b128 v[28:31], v3 offset:20480
    v_mfma_f32_16x16x32_bf16 v[180:183], v[92:95], v[76:79], v[180:183]
    v_mfma_f32_16x16x32_bf16 v[184:187], v[96:99], v[48:51], v[184:187]
    ds_read_b128 v[32:35], v2 offset:1024
    ds_read_b128 v[36:39], v3 offset:1024
    v_mfma_f32_16x16x32_bf16 v[184:187], v[100:103], v[52:55], v[184:187]
    ds_read_b64_tr_b16 v[88:89], v5 offset:1024
    ds_read_b64_tr_b16 v[90:91], v5 offset:1536
    v_mfma_f32_16x16x32_bf16 v[188:191], v[96:99], v[56:59], v[188:191]
    ds_read_b64_tr_b16 v[92:93], v5 offset:4096
    ds_read_b64_tr_b16 v[94:95], v5 offset:4608
    v_mfma_f32_16x16x32_bf16 v[188:191], v[100:103], v[60:63], v[188:191]
    ds_read_b128 v[40:43], v2 offset:21504
    v_mfma_f32_16x16x32_bf16 v[192:195], v[96:99], v[64:67], v[192:195]
    ds_read_b128 v[44:47], v3 offset:21504
    v_mfma_f32_16x16x32_bf16 v[192:195], v[100:103], v[68:71], v[192:195]
    v_mfma_f32_16x16x32_bf16 v[196:199], v[96:99], v[72:75], v[196:199]
    v_mfma_f32_16x16x32_bf16 v[196:199], v[100:103], v[76:79], v[196:199]
    s_cbranch_scc1 F_CLOOP
    s_setprio 3
    s_mov_b32 s46, s43
    s_mov_b32 s47, s43
    v_mul_f32 v244, s43, v104
    v_mul_f32 v245, s43, v105
    v_mul_f32 v246, s43, v106
    v_mul_f32 v247, s43, v107
    v_mul_f32 v248, s43, v108
    v_mul_f32 v249, s43, v109
    v_mul_f32 v250, s43, v110
    v_mul_f32 v251, s43, v111
    v_exp_f32 v244, v244 clamp
    v_max_f32 v104, s42, v104
    v_exp_f32 v245, v245 clamp
    v_max_f32 v105, s42, v105
    v_exp_f32 v246, v246 clamp
    v_max_f32 v106, s42, v106
    v_exp_f32 v247, v247 clamp
    v_max_f32 v107, s42, v107
    v_exp_f32 v248, v248 clamp
    v_max_f32 v108, s42, v108
    v_exp_f32 v249, v249 clamp
    v_max_f32 v109, s42, v109
    v_exp_f32 v250, v250 clamp
    v_max_f32 v110, s42, v110
    v_exp_f32 v251, v251 clamp
    v_max_f32 v111, s42, v111
    v_add_f32 v244, v244, v104
    v_add_f32 v245, v245, v105
    v_add_f32 v246, v246, v106
    v_add_f32 v247, v247, v107
    v_add_f32 v248, v248, v108
    v_add_f32 v249, v249, v109
    v_add_f32 v250, v250, v110
    v_add_f32 v251, v251, v111
    v_cvt_pk_bf16_f32 v212, v244, v245
    v_cvt_pk_bf16_f32 v213, v246, v247
    v_cvt_pk_bf16_f32 v214, v248, v249
    v_cvt_pk_bf16_f32 v215, v250, v251
    v_mov_b32 v252, s49
    v_mov_b32 v253, s49
    v_mov_b32 v254, s49
    v_mov_b32 v255, s49
    v_cvt_pk_bf16_f32 v228, v136, v137
    v_cvt_pk_bf16_f32 v229, v138, v139
    v_cvt_pk_bf16_f32 v230, v140, v141
    v_cvt_pk_bf16_f32 v231, v142, v143
    v_cvt_pk_bf16_f32 v232, v144, v145
    v_cvt_pk_bf16_f32 v233, v146, v147
    v_cvt_pk_bf16_f32 v234, v148, v149
    v_cvt_pk_bf16_f32 v235, v150, v151
    v_cvt_pk_bf16_f32 v236, v152, v153
    v_cvt_pk_bf16_f32 v237, v154, v155
    v_cvt_pk_bf16_f32 v238, v156, v157
    v_cvt_pk_bf16_f32 v239, v158, v159
    v_cvt_pk_bf16_f32 v240, v160, v161
    v_cvt_pk_bf16_f32 v241, v162, v163
    v_cvt_pk_bf16_f32 v242, v164, v165
    v_cvt_pk_bf16_f32 v243, v166, v167
    v_mfma_f32_16x16x32_bf16 v[140:143], v[212:215], v[236:239], 0
    v_mfma_f32_16x16x32_bf16 v[136:139], v[212:215], v[228:231], 0
    v_mfma_f32_16x16x32_bf16 v[152:155], v[212:215], v[252:255], 0
    v_mul_f32 v244, s43, v120
    v_mul_f32 v245, s43, v121
    v_mul_f32 v246, s43, v122
    v_mul_f32 v247, s43, v123
    v_mul_f32 v248, s43, v124
    v_mul_f32 v249, s43, v125
    v_mul_f32 v250, s43, v126
    v_mul_f32 v251, s43, v127
    v_exp_f32 v244, v244 clamp
    v_max_f32 v120, s42, v120
    v_exp_f32 v245, v245 clamp
    v_max_f32 v121, s42, v121
    v_exp_f32 v246, v246 clamp
    v_max_f32 v122, s42, v122
    v_exp_f32 v247, v247 clamp
    v_max_f32 v123, s42, v123
    v_exp_f32 v248, v248 clamp
    v_max_f32 v124, s42, v124
    v_exp_f32 v249, v249 clamp
    v_max_f32 v125, s42, v125
    v_exp_f32 v250, v250 clamp
    v_max_f32 v126, s42, v126
    v_exp_f32 v251, v251 clamp
    v_max_f32 v127, s42, v127
    v_add_f32 v244, v244, v120
    v_add_f32 v245, v245, v121
    v_add_f32 v246, v246, v122
    v_add_f32 v247, v247, v123
    v_add_f32 v248, v248, v124
    v_add_f32 v249, v249, v125
    v_add_f32 v250, v250, v126
    v_add_f32 v251, v251, v127
    v_cvt_pk_bf16_f32 v216, v244, v245
    v_cvt_pk_bf16_f32 v217, v246, v247
    v_cvt_pk_bf16_f32 v218, v248, v249
    v_cvt_pk_bf16_f32 v219, v250, v251
    s_nop 1
    v_mfma_f32_16x16x32_bf16 v[148:151], v[216:219], v[236:239], 0
    v_mfma_f32_16x16x32_bf16 v[144:147], v[216:219], v[228:231], 0
    v_mfma_f32_16x16x32_bf16 v[156:159], v[216:219], v[252:255], 0
    v_mul_f32 v244, s43, v112
    v_mul_f32 v245, s43, v113
    v_mul_f32 v246, s43, v114
    v_mul_f32 v247, s43, v115
    v_mul_f32 v248, s43, v116
    v_mul_f32 v249, s43, v117
    v_mul_f32 v250, s43, v118
    v_mul_f32 v251, s43, v119
    v_exp_f32 v244, v244 clamp
    v_max_f32 v112, s42, v112
    v_exp_f32 v245, v245 clamp
    v_max_f32 v113, s42, v113
    v_exp_f32 v246, v246 clamp
    v_max_f32 v114, s42, v114
    v_exp_f32 v247, v247 clamp
    v_max_f32 v115, s42, v115
    v_exp_f32 v248, v248 clamp
    v_max_f32 v116, s42, v116
    v_exp_f32 v249, v249 clamp
    v_max_f32 v117, s42, v117
    v_exp_f32 v250, v250 clamp
    v_max_f32 v118, s42, v118
    v_exp_f32 v251, v251 clamp
    v_max_f32 v119, s42, v119
    v_add_f32 v244, v244, v112
    v_add_f32 v245, v245, v113
    v_add_f32 v246, v246, v114
    v_add_f32 v247, v247, v115
    v_add_f32 v248, v248, v116
    v_add_f32 v249, v249, v117
    v_add_f32 v250, v250, v118
    v_add_f32 v251, v251, v119
    v_cvt_pk_bf16_f32 v212, v244, v245
    v_cvt_pk_bf16_f32 v213, v246, v247
    v_cvt_pk_bf16_f32 v214, v248, v249
    v_cvt_pk_bf16_f32 v215, v250, v251
    s_nop 1
    v_mfma_f32_16x16x32_bf16 v[140:143], v[212:215], v[240:243], v[140:143]
    v_mfma_f32_16x16x32_bf16 v[136:139], v[212:215], v[232:235], v[136:139]
    v_mfma_f32_16x16x32_bf16 v[152:155], v[212:215], v[252:255], v[152:155]
    v_mul_f32 v244, s43, v128
    v_mul_f32 v245, s43, v129
    v_mul_f32 v246, s43, v130
    v_mul_f32 v247, s43, v131
    v_mul_f32 v248, s43, v132
    v_mul_f32 v249, s43, v133
    v_mul_f32 v250, s43, v134
    v_mul_f32 v251, s43, v135
    v_exp_f32 v244, v244 clamp
    v_max_f32 v128, s42, v128
    v_exp_f32 v245, v245 clamp
    v_max_f32 v129, s42, v129
    v_exp_f32 v246, v246 clamp
    v_max_f32 v130, s42, v130
    v_exp_f32 v247, v247 clamp
    v_max_f32 v131, s42, v131
    v_exp_f32 v248, v248 clamp
    v_max_f32 v132, s42, v132
    v_exp_f32 v249, v249 clamp
    v_max_f32 v133, s42, v133
    v_exp_f32 v250, v250 clamp
    v_max_f32 v134, s42, v134
    v_exp_f32 v251, v251 clamp
    v_max_f32 v135, s42, v135
    v_add_f32 v244, v244, v128
    v_add_f32 v245, v245, v129
    v_add_f32 v246, v246, v130
    v_add_f32 v247, v247, v131
    v_add_f32 v248, v248, v132
    v_add_f32 v249, v249, v133
    v_add_f32 v250, v250, v134
    v_add_f32 v251, v251, v135
    v_cvt_pk_bf16_f32 v216, v244, v245
    v_cvt_pk_bf16_f32 v217, v246, v247
    v_cvt_pk_bf16_f32 v218, v248, v249
    v_cvt_pk_bf16_f32 v219, v250, v251
    s_nop 1
    v_mfma_f32_16x16x32_bf16 v[148:151], v[216:219], v[240:243], v[148:151]
    v_mfma_f32_16x16x32_bf16 v[144:147], v[216:219], v[232:235], v[144:147]
    v_mfma_f32_16x16x32_bf16 v[156:159], v[216:219], v[252:255], v[156:159]
    ds_write_b128 v6, v[140:143]
    s_nop 4
    ds_write_b128 v6, v[148:151] offset:1024
    s_nop 0
    ds_write_b128 v8, v[156:159] offset:2048
    ds_write_b32 v10, v14
F_XA:
    ds_read_b32 v15, v11
    ds_read_b128 v[212:215], v7 offset:1024
    ds_read_b128 v[216:219], v7
    ds_read_b128 v[220:223], v9 offset:2048
    s_waitcnt lgkmcnt(0)
    v_cmp_ne_u32 vcc, 1, v15
    s_cbranch_vccnz F_XA
    v_add_f32 v212, v212, v136
    v_add_f32 v213, v213, v137
    v_add_f32 v214, v214, v138
    v_add_f32 v215, v215, v139
    v_add_f32 v216, v216, v144
    v_add_f32 v217, v217, v145
    v_add_f32 v218, v218, v146
    v_add_f32 v219, v219, v147
    v_cvt_pk_bf16_f32 v224, v212, v213
    v_cvt_pk_bf16_f32 v225, v214, v215
    v_cvt_pk_bf16_f32 v226, v216, v217
    v_cvt_pk_bf16_f32 v227, v218, v219
    buffer_store_dwordx4 v[224:227], v1, s[36:39], s50 offen sc1
    v_add_f32 v220, v220, v152
    v_add_f32 v221, v221, v153
    v_add_f32 v222, v222, v154
    v_add_f32 v223, v223, v155
    s_mov_b32 exec_lo, 0x00010001
    s_mov_b32 exec_hi, 0x00010001
    buffer_store_dwordx4 v[220:223], v12, s[36:39], s51 offen sc1
    s_mov_b64 exec, -1
    v_mov_b32 v112, s42
    v_mov_b32 v113, s42
    v_mov_b32 v114, s42
    v_mov_b32 v115, s42
    v_bfe_u32 v116, v0, 2, 2
    v_lshrrev_b32 v117, 4, v0
    v_cmp_eq_u32 vcc, v116, v117
    v_and_b32 v116, 1, v0
    v_lshlrev_b32 v116, 4, v116
    v_mov_b32 v117, 0x3f80
    v_lshlrev_b32 v116, v116, v117
    v_cndmask_b32 v116, 0, v116, vcc
    v_and_b32 v117, 2, v0
    v_cmp_eq_u32 vcc, 0, v117
    v_mov_b32 v142, 0
    v_mov_b32 v143, 0
    v_mov_b32 v144, 0
    v_mov_b32 v145, 0
    v_cndmask_b32 v140, 0, v116, vcc
    v_cndmask_b32 v146, 0, v116, vcc
    v_cndmask_b32 v141, v116, v142, vcc
    v_cndmask_b32 v147, v116, v142, vcc
    v_mul_f32 v244, s43, v168
    v_mul_f32 v245, s43, v169
    v_mul_f32 v246, s43, v170
    v_mul_f32 v247, s43, v171
    v_mul_f32 v248, s43, v184
    v_mul_f32 v249, s43, v185
    v_mul_f32 v250, s43, v186
    v_mul_f32 v251, s43, v187
    v_exp_f32 v244, v244 clamp
    v_max_f32 v168, s42, v168
    v_exp_f32 v245, v245 clamp
    v_max_f32 v169, s42, v169
    v_exp_f32 v246, v246 clamp
    v_max_f32 v170, s42, v170
    v_exp_f32 v247, v247 clamp
    v_max_f32 v171, s42, v171
    v_exp_f32 v248, v248 clamp
    v_max_f32 v184, s42, v184
    v_exp_f32 v249, v249 clamp
    v_max_f32 v185, s42, v185
    v_exp_f32 v250, v250 clamp
    v_max_f32 v186, s42, v186
    v_exp_f32 v251, v251 clamp
    v_max_f32 v187, s42, v187
    v_add_f32 v244, v244, v168
    v_add_f32 v245, v245, v169
    v_add_f32 v246, v246, v170
    v_add_f32 v247, v247, v171
    v_add_f32 v248, v248, v184
    v_add_f32 v249, v249, v185
    v_add_f32 v250, v250, v186
    v_add_f32 v251, v251, v187
    v_cvt_pk_bf16_f32 v84, v244, v245
    v_cvt_pk_bf16_f32 v85, v246, v247
    v_cvt_pk_bf16_f32 v86, v248, v249
    v_cvt_pk_bf16_f32 v87, v250, v251
    s_mov_b32 s17, 1
    s_waitcnt vmcnt(0)
    s_atomic_add s17, s[10:11], 0 glc
    v_mul_f32 v244, s43, v172
    v_mul_f32 v245, s43, v173
    v_mul_f32 v246, s43, v174
    v_mul_f32 v247, s43, v175
    v_mul_f32 v248, s43, v188
    v_mul_f32 v249, s43, v189
    v_mul_f32 v250, s43, v190
    v_mul_f32 v251, s43, v191
    v_exp_f32 v244, v244 clamp
    v_max_f32 v172, s42, v172
    v_exp_f32 v245, v245 clamp
    v_max_f32 v173, s42, v173
    v_exp_f32 v246, v246 clamp
    v_max_f32 v174, s42, v174
    v_exp_f32 v247, v247 clamp
    v_max_f32 v175, s42, v175
    v_exp_f32 v248, v248 clamp
    v_max_f32 v188, s42, v188
    v_exp_f32 v249, v249 clamp
    v_max_f32 v189, s42, v189
    v_exp_f32 v250, v250 clamp
    v_max_f32 v190, s42, v190
    v_exp_f32 v251, v251 clamp
    v_max_f32 v191, s42, v191
    v_add_f32 v244, v244, v172
    v_add_f32 v245, v245, v173
    v_add_f32 v246, v246, v174
    v_add_f32 v247, v247, v175
    v_add_f32 v248, v248, v188
    v_add_f32 v249, v249, v189
    v_add_f32 v250, v250, v190
    v_add_f32 v251, v251, v191
    v_cvt_pk_bf16_f32 v88, v244, v245
    v_cvt_pk_bf16_f32 v89, v246, v247
    v_cvt_pk_bf16_f32 v90, v248, v249
    v_cvt_pk_bf16_f32 v91, v250, v251
    s_waitcnt lgkmcnt(0)
    s_cmp_lt_u32 s17, 15
    s_cbranch_scc1 F_K1N
    buffer_load_dwordx4 v[100:103], v13, s[36:39], s54 offen sc1
    s_lshl_b32 s59, s30, 12
    s_and_b32 s59, s59, 0x7fff
    s_add_u32 s40, s59, s53
    buffer_load_dwordx4 v[16:19], v1, s[36:39], s40 offen offset:0 sc1
    v_mul_f32 v244, s43, v176
    v_mul_f32 v245, s43, v177
    buffer_load_dwordx4 v[20:23], v1, s[36:39], s40 offen offset:2048 sc1
    v_mul_f32 v246, s43, v178
    v_mul_f32 v247, s43, v179
    s_add_u32 s59, s59, 4096
    s_and_b32 s59, s59, 0x7fff
    s_add_u32 s40, s59, s53
    buffer_load_dwordx4 v[24:27], v1, s[36:39], s40 offen offset:0 sc1
    v_mul_f32 v248, s43, v192
    v_mul_f32 v249, s43, v193
    buffer_load_dwordx4 v[28:31], v1, s[36:39], s40 offen offset:2048 sc1
    v_mul_f32 v250, s43, v194
    v_mul_f32 v251, s43, v195
    s_add_u32 s59, s59, 4096
    s_and_b32 s59, s59, 0x7fff
    s_add_u32 s40, s59, s53
    buffer_load_dwordx4 v[32:35], v1, s[36:39], s40 offen offset:0 sc1
    v_exp_f32 v244, v244 clamp
    v_max_f32 v176, s42, v176
    buffer_load_dwordx4 v[36:39], v1, s[36:39], s40 offen offset:2048 sc1
    v_exp_f32 v245, v245 clamp
    v_max_f32 v177, s42, v177
    s_add_u32 s59, s59, 4096
    s_and_b32 s59, s59, 0x7fff
    s_add_u32 s40, s59, s53
    buffer_load_dwordx4 v[40:43], v1, s[36:39], s40 offen offset:0 sc1
    v_exp_f32 v246, v246 clamp
    v_max_f32 v178, s42, v178
    buffer_load_dwordx4 v[44:47], v1, s[36:39], s40 offen offset:2048 sc1
    v_exp_f32 v247, v247 clamp
    v_max_f32 v179, s42, v179
    s_add_u32 s59, s59, 4096
    s_and_b32 s59, s59, 0x7fff
    s_add_u32 s40, s59, s53
    buffer_load_dwordx4 v[48:51], v1, s[36:39], s40 offen offset:0 sc1
    v_exp_f32 v248, v248 clamp
    v_max_f32 v192, s42, v192
    buffer_load_dwordx4 v[52:55], v1, s[36:39], s40 offen offset:2048 sc1
    v_exp_f32 v249, v249 clamp
    v_max_f32 v193, s42, v193
    s_add_u32 s59, s59, 4096
    s_and_b32 s59, s59, 0x7fff
    s_add_u32 s40, s59, s53
    buffer_load_dwordx4 v[56:59], v1, s[36:39], s40 offen offset:0 sc1
    v_exp_f32 v250, v250 clamp
    v_max_f32 v194, s42, v194
    buffer_load_dwordx4 v[60:63], v1, s[36:39], s40 offen offset:2048 sc1
    v_exp_f32 v251, v251 clamp
    v_max_f32 v195, s42, v195
    s_add_u32 s59, s59, 4096
    s_and_b32 s59, s59, 0x7fff
    s_add_u32 s40, s59, s53
    buffer_load_dwordx4 v[64:67], v1, s[36:39], s40 offen offset:0 sc1
    v_add_f32 v244, v244, v176
    v_add_f32 v245, v245, v177
    buffer_load_dwordx4 v[68:71], v1, s[36:39], s40 offen offset:2048 sc1
    v_add_f32 v246, v246, v178
    v_add_f32 v247, v247, v179
    s_add_u32 s59, s59, 4096
    s_and_b32 s59, s59, 0x7fff
    s_add_u32 s40, s59, s53
    buffer_load_dwordx4 v[72:75], v1, s[36:39], s40 offen offset:0 sc1
    v_add_f32 v248, v248, v192
    v_add_f32 v249, v249, v193
    buffer_load_dwordx4 v[76:79], v1, s[36:39], s40 offen offset:2048 sc1
    v_add_f32 v250, v250, v194
    v_add_f32 v251, v251, v195
    v_cvt_pk_bf16_f32 v92, v244, v245
    v_cvt_pk_bf16_f32 v93, v246, v247
    v_cvt_pk_bf16_f32 v94, v248, v249
    v_cvt_pk_bf16_f32 v95, v250, v251
    s_waitcnt vmcnt(14)
    v_mfma_f32_16x16x32_bf16 v[104:107], v[140:143], v[16:19], 0
    v_mfma_f32_16x16x32_bf16 v[108:111], v[144:147], v[16:19], 0
    v_mul_f32 v244, s43, v180
    v_mul_f32 v245, s43, v181
    v_mul_f32 v246, s43, v182
    v_mul_f32 v247, s43, v183
    v_mfma_f32_16x16x32_bf16 v[104:107], v[140:143], v[20:23], v[104:107]
    v_mfma_f32_16x16x32_bf16 v[108:111], v[144:147], v[20:23], v[108:111]
    v_mul_f32 v248, s43, v196
    v_mul_f32 v249, s43, v197
    v_mul_f32 v250, s43, v198
    v_mul_f32 v251, s43, v199
    s_waitcnt vmcnt(12)
    v_mfma_f32_16x16x32_bf16 v[104:107], v[140:143], v[24:27], v[104:107]
    v_mfma_f32_16x16x32_bf16 v[108:111], v[144:147], v[24:27], v[108:111]
    v_exp_f32 v244, v244 clamp
    v_max_f32 v180, s42, v180
    v_exp_f32 v245, v245 clamp
    v_max_f32 v181, s42, v181
    v_mfma_f32_16x16x32_bf16 v[104:107], v[140:143], v[28:31], v[104:107]
    v_mfma_f32_16x16x32_bf16 v[108:111], v[144:147], v[28:31], v[108:111]
    v_exp_f32 v246, v246 clamp
    v_max_f32 v182, s42, v182
    v_exp_f32 v247, v247 clamp
    v_max_f32 v183, s42, v183
    s_waitcnt vmcnt(10)
    v_mfma_f32_16x16x32_bf16 v[104:107], v[140:143], v[32:35], v[104:107]
    v_mfma_f32_16x16x32_bf16 v[108:111], v[144:147], v[32:35], v[108:111]
    v_exp_f32 v248, v248 clamp
    v_max_f32 v196, s42, v196
    v_exp_f32 v249, v249 clamp
    v_max_f32 v197, s42, v197
    v_mfma_f32_16x16x32_bf16 v[104:107], v[140:143], v[36:39], v[104:107]
    v_mfma_f32_16x16x32_bf16 v[108:111], v[144:147], v[36:39], v[108:111]
    v_exp_f32 v250, v250 clamp
    v_max_f32 v198, s42, v198
    v_exp_f32 v251, v251 clamp
    v_max_f32 v199, s42, v199
    s_waitcnt vmcnt(8)
    v_mfma_f32_16x16x32_bf16 v[104:107], v[140:143], v[40:43], v[104:107]
    v_mfma_f32_16x16x32_bf16 v[108:111], v[144:147], v[40:43], v[108:111]
    v_add_f32 v244, v244, v180
    v_add_f32 v245, v245, v181
    v_add_f32 v246, v246, v182
    v_add_f32 v247, v247, v183
    v_mfma_f32_16x16x32_bf16 v[104:107], v[140:143], v[44:47], v[104:107]
    v_mfma_f32_16x16x32_bf16 v[108:111], v[144:147], v[44:47], v[108:111]
    v_add_f32 v248, v248, v196
    v_add_f32 v249, v249, v197
    v_add_f32 v250, v250, v198
    v_add_f32 v251, v251, v199
    s_waitcnt vmcnt(6)
    v_mfma_f32_16x16x32_bf16 v[104:107], v[140:143], v[48:51], v[104:107]
    v_mfma_f32_16x16x32_bf16 v[108:111], v[144:147], v[48:51], v[108:111]
    v_cvt_pk_bf16_f32 v96, v244, v245
    v_cvt_pk_bf16_f32 v97, v246, v247
    v_cvt_pk_bf16_f32 v98, v248, v249
    v_cvt_pk_bf16_f32 v99, v250, v251
    v_mfma_f32_16x16x32_bf16 v[104:107], v[140:143], v[52:55], v[104:107]
    v_mfma_f32_16x16x32_bf16 v[108:111], v[144:147], v[52:55], v[108:111]
    s_waitcnt vmcnt(16)
    v_add_f32_dpp v120, v100, v100 row_ror:8 row_mask:0xf bank_mask:0xf
    v_add_f32_dpp v121, v101, v101 row_ror:8 row_mask:0xf bank_mask:0xf
    v_add_f32_dpp v122, v102, v102 row_ror:8 row_mask:0xf bank_mask:0xf
    s_waitcnt vmcnt(4)
    v_mfma_f32_16x16x32_bf16 v[104:107], v[140:143], v[56:59], v[104:107]
    v_mfma_f32_16x16x32_bf16 v[108:111], v[144:147], v[56:59], v[108:111]
    v_add_f32_dpp v123, v103, v103 row_ror:8 row_mask:0xf bank_mask:0xf
    v_add_f32_dpp v120, v120, v120 row_ror:4 row_mask:0xf bank_mask:0xf
    v_add_f32_dpp v121, v121, v121 row_ror:4 row_mask:0xf bank_mask:0xf
    v_add_f32_dpp v122, v122, v122 row_ror:4 row_mask:0xf bank_mask:0xf
    v_mfma_f32_16x16x32_bf16 v[104:107], v[140:143], v[60:63], v[104:107]
    v_mfma_f32_16x16x32_bf16 v[108:111], v[144:147], v[60:63], v[108:111]
    v_add_f32_dpp v123, v123, v123 row_ror:4 row_mask:0xf bank_mask:0xf
    v_add_f32_dpp v120, v120, v120 row_ror:2 row_mask:0xf bank_mask:0xf
    v_add_f32_dpp v121, v121, v121 row_ror:2 row_mask:0xf bank_mask:0xf
    v_add_f32_dpp v122, v122, v122 row_ror:2 row_mask:0xf bank_mask:0xf
    s_waitcnt vmcnt(2)
    v_mfma_f32_16x16x32_bf16 v[104:107], v[140:143], v[64:67], v[104:107]
    v_mfma_f32_16x16x32_bf16 v[108:111], v[144:147], v[64:67], v[108:111]
    v_add_f32_dpp v123, v123, v123 row_ror:2 row_mask:0xf bank_mask:0xf
    v_add_f32_dpp v120, v120, v120 row_ror:1 row_mask:0xf bank_mask:0xf
    v_add_f32_dpp v121, v121, v121 row_ror:1 row_mask:0xf bank_mask:0xf
    v_add_f32_dpp v122, v122, v122 row_ror:1 row_mask:0xf bank_mask:0xf
    v_mfma_f32_16x16x32_bf16 v[104:107], v[140:143], v[68:71], v[104:107]
    v_mfma_f32_16x16x32_bf16 v[108:111], v[144:147], v[68:71], v[108:111]
    v_add_f32_dpp v123, v123, v123 row_ror:1 row_mask:0xf bank_mask:0xf
    v_cvt_pk_bf16_f32 v132, v120, v121
    v_cvt_pk_bf16_f32 v133, v122, v123
    s_waitcnt vmcnt(0)
    v_mfma_f32_16x16x32_bf16 v[104:107], v[140:143], v[72:75], v[104:107]
    v_mfma_f32_16x16x32_bf16 v[108:111], v[144:147], v[72:75], v[108:111]
    v_mfma_f32_16x16x32_bf16 v[104:107], v[140:143], v[76:79], v[104:107]
    v_mfma_f32_16x16x32_bf16 v[108:111], v[144:147], v[76:79], v[108:111]
    s_branch F_K2X
F_K1N:
    v_mul_f32 v244, s43, v176
    v_mul_f32 v245, s43, v177
    v_mul_f32 v246, s43, v178
    v_mul_f32 v247, s43, v179
    v_mul_f32 v248, s43, v192
    v_mul_f32 v249, s43, v193
    v_mul_f32 v250, s43, v194
    v_mul_f32 v251, s43, v195
    v_exp_f32 v244, v244 clamp
    v_max_f32 v176, s42, v176
    v_exp_f32 v245, v245 clamp
    v_max_f32 v177, s42, v177
    v_exp_f32 v246, v246 clamp
    v_max_f32 v178, s42, v178
    v_exp_f32 v247, v247 clamp
    v_max_f32 v179, s42, v179
    v_exp_f32 v248, v248 clamp
    v_max_f32 v192, s42, v192
    v_exp_f32 v249, v249 clamp
    v_max_f32 v193, s42, v193
    v_exp_f32 v250, v250 clamp
    v_max_f32 v194, s42, v194
    v_exp_f32 v251, v251 clamp
    v_max_f32 v195, s42, v195
    v_add_f32 v244, v244, v176
    v_add_f32 v245, v245, v177
    v_add_f32 v246, v246, v178
    v_add_f32 v247, v247, v179
    v_add_f32 v248, v248, v192
    v_add_f32 v249, v249, v193
    v_add_f32 v250, v250, v194
    v_add_f32 v251, v251, v195
    v_cvt_pk_bf16_f32 v92, v244, v245
    v_cvt_pk_bf16_f32 v93, v246, v247
    v_cvt_pk_bf16_f32 v94, v248, v249
    v_cvt_pk_bf16_f32 v95, v250, v251
    v_mul_f32 v244, s43, v180
    v_mul_f32 v245, s43, v181
    v_mul_f32 v246, s43, v182
    v_mul_f32 v247, s43, v183
    v_mul_f32 v248, s43, v196
    v_mul_f32 v249, s43, v197
    v_mul_f32 v250, s43, v198
    v_mul_f32 v251, s43, v199
    v_exp_f32 v244, v244 clamp
    v_max_f32 v180, s42, v180
    v_exp_f32 v245, v245 clamp
    v_max_f32 v181, s42, v181
    v_exp_f32 v246, v246 clamp
    v_max_f32 v182, s42, v182
    v_exp_f32 v247, v247 clamp
    v_max_f32 v183, s42, v183
    v_exp_f32 v248, v248 clamp
    v_max_f32 v196, s42, v196
    v_exp_f32 v249, v249 clamp
    v_max_f32 v197, s42, v197
    v_exp_f32 v250, v250 clamp
    v_max_f32 v198, s42, v198
    v_exp_f32 v251, v251 clamp
    v_max_f32 v199, s42, v199
    v_add_f32 v244, v244, v180
    v_add_f32 v245, v245, v181
    v_add_f32 v246, v246, v182
    v_add_f32 v247, v247, v183
    v_add_f32 v248, v248, v196
    v_add_f32 v249, v249, v197
    v_add_f32 v250, v250, v198
    v_add_f32 v251, v251, v199
    v_cvt_pk_bf16_f32 v96, v244, v245
    v_cvt_pk_bf16_f32 v97, v246, v247
    v_cvt_pk_bf16_f32 v98, v248, v249
    v_cvt_pk_bf16_f32 v99, v250, v251
    s_mov_b32 s45, 0
F_P2:
    s_mov_b32 s17, 0
    s_atomic_add s17, s[10:11], 0 glc
    s_waitcnt lgkmcnt(0)
    s_cmp_ge_u32 s17, 16
    s_cbranch_scc1 F_P2_X
    s_sleep 3
    s_add_u32 s45, s45, 1
    s_cmp_lt_u32 s45, 400000
    s_cbranch_scc1 F_P2
F_P2_X:
    buffer_load_dwordx4 v[100:103], v13, s[36:39], s54 offen sc1
    s_lshl_b32 s59, s30, 12
    s_and_b32 s59, s59, 0x7fff
    s_add_u32 s40, s59, s53
    buffer_load_dwordx4 v[16:19], v1, s[36:39], s40 offen offset:0 sc1
    buffer_load_dwordx4 v[20:23], v1, s[36:39], s40 offen offset:2048 sc1
    s_add_u32 s59, s59, 4096
    s_and_b32 s59, s59, 0x7fff
    s_add_u32 s40, s59, s53
    buffer_load_dwordx4 v[24:27], v1, s[36:39], s40 offen offset:0 sc1
    buffer_load_dwordx4 v[28:31], v1, s[36:39], s40 offen offset:2048 sc1
    s_add_u32 s59, s59, 4096
    s_and_b32 s59, s59, 0x7fff
    s_add_u32 s40, s59, s53
    buffer_load_dwordx4 v[32:35], v1, s[36:39], s40 offen offset:0 sc1
    buffer_load_dwordx4 v[36:39], v1, s[36:39], s40 offen offset:2048 sc1
    s_add_u32 s59, s59, 4096
    s_and_b32 s59, s59, 0x7fff
    s_add_u32 s40, s59, s53
    buffer_load_dwordx4 v[40:43], v1, s[36:39], s40 offen offset:0 sc1
    buffer_load_dwordx4 v[44:47], v1, s[36:39], s40 offen offset:2048 sc1
    s_add_u32 s59, s59, 4096
    s_and_b32 s59, s59, 0x7fff
    s_add_u32 s40, s59, s53
    buffer_load_dwordx4 v[48:51], v1, s[36:39], s40 offen offset:0 sc1
    buffer_load_dwordx4 v[52:55], v1, s[36:39], s40 offen offset:2048 sc1
    s_add_u32 s59, s59, 4096
    s_and_b32 s59, s59, 0x7fff
    s_add_u32 s40, s59, s53
    buffer_load_dwordx4 v[56:59], v1, s[36:39], s40 offen offset:0 sc1
    buffer_load_dwordx4 v[60:63], v1, s[36:39], s40 offen offset:2048 sc1
    s_add_u32 s59, s59, 4096
    s_and_b32 s59, s59, 0x7fff
    s_add_u32 s40, s59, s53
    buffer_load_dwordx4 v[64:67], v1, s[36:39], s40 offen offset:0 sc1
    buffer_load_dwordx4 v[68:71], v1, s[36:39], s40 offen offset:2048 sc1
    s_add_u32 s59, s59, 4096
    s_and_b32 s59, s59, 0x7fff
    s_add_u32 s40, s59, s53
    buffer_load_dwordx4 v[72:75], v1, s[36:39], s40 offen offset:0 sc1
    buffer_load_dwordx4 v[76:79], v1, s[36:39], s40 offen offset:2048 sc1
    s_waitcnt vmcnt(16)
    v_add_f32_dpp v120, v100, v100 row_ror:8 row_mask:0xf bank_mask:0xf
    v_add_f32_dpp v121, v101, v101 row_ror:8 row_mask:0xf bank_mask:0xf
    v_add_f32_dpp v122, v102, v102 row_ror:8 row_mask:0xf bank_mask:0xf
    v_add_f32_dpp v123, v103, v103 row_ror:8 row_mask:0xf bank_mask:0xf
    v_add_f32_dpp v120, v120, v120 row_ror:4 row_mask:0xf bank_mask:0xf
    v_add_f32_dpp v121, v121, v121 row_ror:4 row_mask:0xf bank_mask:0xf
    v_add_f32_dpp v122, v122, v122 row_ror:4 row_mask:0xf bank_mask:0xf
    v_add_f32_dpp v123, v123, v123 row_ror:4 row_mask:0xf bank_mask:0xf
    v_add_f32_dpp v120, v120, v120 row_ror:2 row_mask:0xf bank_mask:0xf
    v_add_f32_dpp v121, v121, v121 row_ror:2 row_mask:0xf bank_mask:0xf
    v_add_f32_dpp v122, v122, v122 row_ror:2 row_mask:0xf bank_mask:0xf
    v_add_f32_dpp v123, v123, v123 row_ror:2 row_mask:0xf bank_mask:0xf
    v_add_f32_dpp v120, v120, v120 row_ror:1 row_mask:0xf bank_mask:0xf
    v_add_f32_dpp v121, v121, v121 row_ror:1 row_mask:0xf bank_mask:0xf
    v_add_f32_dpp v122, v122, v122 row_ror:1 row_mask:0xf bank_mask:0xf
    v_add_f32_dpp v123, v123, v123 row_ror:1 row_mask:0xf bank_mask:0xf
    v_cvt_pk_bf16_f32 v132, v120, v121
    v_cvt_pk_bf16_f32 v133, v122, v123
    s_waitcnt vmcnt(14)
    v_mfma_f32_16x16x32_bf16 v[104:107], v[140:143], v[16:19], 0
    v_mfma_f32_16x16x32_bf16 v[108:111], v[144:147], v[16:19], 0
    v_mfma_f32_16x16x32_bf16 v[104:107], v[140:143], v[20:23], v[104:107]
    v_mfma_f32_16x16x32_bf16 v[108:111], v[144:147], v[20:23], v[108:111]
    s_waitcnt vmcnt(12)
    v_mfma_f32_16x16x32_bf16 v[104:107], v[140:143], v[24:27], v[104:107]
    v_mfma_f32_16x16x32_bf16 v[108:111], v[144:147], v[24:27], v[108:111]
    v_mfma_f32_16x16x32_bf16 v[104:107], v[140:143], v[28:31], v[104:107]
    v_mfma_f32_16x16x32_bf16 v[108:111], v[144:147], v[28:31], v[108:111]
    s_waitcnt vmcnt(10)
    v_mfma_f32_16x16x32_bf16 v[104:107], v[140:143], v[32:35], v[104:107]
    v_mfma_f32_16x16x32_bf16 v[108:111], v[144:147], v[32:35], v[108:111]
    v_mfma_f32_16x16x32_bf16 v[104:107], v[140:143], v[36:39], v[104:107]
    v_mfma_f32_16x16x32_bf16 v[108:111], v[144:147], v[36:39], v[108:111]
    s_waitcnt vmcnt(8)
    v_mfma_f32_16x16x32_bf16 v[104:107], v[140:143], v[40:43], v[104:107]
    v_mfma_f32_16x16x32_bf16 v[108:111], v[144:147], v[40:43], v[108:111]
    v_mfma_f32_16x16x32_bf16 v[104:107], v[140:143], v[44:47], v[104:107]
    v_mfma_f32_16x16x32_bf16 v[108:111], v[144:147], v[44:47], v[108:111]
    s_waitcnt vmcnt(6)
    v_mfma_f32_16x16x32_bf16 v[104:107], v[140:143], v[48:51], v[104:107]
    v_mfma_f32_16x16x32_bf16 v[108:111], v[144:147], v[48:51], v[108:111]
    v_mfma_f32_16x16x32_bf16 v[104:107], v[140:143], v[52:55], v[104:107]
    v_mfma_f32_16x16x32_bf16 v[108:111], v[144:147], v[52:55], v[108:111]
    s_waitcnt vmcnt(4)
    v_mfma_f32_16x16x32_bf16 v[104:107], v[140:143], v[56:59], v[104:107]
    v_mfma_f32_16x16x32_bf16 v[108:111], v[144:147], v[56:59], v[108:111]
    v_mfma_f32_16x16x32_bf16 v[104:107], v[140:143], v[60:63], v[104:107]
    v_mfma_f32_16x16x32_bf16 v[108:111], v[144:147], v[60:63], v[108:111]
    s_waitcnt vmcnt(2)
    v_mfma_f32_16x16x32_bf16 v[104:107], v[140:143], v[64:67], v[104:107]
    v_mfma_f32_16x16x32_bf16 v[108:111], v[144:147], v[64:67], v[108:111]
    v_mfma_f32_16x16x32_bf16 v[104:107], v[140:143], v[68:71], v[104:107]
    v_mfma_f32_16x16x32_bf16 v[108:111], v[144:147], v[68:71], v[108:111]
    s_waitcnt vmcnt(0)
    v_mfma_f32_16x16x32_bf16 v[104:107], v[140:143], v[72:75], v[104:107]
    v_mfma_f32_16x16x32_bf16 v[108:111], v[144:147], v[72:75], v[108:111]
    v_mfma_f32_16x16x32_bf16 v[104:107], v[140:143], v[76:79], v[104:107]
    v_mfma_f32_16x16x32_bf16 v[108:111], v[144:147], v[76:79], v[108:111]
F_K2X:
    s_nop 6
    v_cvt_pk_bf16_f32 v136, v104, v105
    v_cvt_pk_bf16_f32 v137, v106, v107
    v_cvt_pk_bf16_f32 v138, v108, v109
    v_cvt_pk_bf16_f32 v139, v110, v111
    ds_write_b128 v7, v[136:139]
    ds_write_b64 v9, v[132:133] offset:2048
    ds_write_b32 v10, v14 offset:4
F_XB:
    ds_read_b32 v15, v11 offset:4
    ds_read_b64 v[134:135], v8 offset:2048
    ds_read_b64 v[124:125], v200
    ds_read_b64 v[126:127], v201
    ds_read_b64 v[128:129], v202
    ds_read_b64 v[130:131], v203
    s_waitcnt lgkmcnt(0)
    v_cmp_ne_u32 vcc, 1, v15
    s_cbranch_vccnz F_XB
    v_mfma_f32_16x16x32_bf16 v[140:143], v[132:135], v[84:87], v[112:115]
    v_mfma_f32_16x16x32_bf16 v[144:147], v[132:135], v[88:91], v[112:115]
    v_mfma_f32_16x16x32_bf16 v[148:151], v[132:135], v[92:95], v[112:115]
    v_mfma_f32_16x16x32_bf16 v[152:155], v[132:135], v[96:99], v[112:115]
    v_mfma_f32_16x16x32_bf16 v[156:159], v[124:127], v[84:87], 0
    v_mfma_f32_16x16x32_bf16 v[160:163], v[128:131], v[84:87], 0
    v_mfma_f32_16x16x32_bf16 v[164:167], v[124:127], v[88:91], 0
    v_mfma_f32_16x16x32_bf16 v[168:171], v[128:131], v[88:91], 0
    v_mfma_f32_16x16x32_bf16 v[172:175], v[124:127], v[92:95], 0
    v_mfma_f32_16x16x32_bf16 v[176:179], v[128:131], v[92:95], 0
    v_mfma_f32_16x16x32_bf16 v[180:183], v[124:127], v[96:99], 0
    v_mfma_f32_16x16x32_bf16 v[184:187], v[128:131], v[96:99], 0
    ds_write_b32 v206, v14
    s_mov_b32 s17, 0
    s_atomic_add s17, s[14:15], 0 glc
    ds_read_b32 v10, v211
    v_rcp_f32 v140, v140
    v_rcp_f32 v144, v144
    v_rcp_f32 v148, v148
    v_rcp_f32 v152, v152
    v_mul_f32 v156, v156, v140
    v_mul_f32 v157, v157, v140
    v_mul_f32 v158, v158, v140
    v_mul_f32 v159, v159, v140
    v_mul_f32 v160, v160, v140
    v_mul_f32 v161, v161, v140
    v_mul_f32 v162, v162, v140
    v_mul_f32 v163, v163, v140
    v_cvt_pk_bf16_f32 v212, v156, v157
    v_cvt_pk_bf16_f32 v213, v158, v159
    v_cvt_pk_bf16_f32 v214, v160, v161
    v_cvt_pk_bf16_f32 v215, v162, v163
    buffer_store_dwordx4 v[212:215], v1, s[36:39], s52 offen sc1
    s_add_u32 s52, s52, 33792
    v_mul_f32 v164, v164, v144
    v_mul_f32 v165, v165, v144
    v_mul_f32 v166, v166, v144
    v_mul_f32 v167, v167, v144
    v_mul_f32 v168, v168, v144
    v_mul_f32 v169, v169, v144
    v_mul_f32 v170, v170, v144
    v_mul_f32 v171, v171, v144
    v_cvt_pk_bf16_f32 v216, v164, v165
    v_cvt_pk_bf16_f32 v217, v166, v167
    v_cvt_pk_bf16_f32 v218, v168, v169
    v_cvt_pk_bf16_f32 v219, v170, v171
    buffer_store_dwordx4 v[216:219], v1, s[36:39], s52 offen sc1
    s_add_u32 s52, s52, 33792
    v_mul_f32 v172, v172, v148
    v_mul_f32 v173, v173, v148
    v_mul_f32 v174, v174, v148
    v_mul_f32 v175, v175, v148
    v_mul_f32 v176, v176, v148
    v_mul_f32 v177, v177, v148
    v_mul_f32 v178, v178, v148
    v_mul_f32 v179, v179, v148
    v_cvt_pk_bf16_f32 v220, v172, v173
    v_cvt_pk_bf16_f32 v221, v174, v175
    v_cvt_pk_bf16_f32 v222, v176, v177
    v_cvt_pk_bf16_f32 v223, v178, v179
    buffer_store_dwordx4 v[220:223], v1, s[36:39], s52 offen sc1
    s_add_u32 s52, s52, 33792
    v_mul_f32 v180, v180, v152
    v_mul_f32 v181, v181, v152
    v_mul_f32 v182, v182, v152
    v_mul_f32 v183, v183, v152
    v_mul_f32 v184, v184, v152
    v_mul_f32 v185, v185, v152
    v_mul_f32 v186, v186, v152
    v_mul_f32 v187, v187, v152
    v_cvt_pk_bf16_f32 v224, v180, v181
    v_cvt_pk_bf16_f32 v225, v182, v183
    v_cvt_pk_bf16_f32 v226, v184, v185
    v_cvt_pk_bf16_f32 v227, v186, v187
    buffer_store_dwordx4 v[224:227], v1, s[36:39], s52 offen sc1
    v_add_u32 v6, 33792, v1
    s_mov_b32 s46, 0x11111111
    s_mov_b32 s50, -1
    s_mov_b32 s51, -1
    v_mov_b32 v16, 0
    v_mov_b32 v17, 0
    v_mov_b32 v18, 0
    v_mov_b32 v19, 0
    v_mov_b32 v20, 0
    v_mov_b32 v21, 0
    v_mov_b32 v22, 0
    v_mov_b32 v23, 0
    v_mov_b32 v24, 0
    v_mov_b32 v25, 0
    v_mov_b32 v26, 0
    v_mov_b32 v27, 0
    v_mov_b32 v28, 0
    v_mov_b32 v29, 0
    v_mov_b32 v30, 0
    v_mov_b32 v31, 0
    v_mov_b32 v32, 0
    v_mov_b32 v33, 0
    v_mov_b32 v34, 0
    v_mov_b32 v35, 0
    v_mov_b32 v36, 0
    v_mov_b32 v37, 0
    v_mov_b32 v38, 0
    v_mov_b32 v39, 0
    v_mov_b32 v40, 0
    v_mov_b32 v41, 0
    v_mov_b32 v42, 0
    v_mov_b32 v43, 0
    v_mov_b32 v44, 0
    v_mov_b32 v45, 0
    v_mov_b32 v46, 0
    v_mov_b32 v47, 0
    s_mov_b32 s47, 0
    s_mov_b32 s54, 0x76432105
    s_mov_b32 s44, 0
    s_mov_b32 s58, 0
    s_mov_b32 s18, 1
    s_branch F_GR0
.p2align 6
F_GLOOP:
    s_cmp_lt_i32 s50, 0
    s_cbranch_scc1 F_GE0
F_GC0:
F_GK0:
    s_waitcnt vmcnt(14) lgkmcnt(0)
    v_mfma_f32_16x16x32_bf16 v[16:19], v[48:51], v[80:83], v[16:19]
    ds_read_b64_tr_b16 v[64:65], v2 offset:4096
    ds_read_b64_tr_b16 v[66:67], v2 offset:6144
    v_mfma_f32_16x16x32_bf16 v[32:35], v[48:51], v[84:87], v[32:35]
    ds_read_b64_tr_b16 v[68:69], v3 offset:4096
    ds_read_b64_tr_b16 v[70:71], v3 offset:6144
    v_mfma_f32_16x16x32_bf16 v[20:23], v[52:55], v[80:83], v[20:23]
    ds_read_b64_tr_b16 v[72:73], v4 offset:4096
    ds_read_b64_tr_b16 v[74:75], v4 offset:6144
    v_mfma_f32_16x16x32_bf16 v[36:39], v[52:55], v[84:87], v[36:39]
    ds_read_b64_tr_b16 v[76:77], v5 offset:4096
    ds_read_b64_tr_b16 v[78:79], v5 offset:6144
    v_mfma_f32_16x16x32_bf16 v[24:27], v[56:59], v[80:83], v[24:27]
    v_mfma_f32_16x16x32_bf16 v[40:43], v[56:59], v[84:87], v[40:43]
    v_mfma_f32_16x16x32_bf16 v[28:31], v[60:63], v[80:83], v[28:31]
    v_mfma_f32_16x16x32_bf16 v[44:47], v[60:63], v[84:87], v[44:47]
    s_and_b32 s45, s46, s47
    s_cbranch_scc0 F_GP0
F_GQ0:
    s_waitcnt vmcnt(12) lgkmcnt(0)
    v_mfma_f32_16x16x32_bf16 v[16:19], v[64:67], v[88:91], v[16:19]
    ds_read_b64_tr_b16 v[48:49], v2 offset:8192
    ds_read_b64_tr_b16 v[50:51], v2 offset:10240
    s_and_b32 s45, s46, s47
    v_mfma_f32_16x16x32_bf16 v[32:35], v[64:67], v[92:95], v[32:35]
    ds_read_b64_tr_b16 v[52:53], v3 offset:8192
    ds_read_b64_tr_b16 v[54:55], v3 offset:10240
    s_cselect_b32 s66, s38, 0
    v_mfma_f32_16x16x32_bf16 v[20:23], v[68:71], v[88:91], v[20:23]
    ds_read_b64_tr_b16 v[56:57], v4 offset:8192
    ds_read_b64_tr_b16 v[58:59], v4 offset:10240
    s_ff1_i32_b32 s50, s45
    v_mfma_f32_16x16x32_bf16 v[36:39], v[68:71], v[92:95], v[36:39]
    ds_read_b64_tr_b16 v[60:61], v5 offset:8192
    ds_read_b64_tr_b16 v[62:63], v5 offset:10240
    s_lshl_b32 s52, s50, 10
    v_mfma_f32_16x16x32_bf16 v[24:27], v[72:75], v[88:91], v[24:27]
    s_add_u32 s52, s52, s55
    s_bitset0_b32 s46, s50
    v_mfma_f32_16x16x32_bf16 v[40:43], v[72:75], v[92:95], v[40:43]
    buffer_load_dwordx4 v[80:83], v1, s[64:67], s52 offen offset:0 sc1
    s_lshr_b32 s48, s54, s51
    v_mfma_f32_16x16x32_bf16 v[28:31], v[76:79], v[88:91], v[28:31]
    buffer_load_dwordx4 v[84:87], v6, s[64:67], s52 offen offset:0 sc1
    s_and_b32 s48, s48, 15
    v_mfma_f32_16x16x32_bf16 v[44:47], v[76:79], v[92:95], v[44:47]
    s_lshl_b32 s48, s48, 14
    s_waitcnt vmcnt(12) lgkmcnt(0)
    v_mfma_f32_16x16x32_bf16 v[16:19], v[48:51], v[96:99], v[16:19]
    ds_read_b64_tr_b16 v[64:65], v2 offset:12288
    ds_read_b64_tr_b16 v[66:67], v2 offset:14336
    v_mfma_f32_16x16x32_bf16 v[32:35], v[48:51], v[100:103], v[32:35]
    ds_read_b64_tr_b16 v[68:69], v3 offset:12288
    ds_read_b64_tr_b16 v[70:71], v3 offset:14336
    v_mfma_f32_16x16x32_bf16 v[20:23], v[52:55], v[96:99], v[20:23]
    ds_read_b64_tr_b16 v[72:73], v4 offset:12288
    ds_read_b64_tr_b16 v[74:75], v4 offset:14336
    v_mfma_f32_16x16x32_bf16 v[36:39], v[52:55], v[100:103], v[36:39]
    ds_read_b64_tr_b16 v[76:77], v5 offset:12288
    ds_read_b64_tr_b16 v[78:79], v5 offset:14336
    v_mfma_f32_16x16x32_bf16 v[24:27], v[56:59], v[96:99], v[24:27]
    buffer_load_dwordx4 v[88:91], v1, s[64:67], s52 offen offset:1024 sc1
    v_add_u32 v2, s48, v207
    v_mfma_f32_16x16x32_bf16 v[40:43], v[56:59], v[100:103], v[40:43]
    buffer_load_dwordx4 v[92:95], v6, s[64:67], s52 offen offset:1024 sc1
    v_xor_b32 v3, 32, v2
    v_mfma_f32_16x16x32_bf16 v[28:31], v[60:63], v[96:99], v[28:31]
    v_xor_b32 v4, 64, v2
    v_xor_b32 v5, 96, v2
    v_mfma_f32_16x16x32_bf16 v[44:47], v[60:63], v[100:103], v[44:47]
    s_waitcnt vmcnt(12) lgkmcnt(0)
    v_mfma_f32_16x16x32_bf16 v[16:19], v[64:67], v[104:107], v[16:19]
    ds_read_b64_tr_b16 v[48:49], v2 offset:0
    ds_read_b64_tr_b16 v[50:51], v2 offset:2048
    v_mfma_f32_16x16x32_bf16 v[32:35], v[64:67], v[108:111], v[32:35]
    ds_read_b64_tr_b16 v[52:53], v3 offset:0
    ds_read_b64_tr_b16 v[54:55], v3 offset:2048
    v_mfma_f32_16x16x32_bf16 v[20:23], v[68:71], v[104:107], v[20:23]
    ds_read_b64_tr_b16 v[56:57], v4 offset:0
    ds_read_b64_tr_b16 v[58:59], v4 offset:2048
    v_mfma_f32_16x16x32_bf16 v[36:39], v[68:71], v[108:111], v[36:39]
    ds_read_b64_tr_b16 v[60:61], v5 offset:0
    ds_read_b64_tr_b16 v[62:63], v5 offset:2048
    v_mfma_f32_16x16x32_bf16 v[24:27], v[72:75], v[104:107], v[24:27]
    buffer_load_dwordx4 v[96:99], v1, s[64:67], s52 offen offset:2048 sc1
    v_mfma_f32_16x16x32_bf16 v[40:43], v[72:75], v[108:111], v[40:43]
    buffer_load_dwordx4 v[100:103], v6, s[64:67], s52 offen offset:2048 sc1
    v_mfma_f32_16x16x32_bf16 v[28:31], v[76:79], v[104:107], v[28:31]
    v_mfma_f32_16x16x32_bf16 v[44:47], v[76:79], v[108:111], v[44:47]
    buffer_load_dwordx4 v[104:107], v1, s[64:67], s52 offen offset:3072 sc1
    buffer_load_dwordx4 v[108:111], v6, s[64:67], s52 offen offset:3072 sc1
    s_cmp_lt_i32 s51, 0
    s_cbranch_scc1 F_GE1
F_GC1:
F_GK1:
    s_waitcnt vmcnt(14) lgkmcnt(0)
    v_mfma_f32_16x16x32_bf16 v[16:19], v[48:51], v[112:115], v[16:19]
    ds_read_b64_tr_b16 v[64:65], v2 offset:4096
    ds_read_b64_tr_b16 v[66:67], v2 offset:6144
    v_mfma_f32_16x16x32_bf16 v[32:35], v[48:51], v[116:119], v[32:35]
    ds_read_b64_tr_b16 v[68:69], v3 offset:4096
    ds_read_b64_tr_b16 v[70:71], v3 offset:6144
    v_mfma_f32_16x16x32_bf16 v[20:23], v[52:55], v[112:115], v[20:23]
    ds_read_b64_tr_b16 v[72:73], v4 offset:4096
    ds_read_b64_tr_b16 v[74:75], v4 offset:6144
    v_mfma_f32_16x16x32_bf16 v[36:39], v[52:55], v[116:119], v[36:39]
    ds_read_b64_tr_b16 v[76:77], v5 offset:4096
    ds_read_b64_tr_b16 v[78:79], v5 offset:6144
    v_mfma_f32_16x16x32_bf16 v[24:27], v[56:59], v[112:115], v[24:27]
    v_mfma_f32_16x16x32_bf16 v[40:43], v[56:59], v[116:119], v[40:43]
    v_mfma_f32_16x16x32_bf16 v[28:31], v[60:63], v[112:115], v[28:31]
    v_mfma_f32_16x16x32_bf16 v[44:47], v[60:63], v[116:119], v[44:47]
    s_and_b32 s45, s46, s47
    s_cbranch_scc0 F_GP1
F_GQ1:
    s_waitcnt vmcnt(12) lgkmcnt(0)
    v_mfma_f32_16x16x32_bf16 v[16:19], v[64:67], v[120:123], v[16:19]
    ds_read_b64_tr_b16 v[48:49], v2 offset:8192
    ds_read_b64_tr_b16 v[50:51], v2 offset:10240
    s_and_b32 s45, s46, s47
    v_mfma_f32_16x16x32_bf16 v[32:35], v[64:67], v[124:127], v[32:35]
    ds_read_b64_tr_b16 v[52:53], v3 offset:8192
    ds_read_b64_tr_b16 v[54:55], v3 offset:10240
    s_cselect_b32 s66, s38, 0
    v_mfma_f32_16x16x32_bf16 v[20:23], v[68:71], v[120:123], v[20:23]
    ds_read_b64_tr_b16 v[56:57], v4 offset:8192
    ds_read_b64_tr_b16 v[58:59], v4 offset:10240
    s_ff1_i32_b32 s51, s45
    v_mfma_f32_16x16x32_bf16 v[36:39], v[68:71], v[124:127], v[36:39]
    ds_read_b64_tr_b16 v[60:61], v5 offset:8192
    ds_read_b64_tr_b16 v[62:63], v5 offset:10240
    s_lshl_b32 s53, s51, 10
    v_mfma_f32_16x16x32_bf16 v[24:27], v[72:75], v[120:123], v[24:27]
    s_add_u32 s53, s53, s55
    s_bitset0_b32 s46, s51
    v_mfma_f32_16x16x32_bf16 v[40:43], v[72:75], v[124:127], v[40:43]
    buffer_load_dwordx4 v[112:115], v1, s[64:67], s53 offen offset:0 sc1
    s_lshr_b32 s48, s54, s50
    v_mfma_f32_16x16x32_bf16 v[28:31], v[76:79], v[120:123], v[28:31]
    buffer_load_dwordx4 v[116:119], v6, s[64:67], s53 offen offset:0 sc1
    s_and_b32 s48, s48, 15
    v_mfma_f32_16x16x32_bf16 v[44:47], v[76:79], v[124:127], v[44:47]
    s_lshl_b32 s48, s48, 14
    s_waitcnt vmcnt(12) lgkmcnt(0)
    v_mfma_f32_16x16x32_bf16 v[16:19], v[48:51], v[128:131], v[16:19]
    ds_read_b64_tr_b16 v[64:65], v2 offset:12288
    ds_read_b64_tr_b16 v[66:67], v2 offset:14336
    v_mfma_f32_16x16x32_bf16 v[32:35], v[48:51], v[132:135], v[32:35]
    ds_read_b64_tr_b16 v[68:69], v3 offset:12288
    ds_read_b64_tr_b16 v[70:71], v3 offset:14336
    v_mfma_f32_16x16x32_bf16 v[20:23], v[52:55], v[128:131], v[20:23]
    ds_read_b64_tr_b16 v[72:73], v4 offset:12288
    ds_read_b64_tr_b16 v[74:75], v4 offset:14336
    v_mfma_f32_16x16x32_bf16 v[36:39], v[52:55], v[132:135], v[36:39]
    ds_read_b64_tr_b16 v[76:77], v5 offset:12288
    ds_read_b64_tr_b16 v[78:79], v5 offset:14336
    v_mfma_f32_16x16x32_bf16 v[24:27], v[56:59], v[128:131], v[24:27]
    buffer_load_dwordx4 v[120:123], v1, s[64:67], s53 offen offset:1024 sc1
    v_add_u32 v2, s48, v207
    v_mfma_f32_16x16x32_bf16 v[40:43], v[56:59], v[132:135], v[40:43]
    buffer_load_dwordx4 v[124:127], v6, s[64:67], s53 offen offset:1024 sc1
    v_xor_b32 v3, 32, v2
    v_mfma_f32_16x16x32_bf16 v[28:31], v[60:63], v[128:131], v[28:31]
    v_xor_b32 v4, 64, v2
    v_xor_b32 v5, 96, v2
    v_mfma_f32_16x16x32_bf16 v[44:47], v[60:63], v[132:135], v[44:47]
    s_waitcnt vmcnt(12) lgkmcnt(0)
    v_mfma_f32_16x16x32_bf16 v[16:19], v[64:67], v[136:139], v[16:19]
    ds_read_b64_tr_b16 v[48:49], v2 offset:0
    ds_read_b64_tr_b16 v[50:51], v2 offset:2048
    v_mfma_f32_16x16x32_bf16 v[32:35], v[64:67], v[140:143], v[32:35]
    ds_read_b64_tr_b16 v[52:53], v3 offset:0
    ds_read_b64_tr_b16 v[54:55], v3 offset:2048
    v_mfma_f32_16x16x32_bf16 v[20:23], v[68:71], v[136:139], v[20:23]
    ds_read_b64_tr_b16 v[56:57], v4 offset:0
    ds_read_b64_tr_b16 v[58:59], v4 offset:2048
    v_mfma_f32_16x16x32_bf16 v[36:39], v[68:71], v[140:143], v[36:39]
    ds_read_b64_tr_b16 v[60:61], v5 offset:0
    ds_read_b64_tr_b16 v[62:63], v5 offset:2048
    v_mfma_f32_16x16x32_bf16 v[24:27], v[72:75], v[136:139], v[24:27]
    buffer_load_dwordx4 v[128:131], v1, s[64:67], s53 offen offset:2048 sc1
    v_mfma_f32_16x16x32_bf16 v[40:43], v[72:75], v[140:143], v[40:43]
    buffer_load_dwordx4 v[132:135], v6, s[64:67], s53 offen offset:2048 sc1
    v_mfma_f32_16x16x32_bf16 v[28:31], v[76:79], v[136:139], v[28:31]
    v_mfma_f32_16x16x32_bf16 v[44:47], v[76:79], v[140:143], v[44:47]
    buffer_load_dwordx4 v[136:139], v1, s[64:67], s53 offen offset:3072 sc1
    buffer_load_dwordx4 v[140:143], v6, s[64:67], s53 offen offset:3072 sc1
    s_add_u32 s44, s44, 1
    s_cmp_lt_u32 s44, 4
    s_cbranch_scc1 F_GLOOP
    s_add_u32 s57, s56, 65536
    s_waitcnt lgkmcnt(0)
    v_cvt_pk_bf16_f32 v48, v16, v17
    v_cvt_pk_bf16_f32 v49, v18, v19
    v_cvt_pk_bf16_f32 v50, v20, v21
    v_cvt_pk_bf16_f32 v51, v22, v23
    v_cvt_pk_bf16_f32 v52, v24, v25
    v_cvt_pk_bf16_f32 v53, v26, v27
    v_cvt_pk_bf16_f32 v54, v28, v29
    v_cvt_pk_bf16_f32 v55, v30, v31
    v_cvt_pk_bf16_f32 v56, v32, v33
    v_cvt_pk_bf16_f32 v57, v34, v35
    v_cvt_pk_bf16_f32 v58, v36, v37
    v_cvt_pk_bf16_f32 v59, v38, v39
    v_cvt_pk_bf16_f32 v60, v40, v41
    v_cvt_pk_bf16_f32 v61, v42, v43
    v_cvt_pk_bf16_f32 v62, v44, v45
    v_cvt_pk_bf16_f32 v63, v46, v47
    v_permlane16_swap_b32 v48, v50
    v_permlane16_swap_b32 v49, v51
    buffer_store_dwordx4 v[48:51], v210, s[60:63], s56 offen offset:0 sc1
    v_permlane16_swap_b32 v52, v54
    v_permlane16_swap_b32 v53, v55
    buffer_store_dwordx4 v[52:55], v210, s[60:63], s56 offen offset:64 sc1
    v_permlane16_swap_b32 v56, v58
    v_permlane16_swap_b32 v57, v59
    buffer_store_dwordx4 v[56:59], v210, s[60:63], s57 offen offset:0 sc1
    v_permlane16_swap_b32 v60, v62
    v_permlane16_swap_b32 v61, v63
    buffer_store_dwordx4 v[60:63], v210, s[60:63], s57 offen offset:64 sc1
    s_endpgm
F_CNB0:
    ds_write_b32 v204, v14 offset:32
F_WS15:
    ds_read_b32 v15, v209 offset:128
    s_waitcnt lgkmcnt(0)
    v_cmp_ne_u32 vcc, 1, v15
    s_cbranch_vccz F_WS15_X
    s_branch F_WS15
F_WS15_X:
    s_branch F_CB0
F_CNB1:
    ds_write_b32 v204, v14
    s_branch F_CB1
F_GP0:
    s_cmp_eq_u32 s46, 0
    s_cbranch_scc1 F_GQ0
    s_cmp_lt_i32 s51, 0
    s_cbranch_scc1 F_GQ0
    s_mov_b32 s17, 0
    s_atomic_add s17, s[14:15], 0 glc
    ds_read_b32 v10, v211
    s_waitcnt lgkmcnt(0)
    v_cmp_ne_u32 s[40:41], 1, v10
    s_lshr_b32 s17, s17, 2
    s_or_b32 s45, s40, s41
    s_lshr_b32 s40, s45, 1
    s_or_b32 s45, s45, s40
    s_lshr_b32 s40, s45, 2
    s_or_b32 s45, s45, s40
    s_andn2_b32 s47, s17, s45
    s_cmp_gt_u32 s58, 400000
    s_cselect_b32 s47, -1, s47
    s_and_b32 s47, s47, s46
    s_branch F_GQ0
F_GS0:
    s_cmp_eq_u32 s18, 0
    s_cbranch_scc1 F_GT0
    s_waitcnt vmcnt(0)
    s_atomic_add s16, s[12:13], 0
    s_mov_b32 s18, 0
F_GT0:
    s_sleep 6
F_GE0:
    s_add_u32 s58, s58, 1
    s_mov_b32 s17, 0
    s_atomic_add s17, s[14:15], 0 glc
    ds_read_b32 v10, v211
F_GR0:
    s_waitcnt lgkmcnt(0)
    v_cmp_ne_u32 s[40:41], 1, v10
    s_lshr_b32 s17, s17, 2
    s_or_b32 s45, s40, s41
    s_lshr_b32 s40, s45, 1
    s_or_b32 s45, s45, s40
    s_lshr_b32 s40, s45, 2
    s_or_b32 s45, s45, s40
    s_andn2_b32 s47, s17, s45
    s_cmp_gt_u32 s58, 400000
    s_cselect_b32 s47, -1, s47
    s_and_b32 s47, s47, s46
    s_cbranch_scc0 F_GS0
    s_and_b32 s45, s46, s47
    s_cselect_b32 s66, s38, 0
    s_ff1_i32_b32 s50, s45
    s_bitset0_b32 s46, s50
    s_lshl_b32 s52, s50, 10
    s_add_u32 s52, s52, s55
    buffer_load_dwordx4 v[80:83], v1, s[36:39], s52 offen offset:0 sc1
    buffer_load_dwordx4 v[84:87], v6, s[36:39], s52 offen offset:0 sc1
    buffer_load_dwordx4 v[88:91], v1, s[36:39], s52 offen offset:1024 sc1
    buffer_load_dwordx4 v[92:95], v6, s[36:39], s52 offen offset:1024 sc1
    buffer_load_dwordx4 v[96:99], v1, s[36:39], s52 offen offset:2048 sc1
    buffer_load_dwordx4 v[100:103], v6, s[36:39], s52 offen offset:2048 sc1
    buffer_load_dwordx4 v[104:107], v1, s[36:39], s52 offen offset:3072 sc1
    buffer_load_dwordx4 v[108:111], v6, s[36:39], s52 offen offset:3072 sc1
    s_cmp_eq_u32 s18, 0
    s_cbranch_scc1 F_GU
    s_waitcnt vmcnt(8)
    s_atomic_add s16, s[12:13], 0
    s_mov_b32 s18, 0
F_GU:
    s_lshr_b32 s48, s54, s50
    s_and_b32 s48, s48, 15
    s_lshl_b32 s48, s48, 14
    v_add_u32 v2, s48, v207
    v_xor_b32 v3, 32, v2
    v_xor_b32 v4, 64, v2
    v_xor_b32 v5, 96, v2
    ds_read_b64_tr_b16 v[48:49], v2 offset:0
    ds_read_b64_tr_b16 v[50:51], v2 offset:2048
    ds_read_b64_tr_b16 v[52:53], v3 offset:0
    ds_read_b64_tr_b16 v[54:55], v3 offset:2048
    ds_read_b64_tr_b16 v[56:57], v4 offset:0
    ds_read_b64_tr_b16 v[58:59], v4 offset:2048
    ds_read_b64_tr_b16 v[60:61], v5 offset:0
    ds_read_b64_tr_b16 v[62:63], v5 offset:2048
    s_cmp_lt_i32 s51, 0
    s_cbranch_scc0 F_GN0
    s_and_b32 s45, s46, s47
    s_cselect_b32 s66, s38, 0
    s_ff1_i32_b32 s51, s45
    s_bitset0_b32 s46, s51
    s_lshl_b32 s53, s51, 10
    s_add_u32 s53, s53, s55
    buffer_load_dwordx4 v[112:115], v1, s[64:67], s53 offen offset:0 sc1
    buffer_load_dwordx4 v[116:119], v6, s[64:67], s53 offen offset:0 sc1
    buffer_load_dwordx4 v[120:123], v1, s[64:67], s53 offen offset:1024 sc1
    buffer_load_dwordx4 v[124:127], v6, s[64:67], s53 offen offset:1024 sc1
    buffer_load_dwordx4 v[128:131], v1, s[64:67], s53 offen offset:2048 sc1
    buffer_load_dwordx4 v[132:135], v6, s[64:67], s53 offen offset:2048 sc1
    buffer_load_dwordx4 v[136:139], v1, s[64:67], s53 offen offset:3072 sc1
    buffer_load_dwordx4 v[140:143], v6, s[64:67], s53 offen offset:3072 sc1
    s_branch F_GC0
F_GN0:
    s_waitcnt vmcnt(0)
    s_branch F_GC0
F_GP1:
    s_cmp_eq_u32 s46, 0
    s_cbranch_scc1 F_GQ1
    s_cmp_lt_i32 s50, 0
    s_cbranch_scc1 F_GQ1
    s_mov_b32 s17, 0
    s_atomic_add s17, s[14:15], 0 glc
    ds_read_b32 v10, v211
    s_waitcnt lgkmcnt(0)
    v_cmp_ne_u32 s[40:41], 1, v10
    s_lshr_b32 s17, s17, 2
    s_or_b32 s45, s40, s41
    s_lshr_b32 s40, s45, 1
    s_or_b32 s45, s45, s40
    s_lshr_b32 s40, s45, 2
    s_or_b32 s45, s45, s40
    s_andn2_b32 s47, s17, s45
    s_cmp_gt_u32 s58, 400000
    s_cselect_b32 s47, -1, s47
    s_and_b32 s47, s47, s46
    s_branch F_GQ1
F_GS1:
    s_cmp_eq_u32 s18, 0
    s_cbranch_scc1 F_GT1
    s_waitcnt vmcnt(0)
    s_atomic_add s16, s[12:13], 0
    s_mov_b32 s18, 0
F_GT1:
    s_sleep 6
F_GE1:
    s_add_u32 s58, s58, 1
    s_mov_b32 s17, 0
    s_atomic_add s17, s[14:15], 0 glc
    ds_read_b32 v10, v211
F_GR1:
    s_waitcnt lgkmcnt(0)
    v_cmp_ne_u32 s[40:41], 1, v10
    s_lshr_b32 s17, s17, 2
    s_or_b32 s45, s40, s41
    s_lshr_b32 s40, s45, 1
    s_or_b32 s45, s45, s40
    s_lshr_b32 s40, s45, 2
    s_or_b32 s45, s45, s40
    s_andn2_b32 s47, s17, s45
    s_cmp_gt_u32 s58, 400000
    s_cselect_b32 s47, -1, s47
    s_and_b32 s47, s47, s46
    s_cbranch_scc0 F_GS1
    s_and_b32 s45, s46, s47
    s_cselect_b32 s66, s38, 0
    s_ff1_i32_b32 s51, s45
    s_bitset0_b32 s46, s51
    s_lshl_b32 s53, s51, 10
    s_add_u32 s53, s53, s55
    buffer_load_dwordx4 v[112:115], v1, s[36:39], s53 offen offset:0 sc1
    buffer_load_dwordx4 v[116:119], v6, s[36:39], s53 offen offset:0 sc1
    buffer_load_dwordx4 v[120:123], v1, s[36:39], s53 offen offset:1024 sc1
    buffer_load_dwordx4 v[124:127], v6, s[36:39], s53 offen offset:1024 sc1
    buffer_load_dwordx4 v[128:131], v1, s[36:39], s53 offen offset:2048 sc1
    buffer_load_dwordx4 v[132:135], v6, s[36:39], s53 offen offset:2048 sc1
    buffer_load_dwordx4 v[136:139], v1, s[36:39], s53 offen offset:3072 sc1
    buffer_load_dwordx4 v[140:143], v6, s[36:39], s53 offen offset:3072 sc1
    s_lshr_b32 s48, s54, s51
    s_and_b32 s48, s48, 15
    s_lshl_b32 s48, s48, 14
    v_add_u32 v2, s48, v207
    v_xor_b32 v3, 32, v2
    v_xor_b32 v4, 64, v2
    v_xor_b32 v5, 96, v2
    ds_read_b64_tr_b16 v[48:49], v2 offset:0
    ds_read_b64_tr_b16 v[50:51], v2 offset:2048
    ds_read_b64_tr_b16 v[52:53], v3 offset:0
    ds_read_b64_tr_b16 v[54:55], v3 offset:2048
    ds_read_b64_tr_b16 v[56:57], v4 offset:0
    ds_read_b64_tr_b16 v[58:59], v4 offset:2048
    ds_read_b64_tr_b16 v[60:61], v5 offset:0
    ds_read_b64_tr_b16 v[62:63], v5 offset:2048
    s_cmp_lt_i32 s50, 0
    s_cbranch_scc0 F_GN1
    s_and_b32 s45, s46, s47
    s_cselect_b32 s66, s38, 0
    s_ff1_i32_b32 s50, s45
    s_bitset0_b32 s46, s50
    s_lshl_b32 s52, s50, 10
    s_add_u32 s52, s52, s55
    buffer_load_dwordx4 v[80:83], v1, s[64:67], s52 offen offset:0 sc1
    buffer_load_dwordx4 v[84:87], v6, s[64:67], s52 offen offset:0 sc1
    buffer_load_dwordx4 v[88:91], v1, s[64:67], s52 offen offset:1024 sc1
    buffer_load_dwordx4 v[92:95], v6, s[64:67], s52 offen offset:1024 sc1
    buffer_load_dwordx4 v[96:99], v1, s[64:67], s52 offen offset:2048 sc1
    buffer_load_dwordx4 v[100:103], v6, s[64:67], s52 offen offset:2048 sc1
    buffer_load_dwordx4 v[104:107], v1, s[64:67], s52 offen offset:3072 sc1
    buffer_load_dwordx4 v[108:111], v6, s[64:67], s52 offen offset:3072 sc1
    s_branch F_GC1
F_GN1:
    s_waitcnt vmcnt(0)
    s_branch F_GC1
F_END:
    s_endpgm

.section .rodata,"a"
.p2align 6
.amdhsa_kernel concat_heads__linear_attn_block__ssm_conv_h3__prompt_kernel
  .amdhsa_next_free_vgpr 256
  .amdhsa_next_free_sgpr 102
  .amdhsa_accum_offset 256
  .amdhsa_group_segment_fixed_size 0
  .amdhsa_kernarg_size 96
  .amdhsa_user_sgpr_count 2
  .amdhsa_user_sgpr_kernarg_segment_ptr 1
  .amdhsa_system_sgpr_workgroup_id_x 1
  .amdhsa_float_denorm_mode_32 3
  .amdhsa_float_denorm_mode_16_64 3
.end_amdhsa_kernel
```

```asm
; @launch grid=(256,1,1) block=(512,1,1) lds=163840
.amdgcn_target "amdgcn-amd-amdhsa--gfx950"
.text
.globl concat_heads__linear_attn_block__ssm_conv_h3__prompt_kernel
.p2align 8
.type concat_heads__linear_attn_block__ssm_conv_h3__prompt_kernel,@function
concat_heads__linear_attn_block__ssm_conv_h3__prompt_kernel:
    s_load_dwordx16 s[4:19], s[0:1], 0
    s_cmp_ge_u32 s2, 256
    s_cbranch_scc1 F_END
    v_lshrrev_b32 v1, 6, v0
    v_and_b32 v0, 63, v0
    s_and_b32 s28, s2, 7
    s_lshr_b32 s29, s2, 3
    v_readfirstlane_b32 s3, v1
    s_and_b32 s30, s28, 1
    s_lshl_b32 s30, s30, 3
    s_and_b32 s31, s29, 7
    s_add_u32 s30, s30, s31
    s_lshr_b32 s31, s28, 1
    s_lshl_b32 s31, s31, 2
    s_lshr_b32 s32, s29, 3
    s_add_u32 s31, s31, s32
    s_lshr_b32 s30, s29, 1
    s_and_b32 s31, s29, 1
    s_lshl_b32 s32, s28, 1
    s_add_u32 s31, s31, s32
    s_cmp_lt_u32 s3, 4
    s_cbranch_scc1 F_C
    s_sub_u32 s34, s3, 4
    v_lshrrev_b32 v2, 3, v0
    v_and_b32 v4, 7, v0
    s_getpc_b64 s[66:67]
F_PC:
    s_lshl_b32 s40, s29, 10
    s_lshl_b32 s41, s34, 8
    s_add_u32 s40, s40, s41
    v_and_b32 v7, 1, v0
    v_lshlrev_b32 v7, 7, v7
    v_add_u32 v7, s40, v7
    v_min_u32 v7, F_END-F_PC, v7
    global_load_dword v250, v7, s[66:67]
    v_lshlrev_b32 v8, 11, v4
    v_and_b32 v9, 15, v0
    v_min_u32 v9, 11, v9
    v_lshrrev_b32 v7, 2, v9
    v_and_b32 v9, 3, v9
    v_lshlrev_b32 v9, 7, v9
    v_lshl_add_u32 v9, v7, 11, v9
    s_and_b32 s100, s28, 1
    s_lshr_b32 s101, s28, 1
    s_lshl_b32 s40, s100, 21
    s_lshl_b32 s41, s101, 19
    s_add_u32 s99, s40, s41
    s_lshl_b32 s40, s29, 14
    s_lshl_b32 s41, s34, 7
    s_add_u32 s42, s40, s41
    s_add_u32 s42, s42, s99
    s_mul_i32 s98, s100, 6144
    s_lshl_b32 s41, s101, 9
    s_add_u32 s98, s98, s41
    s_lshl_b32 s43, s29, 2
    s_add_u32 s43, s43, s34
    s_mul_i32 s43, s43, 12288
    s_add_u32 s43, s43, s98
    v_min_u32 v9, 5, v4
    v_lshrrev_b32 v7, 1, v9
    v_and_b32 v9, 1, v9
    v_lshlrev_b32 v9, 7, v9
    v_lshl_add_u32 v19, v7, 11, v9
    v_and_b32 v7, 1, v2
    v_mul_u32_u24 v7, 6144, v7
    v_add_u32 v9, v19, v7
    s_lshl_b32 s98, s28, 8
    s_lshl_b32 s43, s29, 2
    s_add_u32 s43, s43, s34
    s_mul_i32 s43, s43, 12288
    s_add_u32 s43, s43, s98
    s_mov_b32 s46, 0x400000
    s_mov_b32 s47, 0x00020000
    s_mov_b32 s50, 0x600000
    s_mov_b32 s51, 0x00020000
    s_lshl_b32 s40, s34, 3
    v_add_u32 v3, s40, v2
    v_lshrrev_b32 v5, 4, v0
    s_and_b32 s40, s34, 1
    s_lshl_b32 s41, s40, 2
    v_add_u32 v6, s41, v5
    v_xor_b32 v6, v6, v4
    v_lshlrev_b32 v6, 4, v6
    v_lshl_add_u32 v10, v3, 11, v6
    v_and_b32 v6, 1, v5
    v_lshlrev_b32 v6, 1, v6
    v_or_b32 v6, s41, v6
    v_xor_b32 v6, v6, v4
    v_lshlrev_b32 v6, 4, v6
    v_mul_u32_u24 v11, 6144, v3
    v_add_u32 v11, v11, v6
    s_lshl_b32 s52, s30, 18
    s_add_u32 s53, s52, 64512
    s_add_u32 s54, s52, 129024
    s_add_u32 s55, s52, 193536
    s_lshl_b32 s56, s31, 7
    s_add_u32 s57, s56, 1024
    s_add_u32 s58, s56, 2048
    s_add_u32 s59, s56, 193536
    s_add_u32 s60, s56, 198656
    s_add_u32 s61, s56, 199680
    s_mul_i32 s62, s34, 10240
    s_mov_b32 s63, 393216
    s_waitcnt lgkmcnt(0)
    s_mov_b64 s[44:45], s[4:5]
    s_mov_b64 s[48:49], s[6:7]
    buffer_load_dword v250, v9, s[48:51], s43 offen
    buffer_load_dword v250, v8, s[44:47], s42 offen
    s_add_u32 m0, s62, 45056
    s_nop 0
    buffer_load_dwordx4 v11, s[48:51], s57 offen offset:1024 lds
    buffer_load_dwordx4 v11, s[48:51], s58 offen offset:2048 lds
    buffer_load_dwordx4 v11, s[48:51], s56 offen offset:0 lds
    buffer_load_dwordx4 v11, s[48:51], s59 offen offset:3072 lds
    s_add_u32 m0, s62, 40960
    s_nop 0
    buffer_load_dwordx4 v10, s[44:47], s52 offen offset:0 lds
    buffer_load_dwordx4 v10, s[44:47], s53 offen offset:1024 lds
    buffer_load_dwordx4 v10, s[44:47], s54 offen offset:2048 lds
    buffer_load_dwordx4 v10, s[44:47], s55 offen offset:3072 lds
    s_add_u32 m0, s62, 49152
    s_nop 0
    buffer_load_dwordx4 v11, s[48:51], s60 offen offset:0 lds
    buffer_load_dwordx4 v11, s[48:51], s61 offen offset:1024 lds
    v_add_u32 v10, 128, v10
    v_add_u32 v11, s63, v11
    s_add_u32 m0, s62, 86016
    s_nop 0
    buffer_load_dwordx4 v11, s[48:51], s57 offen offset:1024 lds
    buffer_load_dwordx4 v11, s[48:51], s58 offen offset:2048 lds
    buffer_load_dwordx4 v11, s[48:51], s56 offen offset:0 lds
    buffer_load_dwordx4 v11, s[48:51], s59 offen offset:3072 lds
    s_add_u32 m0, s62, 81920
    s_nop 0
    buffer_load_dwordx4 v10, s[44:47], s52 offen offset:0 lds
    buffer_load_dwordx4 v10, s[44:47], s53 offen offset:1024 lds
    buffer_load_dwordx4 v10, s[44:47], s54 offen offset:2048 lds
    buffer_load_dwordx4 v10, s[44:47], s55 offen offset:3072 lds
    s_add_u32 m0, s62, 90112
    s_nop 0
    buffer_load_dwordx4 v11, s[48:51], s60 offen offset:0 lds
    buffer_load_dwordx4 v11, s[48:51], s61 offen offset:1024 lds
    v_add_u32 v10, 128, v10
    v_add_u32 v11, s63, v11
    s_load_dwordx8 s[20:27], s[0:1], 64
    s_and_b32 s32, s29, 3
    s_lshr_b32 s33, s28, 1
    s_lshl_b32 s33, s33, 2
    s_add_u32 s32, s32, s33
    s_and_b32 s33, s28, 1
    s_lshl_b32 s33, s33, 3
    s_lshr_b32 s35, s29, 2
    s_add_u32 s33, s33, s35
    v_lshlrev_b32 v1, 4, v0
    v_lshlrev_b32 v6, 1, v5
    v_xor_b32 v6, v6, v4
    v_lshlrev_b32 v6, 4, v6
    v_lshl_add_u32 v12, v2, 11, v6
    v_mov_b32 v13, 0
    s_lshr_b32 s35, s29, 4
    s_lshl_b32 s35, s35, 3
    s_add_u32 s35, s35, s28
    s_lshl_b32 s35, s35, 4
    s_and_b32 s40, s29, 15
    s_add_u32 s35, s35, s40
    s_mov_b32 s35, s2
    s_lshl_b32 s35, s35, 2
    s_add_u32 s35, s35, s34
    s_and_b32 s96, s29, 3
    s_waitcnt lgkmcnt(0)
    s_mov_b32 s36, s26
    s_mov_b32 s37, s27
    s_mov_b32 s38, 0x10000000
    s_mov_b32 s39, 0x00020000
    s_mov_b32 s64, s24
    s_mov_b32 s65, s25
    s_mov_b32 s66, 0x100
    s_mov_b32 s67, 0x00020000
    s_lshr_b32 s69, s29, 2
    s_mul_i32 s40, s96, 3
    s_add_u32 s40, s40, 4
    s_add_u32 s41, s40, s34
    s_lshl_b32 s41, s41, 7
    s_add_u32 s99, s99, s41
    s_lshl_b32 s41, s69, 16
    s_add_u32 s99, s99, s41
    s_lshl_b32 s40, s40, 5
    s_mul_i32 s41, s69, 12
    s_add_u32 s40, s40, s41
    s_lshl_b32 s41, s34, 2
    s_add_u32 s40, s40, s41
    s_mul_i32 s40, s40, 12288
    s_add_u32 s98, s98, s40
    s_lshl_b32 s100, s100, 10
    s_lshl_b32 s101, s101, 19
    s_add_u32 s100, s100, s101
    s_lshl_b32 s41, s29, 14
    s_add_u32 s100, s100, s41
    v_and_b32 v16, 31, v0
    v_lshlrev_b32 v16, 11, v16
    v_mul_u32_u24 v17, 6144, v2
    v_add_u32 v17, v17, v19
    v_lshlrev_b32 v18, 7, v4
    v_lshl_add_u32 v18, v2, 11, v18
    s_cmp_lg_u32 s96, 0
    s_cbranch_scc1 F_PF0X
    s_cmp_eq_u32 s34, 3
    s_cbranch_scc1 F_PF0X
    buffer_load_dword v250, v17, s[48:51], s98 offen
    buffer_load_dword v250, v16, s[44:47], s99 offen
F_PF0X:
    s_cmp_lg_u32 s96, 0
    s_cbranch_scc1 F_PW0X
    s_cmp_lg_u32 s34, 3
    s_cbranch_scc1 F_PW0X
    s_mov_b32 s40, s8
    s_mov_b32 s41, s9
    s_mov_b32 s42, 0x200000
    s_mov_b32 s43, 0x00020000
    buffer_load_dword v250, v18, s[40:43], s100 offen
F_PW0X:
    s_lshl_b32 s40, s34, 1
    v_xor_b32 v20, s40, v4
    v_lshlrev_b32 v20, 4, v20
    v_lshl_add_u32 v20, v2, 11, v20
    s_lshr_b32 s40, s2, 4
    s_lshl_b32 s40, s40, 18
    s_and_b32 s41, s2, 15
    s_lshl_b32 s41, s41, 7
    s_add_u32 s40, s40, s41
    v_xor_b32 v21, 6, v4
    v_lshlrev_b32 v21, 4, v21
    v_lshl_add_u32 v21, v2, 11, v21
    v_add_u32 v21, s40, v21
    v_subrev_u32 v21, 6144, v21
    s_lshl_b32 s41, s34, 15
    s_add_u32 s40, s40, s41
    v_add_u32 v20, s40, v20
    v_and_b32 v22, 3, v2
    v_xor_b32 v22, s34, v22
    v_lshlrev_b32 v22, 5, v22
    v_lshl_add_u32 v22, v4, 2, v22
    v_lshl_add_u32 v22, v2, 11, v22
    v_add_u32 v22, 123264, v22
    v_add_u32 v23, 3, v2
    v_and_b32 v23, 3, v23
    v_xor_b32 v23, s34, v23
    v_lshlrev_b32 v23, 5, v23
    v_lshl_add_u32 v23, v4, 2, v23
    v_lshl_add_u32 v23, v2, 11, v23
    v_add_u32 v23, 122880, v23
    s_and_b32 s40, s2, 15
    s_lshl_b32 s40, s40, 6
    s_lshl_b32 s41, s34, 4
    s_add_u32 s40, s40, s41
    v_lshlrev_b32 v24, 1, v4
    v_add_u32 v24, s40, v24
    v_mul_u32_u24 v25, 4224, v24
    v_lshlrev_b32 v24, 3, v24
    s_lshr_b32 s40, s2, 4
    s_lshl_b32 s40, s40, 3
    v_add_u32 v26, s40, v2
    v_lshl_add_u32 v25, v26, 4, v25
    s_lshr_b32 s40, s2, 4
    s_lshl_b32 s40, s40, 4
    s_lshl_b32 s41, s34, 3
    s_add_u32 s40, s40, s41
    v_add_u32 v28, s40, v2
    v_mul_u32_u24 v232, 33792, v4
    v_lshl_add_u32 v232, v28, 4, v232
    v_lshrrev_b32 v29, 6, v28
    v_lshlrev_b32 v29, 9, v29
    v_and_b32 v30, 15, v28
    v_lshl_add_u32 v29, v30, 4, v29
    v_bfe_u32 v30, v28, 4, 2
    v_lshl_add_u32 v29, v30, 2, v29
    v_lshlrev_b32 v30, 4, v4
    v_lshl_add_u32 v234, v29, 11, v30
    v_lshl_add_u32 v233, v29, 12, v30
    s_waitcnt vmcnt(10)
    s_barrier
    s_add_u32 m0, s62, 4096
    s_nop 0
    buffer_load_dwordx4 v11, s[48:51], s57 offen offset:1024 lds
    buffer_load_dwordx4 v11, s[48:51], s58 offen offset:2048 lds
    buffer_load_dwordx4 v11, s[48:51], s56 offen offset:0 lds
    buffer_load_dwordx4 v11, s[48:51], s59 offen offset:3072 lds
    s_cmp_lg_u32 s96, 1
    s_cbranch_scc1 F_PF1X
    s_cmp_eq_u32 s34, 3
    s_cbranch_scc1 F_PF1X
    buffer_load_dword v250, v17, s[48:51], s98 offen
    buffer_load_dword v250, v16, s[44:47], s99 offen
F_PF1X:
    s_add_u32 m0, s62, 0
    s_nop 0
    buffer_load_dwordx4 v10, s[44:47], s52 offen offset:0 lds
    buffer_load_dwordx4 v10, s[44:47], s53 offen offset:1024 lds
    buffer_load_dwordx4 v10, s[44:47], s54 offen offset:2048 lds
    buffer_load_dwordx4 v10, s[44:47], s55 offen offset:3072 lds
    s_cmp_lg_u32 s96, 1
    s_cbranch_scc1 F_PW1X
    s_cmp_lg_u32 s34, 3
    s_cbranch_scc1 F_PW1X
    s_mov_b32 s40, s8
    s_mov_b32 s41, s9
    s_mov_b32 s42, 0x200000
    s_mov_b32 s43, 0x00020000
    buffer_load_dword v250, v18, s[40:43], s100 offen
F_PW1X:
    s_add_u32 m0, s62, 8192
    s_nop 0
    buffer_load_dwordx4 v11, s[48:51], s60 offen offset:0 lds
    buffer_load_dwordx4 v11, s[48:51], s61 offen offset:1024 lds
    v_add_u32 v10, 128, v10
    v_add_u32 v11, s63, v11
    s_cmp_lg_u32 s96, 2
    s_cbranch_scc1 F_KV2X
    s_lshl_b32 s69, s34, 11
    s_mov_b32 s40, s12
    s_mov_b32 s41, s13
    s_mov_b32 s42, 0x400000
    s_mov_b32 s43, 0x00020000
    s_mov_b32 m0, 122880
    s_mov_b64 exec, 0xffffff
    buffer_load_dwordx4 v21, s[40:43], 0 offen nt lds
    s_mov_b64 exec, -1
    s_add_u32 m0, s69, 123264
    s_mov_b32 s97, 0
    buffer_load_dwordx4 v20, s[40:43], s97 offen nt lds
    s_mov_b32 s97, 15360
    buffer_load_dwordx4 v20, s[40:43], s97 offen offset:1024 nt lds
    s_add_u32 m0, s69, 131456
    s_mov_b32 s97, 131072
    buffer_load_dwordx4 v20, s[40:43], s97 offen nt lds
    s_mov_b32 s97, 146432
    buffer_load_dwordx4 v20, s[40:43], s97 offen offset:1024 nt lds
    s_mov_b32 s40, s14
    s_mov_b32 s41, s15
    s_mov_b32 s42, 0x400000
    s_mov_b32 s43, 0x00020000
    s_add_u32 m0, s69, 139648
    s_mov_b32 s97, 0
    buffer_load_dwordx4 v20, s[40:43], s97 offen nt lds
    s_mov_b32 s97, 15360
    buffer_load_dwordx4 v20, s[40:43], s97 offen offset:1024 nt lds
    s_add_u32 m0, s69, 147840
    s_mov_b32 s97, 131072
    buffer_load_dwordx4 v20, s[40:43], s97 offen nt lds
    s_mov_b32 s97, 146432
    buffer_load_dwordx4 v20, s[40:43], s97 offen offset:1024 nt lds
    s_mov_b32 s40, s16
    s_mov_b32 s41, s17
    s_mov_b32 s42, 0x2000
    s_mov_b32 s43, 0x00020000
    buffer_load_dwordx4 v[32:35], v24, s[40:43], 0 offen
F_KV2X:
    s_waitcnt vmcnt(10)
    s_barrier
    s_add_u32 m0, s62, 45056
    s_nop 0
    buffer_load_dwordx4 v11, s[48:51], s57 offen offset:1024 lds
    s_mov_b32 s7, 0xffff0000
    buffer_load_dwordx4 v11, s[48:51], s58 offen offset:2048 lds
    buffer_load_dwordx4 v11, s[48:51], s56 offen offset:0 lds
    buffer_load_dwordx4 v11, s[48:51], s59 offen offset:3072 lds
    s_add_u32 m0, s62, 40960
    s_nop 0
    buffer_load_dwordx4 v10, s[44:47], s52 offen offset:0 lds
    buffer_load_dwordx4 v10, s[44:47], s53 offen offset:1024 lds
    buffer_load_dwordx4 v10, s[44:47], s54 offen offset:2048 lds
    buffer_load_dwordx4 v10, s[44:47], s55 offen offset:3072 lds
    s_add_u32 m0, s62, 49152
    s_nop 0
    buffer_load_dwordx4 v11, s[48:51], s60 offen offset:0 lds
    buffer_load_dwordx4 v11, s[48:51], s61 offen offset:1024 lds
    s_cmp_lg_u32 s96, 0
    s_cbranch_scc1 F_KV0X
    s_lshl_b32 s69, s34, 11
    s_mov_b32 s40, s12
    s_mov_b32 s41, s13
    s_mov_b32 s42, 0x400000
    s_mov_b32 s43, 0x00020000
    s_mov_b32 m0, 122880
    s_mov_b64 exec, 0xffffff
    buffer_load_dwordx4 v21, s[40:43], 0 offen nt lds
    s_mov_b64 exec, -1
    s_add_u32 m0, s69, 123264
    s_mov_b32 s97, 0
    buffer_load_dwordx4 v20, s[40:43], s97 offen nt lds
    s_mov_b32 s97, 15360
    buffer_load_dwordx4 v20, s[40:43], s97 offen offset:1024 nt lds
    s_add_u32 m0, s69, 131456
    s_mov_b32 s97, 131072
    buffer_load_dwordx4 v20, s[40:43], s97 offen nt lds
    s_mov_b32 s97, 146432
    buffer_load_dwordx4 v20, s[40:43], s97 offen offset:1024 nt lds
    s_mov_b32 s40, s14
    s_mov_b32 s41, s15
    s_mov_b32 s42, 0x400000
    s_mov_b32 s43, 0x00020000
    s_add_u32 m0, s69, 139648
    s_mov_b32 s97, 0
    buffer_load_dwordx4 v20, s[40:43], s97 offen nt lds
    s_mov_b32 s97, 15360
    buffer_load_dwordx4 v20, s[40:43], s97 offen offset:1024 nt lds
    s_add_u32 m0, s69, 147840
    s_mov_b32 s97, 131072
    buffer_load_dwordx4 v20, s[40:43], s97 offen nt lds
    s_mov_b32 s97, 146432
    buffer_load_dwordx4 v20, s[40:43], s97 offen offset:1024 nt lds
    s_mov_b32 s40, s16
    s_mov_b32 s41, s17
    s_mov_b32 s42, 0x2000
    s_mov_b32 s43, 0x00020000
    buffer_load_dwordx4 v[32:35], v24, s[40:43], 0 offen
F_KV0X:
    v_add_u32 v10, 128, v10
    v_add_u32 v11, s63, v11
    s_waitcnt vmcnt(10)
    s_barrier
    s_add_u32 m0, s62, 86016
    s_nop 0
    buffer_load_dwordx4 v11, s[48:51], s57 offen offset:1024 lds
    buffer_load_dwordx4 v11, s[48:51], s58 offen offset:2048 lds
    buffer_load_dwordx4 v11, s[48:51], s56 offen offset:0 lds
    buffer_load_dwordx4 v11, s[48:51], s59 offen offset:3072 lds
    s_add_u32 m0, s62, 81920
    s_nop 0
    buffer_load_dwordx4 v10, s[44:47], s52 offen offset:0 lds
    buffer_load_dwordx4 v10, s[44:47], s53 offen offset:1024 lds
    buffer_load_dwordx4 v10, s[44:47], s54 offen offset:2048 lds
    buffer_load_dwordx4 v10, s[44:47], s55 offen offset:3072 lds
    s_add_u32 m0, s62, 90112
    s_nop 0
    buffer_load_dwordx4 v11, s[48:51], s60 offen offset:0 lds
    buffer_load_dwordx4 v11, s[48:51], s61 offen offset:1024 lds
    s_cmp_lg_u32 s96, 1
    s_cbranch_scc1 F_KV1X
    s_lshl_b32 s69, s34, 11
    s_mov_b32 s40, s12
    s_mov_b32 s41, s13
    s_mov_b32 s42, 0x400000
    s_mov_b32 s43, 0x00020000
    s_mov_b32 m0, 122880
    s_mov_b64 exec, 0xffffff
    buffer_load_dwordx4 v21, s[40:43], 0 offen nt lds
    s_mov_b64 exec, -1
    s_add_u32 m0, s69, 123264
    s_mov_b32 s97, 0
    buffer_load_dwordx4 v20, s[40:43], s97 offen nt lds
    s_mov_b32 s97, 15360
    buffer_load_dwordx4 v20, s[40:43], s97 offen offset:1024 nt lds
    s_add_u32 m0, s69, 131456
    s_mov_b32 s97, 131072
    buffer_load_dwordx4 v20, s[40:43], s97 offen nt lds
    s_mov_b32 s97, 146432
    buffer_load_dwordx4 v20, s[40:43], s97 offen offset:1024 nt lds
    s_mov_b32 s40, s14
    s_mov_b32 s41, s15
    s_mov_b32 s42, 0x400000
    s_mov_b32 s43, 0x00020000
    s_add_u32 m0, s69, 139648
    s_mov_b32 s97, 0
    buffer_load_dwordx4 v20, s[40:43], s97 offen nt lds
    s_mov_b32 s97, 15360
    buffer_load_dwordx4 v20, s[40:43], s97 offen offset:1024 nt lds
    s_add_u32 m0, s69, 147840
    s_mov_b32 s97, 131072
    buffer_load_dwordx4 v20, s[40:43], s97 offen nt lds
    s_mov_b32 s97, 146432
    buffer_load_dwordx4 v20, s[40:43], s97 offen offset:1024 nt lds
    s_mov_b32 s40, s16
    s_mov_b32 s41, s17
    s_mov_b32 s42, 0x2000
    s_mov_b32 s43, 0x00020000
    buffer_load_dwordx4 v[32:35], v24, s[40:43], 0 offen
F_KV1X:
    v_add_u32 v10, 128, v10
    v_add_u32 v11, s63, v11
    s_cmp_lg_u32 s96, 3
    s_cbranch_scc1 F_KV3X
    s_lshl_b32 s69, s34, 11
    s_mov_b32 s40, s12
    s_mov_b32 s41, s13
    s_mov_b32 s42, 0x400000
    s_mov_b32 s43, 0x00020000
    s_mov_b32 m0, 122880
    s_mov_b64 exec, 0xffffff
    buffer_load_dwordx4 v21, s[40:43], 0 offen nt lds
    s_mov_b64 exec, -1
    s_add_u32 m0, s69, 123264
    s_mov_b32 s97, 0
    buffer_load_dwordx4 v20, s[40:43], s97 offen nt lds
    s_mov_b32 s97, 15360
    buffer_load_dwordx4 v20, s[40:43], s97 offen offset:1024 nt lds
    s_add_u32 m0, s69, 131456
    s_mov_b32 s97, 131072
    buffer_load_dwordx4 v20, s[40:43], s97 offen nt lds
    s_mov_b32 s97, 146432
    buffer_load_dwordx4 v20, s[40:43], s97 offen offset:1024 nt lds
    s_mov_b32 s40, s14
    s_mov_b32 s41, s15
    s_mov_b32 s42, 0x400000
    s_mov_b32 s43, 0x00020000
    s_add_u32 m0, s69, 139648
    s_mov_b32 s97, 0
    buffer_load_dwordx4 v20, s[40:43], s97 offen nt lds
    s_mov_b32 s97, 15360
    buffer_load_dwordx4 v20, s[40:43], s97 offen offset:1024 nt lds
    s_add_u32 m0, s69, 147840
    s_mov_b32 s97, 131072
    buffer_load_dwordx4 v20, s[40:43], s97 offen nt lds
    s_mov_b32 s97, 146432
    buffer_load_dwordx4 v20, s[40:43], s97 offen offset:1024 nt lds
    s_mov_b32 s40, s16
    s_mov_b32 s41, s17
    s_mov_b32 s42, 0x2000
    s_mov_b32 s43, 0x00020000
    buffer_load_dwordx4 v[32:35], v24, s[40:43], 0 offen
F_KV3X:
    s_waitcnt vmcnt(10)
    s_barrier
    s_add_u32 m0, s62, 4096
    s_nop 0
    buffer_load_dwordx4 v11, s[48:51], s57 offen offset:1024 lds
    v_mov_b32 v44, 0
    v_mov_b32 v45, 0
    v_mov_b32 v46, 0
    v_mov_b32 v47, 0
    buffer_load_dwordx4 v11, s[48:51], s58 offen offset:2048 lds
    v_mov_b32 v48, 0
    v_mov_b32 v49, 0
    v_mov_b32 v50, 0
    v_mov_b32 v51, 0
    buffer_load_dwordx4 v11, s[48:51], s56 offen offset:0 lds
    v_mov_b32 v52, 0
    v_mov_b32 v53, 0
    v_mov_b32 v54, 0
    v_mov_b32 v55, 0
    buffer_load_dwordx4 v11, s[48:51], s59 offen offset:3072 lds
    v_mov_b32 v56, 0
    v_mov_b32 v57, 0
    v_mov_b32 v58, 0
    v_mov_b32 v59, 0
    s_add_u32 m0, s62, 0
    s_nop 0
    buffer_load_dwordx4 v10, s[44:47], s52 offen offset:0 lds
    v_mov_b32 v60, 0
    v_mov_b32 v61, 0
    v_mov_b32 v62, 0
    v_mov_b32 v63, 0
    buffer_load_dwordx4 v10, s[44:47], s53 offen offset:1024 lds
    v_mov_b32 v64, 0
    v_mov_b32 v65, 0
    v_mov_b32 v66, 0
    v_mov_b32 v67, 0
    buffer_load_dwordx4 v10, s[44:47], s54 offen offset:2048 lds
    v_mov_b32 v68, 0
    v_mov_b32 v69, 0
    v_mov_b32 v70, 0
    v_mov_b32 v71, 0
    buffer_load_dwordx4 v10, s[44:47], s55 offen offset:3072 lds
    v_mov_b32 v72, 0
    v_mov_b32 v73, 0
    v_mov_b32 v74, 0
    v_mov_b32 v75, 0
    s_add_u32 m0, s62, 8192
    s_nop 0
    buffer_load_dwordx4 v11, s[48:51], s60 offen offset:0 lds
    v_mov_b32 v76, 0
    v_mov_b32 v77, 0
    v_mov_b32 v78, 0
    v_mov_b32 v79, 0
    buffer_load_dwordx4 v11, s[48:51], s61 offen offset:1024 lds
    v_add_u32 v10, 128, v10
    v_add_u32 v11, s63, v11
    s_waitcnt vmcnt(10)
    s_barrier
    s_add_u32 m0, s62, 45056
    s_nop 0
    buffer_load_dwordx4 v11, s[48:51], s57 offen offset:1024 lds
    buffer_load_dwordx4 v11, s[48:51], s58 offen offset:2048 lds
    buffer_load_dwordx4 v11, s[48:51], s56 offen offset:0 lds
    buffer_load_dwordx4 v11, s[48:51], s59 offen offset:3072 lds
    s_cmp_lg_u32 s96, 2
    s_cbranch_scc1 F_PF2X
    s_cmp_eq_u32 s34, 3
    s_cbranch_scc1 F_PF2X
    buffer_load_dword v250, v17, s[48:51], s98 offen
    buffer_load_dword v250, v16, s[44:47], s99 offen
F_PF2X:
    s_add_u32 m0, s62, 40960
    s_nop 0
    buffer_load_dwordx4 v10, s[44:47], s52 offen offset:0 lds
    buffer_load_dwordx4 v10, s[44:47], s53 offen offset:1024 lds
    buffer_load_dwordx4 v10, s[44:47], s54 offen offset:2048 lds
    buffer_load_dwordx4 v10, s[44:47], s55 offen offset:3072 lds
    s_cmp_lg_u32 s96, 2
    s_cbranch_scc1 F_PW2X
    s_cmp_lg_u32 s34, 3
    s_cbranch_scc1 F_PW2X
    s_mov_b32 s40, s8
    s_mov_b32 s41, s9
    s_mov_b32 s42, 0x200000
    s_mov_b32 s43, 0x00020000
    buffer_load_dword v250, v18, s[40:43], s100 offen
F_PW2X:
    s_add_u32 m0, s62, 49152
    s_nop 0
    buffer_load_dwordx4 v11, s[48:51], s60 offen offset:0 lds
    buffer_load_dwordx4 v11, s[48:51], s61 offen offset:1024 lds
    v_add_u32 v10, 128, v10
    v_add_u32 v11, s63, v11
    s_waitcnt vmcnt(10)
    s_barrier
    s_add_u32 m0, s62, 86016
    s_nop 0
    buffer_load_dwordx4 v11, s[48:51], s57 offen offset:1024 lds
    ds_read_u16_d16_hi v44, v23 offset:0
    ds_read_u16_d16_hi v45, v23 offset:128
    ds_read_u16_d16_hi v46, v23 offset:256
    ds_read_u16_d16_hi v47, v22 offset:0
    ds_read_u16_d16_hi v48, v22 offset:128
    ds_read_u16_d16_hi v49, v22 offset:256
    buffer_load_dwordx4 v11, s[48:51], s58 offen offset:2048 lds
    ds_read_u16_d16_hi v50, v22 offset:384
    ds_read_u16_d16_hi v51, v22 offset:512
    ds_read_u16_d16_hi v52, v22 offset:640
    ds_read_u16_d16_hi v53, v22 offset:768
    ds_read_u16_d16_hi v54, v22 offset:896
    ds_read_u16_d16_hi v55, v22 offset:1024
    buffer_load_dwordx4 v11, s[48:51], s56 offen offset:0 lds
    v_lshlrev_b32 v36, 16, v32
    v_and_b32 v37, s7, v32
    v_lshlrev_b32 v38, 16, v33
    v_and_b32 v39, s7, v33
    s_waitcnt lgkmcnt(4)
    v_mul_f32 v80, v39, v44
    ds_read_u16_d16_hi v56, v22 offset:1152
    buffer_load_dwordx4 v11, s[48:51], s59 offen offset:3072 lds
    v_mul_f32 v81, v39, v45
    ds_read_u16_d16_hi v57, v22 offset:1280
    v_mul_f32 v82, v39, v46
    ds_read_u16_d16_hi v58, v22 offset:1408
    v_mul_f32 v83, v39, v47
    ds_read_u16_d16_hi v59, v22 offset:1536
    s_add_u32 m0, s62, 81920
    s_nop 0
    buffer_load_dwordx4 v10, s[44:47], s52 offen offset:0 lds
    v_mul_f32 v84, v39, v48
    ds_read_u16_d16_hi v60, v22 offset:1664
    v_mul_f32 v85, v39, v49
    ds_read_u16_d16_hi v61, v22 offset:1792
    v_mul_f32 v86, v39, v50
    ds_read_u16_d16_hi v62, v22 offset:1920
    buffer_load_dwordx4 v10, s[44:47], s53 offen offset:1024 lds
    v_mul_f32 v87, v39, v51
    ds_read_u16_d16_hi v64, v22 offset:16384
    s_waitcnt lgkmcnt(4)
    v_mul_f32 v88, v39, v52
    ds_read_u16_d16_hi v65, v22 offset:16512
    v_mul_f32 v89, v39, v53
    ds_read_u16_d16_hi v66, v22 offset:16640
    buffer_load_dwordx4 v10, s[44:47], s54 offen offset:2048 lds
    v_mul_f32 v90, v39, v54
    ds_read_u16_d16_hi v67, v22 offset:16768
    v_mul_f32 v91, v39, v55
    ds_read_u16_d16_hi v68, v22 offset:16896
    v_mul_f32 v92, v39, v56
    ds_read_u16_d16_hi v69, v22 offset:17024
    buffer_load_dwordx4 v10, s[44:47], s55 offen offset:3072 lds
    v_mul_f32 v93, v39, v57
    ds_read_u16_d16_hi v70, v22 offset:17152
    v_mul_f32 v94, v39, v58
    ds_read_u16_d16_hi v71, v22 offset:17280
    v_mul_f32 v95, v39, v59
    ds_read_u16_d16_hi v72, v22 offset:17408
    s_add_u32 m0, s62, 90112
    s_nop 0
    buffer_load_dwordx4 v11, s[48:51], s60 offen offset:0 lds
    s_waitcnt lgkmcnt(9)
    v_fmac_f32 v80, v38, v45
    ds_read_u16_d16_hi v73, v22 offset:17536
    v_fmac_f32 v81, v38, v46
    ds_read_u16_d16_hi v74, v22 offset:17664
    buffer_load_dwordx4 v11, s[48:51], s61 offen offset:1024 lds
    v_add_u32 v10, 128, v10
    v_add_u32 v11, s63, v11
    s_waitcnt vmcnt(10)
    s_barrier
    s_add_u32 m0, s62, 4096
    s_nop 0
    buffer_load_dwordx4 v11, s[48:51], s57 offen offset:1024 lds
    buffer_load_dword v14, v13, s[64:67], 0 offen sc1
    v_fmac_f32 v82, v38, v47
    ds_read_u16_d16_hi v75, v22 offset:17792
    v_fmac_f32 v83, v38, v48
    ds_read_u16_d16_hi v76, v22 offset:17920
    v_fmac_f32 v84, v38, v49
    buffer_load_dwordx4 v11, s[48:51], s58 offen offset:2048 lds
    ds_read_u16_d16_hi v77, v22 offset:18048
    v_fmac_f32 v85, v38, v50
    ds_read_u16_d16_hi v78, v22 offset:18176
    v_fmac_f32 v86, v38, v51
    ds_read_u16_d16_hi v79, v22 offset:18304
    v_fmac_f32 v87, v38, v52
    buffer_load_dwordx4 v11, s[48:51], s56 offen offset:0 lds
    v_fmac_f32 v88, v38, v53
    v_fmac_f32 v89, v38, v54
    v_fmac_f32 v90, v38, v55
    v_fmac_f32 v91, v38, v56
    v_fmac_f32 v92, v38, v57
    v_fmac_f32 v93, v38, v58
    buffer_load_dwordx4 v11, s[48:51], s59 offen offset:3072 lds
    v_fmac_f32 v94, v38, v59
    v_fmac_f32 v95, v38, v60
    v_fmac_f32 v80, v37, v46
    v_fmac_f32 v81, v37, v47
    v_fmac_f32 v82, v37, v48
    v_fmac_f32 v83, v37, v49
    s_add_u32 m0, s62, 0
    s_nop 0
    buffer_load_dwordx4 v10, s[44:47], s52 offen offset:0 lds
    v_fmac_f32 v84, v37, v50
    v_fmac_f32 v85, v37, v51
    v_fmac_f32 v86, v37, v52
    v_fmac_f32 v87, v37, v53
    v_fmac_f32 v88, v37, v54
    v_fmac_f32 v89, v37, v55
    buffer_load_dwordx4 v10, s[44:47], s53 offen offset:1024 lds
    v_fmac_f32 v90, v37, v56
    v_fmac_f32 v91, v37, v57
    v_fmac_f32 v92, v37, v58
    v_fmac_f32 v93, v37, v59
    v_fmac_f32 v94, v37, v60
    v_fmac_f32 v95, v37, v61
    buffer_load_dwordx4 v10, s[44:47], s54 offen offset:2048 lds
    v_fmac_f32 v80, v36, v47
    v_fmac_f32 v81, v36, v48
    v_fmac_f32 v82, v36, v49
    v_fmac_f32 v83, v36, v50
    v_fmac_f32 v84, v36, v51
    v_fmac_f32 v85, v36, v52
    buffer_load_dwordx4 v10, s[44:47], s55 offen offset:3072 lds
    v_fmac_f32 v86, v36, v53
    v_fmac_f32 v87, v36, v54
    v_fmac_f32 v88, v36, v55
    v_fmac_f32 v89, v36, v56
    v_fmac_f32 v90, v36, v57
    v_fmac_f32 v91, v36, v58
    s_add_u32 m0, s62, 8192
    s_nop 0
    buffer_load_dwordx4 v11, s[48:51], s60 offen offset:0 lds
    v_fmac_f32 v92, v36, v59
    v_fmac_f32 v93, v36, v60
    v_fmac_f32 v94, v36, v61
    v_fmac_f32 v95, v36, v62
    s_waitcnt lgkmcnt(0)
    v_mul_f32 v80, v80, v64
    buffer_load_dwordx4 v11, s[48:51], s61 offen offset:1024 lds
    v_add_u32 v10, 128, v10
    v_add_u32 v11, s63, v11
    s_waitcnt vmcnt(11)
    s_barrier
    s_add_u32 m0, s62, 45056
    s_nop 0
    buffer_load_dwordx4 v11, s[48:51], s57 offen offset:1024 lds
    buffer_load_dwordx4 v11, s[48:51], s58 offen offset:2048 lds
    buffer_load_dwordx4 v11, s[48:51], s56 offen offset:0 lds
    buffer_load_dwordx4 v11, s[48:51], s59 offen offset:3072 lds
    s_cmp_lg_u32 s96, 3
    s_cbranch_scc1 F_PF3X
    s_cmp_eq_u32 s34, 3
    s_cbranch_scc1 F_PF3X
    buffer_load_dword v250, v17, s[48:51], s98 offen
    buffer_load_dword v250, v16, s[44:47], s99 offen
F_PF3X:
    s_cmp_lg_u32 s96, 3
    s_cbranch_scc1 F_PW3X
    s_cmp_lg_u32 s34, 3
    s_cbranch_scc1 F_PW3X
    s_mov_b32 s40, s8
    s_mov_b32 s41, s9
    s_mov_b32 s42, 0x200000
    s_mov_b32 s43, 0x00020000
    buffer_load_dword v250, v18, s[40:43], s100 offen
F_PW3X:
    v_mul_f32 v81, v81, v65
    v_mul_f32 v82, v82, v66
    v_mul_f32 v83, v83, v67
    v_mul_f32 v84, v84, v68
    s_add_u32 m0, s62, 40960
    s_nop 0
    buffer_load_dwordx4 v10, s[44:47], s52 offen offset:0 lds
    v_mul_f32 v85, v85, v69
    v_mul_f32 v86, v86, v70
    v_mul_f32 v87, v87, v71
    v_mul_f32 v88, v88, v72
    v_mul_f32 v89, v89, v73
    v_mul_f32 v90, v90, v74
    buffer_load_dwordx4 v10, s[44:47], s53 offen offset:1024 lds
    v_mul_f32 v91, v91, v75
    v_mul_f32 v92, v92, v76
    v_mul_f32 v93, v93, v77
    v_mul_f32 v94, v94, v78
    v_mul_f32 v95, v95, v79
    v_cvt_pk_bf16_f32 v96, v92, v88
    buffer_load_dwordx4 v10, s[44:47], s54 offen offset:2048 lds
    v_cvt_pk_bf16_f32 v97, v84, v80
    v_cvt_pk_bf16_f32 v98, v94, v90
    v_cvt_pk_bf16_f32 v99, v86, v82
    v_cvt_pk_bf16_f32 v100, v93, v89
    v_cvt_pk_bf16_f32 v101, v85, v81
    v_cvt_pk_bf16_f32 v102, v95, v91
    buffer_load_dwordx4 v10, s[44:47], s55 offen offset:3072 lds
    v_cvt_pk_bf16_f32 v103, v87, v83
    ds_read_u16_d16_hi v44, v23 offset:2
    ds_read_u16_d16_hi v45, v23 offset:130
    ds_read_u16_d16_hi v46, v23 offset:258
    ds_read_u16_d16_hi v47, v22 offset:2
    ds_read_u16_d16_hi v48, v22 offset:130
    s_add_u32 m0, s62, 49152
    s_nop 0
    buffer_load_dwordx4 v11, s[48:51], s60 offen offset:0 lds
    ds_read_u16_d16_hi v49, v22 offset:258
    ds_read_u16_d16_hi v50, v22 offset:386
    ds_read_u16_d16_hi v51, v22 offset:514
    ds_read_u16_d16_hi v52, v22 offset:642
    ds_read_u16_d16_hi v53, v22 offset:770
    ds_read_u16_d16_hi v54, v22 offset:898
    buffer_load_dwordx4 v11, s[48:51], s61 offen offset:1024 lds
    ds_read_u16_d16_hi v55, v22 offset:1026
    v_lshlrev_b32 v36, 16, v34
    v_and_b32 v37, s7, v34
    v_lshlrev_b32 v38, 16, v35
    v_and_b32 v39, s7, v35
    s_waitcnt lgkmcnt(4)
    v_mul_f32 v80, v39, v44
    v_add_u32 v10, 128, v10
    v_add_u32 v11, s63, v11
    ds_read_u16_d16_hi v56, v22 offset:1154
    v_mul_f32 v81, v39, v45
    ds_read_u16_d16_hi v57, v22 offset:1282
    v_mul_f32 v82, v39, v46
    ds_read_u16_d16_hi v58, v22 offset:1410
    v_mul_f32 v83, v39, v47
    ds_read_u16_d16_hi v59, v22 offset:1538
    v_mul_f32 v84, v39, v48
    ds_read_u16_d16_hi v60, v22 offset:1666
    v_mul_f32 v85, v39, v49
    ds_read_u16_d16_hi v61, v22 offset:1794
    v_mul_f32 v86, v39, v50
    s_waitcnt vmcnt(10)
    s_barrier
    s_add_u32 m0, s62, 86016
    s_nop 0
    buffer_load_dwordx4 v11, s[48:51], s57 offen offset:1024 lds
    buffer_load_dwordx4 v11, s[48:51], s58 offen offset:2048 lds
    buffer_load_dwordx4 v11, s[48:51], s56 offen offset:0 lds
    buffer_load_dwordx4 v11, s[48:51], s59 offen offset:3072 lds
    v_readfirstlane_b32 s68, v14
    s_mov_b32 s69, 0
F_TK:
    s_cmp_ge_u32 s68, 4
    s_cbranch_scc1 F_TKX
    s_sleep 8
    buffer_load_dword v14, v13, s[64:67], 0 offen sc1
    s_waitcnt vmcnt(0)
    v_readfirstlane_b32 s68, v14
    s_add_u32 s69, s69, 1
    s_cmp_lt_u32 s69, 400000
    s_cbranch_scc1 F_TK
F_TKX:
    ds_read_u16_d16_hi v62, v22 offset:1922
    v_mul_f32 v87, v39, v51
    ds_read_u16_d16_hi v64, v22 offset:16386
    s_waitcnt lgkmcnt(4)
    v_mul_f32 v88, v39, v52
    ds_read_u16_d16_hi v65, v22 offset:16514
    s_add_u32 m0, s62, 81920
    s_nop 0
    buffer_load_dwordx4 v10, s[44:47], s52 offen offset:0 lds
    v_mul_f32 v89, v39, v53
    ds_read_u16_d16_hi v66, v22 offset:16642
    v_mul_f32 v90, v39, v54
    ds_read_u16_d16_hi v67, v22 offset:16770
    v_mul_f32 v91, v39, v55
    ds_read_u16_d16_hi v68, v22 offset:16898
    buffer_load_dwordx4 v10, s[44:47], s53 offen offset:1024 lds
    v_mul_f32 v92, v39, v56
    ds_read_u16_d16_hi v69, v22 offset:17026
    v_mul_f32 v93, v39, v57
    ds_read_u16_d16_hi v70, v22 offset:17154
    v_mul_f32 v94, v39, v58
    ds_read_u16_d16_hi v71, v22 offset:17282
    buffer_load_dwordx4 v10, s[44:47], s54 offen offset:2048 lds
    v_mul_f32 v95, v39, v59
    ds_read_u16_d16_hi v72, v22 offset:17410
    s_waitcnt lgkmcnt(9)
    v_fmac_f32 v80, v38, v45
    ds_read_u16_d16_hi v73, v22 offset:17538
    v_fmac_f32 v81, v38, v46
    ds_read_u16_d16_hi v74, v22 offset:17666
    buffer_load_dwordx4 v10, s[44:47], s55 offen offset:3072 lds
    v_fmac_f32 v82, v38, v47
    ds_read_u16_d16_hi v75, v22 offset:17794
    v_fmac_f32 v83, v38, v48
    ds_read_u16_d16_hi v76, v22 offset:17922
    v_fmac_f32 v84, v38, v49
    ds_read_u16_d16_hi v77, v22 offset:18050
    s_add_u32 m0, s62, 90112
    s_nop 0
    buffer_load_dwordx4 v11, s[48:51], s60 offen offset:0 lds
    v_fmac_f32 v85, v38, v50
    ds_read_u16_d16_hi v78, v22 offset:18178
    v_fmac_f32 v86, v38, v51
    ds_read_u16_d16_hi v79, v22 offset:18306
    v_fmac_f32 v87, v38, v52
    v_fmac_f32 v88, v38, v53
    buffer_load_dwordx4 v11, s[48:51], s61 offen offset:1024 lds
    v_fmac_f32 v89, v38, v54
    v_fmac_f32 v90, v38, v55
    v_fmac_f32 v91, v38, v56
    v_fmac_f32 v92, v38, v57
    v_fmac_f32 v93, v38, v58
    v_fmac_f32 v94, v38, v59
    v_add_u32 v10, 128, v10
    v_add_u32 v11, s63, v11
    v_fmac_f32 v95, v38, v60
    v_fmac_f32 v80, v37, v46
    v_fmac_f32 v81, v37, v47
    v_fmac_f32 v82, v37, v48
    v_fmac_f32 v83, v37, v49
    v_fmac_f32 v84, v37, v50
    v_fmac_f32 v85, v37, v51
    v_fmac_f32 v86, v37, v52
    v_fmac_f32 v87, v37, v53
    v_fmac_f32 v88, v37, v54
    v_fmac_f32 v89, v37, v55
    s_waitcnt vmcnt(10)
    s_barrier
    s_add_u32 m0, s62, 4096
    s_nop 0
    buffer_load_dwordx4 v11, s[48:51], s57 offen offset:1024 lds
    v_fmac_f32 v90, v37, v56
    v_fmac_f32 v91, v37, v57
    v_fmac_f32 v92, v37, v58
    v_fmac_f32 v93, v37, v59
    v_fmac_f32 v94, v37, v60
    buffer_load_dwordx4 v11, s[48:51], s58 offen offset:2048 lds
    v_fmac_f32 v95, v37, v61
    v_fmac_f32 v80, v36, v47
    v_fmac_f32 v81, v36, v48
    v_fmac_f32 v82, v36, v49
    v_fmac_f32 v83, v36, v50
    buffer_load_dwordx4 v11, s[48:51], s56 offen offset:0 lds
    v_fmac_f32 v84, v36, v51
    v_fmac_f32 v85, v36, v52
    v_fmac_f32 v86, v36, v53
    v_fmac_f32 v87, v36, v54
    v_fmac_f32 v88, v36, v55
    buffer_load_dwordx4 v11, s[48:51], s59 offen offset:3072 lds
    v_fmac_f32 v89, v36, v56
    v_fmac_f32 v90, v36, v57
    v_fmac_f32 v91, v36, v58
    v_fmac_f32 v92, v36, v59
    v_fmac_f32 v93, v36, v60
    s_add_u32 m0, s62, 0
    s_nop 0
    buffer_load_dwordx4 v10, s[44:47], s52 offen offset:0 lds
    v_fmac_f32 v94, v36, v61
    v_fmac_f32 v95, v36, v62
    s_waitcnt lgkmcnt(0)
    v_mul_f32 v80, v80, v64
    v_mul_f32 v81, v81, v65
    v_mul_f32 v82, v82, v66
    buffer_load_dwordx4 v10, s[44:47], s53 offen offset:1024 lds
    v_mul_f32 v83, v83, v67
    v_mul_f32 v84, v84, v68
    v_mul_f32 v85, v85, v69
    v_mul_f32 v86, v86, v70
    v_mul_f32 v87, v87, v71
    buffer_load_dwordx4 v10, s[44:47], s54 offen offset:2048 lds
    v_mul_f32 v88, v88, v72
    v_mul_f32 v89, v89, v73
    v_mul_f32 v90, v90, v74
    v_mul_f32 v91, v91, v75
    v_mul_f32 v92, v92, v76
    buffer_load_dwordx4 v10, s[44:47], s55 offen offset:3072 lds
    v_mul_f32 v93, v93, v77
    v_mul_f32 v94, v94, v78
    v_mul_f32 v95, v95, v79
    v_cvt_pk_bf16_f32 v104, v92, v88
    v_cvt_pk_bf16_f32 v105, v84, v80
    s_add_u32 m0, s62, 8192
    s_nop 0
    buffer_load_dwordx4 v11, s[48:51], s60 offen offset:0 lds
    v_cvt_pk_bf16_f32 v106, v94, v90
    v_cvt_pk_bf16_f32 v107, v86, v82
    v_cvt_pk_bf16_f32 v108, v93, v89
    v_cvt_pk_bf16_f32 v109, v85, v81
    v_cvt_pk_bf16_f32 v110, v95, v91
    buffer_load_dwordx4 v11, s[48:51], s61 offen offset:1024 lds
    v_cvt_pk_bf16_f32 v111, v87, v83
    s_mov_b32 s69, 0x700000
    buffer_store_dwordx4 v[96:99], v25, s[36:39], s69 offen offset:0 sc1
    buffer_store_dwordx4 v[100:103], v25, s[36:39], s69 offen offset:2048 sc1
    s_mov_b32 s69, 0x701080
    buffer_store_dwordx4 v[104:107], v25, s[36:39], s69 offen offset:0 sc1
    buffer_store_dwordx4 v[108:111], v25, s[36:39], s69 offen offset:2048 sc1
    v_add_u32 v10, 128, v10
    v_add_u32 v11, s63, v11
    s_waitcnt vmcnt(14)
    s_barrier
    s_add_u32 m0, s62, 45056
    s_nop 0
    buffer_load_dwordx4 v11, s[48:51], s57 offen offset:1024 lds
    s_lshl_b32 s98, s35, 12
    buffer_load_dwordx4 v11, s[48:51], s58 offen offset:2048 lds
    s_mul_i32 s99, s34, 8320
    buffer_load_dwordx4 v11, s[48:51], s56 offen offset:0 lds
    s_add_u32 s99, s99, 122880
    buffer_load_dwordx4 v11, s[48:51], s59 offen offset:3072 lds
    s_add_u32 m0, s62, 40960
    s_nop 0
    buffer_load_dwordx4 v10, s[44:47], s52 offen offset:0 lds
    buffer_load_dwordx4 v10, s[44:47], s53 offen offset:1024 lds
    buffer_load_dwordx4 v10, s[44:47], s54 offen offset:2048 lds
    buffer_load_dwordx4 v10, s[44:47], s55 offen offset:3072 lds
    s_add_u32 m0, s62, 49152
    s_nop 0
    buffer_load_dwordx4 v11, s[48:51], s60 offen offset:0 lds
    buffer_load_dwordx4 v11, s[48:51], s61 offen offset:1024 lds
    v_add_u32 v10, 128, v10
    v_add_u32 v11, s63, v11
    s_waitcnt vmcnt(14)
    s_barrier
    s_add_u32 m0, s62, 86016
    s_nop 0
    buffer_load_dwordx4 v11, s[48:51], s57 offen offset:1024 lds
    buffer_load_dwordx4 v11, s[48:51], s58 offen offset:2048 lds
    buffer_load_dwordx4 v11, s[48:51], s56 offen offset:0 lds
    buffer_load_dwordx4 v11, s[48:51], s59 offen offset:3072 lds
    s_and_b32 s69, s2, 15
    s_lshl_b32 s69, s69, 2
    s_add_u32 s69, s69, s34
    s_lshl_b32 s4, s69, 7
    s_add_u32 s4, s4, 0x120000
    s_add_u32 s4, s4, s26
    s_addc_u32 s5, s27, 0
    s_mov_b32 s6, 1
    s_waitcnt vmcnt(14)
    s_atomic_add s6, s[4:5], 0
    v_mov_b32 v96, 0
    v_mov_b32 v97, 0
    s_add_u32 m0, s62, 81920
    s_nop 0
    buffer_load_dwordx4 v10, s[44:47], s52 offen offset:0 lds
    v_mov_b32 v98, 0
    v_mov_b32 v99, 0
    v_mov_b32 v100, 0
    buffer_load_dwordx4 v10, s[44:47], s53 offen offset:1024 lds
    v_mov_b32 v101, 0
    v_mov_b32 v102, 0
    v_mov_b32 v103, 0
    buffer_load_dwordx4 v10, s[44:47], s54 offen offset:2048 lds
    v_mov_b32 v104, 0
    v_mov_b32 v105, 0
    v_mov_b32 v106, 0
    buffer_load_dwordx4 v10, s[44:47], s55 offen offset:3072 lds
    v_mov_b32 v107, 0
    v_mov_b32 v108, 0
    v_mov_b32 v109, 0
    s_add_u32 m0, s62, 90112
    s_nop 0
    buffer_load_dwordx4 v11, s[48:51], s60 offen offset:0 lds
    v_mov_b32 v110, 0
    v_mov_b32 v111, 0
    v_mov_b32 v112, 0
    buffer_load_dwordx4 v11, s[48:51], s61 offen offset:1024 lds
    v_mov_b32 v113, 0
    v_mov_b32 v114, 0
    v_mov_b32 v115, 0
    v_add_u32 v10, 128, v10
    v_add_u32 v11, s63, v11
    s_waitcnt vmcnt(10)
    s_barrier
    s_add_u32 m0, s62, 4096
    s_nop 0
    buffer_load_dwordx4 v11, s[48:51], s57 offen offset:1024 lds
    v_mov_b32 v116, 0
    v_mov_b32 v117, 0
    v_mov_b32 v118, 0
    v_mov_b32 v119, 0
    v_mov_b32 v120, 0
    buffer_load_dwordx4 v11, s[48:51], s58 offen offset:2048 lds
    v_mov_b32 v121, 0
    v_mov_b32 v122, 0
    v_mov_b32 v123, 0
    v_mov_b32 v124, 0
    v_mov_b32 v125, 0
    buffer_load_dwordx4 v11, s[48:51], s56 offen offset:0 lds
    v_mov_b32 v126, 0
    v_mov_b32 v127, 0
    v_mov_b32 v128, 0
    v_mov_b32 v129, 0
    v_mov_b32 v130, 0
    buffer_load_dwordx4 v11, s[48:51], s59 offen offset:3072 lds
    v_mov_b32 v131, 0
    v_mov_b32 v132, 0
    v_mov_b32 v133, 0
    v_mov_b32 v134, 0
    v_mov_b32 v135, 0
    s_add_u32 m0, s62, 0
    s_nop 0
    buffer_load_dwordx4 v10, s[44:47], s52 offen offset:0 lds
    v_mov_b32 v136, 0
    v_mov_b32 v137, 0
    v_mov_b32 v138, 0
    v_mov_b32 v139, 0
    v_mov_b32 v140, 0
    buffer_load_dwordx4 v10, s[44:47], s53 offen offset:1024 lds
    v_mov_b32 v141, 0
    v_mov_b32 v142, 0
    v_mov_b32 v143, 0
    v_mov_b32 v144, 0
    v_mov_b32 v145, 0
    buffer_load_dwordx4 v10, s[44:47], s54 offen offset:2048 lds
    v_mov_b32 v146, 0
    v_mov_b32 v147, 0
    v_mov_b32 v148, 0
    v_mov_b32 v149, 0
    v_mov_b32 v150, 0
    buffer_load_dwordx4 v10, s[44:47], s55 offen offset:3072 lds
    v_mov_b32 v151, 0
    v_mov_b32 v152, 0
    v_mov_b32 v153, 0
    v_mov_b32 v154, 0
    v_mov_b32 v155, 0
    s_add_u32 m0, s62, 8192
    s_nop 0
    buffer_load_dwordx4 v11, s[48:51], s60 offen offset:0 lds
    v_mov_b32 v156, 0
    v_mov_b32 v157, 0
    v_mov_b32 v158, 0
    v_mov_b32 v159, 0
    buffer_load_dwordx4 v11, s[48:51], s61 offen offset:1024 lds
    v_add_u32 v10, 128, v10
    v_add_u32 v11, s63, v11
    s_waitcnt vmcnt(10)
    s_barrier
    s_add_u32 m0, s62, 45056
    s_nop 0
    buffer_load_dwordx4 v11, s[48:51], s57 offen offset:1024 lds
    buffer_load_dwordx4 v11, s[48:51], s58 offen offset:2048 lds
    buffer_load_dwordx4 v11, s[48:51], s56 offen offset:0 lds
    buffer_load_dwordx4 v11, s[48:51], s59 offen offset:3072 lds
    s_add_u32 s4, s18, s98
    s_addc_u32 s5, s19, 0
    s_load_dword s6, s[4:5], 0
    s_lshl_b32 s7, s35, 1
    s_and_b32 s7, s7, 0xfffffffc
    s_add_u32 s4, s20, s7
    s_addc_u32 s5, s21, 0
    s_load_dword s7, s[4:5], 0
    s_mul_i32 s97, s34, 4608
    s_add_u32 s97, s97, 98304
    v_add_u32 v32, s97, v1
    v_add_u32 v33, 2048, v32
    v_cmp_gt_u32 vcc, 16, v0
    s_add_u32 m0, s62, 40960
    s_nop 0
    buffer_load_dwordx4 v10, s[44:47], s52 offen offset:0 lds
    v_and_b32 v34, 1, v0
    v_lshlrev_b32 v34, 4, v34
    v_cndmask_b32 v32, v33, v32, vcc
    v_bfe_u32 v35, v0, 1, 1
    v_mul_u32_u24 v35, 4160, v35
    v_cmp_gt_u32 vcc, 32, v0
    buffer_load_dwordx4 v10, s[44:47], s53 offen offset:1024 lds
    v_add3_u32 v34, v34, v35, s99
    v_mov_b32 v36, 0
    v_mov_b32 v37, 0
    v_mov_b32 v38, 0
    v_mov_b32 v39, 0
    v_cndmask_b32 v32, v34, v32, vcc
    buffer_load_dwordx4 v10, s[44:47], s54 offen offset:2048 lds
    v_and_b32 v34, 3, v0
    v_lshlrev_b32 v30, 2, v34
    v_add_u32 v30, 156160, v30
    v_bfe_u32 v35, v0, 2, 2
    v_add_u32 v34, v34, v35
    v_lshlrev_b32 v34, 3, v34
    buffer_load_dwordx4 v10, s[44:47], s55 offen offset:3072 lds
    v_lshl_add_u32 v34, v5, 5, v34
    s_add_u32 s69, s99, 8
    v_add_u32 v6, s69, v34
    v_and_b32 v34, 15, v0
    v_sub_u32 v34, v34, v5
    v_lshlrev_b32 v34, 4, v34
    s_add_u32 m0, s62, 49152
    s_nop 0
    buffer_load_dwordx4 v11, s[48:51], s60 offen offset:0 lds
    s_add_u32 s69, s97, 192
    v_add_u32 v7, s69, v34
    v_mov_b32 v5, s99
    v_subrev_u32 v8, 16, v0
    v_add_u32 v9, 47, v0
    v_cmp_gt_u32 vcc, 16, v0
    buffer_load_dwordx4 v11, s[48:51], s61 offen offset:1024 lds
    v_mov_b32 v34, 63
    s_lshl_b32 s69, s34, 2
    v_cndmask_b32 v8, v8, v9, vcc
    v_cmp_eq_u32 vcc, 0, v0
    s_add_u32 s69, s69, 156192
    v_mov_b32 v9, s69
    v_add_u32 v10, 128, v10
    v_add_u32 v11, s63, v11
    v_cndmask_b32 v8, v8, v34, vcc
    v_lshlrev_b32 v8, 2, v8
    s_waitcnt lgkmcnt(0)
    s_lshl_b32 s6, s6, 16
    s_and_b32 s69, s35, 1
    s_lshl_b32 s69, s69, 4
    s_lshr_b32 s7, s7, s69
    s_lshl_b32 s7, s7, 16
    v_mov_b32 v33, s6
    v_add_f32 v33, s7, v33
    v_cvt_pk_bf16_f32 v33, v33, v33
    s_waitcnt vmcnt(10)
    s_barrier
    s_lshl_b32 s97, s34, 2
    s_add_u32 s97, s97, 156288
    v_mov_b32 v28, s97
    v_mov_b32 v29, 1
    s_waitcnt vmcnt(0)
    ds_write_b32 v28, v29
    s_mov_b32 s40, s18
    s_mov_b32 s41, s19
    s_mov_b32 s42, 0x400000
    s_mov_b32 s43, 0x00020000
    s_add_u32 m0, s99, 32
    s_nop 0
    buffer_load_dwordx4 v1, s[40:43], s98 offen offset:0 lds
    s_add_u32 m0, s99, 4196
    s_nop 0
    buffer_load_dwordx4 v1, s[40:43], s98 offen offset:0 lds
    s_add_u32 m0, s99, 32
    s_nop 0
    buffer_load_dwordx4 v1, s[40:43], s98 offen offset:1024 lds
    s_add_u32 m0, s99, 4196
    s_nop 0
    buffer_load_dwordx4 v1, s[40:43], s98 offen offset:1024 lds
    s_add_u32 m0, s99, 32
    s_nop 0
    buffer_load_dwordx4 v1, s[40:43], s98 offen offset:2048 lds
    s_add_u32 m0, s99, 4196
    s_nop 0
    buffer_load_dwordx4 v1, s[40:43], s98 offen offset:2048 lds
    s_add_u32 m0, s99, 32
    s_nop 0
    buffer_load_dwordx4 v1, s[40:43], s98 offen offset:3072 lds
    s_add_u32 m0, s99, 4196
    s_nop 0
    buffer_load_dwordx4 v1, s[40:43], s98 offen offset:3072 lds
    s_cmp_ge_u32 s34, 2
    s_cbranch_scc1 F_QL2
    s_mov_b32 s40, s10
    s_mov_b32 s41, s11
    s_mov_b32 s42, 0x400000
    s_mov_b32 s43, 0x00020000
    s_and_b32 s69, s2, 15
    s_lshl_b32 s69, s69, 7
    s_add_u32 s97, s69, 0
    buffer_load_dwordx4 v[200:203], v234, s[40:43], s97 offen offset:0 nt
    s_add_u32 s97, s69, 0
    buffer_load_dwordx4 v[204:207], v234, s[40:43], s97 offen offset:2048 nt
    s_add_u32 s97, s69, 4096
    buffer_load_dwordx4 v[208:211], v234, s[40:43], s97 offen offset:0 nt
    s_add_u32 s97, s69, 4096
    buffer_load_dwordx4 v[212:215], v234, s[40:43], s97 offen offset:2048 nt
    s_add_u32 s97, s69, 524288
    buffer_load_dwordx4 v[216:219], v234, s[40:43], s97 offen offset:0 nt
    s_add_u32 s97, s69, 524288
    buffer_load_dwordx4 v[220:223], v234, s[40:43], s97 offen offset:2048 nt
    s_add_u32 s97, s69, 528384
    buffer_load_dwordx4 v[224:227], v234, s[40:43], s97 offen offset:0 nt
    s_add_u32 s97, s69, 528384
    buffer_load_dwordx4 v[228:231], v234, s[40:43], s97 offen offset:2048 nt
F_QL2:
    s_mul_i32 s52, s34, 4608
    s_add_u32 s52, s52, 98304
    s_mul_i32 s63, s35, 4224
    s_add_u32 s53, s63, 0x700000
    s_mov_b32 s40, s8
    s_mov_b32 s41, s9
    s_mov_b32 s42, 0x200000
    s_mov_b32 s43, 0x00020000
    s_lshl_b32 s62, s34, 10
    s_lshl_b32 s100, s34, 14
    s_lshl_b32 s101, s33, 7
    s_add_u32 s100, s100, s101
    s_lshr_b32 s69, s35, 4
    s_lshl_b32 s54, s69, 7
    s_add_u32 s54, s54, 0x120000
    s_add_u32 s54, s54, s26
    s_addc_u32 s55, s27, 0
    s_mov_b32 s101, 0
F_P1:
    s_mov_b32 s69, 0
    s_atomic_add s69, s[54:55], 0 glc
    s_waitcnt lgkmcnt(0)
    s_cmp_ge_u32 s69, 16
    s_cbranch_scc1 F_P1_X
    s_sleep 4
    s_add_u32 s101, s101, 1
    s_cmp_lt_u32 s101, 400000
    s_cbranch_scc1 F_P1
F_P1_X:
    s_add_u32 m0, s52, 256
    s_nop 0
    buffer_load_dwordx4 v1, s[36:39], s53 offen offset:0 sc1 lds
    buffer_load_dwordx4 v1, s[36:39], s53 offen offset:1024 sc1 lds
    s_add_u32 m0, s52, 512
    s_nop 0
    buffer_load_dwordx4 v1, s[36:39], s53 offen offset:2048 sc1 lds
    buffer_load_dwordx4 v1, s[36:39], s53 offen offset:3072 sc1 lds
    ds_write_b128 v32, v[36:39]
    ds_write_b32 v5, v36 offset:4192
    s_add_u32 m0, s62, 81920
    s_add_u32 s101, s100, 0
    buffer_load_dwordx4 v12, s[40:43], s101 offen lds
    s_add_u32 m0, s62, 86016
    s_add_u32 s101, s100, 65536
    buffer_load_dwordx4 v12, s[40:43], s101 offen lds
    s_add_u32 m0, s62, 90112
    s_add_u32 s101, s100, 131072
    buffer_load_dwordx4 v12, s[40:43], s101 offen lds
    s_add_u32 m0, s62, 94208
    s_add_u32 s101, s100, 196608
    buffer_load_dwordx4 v12, s[40:43], s101 offen lds
F_WG14:
    ds_read_b32 v11, v30 offset:112
    s_waitcnt lgkmcnt(0)
    v_cmp_ne_u32 vcc, 1, v11
    s_cbranch_vccz F_WG14_X
    s_sleep 1
    s_branch F_WG14
F_WG14_X:
    s_add_u32 m0, s62, 0
    s_add_u32 s101, s100, 262144
    buffer_load_dwordx4 v12, s[40:43], s101 offen lds
    s_add_u32 m0, s62, 4096
    s_add_u32 s101, s100, 327680
    buffer_load_dwordx4 v12, s[40:43], s101 offen lds
    s_add_u32 m0, s62, 8192
    s_add_u32 s101, s100, 393216
    buffer_load_dwordx4 v12, s[40:43], s101 offen lds
    s_add_u32 m0, s62, 12288
    s_add_u32 s101, s100, 458752
    buffer_load_dwordx4 v12, s[40:43], s101 offen lds
    s_add_u32 m0, s62, 16384
    s_add_u32 s101, s100, 524288
    buffer_load_dwordx4 v12, s[40:43], s101 offen lds
    s_add_u32 m0, s62, 20480
    s_add_u32 s101, s100, 589824
    buffer_load_dwordx4 v12, s[40:43], s101 offen lds
    s_add_u32 m0, s62, 24576
    s_add_u32 s101, s100, 655360
    buffer_load_dwordx4 v12, s[40:43], s101 offen lds
    s_add_u32 m0, s62, 28672
    s_add_u32 s101, s100, 720896
    buffer_load_dwordx4 v12, s[40:43], s101 offen lds
    s_add_u32 m0, s62, 32768
    s_add_u32 s101, s100, 786432
    buffer_load_dwordx4 v12, s[40:43], s101 offen lds
    s_add_u32 m0, s62, 36864
    s_add_u32 s101, s100, 851968
    buffer_load_dwordx4 v12, s[40:43], s101 offen lds
F_WGDx:
    ds_read_b32 v11, v30 offset:80
    s_waitcnt lgkmcnt(0)
    v_cmp_ne_u32 vcc, 1, v11
    s_cbranch_vccz F_WGDx_X
    s_sleep 1
    s_branch F_WGDx
F_WGDx_X:
    s_add_u32 m0, s62, 40960
    s_add_u32 s101, s100, 917504
    buffer_load_dwordx4 v12, s[40:43], s101 offen lds
    s_add_u32 m0, s62, 45056
    s_add_u32 s101, s100, 983040
    buffer_load_dwordx4 v12, s[40:43], s101 offen lds
    s_add_u32 m0, s62, 49152
    s_add_u32 s101, s100, 1048576
    buffer_load_dwordx4 v12, s[40:43], s101 offen lds
    s_add_u32 m0, s62, 53248
    s_add_u32 s101, s100, 1114112
    buffer_load_dwordx4 v12, s[40:43], s101 offen lds
    s_add_u32 m0, s62, 57344
    s_add_u32 s101, s100, 1179648
    buffer_load_dwordx4 v12, s[40:43], s101 offen lds
    s_add_u32 m0, s62, 61440
    s_add_u32 s101, s100, 1245184
    buffer_load_dwordx4 v12, s[40:43], s101 offen lds
    s_add_u32 m0, s62, 65536
    s_add_u32 s101, s100, 1310720
    buffer_load_dwordx4 v12, s[40:43], s101 offen lds
    s_add_u32 m0, s62, 69632
    s_add_u32 s101, s100, 1376256
    buffer_load_dwordx4 v12, s[40:43], s101 offen lds
    s_add_u32 m0, s62, 73728
    s_add_u32 s101, s100, 1441792
    buffer_load_dwordx4 v12, s[40:43], s101 offen lds
    s_add_u32 m0, s62, 77824
    s_add_u32 s101, s100, 1507328
    buffer_load_dwordx4 v12, s[40:43], s101 offen lds
    s_waitcnt vmcnt(24)
    ds_write_b16 v5, v33 offset:32
    ds_write_b16 v5, v33 offset:4196
    ds_read_b128 v[76:79], v7 offset:1856
    ds_read_b64_tr_b16 v[16:17], v6 offset:0
    ds_read_b64_tr_b16 v[18:19], v6 offset:4160
    ds_read_b128 v[72:75], v7 offset:1600
    ds_read_b64_tr_b16 v[20:21], v6 offset:512
    ds_read_b64_tr_b16 v[22:23], v6 offset:4672
    ds_read_b128 v[68:71], v7 offset:1344
    ds_read_b64_tr_b16 v[24:25], v6 offset:1024
    ds_read_b64_tr_b16 v[26:27], v6 offset:5184
    ds_read_b128 v[64:67], v7 offset:1088
    ds_read_b64_tr_b16 v[28:29], v6 offset:1536
    ds_read_b64_tr_b16 v[30:31], v6 offset:5696
    ds_read_b128 v[60:63], v7 offset:832
    ds_read_b64_tr_b16 v[32:33], v6 offset:2048
    ds_read_b64_tr_b16 v[34:35], v6 offset:6208
    ds_read_b128 v[56:59], v7 offset:576
    ds_read_b64_tr_b16 v[36:37], v6 offset:2560
    ds_read_b64_tr_b16 v[38:39], v6 offset:6720
    ds_read_b128 v[52:55], v7 offset:320
    ds_read_b64_tr_b16 v[40:41], v6 offset:3072
    ds_read_b64_tr_b16 v[42:43], v6 offset:7232
    ds_read_b128 v[48:51], v7 offset:64
    ds_read_b64_tr_b16 v[44:45], v6 offset:3584
    ds_read_b64_tr_b16 v[46:47], v6 offset:7744
    v_mov_b32 v10, 1
    s_mov_b64 s[60:61], 1
    s_mov_b32 s58, 0
.p2align 6
F_VLOOP:
    s_waitcnt lgkmcnt(15)
    v_mfma_f32_16x16x32_bf16 v[124:127], v[16:19], v[76:79], v[124:127]
    ds_read_b128 v[80:83], v7 offset:2368
    ds_read_b128 v[76:79], v7 offset:4160
    v_mfma_f32_16x16x32_bf16 v[120:123], v[16:19], v[72:75], v[120:123]
    v_mfma_f32_16x16x32_bf16 v[124:127], v[20:23], v[72:75], v[124:127]
    ds_read_b128 v[72:75], v7 offset:3904
    v_mfma_f32_16x16x32_bf16 v[116:119], v[16:19], v[68:71], v[116:119]
    v_mfma_f32_16x16x32_bf16 v[120:123], v[20:23], v[68:71], v[120:123]
    s_waitcnt lgkmcnt(15)
    v_mfma_f32_16x16x32_bf16 v[124:127], v[24:27], v[68:71], v[124:127]
    ds_read_b128 v[68:71], v7 offset:3648
    s_waitcnt lgkmcnt(15)
    v_mfma_f32_16x16x32_bf16 v[112:115], v[16:19], v[64:67], v[112:115]
    v_mfma_f32_16x16x32_bf16 v[116:119], v[20:23], v[64:67], v[116:119]
    v_mfma_f32_16x16x32_bf16 v[120:123], v[24:27], v[64:67], v[120:123]
    v_mfma_f32_16x16x32_bf16 v[124:127], v[28:31], v[64:67], v[124:127]
    ds_read_b128 v[64:67], v7 offset:3392
    s_waitcnt lgkmcnt(15)
    v_mfma_f32_16x16x32_bf16 v[108:111], v[16:19], v[60:63], v[108:111]
    v_mfma_f32_16x16x32_bf16 v[112:115], v[20:23], v[60:63], v[112:115]
    v_mfma_f32_16x16x32_bf16 v[116:119], v[24:27], v[60:63], v[116:119]
    v_mfma_f32_16x16x32_bf16 v[120:123], v[28:31], v[60:63], v[120:123]
    s_waitcnt lgkmcnt(13)
    v_mfma_f32_16x16x32_bf16 v[124:127], v[32:35], v[60:63], v[124:127]
    ds_read_b128 v[60:63], v7 offset:3136
    s_waitcnt lgkmcnt(13)
    v_mfma_f32_16x16x32_bf16 v[104:107], v[16:19], v[56:59], v[104:107]
    v_mfma_f32_16x16x32_bf16 v[108:111], v[20:23], v[56:59], v[108:111]
    v_mfma_f32_16x16x32_bf16 v[112:115], v[24:27], v[56:59], v[112:115]
    v_mfma_f32_16x16x32_bf16 v[116:119], v[28:31], v[56:59], v[116:119]
    v_mfma_f32_16x16x32_bf16 v[120:123], v[32:35], v[56:59], v[120:123]
    s_waitcnt lgkmcnt(11)
    v_mfma_f32_16x16x32_bf16 v[124:127], v[36:39], v[56:59], v[124:127]
    ds_read_b128 v[56:59], v7 offset:2880
    s_waitcnt lgkmcnt(11)
    v_mfma_f32_16x16x32_bf16 v[100:103], v[16:19], v[52:55], v[100:103]
    v_mfma_f32_16x16x32_bf16 v[104:107], v[20:23], v[52:55], v[104:107]
    v_mfma_f32_16x16x32_bf16 v[108:111], v[24:27], v[52:55], v[108:111]
    v_mfma_f32_16x16x32_bf16 v[112:115], v[28:31], v[52:55], v[112:115]
    v_mfma_f32_16x16x32_bf16 v[116:119], v[32:35], v[52:55], v[116:119]
    v_mfma_f32_16x16x32_bf16 v[120:123], v[36:39], v[52:55], v[120:123]
    s_waitcnt lgkmcnt(9)
    v_mfma_f32_16x16x32_bf16 v[124:127], v[40:43], v[52:55], v[124:127]
    ds_read_b128 v[52:55], v7 offset:2624
    s_waitcnt lgkmcnt(10)
    v_mfma_f32_16x16x32_bf16 v[96:99], v[16:19], v[48:51], v[96:99]
    v_mfma_f32_16x16x32_bf16 v[100:103], v[20:23], v[48:51], v[100:103]
    v_mfma_f32_16x16x32_bf16 v[104:107], v[24:27], v[48:51], v[104:107]
    v_mfma_f32_16x16x32_bf16 v[108:111], v[28:31], v[48:51], v[108:111]
    v_mfma_f32_16x16x32_bf16 v[112:115], v[32:35], v[48:51], v[112:115]
    v_mfma_f32_16x16x32_bf16 v[116:119], v[36:39], v[48:51], v[116:119]
    v_mfma_f32_16x16x32_bf16 v[120:123], v[40:43], v[48:51], v[120:123]
    s_waitcnt lgkmcnt(8)
    v_mfma_f32_16x16x32_bf16 v[124:127], v[44:47], v[48:51], v[124:127]
    s_waitcnt lgkmcnt(6)
    v_mfma_f32_16x16x32_bf16 v[156:159], v[16:19], v[76:79], v[156:159]
    ds_read_b128 v[48:51], v7 offset:0
    ds_read_b128 v[76:79], v7 offset:1792
    s_waitcnt lgkmcnt(7)
    v_mfma_f32_16x16x32_bf16 v[152:155], v[16:19], v[72:75], v[152:155]
    s_waitcnt lgkmcnt(6)
    v_mfma_f32_16x16x32_bf16 v[148:151], v[16:19], v[68:71], v[148:151]
    s_waitcnt lgkmcnt(5)
    v_mfma_f32_16x16x32_bf16 v[144:147], v[16:19], v[64:67], v[144:147]
    s_waitcnt lgkmcnt(4)
    v_mfma_f32_16x16x32_bf16 v[140:143], v[16:19], v[60:63], v[140:143]
    s_waitcnt lgkmcnt(3)
    v_mfma_f32_16x16x32_bf16 v[136:139], v[16:19], v[56:59], v[136:139]
    s_waitcnt lgkmcnt(2)
    v_mfma_f32_16x16x32_bf16 v[132:135], v[16:19], v[52:55], v[132:135]
    v_mfma_f32_16x16x32_bf16 v[128:131], v[16:19], v[80:83], v[128:131]
    ds_read_b64_tr_b16 v[16:17], v6 offset:128
    ds_read_b64_tr_b16 v[18:19], v6 offset:4288
    v_mfma_f32_16x16x32_bf16 v[156:159], v[20:23], v[72:75], v[156:159]
    ds_read_b128 v[72:75], v7 offset:1536
    v_mfma_f32_16x16x32_bf16 v[152:155], v[20:23], v[68:71], v[152:155]
    v_mfma_f32_16x16x32_bf16 v[148:151], v[20:23], v[64:67], v[148:151]
    v_mfma_f32_16x16x32_bf16 v[144:147], v[20:23], v[60:63], v[144:147]
    v_mfma_f32_16x16x32_bf16 v[140:143], v[20:23], v[56:59], v[140:143]
    v_mfma_f32_16x16x32_bf16 v[136:139], v[20:23], v[52:55], v[136:139]
    v_mfma_f32_16x16x32_bf16 v[132:135], v[20:23], v[80:83], v[132:135]
    ds_read_b64_tr_b16 v[20:21], v6 offset:640
    ds_read_b64_tr_b16 v[22:23], v6 offset:4800
    v_mfma_f32_16x16x32_bf16 v[156:159], v[24:27], v[68:71], v[156:159]
    ds_read_b128 v[68:71], v7 offset:1280
    v_mfma_f32_16x16x32_bf16 v[152:155], v[24:27], v[64:67], v[152:155]
    v_mfma_f32_16x16x32_bf16 v[148:151], v[24:27], v[60:63], v[148:151]
    v_mfma_f32_16x16x32_bf16 v[144:147], v[24:27], v[56:59], v[144:147]
    v_mfma_f32_16x16x32_bf16 v[140:143], v[24:27], v[52:55], v[140:143]
    v_mfma_f32_16x16x32_bf16 v[136:139], v[24:27], v[80:83], v[136:139]
    ds_read_b64_tr_b16 v[24:25], v6 offset:1152
    ds_read_b64_tr_b16 v[26:27], v6 offset:5312
    v_mfma_f32_16x16x32_bf16 v[156:159], v[28:31], v[64:67], v[156:159]
    ds_read_b128 v[64:67], v7 offset:1024
    v_mfma_f32_16x16x32_bf16 v[152:155], v[28:31], v[60:63], v[152:155]
    v_mfma_f32_16x16x32_bf16 v[148:151], v[28:31], v[56:59], v[148:151]
    v_mfma_f32_16x16x32_bf16 v[144:147], v[28:31], v[52:55], v[144:147]
    v_mfma_f32_16x16x32_bf16 v[140:143], v[28:31], v[80:83], v[140:143]
    ds_read_b64_tr_b16 v[28:29], v6 offset:1664
    ds_read_b64_tr_b16 v[30:31], v6 offset:5824
    v_mfma_f32_16x16x32_bf16 v[156:159], v[32:35], v[60:63], v[156:159]
    ds_read_b128 v[60:63], v7 offset:768
    v_mfma_f32_16x16x32_bf16 v[152:155], v[32:35], v[56:59], v[152:155]
    v_mfma_f32_16x16x32_bf16 v[148:151], v[32:35], v[52:55], v[148:151]
    v_mfma_f32_16x16x32_bf16 v[144:147], v[32:35], v[80:83], v[144:147]
    ds_read_b64_tr_b16 v[32:33], v6 offset:2176
    ds_read_b64_tr_b16 v[34:35], v6 offset:6336
    v_mfma_f32_16x16x32_bf16 v[156:159], v[36:39], v[56:59], v[156:159]
    ds_read_b128 v[56:59], v7 offset:512
    v_mfma_f32_16x16x32_bf16 v[152:155], v[36:39], v[52:55], v[152:155]
    v_mfma_f32_16x16x32_bf16 v[148:151], v[36:39], v[80:83], v[148:151]
    ds_read_b64_tr_b16 v[36:37], v6 offset:2688
    ds_read_b64_tr_b16 v[38:39], v6 offset:6848
    v_mfma_f32_16x16x32_bf16 v[156:159], v[40:43], v[52:55], v[156:159]
    ds_read_b128 v[52:55], v7 offset:256
    v_mfma_f32_16x16x32_bf16 v[152:155], v[40:43], v[80:83], v[152:155]
    ds_read_b64_tr_b16 v[40:41], v6 offset:3200
    ds_read_b64_tr_b16 v[42:43], v6 offset:7360
    v_mfma_f32_16x16x32_bf16 v[156:159], v[44:47], v[80:83], v[156:159]
    ds_read_b64_tr_b16 v[44:45], v6 offset:3712
    ds_read_b64_tr_b16 v[46:47], v6 offset:7872
    s_waitcnt vmcnt(0)
    ds_write_b32 v9, v10 offset:112
F_VWX:
    v_add_u32 v6, 128, v6
    v_subrev_u32 v7, 64, v7
    s_add_u32 s58, s58, 1
    s_cmp_lt_u32 s58, 4
    s_cbranch_scc1 F_VLOOP
    s_waitcnt lgkmcnt(0)
    ds_write_b32 v9, v10
    ds_bpermute_b32 v17, v8, v131
    ds_bpermute_b32 v18, v8, v135
    ds_bpermute_b32 v19, v8, v139
    ds_bpermute_b32 v20, v8, v143
    ds_bpermute_b32 v21, v8, v147
    ds_bpermute_b32 v22, v8, v151
    ds_bpermute_b32 v23, v8, v155
    ds_bpermute_b32 v24, v8, v159
    v_mov_b32 v16, 0
    v_add_f32 v97, v97, v128
    v_add_f32 v98, v98, v129
    v_add_f32 v99, v99, v130
    v_add_f32 v101, v101, v132
    v_add_f32 v102, v102, v133
    v_add_f32 v103, v103, v134
    v_add_f32 v105, v105, v136
    v_add_f32 v106, v106, v137
    v_add_f32 v107, v107, v138
    v_add_f32 v109, v109, v140
    v_add_f32 v110, v110, v141
    v_add_f32 v111, v111, v142
    v_add_f32 v113, v113, v144
    v_add_f32 v114, v114, v145
    v_add_f32 v115, v115, v146
    v_add_f32 v117, v117, v148
    v_add_f32 v118, v118, v149
    v_add_f32 v119, v119, v150
    v_add_f32 v121, v121, v152
    v_add_f32 v122, v122, v153
    v_add_f32 v123, v123, v154
    v_add_f32 v125, v125, v156
    v_add_f32 v126, v126, v157
    v_add_f32 v127, v127, v158
    s_waitcnt lgkmcnt(0)
    v_cndmask_b32 v28, v17, v16, s[60:61]
    v_cndmask_b32 v29, v18, v17, s[60:61]
    v_cndmask_b32 v30, v19, v18, s[60:61]
    v_cndmask_b32 v31, v20, v19, s[60:61]
    v_cndmask_b32 v32, v21, v20, s[60:61]
    v_cndmask_b32 v33, v22, v21, s[60:61]
    v_cndmask_b32 v34, v23, v22, s[60:61]
    v_cndmask_b32 v35, v24, v23, s[60:61]
    v_add_f32 v96, v96, v28
    v_add_f32 v100, v100, v29
    v_add_f32 v104, v104, v30
    v_add_f32 v108, v108, v31
    v_add_f32 v112, v112, v32
    v_add_f32 v116, v116, v33
    v_add_f32 v120, v120, v34
    v_add_f32 v124, v124, v35
    v_cvt_pk_bf16_f32 v48, v96, v97
    v_cvt_pk_bf16_f32 v49, v98, v99
    v_cvt_pk_bf16_f32 v50, v100, v101
    v_cvt_pk_bf16_f32 v51, v102, v103
    v_cvt_pk_bf16_f32 v52, v104, v105
    v_cvt_pk_bf16_f32 v53, v106, v107
    v_cvt_pk_bf16_f32 v54, v108, v109
    v_cvt_pk_bf16_f32 v55, v110, v111
    v_cvt_pk_bf16_f32 v56, v112, v113
    v_cvt_pk_bf16_f32 v57, v114, v115
    v_cvt_pk_bf16_f32 v58, v116, v117
    v_cvt_pk_bf16_f32 v59, v118, v119
    v_cvt_pk_bf16_f32 v60, v120, v121
    v_cvt_pk_bf16_f32 v61, v122, v123
    v_cvt_pk_bf16_f32 v62, v124, v125
    v_cvt_pk_bf16_f32 v63, v126, v127
    s_add_u32 s53, s63, 0xc00000
    buffer_store_dwordx4 v[48:51], v1, s[36:39], s53 offen offset:0 sc1
    buffer_store_dwordx4 v[52:55], v1, s[36:39], s53 offen offset:1024 sc1
    buffer_store_dwordx4 v[56:59], v1, s[36:39], s53 offen offset:2048 sc1
    buffer_store_dwordx4 v[60:63], v1, s[36:39], s53 offen offset:3072 sc1
    s_lshr_b32 s69, s35, 6
    s_lshl_b32 s4, s69, 7
    s_add_u32 s4, s4, 0x125000
    s_add_u32 s4, s4, s26
    s_addc_u32 s5, s27, 0
    s_mov_b32 s69, 1
    s_cmp_ge_u32 s34, 2
    s_cbranch_scc0 F_POST
    v_and_b32 v9, 3, v0
    v_lshlrev_b32 v9, 2, v9
    v_and_b32 v11, 4, v0
    v_lshl_add_u32 v9, v11, 3, v9
    v_add_u32 v9, 156192, v9
F_WL:
    ds_read_b32 v11, v9 offset:0
    s_waitcnt lgkmcnt(0)
    v_cmp_ne_u32 vcc, 1, v11
    s_cbranch_vccz F_WL_X
    s_sleep 1
    s_branch F_WL
F_WL_X:
    s_add_u32 s62, s62, 96256
    s_add_u32 s100, s100, 1540096
    s_add_u32 m0, s62, 0
    s_add_u32 s101, s100, 0
    buffer_load_dwordx4 v12, s[40:43], s101 offen lds
    s_add_u32 m0, s62, 2048
    s_add_u32 s101, s100, 32768
    buffer_load_dwordx4 v12, s[40:43], s101 offen lds
    s_add_u32 m0, s62, 4096
    s_add_u32 s101, s100, 65536
    buffer_load_dwordx4 v12, s[40:43], s101 offen lds
    s_add_u32 m0, s62, 6144
    s_add_u32 s101, s100, 98304
    buffer_load_dwordx4 v12, s[40:43], s101 offen lds
    s_add_u32 m0, s62, 8192
    s_add_u32 s101, s100, 131072
    buffer_load_dwordx4 v12, s[40:43], s101 offen lds
    s_add_u32 m0, s62, 10240
    s_add_u32 s101, s100, 163840
    buffer_load_dwordx4 v12, s[40:43], s101 offen lds
    s_add_u32 m0, s62, 12288
    s_add_u32 s101, s100, 196608
    buffer_load_dwordx4 v12, s[40:43], s101 offen lds
    s_add_u32 m0, s62, 14336
    s_add_u32 s101, s100, 229376
    buffer_load_dwordx4 v12, s[40:43], s101 offen lds
    s_add_u32 m0, s62, 16384
    s_add_u32 s101, s100, 262144
    buffer_load_dwordx4 v12, s[40:43], s101 offen lds
    s_add_u32 m0, s62, 18432
    s_add_u32 s101, s100, 294912
    buffer_load_dwordx4 v12, s[40:43], s101 offen lds
    s_add_u32 m0, s62, 20480
    s_add_u32 s101, s100, 327680
    buffer_load_dwordx4 v12, s[40:43], s101 offen lds
    s_add_u32 m0, s62, 22528
    s_add_u32 s101, s100, 360448
    buffer_load_dwordx4 v12, s[40:43], s101 offen lds
    s_add_u32 m0, s62, 24576
    s_add_u32 s101, s100, 393216
    buffer_load_dwordx4 v12, s[40:43], s101 offen lds
    s_add_u32 m0, s62, 26624
    s_add_u32 s101, s100, 425984
    buffer_load_dwordx4 v12, s[40:43], s101 offen lds
    s_add_u32 m0, s62, 28672
    s_add_u32 s101, s100, 458752
    buffer_load_dwordx4 v12, s[40:43], s101 offen lds
    s_add_u32 m0, s62, 30720
    s_add_u32 s101, s100, 491520
    buffer_load_dwordx4 v12, s[40:43], s101 offen lds
    s_waitcnt vmcnt(16)
    s_atomic_add s69, s[4:5], 0
    s_lshl_b32 s58, s34, 2
    s_add_u32 s58, s58, 156200
    v_mov_b32 v9, s58
    s_waitcnt vmcnt(0)
    ds_write_b32 v9, v10
    s_waitcnt lgkmcnt(0)
    s_endpgm
F_POST:
    s_and_b32 s52, s2, 15
    s_lshl_b32 s56, s52, 7
    s_mul_i32 s53, s52, 270336
    s_add_u32 s53, s53, 0xc00000
    s_mov_b32 s44, s22
    s_mov_b32 s45, s23
    s_mov_b32 s46, 0x800000
    s_mov_b32 s47, 0x00020000
    s_mov_b32 s55, 0xffff0000
    s_add_u32 s56, s56, 2048
    s_waitcnt vmcnt(0)
    s_atomic_add s69, s[4:5], 0
    v_lshlrev_b32 v132, 16, v200
    v_and_b32 v133, s55, v200
    v_lshlrev_b32 v134, 16, v201
    v_and_b32 v135, s55, v201
    v_lshlrev_b32 v136, 16, v202
    v_and_b32 v137, s55, v202
    v_lshlrev_b32 v138, 16, v203
    v_and_b32 v139, s55, v203
    v_lshlrev_b32 v140, 16, v204
    v_and_b32 v141, s55, v204
    v_lshlrev_b32 v142, 16, v205
    v_and_b32 v143, s55, v205
    v_lshlrev_b32 v144, 16, v206
    v_and_b32 v145, s55, v206
    v_lshlrev_b32 v146, 16, v207
    v_and_b32 v147, s55, v207
    v_lshlrev_b32 v148, 16, v208
    v_and_b32 v149, s55, v208
    v_lshlrev_b32 v150, 16, v209
    v_and_b32 v151, s55, v209
    v_lshlrev_b32 v152, 16, v210
    v_and_b32 v153, s55, v210
    v_lshlrev_b32 v154, 16, v211
    v_and_b32 v155, s55, v211
    v_lshlrev_b32 v156, 16, v212
    v_and_b32 v157, s55, v212
    v_lshlrev_b32 v158, 16, v213
    v_and_b32 v159, s55, v213
    v_lshlrev_b32 v160, 16, v214
    v_and_b32 v161, s55, v214
    v_lshlrev_b32 v162, 16, v215
    v_and_b32 v163, s55, v215
    v_lshlrev_b32 v164, 16, v216
    v_and_b32 v165, s55, v216
    v_lshlrev_b32 v166, 16, v217
    v_and_b32 v167, s55, v217
    v_lshlrev_b32 v168, 16, v218
    v_and_b32 v169, s55, v218
    v_lshlrev_b32 v170, 16, v219
    v_and_b32 v171, s55, v219
    v_lshlrev_b32 v172, 16, v220
    v_and_b32 v173, s55, v220
    v_lshlrev_b32 v174, 16, v221
    v_and_b32 v175, s55, v221
    v_lshlrev_b32 v176, 16, v222
    v_and_b32 v177, s55, v222
    v_lshlrev_b32 v178, 16, v223
    v_and_b32 v179, s55, v223
    v_lshlrev_b32 v180, 16, v224
    v_and_b32 v181, s55, v224
    v_lshlrev_b32 v182, 16, v225
    v_and_b32 v183, s55, v225
    v_lshlrev_b32 v184, 16, v226
    v_and_b32 v185, s55, v226
    v_lshlrev_b32 v186, 16, v227
    v_and_b32 v187, s55, v227
    v_lshlrev_b32 v188, 16, v228
    v_and_b32 v189, s55, v228
    v_lshlrev_b32 v190, 16, v229
    v_and_b32 v191, s55, v229
    v_lshlrev_b32 v192, 16, v230
    v_and_b32 v193, s55, v230
    v_lshlrev_b32 v194, 16, v231
    v_and_b32 v195, s55, v231
    s_lshl_b32 s6, s52, 7
    s_add_u32 s6, s6, 0x125000
    s_add_u32 s6, s6, s26
    s_addc_u32 s7, s27, 0
    s_mov_b32 s101, 0
F_P4:
    s_mov_b32 s54, 0
    s_atomic_add s54, s[6:7], 0 glc
    s_waitcnt lgkmcnt(0)
    s_cmp_ge_u32 s54, 64
    s_cbranch_scc1 F_P4_X
    s_sleep 16
    s_add_u32 s101, s101, 1
    s_cmp_lt_u32 s101, 400000
    s_cbranch_scc1 F_P4
F_P4_X:
    buffer_load_dwordx4 v[48:51], v232, s[36:39], s53 offen sc1
    s_add_u32 s53, s53, 4224
    buffer_load_dwordx4 v[52:55], v232, s[36:39], s53 offen sc1
    s_add_u32 s53, s53, 4224
    buffer_load_dwordx4 v[56:59], v232, s[36:39], s53 offen sc1
    s_add_u32 s53, s53, 4224
    buffer_load_dwordx4 v[60:63], v232, s[36:39], s53 offen sc1
    s_add_u32 s53, s53, 4224
    buffer_load_dwordx4 v[64:67], v232, s[36:39], s53 offen sc1
    s_add_u32 s53, s53, 4224
    buffer_load_dwordx4 v[68:71], v232, s[36:39], s53 offen sc1
    s_add_u32 s53, s53, 4224
    buffer_load_dwordx4 v[72:75], v232, s[36:39], s53 offen sc1
    s_add_u32 s53, s53, 4224
    buffer_load_dwordx4 v[76:79], v232, s[36:39], s53 offen sc1
    s_waitcnt vmcnt(0)
    v_lshlrev_b32 v88, 16, v48
    v_lshlrev_b32 v89, 16, v52
    v_lshlrev_b32 v90, 16, v56
    v_lshlrev_b32 v91, 16, v60
    v_lshlrev_b32 v92, 16, v64
    v_lshlrev_b32 v93, 16, v68
    v_lshlrev_b32 v94, 16, v72
    v_lshlrev_b32 v95, 16, v76
    v_mul_f32 v80, v132, v88
    v_mul_f32 v81, v133, v89
    v_mul_f32 v82, v134, v90
    v_mul_f32 v83, v135, v91
    v_mul_f32 v84, v136, v92
    v_mul_f32 v85, v137, v93
    v_mul_f32 v86, v138, v94
    v_mul_f32 v87, v139, v95
    v_cvt_pk_bf16_f32 v100, v80, v81
    v_cvt_pk_bf16_f32 v101, v82, v83
    v_cvt_pk_bf16_f32 v102, v84, v85
    v_cvt_pk_bf16_f32 v103, v86, v87
    s_add_u32 s57, s56, 0
    buffer_store_dwordx4 v[100:103], v233, s[44:47], s57 offen sc1
    v_and_b32 v88, s55, v48
    v_and_b32 v89, s55, v52
    v_and_b32 v90, s55, v56
    v_and_b32 v91, s55, v60
    v_and_b32 v92, s55, v64
    v_and_b32 v93, s55, v68
    v_and_b32 v94, s55, v72
    v_and_b32 v95, s55, v76
    v_mul_f32 v80, v140, v88
    v_mul_f32 v81, v141, v89
    v_mul_f32 v82, v142, v90
    v_mul_f32 v83, v143, v91
    v_mul_f32 v84, v144, v92
    v_mul_f32 v85, v145, v93
    v_mul_f32 v86, v146, v94
    v_mul_f32 v87, v147, v95
    v_cvt_pk_bf16_f32 v104, v80, v81
    v_cvt_pk_bf16_f32 v105, v82, v83
    v_cvt_pk_bf16_f32 v106, v84, v85
    v_cvt_pk_bf16_f32 v107, v86, v87
    s_add_u32 s57, s56, 4096
    buffer_store_dwordx4 v[104:107], v233, s[44:47], s57 offen sc1
    v_lshlrev_b32 v88, 16, v49
    v_lshlrev_b32 v89, 16, v53
    v_lshlrev_b32 v90, 16, v57
    v_lshlrev_b32 v91, 16, v61
    v_lshlrev_b32 v92, 16, v65
    v_lshlrev_b32 v93, 16, v69
    v_lshlrev_b32 v94, 16, v73
    v_lshlrev_b32 v95, 16, v77
    v_mul_f32 v80, v148, v88
    v_mul_f32 v81, v149, v89
    v_mul_f32 v82, v150, v90
    v_mul_f32 v83, v151, v91
    v_mul_f32 v84, v152, v92
    v_mul_f32 v85, v153, v93
    v_mul_f32 v86, v154, v94
    v_mul_f32 v87, v155, v95
    v_cvt_pk_bf16_f32 v108, v80, v81
    v_cvt_pk_bf16_f32 v109, v82, v83
    v_cvt_pk_bf16_f32 v110, v84, v85
    v_cvt_pk_bf16_f32 v111, v86, v87
    s_add_u32 s57, s56, 8192
    buffer_store_dwordx4 v[108:111], v233, s[44:47], s57 offen sc1
    v_and_b32 v88, s55, v49
    v_and_b32 v89, s55, v53
    v_and_b32 v90, s55, v57
    v_and_b32 v91, s55, v61
    v_and_b32 v92, s55, v65
    v_and_b32 v93, s55, v69
    v_and_b32 v94, s55, v73
    v_and_b32 v95, s55, v77
    v_mul_f32 v80, v156, v88
    v_mul_f32 v81, v157, v89
    v_mul_f32 v82, v158, v90
    v_mul_f32 v83, v159, v91
    v_mul_f32 v84, v160, v92
    v_mul_f32 v85, v161, v93
    v_mul_f32 v86, v162, v94
    v_mul_f32 v87, v163, v95
    v_cvt_pk_bf16_f32 v112, v80, v81
    v_cvt_pk_bf16_f32 v113, v82, v83
    v_cvt_pk_bf16_f32 v114, v84, v85
    v_cvt_pk_bf16_f32 v115, v86, v87
    s_add_u32 s57, s56, 12288
    buffer_store_dwordx4 v[112:115], v233, s[44:47], s57 offen sc1
    v_lshlrev_b32 v88, 16, v50
    v_lshlrev_b32 v89, 16, v54
    v_lshlrev_b32 v90, 16, v58
    v_lshlrev_b32 v91, 16, v62
    v_lshlrev_b32 v92, 16, v66
    v_lshlrev_b32 v93, 16, v70
    v_lshlrev_b32 v94, 16, v74
    v_lshlrev_b32 v95, 16, v78
    v_mul_f32 v80, v164, v88
    v_mul_f32 v81, v165, v89
    v_mul_f32 v82, v166, v90
    v_mul_f32 v83, v167, v91
    v_mul_f32 v84, v168, v92
    v_mul_f32 v85, v169, v93
    v_mul_f32 v86, v170, v94
    v_mul_f32 v87, v171, v95
    v_cvt_pk_bf16_f32 v116, v80, v81
    v_cvt_pk_bf16_f32 v117, v82, v83
    v_cvt_pk_bf16_f32 v118, v84, v85
    v_cvt_pk_bf16_f32 v119, v86, v87
    s_add_u32 s57, s56, 1048576
    buffer_store_dwordx4 v[116:119], v233, s[44:47], s57 offen sc1
    v_and_b32 v88, s55, v50
    v_and_b32 v89, s55, v54
    v_and_b32 v90, s55, v58
    v_and_b32 v91, s55, v62
    v_and_b32 v92, s55, v66
    v_and_b32 v93, s55, v70
    v_and_b32 v94, s55, v74
    v_and_b32 v95, s55, v78
    v_mul_f32 v80, v172, v88
    v_mul_f32 v81, v173, v89
    v_mul_f32 v82, v174, v90
    v_mul_f32 v83, v175, v91
    v_mul_f32 v84, v176, v92
    v_mul_f32 v85, v177, v93
    v_mul_f32 v86, v178, v94
    v_mul_f32 v87, v179, v95
    v_cvt_pk_bf16_f32 v120, v80, v81
    v_cvt_pk_bf16_f32 v121, v82, v83
    v_cvt_pk_bf16_f32 v122, v84, v85
    v_cvt_pk_bf16_f32 v123, v86, v87
    s_add_u32 s57, s56, 1052672
    buffer_store_dwordx4 v[120:123], v233, s[44:47], s57 offen sc1
    v_lshlrev_b32 v88, 16, v51
    v_lshlrev_b32 v89, 16, v55
    v_lshlrev_b32 v90, 16, v59
    v_lshlrev_b32 v91, 16, v63
    v_lshlrev_b32 v92, 16, v67
    v_lshlrev_b32 v93, 16, v71
    v_lshlrev_b32 v94, 16, v75
    v_lshlrev_b32 v95, 16, v79
    v_mul_f32 v80, v180, v88
    v_mul_f32 v81, v181, v89
    v_mul_f32 v82, v182, v90
    v_mul_f32 v83, v183, v91
    v_mul_f32 v84, v184, v92
    v_mul_f32 v85, v185, v93
    v_mul_f32 v86, v186, v94
    v_mul_f32 v87, v187, v95
    v_cvt_pk_bf16_f32 v124, v80, v81
    v_cvt_pk_bf16_f32 v125, v82, v83
    v_cvt_pk_bf16_f32 v126, v84, v85
    v_cvt_pk_bf16_f32 v127, v86, v87
    s_add_u32 s57, s56, 1056768
    buffer_store_dwordx4 v[124:127], v233, s[44:47], s57 offen sc1
    v_and_b32 v88, s55, v51
    v_and_b32 v89, s55, v55
    v_and_b32 v90, s55, v59
    v_and_b32 v91, s55, v63
    v_and_b32 v92, s55, v67
    v_and_b32 v93, s55, v71
    v_and_b32 v94, s55, v75
    v_and_b32 v95, s55, v79
    v_mul_f32 v80, v188, v88
    v_mul_f32 v81, v189, v89
    v_mul_f32 v82, v190, v90
    v_mul_f32 v83, v191, v91
    v_mul_f32 v84, v192, v92
    v_mul_f32 v85, v193, v93
    v_mul_f32 v86, v194, v94
    v_mul_f32 v87, v195, v95
    v_cvt_pk_bf16_f32 v128, v80, v81
    v_cvt_pk_bf16_f32 v129, v82, v83
    v_cvt_pk_bf16_f32 v130, v84, v85
    v_cvt_pk_bf16_f32 v131, v86, v87
    s_add_u32 s57, s56, 1060864
    buffer_store_dwordx4 v[128:131], v233, s[44:47], s57 offen sc1
    s_endpgm
F_C:
    s_load_dwordx8 s[20:27], s[0:1], 64
    s_and_b32 s32, s29, 3
    s_lshr_b32 s33, s28, 1
    s_lshl_b32 s33, s33, 2
    s_add_u32 s32, s32, s33
    s_and_b32 s33, s28, 1
    s_lshl_b32 s33, s33, 3
    s_lshr_b32 s35, s29, 2
    s_add_u32 s33, s33, s35
    v_lshlrev_b32 v1, 4, v0
    s_lshr_b32 s34, s3, 1
    s_and_b32 s35, s3, 1
    v_and_b32 v16, 15, v0
    v_lshrrev_b32 v17, 4, v0
    v_lshrrev_b32 v18, 1, v16
    v_xor_b32 v18, v18, v17
    v_lshlrev_b32 v18, 4, v18
    v_and_b32 v19, 7, v0
    v_lshl_add_u32 v18, v19, 7, v18
    v_bfe_u32 v19, v0, 3, 1
    v_mul_u32_u24 v19, 10240, v19
    s_lshl_b32 s40, s34, 11
    s_add_u32 s40, s40, 40960
    v_add3_u32 v2, v18, v19, s40
    v_xor_b32 v3, 64, v2
    v_bfe_u32 v18, v0, 2, 2
    v_lshlrev_b32 v18, 7, v18
    v_and_b32 v19, 3, v0
    v_lshl_add_u32 v18, v19, 3, v18
    v_bfe_u32 v19, v0, 3, 2
    v_lshlrev_b32 v19, 5, v19
    v_lshl_add_u32 v207, v17, 9, v18
    v_add_u32 v207, v207, v19
    s_lshl_b32 s40, s35, 6
    s_lshl_b32 s41, s34, 5
    s_or_b32 s40, s40, s41
    v_xor_b32 v19, s40, v19
    v_mul_u32_u24 v20, 10240, v17
    v_add3_u32 v18, v18, v19, v20
    v_add_u32 v4, 45056, v18
    v_xor_b32 v5, 32, v4
    v_mov_b32 v18, 0
    v_lshlrev_b32 v19, 2, v0
    v_add_u32 v20, 156160, v19
    ds_write_b32 v20, v18
    s_mov_b32 s42, 0x358637bd
    s_mov_b32 s43, 0x3fb8aa3b
    s_mov_b32 s49, 0x3f803f80
    v_mov_b32 v104, s42
    v_mov_b32 v105, s42
    v_mov_b32 v106, s42
    v_mov_b32 v107, s42
    v_mov_b32 v108, s42
    v_mov_b32 v109, s42
    v_mov_b32 v110, s42
    v_mov_b32 v111, s42
    v_mov_b32 v112, s42
    v_mov_b32 v113, s42
    v_mov_b32 v114, s42
    v_mov_b32 v115, s42
    v_mov_b32 v116, s42
    v_mov_b32 v117, s42
    v_mov_b32 v118, s42
    v_mov_b32 v119, s42
    v_mov_b32 v120, s42
    v_mov_b32 v121, s42
    v_mov_b32 v122, s42
    v_mov_b32 v123, s42
    v_mov_b32 v124, s42
    v_mov_b32 v125, s42
    v_mov_b32 v126, s42
    v_mov_b32 v127, s42
    v_mov_b32 v128, s42
    v_mov_b32 v129, s42
    v_mov_b32 v130, s42
    v_mov_b32 v131, s42
    v_mov_b32 v132, s42
    v_mov_b32 v133, s42
    v_mov_b32 v134, s42
    v_mov_b32 v135, s42
    v_mov_b32 v136, 0
    v_mov_b32 v137, 0
    v_mov_b32 v138, 0
    v_mov_b32 v139, 0
    v_mov_b32 v140, 0
    v_mov_b32 v141, 0
    v_mov_b32 v142, 0
    v_mov_b32 v143, 0
    v_mov_b32 v144, 0
    v_mov_b32 v145, 0
    v_mov_b32 v146, 0
    v_mov_b32 v147, 0
    v_mov_b32 v148, 0
    v_mov_b32 v149, 0
    v_mov_b32 v150, 0
    v_mov_b32 v151, 0
    v_mov_b32 v152, 0
    v_mov_b32 v153, 0
    v_mov_b32 v154, 0
    v_mov_b32 v155, 0
    v_mov_b32 v156, 0
    v_mov_b32 v157, 0
    v_mov_b32 v158, 0
    v_mov_b32 v159, 0
    v_mov_b32 v160, 0
    v_mov_b32 v161, 0
    v_mov_b32 v162, 0
    v_mov_b32 v163, 0
    v_mov_b32 v164, 0
    v_mov_b32 v165, 0
    v_mov_b32 v166, 0
    v_mov_b32 v167, 0
    v_mov_b32 v168, s42
    v_mov_b32 v169, s42
    v_mov_b32 v170, s42
    v_mov_b32 v171, s42
    v_mov_b32 v172, s42
    v_mov_b32 v173, s42
    v_mov_b32 v174, s42
    v_mov_b32 v175, s42
    v_mov_b32 v176, s42
    v_mov_b32 v177, s42
    v_mov_b32 v178, s42
    v_mov_b32 v179, s42
    v_mov_b32 v180, s42
    v_mov_b32 v181, s42
    v_mov_b32 v182, s42
    v_mov_b32 v183, s42
    v_mov_b32 v184, s42
    v_mov_b32 v185, s42
    v_mov_b32 v186, s42
    v_mov_b32 v187, s42
    v_mov_b32 v188, s42
    v_mov_b32 v189, s42
    v_mov_b32 v190, s42
    v_mov_b32 v191, s42
    v_mov_b32 v192, s42
    v_mov_b32 v193, s42
    v_mov_b32 v194, s42
    v_mov_b32 v195, s42
    v_mov_b32 v196, s42
    v_mov_b32 v197, s42
    v_mov_b32 v198, s42
    v_mov_b32 v199, s42
    s_and_b32 s40, s3, 1
    s_lshl_b32 s41, s31, 1
    s_add_u32 s40, s40, s41
    s_lshr_b32 s41, s3, 1
    s_lshl_b32 s52, s30, 1
    s_add_u32 s52, s52, s41
    s_mul_i32 s52, s52, 132
    s_add_u32 s52, s52, s40
    s_lshl_b32 s52, s52, 10
    s_add_u32 s52, s52, 0x200000
    s_lshl_b32 s50, s40, 15
    s_lshl_b32 s51, s41, 10
    s_add_u32 s53, s50, s51
    s_lshl_b32 s50, s30, 11
    s_add_u32 s50, s50, s53
    s_lshl_b32 s40, s40, 11
    s_add_u32 s54, s40, s51
    s_add_u32 s54, s54, 0x100000
    s_lshl_b32 s51, s30, 6
    s_add_u32 s51, s51, s54
    s_mul_i32 s40, s35, 2304
    s_add_u32 s58, s40, 156416
    s_add_u32 s59, s40, 116736
    s_cmp_eq_u32 s34, 0
    s_cselect_b32 s40, s58, s59
    s_cselect_b32 s41, s59, s58
    v_lshlrev_b32 v12, 4, v17
    v_add_u32 v6, s40, v1
    v_add_u32 v7, s41, v1
    v_add_u32 v8, s40, v12
    v_add_u32 v9, s41, v12
    s_lshl_b32 s40, s3, 3
    s_add_u32 s41, s40, 156160
    v_mov_b32 v10, s41
    v_xor_b32 v11, 16, v10
    v_lshl_add_u32 v13, v16, 6, v12
    s_lshl_b32 s40, s34, 3
    s_add_u32 s41, s59, s40
    v_add_u32 v200, s41, v1
    v_xor_b32 v201, 8, v200
    s_add_u32 s41, s58, s40
    v_add_u32 v203, s41, v1
    v_xor_b32 v202, 8, v203
    s_lshl_b32 s40, s3, 2
    s_add_u32 s41, s40, 156240
    v_mov_b32 v204, s41
    s_add_u32 s41, s40, 156224
    v_mov_b32 v206, s41
    v_lshlrev_b32 v18, 1, v17
    v_and_b32 v20, 7, v0
    v_xor_b32 v18, v18, v20
    v_lshlrev_b32 v18, 4, v18
    v_lshrrev_b32 v20, 3, v0
    v_lshl_add_u32 v205, v20, 11, v18
    v_mov_b32 v14, 1
    v_and_b32 v18, 12, v19
    v_add_u32 v209, 156160, v18
    v_add_u32 v211, 144, v209
    v_add_u32 v20, 144, v209
    v_subrev_u32 v21, 12, v0
    v_cmp_gt_u32 vcc, 12, v21
    v_and_b32 v18, 4, v19
    v_add_u32 v18, 156208, v18
    v_cndmask_b32 v211, v211, v20, vcc
    v_and_b32 v21, 31, v0
    v_cmp_lt_u32 vcc, 23, v21
    s_nop 1
    v_cndmask_b32 v211, v211, v18, vcc
    s_lshl_b32 s55, s32, 2
    s_add_u32 s55, s55, s3
    s_lshl_b32 s56, s55, 17
    s_lshl_b32 s40, s33, 7
    s_add_u32 s56, s56, s40
    s_mul_i32 s55, s55, 67584
    s_add_u32 s55, s55, 0x200000
    v_and_b32 v18, 31, v0
    v_add_u32 v18, 33, v18
    s_xor_b32 s40, s35, 1
    s_mul_i32 s40, s40, 66
    v_add_u32 v18, s40, v18
    v_lshlrev_b32 v208, 10, v18
    s_and_b32 s57, s33, 7
    s_mul_i32 s57, s57, 3
    s_lshr_b32 s57, s57, 2
    v_lshlrev_b32 v210, 12, v16
    v_bfe_u32 v18, v0, 4, 1
    v_lshl_add_u32 v210, v18, 5, v210
    v_lshrrev_b32 v18, 5, v0
    v_lshl_add_u32 v210, v18, 4, v210
    s_mov_b32 s44, 0
    s_mov_b32 s45, 1
    s_mov_b32 s46, 0xfffec000
    s_mov_b32 s47, 40960
    s_waitcnt lgkmcnt(0)
    s_mov_b32 s36, s26
    s_mov_b32 s37, s27
    s_mov_b32 s38, 0x10000000
    s_mov_b32 s39, 0x00020000
    s_mov_b32 s60, s22
    s_mov_b32 s61, s23
    s_mov_b32 s62, 0x800000
    s_mov_b32 s63, 0x00020000
    s_mov_b32 s64, s26
    s_mov_b32 s65, s27
    s_mov_b32 s66, 0x10000000
    s_mov_b32 s67, 0x00020000
    s_cmp_lg_u32 s2, 0
    s_cbranch_scc1 F_NOINIT
    v_mov_b32 v20, 0
    v_mov_b32 v21, 0
    v_mov_b32 v22, 0
    v_mov_b32 v23, 0
    s_mul_i32 s40, s3, 6144
    s_add_u32 s40, s40, 0x120000
    s_add_u32 s41, s40, 4096
    buffer_store_dwordx4 v[20:23], v1, s[36:39], s40 offen offset:0 sc1
    buffer_store_dwordx4 v[20:23], v1, s[36:39], s40 offen offset:1024 sc1
    buffer_store_dwordx4 v[20:23], v1, s[36:39], s40 offen offset:2048 sc1
    buffer_store_dwordx4 v[20:23], v1, s[36:39], s40 offen offset:3072 sc1
    buffer_store_dwordx4 v[20:23], v1, s[36:39], s41 offen offset:0 sc1
    buffer_store_dwordx4 v[20:23], v1, s[36:39], s41 offen offset:1024 sc1
    s_mov_b32 s40, 1
    s_waitcnt vmcnt(0)
    s_atomic_add s40, s[24:25], 0
    s_waitcnt lgkmcnt(0)
F_NOINIT:
    s_lshl_b32 s40, s31, 2
    s_lshl_b32 s41, s35, 1
    s_add_u32 s40, s40, s41
    s_add_u32 s40, s40, s34
    s_lshl_b32 s10, s40, 7
    s_add_u32 s10, s10, 0x122000
    s_add_u32 s10, s10, s26
    s_addc_u32 s11, s27, 0
    s_lshl_b32 s40, s30, 1
    s_add_u32 s40, s40, s34
    s_lshl_b32 s12, s40, 7
    s_add_u32 s12, s12, 0x124000
    s_add_u32 s12, s12, s26
    s_addc_u32 s13, s27, 0
    s_lshl_b32 s40, s32, 1
    s_add_u32 s40, s40, s34
    s_lshl_b32 s14, s40, 7
    s_add_u32 s14, s14, 0x124000
    s_add_u32 s14, s14, s26
    s_addc_u32 s15, s27, 0
    s_lshr_b32 s40, s31, 1
    s_lshl_b32 s40, s40, 2
    s_lshl_b32 s16, 1, s40
    s_mov_b32 s4, s8
    s_mov_b32 s5, s9
    s_mov_b32 s6, 0x200000
    s_mov_b32 s7, 0x00020000
    s_lshl_b32 s68, s3, 10
    s_lshl_b32 s69, s3, 14
    s_lshl_b32 s40, s33, 7
    s_add_u32 s69, s69, s40
    s_barrier
    ds_read_b64_tr_b16 v[80:81], v4 offset:1024
    ds_read_b64_tr_b16 v[82:83], v4 offset:1536
    ds_read_b128 v[16:19], v2 offset:0
    ds_read_b64_tr_b16 v[84:85], v4 offset:4096
    ds_read_b64_tr_b16 v[86:87], v4 offset:4608
    ds_read_b128 v[20:23], v3 offset:0
    ds_read_b128 v[24:27], v2 offset:20480
    ds_read_b128 v[28:31], v3 offset:20480
    ds_read_b128 v[32:35], v2 offset:1024
    ds_read_b128 v[36:39], v3 offset:1024
    ds_read_b64_tr_b16 v[88:89], v5 offset:1024
    ds_read_b64_tr_b16 v[90:91], v5 offset:1536
    ds_read_b64_tr_b16 v[92:93], v5 offset:4096
    ds_read_b64_tr_b16 v[94:95], v5 offset:4608
    ds_read_b128 v[40:43], v2 offset:21504
    ds_read_b128 v[44:47], v3 offset:21504
.p2align 6
F_CLOOP:
    s_waitcnt lgkmcnt(8)
    v_mfma_f32_16x16x32_bf16 v[104:107], v[16:19], v[80:83], v[104:107]
    ds_read_b64_tr_b16 v[96:97], v4 offset:2048
    v_mfma_f32_16x16x32_bf16 v[104:107], v[20:23], v[84:87], v[104:107]
    ds_read_b64_tr_b16 v[98:99], v4 offset:2560
    v_mfma_f32_16x16x32_bf16 v[108:111], v[24:27], v[80:83], v[108:111]
    ds_read_b64_tr_b16 v[100:101], v4 offset:5120
    v_mfma_f32_16x16x32_bf16 v[108:111], v[28:31], v[84:87], v[108:111]
    ds_read_b64_tr_b16 v[102:103], v4 offset:5632
    s_waitcnt lgkmcnt(4)
    v_mfma_f32_16x16x32_bf16 v[112:115], v[32:35], v[80:83], v[112:115]
    v_mfma_f32_16x16x32_bf16 v[112:115], v[36:39], v[84:87], v[112:115]
    v_mfma_f32_16x16x32_bf16 v[116:119], v[40:43], v[80:83], v[116:119]
    v_mfma_f32_16x16x32_bf16 v[116:119], v[44:47], v[84:87], v[116:119]
    v_mfma_f32_16x16x32_bf16 v[120:123], v[16:19], v[88:91], v[120:123]
    ds_read_b64_tr_b16 v[80:81], v5 offset:2048
    v_mfma_f32_16x16x32_bf16 v[120:123], v[20:23], v[92:95], v[120:123]
    ds_read_b64_tr_b16 v[82:83], v5 offset:2560
    v_mfma_f32_16x16x32_bf16 v[124:127], v[24:27], v[88:91], v[124:127]
    ds_read_b64_tr_b16 v[84:85], v5 offset:5120
    v_mfma_f32_16x16x32_bf16 v[124:127], v[28:31], v[92:95], v[124:127]
    ds_read_b64_tr_b16 v[86:87], v5 offset:5632
    v_mfma_f32_16x16x32_bf16 v[128:131], v[32:35], v[88:91], v[128:131]
    v_mfma_f32_16x16x32_bf16 v[128:131], v[36:39], v[92:95], v[128:131]
    v_mfma_f32_16x16x32_bf16 v[132:135], v[40:43], v[88:91], v[132:135]
    v_mfma_f32_16x16x32_bf16 v[132:135], v[44:47], v[92:95], v[132:135]
    s_waitcnt lgkmcnt(4)
    v_mfma_f32_16x16x32_bf16 v[136:139], v[16:19], v[96:99], v[136:139]
    ds_read_b64_tr_b16 v[88:89], v4 offset:0
    v_mfma_f32_16x16x32_bf16 v[136:139], v[20:23], v[100:103], v[136:139]
    ds_read_b64_tr_b16 v[90:91], v4 offset:512
    v_mfma_f32_16x16x32_bf16 v[140:143], v[24:27], v[96:99], v[140:143]
    ds_read_b64_tr_b16 v[92:93], v4 offset:3072
    v_mfma_f32_16x16x32_bf16 v[140:143], v[28:31], v[100:103], v[140:143]
    ds_read_b64_tr_b16 v[94:95], v4 offset:3584
    v_mfma_f32_16x16x32_bf16 v[144:147], v[32:35], v[96:99], v[144:147]
    v_mfma_f32_16x16x32_bf16 v[144:147], v[36:39], v[100:103], v[144:147]
    s_add_u32 s44, s44, 1
    v_mfma_f32_16x16x32_bf16 v[148:151], v[40:43], v[96:99], v[148:151]
    v_mfma_f32_16x16x32_bf16 v[148:151], v[44:47], v[100:103], v[148:151]
    s_waitcnt lgkmcnt(4)
    v_mfma_f32_16x16x32_bf16 v[152:155], v[16:19], v[80:83], v[152:155]
    ds_read_b64_tr_b16 v[96:97], v5 offset:0
    v_mfma_f32_16x16x32_bf16 v[152:155], v[20:23], v[84:87], v[152:155]
    ds_read_b64_tr_b16 v[98:99], v5 offset:512
    v_mfma_f32_16x16x32_bf16 v[156:159], v[24:27], v[80:83], v[156:159]
    ds_read_b64_tr_b16 v[100:101], v5 offset:3072
    v_mfma_f32_16x16x32_bf16 v[156:159], v[28:31], v[84:87], v[156:159]
    ds_read_b64_tr_b16 v[102:103], v5 offset:3584
    v_mfma_f32_16x16x32_bf16 v[160:163], v[32:35], v[80:83], v[160:163]
    s_add_u32 s45, s45, 1
    s_cmp_eq_u32 s45, 3
    v_mfma_f32_16x16x32_bf16 v[160:163], v[36:39], v[84:87], v[160:163]
    s_cselect_b32 s48, s46, s47
    s_cselect_b32 s45, 0, s45
    v_mfma_f32_16x16x32_bf16 v[164:167], v[40:43], v[80:83], v[164:167]
    v_add_u32 v4, s48, v4
    v_add_u32 v2, s48, v2
    v_mfma_f32_16x16x32_bf16 v[164:167], v[44:47], v[84:87], v[164:167]
    v_add_u32 v3, s48, v3
    v_add_u32 v5, s48, v5
    s_waitcnt lgkmcnt(0)
    v_mfma_f32_16x16x32_bf16 v[168:171], v[88:91], v[16:19], v[168:171]
    s_cmp_lt_u32 s44, 8
    s_cbranch_scc0 F_CNB0
    s_barrier
F_CB0:
    v_mfma_f32_16x16x32_bf16 v[168:171], v[92:95], v[20:23], v[168:171]
    ds_read_b64_tr_b16 v[80:81], v4 offset:1024
    ds_read_b64_tr_b16 v[82:83], v4 offset:1536
    v_mfma_f32_16x16x32_bf16 v[172:175], v[88:91], v[24:27], v[172:175]
    ds_read_b128 v[48:51], v2 offset:0
    ds_read_b64_tr_b16 v[84:85], v4 offset:4096
    v_mfma_f32_16x16x32_bf16 v[172:175], v[92:95], v[28:31], v[172:175]
    ds_read_b64_tr_b16 v[86:87], v4 offset:4608
    v_mfma_f32_16x16x32_bf16 v[176:179], v[88:91], v[32:35], v[176:179]
    ds_read_b128 v[52:55], v3 offset:0
    v_mfma_f32_16x16x32_bf16 v[176:179], v[92:95], v[36:39], v[176:179]
    ds_read_b128 v[56:59], v2 offset:20480
    v_mfma_f32_16x16x32_bf16 v[180:183], v[88:91], v[40:43], v[180:183]
    ds_read_b128 v[60:63], v3 offset:20480
    v_mfma_f32_16x16x32_bf16 v[180:183], v[92:95], v[44:47], v[180:183]
    v_mfma_f32_16x16x32_bf16 v[184:187], v[96:99], v[16:19], v[184:187]
    ds_read_b128 v[64:67], v2 offset:1024
    ds_read_b128 v[68:71], v3 offset:1024
    v_mfma_f32_16x16x32_bf16 v[184:187], v[100:103], v[20:23], v[184:187]
    ds_read_b64_tr_b16 v[88:89], v5 offset:1024
    ds_read_b64_tr_b16 v[90:91], v5 offset:1536
    v_mfma_f32_16x16x32_bf16 v[188:191], v[96:99], v[24:27], v[188:191]
    ds_read_b64_tr_b16 v[92:93], v5 offset:4096
    ds_read_b64_tr_b16 v[94:95], v5 offset:4608
    v_mfma_f32_16x16x32_bf16 v[188:191], v[100:103], v[28:31], v[188:191]
    ds_read_b128 v[72:75], v2 offset:21504
    v_mfma_f32_16x16x32_bf16 v[192:195], v[96:99], v[32:35], v[192:195]
    ds_read_b128 v[76:79], v3 offset:21504
    v_mfma_f32_16x16x32_bf16 v[192:195], v[100:103], v[36:39], v[192:195]
    v_mfma_f32_16x16x32_bf16 v[196:199], v[96:99], v[40:43], v[196:199]
    v_mfma_f32_16x16x32_bf16 v[196:199], v[100:103], v[44:47], v[196:199]
    s_waitcnt lgkmcnt(8)
    v_mfma_f32_16x16x32_bf16 v[104:107], v[48:51], v[80:83], v[104:107]
    ds_read_b64_tr_b16 v[96:97], v4 offset:2048
    v_mfma_f32_16x16x32_bf16 v[104:107], v[52:55], v[84:87], v[104:107]
    ds_read_b64_tr_b16 v[98:99], v4 offset:2560
    v_mfma_f32_16x16x32_bf16 v[108:111], v[56:59], v[80:83], v[108:111]
    ds_read_b64_tr_b16 v[100:101], v4 offset:5120
    v_mfma_f32_16x16x32_bf16 v[108:111], v[60:63], v[84:87], v[108:111]
    ds_read_b64_tr_b16 v[102:103], v4 offset:5632
    s_waitcnt lgkmcnt(4)
    v_mfma_f32_16x16x32_bf16 v[112:115], v[64:67], v[80:83], v[112:115]
    v_mfma_f32_16x16x32_bf16 v[112:115], v[68:71], v[84:87], v[112:115]
    v_mfma_f32_16x16x32_bf16 v[116:119], v[72:75], v[80:83], v[116:119]
    v_mfma_f32_16x16x32_bf16 v[116:119], v[76:79], v[84:87], v[116:119]
    v_mfma_f32_16x16x32_bf16 v[120:123], v[48:51], v[88:91], v[120:123]
    ds_read_b64_tr_b16 v[80:81], v5 offset:2048
    v_mfma_f32_16x16x32_bf16 v[120:123], v[52:55], v[92:95], v[120:123]
    ds_read_b64_tr_b16 v[82:83], v5 offset:2560
    v_mfma_f32_16x16x32_bf16 v[124:127], v[56:59], v[88:91], v[124:127]
    ds_read_b64_tr_b16 v[84:85], v5 offset:5120
    v_mfma_f32_16x16x32_bf16 v[124:127], v[60:63], v[92:95], v[124:127]
    ds_read_b64_tr_b16 v[86:87], v5 offset:5632
    v_mfma_f32_16x16x32_bf16 v[128:131], v[64:67], v[88:91], v[128:131]
    v_mfma_f32_16x16x32_bf16 v[128:131], v[68:71], v[92:95], v[128:131]
    v_mfma_f32_16x16x32_bf16 v[132:135], v[72:75], v[88:91], v[132:135]
    v_mfma_f32_16x16x32_bf16 v[132:135], v[76:79], v[92:95], v[132:135]
    s_waitcnt lgkmcnt(4)
    v_mfma_f32_16x16x32_bf16 v[136:139], v[48:51], v[96:99], v[136:139]
    ds_read_b64_tr_b16 v[88:89], v4 offset:0
    v_mfma_f32_16x16x32_bf16 v[136:139], v[52:55], v[100:103], v[136:139]
    ds_read_b64_tr_b16 v[90:91], v4 offset:512
    v_mfma_f32_16x16x32_bf16 v[140:143], v[56:59], v[96:99], v[140:143]
    ds_read_b64_tr_b16 v[92:93], v4 offset:3072
    v_mfma_f32_16x16x32_bf16 v[140:143], v[60:63], v[100:103], v[140:143]
    ds_read_b64_tr_b16 v[94:95], v4 offset:3584
    v_mfma_f32_16x16x32_bf16 v[144:147], v[64:67], v[96:99], v[144:147]
    v_mfma_f32_16x16x32_bf16 v[144:147], v[68:71], v[100:103], v[144:147]
    v_mfma_f32_16x16x32_bf16 v[148:151], v[72:75], v[96:99], v[148:151]
    v_mfma_f32_16x16x32_bf16 v[148:151], v[76:79], v[100:103], v[148:151]
    s_waitcnt lgkmcnt(4)
    v_mfma_f32_16x16x32_bf16 v[152:155], v[48:51], v[80:83], v[152:155]
    ds_read_b64_tr_b16 v[96:97], v5 offset:0
    v_mfma_f32_16x16x32_bf16 v[152:155], v[52:55], v[84:87], v[152:155]
    ds_read_b64_tr_b16 v[98:99], v5 offset:512
    v_mfma_f32_16x16x32_bf16 v[156:159], v[56:59], v[80:83], v[156:159]
    ds_read_b64_tr_b16 v[100:101], v5 offset:3072
    v_mfma_f32_16x16x32_bf16 v[156:159], v[60:63], v[84:87], v[156:159]
    ds_read_b64_tr_b16 v[102:103], v5 offset:3584
    v_mfma_f32_16x16x32_bf16 v[160:163], v[64:67], v[80:83], v[160:163]
    s_add_u32 s45, s45, 1
    s_cmp_eq_u32 s45, 3
    v_mfma_f32_16x16x32_bf16 v[160:163], v[68:71], v[84:87], v[160:163]
    s_cselect_b32 s48, s46, s47
    s_cselect_b32 s45, 0, s45
    v_mfma_f32_16x16x32_bf16 v[164:167], v[72:75], v[80:83], v[164:167]
    v_add_u32 v4, s48, v4
    v_add_u32 v2, s48, v2
    v_mfma_f32_16x16x32_bf16 v[164:167], v[76:79], v[84:87], v[164:167]
    v_add_u32 v3, s48, v3
    v_add_u32 v5, s48, v5
    s_waitcnt lgkmcnt(0)
    v_mfma_f32_16x16x32_bf16 v[168:171], v[88:91], v[48:51], v[168:171]
    s_cmp_lt_u32 s44, 8
    s_cbranch_scc0 F_CNB1
    s_barrier
F_CB1:
    v_mfma_f32_16x16x32_bf16 v[168:171], v[92:95], v[52:55], v[168:171]
    ds_read_b64_tr_b16 v[80:81], v4 offset:1024
    ds_read_b64_tr_b16 v[82:83], v4 offset:1536
    v_mfma_f32_16x16x32_bf16 v[172:175], v[88:91], v[56:59], v[172:175]
    ds_read_b128 v[16:19], v2 offset:0
    ds_read_b64_tr_b16 v[84:85], v4 offset:4096
    v_mfma_f32_16x16x32_bf16 v[172:175], v[92:95], v[60:63], v[172:175]
    ds_read_b64_tr_b16 v[86:87], v4 offset:4608
    v_mfma_f32_16x16x32_bf16 v[176:179], v[88:91], v[64:67], v[176:179]
    ds_read_b128 v[20:23], v3 offset:0
    v_mfma_f32_16x16x32_bf16 v[176:179], v[92:95], v[68:71], v[176:179]
    ds_read_b128 v[24:27], v2 offset:20480
    v_mfma_f32_16x16x32_bf16 v[180:183], v[88:91], v[72:75], v[180:183]
    ds_read_b128 v[28:31], v3 offset:20480
    v_mfma_f32_16x16x32_bf16 v[180:183], v[92:95], v[76:79], v[180:183]
    v_mfma_f32_16x16x32_bf16 v[184:187], v[96:99], v[48:51], v[184:187]
    ds_read_b128 v[32:35], v2 offset:1024
    ds_read_b128 v[36:39], v3 offset:1024
    v_mfma_f32_16x16x32_bf16 v[184:187], v[100:103], v[52:55], v[184:187]
    ds_read_b64_tr_b16 v[88:89], v5 offset:1024
    ds_read_b64_tr_b16 v[90:91], v5 offset:1536
    v_mfma_f32_16x16x32_bf16 v[188:191], v[96:99], v[56:59], v[188:191]
    ds_read_b64_tr_b16 v[92:93], v5 offset:4096
    ds_read_b64_tr_b16 v[94:95], v5 offset:4608
    v_mfma_f32_16x16x32_bf16 v[188:191], v[100:103], v[60:63], v[188:191]
    ds_read_b128 v[40:43], v2 offset:21504
    v_mfma_f32_16x16x32_bf16 v[192:195], v[96:99], v[64:67], v[192:195]
    ds_read_b128 v[44:47], v3 offset:21504
    v_mfma_f32_16x16x32_bf16 v[192:195], v[100:103], v[68:71], v[192:195]
    v_mfma_f32_16x16x32_bf16 v[196:199], v[96:99], v[72:75], v[196:199]
    v_mfma_f32_16x16x32_bf16 v[196:199], v[100:103], v[76:79], v[196:199]
    s_cbranch_scc1 F_CLOOP
    s_setprio 3
    s_mov_b32 s46, s43
    s_mov_b32 s47, s43
    v_mul_f32 v244, s43, v104
    v_mul_f32 v245, s43, v105
    v_mul_f32 v246, s43, v106
    v_mul_f32 v247, s43, v107
    v_mul_f32 v248, s43, v108
    v_mul_f32 v249, s43, v109
    v_mul_f32 v250, s43, v110
    v_mul_f32 v251, s43, v111
    v_exp_f32 v244, v244 clamp
    v_max_f32 v104, s42, v104
    v_exp_f32 v245, v245 clamp
    v_max_f32 v105, s42, v105
    v_exp_f32 v246, v246 clamp
    v_max_f32 v106, s42, v106
    v_exp_f32 v247, v247 clamp
    v_max_f32 v107, s42, v107
    v_exp_f32 v248, v248 clamp
    v_max_f32 v108, s42, v108
    v_exp_f32 v249, v249 clamp
    v_max_f32 v109, s42, v109
    v_exp_f32 v250, v250 clamp
    v_max_f32 v110, s42, v110
    v_exp_f32 v251, v251 clamp
    v_max_f32 v111, s42, v111
    v_add_f32 v244, v244, v104
    v_add_f32 v245, v245, v105
    v_add_f32 v246, v246, v106
    v_add_f32 v247, v247, v107
    v_add_f32 v248, v248, v108
    v_add_f32 v249, v249, v109
    v_add_f32 v250, v250, v110
    v_add_f32 v251, v251, v111
    v_cvt_pk_bf16_f32 v212, v244, v245
    v_cvt_pk_bf16_f32 v213, v246, v247
    v_cvt_pk_bf16_f32 v214, v248, v249
    v_cvt_pk_bf16_f32 v215, v250, v251
    v_mov_b32 v252, s49
    v_mov_b32 v253, s49
    v_mov_b32 v254, s49
    v_mov_b32 v255, s49
    v_cvt_pk_bf16_f32 v228, v136, v137
    v_cvt_pk_bf16_f32 v229, v138, v139
    v_cvt_pk_bf16_f32 v230, v140, v141
    v_cvt_pk_bf16_f32 v231, v142, v143
    v_cvt_pk_bf16_f32 v232, v144, v145
    v_cvt_pk_bf16_f32 v233, v146, v147
    v_cvt_pk_bf16_f32 v234, v148, v149
    v_cvt_pk_bf16_f32 v235, v150, v151
    v_cvt_pk_bf16_f32 v236, v152, v153
    v_cvt_pk_bf16_f32 v237, v154, v155
    v_cvt_pk_bf16_f32 v238, v156, v157
    v_cvt_pk_bf16_f32 v239, v158, v159
    v_cvt_pk_bf16_f32 v240, v160, v161
    v_cvt_pk_bf16_f32 v241, v162, v163
    v_cvt_pk_bf16_f32 v242, v164, v165
    v_cvt_pk_bf16_f32 v243, v166, v167
    v_mfma_f32_16x16x32_bf16 v[140:143], v[212:215], v[236:239], 0
    v_mfma_f32_16x16x32_bf16 v[136:139], v[212:215], v[228:231], 0
    v_mfma_f32_16x16x32_bf16 v[152:155], v[212:215], v[252:255], 0
    v_mul_f32 v244, s43, v120
    v_mul_f32 v245, s43, v121
    v_mul_f32 v246, s43, v122
    v_mul_f32 v247, s43, v123
    v_mul_f32 v248, s43, v124
    v_mul_f32 v249, s43, v125
    v_mul_f32 v250, s43, v126
    v_mul_f32 v251, s43, v127
    v_exp_f32 v244, v244 clamp
    v_max_f32 v120, s42, v120
    v_exp_f32 v245, v245 clamp
    v_max_f32 v121, s42, v121
    v_exp_f32 v246, v246 clamp
    v_max_f32 v122, s42, v122
    v_exp_f32 v247, v247 clamp
    v_max_f32 v123, s42, v123
    v_exp_f32 v248, v248 clamp
    v_max_f32 v124, s42, v124
    v_exp_f32 v249, v249 clamp
    v_max_f32 v125, s42, v125
    v_exp_f32 v250, v250 clamp
    v_max_f32 v126, s42, v126
    v_exp_f32 v251, v251 clamp
    v_max_f32 v127, s42, v127
    v_add_f32 v244, v244, v120
    v_add_f32 v245, v245, v121
    v_add_f32 v246, v246, v122
    v_add_f32 v247, v247, v123
    v_add_f32 v248, v248, v124
    v_add_f32 v249, v249, v125
    v_add_f32 v250, v250, v126
    v_add_f32 v251, v251, v127
    v_cvt_pk_bf16_f32 v216, v244, v245
    v_cvt_pk_bf16_f32 v217, v246, v247
    v_cvt_pk_bf16_f32 v218, v248, v249
    v_cvt_pk_bf16_f32 v219, v250, v251
    s_nop 1
    v_mfma_f32_16x16x32_bf16 v[148:151], v[216:219], v[236:239], 0
    v_mfma_f32_16x16x32_bf16 v[144:147], v[216:219], v[228:231], 0
    v_mfma_f32_16x16x32_bf16 v[156:159], v[216:219], v[252:255], 0
    v_mul_f32 v244, s43, v112
    v_mul_f32 v245, s43, v113
    v_mul_f32 v246, s43, v114
    v_mul_f32 v247, s43, v115
    v_mul_f32 v248, s43, v116
    v_mul_f32 v249, s43, v117
    v_mul_f32 v250, s43, v118
    v_mul_f32 v251, s43, v119
    v_exp_f32 v244, v244 clamp
    v_max_f32 v112, s42, v112
    v_exp_f32 v245, v245 clamp
    v_max_f32 v113, s42, v113
    v_exp_f32 v246, v246 clamp
    v_max_f32 v114, s42, v114
    v_exp_f32 v247, v247 clamp
    v_max_f32 v115, s42, v115
    v_exp_f32 v248, v248 clamp
    v_max_f32 v116, s42, v116
    v_exp_f32 v249, v249 clamp
    v_max_f32 v117, s42, v117
    v_exp_f32 v250, v250 clamp
    v_max_f32 v118, s42, v118
    v_exp_f32 v251, v251 clamp
    v_max_f32 v119, s42, v119
    v_add_f32 v244, v244, v112
    v_add_f32 v245, v245, v113
    v_add_f32 v246, v246, v114
    v_add_f32 v247, v247, v115
    v_add_f32 v248, v248, v116
    v_add_f32 v249, v249, v117
    v_add_f32 v250, v250, v118
    v_add_f32 v251, v251, v119
    v_cvt_pk_bf16_f32 v212, v244, v245
    v_cvt_pk_bf16_f32 v213, v246, v247
    v_cvt_pk_bf16_f32 v214, v248, v249
    v_cvt_pk_bf16_f32 v215, v250, v251
    s_nop 1
    v_mfma_f32_16x16x32_bf16 v[140:143], v[212:215], v[240:243], v[140:143]
    v_mfma_f32_16x16x32_bf16 v[136:139], v[212:215], v[232:235], v[136:139]
    v_mfma_f32_16x16x32_bf16 v[152:155], v[212:215], v[252:255], v[152:155]
    v_mul_f32 v244, s43, v128
    v_mul_f32 v245, s43, v129
    v_mul_f32 v246, s43, v130
    v_mul_f32 v247, s43, v131
    v_mul_f32 v248, s43, v132
    v_mul_f32 v249, s43, v133
    v_mul_f32 v250, s43, v134
    v_mul_f32 v251, s43, v135
    v_exp_f32 v244, v244 clamp
    v_max_f32 v128, s42, v128
    v_exp_f32 v245, v245 clamp
    v_max_f32 v129, s42, v129
    v_exp_f32 v246, v246 clamp
    v_max_f32 v130, s42, v130
    v_exp_f32 v247, v247 clamp
    v_max_f32 v131, s42, v131
    v_exp_f32 v248, v248 clamp
    v_max_f32 v132, s42, v132
    v_exp_f32 v249, v249 clamp
    v_max_f32 v133, s42, v133
    v_exp_f32 v250, v250 clamp
    v_max_f32 v134, s42, v134
    v_exp_f32 v251, v251 clamp
    v_max_f32 v135, s42, v135
    v_add_f32 v244, v244, v128
    v_add_f32 v245, v245, v129
    v_add_f32 v246, v246, v130
    v_add_f32 v247, v247, v131
    v_add_f32 v248, v248, v132
    v_add_f32 v249, v249, v133
    v_add_f32 v250, v250, v134
    v_add_f32 v251, v251, v135
    v_cvt_pk_bf16_f32 v216, v244, v245
    v_cvt_pk_bf16_f32 v217, v246, v247
    v_cvt_pk_bf16_f32 v218, v248, v249
    v_cvt_pk_bf16_f32 v219, v250, v251
    s_nop 1
    v_mfma_f32_16x16x32_bf16 v[148:151], v[216:219], v[240:243], v[148:151]
    v_mfma_f32_16x16x32_bf16 v[144:147], v[216:219], v[232:235], v[144:147]
    v_mfma_f32_16x16x32_bf16 v[156:159], v[216:219], v[252:255], v[156:159]
    ds_write_b128 v6, v[140:143]
    s_nop 4
    ds_write_b128 v6, v[148:151] offset:1024
    s_nop 0
    ds_write_b128 v8, v[156:159] offset:2048
    ds_write_b32 v10, v14
F_XA:
    ds_read_b32 v15, v11
    ds_read_b128 v[212:215], v7 offset:1024
    ds_read_b128 v[216:219], v7
    ds_read_b128 v[220:223], v9 offset:2048
    s_waitcnt lgkmcnt(0)
    v_cmp_ne_u32 vcc, 1, v15
    s_cbranch_vccnz F_XA
    v_add_f32 v212, v212, v136
    v_add_f32 v213, v213, v137
    v_add_f32 v214, v214, v138
    v_add_f32 v215, v215, v139
    v_add_f32 v216, v216, v144
    v_add_f32 v217, v217, v145
    v_add_f32 v218, v218, v146
    v_add_f32 v219, v219, v147
    v_cvt_pk_bf16_f32 v224, v212, v213
    v_cvt_pk_bf16_f32 v225, v214, v215
    v_cvt_pk_bf16_f32 v226, v216, v217
    v_cvt_pk_bf16_f32 v227, v218, v219
    buffer_store_dwordx4 v[224:227], v1, s[36:39], s50 offen sc1
    v_add_f32 v220, v220, v152
    v_add_f32 v221, v221, v153
    v_add_f32 v222, v222, v154
    v_add_f32 v223, v223, v155
    s_mov_b32 exec_lo, 0x00010001
    s_mov_b32 exec_hi, 0x00010001
    buffer_store_dwordx4 v[220:223], v12, s[36:39], s51 offen sc1
    s_mov_b64 exec, -1
    v_mov_b32 v112, s42
    v_mov_b32 v113, s42
    v_mov_b32 v114, s42
    v_mov_b32 v115, s42
    v_bfe_u32 v116, v0, 2, 2
    v_lshrrev_b32 v117, 4, v0
    v_cmp_eq_u32 vcc, v116, v117
    v_and_b32 v116, 1, v0
    v_lshlrev_b32 v116, 4, v116
    v_mov_b32 v117, 0x3f80
    v_lshlrev_b32 v116, v116, v117
    v_cndmask_b32 v116, 0, v116, vcc
    v_and_b32 v117, 2, v0
    v_cmp_eq_u32 vcc, 0, v117
    v_mov_b32 v142, 0
    v_mov_b32 v143, 0
    v_mov_b32 v144, 0
    v_mov_b32 v145, 0
    v_cndmask_b32 v140, 0, v116, vcc
    v_cndmask_b32 v146, 0, v116, vcc
    v_cndmask_b32 v141, v116, v142, vcc
    v_cndmask_b32 v147, v116, v142, vcc
    v_mul_f32 v244, s43, v168
    v_mul_f32 v245, s43, v169
    v_mul_f32 v246, s43, v170
    v_mul_f32 v247, s43, v171
    v_mul_f32 v248, s43, v184
    v_mul_f32 v249, s43, v185
    v_mul_f32 v250, s43, v186
    v_mul_f32 v251, s43, v187
    v_exp_f32 v244, v244 clamp
    v_max_f32 v168, s42, v168
    v_exp_f32 v245, v245 clamp
    v_max_f32 v169, s42, v169
    v_exp_f32 v246, v246 clamp
    v_max_f32 v170, s42, v170
    v_exp_f32 v247, v247 clamp
    v_max_f32 v171, s42, v171
    v_exp_f32 v248, v248 clamp
    v_max_f32 v184, s42, v184
    v_exp_f32 v249, v249 clamp
    v_max_f32 v185, s42, v185
    v_exp_f32 v250, v250 clamp
    v_max_f32 v186, s42, v186
    v_exp_f32 v251, v251 clamp
    v_max_f32 v187, s42, v187
    v_add_f32 v244, v244, v168
    v_add_f32 v245, v245, v169
    v_add_f32 v246, v246, v170
    v_add_f32 v247, v247, v171
    v_add_f32 v248, v248, v184
    v_add_f32 v249, v249, v185
    v_add_f32 v250, v250, v186
    v_add_f32 v251, v251, v187
    v_cvt_pk_bf16_f32 v84, v244, v245
    v_cvt_pk_bf16_f32 v85, v246, v247
    v_cvt_pk_bf16_f32 v86, v248, v249
    v_cvt_pk_bf16_f32 v87, v250, v251
    v_mul_f32 v244, s43, v172
    v_mul_f32 v245, s43, v173
    v_mul_f32 v246, s43, v174
    v_mul_f32 v247, s43, v175
    v_mul_f32 v248, s43, v188
    v_mul_f32 v249, s43, v189
    v_mul_f32 v250, s43, v190
    v_mul_f32 v251, s43, v191
    v_exp_f32 v244, v244 clamp
    v_max_f32 v172, s42, v172
    v_exp_f32 v245, v245 clamp
    v_max_f32 v173, s42, v173
    v_exp_f32 v246, v246 clamp
    v_max_f32 v174, s42, v174
    v_exp_f32 v247, v247 clamp
    v_max_f32 v175, s42, v175
    v_exp_f32 v248, v248 clamp
    v_max_f32 v188, s42, v188
    v_exp_f32 v249, v249 clamp
    v_max_f32 v189, s42, v189
    v_exp_f32 v250, v250 clamp
    v_max_f32 v190, s42, v190
    v_exp_f32 v251, v251 clamp
    v_max_f32 v191, s42, v191
    v_add_f32 v244, v244, v172
    v_add_f32 v245, v245, v173
    v_add_f32 v246, v246, v174
    v_add_f32 v247, v247, v175
    v_add_f32 v248, v248, v188
    v_add_f32 v249, v249, v189
    v_add_f32 v250, v250, v190
    v_add_f32 v251, v251, v191
    v_cvt_pk_bf16_f32 v88, v244, v245
    v_cvt_pk_bf16_f32 v89, v246, v247
    v_cvt_pk_bf16_f32 v90, v248, v249
    v_cvt_pk_bf16_f32 v91, v250, v251
    v_mul_f32 v244, s43, v176
    v_mul_f32 v245, s43, v177
    v_mul_f32 v246, s43, v178
    v_mul_f32 v247, s43, v179
    v_mul_f32 v248, s43, v192
    v_mul_f32 v249, s43, v193
    v_mul_f32 v250, s43, v194
    v_mul_f32 v251, s43, v195
    v_exp_f32 v244, v244 clamp
    v_max_f32 v176, s42, v176
    v_exp_f32 v245, v245 clamp
    v_max_f32 v177, s42, v177
    v_exp_f32 v246, v246 clamp
    v_max_f32 v178, s42, v178
    v_exp_f32 v247, v247 clamp
    v_max_f32 v179, s42, v179
    v_exp_f32 v248, v248 clamp
    v_max_f32 v192, s42, v192
    v_exp_f32 v249, v249 clamp
    v_max_f32 v193, s42, v193
    v_exp_f32 v250, v250 clamp
    v_max_f32 v194, s42, v194
    v_exp_f32 v251, v251 clamp
    v_max_f32 v195, s42, v195
    v_add_f32 v244, v244, v176
    v_add_f32 v245, v245, v177
    v_add_f32 v246, v246, v178
    v_add_f32 v247, v247, v179
    v_add_f32 v248, v248, v192
    v_add_f32 v249, v249, v193
    v_add_f32 v250, v250, v194
    v_add_f32 v251, v251, v195
    v_cvt_pk_bf16_f32 v92, v244, v245
    v_cvt_pk_bf16_f32 v93, v246, v247
    v_cvt_pk_bf16_f32 v94, v248, v249
    v_cvt_pk_bf16_f32 v95, v250, v251
    s_mov_b32 s17, 1
    s_waitcnt vmcnt(0)
    s_atomic_add s17, s[10:11], 0 glc
    v_mul_f32 v244, s43, v180
    v_mul_f32 v245, s43, v181
    v_mul_f32 v246, s43, v182
    v_mul_f32 v247, s43, v183
    v_mul_f32 v248, s43, v196
    v_mul_f32 v249, s43, v197
    v_mul_f32 v250, s43, v198
    v_mul_f32 v251, s43, v199
    v_exp_f32 v244, v244 clamp
    v_max_f32 v180, s42, v180
    v_exp_f32 v245, v245 clamp
    v_max_f32 v181, s42, v181
    v_exp_f32 v246, v246 clamp
    v_max_f32 v182, s42, v182
    v_exp_f32 v247, v247 clamp
    v_max_f32 v183, s42, v183
    v_exp_f32 v248, v248 clamp
    v_max_f32 v196, s42, v196
    v_exp_f32 v249, v249 clamp
    v_max_f32 v197, s42, v197
    v_exp_f32 v250, v250 clamp
    v_max_f32 v198, s42, v198
    v_exp_f32 v251, v251 clamp
    v_max_f32 v199, s42, v199
    v_add_f32 v244, v244, v180
    v_add_f32 v245, v245, v181
    v_add_f32 v246, v246, v182
    v_add_f32 v247, v247, v183
    v_add_f32 v248, v248, v196
    v_add_f32 v249, v249, v197
    v_add_f32 v250, v250, v198
    v_add_f32 v251, v251, v199
    v_cvt_pk_bf16_f32 v96, v244, v245
    v_cvt_pk_bf16_f32 v97, v246, v247
    v_cvt_pk_bf16_f32 v98, v248, v249
    v_cvt_pk_bf16_f32 v99, v250, v251
    s_waitcnt lgkmcnt(0)
    s_cmp_ge_u32 s17, 15
    s_cbranch_scc1 F_P2_X
    s_mov_b32 s45, 0
F_P2:
    s_mov_b32 s17, 0
    s_atomic_add s17, s[10:11], 0 glc
    s_waitcnt lgkmcnt(0)
    s_cmp_ge_u32 s17, 16
    s_cbranch_scc1 F_P2_X
    s_sleep 3
    s_add_u32 s45, s45, 1
    s_cmp_lt_u32 s45, 400000
    s_cbranch_scc1 F_P2
F_P2_X:
    buffer_load_dwordx4 v[100:103], v13, s[36:39], s54 offen sc1
    s_lshl_b32 s59, s30, 12
    s_and_b32 s59, s59, 0x7fff
    s_add_u32 s40, s59, s53
    buffer_load_dwordx4 v[16:19], v1, s[36:39], s40 offen offset:0 sc1
    buffer_load_dwordx4 v[20:23], v1, s[36:39], s40 offen offset:2048 sc1
    s_add_u32 s59, s59, 4096
    s_and_b32 s59, s59, 0x7fff
    s_add_u32 s40, s59, s53
    buffer_load_dwordx4 v[24:27], v1, s[36:39], s40 offen offset:0 sc1
    buffer_load_dwordx4 v[28:31], v1, s[36:39], s40 offen offset:2048 sc1
    s_add_u32 s59, s59, 4096
    s_and_b32 s59, s59, 0x7fff
    s_add_u32 s40, s59, s53
    buffer_load_dwordx4 v[32:35], v1, s[36:39], s40 offen offset:0 sc1
    buffer_load_dwordx4 v[36:39], v1, s[36:39], s40 offen offset:2048 sc1
    s_add_u32 s59, s59, 4096
    s_and_b32 s59, s59, 0x7fff
    s_add_u32 s40, s59, s53
    buffer_load_dwordx4 v[40:43], v1, s[36:39], s40 offen offset:0 sc1
    buffer_load_dwordx4 v[44:47], v1, s[36:39], s40 offen offset:2048 sc1
    s_add_u32 s59, s59, 4096
    s_and_b32 s59, s59, 0x7fff
    s_add_u32 s40, s59, s53
    buffer_load_dwordx4 v[48:51], v1, s[36:39], s40 offen offset:0 sc1
    buffer_load_dwordx4 v[52:55], v1, s[36:39], s40 offen offset:2048 sc1
    s_add_u32 s59, s59, 4096
    s_and_b32 s59, s59, 0x7fff
    s_add_u32 s40, s59, s53
    buffer_load_dwordx4 v[56:59], v1, s[36:39], s40 offen offset:0 sc1
    buffer_load_dwordx4 v[60:63], v1, s[36:39], s40 offen offset:2048 sc1
    s_add_u32 s59, s59, 4096
    s_and_b32 s59, s59, 0x7fff
    s_add_u32 s40, s59, s53
    buffer_load_dwordx4 v[64:67], v1, s[36:39], s40 offen offset:0 sc1
    buffer_load_dwordx4 v[68:71], v1, s[36:39], s40 offen offset:2048 sc1
    s_add_u32 s59, s59, 4096
    s_and_b32 s59, s59, 0x7fff
    s_add_u32 s40, s59, s53
    buffer_load_dwordx4 v[72:75], v1, s[36:39], s40 offen offset:0 sc1
    buffer_load_dwordx4 v[76:79], v1, s[36:39], s40 offen offset:2048 sc1
    s_waitcnt vmcnt(14)
    v_mfma_f32_16x16x32_bf16 v[104:107], v[140:143], v[16:19], 0
    v_add_f32_dpp v120, v100, v100 row_ror:8 row_mask:0xf bank_mask:0xf
    v_mfma_f32_16x16x32_bf16 v[108:111], v[144:147], v[16:19], 0
    v_add_f32_dpp v121, v101, v101 row_ror:8 row_mask:0xf bank_mask:0xf
    v_mfma_f32_16x16x32_bf16 v[148:151], v[140:143], v[20:23], 0
    v_add_f32_dpp v122, v102, v102 row_ror:8 row_mask:0xf bank_mask:0xf
    v_mfma_f32_16x16x32_bf16 v[152:155], v[144:147], v[20:23], 0
    v_add_f32_dpp v123, v103, v103 row_ror:8 row_mask:0xf bank_mask:0xf
    s_waitcnt vmcnt(12)
    v_mfma_f32_16x16x32_bf16 v[104:107], v[140:143], v[24:27], v[104:107]
    v_add_f32_dpp v120, v120, v120 row_ror:4 row_mask:0xf bank_mask:0xf
    v_mfma_f32_16x16x32_bf16 v[108:111], v[144:147], v[24:27], v[108:111]
    v_add_f32_dpp v121, v121, v121 row_ror:4 row_mask:0xf bank_mask:0xf
    v_mfma_f32_16x16x32_bf16 v[148:151], v[140:143], v[28:31], v[148:151]
    v_add_f32_dpp v122, v122, v122 row_ror:4 row_mask:0xf bank_mask:0xf
    v_mfma_f32_16x16x32_bf16 v[152:155], v[144:147], v[28:31], v[152:155]
    v_add_f32_dpp v123, v123, v123 row_ror:4 row_mask:0xf bank_mask:0xf
    s_waitcnt vmcnt(10)
    v_mfma_f32_16x16x32_bf16 v[104:107], v[140:143], v[32:35], v[104:107]
    v_add_f32_dpp v120, v120, v120 row_ror:2 row_mask:0xf bank_mask:0xf
    v_mfma_f32_16x16x32_bf16 v[108:111], v[144:147], v[32:35], v[108:111]
    v_add_f32_dpp v121, v121, v121 row_ror:2 row_mask:0xf bank_mask:0xf
    v_mfma_f32_16x16x32_bf16 v[148:151], v[140:143], v[36:39], v[148:151]
    v_add_f32_dpp v122, v122, v122 row_ror:2 row_mask:0xf bank_mask:0xf
    v_mfma_f32_16x16x32_bf16 v[152:155], v[144:147], v[36:39], v[152:155]
    v_add_f32_dpp v123, v123, v123 row_ror:2 row_mask:0xf bank_mask:0xf
    s_waitcnt vmcnt(8)
    v_mfma_f32_16x16x32_bf16 v[104:107], v[140:143], v[40:43], v[104:107]
    v_add_f32_dpp v120, v120, v120 row_ror:1 row_mask:0xf bank_mask:0xf
    v_mfma_f32_16x16x32_bf16 v[108:111], v[144:147], v[40:43], v[108:111]
    v_add_f32_dpp v121, v121, v121 row_ror:1 row_mask:0xf bank_mask:0xf
    v_mfma_f32_16x16x32_bf16 v[148:151], v[140:143], v[44:47], v[148:151]
    v_add_f32_dpp v122, v122, v122 row_ror:1 row_mask:0xf bank_mask:0xf
    v_mfma_f32_16x16x32_bf16 v[152:155], v[144:147], v[44:47], v[152:155]
    v_add_f32_dpp v123, v123, v123 row_ror:1 row_mask:0xf bank_mask:0xf
    s_waitcnt vmcnt(6)
    v_mfma_f32_16x16x32_bf16 v[104:107], v[140:143], v[48:51], v[104:107]
    v_cvt_pk_bf16_f32 v132, v120, v121
    v_mfma_f32_16x16x32_bf16 v[108:111], v[144:147], v[48:51], v[108:111]
    v_cvt_pk_bf16_f32 v133, v122, v123
    v_mfma_f32_16x16x32_bf16 v[148:151], v[140:143], v[52:55], v[148:151]
    v_mfma_f32_16x16x32_bf16 v[152:155], v[144:147], v[52:55], v[152:155]
    s_waitcnt vmcnt(4)
    v_mfma_f32_16x16x32_bf16 v[104:107], v[140:143], v[56:59], v[104:107]
    v_mfma_f32_16x16x32_bf16 v[108:111], v[144:147], v[56:59], v[108:111]
    v_mfma_f32_16x16x32_bf16 v[148:151], v[140:143], v[60:63], v[148:151]
    v_mfma_f32_16x16x32_bf16 v[152:155], v[144:147], v[60:63], v[152:155]
    s_waitcnt vmcnt(2)
    v_mfma_f32_16x16x32_bf16 v[104:107], v[140:143], v[64:67], v[104:107]
    v_mfma_f32_16x16x32_bf16 v[108:111], v[144:147], v[64:67], v[108:111]
    v_mfma_f32_16x16x32_bf16 v[148:151], v[140:143], v[68:71], v[148:151]
    v_mfma_f32_16x16x32_bf16 v[152:155], v[144:147], v[68:71], v[152:155]
    s_waitcnt vmcnt(0)
    v_mfma_f32_16x16x32_bf16 v[104:107], v[140:143], v[72:75], v[104:107]
    v_mfma_f32_16x16x32_bf16 v[108:111], v[144:147], v[72:75], v[108:111]
    v_mfma_f32_16x16x32_bf16 v[148:151], v[140:143], v[76:79], v[148:151]
    v_mfma_f32_16x16x32_bf16 v[152:155], v[144:147], v[76:79], v[152:155]
    s_nop 6
    v_add_f32 v104, v104, v148
    v_add_f32 v105, v105, v149
    v_add_f32 v106, v106, v150
    v_add_f32 v107, v107, v151
    v_add_f32 v108, v108, v152
    v_add_f32 v109, v109, v153
    v_add_f32 v110, v110, v154
    v_add_f32 v111, v111, v155
F_K2X:
    v_cvt_pk_bf16_f32 v136, v104, v105
    v_cvt_pk_bf16_f32 v137, v106, v107
    v_cvt_pk_bf16_f32 v138, v108, v109
    v_cvt_pk_bf16_f32 v139, v110, v111
    ds_write_b128 v7, v[136:139]
    ds_write_b64 v9, v[132:133] offset:2048
    ds_write_b32 v10, v14 offset:4
F_XB:
    ds_read_b32 v15, v11 offset:4
    ds_read_b64 v[134:135], v8 offset:2048
    ds_read_b64 v[124:125], v200
    ds_read_b64 v[126:127], v201
    ds_read_b64 v[128:129], v202
    ds_read_b64 v[130:131], v203
    s_waitcnt lgkmcnt(0)
    v_cmp_ne_u32 vcc, 1, v15
    s_cbranch_vccnz F_XB
    v_mfma_f32_16x16x32_bf16 v[140:143], v[132:135], v[84:87], v[112:115]
    v_mfma_f32_16x16x32_bf16 v[144:147], v[132:135], v[88:91], v[112:115]
    v_mfma_f32_16x16x32_bf16 v[148:151], v[132:135], v[92:95], v[112:115]
    v_mfma_f32_16x16x32_bf16 v[152:155], v[132:135], v[96:99], v[112:115]
    v_mfma_f32_16x16x32_bf16 v[156:159], v[124:127], v[84:87], 0
    v_mfma_f32_16x16x32_bf16 v[160:163], v[128:131], v[84:87], 0
    v_mfma_f32_16x16x32_bf16 v[164:167], v[124:127], v[88:91], 0
    v_mfma_f32_16x16x32_bf16 v[168:171], v[128:131], v[88:91], 0
    v_mfma_f32_16x16x32_bf16 v[172:175], v[124:127], v[92:95], 0
    v_mfma_f32_16x16x32_bf16 v[176:179], v[128:131], v[92:95], 0
    v_mfma_f32_16x16x32_bf16 v[180:183], v[124:127], v[96:99], 0
    v_mfma_f32_16x16x32_bf16 v[184:187], v[128:131], v[96:99], 0
    ds_write_b32 v206, v14
    s_mov_b32 s17, 0
    s_atomic_add s17, s[14:15], 0 glc
    ds_read_b32 v10, v211
    v_rcp_f32 v140, v140
    v_rcp_f32 v144, v144
    v_rcp_f32 v148, v148
    v_rcp_f32 v152, v152
    v_mul_f32 v156, v156, v140
    v_mul_f32 v157, v157, v140
    v_mul_f32 v158, v158, v140
    v_mul_f32 v159, v159, v140
    v_mul_f32 v160, v160, v140
    v_mul_f32 v161, v161, v140
    v_mul_f32 v162, v162, v140
    v_mul_f32 v163, v163, v140
    v_cvt_pk_bf16_f32 v212, v156, v157
    v_cvt_pk_bf16_f32 v213, v158, v159
    v_cvt_pk_bf16_f32 v214, v160, v161
    v_cvt_pk_bf16_f32 v215, v162, v163
    buffer_store_dwordx4 v[212:215], v1, s[36:39], s52 offen sc1
    s_add_u32 s52, s52, 33792
    v_mul_f32 v164, v164, v144
    v_mul_f32 v165, v165, v144
    v_mul_f32 v166, v166, v144
    v_mul_f32 v167, v167, v144
    v_mul_f32 v168, v168, v144
    v_mul_f32 v169, v169, v144
    v_mul_f32 v170, v170, v144
    v_mul_f32 v171, v171, v144
    v_cvt_pk_bf16_f32 v216, v164, v165
    v_cvt_pk_bf16_f32 v217, v166, v167
    v_cvt_pk_bf16_f32 v218, v168, v169
    v_cvt_pk_bf16_f32 v219, v170, v171
    buffer_store_dwordx4 v[216:219], v1, s[36:39], s52 offen sc1
    s_add_u32 s52, s52, 33792
    v_mul_f32 v172, v172, v148
    v_mul_f32 v173, v173, v148
    v_mul_f32 v174, v174, v148
    v_mul_f32 v175, v175, v148
    v_mul_f32 v176, v176, v148
    v_mul_f32 v177, v177, v148
    v_mul_f32 v178, v178, v148
    v_mul_f32 v179, v179, v148
    v_cvt_pk_bf16_f32 v220, v172, v173
    v_cvt_pk_bf16_f32 v221, v174, v175
    v_cvt_pk_bf16_f32 v222, v176, v177
    v_cvt_pk_bf16_f32 v223, v178, v179
    buffer_store_dwordx4 v[220:223], v1, s[36:39], s52 offen sc1
    s_add_u32 s52, s52, 33792
    v_mul_f32 v180, v180, v152
    v_mul_f32 v181, v181, v152
    v_mul_f32 v182, v182, v152
    v_mul_f32 v183, v183, v152
    v_mul_f32 v184, v184, v152
    v_mul_f32 v185, v185, v152
    v_mul_f32 v186, v186, v152
    v_mul_f32 v187, v187, v152
    v_cvt_pk_bf16_f32 v224, v180, v181
    v_cvt_pk_bf16_f32 v225, v182, v183
    v_cvt_pk_bf16_f32 v226, v184, v185
    v_cvt_pk_bf16_f32 v227, v186, v187
    buffer_store_dwordx4 v[224:227], v1, s[36:39], s52 offen sc1
    v_add_u32 v6, 33792, v1
    s_mov_b32 s46, 0x11111111
    s_mov_b32 s50, -1
    s_mov_b32 s51, -1
    v_mov_b32 v16, 0
    v_mov_b32 v17, 0
    v_mov_b32 v18, 0
    v_mov_b32 v19, 0
    v_mov_b32 v20, 0
    v_mov_b32 v21, 0
    v_mov_b32 v22, 0
    v_mov_b32 v23, 0
    v_mov_b32 v24, 0
    v_mov_b32 v25, 0
    v_mov_b32 v26, 0
    v_mov_b32 v27, 0
    v_mov_b32 v28, 0
    v_mov_b32 v29, 0
    v_mov_b32 v30, 0
    v_mov_b32 v31, 0
    v_mov_b32 v32, 0
    v_mov_b32 v33, 0
    v_mov_b32 v34, 0
    v_mov_b32 v35, 0
    v_mov_b32 v36, 0
    v_mov_b32 v37, 0
    v_mov_b32 v38, 0
    v_mov_b32 v39, 0
    v_mov_b32 v40, 0
    v_mov_b32 v41, 0
    v_mov_b32 v42, 0
    v_mov_b32 v43, 0
    v_mov_b32 v44, 0
    v_mov_b32 v45, 0
    v_mov_b32 v46, 0
    v_mov_b32 v47, 0
    s_mov_b32 s47, 0
    s_mov_b32 s54, 0x76432105
    s_mov_b32 s44, 0
    s_mov_b32 s58, 0
    s_mov_b32 s18, 1
    s_branch F_GR0
.p2align 6
F_GLOOP:
    s_cmp_lt_i32 s50, 0
    s_cbranch_scc1 F_GE0
F_GC0:
F_GK0:
    s_waitcnt vmcnt(14) lgkmcnt(0)
    v_mfma_f32_16x16x32_bf16 v[16:19], v[48:51], v[80:83], v[16:19]
    ds_read_b64_tr_b16 v[64:65], v2 offset:4096
    ds_read_b64_tr_b16 v[66:67], v2 offset:6144
    v_mfma_f32_16x16x32_bf16 v[32:35], v[48:51], v[84:87], v[32:35]
    ds_read_b64_tr_b16 v[68:69], v3 offset:4096
    ds_read_b64_tr_b16 v[70:71], v3 offset:6144
    v_mfma_f32_16x16x32_bf16 v[20:23], v[52:55], v[80:83], v[20:23]
    ds_read_b64_tr_b16 v[72:73], v4 offset:4096
    ds_read_b64_tr_b16 v[74:75], v4 offset:6144
    v_mfma_f32_16x16x32_bf16 v[36:39], v[52:55], v[84:87], v[36:39]
    ds_read_b64_tr_b16 v[76:77], v5 offset:4096
    ds_read_b64_tr_b16 v[78:79], v5 offset:6144
    v_mfma_f32_16x16x32_bf16 v[24:27], v[56:59], v[80:83], v[24:27]
    v_mfma_f32_16x16x32_bf16 v[40:43], v[56:59], v[84:87], v[40:43]
    v_mfma_f32_16x16x32_bf16 v[28:31], v[60:63], v[80:83], v[28:31]
    v_mfma_f32_16x16x32_bf16 v[44:47], v[60:63], v[84:87], v[44:47]
    s_and_b32 s45, s46, s47
    s_cbranch_scc0 F_GP0
F_GQ0:
    s_waitcnt vmcnt(12) lgkmcnt(0)
    v_mfma_f32_16x16x32_bf16 v[16:19], v[64:67], v[88:91], v[16:19]
    ds_read_b64_tr_b16 v[48:49], v2 offset:8192
    ds_read_b64_tr_b16 v[50:51], v2 offset:10240
    s_and_b32 s45, s46, s47
    v_mfma_f32_16x16x32_bf16 v[32:35], v[64:67], v[92:95], v[32:35]
    ds_read_b64_tr_b16 v[52:53], v3 offset:8192
    ds_read_b64_tr_b16 v[54:55], v3 offset:10240
    s_cselect_b32 s66, s38, 0
    v_mfma_f32_16x16x32_bf16 v[20:23], v[68:71], v[88:91], v[20:23]
    ds_read_b64_tr_b16 v[56:57], v4 offset:8192
    ds_read_b64_tr_b16 v[58:59], v4 offset:10240
    s_ff1_i32_b32 s50, s45
    v_mfma_f32_16x16x32_bf16 v[36:39], v[68:71], v[92:95], v[36:39]
    ds_read_b64_tr_b16 v[60:61], v5 offset:8192
    ds_read_b64_tr_b16 v[62:63], v5 offset:10240
    s_lshl_b32 s52, s50, 10
    v_mfma_f32_16x16x32_bf16 v[24:27], v[72:75], v[88:91], v[24:27]
    s_add_u32 s52, s52, s55
    s_bitset0_b32 s46, s50
    v_mfma_f32_16x16x32_bf16 v[40:43], v[72:75], v[92:95], v[40:43]
    buffer_load_dwordx4 v[80:83], v1, s[64:67], s52 offen offset:0 sc1
    s_lshr_b32 s48, s54, s51
    v_mfma_f32_16x16x32_bf16 v[28:31], v[76:79], v[88:91], v[28:31]
    buffer_load_dwordx4 v[84:87], v6, s[64:67], s52 offen offset:0 sc1
    s_and_b32 s48, s48, 15
    v_mfma_f32_16x16x32_bf16 v[44:47], v[76:79], v[92:95], v[44:47]
    s_lshl_b32 s48, s48, 14
    s_waitcnt vmcnt(12) lgkmcnt(0)
    v_mfma_f32_16x16x32_bf16 v[16:19], v[48:51], v[96:99], v[16:19]
    ds_read_b64_tr_b16 v[64:65], v2 offset:12288
    ds_read_b64_tr_b16 v[66:67], v2 offset:14336
    v_mfma_f32_16x16x32_bf16 v[32:35], v[48:51], v[100:103], v[32:35]
    ds_read_b64_tr_b16 v[68:69], v3 offset:12288
    ds_read_b64_tr_b16 v[70:71], v3 offset:14336
    v_mfma_f32_16x16x32_bf16 v[20:23], v[52:55], v[96:99], v[20:23]
    ds_read_b64_tr_b16 v[72:73], v4 offset:12288
    ds_read_b64_tr_b16 v[74:75], v4 offset:14336
    v_mfma_f32_16x16x32_bf16 v[36:39], v[52:55], v[100:103], v[36:39]
    ds_read_b64_tr_b16 v[76:77], v5 offset:12288
    ds_read_b64_tr_b16 v[78:79], v5 offset:14336
    v_mfma_f32_16x16x32_bf16 v[24:27], v[56:59], v[96:99], v[24:27]
    buffer_load_dwordx4 v[88:91], v1, s[64:67], s52 offen offset:1024 sc1
    v_add_u32 v2, s48, v207
    v_mfma_f32_16x16x32_bf16 v[40:43], v[56:59], v[100:103], v[40:43]
    buffer_load_dwordx4 v[92:95], v6, s[64:67], s52 offen offset:1024 sc1
    v_xor_b32 v3, 32, v2
    v_mfma_f32_16x16x32_bf16 v[28:31], v[60:63], v[96:99], v[28:31]
    v_xor_b32 v4, 64, v2
    v_xor_b32 v5, 96, v2
    v_mfma_f32_16x16x32_bf16 v[44:47], v[60:63], v[100:103], v[44:47]
    s_waitcnt vmcnt(12) lgkmcnt(0)
    v_mfma_f32_16x16x32_bf16 v[16:19], v[64:67], v[104:107], v[16:19]
    ds_read_b64_tr_b16 v[48:49], v2 offset:0
    ds_read_b64_tr_b16 v[50:51], v2 offset:2048
    v_mfma_f32_16x16x32_bf16 v[32:35], v[64:67], v[108:111], v[32:35]
    ds_read_b64_tr_b16 v[52:53], v3 offset:0
    ds_read_b64_tr_b16 v[54:55], v3 offset:2048
    v_mfma_f32_16x16x32_bf16 v[20:23], v[68:71], v[104:107], v[20:23]
    ds_read_b64_tr_b16 v[56:57], v4 offset:0
    ds_read_b64_tr_b16 v[58:59], v4 offset:2048
    v_mfma_f32_16x16x32_bf16 v[36:39], v[68:71], v[108:111], v[36:39]
    ds_read_b64_tr_b16 v[60:61], v5 offset:0
    ds_read_b64_tr_b16 v[62:63], v5 offset:2048
    v_mfma_f32_16x16x32_bf16 v[24:27], v[72:75], v[104:107], v[24:27]
    buffer_load_dwordx4 v[96:99], v1, s[64:67], s52 offen offset:2048 sc1
    v_mfma_f32_16x16x32_bf16 v[40:43], v[72:75], v[108:111], v[40:43]
    buffer_load_dwordx4 v[100:103], v6, s[64:67], s52 offen offset:2048 sc1
    v_mfma_f32_16x16x32_bf16 v[28:31], v[76:79], v[104:107], v[28:31]
    v_mfma_f32_16x16x32_bf16 v[44:47], v[76:79], v[108:111], v[44:47]
    buffer_load_dwordx4 v[104:107], v1, s[64:67], s52 offen offset:3072 sc1
    buffer_load_dwordx4 v[108:111], v6, s[64:67], s52 offen offset:3072 sc1
    s_cmp_lt_i32 s51, 0
    s_cbranch_scc1 F_GE1
F_GC1:
F_GK1:
    s_waitcnt vmcnt(14) lgkmcnt(0)
    v_mfma_f32_16x16x32_bf16 v[16:19], v[48:51], v[112:115], v[16:19]
    ds_read_b64_tr_b16 v[64:65], v2 offset:4096
    ds_read_b64_tr_b16 v[66:67], v2 offset:6144
    v_mfma_f32_16x16x32_bf16 v[32:35], v[48:51], v[116:119], v[32:35]
    ds_read_b64_tr_b16 v[68:69], v3 offset:4096
    ds_read_b64_tr_b16 v[70:71], v3 offset:6144
    v_mfma_f32_16x16x32_bf16 v[20:23], v[52:55], v[112:115], v[20:23]
    ds_read_b64_tr_b16 v[72:73], v4 offset:4096
    ds_read_b64_tr_b16 v[74:75], v4 offset:6144
    v_mfma_f32_16x16x32_bf16 v[36:39], v[52:55], v[116:119], v[36:39]
    ds_read_b64_tr_b16 v[76:77], v5 offset:4096
    ds_read_b64_tr_b16 v[78:79], v5 offset:6144
    v_mfma_f32_16x16x32_bf16 v[24:27], v[56:59], v[112:115], v[24:27]
    v_mfma_f32_16x16x32_bf16 v[40:43], v[56:59], v[116:119], v[40:43]
    v_mfma_f32_16x16x32_bf16 v[28:31], v[60:63], v[112:115], v[28:31]
    v_mfma_f32_16x16x32_bf16 v[44:47], v[60:63], v[116:119], v[44:47]
    s_and_b32 s45, s46, s47
    s_cbranch_scc0 F_GP1
F_GQ1:
    s_waitcnt vmcnt(12) lgkmcnt(0)
    v_mfma_f32_16x16x32_bf16 v[16:19], v[64:67], v[120:123], v[16:19]
    ds_read_b64_tr_b16 v[48:49], v2 offset:8192
    ds_read_b64_tr_b16 v[50:51], v2 offset:10240
    s_and_b32 s45, s46, s47
    v_mfma_f32_16x16x32_bf16 v[32:35], v[64:67], v[124:127], v[32:35]
    ds_read_b64_tr_b16 v[52:53], v3 offset:8192
    ds_read_b64_tr_b16 v[54:55], v3 offset:10240
    s_cselect_b32 s66, s38, 0
    v_mfma_f32_16x16x32_bf16 v[20:23], v[68:71], v[120:123], v[20:23]
    ds_read_b64_tr_b16 v[56:57], v4 offset:8192
    ds_read_b64_tr_b16 v[58:59], v4 offset:10240
    s_ff1_i32_b32 s51, s45
    v_mfma_f32_16x16x32_bf16 v[36:39], v[68:71], v[124:127], v[36:39]
    ds_read_b64_tr_b16 v[60:61], v5 offset:8192
    ds_read_b64_tr_b16 v[62:63], v5 offset:10240
    s_lshl_b32 s53, s51, 10
    v_mfma_f32_16x16x32_bf16 v[24:27], v[72:75], v[120:123], v[24:27]
    s_add_u32 s53, s53, s55
    s_bitset0_b32 s46, s51
    v_mfma_f32_16x16x32_bf16 v[40:43], v[72:75], v[124:127], v[40:43]
    buffer_load_dwordx4 v[112:115], v1, s[64:67], s53 offen offset:0 sc1
    s_lshr_b32 s48, s54, s50
    v_mfma_f32_16x16x32_bf16 v[28:31], v[76:79], v[120:123], v[28:31]
    buffer_load_dwordx4 v[116:119], v6, s[64:67], s53 offen offset:0 sc1
    s_and_b32 s48, s48, 15
    v_mfma_f32_16x16x32_bf16 v[44:47], v[76:79], v[124:127], v[44:47]
    s_lshl_b32 s48, s48, 14
    s_waitcnt vmcnt(12) lgkmcnt(0)
    v_mfma_f32_16x16x32_bf16 v[16:19], v[48:51], v[128:131], v[16:19]
    ds_read_b64_tr_b16 v[64:65], v2 offset:12288
    ds_read_b64_tr_b16 v[66:67], v2 offset:14336
    v_mfma_f32_16x16x32_bf16 v[32:35], v[48:51], v[132:135], v[32:35]
    ds_read_b64_tr_b16 v[68:69], v3 offset:12288
    ds_read_b64_tr_b16 v[70:71], v3 offset:14336
    v_mfma_f32_16x16x32_bf16 v[20:23], v[52:55], v[128:131], v[20:23]
    ds_read_b64_tr_b16 v[72:73], v4 offset:12288
    ds_read_b64_tr_b16 v[74:75], v4 offset:14336
    v_mfma_f32_16x16x32_bf16 v[36:39], v[52:55], v[132:135], v[36:39]
    ds_read_b64_tr_b16 v[76:77], v5 offset:12288
    ds_read_b64_tr_b16 v[78:79], v5 offset:14336
    v_mfma_f32_16x16x32_bf16 v[24:27], v[56:59], v[128:131], v[24:27]
    buffer_load_dwordx4 v[120:123], v1, s[64:67], s53 offen offset:1024 sc1
    v_add_u32 v2, s48, v207
    v_mfma_f32_16x16x32_bf16 v[40:43], v[56:59], v[132:135], v[40:43]
    buffer_load_dwordx4 v[124:127], v6, s[64:67], s53 offen offset:1024 sc1
    v_xor_b32 v3, 32, v2
    v_mfma_f32_16x16x32_bf16 v[28:31], v[60:63], v[128:131], v[28:31]
    v_xor_b32 v4, 64, v2
    v_xor_b32 v5, 96, v2
    v_mfma_f32_16x16x32_bf16 v[44:47], v[60:63], v[132:135], v[44:47]
    s_waitcnt vmcnt(12) lgkmcnt(0)
    v_mfma_f32_16x16x32_bf16 v[16:19], v[64:67], v[136:139], v[16:19]
    ds_read_b64_tr_b16 v[48:49], v2 offset:0
    ds_read_b64_tr_b16 v[50:51], v2 offset:2048
    v_mfma_f32_16x16x32_bf16 v[32:35], v[64:67], v[140:143], v[32:35]
    ds_read_b64_tr_b16 v[52:53], v3 offset:0
    ds_read_b64_tr_b16 v[54:55], v3 offset:2048
    v_mfma_f32_16x16x32_bf16 v[20:23], v[68:71], v[136:139], v[20:23]
    ds_read_b64_tr_b16 v[56:57], v4 offset:0
    ds_read_b64_tr_b16 v[58:59], v4 offset:2048
    v_mfma_f32_16x16x32_bf16 v[36:39], v[68:71], v[140:143], v[36:39]
    ds_read_b64_tr_b16 v[60:61], v5 offset:0
    ds_read_b64_tr_b16 v[62:63], v5 offset:2048
    v_mfma_f32_16x16x32_bf16 v[24:27], v[72:75], v[136:139], v[24:27]
    buffer_load_dwordx4 v[128:131], v1, s[64:67], s53 offen offset:2048 sc1
    v_mfma_f32_16x16x32_bf16 v[40:43], v[72:75], v[140:143], v[40:43]
    buffer_load_dwordx4 v[132:135], v6, s[64:67], s53 offen offset:2048 sc1
    v_mfma_f32_16x16x32_bf16 v[28:31], v[76:79], v[136:139], v[28:31]
    v_mfma_f32_16x16x32_bf16 v[44:47], v[76:79], v[140:143], v[44:47]
    buffer_load_dwordx4 v[136:139], v1, s[64:67], s53 offen offset:3072 sc1
    buffer_load_dwordx4 v[140:143], v6, s[64:67], s53 offen offset:3072 sc1
    s_add_u32 s44, s44, 1
    s_cmp_lt_u32 s44, 4
    s_cbranch_scc1 F_GLOOP
    s_add_u32 s57, s56, 65536
    s_waitcnt lgkmcnt(0)
    v_cvt_pk_bf16_f32 v48, v16, v17
    v_cvt_pk_bf16_f32 v49, v18, v19
    v_cvt_pk_bf16_f32 v50, v20, v21
    v_cvt_pk_bf16_f32 v51, v22, v23
    v_cvt_pk_bf16_f32 v52, v24, v25
    v_cvt_pk_bf16_f32 v53, v26, v27
    v_cvt_pk_bf16_f32 v54, v28, v29
    v_cvt_pk_bf16_f32 v55, v30, v31
    v_cvt_pk_bf16_f32 v56, v32, v33
    v_cvt_pk_bf16_f32 v57, v34, v35
    v_cvt_pk_bf16_f32 v58, v36, v37
    v_cvt_pk_bf16_f32 v59, v38, v39
    v_cvt_pk_bf16_f32 v60, v40, v41
    v_cvt_pk_bf16_f32 v61, v42, v43
    v_cvt_pk_bf16_f32 v62, v44, v45
    v_cvt_pk_bf16_f32 v63, v46, v47
    v_permlane16_swap_b32 v48, v50
    v_permlane16_swap_b32 v49, v51
    buffer_store_dwordx4 v[48:51], v210, s[60:63], s56 offen offset:0 sc1
    v_permlane16_swap_b32 v52, v54
    v_permlane16_swap_b32 v53, v55
    buffer_store_dwordx4 v[52:55], v210, s[60:63], s56 offen offset:64 sc1
    v_permlane16_swap_b32 v56, v58
    v_permlane16_swap_b32 v57, v59
    buffer_store_dwordx4 v[56:59], v210, s[60:63], s57 offen offset:0 sc1
    v_permlane16_swap_b32 v60, v62
    v_permlane16_swap_b32 v61, v63
    buffer_store_dwordx4 v[60:63], v210, s[60:63], s57 offen offset:64 sc1
    s_endpgm
F_CNB0:
    ds_write_b32 v204, v14 offset:32
F_WS15:
    ds_read_b32 v15, v209 offset:128
    s_waitcnt lgkmcnt(0)
    v_cmp_ne_u32 vcc, 1, v15
    s_cbranch_vccz F_WS15_X
    s_branch F_WS15
F_WS15_X:
    s_branch F_CB0
F_CNB1:
    ds_write_b32 v204, v14
    s_branch F_CB1
F_GP0:
    s_cmp_eq_u32 s46, 0
    s_cbranch_scc1 F_GQ0
    s_cmp_lt_i32 s51, 0
    s_cbranch_scc1 F_GQ0
    s_mov_b32 s17, 0
    s_atomic_add s17, s[14:15], 0 glc
    ds_read_b32 v10, v211
    s_waitcnt lgkmcnt(0)
    v_cmp_ne_u32 s[40:41], 1, v10
    s_lshr_b32 s17, s17, 2
    s_or_b32 s45, s40, s41
    s_lshr_b32 s40, s45, 1
    s_or_b32 s45, s45, s40
    s_lshr_b32 s40, s45, 2
    s_or_b32 s45, s45, s40
    s_andn2_b32 s47, s17, s45
    s_cmp_gt_u32 s58, 400000
    s_cselect_b32 s47, -1, s47
    s_and_b32 s47, s47, s46
    s_branch F_GQ0
F_GS0:
    s_cmp_eq_u32 s18, 0
    s_cbranch_scc1 F_GT0
    s_waitcnt vmcnt(0)
    s_atomic_add s16, s[12:13], 0
    s_mov_b32 s18, 0
F_GT0:
    s_sleep 6
F_GE0:
    s_add_u32 s58, s58, 1
    s_mov_b32 s17, 0
    s_atomic_add s17, s[14:15], 0 glc
    ds_read_b32 v10, v211
F_GR0:
    s_waitcnt lgkmcnt(0)
    v_cmp_ne_u32 s[40:41], 1, v10
    s_lshr_b32 s17, s17, 2
    s_or_b32 s45, s40, s41
    s_lshr_b32 s40, s45, 1
    s_or_b32 s45, s45, s40
    s_lshr_b32 s40, s45, 2
    s_or_b32 s45, s45, s40
    s_andn2_b32 s47, s17, s45
    s_cmp_gt_u32 s58, 400000
    s_cselect_b32 s47, -1, s47
    s_and_b32 s47, s47, s46
    s_cbranch_scc0 F_GS0
    s_and_b32 s45, s46, s47
    s_cselect_b32 s66, s38, 0
    s_ff1_i32_b32 s50, s45
    s_bitset0_b32 s46, s50
    s_lshl_b32 s52, s50, 10
    s_add_u32 s52, s52, s55
    buffer_load_dwordx4 v[80:83], v1, s[36:39], s52 offen offset:0 sc1
    buffer_load_dwordx4 v[84:87], v6, s[36:39], s52 offen offset:0 sc1
    buffer_load_dwordx4 v[88:91], v1, s[36:39], s52 offen offset:1024 sc1
    buffer_load_dwordx4 v[92:95], v6, s[36:39], s52 offen offset:1024 sc1
    buffer_load_dwordx4 v[96:99], v1, s[36:39], s52 offen offset:2048 sc1
    buffer_load_dwordx4 v[100:103], v6, s[36:39], s52 offen offset:2048 sc1
    buffer_load_dwordx4 v[104:107], v1, s[36:39], s52 offen offset:3072 sc1
    buffer_load_dwordx4 v[108:111], v6, s[36:39], s52 offen offset:3072 sc1
    s_cmp_eq_u32 s18, 0
    s_cbranch_scc1 F_GU
    s_waitcnt vmcnt(8)
    s_atomic_add s16, s[12:13], 0
    s_mov_b32 s18, 0
F_GU:
    s_lshr_b32 s48, s54, s50
    s_and_b32 s48, s48, 15
    s_lshl_b32 s48, s48, 14
    v_add_u32 v2, s48, v207
    v_xor_b32 v3, 32, v2
    v_xor_b32 v4, 64, v2
    v_xor_b32 v5, 96, v2
    ds_read_b64_tr_b16 v[48:49], v2 offset:0
    ds_read_b64_tr_b16 v[50:51], v2 offset:2048
    ds_read_b64_tr_b16 v[52:53], v3 offset:0
    ds_read_b64_tr_b16 v[54:55], v3 offset:2048
    ds_read_b64_tr_b16 v[56:57], v4 offset:0
    ds_read_b64_tr_b16 v[58:59], v4 offset:2048
    ds_read_b64_tr_b16 v[60:61], v5 offset:0
    ds_read_b64_tr_b16 v[62:63], v5 offset:2048
    s_cmp_lt_i32 s51, 0
    s_cbranch_scc0 F_GN0
    s_and_b32 s45, s46, s47
    s_cselect_b32 s66, s38, 0
    s_ff1_i32_b32 s51, s45
    s_bitset0_b32 s46, s51
    s_lshl_b32 s53, s51, 10
    s_add_u32 s53, s53, s55
    buffer_load_dwordx4 v[112:115], v1, s[64:67], s53 offen offset:0 sc1
    buffer_load_dwordx4 v[116:119], v6, s[64:67], s53 offen offset:0 sc1
    buffer_load_dwordx4 v[120:123], v1, s[64:67], s53 offen offset:1024 sc1
    buffer_load_dwordx4 v[124:127], v6, s[64:67], s53 offen offset:1024 sc1
    buffer_load_dwordx4 v[128:131], v1, s[64:67], s53 offen offset:2048 sc1
    buffer_load_dwordx4 v[132:135], v6, s[64:67], s53 offen offset:2048 sc1
    buffer_load_dwordx4 v[136:139], v1, s[64:67], s53 offen offset:3072 sc1
    buffer_load_dwordx4 v[140:143], v6, s[64:67], s53 offen offset:3072 sc1
    s_branch F_GC0
F_GN0:
    s_waitcnt vmcnt(0)
    s_branch F_GC0
F_GP1:
    s_cmp_eq_u32 s46, 0
    s_cbranch_scc1 F_GQ1
    s_cmp_lt_i32 s50, 0
    s_cbranch_scc1 F_GQ1
    s_mov_b32 s17, 0
    s_atomic_add s17, s[14:15], 0 glc
    ds_read_b32 v10, v211
    s_waitcnt lgkmcnt(0)
    v_cmp_ne_u32 s[40:41], 1, v10
    s_lshr_b32 s17, s17, 2
    s_or_b32 s45, s40, s41
    s_lshr_b32 s40, s45, 1
    s_or_b32 s45, s45, s40
    s_lshr_b32 s40, s45, 2
    s_or_b32 s45, s45, s40
    s_andn2_b32 s47, s17, s45
    s_cmp_gt_u32 s58, 400000
    s_cselect_b32 s47, -1, s47
    s_and_b32 s47, s47, s46
    s_branch F_GQ1
F_GS1:
    s_cmp_eq_u32 s18, 0
    s_cbranch_scc1 F_GT1
    s_waitcnt vmcnt(0)
    s_atomic_add s16, s[12:13], 0
    s_mov_b32 s18, 0
F_GT1:
    s_sleep 6
F_GE1:
    s_add_u32 s58, s58, 1
    s_mov_b32 s17, 0
    s_atomic_add s17, s[14:15], 0 glc
    ds_read_b32 v10, v211
F_GR1:
    s_waitcnt lgkmcnt(0)
    v_cmp_ne_u32 s[40:41], 1, v10
    s_lshr_b32 s17, s17, 2
    s_or_b32 s45, s40, s41
    s_lshr_b32 s40, s45, 1
    s_or_b32 s45, s45, s40
    s_lshr_b32 s40, s45, 2
    s_or_b32 s45, s45, s40
    s_andn2_b32 s47, s17, s45
    s_cmp_gt_u32 s58, 400000
    s_cselect_b32 s47, -1, s47
    s_and_b32 s47, s47, s46
    s_cbranch_scc0 F_GS1
    s_and_b32 s45, s46, s47
    s_cselect_b32 s66, s38, 0
    s_ff1_i32_b32 s51, s45
    s_bitset0_b32 s46, s51
    s_lshl_b32 s53, s51, 10
    s_add_u32 s53, s53, s55
    buffer_load_dwordx4 v[112:115], v1, s[36:39], s53 offen offset:0 sc1
    buffer_load_dwordx4 v[116:119], v6, s[36:39], s53 offen offset:0 sc1
    buffer_load_dwordx4 v[120:123], v1, s[36:39], s53 offen offset:1024 sc1
    buffer_load_dwordx4 v[124:127], v6, s[36:39], s53 offen offset:1024 sc1
    buffer_load_dwordx4 v[128:131], v1, s[36:39], s53 offen offset:2048 sc1
    buffer_load_dwordx4 v[132:135], v6, s[36:39], s53 offen offset:2048 sc1
    buffer_load_dwordx4 v[136:139], v1, s[36:39], s53 offen offset:3072 sc1
    buffer_load_dwordx4 v[140:143], v6, s[36:39], s53 offen offset:3072 sc1
    s_lshr_b32 s48, s54, s51
    s_and_b32 s48, s48, 15
    s_lshl_b32 s48, s48, 14
    v_add_u32 v2, s48, v207
    v_xor_b32 v3, 32, v2
    v_xor_b32 v4, 64, v2
    v_xor_b32 v5, 96, v2
    ds_read_b64_tr_b16 v[48:49], v2 offset:0
    ds_read_b64_tr_b16 v[50:51], v2 offset:2048
    ds_read_b64_tr_b16 v[52:53], v3 offset:0
    ds_read_b64_tr_b16 v[54:55], v3 offset:2048
    ds_read_b64_tr_b16 v[56:57], v4 offset:0
    ds_read_b64_tr_b16 v[58:59], v4 offset:2048
    ds_read_b64_tr_b16 v[60:61], v5 offset:0
    ds_read_b64_tr_b16 v[62:63], v5 offset:2048
    s_cmp_lt_i32 s50, 0
    s_cbranch_scc0 F_GN1
    s_and_b32 s45, s46, s47
    s_cselect_b32 s66, s38, 0
    s_ff1_i32_b32 s50, s45
    s_bitset0_b32 s46, s50
    s_lshl_b32 s52, s50, 10
    s_add_u32 s52, s52, s55
    buffer_load_dwordx4 v[80:83], v1, s[64:67], s52 offen offset:0 sc1
    buffer_load_dwordx4 v[84:87], v6, s[64:67], s52 offen offset:0 sc1
    buffer_load_dwordx4 v[88:91], v1, s[64:67], s52 offen offset:1024 sc1
    buffer_load_dwordx4 v[92:95], v6, s[64:67], s52 offen offset:1024 sc1
    buffer_load_dwordx4 v[96:99], v1, s[64:67], s52 offen offset:2048 sc1
    buffer_load_dwordx4 v[100:103], v6, s[64:67], s52 offen offset:2048 sc1
    buffer_load_dwordx4 v[104:107], v1, s[64:67], s52 offen offset:3072 sc1
    buffer_load_dwordx4 v[108:111], v6, s[64:67], s52 offen offset:3072 sc1
    s_branch F_GC1
F_GN1:
    s_waitcnt vmcnt(0)
    s_branch F_GC1
F_END:
    s_endpgm

.section .rodata,"a"
.p2align 6
.amdhsa_kernel concat_heads__linear_attn_block__ssm_conv_h3__prompt_kernel
  .amdhsa_next_free_vgpr 256
  .amdhsa_next_free_sgpr 102
  .amdhsa_accum_offset 256
  .amdhsa_group_segment_fixed_size 0
  .amdhsa_kernarg_size 96
  .amdhsa_user_sgpr_count 2
  .amdhsa_user_sgpr_kernarg_segment_ptr 1
  .amdhsa_system_sgpr_workgroup_id_x 1
  .amdhsa_float_denorm_mode_32 3
  .amdhsa_float_denorm_mode_16_64 3
.end_amdhsa_kernel
```

```asm
; @launch grid=(256,1,1) block=(512,1,1) lds=163840
.amdgcn_target "amdgcn-amd-amdhsa--gfx950"
.text
.globl concat_heads__linear_attn_block__ssm_conv_h3__prompt_kernel
.p2align 8
.type concat_heads__linear_attn_block__ssm_conv_h3__prompt_kernel,@function
concat_heads__linear_attn_block__ssm_conv_h3__prompt_kernel:
    s_load_dwordx16 s[4:19], s[0:1], 0
    s_cmp_ge_u32 s2, 256
    s_cbranch_scc1 F_END
    v_lshrrev_b32 v1, 6, v0
    v_and_b32 v0, 63, v0
    s_and_b32 s28, s2, 7
    s_lshr_b32 s29, s2, 3
    v_readfirstlane_b32 s3, v1
    s_and_b32 s30, s28, 1
    s_lshl_b32 s30, s30, 3
    s_and_b32 s31, s29, 7
    s_add_u32 s30, s30, s31
    s_lshr_b32 s31, s28, 1
    s_lshl_b32 s31, s31, 2
    s_lshr_b32 s32, s29, 3
    s_add_u32 s31, s31, s32
    s_lshr_b32 s30, s29, 1
    s_and_b32 s31, s29, 1
    s_lshl_b32 s32, s28, 1
    s_add_u32 s31, s31, s32
    s_cmp_lt_u32 s3, 4
    s_cbranch_scc1 F_C
    s_sub_u32 s34, s3, 4
    v_lshrrev_b32 v2, 3, v0
    v_and_b32 v4, 7, v0
    s_getpc_b64 s[66:67]
F_PC:
    s_lshl_b32 s40, s29, 10
    s_lshl_b32 s41, s34, 8
    s_add_u32 s40, s40, s41
    v_and_b32 v7, 1, v0
    v_lshlrev_b32 v7, 7, v7
    v_add_u32 v7, s40, v7
    v_min_u32 v7, F_END-F_PC, v7
    global_load_dword v250, v7, s[66:67]
    v_lshlrev_b32 v8, 11, v4
    v_and_b32 v9, 15, v0
    v_min_u32 v9, 11, v9
    v_lshrrev_b32 v7, 2, v9
    v_and_b32 v9, 3, v9
    v_lshlrev_b32 v9, 7, v9
    v_lshl_add_u32 v9, v7, 11, v9
    s_and_b32 s100, s28, 1
    s_lshr_b32 s101, s28, 1
    s_lshl_b32 s40, s100, 21
    s_lshl_b32 s41, s101, 19
    s_add_u32 s99, s40, s41
    s_lshl_b32 s40, s29, 14
    s_lshl_b32 s41, s34, 7
    s_add_u32 s42, s40, s41
    s_add_u32 s42, s42, s99
    s_mul_i32 s98, s100, 6144
    s_lshl_b32 s41, s101, 9
    s_add_u32 s98, s98, s41
    s_lshl_b32 s43, s29, 2
    s_add_u32 s43, s43, s34
    s_mul_i32 s43, s43, 12288
    s_add_u32 s43, s43, s98
    v_min_u32 v9, 5, v4
    v_lshrrev_b32 v7, 1, v9
    v_and_b32 v9, 1, v9
    v_lshlrev_b32 v9, 7, v9
    v_lshl_add_u32 v19, v7, 11, v9
    v_and_b32 v7, 1, v2
    v_mul_u32_u24 v7, 6144, v7
    v_add_u32 v9, v19, v7
    s_lshl_b32 s98, s28, 8
    s_lshl_b32 s43, s29, 2
    s_add_u32 s43, s43, s34
    s_mul_i32 s43, s43, 12288
    s_add_u32 s43, s43, s98
    s_mov_b32 s46, 0x400000
    s_mov_b32 s47, 0x00020000
    s_mov_b32 s50, 0x600000
    s_mov_b32 s51, 0x00020000
    s_lshl_b32 s40, s34, 3
    v_add_u32 v3, s40, v2
    v_lshrrev_b32 v5, 4, v0
    s_and_b32 s40, s34, 1
    s_lshl_b32 s41, s40, 2
    v_add_u32 v6, s41, v5
    v_xor_b32 v6, v6, v4
    v_lshlrev_b32 v6, 4, v6
    v_lshl_add_u32 v10, v3, 11, v6
    v_and_b32 v6, 1, v5
    v_lshlrev_b32 v6, 1, v6
    v_or_b32 v6, s41, v6
    v_xor_b32 v6, v6, v4
    v_lshlrev_b32 v6, 4, v6
    v_mul_u32_u24 v11, 6144, v3
    v_add_u32 v11, v11, v6
    s_lshl_b32 s52, s30, 18
    s_add_u32 s53, s52, 64512
    s_add_u32 s54, s52, 129024
    s_add_u32 s55, s52, 193536
    s_lshl_b32 s56, s31, 7
    s_add_u32 s57, s56, 1024
    s_add_u32 s58, s56, 2048
    s_add_u32 s59, s56, 193536
    s_add_u32 s60, s56, 198656
    s_add_u32 s61, s56, 199680
    s_mul_i32 s62, s34, 10240
    s_mov_b32 s63, 393216
    s_waitcnt lgkmcnt(0)
    s_mov_b64 s[44:45], s[4:5]
    s_mov_b64 s[48:49], s[6:7]
    buffer_load_dword v250, v9, s[48:51], s43 offen
    buffer_load_dword v250, v8, s[44:47], s42 offen
    s_add_u32 m0, s62, 45056
    s_nop 0
    buffer_load_dwordx4 v11, s[48:51], s57 offen offset:1024 lds
    buffer_load_dwordx4 v11, s[48:51], s58 offen offset:2048 lds
    buffer_load_dwordx4 v11, s[48:51], s56 offen offset:0 lds
    buffer_load_dwordx4 v11, s[48:51], s59 offen offset:3072 lds
    s_add_u32 m0, s62, 40960
    s_nop 0
    buffer_load_dwordx4 v10, s[44:47], s52 offen offset:0 lds
    buffer_load_dwordx4 v10, s[44:47], s53 offen offset:1024 lds
    buffer_load_dwordx4 v10, s[44:47], s54 offen offset:2048 lds
    buffer_load_dwordx4 v10, s[44:47], s55 offen offset:3072 lds
    s_add_u32 m0, s62, 49152
    s_nop 0
    buffer_load_dwordx4 v11, s[48:51], s60 offen offset:0 lds
    buffer_load_dwordx4 v11, s[48:51], s61 offen offset:1024 lds
    v_add_u32 v10, 128, v10
    v_add_u32 v11, s63, v11
    s_add_u32 m0, s62, 86016
    s_nop 0
    buffer_load_dwordx4 v11, s[48:51], s57 offen offset:1024 lds
    buffer_load_dwordx4 v11, s[48:51], s58 offen offset:2048 lds
    buffer_load_dwordx4 v11, s[48:51], s56 offen offset:0 lds
    buffer_load_dwordx4 v11, s[48:51], s59 offen offset:3072 lds
    s_add_u32 m0, s62, 81920
    s_nop 0
    buffer_load_dwordx4 v10, s[44:47], s52 offen offset:0 lds
    buffer_load_dwordx4 v10, s[44:47], s53 offen offset:1024 lds
    buffer_load_dwordx4 v10, s[44:47], s54 offen offset:2048 lds
    buffer_load_dwordx4 v10, s[44:47], s55 offen offset:3072 lds
    s_add_u32 m0, s62, 90112
    s_nop 0
    buffer_load_dwordx4 v11, s[48:51], s60 offen offset:0 lds
    buffer_load_dwordx4 v11, s[48:51], s61 offen offset:1024 lds
    v_add_u32 v10, 128, v10
    v_add_u32 v11, s63, v11
    s_load_dwordx8 s[20:27], s[0:1], 64
    s_and_b32 s32, s29, 3
    s_lshr_b32 s33, s28, 1
    s_lshl_b32 s33, s33, 2
    s_add_u32 s32, s32, s33
    s_and_b32 s33, s28, 1
    s_lshl_b32 s33, s33, 3
    s_lshr_b32 s35, s29, 2
    s_add_u32 s33, s33, s35
    v_lshlrev_b32 v1, 4, v0
    v_lshlrev_b32 v6, 1, v5
    v_xor_b32 v6, v6, v4
    v_lshlrev_b32 v6, 4, v6
    v_lshl_add_u32 v12, v2, 11, v6
    v_mov_b32 v13, 0
    s_lshr_b32 s35, s29, 4
    s_lshl_b32 s35, s35, 3
    s_add_u32 s35, s35, s28
    s_lshl_b32 s35, s35, 4
    s_and_b32 s40, s29, 15
    s_add_u32 s35, s35, s40
    s_mov_b32 s35, s2
    s_lshl_b32 s35, s35, 2
    s_add_u32 s35, s35, s34
    s_and_b32 s96, s29, 3
    s_waitcnt lgkmcnt(0)
    s_mov_b32 s36, s26
    s_mov_b32 s37, s27
    s_mov_b32 s38, 0x10000000
    s_mov_b32 s39, 0x00020000
    s_mov_b32 s64, s24
    s_mov_b32 s65, s25
    s_mov_b32 s66, 0x100
    s_mov_b32 s67, 0x00020000
    s_lshr_b32 s69, s29, 2
    s_mul_i32 s40, s96, 3
    s_add_u32 s40, s40, 4
    s_add_u32 s41, s40, s34
    s_lshl_b32 s41, s41, 7
    s_add_u32 s99, s99, s41
    s_lshl_b32 s41, s69, 16
    s_add_u32 s99, s99, s41
    s_lshl_b32 s40, s40, 5
    s_mul_i32 s41, s69, 12
    s_add_u32 s40, s40, s41
    s_lshl_b32 s41, s34, 2
    s_add_u32 s40, s40, s41
    s_mul_i32 s40, s40, 12288
    s_add_u32 s98, s98, s40
    s_lshl_b32 s100, s100, 10
    s_lshl_b32 s101, s101, 19
    s_add_u32 s100, s100, s101
    s_lshl_b32 s41, s29, 14
    s_add_u32 s100, s100, s41
    v_and_b32 v16, 31, v0
    v_lshlrev_b32 v16, 11, v16
    v_mul_u32_u24 v17, 6144, v2
    v_add_u32 v17, v17, v19
    v_lshlrev_b32 v18, 7, v4
    v_lshl_add_u32 v18, v2, 11, v18
    s_cmp_lg_u32 s96, 0
    s_cbranch_scc1 F_PF0X
    s_cmp_eq_u32 s34, 3
    s_cbranch_scc1 F_PF0X
    buffer_load_dword v250, v17, s[48:51], s98 offen
    buffer_load_dword v250, v16, s[44:47], s99 offen
F_PF0X:
    s_cmp_lg_u32 s96, 0
    s_cbranch_scc1 F_PW0X
    s_cmp_lg_u32 s34, 3
    s_cbranch_scc1 F_PW0X
    s_mov_b32 s40, s8
    s_mov_b32 s41, s9
    s_mov_b32 s42, 0x200000
    s_mov_b32 s43, 0x00020000
    buffer_load_dword v250, v18, s[40:43], s100 offen
F_PW0X:
    s_lshl_b32 s40, s34, 1
    v_xor_b32 v20, s40, v4
    v_lshlrev_b32 v20, 4, v20
    v_lshl_add_u32 v20, v2, 11, v20
    s_lshr_b32 s40, s2, 4
    s_lshl_b32 s40, s40, 18
    s_and_b32 s41, s2, 15
    s_lshl_b32 s41, s41, 7
    s_add_u32 s40, s40, s41
    v_xor_b32 v21, 6, v4
    v_lshlrev_b32 v21, 4, v21
    v_lshl_add_u32 v21, v2, 11, v21
    v_add_u32 v21, s40, v21
    v_subrev_u32 v21, 6144, v21
    s_lshl_b32 s41, s34, 15
    s_add_u32 s40, s40, s41
    v_add_u32 v20, s40, v20
    v_and_b32 v22, 3, v2
    v_xor_b32 v22, s34, v22
    v_lshlrev_b32 v22, 5, v22
    v_lshl_add_u32 v22, v4, 2, v22
    v_lshl_add_u32 v22, v2, 11, v22
    v_add_u32 v22, 123264, v22
    v_add_u32 v23, 3, v2
    v_and_b32 v23, 3, v23
    v_xor_b32 v23, s34, v23
    v_lshlrev_b32 v23, 5, v23
    v_lshl_add_u32 v23, v4, 2, v23
    v_lshl_add_u32 v23, v2, 11, v23
    v_add_u32 v23, 122880, v23
    s_and_b32 s40, s2, 15
    s_lshl_b32 s40, s40, 6
    s_lshl_b32 s41, s34, 4
    s_add_u32 s40, s40, s41
    v_lshlrev_b32 v24, 1, v4
    v_add_u32 v24, s40, v24
    v_mul_u32_u24 v25, 4224, v24
    v_lshlrev_b32 v24, 3, v24
    s_lshr_b32 s40, s2, 4
    s_lshl_b32 s40, s40, 3
    v_add_u32 v26, s40, v2
    v_lshl_add_u32 v25, v26, 4, v25
    s_lshr_b32 s40, s2, 4
    s_lshl_b32 s40, s40, 4
    s_lshl_b32 s41, s34, 3
    s_add_u32 s40, s40, s41
    v_add_u32 v28, s40, v2
    v_mul_u32_u24 v232, 33792, v4
    v_lshl_add_u32 v232, v28, 4, v232
    v_lshrrev_b32 v29, 6, v28
    v_lshlrev_b32 v29, 9, v29
    v_and_b32 v30, 15, v28
    v_lshl_add_u32 v29, v30, 4, v29
    v_bfe_u32 v30, v28, 4, 2
    v_lshl_add_u32 v29, v30, 2, v29
    v_lshlrev_b32 v30, 4, v4
    v_lshl_add_u32 v234, v29, 11, v30
    v_lshl_add_u32 v233, v29, 12, v30
    s_waitcnt vmcnt(10)
    s_barrier
    s_add_u32 m0, s62, 4096
    s_nop 0
    buffer_load_dwordx4 v11, s[48:51], s57 offen offset:1024 lds
    buffer_load_dwordx4 v11, s[48:51], s58 offen offset:2048 lds
    buffer_load_dwordx4 v11, s[48:51], s56 offen offset:0 lds
    buffer_load_dwordx4 v11, s[48:51], s59 offen offset:3072 lds
    s_cmp_lg_u32 s96, 1
    s_cbranch_scc1 F_PF1X
    s_cmp_eq_u32 s34, 3
    s_cbranch_scc1 F_PF1X
    buffer_load_dword v250, v17, s[48:51], s98 offen
    buffer_load_dword v250, v16, s[44:47], s99 offen
F_PF1X:
    s_add_u32 m0, s62, 0
    s_nop 0
    buffer_load_dwordx4 v10, s[44:47], s52 offen offset:0 lds
    buffer_load_dwordx4 v10, s[44:47], s53 offen offset:1024 lds
    buffer_load_dwordx4 v10, s[44:47], s54 offen offset:2048 lds
    buffer_load_dwordx4 v10, s[44:47], s55 offen offset:3072 lds
    s_cmp_lg_u32 s96, 1
    s_cbranch_scc1 F_PW1X
    s_cmp_lg_u32 s34, 3
    s_cbranch_scc1 F_PW1X
    s_mov_b32 s40, s8
    s_mov_b32 s41, s9
    s_mov_b32 s42, 0x200000
    s_mov_b32 s43, 0x00020000
    buffer_load_dword v250, v18, s[40:43], s100 offen
F_PW1X:
    s_add_u32 m0, s62, 8192
    s_nop 0
    buffer_load_dwordx4 v11, s[48:51], s60 offen offset:0 lds
    buffer_load_dwordx4 v11, s[48:51], s61 offen offset:1024 lds
    v_add_u32 v10, 128, v10
    v_add_u32 v11, s63, v11
    s_cmp_lg_u32 s96, 2
    s_cbranch_scc1 F_KV2X
    s_lshl_b32 s69, s34, 11
    s_mov_b32 s40, s12
    s_mov_b32 s41, s13
    s_mov_b32 s42, 0x400000
    s_mov_b32 s43, 0x00020000
    s_mov_b32 m0, 122880
    s_mov_b64 exec, 0xffffff
    buffer_load_dwordx4 v21, s[40:43], 0 offen nt lds
    s_mov_b64 exec, -1
    s_add_u32 m0, s69, 123264
    s_mov_b32 s97, 0
    buffer_load_dwordx4 v20, s[40:43], s97 offen nt lds
    s_mov_b32 s97, 15360
    buffer_load_dwordx4 v20, s[40:43], s97 offen offset:1024 nt lds
    s_add_u32 m0, s69, 131456
    s_mov_b32 s97, 131072
    buffer_load_dwordx4 v20, s[40:43], s97 offen nt lds
    s_mov_b32 s97, 146432
    buffer_load_dwordx4 v20, s[40:43], s97 offen offset:1024 nt lds
    s_mov_b32 s40, s14
    s_mov_b32 s41, s15
    s_mov_b32 s42, 0x400000
    s_mov_b32 s43, 0x00020000
    s_add_u32 m0, s69, 139648
    s_mov_b32 s97, 0
    buffer_load_dwordx4 v20, s[40:43], s97 offen nt lds
    s_mov_b32 s97, 15360
    buffer_load_dwordx4 v20, s[40:43], s97 offen offset:1024 nt lds
    s_add_u32 m0, s69, 147840
    s_mov_b32 s97, 131072
    buffer_load_dwordx4 v20, s[40:43], s97 offen nt lds
    s_mov_b32 s97, 146432
    buffer_load_dwordx4 v20, s[40:43], s97 offen offset:1024 nt lds
    s_mov_b32 s40, s16
    s_mov_b32 s41, s17
    s_mov_b32 s42, 0x2000
    s_mov_b32 s43, 0x00020000
    buffer_load_dwordx4 v[32:35], v24, s[40:43], 0 offen
F_KV2X:
    s_waitcnt vmcnt(10)
    s_barrier
    s_add_u32 m0, s62, 45056
    s_nop 0
    buffer_load_dwordx4 v11, s[48:51], s57 offen offset:1024 lds
    s_mov_b32 s7, 0xffff0000
    buffer_load_dwordx4 v11, s[48:51], s58 offen offset:2048 lds
    buffer_load_dwordx4 v11, s[48:51], s56 offen offset:0 lds
    buffer_load_dwordx4 v11, s[48:51], s59 offen offset:3072 lds
    s_add_u32 m0, s62, 40960
    s_nop 0
    buffer_load_dwordx4 v10, s[44:47], s52 offen offset:0 lds
    buffer_load_dwordx4 v10, s[44:47], s53 offen offset:1024 lds
    buffer_load_dwordx4 v10, s[44:47], s54 offen offset:2048 lds
    buffer_load_dwordx4 v10, s[44:47], s55 offen offset:3072 lds
    s_add_u32 m0, s62, 49152
    s_nop 0
    buffer_load_dwordx4 v11, s[48:51], s60 offen offset:0 lds
    buffer_load_dwordx4 v11, s[48:51], s61 offen offset:1024 lds
    s_cmp_lg_u32 s96, 0
    s_cbranch_scc1 F_KV0X
    s_lshl_b32 s69, s34, 11
    s_mov_b32 s40, s12
    s_mov_b32 s41, s13
    s_mov_b32 s42, 0x400000
    s_mov_b32 s43, 0x00020000
    s_mov_b32 m0, 122880
    s_mov_b64 exec, 0xffffff
    buffer_load_dwordx4 v21, s[40:43], 0 offen nt lds
    s_mov_b64 exec, -1
    s_add_u32 m0, s69, 123264
    s_mov_b32 s97, 0
    buffer_load_dwordx4 v20, s[40:43], s97 offen nt lds
    s_mov_b32 s97, 15360
    buffer_load_dwordx4 v20, s[40:43], s97 offen offset:1024 nt lds
    s_add_u32 m0, s69, 131456
    s_mov_b32 s97, 131072
    buffer_load_dwordx4 v20, s[40:43], s97 offen nt lds
    s_mov_b32 s97, 146432
    buffer_load_dwordx4 v20, s[40:43], s97 offen offset:1024 nt lds
    s_mov_b32 s40, s14
    s_mov_b32 s41, s15
    s_mov_b32 s42, 0x400000
    s_mov_b32 s43, 0x00020000
    s_add_u32 m0, s69, 139648
    s_mov_b32 s97, 0
    buffer_load_dwordx4 v20, s[40:43], s97 offen nt lds
    s_mov_b32 s97, 15360
    buffer_load_dwordx4 v20, s[40:43], s97 offen offset:1024 nt lds
    s_add_u32 m0, s69, 147840
    s_mov_b32 s97, 131072
    buffer_load_dwordx4 v20, s[40:43], s97 offen nt lds
    s_mov_b32 s97, 146432
    buffer_load_dwordx4 v20, s[40:43], s97 offen offset:1024 nt lds
    s_mov_b32 s40, s16
    s_mov_b32 s41, s17
    s_mov_b32 s42, 0x2000
    s_mov_b32 s43, 0x00020000
    buffer_load_dwordx4 v[32:35], v24, s[40:43], 0 offen
F_KV0X:
    v_add_u32 v10, 128, v10
    v_add_u32 v11, s63, v11
    s_waitcnt vmcnt(10)
    s_barrier
    s_add_u32 m0, s62, 86016
    s_nop 0
    buffer_load_dwordx4 v11, s[48:51], s57 offen offset:1024 lds
    buffer_load_dwordx4 v11, s[48:51], s58 offen offset:2048 lds
    buffer_load_dwordx4 v11, s[48:51], s56 offen offset:0 lds
    buffer_load_dwordx4 v11, s[48:51], s59 offen offset:3072 lds
    s_add_u32 m0, s62, 81920
    s_nop 0
    buffer_load_dwordx4 v10, s[44:47], s52 offen offset:0 lds
    buffer_load_dwordx4 v10, s[44:47], s53 offen offset:1024 lds
    buffer_load_dwordx4 v10, s[44:47], s54 offen offset:2048 lds
    buffer_load_dwordx4 v10, s[44:47], s55 offen offset:3072 lds
    s_add_u32 m0, s62, 90112
    s_nop 0
    buffer_load_dwordx4 v11, s[48:51], s60 offen offset:0 lds
    buffer_load_dwordx4 v11, s[48:51], s61 offen offset:1024 lds
    s_cmp_lg_u32 s96, 1
    s_cbranch_scc1 F_KV1X
    s_lshl_b32 s69, s34, 11
    s_mov_b32 s40, s12
    s_mov_b32 s41, s13
    s_mov_b32 s42, 0x400000
    s_mov_b32 s43, 0x00020000
    s_mov_b32 m0, 122880
    s_mov_b64 exec, 0xffffff
    buffer_load_dwordx4 v21, s[40:43], 0 offen nt lds
    s_mov_b64 exec, -1
    s_add_u32 m0, s69, 123264
    s_mov_b32 s97, 0
    buffer_load_dwordx4 v20, s[40:43], s97 offen nt lds
    s_mov_b32 s97, 15360
    buffer_load_dwordx4 v20, s[40:43], s97 offen offset:1024 nt lds
    s_add_u32 m0, s69, 131456
    s_mov_b32 s97, 131072
    buffer_load_dwordx4 v20, s[40:43], s97 offen nt lds
    s_mov_b32 s97, 146432
    buffer_load_dwordx4 v20, s[40:43], s97 offen offset:1024 nt lds
    s_mov_b32 s40, s14
    s_mov_b32 s41, s15
    s_mov_b32 s42, 0x400000
    s_mov_b32 s43, 0x00020000
    s_add_u32 m0, s69, 139648
    s_mov_b32 s97, 0
    buffer_load_dwordx4 v20, s[40:43], s97 offen nt lds
    s_mov_b32 s97, 15360
    buffer_load_dwordx4 v20, s[40:43], s97 offen offset:1024 nt lds
    s_add_u32 m0, s69, 147840
    s_mov_b32 s97, 131072
    buffer_load_dwordx4 v20, s[40:43], s97 offen nt lds
    s_mov_b32 s97, 146432
    buffer_load_dwordx4 v20, s[40:43], s97 offen offset:1024 nt lds
    s_mov_b32 s40, s16
    s_mov_b32 s41, s17
    s_mov_b32 s42, 0x2000
    s_mov_b32 s43, 0x00020000
    buffer_load_dwordx4 v[32:35], v24, s[40:43], 0 offen
F_KV1X:
    v_add_u32 v10, 128, v10
    v_add_u32 v11, s63, v11
    s_cmp_lg_u32 s96, 3
    s_cbranch_scc1 F_KV3X
    s_lshl_b32 s69, s34, 11
    s_mov_b32 s40, s12
    s_mov_b32 s41, s13
    s_mov_b32 s42, 0x400000
    s_mov_b32 s43, 0x00020000
    s_mov_b32 m0, 122880
    s_mov_b64 exec, 0xffffff
    buffer_load_dwordx4 v21, s[40:43], 0 offen nt lds
    s_mov_b64 exec, -1
    s_add_u32 m0, s69, 123264
    s_mov_b32 s97, 0
    buffer_load_dwordx4 v20, s[40:43], s97 offen nt lds
    s_mov_b32 s97, 15360
    buffer_load_dwordx4 v20, s[40:43], s97 offen offset:1024 nt lds
    s_add_u32 m0, s69, 131456
    s_mov_b32 s97, 131072
    buffer_load_dwordx4 v20, s[40:43], s97 offen nt lds
    s_mov_b32 s97, 146432
    buffer_load_dwordx4 v20, s[40:43], s97 offen offset:1024 nt lds
    s_mov_b32 s40, s14
    s_mov_b32 s41, s15
    s_mov_b32 s42, 0x400000
    s_mov_b32 s43, 0x00020000
    s_add_u32 m0, s69, 139648
    s_mov_b32 s97, 0
    buffer_load_dwordx4 v20, s[40:43], s97 offen nt lds
    s_mov_b32 s97, 15360
    buffer_load_dwordx4 v20, s[40:43], s97 offen offset:1024 nt lds
    s_add_u32 m0, s69, 147840
    s_mov_b32 s97, 131072
    buffer_load_dwordx4 v20, s[40:43], s97 offen nt lds
    s_mov_b32 s97, 146432
    buffer_load_dwordx4 v20, s[40:43], s97 offen offset:1024 nt lds
    s_mov_b32 s40, s16
    s_mov_b32 s41, s17
    s_mov_b32 s42, 0x2000
    s_mov_b32 s43, 0x00020000
    buffer_load_dwordx4 v[32:35], v24, s[40:43], 0 offen
F_KV3X:
    s_waitcnt vmcnt(10)
    s_barrier
    s_add_u32 m0, s62, 4096
    s_nop 0
    buffer_load_dwordx4 v11, s[48:51], s57 offen offset:1024 lds
    v_mov_b32 v44, 0
    v_mov_b32 v45, 0
    v_mov_b32 v46, 0
    v_mov_b32 v47, 0
    buffer_load_dwordx4 v11, s[48:51], s58 offen offset:2048 lds
    v_mov_b32 v48, 0
    v_mov_b32 v49, 0
    v_mov_b32 v50, 0
    v_mov_b32 v51, 0
    buffer_load_dwordx4 v11, s[48:51], s56 offen offset:0 lds
    v_mov_b32 v52, 0
    v_mov_b32 v53, 0
    v_mov_b32 v54, 0
    v_mov_b32 v55, 0
    buffer_load_dwordx4 v11, s[48:51], s59 offen offset:3072 lds
    v_mov_b32 v56, 0
    v_mov_b32 v57, 0
    v_mov_b32 v58, 0
    v_mov_b32 v59, 0
    s_add_u32 m0, s62, 0
    s_nop 0
    buffer_load_dwordx4 v10, s[44:47], s52 offen offset:0 lds
    v_mov_b32 v60, 0
    v_mov_b32 v61, 0
    v_mov_b32 v62, 0
    v_mov_b32 v63, 0
    buffer_load_dwordx4 v10, s[44:47], s53 offen offset:1024 lds
    v_mov_b32 v64, 0
    v_mov_b32 v65, 0
    v_mov_b32 v66, 0
    v_mov_b32 v67, 0
    buffer_load_dwordx4 v10, s[44:47], s54 offen offset:2048 lds
    v_mov_b32 v68, 0
    v_mov_b32 v69, 0
    v_mov_b32 v70, 0
    v_mov_b32 v71, 0
    buffer_load_dwordx4 v10, s[44:47], s55 offen offset:3072 lds
    v_mov_b32 v72, 0
    v_mov_b32 v73, 0
    v_mov_b32 v74, 0
    v_mov_b32 v75, 0
    s_add_u32 m0, s62, 8192
    s_nop 0
    buffer_load_dwordx4 v11, s[48:51], s60 offen offset:0 lds
    v_mov_b32 v76, 0
    v_mov_b32 v77, 0
    v_mov_b32 v78, 0
    v_mov_b32 v79, 0
    buffer_load_dwordx4 v11, s[48:51], s61 offen offset:1024 lds
    v_add_u32 v10, 128, v10
    v_add_u32 v11, s63, v11
    s_waitcnt vmcnt(10)
    s_barrier
    s_add_u32 m0, s62, 45056
    s_nop 0
    buffer_load_dwordx4 v11, s[48:51], s57 offen offset:1024 lds
    buffer_load_dwordx4 v11, s[48:51], s58 offen offset:2048 lds
    buffer_load_dwordx4 v11, s[48:51], s56 offen offset:0 lds
    buffer_load_dwordx4 v11, s[48:51], s59 offen offset:3072 lds
    s_cmp_lg_u32 s96, 2
    s_cbranch_scc1 F_PF2X
    s_cmp_eq_u32 s34, 3
    s_cbranch_scc1 F_PF2X
    buffer_load_dword v250, v17, s[48:51], s98 offen
    buffer_load_dword v250, v16, s[44:47], s99 offen
F_PF2X:
    s_add_u32 m0, s62, 40960
    s_nop 0
    buffer_load_dwordx4 v10, s[44:47], s52 offen offset:0 lds
    buffer_load_dwordx4 v10, s[44:47], s53 offen offset:1024 lds
    buffer_load_dwordx4 v10, s[44:47], s54 offen offset:2048 lds
    buffer_load_dwordx4 v10, s[44:47], s55 offen offset:3072 lds
    s_cmp_lg_u32 s96, 2
    s_cbranch_scc1 F_PW2X
    s_cmp_lg_u32 s34, 3
    s_cbranch_scc1 F_PW2X
    s_mov_b32 s40, s8
    s_mov_b32 s41, s9
    s_mov_b32 s42, 0x200000
    s_mov_b32 s43, 0x00020000
    buffer_load_dword v250, v18, s[40:43], s100 offen
F_PW2X:
    s_add_u32 m0, s62, 49152
    s_nop 0
    buffer_load_dwordx4 v11, s[48:51], s60 offen offset:0 lds
    buffer_load_dwordx4 v11, s[48:51], s61 offen offset:1024 lds
    v_add_u32 v10, 128, v10
    v_add_u32 v11, s63, v11
    s_waitcnt vmcnt(10)
    s_barrier
    s_add_u32 m0, s62, 86016
    s_nop 0
    buffer_load_dwordx4 v11, s[48:51], s57 offen offset:1024 lds
    ds_read_u16_d16_hi v44, v23 offset:0
    ds_read_u16_d16_hi v45, v23 offset:128
    ds_read_u16_d16_hi v46, v23 offset:256
    ds_read_u16_d16_hi v47, v22 offset:0
    ds_read_u16_d16_hi v48, v22 offset:128
    ds_read_u16_d16_hi v49, v22 offset:256
    buffer_load_dwordx4 v11, s[48:51], s58 offen offset:2048 lds
    ds_read_u16_d16_hi v50, v22 offset:384
    ds_read_u16_d16_hi v51, v22 offset:512
    ds_read_u16_d16_hi v52, v22 offset:640
    ds_read_u16_d16_hi v53, v22 offset:768
    ds_read_u16_d16_hi v54, v22 offset:896
    ds_read_u16_d16_hi v55, v22 offset:1024
    buffer_load_dwordx4 v11, s[48:51], s56 offen offset:0 lds
    v_lshlrev_b32 v36, 16, v32
    v_and_b32 v37, s7, v32
    v_lshlrev_b32 v38, 16, v33
    v_and_b32 v39, s7, v33
    s_waitcnt lgkmcnt(4)
    v_mul_f32 v80, v39, v44
    ds_read_u16_d16_hi v56, v22 offset:1152
    buffer_load_dwordx4 v11, s[48:51], s59 offen offset:3072 lds
    v_mul_f32 v81, v39, v45
    ds_read_u16_d16_hi v57, v22 offset:1280
    v_mul_f32 v82, v39, v46
    ds_read_u16_d16_hi v58, v22 offset:1408
    v_mul_f32 v83, v39, v47
    ds_read_u16_d16_hi v59, v22 offset:1536
    s_add_u32 m0, s62, 81920
    s_nop 0
    buffer_load_dwordx4 v10, s[44:47], s52 offen offset:0 lds
    v_mul_f32 v84, v39, v48
    ds_read_u16_d16_hi v60, v22 offset:1664
    v_mul_f32 v85, v39, v49
    ds_read_u16_d16_hi v61, v22 offset:1792
    v_mul_f32 v86, v39, v50
    ds_read_u16_d16_hi v62, v22 offset:1920
    buffer_load_dwordx4 v10, s[44:47], s53 offen offset:1024 lds
    v_mul_f32 v87, v39, v51
    ds_read_u16_d16_hi v64, v22 offset:16384
    s_waitcnt lgkmcnt(4)
    v_mul_f32 v88, v39, v52
    ds_read_u16_d16_hi v65, v22 offset:16512
    v_mul_f32 v89, v39, v53
    ds_read_u16_d16_hi v66, v22 offset:16640
    buffer_load_dwordx4 v10, s[44:47], s54 offen offset:2048 lds
    v_mul_f32 v90, v39, v54
    ds_read_u16_d16_hi v67, v22 offset:16768
    v_mul_f32 v91, v39, v55
    ds_read_u16_d16_hi v68, v22 offset:16896
    v_mul_f32 v92, v39, v56
    ds_read_u16_d16_hi v69, v22 offset:17024
    buffer_load_dwordx4 v10, s[44:47], s55 offen offset:3072 lds
    v_mul_f32 v93, v39, v57
    ds_read_u16_d16_hi v70, v22 offset:17152
    v_mul_f32 v94, v39, v58
    ds_read_u16_d16_hi v71, v22 offset:17280
    v_mul_f32 v95, v39, v59
    ds_read_u16_d16_hi v72, v22 offset:17408
    s_add_u32 m0, s62, 90112
    s_nop 0
    buffer_load_dwordx4 v11, s[48:51], s60 offen offset:0 lds
    s_waitcnt lgkmcnt(9)
    v_fmac_f32 v80, v38, v45
    ds_read_u16_d16_hi v73, v22 offset:17536
    v_fmac_f32 v81, v38, v46
    ds_read_u16_d16_hi v74, v22 offset:17664
    buffer_load_dwordx4 v11, s[48:51], s61 offen offset:1024 lds
    v_add_u32 v10, 128, v10
    v_add_u32 v11, s63, v11
    s_waitcnt vmcnt(10)
    s_barrier
    s_add_u32 m0, s62, 4096
    s_nop 0
    buffer_load_dwordx4 v11, s[48:51], s57 offen offset:1024 lds
    buffer_load_dword v14, v13, s[64:67], 0 offen sc1
    v_fmac_f32 v82, v38, v47
    ds_read_u16_d16_hi v75, v22 offset:17792
    v_fmac_f32 v83, v38, v48
    ds_read_u16_d16_hi v76, v22 offset:17920
    v_fmac_f32 v84, v38, v49
    buffer_load_dwordx4 v11, s[48:51], s58 offen offset:2048 lds
    ds_read_u16_d16_hi v77, v22 offset:18048
    v_fmac_f32 v85, v38, v50
    ds_read_u16_d16_hi v78, v22 offset:18176
    v_fmac_f32 v86, v38, v51
    ds_read_u16_d16_hi v79, v22 offset:18304
    v_fmac_f32 v87, v38, v52
    buffer_load_dwordx4 v11, s[48:51], s56 offen offset:0 lds
    v_fmac_f32 v88, v38, v53
    v_fmac_f32 v89, v38, v54
    v_fmac_f32 v90, v38, v55
    v_fmac_f32 v91, v38, v56
    v_fmac_f32 v92, v38, v57
    v_fmac_f32 v93, v38, v58
    buffer_load_dwordx4 v11, s[48:51], s59 offen offset:3072 lds
    v_fmac_f32 v94, v38, v59
    v_fmac_f32 v95, v38, v60
    v_fmac_f32 v80, v37, v46
    v_fmac_f32 v81, v37, v47
    v_fmac_f32 v82, v37, v48
    v_fmac_f32 v83, v37, v49
    s_add_u32 m0, s62, 0
    s_nop 0
    buffer_load_dwordx4 v10, s[44:47], s52 offen offset:0 lds
    v_fmac_f32 v84, v37, v50
    v_fmac_f32 v85, v37, v51
    v_fmac_f32 v86, v37, v52
    v_fmac_f32 v87, v37, v53
    v_fmac_f32 v88, v37, v54
    v_fmac_f32 v89, v37, v55
    buffer_load_dwordx4 v10, s[44:47], s53 offen offset:1024 lds
    v_fmac_f32 v90, v37, v56
    v_fmac_f32 v91, v37, v57
    v_fmac_f32 v92, v37, v58
    v_fmac_f32 v93, v37, v59
    v_fmac_f32 v94, v37, v60
    v_fmac_f32 v95, v37, v61
    buffer_load_dwordx4 v10, s[44:47], s54 offen offset:2048 lds
    v_fmac_f32 v80, v36, v47
    v_fmac_f32 v81, v36, v48
    v_fmac_f32 v82, v36, v49
    v_fmac_f32 v83, v36, v50
    v_fmac_f32 v84, v36, v51
    v_fmac_f32 v85, v36, v52
    buffer_load_dwordx4 v10, s[44:47], s55 offen offset:3072 lds
    v_fmac_f32 v86, v36, v53
    v_fmac_f32 v87, v36, v54
    v_fmac_f32 v88, v36, v55
    v_fmac_f32 v89, v36, v56
    v_fmac_f32 v90, v36, v57
    v_fmac_f32 v91, v36, v58
    s_add_u32 m0, s62, 8192
    s_nop 0
    buffer_load_dwordx4 v11, s[48:51], s60 offen offset:0 lds
    v_fmac_f32 v92, v36, v59
    v_fmac_f32 v93, v36, v60
    v_fmac_f32 v94, v36, v61
    v_fmac_f32 v95, v36, v62
    s_waitcnt lgkmcnt(0)
    v_mul_f32 v80, v80, v64
    buffer_load_dwordx4 v11, s[48:51], s61 offen offset:1024 lds
    v_add_u32 v10, 128, v10
    v_add_u32 v11, s63, v11
    s_waitcnt vmcnt(11)
    s_barrier
    s_add_u32 m0, s62, 45056
    s_nop 0
    buffer_load_dwordx4 v11, s[48:51], s57 offen offset:1024 lds
    buffer_load_dwordx4 v11, s[48:51], s58 offen offset:2048 lds
    buffer_load_dwordx4 v11, s[48:51], s56 offen offset:0 lds
    buffer_load_dwordx4 v11, s[48:51], s59 offen offset:3072 lds
    s_cmp_lg_u32 s96, 3
    s_cbranch_scc1 F_PF3X
    s_cmp_eq_u32 s34, 3
    s_cbranch_scc1 F_PF3X
    buffer_load_dword v250, v17, s[48:51], s98 offen
    buffer_load_dword v250, v16, s[44:47], s99 offen
F_PF3X:
    s_cmp_lg_u32 s96, 3
    s_cbranch_scc1 F_PW3X
    s_cmp_lg_u32 s34, 3
    s_cbranch_scc1 F_PW3X
    s_mov_b32 s40, s8
    s_mov_b32 s41, s9
    s_mov_b32 s42, 0x200000
    s_mov_b32 s43, 0x00020000
    buffer_load_dword v250, v18, s[40:43], s100 offen
F_PW3X:
    v_mul_f32 v81, v81, v65
    v_mul_f32 v82, v82, v66
    v_mul_f32 v83, v83, v67
    v_mul_f32 v84, v84, v68
    s_add_u32 m0, s62, 40960
    s_nop 0
    buffer_load_dwordx4 v10, s[44:47], s52 offen offset:0 lds
    v_mul_f32 v85, v85, v69
    v_mul_f32 v86, v86, v70
    v_mul_f32 v87, v87, v71
    v_mul_f32 v88, v88, v72
    v_mul_f32 v89, v89, v73
    v_mul_f32 v90, v90, v74
    buffer_load_dwordx4 v10, s[44:47], s53 offen offset:1024 lds
    v_mul_f32 v91, v91, v75
    v_mul_f32 v92, v92, v76
    v_mul_f32 v93, v93, v77
    v_mul_f32 v94, v94, v78
    v_mul_f32 v95, v95, v79
    v_cvt_pk_bf16_f32 v96, v92, v88
    buffer_load_dwordx4 v10, s[44:47], s54 offen offset:2048 lds
    v_cvt_pk_bf16_f32 v97, v84, v80
    v_cvt_pk_bf16_f32 v98, v94, v90
    v_cvt_pk_bf16_f32 v99, v86, v82
    v_cvt_pk_bf16_f32 v100, v93, v89
    v_cvt_pk_bf16_f32 v101, v85, v81
    v_cvt_pk_bf16_f32 v102, v95, v91
    buffer_load_dwordx4 v10, s[44:47], s55 offen offset:3072 lds
    v_cvt_pk_bf16_f32 v103, v87, v83
    ds_read_u16_d16_hi v44, v23 offset:2
    ds_read_u16_d16_hi v45, v23 offset:130
    ds_read_u16_d16_hi v46, v23 offset:258
    ds_read_u16_d16_hi v47, v22 offset:2
    ds_read_u16_d16_hi v48, v22 offset:130
    s_add_u32 m0, s62, 49152
    s_nop 0
    buffer_load_dwordx4 v11, s[48:51], s60 offen offset:0 lds
    ds_read_u16_d16_hi v49, v22 offset:258
    ds_read_u16_d16_hi v50, v22 offset:386
    ds_read_u16_d16_hi v51, v22 offset:514
    ds_read_u16_d16_hi v52, v22 offset:642
    ds_read_u16_d16_hi v53, v22 offset:770
    ds_read_u16_d16_hi v54, v22 offset:898
    buffer_load_dwordx4 v11, s[48:51], s61 offen offset:1024 lds
    ds_read_u16_d16_hi v55, v22 offset:1026
    v_lshlrev_b32 v36, 16, v34
    v_and_b32 v37, s7, v34
    v_lshlrev_b32 v38, 16, v35
    v_and_b32 v39, s7, v35
    s_waitcnt lgkmcnt(4)
    v_mul_f32 v80, v39, v44
    v_add_u32 v10, 128, v10
    v_add_u32 v11, s63, v11
    ds_read_u16_d16_hi v56, v22 offset:1154
    v_mul_f32 v81, v39, v45
    ds_read_u16_d16_hi v57, v22 offset:1282
    v_mul_f32 v82, v39, v46
    ds_read_u16_d16_hi v58, v22 offset:1410
    v_mul_f32 v83, v39, v47
    ds_read_u16_d16_hi v59, v22 offset:1538
    v_mul_f32 v84, v39, v48
    ds_read_u16_d16_hi v60, v22 offset:1666
    v_mul_f32 v85, v39, v49
    ds_read_u16_d16_hi v61, v22 offset:1794
    v_mul_f32 v86, v39, v50
    s_waitcnt vmcnt(10)
    s_barrier
    s_add_u32 m0, s62, 86016
    s_nop 0
    buffer_load_dwordx4 v11, s[48:51], s57 offen offset:1024 lds
    buffer_load_dwordx4 v11, s[48:51], s58 offen offset:2048 lds
    buffer_load_dwordx4 v11, s[48:51], s56 offen offset:0 lds
    buffer_load_dwordx4 v11, s[48:51], s59 offen offset:3072 lds
    v_readfirstlane_b32 s68, v14
    s_mov_b32 s69, 0
F_TK:
    s_cmp_ge_u32 s68, 4
    s_cbranch_scc1 F_TKX
    s_sleep 8
    buffer_load_dword v14, v13, s[64:67], 0 offen sc1
    s_waitcnt vmcnt(0)
    v_readfirstlane_b32 s68, v14
    s_add_u32 s69, s69, 1
    s_cmp_lt_u32 s69, 400000
    s_cbranch_scc1 F_TK
F_TKX:
    ds_read_u16_d16_hi v62, v22 offset:1922
    v_mul_f32 v87, v39, v51
    ds_read_u16_d16_hi v64, v22 offset:16386
    s_waitcnt lgkmcnt(4)
    v_mul_f32 v88, v39, v52
    ds_read_u16_d16_hi v65, v22 offset:16514
    s_add_u32 m0, s62, 81920
    s_nop 0
    buffer_load_dwordx4 v10, s[44:47], s52 offen offset:0 lds
    v_mul_f32 v89, v39, v53
    ds_read_u16_d16_hi v66, v22 offset:16642
    v_mul_f32 v90, v39, v54
    ds_read_u16_d16_hi v67, v22 offset:16770
    v_mul_f32 v91, v39, v55
    ds_read_u16_d16_hi v68, v22 offset:16898
    buffer_load_dwordx4 v10, s[44:47], s53 offen offset:1024 lds
    v_mul_f32 v92, v39, v56
    ds_read_u16_d16_hi v69, v22 offset:17026
    v_mul_f32 v93, v39, v57
    ds_read_u16_d16_hi v70, v22 offset:17154
    v_mul_f32 v94, v39, v58
    ds_read_u16_d16_hi v71, v22 offset:17282
    buffer_load_dwordx4 v10, s[44:47], s54 offen offset:2048 lds
    v_mul_f32 v95, v39, v59
    ds_read_u16_d16_hi v72, v22 offset:17410
    s_waitcnt lgkmcnt(9)
    v_fmac_f32 v80, v38, v45
    ds_read_u16_d16_hi v73, v22 offset:17538
    v_fmac_f32 v81, v38, v46
    ds_read_u16_d16_hi v74, v22 offset:17666
    buffer_load_dwordx4 v10, s[44:47], s55 offen offset:3072 lds
    v_fmac_f32 v82, v38, v47
    ds_read_u16_d16_hi v75, v22 offset:17794
    v_fmac_f32 v83, v38, v48
    ds_read_u16_d16_hi v76, v22 offset:17922
    v_fmac_f32 v84, v38, v49
    ds_read_u16_d16_hi v77, v22 offset:18050
    s_add_u32 m0, s62, 90112
    s_nop 0
    buffer_load_dwordx4 v11, s[48:51], s60 offen offset:0 lds
    v_fmac_f32 v85, v38, v50
    ds_read_u16_d16_hi v78, v22 offset:18178
    v_fmac_f32 v86, v38, v51
    ds_read_u16_d16_hi v79, v22 offset:18306
    v_fmac_f32 v87, v38, v52
    v_fmac_f32 v88, v38, v53
    buffer_load_dwordx4 v11, s[48:51], s61 offen offset:1024 lds
    v_fmac_f32 v89, v38, v54
    v_fmac_f32 v90, v38, v55
    v_fmac_f32 v91, v38, v56
    v_fmac_f32 v92, v38, v57
    v_fmac_f32 v93, v38, v58
    v_fmac_f32 v94, v38, v59
    v_add_u32 v10, 128, v10
    v_add_u32 v11, s63, v11
    v_fmac_f32 v95, v38, v60
    v_fmac_f32 v80, v37, v46
    v_fmac_f32 v81, v37, v47
    v_fmac_f32 v82, v37, v48
    v_fmac_f32 v83, v37, v49
    v_fmac_f32 v84, v37, v50
    v_fmac_f32 v85, v37, v51
    v_fmac_f32 v86, v37, v52
    v_fmac_f32 v87, v37, v53
    v_fmac_f32 v88, v37, v54
    v_fmac_f32 v89, v37, v55
    s_waitcnt vmcnt(10)
    s_barrier
    s_add_u32 m0, s62, 4096
    s_nop 0
    buffer_load_dwordx4 v11, s[48:51], s57 offen offset:1024 lds
    v_fmac_f32 v90, v37, v56
    v_fmac_f32 v91, v37, v57
    v_fmac_f32 v92, v37, v58
    v_fmac_f32 v93, v37, v59
    v_fmac_f32 v94, v37, v60
    buffer_load_dwordx4 v11, s[48:51], s58 offen offset:2048 lds
    v_fmac_f32 v95, v37, v61
    v_fmac_f32 v80, v36, v47
    v_fmac_f32 v81, v36, v48
    v_fmac_f32 v82, v36, v49
    v_fmac_f32 v83, v36, v50
    buffer_load_dwordx4 v11, s[48:51], s56 offen offset:0 lds
    v_fmac_f32 v84, v36, v51
    v_fmac_f32 v85, v36, v52
    v_fmac_f32 v86, v36, v53
    v_fmac_f32 v87, v36, v54
    v_fmac_f32 v88, v36, v55
    buffer_load_dwordx4 v11, s[48:51], s59 offen offset:3072 lds
    v_fmac_f32 v89, v36, v56
    v_fmac_f32 v90, v36, v57
    v_fmac_f32 v91, v36, v58
    v_fmac_f32 v92, v36, v59
    v_fmac_f32 v93, v36, v60
    s_add_u32 m0, s62, 0
    s_nop 0
    buffer_load_dwordx4 v10, s[44:47], s52 offen offset:0 lds
    v_fmac_f32 v94, v36, v61
    v_fmac_f32 v95, v36, v62
    s_waitcnt lgkmcnt(0)
    v_mul_f32 v80, v80, v64
    v_mul_f32 v81, v81, v65
    v_mul_f32 v82, v82, v66
    buffer_load_dwordx4 v10, s[44:47], s53 offen offset:1024 lds
    v_mul_f32 v83, v83, v67
    v_mul_f32 v84, v84, v68
    v_mul_f32 v85, v85, v69
    v_mul_f32 v86, v86, v70
    v_mul_f32 v87, v87, v71
    buffer_load_dwordx4 v10, s[44:47], s54 offen offset:2048 lds
    v_mul_f32 v88, v88, v72
    v_mul_f32 v89, v89, v73
    v_mul_f32 v90, v90, v74
    v_mul_f32 v91, v91, v75
    v_mul_f32 v92, v92, v76
    buffer_load_dwordx4 v10, s[44:47], s55 offen offset:3072 lds
    v_mul_f32 v93, v93, v77
    v_mul_f32 v94, v94, v78
    v_mul_f32 v95, v95, v79
    v_cvt_pk_bf16_f32 v104, v92, v88
    v_cvt_pk_bf16_f32 v105, v84, v80
    s_add_u32 m0, s62, 8192
    s_nop 0
    buffer_load_dwordx4 v11, s[48:51], s60 offen offset:0 lds
    v_cvt_pk_bf16_f32 v106, v94, v90
    v_cvt_pk_bf16_f32 v107, v86, v82
    v_cvt_pk_bf16_f32 v108, v93, v89
    v_cvt_pk_bf16_f32 v109, v85, v81
    v_cvt_pk_bf16_f32 v110, v95, v91
    buffer_load_dwordx4 v11, s[48:51], s61 offen offset:1024 lds
    v_cvt_pk_bf16_f32 v111, v87, v83
    s_mov_b32 s69, 0x700000
    buffer_store_dwordx4 v[96:99], v25, s[36:39], s69 offen offset:0 sc1
    buffer_store_dwordx4 v[100:103], v25, s[36:39], s69 offen offset:2048 sc1
    s_mov_b32 s69, 0x701080
    buffer_store_dwordx4 v[104:107], v25, s[36:39], s69 offen offset:0 sc1
    buffer_store_dwordx4 v[108:111], v25, s[36:39], s69 offen offset:2048 sc1
    v_add_u32 v10, 128, v10
    v_add_u32 v11, s63, v11
    s_waitcnt vmcnt(14)
    s_barrier
    s_add_u32 m0, s62, 45056
    s_nop 0
    buffer_load_dwordx4 v11, s[48:51], s57 offen offset:1024 lds
    s_lshl_b32 s98, s35, 12
    buffer_load_dwordx4 v11, s[48:51], s58 offen offset:2048 lds
    s_mul_i32 s99, s34, 8320
    buffer_load_dwordx4 v11, s[48:51], s56 offen offset:0 lds
    s_add_u32 s99, s99, 122880
    buffer_load_dwordx4 v11, s[48:51], s59 offen offset:3072 lds
    s_add_u32 m0, s62, 40960
    s_nop 0
    buffer_load_dwordx4 v10, s[44:47], s52 offen offset:0 lds
    buffer_load_dwordx4 v10, s[44:47], s53 offen offset:1024 lds
    buffer_load_dwordx4 v10, s[44:47], s54 offen offset:2048 lds
    buffer_load_dwordx4 v10, s[44:47], s55 offen offset:3072 lds
    s_add_u32 m0, s62, 49152
    s_nop 0
    buffer_load_dwordx4 v11, s[48:51], s60 offen offset:0 lds
    buffer_load_dwordx4 v11, s[48:51], s61 offen offset:1024 lds
    v_add_u32 v10, 128, v10
    v_add_u32 v11, s63, v11
    s_waitcnt vmcnt(14)
    s_barrier
    s_add_u32 m0, s62, 86016
    s_nop 0
    buffer_load_dwordx4 v11, s[48:51], s57 offen offset:1024 lds
    buffer_load_dwordx4 v11, s[48:51], s58 offen offset:2048 lds
    buffer_load_dwordx4 v11, s[48:51], s56 offen offset:0 lds
    buffer_load_dwordx4 v11, s[48:51], s59 offen offset:3072 lds
    s_and_b32 s69, s2, 15
    s_lshl_b32 s69, s69, 2
    s_add_u32 s69, s69, s34
    s_lshl_b32 s4, s69, 7
    s_add_u32 s4, s4, 0x120000
    s_add_u32 s4, s4, s26
    s_addc_u32 s5, s27, 0
    s_mov_b32 s6, 1
    s_waitcnt vmcnt(14)
    s_atomic_add s6, s[4:5], 0
    s_add_u32 m0, s62, 81920
    s_nop 0
    buffer_load_dwordx4 v10, s[44:47], s52 offen offset:0 lds
    buffer_load_dwordx4 v10, s[44:47], s53 offen offset:1024 lds
    buffer_load_dwordx4 v10, s[44:47], s54 offen offset:2048 lds
    buffer_load_dwordx4 v10, s[44:47], s55 offen offset:3072 lds
    s_add_u32 m0, s62, 90112
    s_nop 0
    buffer_load_dwordx4 v11, s[48:51], s60 offen offset:0 lds
    buffer_load_dwordx4 v11, s[48:51], s61 offen offset:1024 lds
    v_add_u32 v10, 128, v10
    v_add_u32 v11, s63, v11
    s_waitcnt vmcnt(10)
    s_barrier
    s_add_u32 m0, s62, 4096
    s_nop 0
    buffer_load_dwordx4 v11, s[48:51], s57 offen offset:1024 lds
    buffer_load_dwordx4 v11, s[48:51], s58 offen offset:2048 lds
    buffer_load_dwordx4 v11, s[48:51], s56 offen offset:0 lds
    buffer_load_dwordx4 v11, s[48:51], s59 offen offset:3072 lds
    s_add_u32 s4, s18, s98
    s_addc_u32 s5, s19, 0
    s_load_dword s6, s[4:5], 0
    s_lshl_b32 s7, s35, 1
    s_and_b32 s7, s7, 0xfffffffc
    s_add_u32 s4, s20, s7
    s_addc_u32 s5, s21, 0
    s_load_dword s7, s[4:5], 0
    s_mul_i32 s97, s34, 4608
    s_add_u32 m0, s62, 0
    s_nop 0
    buffer_load_dwordx4 v10, s[44:47], s52 offen offset:0 lds
    s_add_u32 s97, s97, 98304
    v_add_u32 v32, s97, v1
    buffer_load_dwordx4 v10, s[44:47], s53 offen offset:1024 lds
    v_add_u32 v33, 2048, v32
    v_cmp_gt_u32 vcc, 16, v0
    buffer_load_dwordx4 v10, s[44:47], s54 offen offset:2048 lds
    v_and_b32 v34, 1, v0
    v_lshlrev_b32 v34, 4, v34
    buffer_load_dwordx4 v10, s[44:47], s55 offen offset:3072 lds
    v_cndmask_b32 v32, v33, v32, vcc
    v_bfe_u32 v35, v0, 1, 1
    s_add_u32 m0, s62, 8192
    s_nop 0
    buffer_load_dwordx4 v11, s[48:51], s60 offen offset:0 lds
    v_mul_u32_u24 v35, 4160, v35
    v_cmp_gt_u32 vcc, 32, v0
    buffer_load_dwordx4 v11, s[48:51], s61 offen offset:1024 lds
    v_add3_u32 v34, v34, v35, s99
    v_mov_b32 v36, 0
    v_add_u32 v10, 128, v10
    v_add_u32 v11, s63, v11
    v_mov_b32 v37, 0
    v_mov_b32 v38, 0
    v_mov_b32 v39, 0
    v_cndmask_b32 v32, v34, v32, vcc
    s_waitcnt vmcnt(10)
    s_barrier
    s_add_u32 m0, s62, 45056
    s_nop 0
    buffer_load_dwordx4 v11, s[48:51], s57 offen offset:1024 lds
    v_and_b32 v34, 3, v0
    v_lshlrev_b32 v30, 2, v34
    v_add_u32 v30, 156160, v30
    v_bfe_u32 v35, v0, 2, 2
    buffer_load_dwordx4 v11, s[48:51], s58 offen offset:2048 lds
    v_add_u32 v34, v34, v35
    v_lshlrev_b32 v34, 3, v34
    v_lshl_add_u32 v34, v5, 5, v34
    s_add_u32 s69, s99, 8
    buffer_load_dwordx4 v11, s[48:51], s56 offen offset:0 lds
    v_add_u32 v6, s69, v34
    v_and_b32 v34, 15, v0
    v_sub_u32 v34, v34, v5
    v_lshlrev_b32 v34, 4, v34
    buffer_load_dwordx4 v11, s[48:51], s59 offen offset:3072 lds
    s_add_u32 s69, s97, 192
    v_add_u32 v7, s69, v34
    v_mov_b32 v5, s99
    v_subrev_u32 v8, 16, v0
    s_add_u32 m0, s62, 40960
    s_nop 0
    buffer_load_dwordx4 v10, s[44:47], s52 offen offset:0 lds
    v_add_u32 v9, 47, v0
    v_cmp_gt_u32 vcc, 16, v0
    v_mov_b32 v34, 63
    s_lshl_b32 s69, s34, 2
    buffer_load_dwordx4 v10, s[44:47], s53 offen offset:1024 lds
    v_cndmask_b32 v8, v8, v9, vcc
    v_cmp_eq_u32 vcc, 0, v0
    s_add_u32 s69, s69, 156192
    v_mov_b32 v9, s69
    buffer_load_dwordx4 v10, s[44:47], s54 offen offset:2048 lds
    v_cndmask_b32 v8, v8, v34, vcc
    v_lshlrev_b32 v8, 2, v8
    s_waitcnt lgkmcnt(0)
    s_lshl_b32 s6, s6, 16
    buffer_load_dwordx4 v10, s[44:47], s55 offen offset:3072 lds
    s_and_b32 s69, s35, 1
    s_lshl_b32 s69, s69, 4
    s_lshr_b32 s7, s7, s69
    s_lshl_b32 s7, s7, 16
    s_add_u32 m0, s62, 49152
    s_nop 0
    buffer_load_dwordx4 v11, s[48:51], s60 offen offset:0 lds
    v_mov_b32 v33, s6
    v_add_f32 v33, s7, v33
    v_cvt_pk_bf16_f32 v33, v33, v33
    buffer_load_dwordx4 v11, s[48:51], s61 offen offset:1024 lds
    v_add_u32 v10, 128, v10
    v_add_u32 v11, s63, v11
    s_waitcnt vmcnt(10)
    s_barrier
    s_lshl_b32 s97, s34, 2
    s_add_u32 s97, s97, 156288
    v_mov_b32 v28, s97
    v_mov_b32 v29, 1
    s_waitcnt vmcnt(0)
    ds_write_b32 v28, v29
    s_mov_b32 s40, s18
    s_mov_b32 s41, s19
    s_mov_b32 s42, 0x400000
    s_mov_b32 s43, 0x00020000
    s_add_u32 m0, s99, 32
    s_nop 0
    buffer_load_dwordx4 v1, s[40:43], s98 offen offset:0 lds
    s_add_u32 m0, s99, 4196
    s_nop 0
    buffer_load_dwordx4 v1, s[40:43], s98 offen offset:0 lds
    s_add_u32 m0, s99, 32
    s_nop 0
    buffer_load_dwordx4 v1, s[40:43], s98 offen offset:1024 lds
    s_add_u32 m0, s99, 4196
    s_nop 0
    buffer_load_dwordx4 v1, s[40:43], s98 offen offset:1024 lds
    s_add_u32 m0, s99, 32
    s_nop 0
    buffer_load_dwordx4 v1, s[40:43], s98 offen offset:2048 lds
    s_add_u32 m0, s99, 4196
    s_nop 0
    buffer_load_dwordx4 v1, s[40:43], s98 offen offset:2048 lds
    s_add_u32 m0, s99, 32
    s_nop 0
    buffer_load_dwordx4 v1, s[40:43], s98 offen offset:3072 lds
    s_add_u32 m0, s99, 4196
    s_nop 0
    buffer_load_dwordx4 v1, s[40:43], s98 offen offset:3072 lds
    s_cmp_ge_u32 s34, 2
    s_cbranch_scc1 F_QL2
    s_mov_b32 s40, s10
    s_mov_b32 s41, s11
    s_mov_b32 s42, 0x400000
    s_mov_b32 s43, 0x00020000
    s_and_b32 s69, s2, 15
    s_lshl_b32 s69, s69, 7
    s_add_u32 s97, s69, 0
    buffer_load_dwordx4 v[200:203], v234, s[40:43], s97 offen offset:0 nt
    s_add_u32 s97, s69, 0
    buffer_load_dwordx4 v[204:207], v234, s[40:43], s97 offen offset:2048 nt
    s_add_u32 s97, s69, 4096
    buffer_load_dwordx4 v[208:211], v234, s[40:43], s97 offen offset:0 nt
    s_add_u32 s97, s69, 4096
    buffer_load_dwordx4 v[212:215], v234, s[40:43], s97 offen offset:2048 nt
    s_add_u32 s97, s69, 524288
    buffer_load_dwordx4 v[216:219], v234, s[40:43], s97 offen offset:0 nt
    s_add_u32 s97, s69, 524288
    buffer_load_dwordx4 v[220:223], v234, s[40:43], s97 offen offset:2048 nt
    s_add_u32 s97, s69, 528384
    buffer_load_dwordx4 v[224:227], v234, s[40:43], s97 offen offset:0 nt
    s_add_u32 s97, s69, 528384
    buffer_load_dwordx4 v[228:231], v234, s[40:43], s97 offen offset:2048 nt
F_QL2:
    s_mul_i32 s52, s34, 4608
    s_add_u32 s52, s52, 98304
    s_mul_i32 s63, s35, 4224
    s_add_u32 s53, s63, 0x700000
    s_mov_b32 s40, s8
    s_mov_b32 s41, s9
    s_mov_b32 s42, 0x200000
    s_mov_b32 s43, 0x00020000
    s_lshl_b32 s62, s34, 10
    s_lshl_b32 s100, s34, 14
    s_lshl_b32 s101, s33, 7
    s_add_u32 s100, s100, s101
    s_lshr_b32 s69, s35, 4
    s_lshl_b32 s54, s69, 7
    s_add_u32 s54, s54, 0x120000
    s_add_u32 s54, s54, s26
    s_addc_u32 s55, s27, 0
    s_mov_b32 s101, 0
F_P1:
    s_mov_b32 s69, 0
    s_atomic_add s69, s[54:55], 0 glc
    s_waitcnt lgkmcnt(0)
    s_cmp_ge_u32 s69, 16
    s_cbranch_scc1 F_P1_X
    s_sleep 4
    s_add_u32 s101, s101, 1
    s_cmp_lt_u32 s101, 400000
    s_cbranch_scc1 F_P1
F_P1_X:
    s_add_u32 m0, s52, 256
    s_nop 0
    buffer_load_dwordx4 v1, s[36:39], s53 offen offset:0 sc1 lds
    buffer_load_dwordx4 v1, s[36:39], s53 offen offset:1024 sc1 lds
    s_add_u32 m0, s52, 512
    s_nop 0
    buffer_load_dwordx4 v1, s[36:39], s53 offen offset:2048 sc1 lds
    buffer_load_dwordx4 v1, s[36:39], s53 offen offset:3072 sc1 lds
    ds_write_b128 v32, v[36:39]
    ds_write_b32 v5, v36 offset:4192
    s_add_u32 m0, s62, 81920
    s_add_u32 s101, s100, 0
    buffer_load_dwordx4 v12, s[40:43], s101 offen lds
    s_add_u32 m0, s62, 86016
    s_add_u32 s101, s100, 65536
    buffer_load_dwordx4 v12, s[40:43], s101 offen lds
    s_add_u32 m0, s62, 90112
    s_add_u32 s101, s100, 131072
    buffer_load_dwordx4 v12, s[40:43], s101 offen lds
    s_add_u32 m0, s62, 94208
    s_add_u32 s101, s100, 196608
    buffer_load_dwordx4 v12, s[40:43], s101 offen lds
    v_mov_b32 v96, 0
    v_mov_b32 v97, 0
    v_mov_b32 v98, 0
    v_mov_b32 v99, 0
    v_mov_b32 v100, 0
    v_mov_b32 v101, 0
    v_mov_b32 v102, 0
    v_mov_b32 v103, 0
    v_mov_b32 v104, 0
    v_mov_b32 v105, 0
    v_mov_b32 v106, 0
    v_mov_b32 v107, 0
    v_mov_b32 v108, 0
    v_mov_b32 v109, 0
    v_mov_b32 v110, 0
    v_mov_b32 v111, 0
    v_mov_b32 v112, 0
    v_mov_b32 v113, 0
    v_mov_b32 v114, 0
    v_mov_b32 v115, 0
    v_mov_b32 v116, 0
    v_mov_b32 v117, 0
    v_mov_b32 v118, 0
    v_mov_b32 v119, 0
    v_mov_b32 v120, 0
    v_mov_b32 v121, 0
    v_mov_b32 v122, 0
    v_mov_b32 v123, 0
    v_mov_b32 v124, 0
    v_mov_b32 v125, 0
    v_mov_b32 v126, 0
    v_mov_b32 v127, 0
    v_mov_b32 v128, 0
    v_mov_b32 v129, 0
    v_mov_b32 v130, 0
    v_mov_b32 v131, 0
    v_mov_b32 v132, 0
    v_mov_b32 v133, 0
    v_mov_b32 v134, 0
    v_mov_b32 v135, 0
    v_mov_b32 v136, 0
    v_mov_b32 v137, 0
    v_mov_b32 v138, 0
    v_mov_b32 v139, 0
    v_mov_b32 v140, 0
    v_mov_b32 v141, 0
    v_mov_b32 v142, 0
    v_mov_b32 v143, 0
    v_mov_b32 v144, 0
    v_mov_b32 v145, 0
    v_mov_b32 v146, 0
    v_mov_b32 v147, 0
    v_mov_b32 v148, 0
    v_mov_b32 v149, 0
    v_mov_b32 v150, 0
    v_mov_b32 v151, 0
    v_mov_b32 v152, 0
    v_mov_b32 v153, 0
    v_mov_b32 v154, 0
    v_mov_b32 v155, 0
    v_mov_b32 v156, 0
    v_mov_b32 v157, 0
    v_mov_b32 v158, 0
    v_mov_b32 v159, 0
F_WG14:
    ds_read_b32 v11, v30 offset:112
    s_waitcnt lgkmcnt(0)
    v_cmp_ne_u32 vcc, 1, v11
    s_cbranch_vccz F_WG14_X
    s_sleep 1
    s_branch F_WG14
F_WG14_X:
    s_add_u32 m0, s62, 0
    s_add_u32 s101, s100, 262144
    buffer_load_dwordx4 v12, s[40:43], s101 offen lds
    s_add_u32 m0, s62, 4096
    s_add_u32 s101, s100, 327680
    buffer_load_dwordx4 v12, s[40:43], s101 offen lds
    s_add_u32 m0, s62, 8192
    s_add_u32 s101, s100, 393216
    buffer_load_dwordx4 v12, s[40:43], s101 offen lds
    s_add_u32 m0, s62, 12288
    s_add_u32 s101, s100, 458752
    buffer_load_dwordx4 v12, s[40:43], s101 offen lds
    s_add_u32 m0, s62, 16384
    s_add_u32 s101, s100, 524288
    buffer_load_dwordx4 v12, s[40:43], s101 offen lds
    s_add_u32 m0, s62, 20480
    s_add_u32 s101, s100, 589824
    buffer_load_dwordx4 v12, s[40:43], s101 offen lds
    s_add_u32 m0, s62, 24576
    s_add_u32 s101, s100, 655360
    buffer_load_dwordx4 v12, s[40:43], s101 offen lds
    s_add_u32 m0, s62, 28672
    s_add_u32 s101, s100, 720896
    buffer_load_dwordx4 v12, s[40:43], s101 offen lds
    s_add_u32 m0, s62, 32768
    s_add_u32 s101, s100, 786432
    buffer_load_dwordx4 v12, s[40:43], s101 offen lds
    s_add_u32 m0, s62, 36864
    s_add_u32 s101, s100, 851968
    buffer_load_dwordx4 v12, s[40:43], s101 offen lds
F_WGDx:
    ds_read_b32 v11, v30 offset:80
    s_waitcnt lgkmcnt(0)
    v_cmp_ne_u32 vcc, 1, v11
    s_cbranch_vccz F_WGDx_X
    s_sleep 1
    s_branch F_WGDx
F_WGDx_X:
    s_add_u32 m0, s62, 40960
    s_add_u32 s101, s100, 917504
    buffer_load_dwordx4 v12, s[40:43], s101 offen lds
    s_add_u32 m0, s62, 45056
    s_add_u32 s101, s100, 983040
    buffer_load_dwordx4 v12, s[40:43], s101 offen lds
    s_add_u32 m0, s62, 49152
    s_add_u32 s101, s100, 1048576
    buffer_load_dwordx4 v12, s[40:43], s101 offen lds
    s_add_u32 m0, s62, 53248
    s_add_u32 s101, s100, 1114112
    buffer_load_dwordx4 v12, s[40:43], s101 offen lds
    s_add_u32 m0, s62, 57344
    s_add_u32 s101, s100, 1179648
    buffer_load_dwordx4 v12, s[40:43], s101 offen lds
    s_add_u32 m0, s62, 61440
    s_add_u32 s101, s100, 1245184
    buffer_load_dwordx4 v12, s[40:43], s101 offen lds
    s_add_u32 m0, s62, 65536
    s_add_u32 s101, s100, 1310720
    buffer_load_dwordx4 v12, s[40:43], s101 offen lds
    s_add_u32 m0, s62, 69632
    s_add_u32 s101, s100, 1376256
    buffer_load_dwordx4 v12, s[40:43], s101 offen lds
    s_add_u32 m0, s62, 73728
    s_add_u32 s101, s100, 1441792
    buffer_load_dwordx4 v12, s[40:43], s101 offen lds
    s_add_u32 m0, s62, 77824
    s_add_u32 s101, s100, 1507328
    buffer_load_dwordx4 v12, s[40:43], s101 offen lds
    s_waitcnt vmcnt(24)
    ds_write_b16 v5, v33 offset:32
    ds_write_b16 v5, v33 offset:4196
    ds_read_b128 v[76:79], v7 offset:1856
    ds_read_b64_tr_b16 v[16:17], v6 offset:0
    ds_read_b64_tr_b16 v[18:19], v6 offset:4160
    ds_read_b128 v[72:75], v7 offset:1600
    ds_read_b64_tr_b16 v[20:21], v6 offset:512
    ds_read_b64_tr_b16 v[22:23], v6 offset:4672
    ds_read_b128 v[68:71], v7 offset:1344
    ds_read_b64_tr_b16 v[24:25], v6 offset:1024
    ds_read_b64_tr_b16 v[26:27], v6 offset:5184
    ds_read_b128 v[64:67], v7 offset:1088
    ds_read_b64_tr_b16 v[28:29], v6 offset:1536
    ds_read_b64_tr_b16 v[30:31], v6 offset:5696
    ds_read_b128 v[60:63], v7 offset:832
    ds_read_b64_tr_b16 v[32:33], v6 offset:2048
    ds_read_b64_tr_b16 v[34:35], v6 offset:6208
    ds_read_b128 v[56:59], v7 offset:576
    ds_read_b64_tr_b16 v[36:37], v6 offset:2560
    ds_read_b64_tr_b16 v[38:39], v6 offset:6720
    ds_read_b128 v[52:55], v7 offset:320
    ds_read_b64_tr_b16 v[40:41], v6 offset:3072
    ds_read_b64_tr_b16 v[42:43], v6 offset:7232
    ds_read_b128 v[48:51], v7 offset:64
    ds_read_b64_tr_b16 v[44:45], v6 offset:3584
    ds_read_b64_tr_b16 v[46:47], v6 offset:7744
    v_mov_b32 v10, 1
    s_mov_b64 s[60:61], 1
    s_mov_b32 s58, 0
    s_movk_i32 s59, 4096
.p2align 6
F_VLOOP:
    s_waitcnt lgkmcnt(15)
    v_mfma_f32_16x16x32_bf16 v[124:127], v[16:19], v[76:79], v[124:127]
    ds_read_b128 v[80:83], v7 offset:2368
    ds_read_b128 v[76:79], v7 offset:4160
    v_mfma_f32_16x16x32_bf16 v[120:123], v[16:19], v[72:75], v[120:123]
    v_mfma_f32_16x16x32_bf16 v[124:127], v[20:23], v[72:75], v[124:127]
    ds_read_b128 v[72:75], v7 offset:3904
    v_mfma_f32_16x16x32_bf16 v[116:119], v[16:19], v[68:71], v[116:119]
    v_mfma_f32_16x16x32_bf16 v[120:123], v[20:23], v[68:71], v[120:123]
    s_waitcnt lgkmcnt(15)
    v_mfma_f32_16x16x32_bf16 v[124:127], v[24:27], v[68:71], v[124:127]
    ds_read_b128 v[68:71], v7 offset:3648
    s_waitcnt lgkmcnt(15)
    v_mfma_f32_16x16x32_bf16 v[112:115], v[16:19], v[64:67], v[112:115]
    v_mfma_f32_16x16x32_bf16 v[116:119], v[20:23], v[64:67], v[116:119]
    v_mfma_f32_16x16x32_bf16 v[120:123], v[24:27], v[64:67], v[120:123]
    v_mfma_f32_16x16x32_bf16 v[124:127], v[28:31], v[64:67], v[124:127]
    ds_read_b128 v[64:67], v7 offset:3392
    s_waitcnt lgkmcnt(15)
    v_mfma_f32_16x16x32_bf16 v[108:111], v[16:19], v[60:63], v[108:111]
    v_mfma_f32_16x16x32_bf16 v[112:115], v[20:23], v[60:63], v[112:115]
    v_mfma_f32_16x16x32_bf16 v[116:119], v[24:27], v[60:63], v[116:119]
    v_mfma_f32_16x16x32_bf16 v[120:123], v[28:31], v[60:63], v[120:123]
    s_waitcnt lgkmcnt(13)
    v_mfma_f32_16x16x32_bf16 v[124:127], v[32:35], v[60:63], v[124:127]
    ds_read_b128 v[60:63], v7 offset:3136
    s_waitcnt lgkmcnt(13)
    v_mfma_f32_16x16x32_bf16 v[104:107], v[16:19], v[56:59], v[104:107]
    v_mfma_f32_16x16x32_bf16 v[108:111], v[20:23], v[56:59], v[108:111]
    v_mfma_f32_16x16x32_bf16 v[112:115], v[24:27], v[56:59], v[112:115]
    v_mfma_f32_16x16x32_bf16 v[116:119], v[28:31], v[56:59], v[116:119]
    v_mfma_f32_16x16x32_bf16 v[120:123], v[32:35], v[56:59], v[120:123]
    s_waitcnt lgkmcnt(11)
    v_mfma_f32_16x16x32_bf16 v[124:127], v[36:39], v[56:59], v[124:127]
    ds_read_b128 v[56:59], v7 offset:2880
    s_waitcnt lgkmcnt(11)
    v_mfma_f32_16x16x32_bf16 v[100:103], v[16:19], v[52:55], v[100:103]
    v_mfma_f32_16x16x32_bf16 v[104:107], v[20:23], v[52:55], v[104:107]
    v_mfma_f32_16x16x32_bf16 v[108:111], v[24:27], v[52:55], v[108:111]
    v_mfma_f32_16x16x32_bf16 v[112:115], v[28:31], v[52:55], v[112:115]
    v_mfma_f32_16x16x32_bf16 v[116:119], v[32:35], v[52:55], v[116:119]
    v_mfma_f32_16x16x32_bf16 v[120:123], v[36:39], v[52:55], v[120:123]
    s_waitcnt lgkmcnt(9)
    v_mfma_f32_16x16x32_bf16 v[124:127], v[40:43], v[52:55], v[124:127]
    ds_read_b128 v[52:55], v7 offset:2624
    s_waitcnt lgkmcnt(10)
    v_mfma_f32_16x16x32_bf16 v[96:99], v[16:19], v[48:51], v[96:99]
    v_mfma_f32_16x16x32_bf16 v[100:103], v[20:23], v[48:51], v[100:103]
    v_mfma_f32_16x16x32_bf16 v[104:107], v[24:27], v[48:51], v[104:107]
    v_mfma_f32_16x16x32_bf16 v[108:111], v[28:31], v[48:51], v[108:111]
    v_mfma_f32_16x16x32_bf16 v[112:115], v[32:35], v[48:51], v[112:115]
    v_mfma_f32_16x16x32_bf16 v[116:119], v[36:39], v[48:51], v[116:119]
    v_mfma_f32_16x16x32_bf16 v[120:123], v[40:43], v[48:51], v[120:123]
    s_waitcnt lgkmcnt(8)
    v_mfma_f32_16x16x32_bf16 v[124:127], v[44:47], v[48:51], v[124:127]
    s_waitcnt lgkmcnt(6)
    v_mfma_f32_16x16x32_bf16 v[156:159], v[16:19], v[76:79], v[156:159]
    ds_read_b128 v[48:51], v7 offset:0
    ds_read_b128 v[76:79], v7 offset:1792
    s_waitcnt lgkmcnt(7)
    v_mfma_f32_16x16x32_bf16 v[152:155], v[16:19], v[72:75], v[152:155]
    s_waitcnt lgkmcnt(6)
    v_mfma_f32_16x16x32_bf16 v[148:151], v[16:19], v[68:71], v[148:151]
    s_waitcnt lgkmcnt(5)
    v_mfma_f32_16x16x32_bf16 v[144:147], v[16:19], v[64:67], v[144:147]
    s_waitcnt lgkmcnt(4)
    v_mfma_f32_16x16x32_bf16 v[140:143], v[16:19], v[60:63], v[140:143]
    s_waitcnt lgkmcnt(3)
    v_mfma_f32_16x16x32_bf16 v[136:139], v[16:19], v[56:59], v[136:139]
    s_waitcnt lgkmcnt(2)
    v_mfma_f32_16x16x32_bf16 v[132:135], v[16:19], v[52:55], v[132:135]
    v_mfma_f32_16x16x32_bf16 v[128:131], v[16:19], v[80:83], v[128:131]
    ds_read_b64_tr_b16 v[16:17], v6 offset:128
    ds_read_b64_tr_b16 v[18:19], v6 offset:4288
    v_mfma_f32_16x16x32_bf16 v[156:159], v[20:23], v[72:75], v[156:159]
    ds_read_b128 v[72:75], v7 offset:1536
    v_mfma_f32_16x16x32_bf16 v[152:155], v[20:23], v[68:71], v[152:155]
    v_mfma_f32_16x16x32_bf16 v[148:151], v[20:23], v[64:67], v[148:151]
    v_mfma_f32_16x16x32_bf16 v[144:147], v[20:23], v[60:63], v[144:147]
    v_mfma_f32_16x16x32_bf16 v[140:143], v[20:23], v[56:59], v[140:143]
    v_mfma_f32_16x16x32_bf16 v[136:139], v[20:23], v[52:55], v[136:139]
    v_mfma_f32_16x16x32_bf16 v[132:135], v[20:23], v[80:83], v[132:135]
    ds_read_b64_tr_b16 v[20:21], v6 offset:640
    ds_read_b64_tr_b16 v[22:23], v6 offset:4800
    v_mfma_f32_16x16x32_bf16 v[156:159], v[24:27], v[68:71], v[156:159]
    ds_read_b128 v[68:71], v7 offset:1280
    v_mfma_f32_16x16x32_bf16 v[152:155], v[24:27], v[64:67], v[152:155]
    v_mfma_f32_16x16x32_bf16 v[148:151], v[24:27], v[60:63], v[148:151]
    v_mfma_f32_16x16x32_bf16 v[144:147], v[24:27], v[56:59], v[144:147]
    v_mfma_f32_16x16x32_bf16 v[140:143], v[24:27], v[52:55], v[140:143]
    v_mfma_f32_16x16x32_bf16 v[136:139], v[24:27], v[80:83], v[136:139]
    ds_read_b64_tr_b16 v[24:25], v6 offset:1152
    ds_read_b64_tr_b16 v[26:27], v6 offset:5312
    v_mfma_f32_16x16x32_bf16 v[156:159], v[28:31], v[64:67], v[156:159]
    ds_read_b128 v[64:67], v7 offset:1024
    v_mfma_f32_16x16x32_bf16 v[152:155], v[28:31], v[60:63], v[152:155]
    v_mfma_f32_16x16x32_bf16 v[148:151], v[28:31], v[56:59], v[148:151]
    v_mfma_f32_16x16x32_bf16 v[144:147], v[28:31], v[52:55], v[144:147]
    v_mfma_f32_16x16x32_bf16 v[140:143], v[28:31], v[80:83], v[140:143]
    ds_read_b64_tr_b16 v[28:29], v6 offset:1664
    ds_read_b64_tr_b16 v[30:31], v6 offset:5824
    v_mfma_f32_16x16x32_bf16 v[156:159], v[32:35], v[60:63], v[156:159]
    ds_read_b128 v[60:63], v7 offset:768
    v_mfma_f32_16x16x32_bf16 v[152:155], v[32:35], v[56:59], v[152:155]
    v_mfma_f32_16x16x32_bf16 v[148:151], v[32:35], v[52:55], v[148:151]
    v_mfma_f32_16x16x32_bf16 v[144:147], v[32:35], v[80:83], v[144:147]
    ds_read_b64_tr_b16 v[32:33], v6 offset:2176
    ds_read_b64_tr_b16 v[34:35], v6 offset:6336
    v_mfma_f32_16x16x32_bf16 v[156:159], v[36:39], v[56:59], v[156:159]
    ds_read_b128 v[56:59], v7 offset:512
    v_mfma_f32_16x16x32_bf16 v[152:155], v[36:39], v[52:55], v[152:155]
    v_mfma_f32_16x16x32_bf16 v[148:151], v[36:39], v[80:83], v[148:151]
    ds_read_b64_tr_b16 v[36:37], v6 offset:2688
    ds_read_b64_tr_b16 v[38:39], v6 offset:6848
    v_mfma_f32_16x16x32_bf16 v[156:159], v[40:43], v[52:55], v[156:159]
    ds_read_b128 v[52:55], v7 offset:256
    v_mfma_f32_16x16x32_bf16 v[152:155], v[40:43], v[80:83], v[152:155]
    ds_read_b64_tr_b16 v[40:41], v6 offset:3200
    ds_read_b64_tr_b16 v[42:43], v6 offset:7360
    v_mfma_f32_16x16x32_bf16 v[156:159], v[44:47], v[80:83], v[156:159]
    ds_read_b64_tr_b16 v[44:45], v6 offset:3712
    ds_read_b64_tr_b16 v[46:47], v6 offset:7872
    s_waitcnt vmcnt(0)
    ds_write_b32 v9, v10 offset:112
F_VWX:
    v_add_u32 v6, 128, v6
    v_subrev_u32 v7, 64, v7
    s_add_u32 s58, s58, 1
    s_cmp_lt_u32 s58, 4
    s_cbranch_scc1 F_VLOOP
    s_waitcnt lgkmcnt(0)
    ds_write_b32 v9, v10
    ds_bpermute_b32 v17, v8, v131
    ds_bpermute_b32 v18, v8, v135
    ds_bpermute_b32 v19, v8, v139
    ds_bpermute_b32 v20, v8, v143
    ds_bpermute_b32 v21, v8, v147
    ds_bpermute_b32 v22, v8, v151
    ds_bpermute_b32 v23, v8, v155
    ds_bpermute_b32 v24, v8, v159
    v_mov_b32 v16, 0
    v_add_f32 v97, v97, v128
    v_add_f32 v98, v98, v129
    v_add_f32 v99, v99, v130
    v_add_f32 v101, v101, v132
    v_add_f32 v102, v102, v133
    v_add_f32 v103, v103, v134
    v_add_f32 v105, v105, v136
    v_add_f32 v106, v106, v137
    v_add_f32 v107, v107, v138
    v_add_f32 v109, v109, v140
    v_add_f32 v110, v110, v141
    v_add_f32 v111, v111, v142
    v_add_f32 v113, v113, v144
    v_add_f32 v114, v114, v145
    v_add_f32 v115, v115, v146
    v_add_f32 v117, v117, v148
    v_add_f32 v118, v118, v149
    v_add_f32 v119, v119, v150
    v_add_f32 v121, v121, v152
    v_add_f32 v122, v122, v153
    v_add_f32 v123, v123, v154
    v_add_f32 v125, v125, v156
    v_add_f32 v126, v126, v157
    v_add_f32 v127, v127, v158
    s_waitcnt lgkmcnt(0)
    v_cndmask_b32 v28, v17, v16, s[60:61]
    v_cndmask_b32 v29, v18, v17, s[60:61]
    v_cndmask_b32 v30, v19, v18, s[60:61]
    v_cndmask_b32 v31, v20, v19, s[60:61]
    v_cndmask_b32 v32, v21, v20, s[60:61]
    v_cndmask_b32 v33, v22, v21, s[60:61]
    v_cndmask_b32 v34, v23, v22, s[60:61]
    v_cndmask_b32 v35, v24, v23, s[60:61]
    v_add_f32 v96, v96, v28
    v_add_f32 v100, v100, v29
    v_add_f32 v104, v104, v30
    v_add_f32 v108, v108, v31
    v_add_f32 v112, v112, v32
    v_add_f32 v116, v116, v33
    v_add_f32 v120, v120, v34
    v_add_f32 v124, v124, v35
    v_cvt_pk_bf16_f32 v48, v96, v97
    v_cvt_pk_bf16_f32 v49, v98, v99
    v_cvt_pk_bf16_f32 v50, v100, v101
    v_cvt_pk_bf16_f32 v51, v102, v103
    v_cvt_pk_bf16_f32 v52, v104, v105
    v_cvt_pk_bf16_f32 v53, v106, v107
    v_cvt_pk_bf16_f32 v54, v108, v109
    v_cvt_pk_bf16_f32 v55, v110, v111
    v_cvt_pk_bf16_f32 v56, v112, v113
    v_cvt_pk_bf16_f32 v57, v114, v115
    v_cvt_pk_bf16_f32 v58, v116, v117
    v_cvt_pk_bf16_f32 v59, v118, v119
    v_cvt_pk_bf16_f32 v60, v120, v121
    v_cvt_pk_bf16_f32 v61, v122, v123
    v_cvt_pk_bf16_f32 v62, v124, v125
    v_cvt_pk_bf16_f32 v63, v126, v127
    s_add_u32 s53, s63, 0xc00000
    buffer_store_dwordx4 v[48:51], v1, s[36:39], s53 offen offset:0 sc1
    buffer_store_dwordx4 v[52:55], v1, s[36:39], s53 offen offset:1024 sc1
    buffer_store_dwordx4 v[56:59], v1, s[36:39], s53 offen offset:2048 sc1
    buffer_store_dwordx4 v[60:63], v1, s[36:39], s53 offen offset:3072 sc1
    s_lshr_b32 s69, s35, 6
    s_lshl_b32 s4, s69, 7
    s_add_u32 s4, s4, 0x125000
    s_add_u32 s4, s4, s26
    s_addc_u32 s5, s27, 0
    s_mov_b32 s69, 1
    s_cmp_ge_u32 s34, 2
    s_cbranch_scc0 F_POST
    v_and_b32 v9, 3, v0
    v_lshlrev_b32 v9, 2, v9
    v_and_b32 v11, 4, v0
    v_lshl_add_u32 v9, v11, 3, v9
    v_add_u32 v9, 156192, v9
F_WL:
    ds_read_b32 v11, v9 offset:0
    s_waitcnt lgkmcnt(0)
    v_cmp_ne_u32 vcc, 1, v11
    s_cbranch_vccz F_WL_X
    s_sleep 1
    s_branch F_WL
F_WL_X:
    s_add_u32 s62, s62, 96256
    s_add_u32 s100, s100, 1540096
    s_add_u32 m0, s62, 0
    s_add_u32 s101, s100, 0
    buffer_load_dwordx4 v12, s[40:43], s101 offen lds
    s_add_u32 m0, s62, 2048
    s_add_u32 s101, s100, 32768
    buffer_load_dwordx4 v12, s[40:43], s101 offen lds
    s_add_u32 m0, s62, 4096
    s_add_u32 s101, s100, 65536
    buffer_load_dwordx4 v12, s[40:43], s101 offen lds
    s_add_u32 m0, s62, 6144
    s_add_u32 s101, s100, 98304
    buffer_load_dwordx4 v12, s[40:43], s101 offen lds
    s_add_u32 m0, s62, 8192
    s_add_u32 s101, s100, 131072
    buffer_load_dwordx4 v12, s[40:43], s101 offen lds
    s_add_u32 m0, s62, 10240
    s_add_u32 s101, s100, 163840
    buffer_load_dwordx4 v12, s[40:43], s101 offen lds
    s_add_u32 m0, s62, 12288
    s_add_u32 s101, s100, 196608
    buffer_load_dwordx4 v12, s[40:43], s101 offen lds
    s_add_u32 m0, s62, 14336
    s_add_u32 s101, s100, 229376
    buffer_load_dwordx4 v12, s[40:43], s101 offen lds
    s_add_u32 m0, s62, 16384
    s_add_u32 s101, s100, 262144
    buffer_load_dwordx4 v12, s[40:43], s101 offen lds
    s_add_u32 m0, s62, 18432
    s_add_u32 s101, s100, 294912
    buffer_load_dwordx4 v12, s[40:43], s101 offen lds
    s_add_u32 m0, s62, 20480
    s_add_u32 s101, s100, 327680
    buffer_load_dwordx4 v12, s[40:43], s101 offen lds
    s_add_u32 m0, s62, 22528
    s_add_u32 s101, s100, 360448
    buffer_load_dwordx4 v12, s[40:43], s101 offen lds
    s_add_u32 m0, s62, 24576
    s_add_u32 s101, s100, 393216
    buffer_load_dwordx4 v12, s[40:43], s101 offen lds
    s_add_u32 m0, s62, 26624
    s_add_u32 s101, s100, 425984
    buffer_load_dwordx4 v12, s[40:43], s101 offen lds
    s_add_u32 m0, s62, 28672
    s_add_u32 s101, s100, 458752
    buffer_load_dwordx4 v12, s[40:43], s101 offen lds
    s_add_u32 m0, s62, 30720
    s_add_u32 s101, s100, 491520
    buffer_load_dwordx4 v12, s[40:43], s101 offen lds
    s_waitcnt vmcnt(16)
    s_atomic_add s69, s[4:5], 0
    s_lshl_b32 s58, s34, 2
    s_add_u32 s58, s58, 156200
    v_mov_b32 v9, s58
    s_waitcnt vmcnt(0)
    ds_write_b32 v9, v10
    s_waitcnt lgkmcnt(0)
    s_endpgm
F_POST:
    s_and_b32 s52, s2, 15
    s_lshl_b32 s56, s52, 7
    s_mul_i32 s53, s52, 270336
    s_add_u32 s53, s53, 0xc00000
    s_mov_b32 s44, s22
    s_mov_b32 s45, s23
    s_mov_b32 s46, 0x800000
    s_mov_b32 s47, 0x00020000
    s_mov_b32 s55, 0xffff0000
    s_add_u32 s56, s56, 2048
    s_waitcnt vmcnt(0)
    s_atomic_add s69, s[4:5], 0
    v_lshlrev_b32 v132, 16, v200
    v_and_b32 v133, s55, v200
    v_lshlrev_b32 v134, 16, v201
    v_and_b32 v135, s55, v201
    v_lshlrev_b32 v136, 16, v202
    v_and_b32 v137, s55, v202
    v_lshlrev_b32 v138, 16, v203
    v_and_b32 v139, s55, v203
    v_lshlrev_b32 v140, 16, v204
    v_and_b32 v141, s55, v204
    v_lshlrev_b32 v142, 16, v205
    v_and_b32 v143, s55, v205
    v_lshlrev_b32 v144, 16, v206
    v_and_b32 v145, s55, v206
    v_lshlrev_b32 v146, 16, v207
    v_and_b32 v147, s55, v207
    v_lshlrev_b32 v148, 16, v208
    v_and_b32 v149, s55, v208
    v_lshlrev_b32 v150, 16, v209
    v_and_b32 v151, s55, v209
    v_lshlrev_b32 v152, 16, v210
    v_and_b32 v153, s55, v210
    v_lshlrev_b32 v154, 16, v211
    v_and_b32 v155, s55, v211
    v_lshlrev_b32 v156, 16, v212
    v_and_b32 v157, s55, v212
    v_lshlrev_b32 v158, 16, v213
    v_and_b32 v159, s55, v213
    v_lshlrev_b32 v160, 16, v214
    v_and_b32 v161, s55, v214
    v_lshlrev_b32 v162, 16, v215
    v_and_b32 v163, s55, v215
    v_lshlrev_b32 v164, 16, v216
    v_and_b32 v165, s55, v216
    v_lshlrev_b32 v166, 16, v217
    v_and_b32 v167, s55, v217
    v_lshlrev_b32 v168, 16, v218
    v_and_b32 v169, s55, v218
    v_lshlrev_b32 v170, 16, v219
    v_and_b32 v171, s55, v219
    v_lshlrev_b32 v172, 16, v220
    v_and_b32 v173, s55, v220
    v_lshlrev_b32 v174, 16, v221
    v_and_b32 v175, s55, v221
    v_lshlrev_b32 v176, 16, v222
    v_and_b32 v177, s55, v222
    v_lshlrev_b32 v178, 16, v223
    v_and_b32 v179, s55, v223
    v_lshlrev_b32 v180, 16, v224
    v_and_b32 v181, s55, v224
    v_lshlrev_b32 v182, 16, v225
    v_and_b32 v183, s55, v225
    v_lshlrev_b32 v184, 16, v226
    v_and_b32 v185, s55, v226
    v_lshlrev_b32 v186, 16, v227
    v_and_b32 v187, s55, v227
    v_lshlrev_b32 v188, 16, v228
    v_and_b32 v189, s55, v228
    v_lshlrev_b32 v190, 16, v229
    v_and_b32 v191, s55, v229
    v_lshlrev_b32 v192, 16, v230
    v_and_b32 v193, s55, v230
    v_lshlrev_b32 v194, 16, v231
    v_and_b32 v195, s55, v231
    s_lshl_b32 s6, s52, 7
    s_add_u32 s6, s6, 0x125000
    s_add_u32 s6, s6, s26
    s_addc_u32 s7, s27, 0
    s_mov_b32 s101, 0
F_P4:
    s_mov_b32 s54, 0
    s_atomic_add s54, s[6:7], 0 glc
    s_waitcnt lgkmcnt(0)
    s_cmp_ge_u32 s54, 64
    s_cbranch_scc1 F_P4_X
    s_sleep 16
    s_add_u32 s101, s101, 1
    s_cmp_lt_u32 s101, 400000
    s_cbranch_scc1 F_P4
F_P4_X:
    buffer_load_dwordx4 v[48:51], v232, s[36:39], s53 offen sc1
    s_add_u32 s53, s53, 4224
    buffer_load_dwordx4 v[52:55], v232, s[36:39], s53 offen sc1
    s_add_u32 s53, s53, 4224
    buffer_load_dwordx4 v[56:59], v232, s[36:39], s53 offen sc1
    s_add_u32 s53, s53, 4224
    buffer_load_dwordx4 v[60:63], v232, s[36:39], s53 offen sc1
    s_add_u32 s53, s53, 4224
    buffer_load_dwordx4 v[64:67], v232, s[36:39], s53 offen sc1
    s_add_u32 s53, s53, 4224
    buffer_load_dwordx4 v[68:71], v232, s[36:39], s53 offen sc1
    s_add_u32 s53, s53, 4224
    buffer_load_dwordx4 v[72:75], v232, s[36:39], s53 offen sc1
    s_add_u32 s53, s53, 4224
    buffer_load_dwordx4 v[76:79], v232, s[36:39], s53 offen sc1
    s_waitcnt vmcnt(0)
    v_lshlrev_b32 v88, 16, v48
    v_lshlrev_b32 v89, 16, v52
    v_lshlrev_b32 v90, 16, v56
    v_lshlrev_b32 v91, 16, v60
    v_lshlrev_b32 v92, 16, v64
    v_lshlrev_b32 v93, 16, v68
    v_lshlrev_b32 v94, 16, v72
    v_lshlrev_b32 v95, 16, v76
    v_mul_f32 v80, v132, v88
    v_mul_f32 v81, v133, v89
    v_mul_f32 v82, v134, v90
    v_mul_f32 v83, v135, v91
    v_mul_f32 v84, v136, v92
    v_mul_f32 v85, v137, v93
    v_mul_f32 v86, v138, v94
    v_mul_f32 v87, v139, v95
    v_cvt_pk_bf16_f32 v100, v80, v81
    v_cvt_pk_bf16_f32 v101, v82, v83
    v_cvt_pk_bf16_f32 v102, v84, v85
    v_cvt_pk_bf16_f32 v103, v86, v87
    s_add_u32 s57, s56, 0
    buffer_store_dwordx4 v[100:103], v233, s[44:47], s57 offen sc1
    v_and_b32 v88, s55, v48
    v_and_b32 v89, s55, v52
    v_and_b32 v90, s55, v56
    v_and_b32 v91, s55, v60
    v_and_b32 v92, s55, v64
    v_and_b32 v93, s55, v68
    v_and_b32 v94, s55, v72
    v_and_b32 v95, s55, v76
    v_mul_f32 v80, v140, v88
    v_mul_f32 v81, v141, v89
    v_mul_f32 v82, v142, v90
    v_mul_f32 v83, v143, v91
    v_mul_f32 v84, v144, v92
    v_mul_f32 v85, v145, v93
    v_mul_f32 v86, v146, v94
    v_mul_f32 v87, v147, v95
    v_cvt_pk_bf16_f32 v104, v80, v81
    v_cvt_pk_bf16_f32 v105, v82, v83
    v_cvt_pk_bf16_f32 v106, v84, v85
    v_cvt_pk_bf16_f32 v107, v86, v87
    s_add_u32 s57, s56, 4096
    buffer_store_dwordx4 v[104:107], v233, s[44:47], s57 offen sc1
    v_lshlrev_b32 v88, 16, v49
    v_lshlrev_b32 v89, 16, v53
    v_lshlrev_b32 v90, 16, v57
    v_lshlrev_b32 v91, 16, v61
    v_lshlrev_b32 v92, 16, v65
    v_lshlrev_b32 v93, 16, v69
    v_lshlrev_b32 v94, 16, v73
    v_lshlrev_b32 v95, 16, v77
    v_mul_f32 v80, v148, v88
    v_mul_f32 v81, v149, v89
    v_mul_f32 v82, v150, v90
    v_mul_f32 v83, v151, v91
    v_mul_f32 v84, v152, v92
    v_mul_f32 v85, v153, v93
    v_mul_f32 v86, v154, v94
    v_mul_f32 v87, v155, v95
    v_cvt_pk_bf16_f32 v108, v80, v81
    v_cvt_pk_bf16_f32 v109, v82, v83
    v_cvt_pk_bf16_f32 v110, v84, v85
    v_cvt_pk_bf16_f32 v111, v86, v87
    s_add_u32 s57, s56, 8192
    buffer_store_dwordx4 v[108:111], v233, s[44:47], s57 offen sc1
    v_and_b32 v88, s55, v49
    v_and_b32 v89, s55, v53
    v_and_b32 v90, s55, v57
    v_and_b32 v91, s55, v61
    v_and_b32 v92, s55, v65
    v_and_b32 v93, s55, v69
    v_and_b32 v94, s55, v73
    v_and_b32 v95, s55, v77
    v_mul_f32 v80, v156, v88
    v_mul_f32 v81, v157, v89
    v_mul_f32 v82, v158, v90
    v_mul_f32 v83, v159, v91
    v_mul_f32 v84, v160, v92
    v_mul_f32 v85, v161, v93
    v_mul_f32 v86, v162, v94
    v_mul_f32 v87, v163, v95
    v_cvt_pk_bf16_f32 v112, v80, v81
    v_cvt_pk_bf16_f32 v113, v82, v83
    v_cvt_pk_bf16_f32 v114, v84, v85
    v_cvt_pk_bf16_f32 v115, v86, v87
    s_add_u32 s57, s56, 12288
    buffer_store_dwordx4 v[112:115], v233, s[44:47], s57 offen sc1
    v_lshlrev_b32 v88, 16, v50
    v_lshlrev_b32 v89, 16, v54
    v_lshlrev_b32 v90, 16, v58
    v_lshlrev_b32 v91, 16, v62
    v_lshlrev_b32 v92, 16, v66
    v_lshlrev_b32 v93, 16, v70
    v_lshlrev_b32 v94, 16, v74
    v_lshlrev_b32 v95, 16, v78
    v_mul_f32 v80, v164, v88
    v_mul_f32 v81, v165, v89
    v_mul_f32 v82, v166, v90
    v_mul_f32 v83, v167, v91
    v_mul_f32 v84, v168, v92
    v_mul_f32 v85, v169, v93
    v_mul_f32 v86, v170, v94
    v_mul_f32 v87, v171, v95
    v_cvt_pk_bf16_f32 v116, v80, v81
    v_cvt_pk_bf16_f32 v117, v82, v83
    v_cvt_pk_bf16_f32 v118, v84, v85
    v_cvt_pk_bf16_f32 v119, v86, v87
    s_add_u32 s57, s56, 1048576
    buffer_store_dwordx4 v[116:119], v233, s[44:47], s57 offen sc1
    v_and_b32 v88, s55, v50
    v_and_b32 v89, s55, v54
    v_and_b32 v90, s55, v58
    v_and_b32 v91, s55, v62
    v_and_b32 v92, s55, v66
    v_and_b32 v93, s55, v70
    v_and_b32 v94, s55, v74
    v_and_b32 v95, s55, v78
    v_mul_f32 v80, v172, v88
    v_mul_f32 v81, v173, v89
    v_mul_f32 v82, v174, v90
    v_mul_f32 v83, v175, v91
    v_mul_f32 v84, v176, v92
    v_mul_f32 v85, v177, v93
    v_mul_f32 v86, v178, v94
    v_mul_f32 v87, v179, v95
    v_cvt_pk_bf16_f32 v120, v80, v81
    v_cvt_pk_bf16_f32 v121, v82, v83
    v_cvt_pk_bf16_f32 v122, v84, v85
    v_cvt_pk_bf16_f32 v123, v86, v87
    s_add_u32 s57, s56, 1052672
    buffer_store_dwordx4 v[120:123], v233, s[44:47], s57 offen sc1
    v_lshlrev_b32 v88, 16, v51
    v_lshlrev_b32 v89, 16, v55
    v_lshlrev_b32 v90, 16, v59
    v_lshlrev_b32 v91, 16, v63
    v_lshlrev_b32 v92, 16, v67
    v_lshlrev_b32 v93, 16, v71
    v_lshlrev_b32 v94, 16, v75
    v_lshlrev_b32 v95, 16, v79
    v_mul_f32 v80, v180, v88
    v_mul_f32 v81, v181, v89
    v_mul_f32 v82, v182, v90
    v_mul_f32 v83, v183, v91
    v_mul_f32 v84, v184, v92
    v_mul_f32 v85, v185, v93
    v_mul_f32 v86, v186, v94
    v_mul_f32 v87, v187, v95
    v_cvt_pk_bf16_f32 v124, v80, v81
    v_cvt_pk_bf16_f32 v125, v82, v83
    v_cvt_pk_bf16_f32 v126, v84, v85
    v_cvt_pk_bf16_f32 v127, v86, v87
    s_add_u32 s57, s56, 1056768
    buffer_store_dwordx4 v[124:127], v233, s[44:47], s57 offen sc1
    v_and_b32 v88, s55, v51
    v_and_b32 v89, s55, v55
    v_and_b32 v90, s55, v59
    v_and_b32 v91, s55, v63
    v_and_b32 v92, s55, v67
    v_and_b32 v93, s55, v71
    v_and_b32 v94, s55, v75
    v_and_b32 v95, s55, v79
    v_mul_f32 v80, v188, v88
    v_mul_f32 v81, v189, v89
    v_mul_f32 v82, v190, v90
    v_mul_f32 v83, v191, v91
    v_mul_f32 v84, v192, v92
    v_mul_f32 v85, v193, v93
    v_mul_f32 v86, v194, v94
    v_mul_f32 v87, v195, v95
    v_cvt_pk_bf16_f32 v128, v80, v81
    v_cvt_pk_bf16_f32 v129, v82, v83
    v_cvt_pk_bf16_f32 v130, v84, v85
    v_cvt_pk_bf16_f32 v131, v86, v87
    s_add_u32 s57, s56, 1060864
    buffer_store_dwordx4 v[128:131], v233, s[44:47], s57 offen sc1
    s_endpgm
F_C:
    s_load_dwordx8 s[20:27], s[0:1], 64
    s_and_b32 s32, s29, 3
    s_lshr_b32 s33, s28, 1
    s_lshl_b32 s33, s33, 2
    s_add_u32 s32, s32, s33
    s_and_b32 s33, s28, 1
    s_lshl_b32 s33, s33, 3
    s_lshr_b32 s35, s29, 2
    s_add_u32 s33, s33, s35
    v_lshlrev_b32 v1, 4, v0
    s_lshr_b32 s34, s3, 1
    s_and_b32 s35, s3, 1
    v_and_b32 v16, 15, v0
    v_lshrrev_b32 v17, 4, v0
    v_lshrrev_b32 v18, 1, v16
    v_xor_b32 v18, v18, v17
    v_lshlrev_b32 v18, 4, v18
    v_and_b32 v19, 7, v0
    v_lshl_add_u32 v18, v19, 7, v18
    v_bfe_u32 v19, v0, 3, 1
    v_mul_u32_u24 v19, 10240, v19
    s_lshl_b32 s40, s34, 11
    s_add_u32 s40, s40, 40960
    v_add3_u32 v2, v18, v19, s40
    v_xor_b32 v3, 64, v2
    v_bfe_u32 v18, v0, 2, 2
    v_lshlrev_b32 v18, 7, v18
    v_and_b32 v19, 3, v0
    v_lshl_add_u32 v18, v19, 3, v18
    v_bfe_u32 v19, v0, 3, 2
    v_lshlrev_b32 v19, 5, v19
    v_lshl_add_u32 v207, v17, 9, v18
    v_add_u32 v207, v207, v19
    s_lshl_b32 s40, s35, 6
    s_lshl_b32 s41, s34, 5
    s_or_b32 s40, s40, s41
    v_xor_b32 v19, s40, v19
    v_mul_u32_u24 v20, 10240, v17
    v_add3_u32 v18, v18, v19, v20
    v_add_u32 v4, 45056, v18
    v_xor_b32 v5, 32, v4
    v_mov_b32 v18, 0
    v_lshlrev_b32 v19, 2, v0
    v_add_u32 v20, 156160, v19
    ds_write_b32 v20, v18
    s_mov_b32 s42, 0x358637bd
    s_mov_b32 s43, 0x3fb8aa3b
    s_mov_b32 s49, 0x3f803f80
    v_mov_b32 v104, s42
    v_mov_b32 v105, s42
    v_mov_b32 v106, s42
    v_mov_b32 v107, s42
    v_mov_b32 v108, s42
    v_mov_b32 v109, s42
    v_mov_b32 v110, s42
    v_mov_b32 v111, s42
    v_mov_b32 v112, s42
    v_mov_b32 v113, s42
    v_mov_b32 v114, s42
    v_mov_b32 v115, s42
    v_mov_b32 v116, s42
    v_mov_b32 v117, s42
    v_mov_b32 v118, s42
    v_mov_b32 v119, s42
    v_mov_b32 v120, s42
    v_mov_b32 v121, s42
    v_mov_b32 v122, s42
    v_mov_b32 v123, s42
    v_mov_b32 v124, s42
    v_mov_b32 v125, s42
    v_mov_b32 v126, s42
    v_mov_b32 v127, s42
    v_mov_b32 v128, s42
    v_mov_b32 v129, s42
    v_mov_b32 v130, s42
    v_mov_b32 v131, s42
    v_mov_b32 v132, s42
    v_mov_b32 v133, s42
    v_mov_b32 v134, s42
    v_mov_b32 v135, s42
    v_mov_b32 v136, 0
    v_mov_b32 v137, 0
    v_mov_b32 v138, 0
    v_mov_b32 v139, 0
    v_mov_b32 v140, 0
    v_mov_b32 v141, 0
    v_mov_b32 v142, 0
    v_mov_b32 v143, 0
    v_mov_b32 v144, 0
    v_mov_b32 v145, 0
    v_mov_b32 v146, 0
    v_mov_b32 v147, 0
    v_mov_b32 v148, 0
    v_mov_b32 v149, 0
    v_mov_b32 v150, 0
    v_mov_b32 v151, 0
    v_mov_b32 v152, 0
    v_mov_b32 v153, 0
    v_mov_b32 v154, 0
    v_mov_b32 v155, 0
    v_mov_b32 v156, 0
    v_mov_b32 v157, 0
    v_mov_b32 v158, 0
    v_mov_b32 v159, 0
    v_mov_b32 v160, 0
    v_mov_b32 v161, 0
    v_mov_b32 v162, 0
    v_mov_b32 v163, 0
    v_mov_b32 v164, 0
    v_mov_b32 v165, 0
    v_mov_b32 v166, 0
    v_mov_b32 v167, 0
    v_mov_b32 v168, s42
    v_mov_b32 v169, s42
    v_mov_b32 v170, s42
    v_mov_b32 v171, s42
    v_mov_b32 v172, s42
    v_mov_b32 v173, s42
    v_mov_b32 v174, s42
    v_mov_b32 v175, s42
    v_mov_b32 v176, s42
    v_mov_b32 v177, s42
    v_mov_b32 v178, s42
    v_mov_b32 v179, s42
    v_mov_b32 v180, s42
    v_mov_b32 v181, s42
    v_mov_b32 v182, s42
    v_mov_b32 v183, s42
    v_mov_b32 v184, s42
    v_mov_b32 v185, s42
    v_mov_b32 v186, s42
    v_mov_b32 v187, s42
    v_mov_b32 v188, s42
    v_mov_b32 v189, s42
    v_mov_b32 v190, s42
    v_mov_b32 v191, s42
    v_mov_b32 v192, s42
    v_mov_b32 v193, s42
    v_mov_b32 v194, s42
    v_mov_b32 v195, s42
    v_mov_b32 v196, s42
    v_mov_b32 v197, s42
    v_mov_b32 v198, s42
    v_mov_b32 v199, s42
    s_and_b32 s40, s3, 1
    s_lshl_b32 s41, s31, 1
    s_add_u32 s40, s40, s41
    s_lshr_b32 s41, s3, 1
    s_lshl_b32 s52, s30, 1
    s_add_u32 s52, s52, s41
    s_mul_i32 s52, s52, 132
    s_add_u32 s52, s52, s40
    s_lshl_b32 s52, s52, 10
    s_add_u32 s52, s52, 0x200000
    s_lshl_b32 s50, s40, 15
    s_lshl_b32 s51, s41, 10
    s_add_u32 s53, s50, s51
    s_lshl_b32 s50, s30, 11
    s_add_u32 s50, s50, s53
    s_lshl_b32 s40, s40, 11
    s_add_u32 s54, s40, s51
    s_add_u32 s54, s54, 0x100000
    s_lshl_b32 s51, s30, 6
    s_add_u32 s51, s51, s54
    s_mul_i32 s40, s35, 2304
    s_add_u32 s58, s40, 156416
    s_add_u32 s59, s40, 116736
    s_cmp_eq_u32 s34, 0
    s_cselect_b32 s40, s58, s59
    s_cselect_b32 s41, s59, s58
    v_lshlrev_b32 v12, 4, v17
    v_add_u32 v6, s40, v1
    v_add_u32 v7, s41, v1
    v_add_u32 v8, s40, v12
    v_add_u32 v9, s41, v12
    s_lshl_b32 s40, s3, 3
    s_add_u32 s41, s40, 156160
    v_mov_b32 v10, s41
    v_xor_b32 v11, 16, v10
    v_lshl_add_u32 v13, v16, 6, v12
    s_lshl_b32 s40, s34, 3
    s_add_u32 s41, s59, s40
    v_add_u32 v200, s41, v1
    v_xor_b32 v201, 8, v200
    s_add_u32 s41, s58, s40
    v_add_u32 v203, s41, v1
    v_xor_b32 v202, 8, v203
    s_lshl_b32 s40, s3, 2
    s_add_u32 s41, s40, 156240
    v_mov_b32 v204, s41
    s_add_u32 s41, s40, 156224
    v_mov_b32 v206, s41
    v_lshlrev_b32 v18, 1, v17
    v_and_b32 v20, 7, v0
    v_xor_b32 v18, v18, v20
    v_lshlrev_b32 v18, 4, v18
    v_lshrrev_b32 v20, 3, v0
    v_lshl_add_u32 v205, v20, 11, v18
    v_mov_b32 v14, 1
    v_and_b32 v18, 12, v19
    v_add_u32 v209, 156160, v18
    v_add_u32 v211, 144, v209
    v_add_u32 v20, 144, v209
    v_subrev_u32 v21, 12, v0
    v_cmp_gt_u32 vcc, 12, v21
    v_and_b32 v18, 4, v19
    v_add_u32 v18, 156208, v18
    v_cndmask_b32 v211, v211, v20, vcc
    v_and_b32 v21, 31, v0
    v_cmp_lt_u32 vcc, 23, v21
    s_nop 1
    v_cndmask_b32 v211, v211, v18, vcc
    s_lshl_b32 s55, s32, 2
    s_add_u32 s55, s55, s3
    s_lshl_b32 s56, s55, 17
    s_lshl_b32 s40, s33, 7
    s_add_u32 s56, s56, s40
    s_mul_i32 s55, s55, 67584
    s_add_u32 s55, s55, 0x200000
    v_and_b32 v18, 31, v0
    v_add_u32 v18, 33, v18
    s_xor_b32 s40, s35, 1
    s_mul_i32 s40, s40, 66
    v_add_u32 v18, s40, v18
    v_lshlrev_b32 v208, 10, v18
    s_and_b32 s57, s33, 7
    s_mul_i32 s57, s57, 3
    s_lshr_b32 s57, s57, 2
    v_lshlrev_b32 v210, 12, v16
    v_bfe_u32 v18, v0, 4, 1
    v_lshl_add_u32 v210, v18, 5, v210
    v_lshrrev_b32 v18, 5, v0
    v_lshl_add_u32 v210, v18, 4, v210
    s_mov_b32 s44, 0
    s_mov_b32 s45, 1
    s_mov_b32 s46, 0xfffec000
    s_mov_b32 s47, 40960
    s_waitcnt lgkmcnt(0)
    s_mov_b32 s36, s26
    s_mov_b32 s37, s27
    s_mov_b32 s38, 0x10000000
    s_mov_b32 s39, 0x00020000
    s_mov_b32 s60, s22
    s_mov_b32 s61, s23
    s_mov_b32 s62, 0x800000
    s_mov_b32 s63, 0x00020000
    s_mov_b32 s64, s26
    s_mov_b32 s65, s27
    s_mov_b32 s66, 0x10000000
    s_mov_b32 s67, 0x00020000
    s_cmp_lg_u32 s2, 0
    s_cbranch_scc1 F_NOINIT
    v_mov_b32 v20, 0
    v_mov_b32 v21, 0
    v_mov_b32 v22, 0
    v_mov_b32 v23, 0
    s_mul_i32 s40, s3, 6144
    s_add_u32 s40, s40, 0x120000
    s_add_u32 s41, s40, 4096
    buffer_store_dwordx4 v[20:23], v1, s[36:39], s40 offen offset:0 sc1
    buffer_store_dwordx4 v[20:23], v1, s[36:39], s40 offen offset:1024 sc1
    buffer_store_dwordx4 v[20:23], v1, s[36:39], s40 offen offset:2048 sc1
    buffer_store_dwordx4 v[20:23], v1, s[36:39], s40 offen offset:3072 sc1
    buffer_store_dwordx4 v[20:23], v1, s[36:39], s41 offen offset:0 sc1
    buffer_store_dwordx4 v[20:23], v1, s[36:39], s41 offen offset:1024 sc1
    s_mov_b32 s40, 1
    s_waitcnt vmcnt(0)
    s_atomic_add s40, s[24:25], 0
    s_waitcnt lgkmcnt(0)
F_NOINIT:
    s_lshl_b32 s40, s31, 2
    s_lshl_b32 s41, s35, 1
    s_add_u32 s40, s40, s41
    s_add_u32 s40, s40, s34
    s_lshl_b32 s10, s40, 7
    s_add_u32 s10, s10, 0x122000
    s_add_u32 s10, s10, s26
    s_addc_u32 s11, s27, 0
    s_lshl_b32 s40, s30, 1
    s_add_u32 s40, s40, s34
    s_lshl_b32 s12, s40, 7
    s_add_u32 s12, s12, 0x124000
    s_add_u32 s12, s12, s26
    s_addc_u32 s13, s27, 0
    s_lshl_b32 s40, s32, 1
    s_add_u32 s40, s40, s34
    s_lshl_b32 s14, s40, 7
    s_add_u32 s14, s14, 0x124000
    s_add_u32 s14, s14, s26
    s_addc_u32 s15, s27, 0
    s_lshr_b32 s40, s31, 1
    s_lshl_b32 s40, s40, 2
    s_lshl_b32 s16, 1, s40
    s_mov_b32 s4, s8
    s_mov_b32 s5, s9
    s_mov_b32 s6, 0x200000
    s_mov_b32 s7, 0x00020000
    s_lshl_b32 s68, s3, 10
    s_lshl_b32 s69, s3, 14
    s_lshl_b32 s40, s33, 7
    s_add_u32 s69, s69, s40
    s_barrier
    ds_read_b64_tr_b16 v[80:81], v4 offset:1024
    ds_read_b64_tr_b16 v[82:83], v4 offset:1536
    ds_read_b128 v[16:19], v2 offset:0
    ds_read_b64_tr_b16 v[84:85], v4 offset:4096
    ds_read_b64_tr_b16 v[86:87], v4 offset:4608
    ds_read_b128 v[20:23], v3 offset:0
    ds_read_b128 v[24:27], v2 offset:20480
    ds_read_b128 v[28:31], v3 offset:20480
    ds_read_b128 v[32:35], v2 offset:1024
    ds_read_b128 v[36:39], v3 offset:1024
    ds_read_b64_tr_b16 v[88:89], v5 offset:1024
    ds_read_b64_tr_b16 v[90:91], v5 offset:1536
    ds_read_b64_tr_b16 v[92:93], v5 offset:4096
    ds_read_b64_tr_b16 v[94:95], v5 offset:4608
    ds_read_b128 v[40:43], v2 offset:21504
    ds_read_b128 v[44:47], v3 offset:21504
.p2align 6
F_CLOOP:
    s_waitcnt lgkmcnt(8)
    v_mfma_f32_16x16x32_bf16 v[104:107], v[16:19], v[80:83], v[104:107]
    ds_read_b64_tr_b16 v[96:97], v4 offset:2048
    v_mfma_f32_16x16x32_bf16 v[104:107], v[20:23], v[84:87], v[104:107]
    ds_read_b64_tr_b16 v[98:99], v4 offset:2560
    v_mfma_f32_16x16x32_bf16 v[108:111], v[24:27], v[80:83], v[108:111]
    ds_read_b64_tr_b16 v[100:101], v4 offset:5120
    v_mfma_f32_16x16x32_bf16 v[108:111], v[28:31], v[84:87], v[108:111]
    ds_read_b64_tr_b16 v[102:103], v4 offset:5632
    s_waitcnt lgkmcnt(4)
    v_mfma_f32_16x16x32_bf16 v[112:115], v[32:35], v[80:83], v[112:115]
    v_mfma_f32_16x16x32_bf16 v[112:115], v[36:39], v[84:87], v[112:115]
    v_mfma_f32_16x16x32_bf16 v[116:119], v[40:43], v[80:83], v[116:119]
    v_mfma_f32_16x16x32_bf16 v[116:119], v[44:47], v[84:87], v[116:119]
    v_mfma_f32_16x16x32_bf16 v[120:123], v[16:19], v[88:91], v[120:123]
    ds_read_b64_tr_b16 v[80:81], v5 offset:2048
    v_mfma_f32_16x16x32_bf16 v[120:123], v[20:23], v[92:95], v[120:123]
    ds_read_b64_tr_b16 v[82:83], v5 offset:2560
    v_mfma_f32_16x16x32_bf16 v[124:127], v[24:27], v[88:91], v[124:127]
    ds_read_b64_tr_b16 v[84:85], v5 offset:5120
    v_mfma_f32_16x16x32_bf16 v[124:127], v[28:31], v[92:95], v[124:127]
    ds_read_b64_tr_b16 v[86:87], v5 offset:5632
    v_mfma_f32_16x16x32_bf16 v[128:131], v[32:35], v[88:91], v[128:131]
    v_mfma_f32_16x16x32_bf16 v[128:131], v[36:39], v[92:95], v[128:131]
    v_mfma_f32_16x16x32_bf16 v[132:135], v[40:43], v[88:91], v[132:135]
    v_mfma_f32_16x16x32_bf16 v[132:135], v[44:47], v[92:95], v[132:135]
    s_waitcnt lgkmcnt(4)
    v_mfma_f32_16x16x32_bf16 v[136:139], v[16:19], v[96:99], v[136:139]
    ds_read_b64_tr_b16 v[88:89], v4 offset:0
    v_mfma_f32_16x16x32_bf16 v[136:139], v[20:23], v[100:103], v[136:139]
    ds_read_b64_tr_b16 v[90:91], v4 offset:512
    v_mfma_f32_16x16x32_bf16 v[140:143], v[24:27], v[96:99], v[140:143]
    ds_read_b64_tr_b16 v[92:93], v4 offset:3072
    v_mfma_f32_16x16x32_bf16 v[140:143], v[28:31], v[100:103], v[140:143]
    ds_read_b64_tr_b16 v[94:95], v4 offset:3584
    v_mfma_f32_16x16x32_bf16 v[144:147], v[32:35], v[96:99], v[144:147]
    v_mfma_f32_16x16x32_bf16 v[144:147], v[36:39], v[100:103], v[144:147]
    s_add_u32 s44, s44, 1
    v_mfma_f32_16x16x32_bf16 v[148:151], v[40:43], v[96:99], v[148:151]
    v_mfma_f32_16x16x32_bf16 v[148:151], v[44:47], v[100:103], v[148:151]
    s_waitcnt lgkmcnt(4)
    v_mfma_f32_16x16x32_bf16 v[152:155], v[16:19], v[80:83], v[152:155]
    ds_read_b64_tr_b16 v[96:97], v5 offset:0
    v_mfma_f32_16x16x32_bf16 v[152:155], v[20:23], v[84:87], v[152:155]
    ds_read_b64_tr_b16 v[98:99], v5 offset:512
    v_mfma_f32_16x16x32_bf16 v[156:159], v[24:27], v[80:83], v[156:159]
    ds_read_b64_tr_b16 v[100:101], v5 offset:3072
    v_mfma_f32_16x16x32_bf16 v[156:159], v[28:31], v[84:87], v[156:159]
    ds_read_b64_tr_b16 v[102:103], v5 offset:3584
    v_mfma_f32_16x16x32_bf16 v[160:163], v[32:35], v[80:83], v[160:163]
    s_add_u32 s45, s45, 1
    s_cmp_eq_u32 s45, 3
    v_mfma_f32_16x16x32_bf16 v[160:163], v[36:39], v[84:87], v[160:163]
    s_cselect_b32 s48, s46, s47
    s_cselect_b32 s45, 0, s45
    v_mfma_f32_16x16x32_bf16 v[164:167], v[40:43], v[80:83], v[164:167]
    v_add_u32 v4, s48, v4
    v_add_u32 v2, s48, v2
    v_mfma_f32_16x16x32_bf16 v[164:167], v[44:47], v[84:87], v[164:167]
    v_add_u32 v3, s48, v3
    v_add_u32 v5, s48, v5
    s_waitcnt lgkmcnt(0)
    v_mfma_f32_16x16x32_bf16 v[168:171], v[88:91], v[16:19], v[168:171]
    s_cmp_lt_u32 s44, 8
    s_cbranch_scc0 F_CNB0
    s_barrier
F_CB0:
    v_mfma_f32_16x16x32_bf16 v[168:171], v[92:95], v[20:23], v[168:171]
    ds_read_b64_tr_b16 v[80:81], v4 offset:1024
    ds_read_b64_tr_b16 v[82:83], v4 offset:1536
    v_mfma_f32_16x16x32_bf16 v[172:175], v[88:91], v[24:27], v[172:175]
    ds_read_b128 v[48:51], v2 offset:0
    ds_read_b64_tr_b16 v[84:85], v4 offset:4096
    v_mfma_f32_16x16x32_bf16 v[172:175], v[92:95], v[28:31], v[172:175]
    ds_read_b64_tr_b16 v[86:87], v4 offset:4608
    v_mfma_f32_16x16x32_bf16 v[176:179], v[88:91], v[32:35], v[176:179]
    ds_read_b128 v[52:55], v3 offset:0
    v_mfma_f32_16x16x32_bf16 v[176:179], v[92:95], v[36:39], v[176:179]
    ds_read_b128 v[56:59], v2 offset:20480
    v_mfma_f32_16x16x32_bf16 v[180:183], v[88:91], v[40:43], v[180:183]
    ds_read_b128 v[60:63], v3 offset:20480
    v_mfma_f32_16x16x32_bf16 v[180:183], v[92:95], v[44:47], v[180:183]
    v_mfma_f32_16x16x32_bf16 v[184:187], v[96:99], v[16:19], v[184:187]
    ds_read_b128 v[64:67], v2 offset:1024
    ds_read_b128 v[68:71], v3 offset:1024
    v_mfma_f32_16x16x32_bf16 v[184:187], v[100:103], v[20:23], v[184:187]
    ds_read_b64_tr_b16 v[88:89], v5 offset:1024
    ds_read_b64_tr_b16 v[90:91], v5 offset:1536
    v_mfma_f32_16x16x32_bf16 v[188:191], v[96:99], v[24:27], v[188:191]
    ds_read_b64_tr_b16 v[92:93], v5 offset:4096
    ds_read_b64_tr_b16 v[94:95], v5 offset:4608
    v_mfma_f32_16x16x32_bf16 v[188:191], v[100:103], v[28:31], v[188:191]
    ds_read_b128 v[72:75], v2 offset:21504
    v_mfma_f32_16x16x32_bf16 v[192:195], v[96:99], v[32:35], v[192:195]
    ds_read_b128 v[76:79], v3 offset:21504
    v_mfma_f32_16x16x32_bf16 v[192:195], v[100:103], v[36:39], v[192:195]
    v_mfma_f32_16x16x32_bf16 v[196:199], v[96:99], v[40:43], v[196:199]
    v_mfma_f32_16x16x32_bf16 v[196:199], v[100:103], v[44:47], v[196:199]
    s_waitcnt lgkmcnt(8)
    v_mfma_f32_16x16x32_bf16 v[104:107], v[48:51], v[80:83], v[104:107]
    ds_read_b64_tr_b16 v[96:97], v4 offset:2048
    v_mfma_f32_16x16x32_bf16 v[104:107], v[52:55], v[84:87], v[104:107]
    ds_read_b64_tr_b16 v[98:99], v4 offset:2560
    v_mfma_f32_16x16x32_bf16 v[108:111], v[56:59], v[80:83], v[108:111]
    ds_read_b64_tr_b16 v[100:101], v4 offset:5120
    v_mfma_f32_16x16x32_bf16 v[108:111], v[60:63], v[84:87], v[108:111]
    ds_read_b64_tr_b16 v[102:103], v4 offset:5632
    s_waitcnt lgkmcnt(4)
    v_mfma_f32_16x16x32_bf16 v[112:115], v[64:67], v[80:83], v[112:115]
    v_mfma_f32_16x16x32_bf16 v[112:115], v[68:71], v[84:87], v[112:115]
    v_mfma_f32_16x16x32_bf16 v[116:119], v[72:75], v[80:83], v[116:119]
    v_mfma_f32_16x16x32_bf16 v[116:119], v[76:79], v[84:87], v[116:119]
    v_mfma_f32_16x16x32_bf16 v[120:123], v[48:51], v[88:91], v[120:123]
    ds_read_b64_tr_b16 v[80:81], v5 offset:2048
    v_mfma_f32_16x16x32_bf16 v[120:123], v[52:55], v[92:95], v[120:123]
    ds_read_b64_tr_b16 v[82:83], v5 offset:2560
    v_mfma_f32_16x16x32_bf16 v[124:127], v[56:59], v[88:91], v[124:127]
    ds_read_b64_tr_b16 v[84:85], v5 offset:5120
    v_mfma_f32_16x16x32_bf16 v[124:127], v[60:63], v[92:95], v[124:127]
    ds_read_b64_tr_b16 v[86:87], v5 offset:5632
    v_mfma_f32_16x16x32_bf16 v[128:131], v[64:67], v[88:91], v[128:131]
    v_mfma_f32_16x16x32_bf16 v[128:131], v[68:71], v[92:95], v[128:131]
    v_mfma_f32_16x16x32_bf16 v[132:135], v[72:75], v[88:91], v[132:135]
    v_mfma_f32_16x16x32_bf16 v[132:135], v[76:79], v[92:95], v[132:135]
    s_waitcnt lgkmcnt(4)
    v_mfma_f32_16x16x32_bf16 v[136:139], v[48:51], v[96:99], v[136:139]
    ds_read_b64_tr_b16 v[88:89], v4 offset:0
    v_mfma_f32_16x16x32_bf16 v[136:139], v[52:55], v[100:103], v[136:139]
    ds_read_b64_tr_b16 v[90:91], v4 offset:512
    v_mfma_f32_16x16x32_bf16 v[140:143], v[56:59], v[96:99], v[140:143]
    ds_read_b64_tr_b16 v[92:93], v4 offset:3072
    v_mfma_f32_16x16x32_bf16 v[140:143], v[60:63], v[100:103], v[140:143]
    ds_read_b64_tr_b16 v[94:95], v4 offset:3584
    v_mfma_f32_16x16x32_bf16 v[144:147], v[64:67], v[96:99], v[144:147]
    v_mfma_f32_16x16x32_bf16 v[144:147], v[68:71], v[100:103], v[144:147]
    v_mfma_f32_16x16x32_bf16 v[148:151], v[72:75], v[96:99], v[148:151]
    v_mfma_f32_16x16x32_bf16 v[148:151], v[76:79], v[100:103], v[148:151]
    s_waitcnt lgkmcnt(4)
    v_mfma_f32_16x16x32_bf16 v[152:155], v[48:51], v[80:83], v[152:155]
    ds_read_b64_tr_b16 v[96:97], v5 offset:0
    v_mfma_f32_16x16x32_bf16 v[152:155], v[52:55], v[84:87], v[152:155]
    ds_read_b64_tr_b16 v[98:99], v5 offset:512
    v_mfma_f32_16x16x32_bf16 v[156:159], v[56:59], v[80:83], v[156:159]
    ds_read_b64_tr_b16 v[100:101], v5 offset:3072
    v_mfma_f32_16x16x32_bf16 v[156:159], v[60:63], v[84:87], v[156:159]
    ds_read_b64_tr_b16 v[102:103], v5 offset:3584
    v_mfma_f32_16x16x32_bf16 v[160:163], v[64:67], v[80:83], v[160:163]
    s_add_u32 s45, s45, 1
    s_cmp_eq_u32 s45, 3
    v_mfma_f32_16x16x32_bf16 v[160:163], v[68:71], v[84:87], v[160:163]
    s_cselect_b32 s48, s46, s47
    s_cselect_b32 s45, 0, s45
    v_mfma_f32_16x16x32_bf16 v[164:167], v[72:75], v[80:83], v[164:167]
    v_add_u32 v4, s48, v4
    v_add_u32 v2, s48, v2
    v_mfma_f32_16x16x32_bf16 v[164:167], v[76:79], v[84:87], v[164:167]
    v_add_u32 v3, s48, v3
    v_add_u32 v5, s48, v5
    s_waitcnt lgkmcnt(0)
    v_mfma_f32_16x16x32_bf16 v[168:171], v[88:91], v[48:51], v[168:171]
    s_cmp_lt_u32 s44, 8
    s_cbranch_scc0 F_CNB1
    s_barrier
F_CB1:
    v_mfma_f32_16x16x32_bf16 v[168:171], v[92:95], v[52:55], v[168:171]
    ds_read_b64_tr_b16 v[80:81], v4 offset:1024
    ds_read_b64_tr_b16 v[82:83], v4 offset:1536
    v_mfma_f32_16x16x32_bf16 v[172:175], v[88:91], v[56:59], v[172:175]
    ds_read_b128 v[16:19], v2 offset:0
    ds_read_b64_tr_b16 v[84:85], v4 offset:4096
    v_mfma_f32_16x16x32_bf16 v[172:175], v[92:95], v[60:63], v[172:175]
    ds_read_b64_tr_b16 v[86:87], v4 offset:4608
    v_mfma_f32_16x16x32_bf16 v[176:179], v[88:91], v[64:67], v[176:179]
    ds_read_b128 v[20:23], v3 offset:0
    v_mfma_f32_16x16x32_bf16 v[176:179], v[92:95], v[68:71], v[176:179]
    ds_read_b128 v[24:27], v2 offset:20480
    v_mfma_f32_16x16x32_bf16 v[180:183], v[88:91], v[72:75], v[180:183]
    ds_read_b128 v[28:31], v3 offset:20480
    v_mfma_f32_16x16x32_bf16 v[180:183], v[92:95], v[76:79], v[180:183]
    v_mfma_f32_16x16x32_bf16 v[184:187], v[96:99], v[48:51], v[184:187]
    ds_read_b128 v[32:35], v2 offset:1024
    ds_read_b128 v[36:39], v3 offset:1024
    v_mfma_f32_16x16x32_bf16 v[184:187], v[100:103], v[52:55], v[184:187]
    ds_read_b64_tr_b16 v[88:89], v5 offset:1024
    ds_read_b64_tr_b16 v[90:91], v5 offset:1536
    v_mfma_f32_16x16x32_bf16 v[188:191], v[96:99], v[56:59], v[188:191]
    ds_read_b64_tr_b16 v[92:93], v5 offset:4096
    ds_read_b64_tr_b16 v[94:95], v5 offset:4608
    v_mfma_f32_16x16x32_bf16 v[188:191], v[100:103], v[60:63], v[188:191]
    ds_read_b128 v[40:43], v2 offset:21504
    v_mfma_f32_16x16x32_bf16 v[192:195], v[96:99], v[64:67], v[192:195]
    ds_read_b128 v[44:47], v3 offset:21504
    v_mfma_f32_16x16x32_bf16 v[192:195], v[100:103], v[68:71], v[192:195]
    v_mfma_f32_16x16x32_bf16 v[196:199], v[96:99], v[72:75], v[196:199]
    v_mfma_f32_16x16x32_bf16 v[196:199], v[100:103], v[76:79], v[196:199]
    s_cbranch_scc1 F_CLOOP
    s_setprio 3
    s_mov_b32 s46, s43
    s_mov_b32 s47, s43
    v_mul_f32 v244, s43, v104
    v_mul_f32 v245, s43, v105
    v_mul_f32 v246, s43, v106
    v_mul_f32 v247, s43, v107
    v_mul_f32 v248, s43, v108
    v_mul_f32 v249, s43, v109
    v_mul_f32 v250, s43, v110
    v_mul_f32 v251, s43, v111
    v_exp_f32 v244, v244 clamp
    v_max_f32 v104, s42, v104
    v_exp_f32 v245, v245 clamp
    v_max_f32 v105, s42, v105
    v_exp_f32 v246, v246 clamp
    v_max_f32 v106, s42, v106
    v_exp_f32 v247, v247 clamp
    v_max_f32 v107, s42, v107
    v_exp_f32 v248, v248 clamp
    v_max_f32 v108, s42, v108
    v_exp_f32 v249, v249 clamp
    v_max_f32 v109, s42, v109
    v_exp_f32 v250, v250 clamp
    v_max_f32 v110, s42, v110
    v_exp_f32 v251, v251 clamp
    v_max_f32 v111, s42, v111
    v_add_f32 v244, v244, v104
    v_add_f32 v245, v245, v105
    v_add_f32 v246, v246, v106
    v_add_f32 v247, v247, v107
    v_add_f32 v248, v248, v108
    v_add_f32 v249, v249, v109
    v_add_f32 v250, v250, v110
    v_add_f32 v251, v251, v111
    v_cvt_pk_bf16_f32 v212, v244, v245
    v_cvt_pk_bf16_f32 v213, v246, v247
    v_cvt_pk_bf16_f32 v214, v248, v249
    v_cvt_pk_bf16_f32 v215, v250, v251
    v_mov_b32 v252, s49
    v_mov_b32 v253, s49
    v_mov_b32 v254, s49
    v_mov_b32 v255, s49
    v_cvt_pk_bf16_f32 v228, v136, v137
    v_cvt_pk_bf16_f32 v229, v138, v139
    v_cvt_pk_bf16_f32 v230, v140, v141
    v_cvt_pk_bf16_f32 v231, v142, v143
    v_cvt_pk_bf16_f32 v232, v144, v145
    v_cvt_pk_bf16_f32 v233, v146, v147
    v_cvt_pk_bf16_f32 v234, v148, v149
    v_cvt_pk_bf16_f32 v235, v150, v151
    v_cvt_pk_bf16_f32 v236, v152, v153
    v_cvt_pk_bf16_f32 v237, v154, v155
    v_cvt_pk_bf16_f32 v238, v156, v157
    v_cvt_pk_bf16_f32 v239, v158, v159
    v_cvt_pk_bf16_f32 v240, v160, v161
    v_cvt_pk_bf16_f32 v241, v162, v163
    v_cvt_pk_bf16_f32 v242, v164, v165
    v_cvt_pk_bf16_f32 v243, v166, v167
    v_mfma_f32_16x16x32_bf16 v[140:143], v[212:215], v[236:239], 0
    v_mfma_f32_16x16x32_bf16 v[136:139], v[212:215], v[228:231], 0
    v_mfma_f32_16x16x32_bf16 v[152:155], v[212:215], v[252:255], 0
    v_mul_f32 v244, s43, v120
    v_mul_f32 v245, s43, v121
    v_mul_f32 v246, s43, v122
    v_mul_f32 v247, s43, v123
    v_mul_f32 v248, s43, v124
    v_mul_f32 v249, s43, v125
    v_mul_f32 v250, s43, v126
    v_mul_f32 v251, s43, v127
    v_exp_f32 v244, v244 clamp
    v_max_f32 v120, s42, v120
    v_exp_f32 v245, v245 clamp
    v_max_f32 v121, s42, v121
    v_exp_f32 v246, v246 clamp
    v_max_f32 v122, s42, v122
    v_exp_f32 v247, v247 clamp
    v_max_f32 v123, s42, v123
    v_exp_f32 v248, v248 clamp
    v_max_f32 v124, s42, v124
    v_exp_f32 v249, v249 clamp
    v_max_f32 v125, s42, v125
    v_exp_f32 v250, v250 clamp
    v_max_f32 v126, s42, v126
    v_exp_f32 v251, v251 clamp
    v_max_f32 v127, s42, v127
    v_add_f32 v244, v244, v120
    v_add_f32 v245, v245, v121
    v_add_f32 v246, v246, v122
    v_add_f32 v247, v247, v123
    v_add_f32 v248, v248, v124
    v_add_f32 v249, v249, v125
    v_add_f32 v250, v250, v126
    v_add_f32 v251, v251, v127
    v_cvt_pk_bf16_f32 v216, v244, v245
    v_cvt_pk_bf16_f32 v217, v246, v247
    v_cvt_pk_bf16_f32 v218, v248, v249
    v_cvt_pk_bf16_f32 v219, v250, v251
    s_nop 1
    v_mfma_f32_16x16x32_bf16 v[148:151], v[216:219], v[236:239], 0
    v_mfma_f32_16x16x32_bf16 v[144:147], v[216:219], v[228:231], 0
    v_mfma_f32_16x16x32_bf16 v[156:159], v[216:219], v[252:255], 0
    v_mul_f32 v244, s43, v112
    v_mul_f32 v245, s43, v113
    v_mul_f32 v246, s43, v114
    v_mul_f32 v247, s43, v115
    v_mul_f32 v248, s43, v116
    v_mul_f32 v249, s43, v117
    v_mul_f32 v250, s43, v118
    v_mul_f32 v251, s43, v119
    v_exp_f32 v244, v244 clamp
    v_max_f32 v112, s42, v112
    v_exp_f32 v245, v245 clamp
    v_max_f32 v113, s42, v113
    v_exp_f32 v246, v246 clamp
    v_max_f32 v114, s42, v114
    v_exp_f32 v247, v247 clamp
    v_max_f32 v115, s42, v115
    v_exp_f32 v248, v248 clamp
    v_max_f32 v116, s42, v116
    v_exp_f32 v249, v249 clamp
    v_max_f32 v117, s42, v117
    v_exp_f32 v250, v250 clamp
    v_max_f32 v118, s42, v118
    v_exp_f32 v251, v251 clamp
    v_max_f32 v119, s42, v119
    v_add_f32 v244, v244, v112
    v_add_f32 v245, v245, v113
    v_add_f32 v246, v246, v114
    v_add_f32 v247, v247, v115
    v_add_f32 v248, v248, v116
    v_add_f32 v249, v249, v117
    v_add_f32 v250, v250, v118
    v_add_f32 v251, v251, v119
    v_cvt_pk_bf16_f32 v212, v244, v245
    v_cvt_pk_bf16_f32 v213, v246, v247
    v_cvt_pk_bf16_f32 v214, v248, v249
    v_cvt_pk_bf16_f32 v215, v250, v251
    s_nop 1
    v_mfma_f32_16x16x32_bf16 v[140:143], v[212:215], v[240:243], v[140:143]
    v_mfma_f32_16x16x32_bf16 v[136:139], v[212:215], v[232:235], v[136:139]
    v_mfma_f32_16x16x32_bf16 v[152:155], v[212:215], v[252:255], v[152:155]
    v_mul_f32 v244, s43, v128
    v_mul_f32 v245, s43, v129
    v_mul_f32 v246, s43, v130
    v_mul_f32 v247, s43, v131
    v_mul_f32 v248, s43, v132
    v_mul_f32 v249, s43, v133
    v_mul_f32 v250, s43, v134
    v_mul_f32 v251, s43, v135
    v_exp_f32 v244, v244 clamp
    v_max_f32 v128, s42, v128
    v_exp_f32 v245, v245 clamp
    v_max_f32 v129, s42, v129
    v_exp_f32 v246, v246 clamp
    v_max_f32 v130, s42, v130
    v_exp_f32 v247, v247 clamp
    v_max_f32 v131, s42, v131
    v_exp_f32 v248, v248 clamp
    v_max_f32 v132, s42, v132
    v_exp_f32 v249, v249 clamp
    v_max_f32 v133, s42, v133
    v_exp_f32 v250, v250 clamp
    v_max_f32 v134, s42, v134
    v_exp_f32 v251, v251 clamp
    v_max_f32 v135, s42, v135
    v_add_f32 v244, v244, v128
    v_add_f32 v245, v245, v129
    v_add_f32 v246, v246, v130
    v_add_f32 v247, v247, v131
    v_add_f32 v248, v248, v132
    v_add_f32 v249, v249, v133
    v_add_f32 v250, v250, v134
    v_add_f32 v251, v251, v135
    v_cvt_pk_bf16_f32 v216, v244, v245
    v_cvt_pk_bf16_f32 v217, v246, v247
    v_cvt_pk_bf16_f32 v218, v248, v249
    v_cvt_pk_bf16_f32 v219, v250, v251
    s_nop 1
    v_mfma_f32_16x16x32_bf16 v[148:151], v[216:219], v[240:243], v[148:151]
    v_mfma_f32_16x16x32_bf16 v[144:147], v[216:219], v[232:235], v[144:147]
    v_mfma_f32_16x16x32_bf16 v[156:159], v[216:219], v[252:255], v[156:159]
    ds_write_b128 v6, v[140:143]
    s_nop 4
    ds_write_b128 v6, v[148:151] offset:1024
    s_nop 0
    ds_write_b128 v8, v[156:159] offset:2048
    ds_write_b32 v10, v14
F_XA:
    ds_read_b32 v15, v11
    ds_read_b128 v[212:215], v7 offset:1024
    ds_read_b128 v[216:219], v7
    ds_read_b128 v[220:223], v9 offset:2048
    s_waitcnt lgkmcnt(0)
    v_cmp_ne_u32 vcc, 1, v15
    s_cbranch_vccnz F_XA
    v_add_f32 v212, v212, v136
    v_add_f32 v213, v213, v137
    v_add_f32 v214, v214, v138
    v_add_f32 v215, v215, v139
    v_add_f32 v216, v216, v144
    v_add_f32 v217, v217, v145
    v_add_f32 v218, v218, v146
    v_add_f32 v219, v219, v147
    v_cvt_pk_bf16_f32 v224, v212, v213
    v_cvt_pk_bf16_f32 v225, v214, v215
    v_cvt_pk_bf16_f32 v226, v216, v217
    v_cvt_pk_bf16_f32 v227, v218, v219
    buffer_store_dwordx4 v[224:227], v1, s[36:39], s50 offen sc1
    v_add_f32 v220, v220, v152
    v_add_f32 v221, v221, v153
    v_add_f32 v222, v222, v154
    v_add_f32 v223, v223, v155
    s_mov_b32 exec_lo, 0x00010001
    s_mov_b32 exec_hi, 0x00010001
    buffer_store_dwordx4 v[220:223], v12, s[36:39], s51 offen sc1
    s_mov_b64 exec, -1
    v_mov_b32 v112, s42
    v_mov_b32 v113, s42
    v_mov_b32 v114, s42
    v_mov_b32 v115, s42
    v_bfe_u32 v116, v0, 2, 2
    v_lshrrev_b32 v117, 4, v0
    v_cmp_eq_u32 vcc, v116, v117
    v_and_b32 v116, 1, v0
    v_lshlrev_b32 v116, 4, v116
    v_mov_b32 v117, 0x3f80
    v_lshlrev_b32 v116, v116, v117
    v_cndmask_b32 v116, 0, v116, vcc
    v_and_b32 v117, 2, v0
    v_cmp_eq_u32 vcc, 0, v117
    v_mov_b32 v142, 0
    v_mov_b32 v143, 0
    v_mov_b32 v144, 0
    v_mov_b32 v145, 0
    v_cndmask_b32 v140, 0, v116, vcc
    v_cndmask_b32 v146, 0, v116, vcc
    v_cndmask_b32 v141, v116, v142, vcc
    v_cndmask_b32 v147, v116, v142, vcc
    v_mul_f32 v244, s43, v168
    v_mul_f32 v245, s43, v169
    v_mul_f32 v246, s43, v170
    v_mul_f32 v247, s43, v171
    v_mul_f32 v248, s43, v184
    v_mul_f32 v249, s43, v185
    v_mul_f32 v250, s43, v186
    v_mul_f32 v251, s43, v187
    v_exp_f32 v244, v244 clamp
    v_max_f32 v168, s42, v168
    v_exp_f32 v245, v245 clamp
    v_max_f32 v169, s42, v169
    v_exp_f32 v246, v246 clamp
    v_max_f32 v170, s42, v170
    v_exp_f32 v247, v247 clamp
    v_max_f32 v171, s42, v171
    v_exp_f32 v248, v248 clamp
    v_max_f32 v184, s42, v184
    v_exp_f32 v249, v249 clamp
    v_max_f32 v185, s42, v185
    v_exp_f32 v250, v250 clamp
    v_max_f32 v186, s42, v186
    v_exp_f32 v251, v251 clamp
    v_max_f32 v187, s42, v187
    v_add_f32 v244, v244, v168
    v_add_f32 v245, v245, v169
    v_add_f32 v246, v246, v170
    v_add_f32 v247, v247, v171
    v_add_f32 v248, v248, v184
    v_add_f32 v249, v249, v185
    v_add_f32 v250, v250, v186
    v_add_f32 v251, v251, v187
    v_cvt_pk_bf16_f32 v84, v244, v245
    v_cvt_pk_bf16_f32 v85, v246, v247
    v_cvt_pk_bf16_f32 v86, v248, v249
    v_cvt_pk_bf16_f32 v87, v250, v251
    v_mul_f32 v244, s43, v172
    v_mul_f32 v245, s43, v173
    v_mul_f32 v246, s43, v174
    v_mul_f32 v247, s43, v175
    v_mul_f32 v248, s43, v188
    v_mul_f32 v249, s43, v189
    v_mul_f32 v250, s43, v190
    v_mul_f32 v251, s43, v191
    v_exp_f32 v244, v244 clamp
    v_max_f32 v172, s42, v172
    v_exp_f32 v245, v245 clamp
    v_max_f32 v173, s42, v173
    v_exp_f32 v246, v246 clamp
    v_max_f32 v174, s42, v174
    v_exp_f32 v247, v247 clamp
    v_max_f32 v175, s42, v175
    v_exp_f32 v248, v248 clamp
    v_max_f32 v188, s42, v188
    v_exp_f32 v249, v249 clamp
    v_max_f32 v189, s42, v189
    v_exp_f32 v250, v250 clamp
    v_max_f32 v190, s42, v190
    v_exp_f32 v251, v251 clamp
    v_max_f32 v191, s42, v191
    v_add_f32 v244, v244, v172
    v_add_f32 v245, v245, v173
    v_add_f32 v246, v246, v174
    v_add_f32 v247, v247, v175
    v_add_f32 v248, v248, v188
    v_add_f32 v249, v249, v189
    v_add_f32 v250, v250, v190
    v_add_f32 v251, v251, v191
    v_cvt_pk_bf16_f32 v88, v244, v245
    v_cvt_pk_bf16_f32 v89, v246, v247
    v_cvt_pk_bf16_f32 v90, v248, v249
    v_cvt_pk_bf16_f32 v91, v250, v251
    v_mul_f32 v244, s43, v176
    v_mul_f32 v245, s43, v177
    v_mul_f32 v246, s43, v178
    v_mul_f32 v247, s43, v179
    v_mul_f32 v248, s43, v192
    v_mul_f32 v249, s43, v193
    v_mul_f32 v250, s43, v194
    v_mul_f32 v251, s43, v195
    v_exp_f32 v244, v244 clamp
    v_max_f32 v176, s42, v176
    v_exp_f32 v245, v245 clamp
    v_max_f32 v177, s42, v177
    v_exp_f32 v246, v246 clamp
    v_max_f32 v178, s42, v178
    v_exp_f32 v247, v247 clamp
    v_max_f32 v179, s42, v179
    v_exp_f32 v248, v248 clamp
    v_max_f32 v192, s42, v192
    v_exp_f32 v249, v249 clamp
    v_max_f32 v193, s42, v193
    v_exp_f32 v250, v250 clamp
    v_max_f32 v194, s42, v194
    v_exp_f32 v251, v251 clamp
    v_max_f32 v195, s42, v195
    v_add_f32 v244, v244, v176
    v_add_f32 v245, v245, v177
    v_add_f32 v246, v246, v178
    v_add_f32 v247, v247, v179
    v_add_f32 v248, v248, v192
    v_add_f32 v249, v249, v193
    v_add_f32 v250, v250, v194
    v_add_f32 v251, v251, v195
    v_cvt_pk_bf16_f32 v92, v244, v245
    v_cvt_pk_bf16_f32 v93, v246, v247
    v_cvt_pk_bf16_f32 v94, v248, v249
    v_cvt_pk_bf16_f32 v95, v250, v251
    s_mov_b32 s17, 1
    s_waitcnt vmcnt(0)
    s_atomic_add s17, s[10:11], 0 glc
    v_mul_f32 v244, s43, v180
    v_mul_f32 v245, s43, v181
    v_mul_f32 v246, s43, v182
    v_mul_f32 v247, s43, v183
    v_mul_f32 v248, s43, v196
    v_mul_f32 v249, s43, v197
    v_mul_f32 v250, s43, v198
    v_mul_f32 v251, s43, v199
    v_exp_f32 v244, v244 clamp
    v_max_f32 v180, s42, v180
    v_exp_f32 v245, v245 clamp
    v_max_f32 v181, s42, v181
    v_exp_f32 v246, v246 clamp
    v_max_f32 v182, s42, v182
    v_exp_f32 v247, v247 clamp
    v_max_f32 v183, s42, v183
    v_exp_f32 v248, v248 clamp
    v_max_f32 v196, s42, v196
    v_exp_f32 v249, v249 clamp
    v_max_f32 v197, s42, v197
    v_exp_f32 v250, v250 clamp
    v_max_f32 v198, s42, v198
    v_exp_f32 v251, v251 clamp
    v_max_f32 v199, s42, v199
    v_add_f32 v244, v244, v180
    v_add_f32 v245, v245, v181
    v_add_f32 v246, v246, v182
    v_add_f32 v247, v247, v183
    v_add_f32 v248, v248, v196
    v_add_f32 v249, v249, v197
    v_add_f32 v250, v250, v198
    v_add_f32 v251, v251, v199
    v_cvt_pk_bf16_f32 v96, v244, v245
    v_cvt_pk_bf16_f32 v97, v246, v247
    v_cvt_pk_bf16_f32 v98, v248, v249
    v_cvt_pk_bf16_f32 v99, v250, v251
    s_waitcnt lgkmcnt(0)
    s_cmp_ge_u32 s17, 15
    s_cbranch_scc1 F_P2_X
    s_mov_b32 s45, 0
F_P2:
    s_mov_b32 s17, 0
    s_atomic_add s17, s[10:11], 0 glc
    s_waitcnt lgkmcnt(0)
    s_cmp_ge_u32 s17, 16
    s_cbranch_scc1 F_P2_X
    s_sleep 3
    s_add_u32 s45, s45, 1
    s_cmp_lt_u32 s45, 400000
    s_cbranch_scc1 F_P2
F_P2_X:
    buffer_load_dwordx4 v[100:103], v13, s[36:39], s54 offen sc1
    s_lshl_b32 s59, s30, 12
    s_and_b32 s59, s59, 0x7fff
    s_add_u32 s40, s59, s53
    buffer_load_dwordx4 v[16:19], v1, s[36:39], s40 offen offset:0 sc1
    buffer_load_dwordx4 v[20:23], v1, s[36:39], s40 offen offset:2048 sc1
    s_add_u32 s59, s59, 4096
    s_and_b32 s59, s59, 0x7fff
    s_add_u32 s40, s59, s53
    buffer_load_dwordx4 v[24:27], v1, s[36:39], s40 offen offset:0 sc1
    buffer_load_dwordx4 v[28:31], v1, s[36:39], s40 offen offset:2048 sc1
    s_add_u32 s59, s59, 4096
    s_and_b32 s59, s59, 0x7fff
    s_add_u32 s40, s59, s53
    buffer_load_dwordx4 v[32:35], v1, s[36:39], s40 offen offset:0 sc1
    buffer_load_dwordx4 v[36:39], v1, s[36:39], s40 offen offset:2048 sc1
    s_add_u32 s59, s59, 4096
    s_and_b32 s59, s59, 0x7fff
    s_add_u32 s40, s59, s53
    buffer_load_dwordx4 v[40:43], v1, s[36:39], s40 offen offset:0 sc1
    buffer_load_dwordx4 v[44:47], v1, s[36:39], s40 offen offset:2048 sc1
    s_add_u32 s59, s59, 4096
    s_and_b32 s59, s59, 0x7fff
    s_add_u32 s40, s59, s53
    buffer_load_dwordx4 v[48:51], v1, s[36:39], s40 offen offset:0 sc1
    buffer_load_dwordx4 v[52:55], v1, s[36:39], s40 offen offset:2048 sc1
    s_add_u32 s59, s59, 4096
    s_and_b32 s59, s59, 0x7fff
    s_add_u32 s40, s59, s53
    buffer_load_dwordx4 v[56:59], v1, s[36:39], s40 offen offset:0 sc1
    buffer_load_dwordx4 v[60:63], v1, s[36:39], s40 offen offset:2048 sc1
    s_add_u32 s59, s59, 4096
    s_and_b32 s59, s59, 0x7fff
    s_add_u32 s40, s59, s53
    buffer_load_dwordx4 v[64:67], v1, s[36:39], s40 offen offset:0 sc1
    buffer_load_dwordx4 v[68:71], v1, s[36:39], s40 offen offset:2048 sc1
    s_add_u32 s59, s59, 4096
    s_and_b32 s59, s59, 0x7fff
    s_add_u32 s40, s59, s53
    buffer_load_dwordx4 v[72:75], v1, s[36:39], s40 offen offset:0 sc1
    buffer_load_dwordx4 v[76:79], v1, s[36:39], s40 offen offset:2048 sc1
    s_waitcnt vmcnt(14)
    v_mfma_f32_16x16x32_bf16 v[104:107], v[140:143], v[16:19], 0
    v_add_f32_dpp v120, v100, v100 row_ror:8 row_mask:0xf bank_mask:0xf
    v_mfma_f32_16x16x32_bf16 v[108:111], v[144:147], v[16:19], 0
    v_add_f32_dpp v121, v101, v101 row_ror:8 row_mask:0xf bank_mask:0xf
    v_mfma_f32_16x16x32_bf16 v[148:151], v[140:143], v[20:23], 0
    v_add_f32_dpp v122, v102, v102 row_ror:8 row_mask:0xf bank_mask:0xf
    v_mfma_f32_16x16x32_bf16 v[152:155], v[144:147], v[20:23], 0
    v_add_f32_dpp v123, v103, v103 row_ror:8 row_mask:0xf bank_mask:0xf
    s_waitcnt vmcnt(12)
    v_mfma_f32_16x16x32_bf16 v[104:107], v[140:143], v[24:27], v[104:107]
    v_add_f32_dpp v120, v120, v120 row_ror:4 row_mask:0xf bank_mask:0xf
    v_mfma_f32_16x16x32_bf16 v[108:111], v[144:147], v[24:27], v[108:111]
    v_add_f32_dpp v121, v121, v121 row_ror:4 row_mask:0xf bank_mask:0xf
    v_mfma_f32_16x16x32_bf16 v[148:151], v[140:143], v[28:31], v[148:151]
    v_add_f32_dpp v122, v122, v122 row_ror:4 row_mask:0xf bank_mask:0xf
    v_mfma_f32_16x16x32_bf16 v[152:155], v[144:147], v[28:31], v[152:155]
    v_add_f32_dpp v123, v123, v123 row_ror:4 row_mask:0xf bank_mask:0xf
    s_waitcnt vmcnt(10)
    v_mfma_f32_16x16x32_bf16 v[104:107], v[140:143], v[32:35], v[104:107]
    v_add_f32_dpp v120, v120, v120 row_ror:2 row_mask:0xf bank_mask:0xf
    v_mfma_f32_16x16x32_bf16 v[108:111], v[144:147], v[32:35], v[108:111]
    v_add_f32_dpp v121, v121, v121 row_ror:2 row_mask:0xf bank_mask:0xf
    v_mfma_f32_16x16x32_bf16 v[148:151], v[140:143], v[36:39], v[148:151]
    v_add_f32_dpp v122, v122, v122 row_ror:2 row_mask:0xf bank_mask:0xf
    v_mfma_f32_16x16x32_bf16 v[152:155], v[144:147], v[36:39], v[152:155]
    v_add_f32_dpp v123, v123, v123 row_ror:2 row_mask:0xf bank_mask:0xf
    s_waitcnt vmcnt(8)
    v_mfma_f32_16x16x32_bf16 v[104:107], v[140:143], v[40:43], v[104:107]
    v_add_f32_dpp v120, v120, v120 row_ror:1 row_mask:0xf bank_mask:0xf
    v_mfma_f32_16x16x32_bf16 v[108:111], v[144:147], v[40:43], v[108:111]
    v_add_f32_dpp v121, v121, v121 row_ror:1 row_mask:0xf bank_mask:0xf
    v_mfma_f32_16x16x32_bf16 v[148:151], v[140:143], v[44:47], v[148:151]
    v_add_f32_dpp v122, v122, v122 row_ror:1 row_mask:0xf bank_mask:0xf
    v_mfma_f32_16x16x32_bf16 v[152:155], v[144:147], v[44:47], v[152:155]
    v_add_f32_dpp v123, v123, v123 row_ror:1 row_mask:0xf bank_mask:0xf
    s_waitcnt vmcnt(6)
    v_mfma_f32_16x16x32_bf16 v[104:107], v[140:143], v[48:51], v[104:107]
    v_cvt_pk_bf16_f32 v132, v120, v121
    v_mfma_f32_16x16x32_bf16 v[108:111], v[144:147], v[48:51], v[108:111]
    v_cvt_pk_bf16_f32 v133, v122, v123
    v_mfma_f32_16x16x32_bf16 v[148:151], v[140:143], v[52:55], v[148:151]
    v_mfma_f32_16x16x32_bf16 v[152:155], v[144:147], v[52:55], v[152:155]
    s_waitcnt vmcnt(4)
    v_mfma_f32_16x16x32_bf16 v[104:107], v[140:143], v[56:59], v[104:107]
    v_mfma_f32_16x16x32_bf16 v[108:111], v[144:147], v[56:59], v[108:111]
    v_mfma_f32_16x16x32_bf16 v[148:151], v[140:143], v[60:63], v[148:151]
    v_mfma_f32_16x16x32_bf16 v[152:155], v[144:147], v[60:63], v[152:155]
    s_waitcnt vmcnt(2)
    v_mfma_f32_16x16x32_bf16 v[104:107], v[140:143], v[64:67], v[104:107]
    v_mfma_f32_16x16x32_bf16 v[108:111], v[144:147], v[64:67], v[108:111]
    v_mfma_f32_16x16x32_bf16 v[148:151], v[140:143], v[68:71], v[148:151]
    v_mfma_f32_16x16x32_bf16 v[152:155], v[144:147], v[68:71], v[152:155]
    s_waitcnt vmcnt(0)
    v_mfma_f32_16x16x32_bf16 v[104:107], v[140:143], v[72:75], v[104:107]
    v_mfma_f32_16x16x32_bf16 v[108:111], v[144:147], v[72:75], v[108:111]
    v_mfma_f32_16x16x32_bf16 v[148:151], v[140:143], v[76:79], v[148:151]
    v_mfma_f32_16x16x32_bf16 v[152:155], v[144:147], v[76:79], v[152:155]
    s_nop 6
    v_add_f32 v104, v104, v148
    v_add_f32 v105, v105, v149
    v_add_f32 v106, v106, v150
    v_add_f32 v107, v107, v151
    v_add_f32 v108, v108, v152
    v_add_f32 v109, v109, v153
    v_add_f32 v110, v110, v154
    v_add_f32 v111, v111, v155
F_K2X:
    v_cvt_pk_bf16_f32 v136, v104, v105
    v_cvt_pk_bf16_f32 v137, v106, v107
    v_cvt_pk_bf16_f32 v138, v108, v109
    v_cvt_pk_bf16_f32 v139, v110, v111
    ds_write_b128 v7, v[136:139]
    ds_write_b64 v9, v[132:133] offset:2048
    ds_write_b32 v10, v14 offset:4
F_XB:
    ds_read_b32 v15, v11 offset:4
    ds_read_b64 v[134:135], v8 offset:2048
    ds_read_b64 v[124:125], v200
    ds_read_b64 v[126:127], v201
    ds_read_b64 v[128:129], v202
    ds_read_b64 v[130:131], v203
    s_waitcnt lgkmcnt(0)
    v_cmp_ne_u32 vcc, 1, v15
    s_cbranch_vccnz F_XB
    v_mfma_f32_16x16x32_bf16 v[140:143], v[132:135], v[84:87], v[112:115]
    v_mfma_f32_16x16x32_bf16 v[144:147], v[132:135], v[88:91], v[112:115]
    v_mfma_f32_16x16x32_bf16 v[148:151], v[132:135], v[92:95], v[112:115]
    v_mfma_f32_16x16x32_bf16 v[152:155], v[132:135], v[96:99], v[112:115]
    v_mfma_f32_16x16x32_bf16 v[156:159], v[124:127], v[84:87], 0
    v_mfma_f32_16x16x32_bf16 v[160:163], v[128:131], v[84:87], 0
    v_mfma_f32_16x16x32_bf16 v[164:167], v[124:127], v[88:91], 0
    v_mfma_f32_16x16x32_bf16 v[168:171], v[128:131], v[88:91], 0
    v_mfma_f32_16x16x32_bf16 v[172:175], v[124:127], v[92:95], 0
    v_mfma_f32_16x16x32_bf16 v[176:179], v[128:131], v[92:95], 0
    v_mfma_f32_16x16x32_bf16 v[180:183], v[124:127], v[96:99], 0
    v_mfma_f32_16x16x32_bf16 v[184:187], v[128:131], v[96:99], 0
    ds_write_b32 v206, v14
    s_mov_b32 s17, 0
    s_atomic_add s17, s[14:15], 0 glc
    ds_read_b32 v10, v211
    v_rcp_f32 v140, v140
    v_rcp_f32 v144, v144
    v_rcp_f32 v148, v148
    v_rcp_f32 v152, v152
    v_mul_f32 v156, v156, v140
    v_mul_f32 v157, v157, v140
    v_mul_f32 v158, v158, v140
    v_mul_f32 v159, v159, v140
    v_mul_f32 v160, v160, v140
    v_mul_f32 v161, v161, v140
    v_mul_f32 v162, v162, v140
    v_mul_f32 v163, v163, v140
    v_cvt_pk_bf16_f32 v212, v156, v157
    v_cvt_pk_bf16_f32 v213, v158, v159
    v_cvt_pk_bf16_f32 v214, v160, v161
    v_cvt_pk_bf16_f32 v215, v162, v163
    buffer_store_dwordx4 v[212:215], v1, s[36:39], s52 offen sc1
    s_add_u32 s52, s52, 33792
    v_mul_f32 v164, v164, v144
    v_mul_f32 v165, v165, v144
    v_mul_f32 v166, v166, v144
    v_mul_f32 v167, v167, v144
    v_mul_f32 v168, v168, v144
    v_mul_f32 v169, v169, v144
    v_mul_f32 v170, v170, v144
    v_mul_f32 v171, v171, v144
    v_cvt_pk_bf16_f32 v216, v164, v165
    v_cvt_pk_bf16_f32 v217, v166, v167
    v_cvt_pk_bf16_f32 v218, v168, v169
    v_cvt_pk_bf16_f32 v219, v170, v171
    buffer_store_dwordx4 v[216:219], v1, s[36:39], s52 offen sc1
    s_add_u32 s52, s52, 33792
    v_mul_f32 v172, v172, v148
    v_mul_f32 v173, v173, v148
    v_mul_f32 v174, v174, v148
    v_mul_f32 v175, v175, v148
    v_mul_f32 v176, v176, v148
    v_mul_f32 v177, v177, v148
    v_mul_f32 v178, v178, v148
    v_mul_f32 v179, v179, v148
    v_cvt_pk_bf16_f32 v220, v172, v173
    v_cvt_pk_bf16_f32 v221, v174, v175
    v_cvt_pk_bf16_f32 v222, v176, v177
    v_cvt_pk_bf16_f32 v223, v178, v179
    buffer_store_dwordx4 v[220:223], v1, s[36:39], s52 offen sc1
    s_add_u32 s52, s52, 33792
    v_mul_f32 v180, v180, v152
    v_mul_f32 v181, v181, v152
    v_mul_f32 v182, v182, v152
    v_mul_f32 v183, v183, v152
    v_mul_f32 v184, v184, v152
    v_mul_f32 v185, v185, v152
    v_mul_f32 v186, v186, v152
    v_mul_f32 v187, v187, v152
    v_cvt_pk_bf16_f32 v224, v180, v181
    v_cvt_pk_bf16_f32 v225, v182, v183
    v_cvt_pk_bf16_f32 v226, v184, v185
    v_cvt_pk_bf16_f32 v227, v186, v187
    buffer_store_dwordx4 v[224:227], v1, s[36:39], s52 offen sc1
    v_add_u32 v6, 33792, v1
    s_mov_b32 s46, 0x11111111
    s_mov_b32 s50, -1
    s_mov_b32 s51, -1
    v_mov_b32 v16, 0
    v_mov_b32 v17, 0
    v_mov_b32 v18, 0
    v_mov_b32 v19, 0
    v_mov_b32 v20, 0
    v_mov_b32 v21, 0
    v_mov_b32 v22, 0
    v_mov_b32 v23, 0
    v_mov_b32 v24, 0
    v_mov_b32 v25, 0
    v_mov_b32 v26, 0
    v_mov_b32 v27, 0
    v_mov_b32 v28, 0
    v_mov_b32 v29, 0
    v_mov_b32 v30, 0
    v_mov_b32 v31, 0
    v_mov_b32 v32, 0
    v_mov_b32 v33, 0
    v_mov_b32 v34, 0
    v_mov_b32 v35, 0
    v_mov_b32 v36, 0
    v_mov_b32 v37, 0
    v_mov_b32 v38, 0
    v_mov_b32 v39, 0
    v_mov_b32 v40, 0
    v_mov_b32 v41, 0
    v_mov_b32 v42, 0
    v_mov_b32 v43, 0
    v_mov_b32 v44, 0
    v_mov_b32 v45, 0
    v_mov_b32 v46, 0
    v_mov_b32 v47, 0
    s_mov_b32 s47, 0
    s_mov_b32 s54, 0x76432105
    s_mov_b32 s44, 0
    s_mov_b32 s58, 0
    s_mov_b32 s18, 1
    s_branch F_GR0
.p2align 6
F_GLOOP:
    s_cmp_lt_i32 s50, 0
    s_cbranch_scc1 F_GE0
F_GC0:
F_GK0:
    s_waitcnt vmcnt(14) lgkmcnt(0)
    v_mfma_f32_16x16x32_bf16 v[16:19], v[48:51], v[80:83], v[16:19]
    ds_read_b64_tr_b16 v[64:65], v2 offset:4096
    ds_read_b64_tr_b16 v[66:67], v2 offset:6144
    v_mfma_f32_16x16x32_bf16 v[32:35], v[48:51], v[84:87], v[32:35]
    ds_read_b64_tr_b16 v[68:69], v3 offset:4096
    ds_read_b64_tr_b16 v[70:71], v3 offset:6144
    v_mfma_f32_16x16x32_bf16 v[20:23], v[52:55], v[80:83], v[20:23]
    ds_read_b64_tr_b16 v[72:73], v4 offset:4096
    ds_read_b64_tr_b16 v[74:75], v4 offset:6144
    v_mfma_f32_16x16x32_bf16 v[36:39], v[52:55], v[84:87], v[36:39]
    ds_read_b64_tr_b16 v[76:77], v5 offset:4096
    ds_read_b64_tr_b16 v[78:79], v5 offset:6144
    v_mfma_f32_16x16x32_bf16 v[24:27], v[56:59], v[80:83], v[24:27]
    v_mfma_f32_16x16x32_bf16 v[40:43], v[56:59], v[84:87], v[40:43]
    v_mfma_f32_16x16x32_bf16 v[28:31], v[60:63], v[80:83], v[28:31]
    v_mfma_f32_16x16x32_bf16 v[44:47], v[60:63], v[84:87], v[44:47]
    s_and_b32 s45, s46, s47
    s_cbranch_scc0 F_GP0
F_GQ0:
    s_waitcnt vmcnt(12) lgkmcnt(0)
    v_mfma_f32_16x16x32_bf16 v[16:19], v[64:67], v[88:91], v[16:19]
    ds_read_b64_tr_b16 v[48:49], v2 offset:8192
    ds_read_b64_tr_b16 v[50:51], v2 offset:10240
    s_and_b32 s45, s46, s47
    v_mfma_f32_16x16x32_bf16 v[32:35], v[64:67], v[92:95], v[32:35]
    ds_read_b64_tr_b16 v[52:53], v3 offset:8192
    ds_read_b64_tr_b16 v[54:55], v3 offset:10240
    s_cselect_b32 s66, s38, 0
    v_mfma_f32_16x16x32_bf16 v[20:23], v[68:71], v[88:91], v[20:23]
    ds_read_b64_tr_b16 v[56:57], v4 offset:8192
    ds_read_b64_tr_b16 v[58:59], v4 offset:10240
    s_ff1_i32_b32 s50, s45
    v_mfma_f32_16x16x32_bf16 v[36:39], v[68:71], v[92:95], v[36:39]
    ds_read_b64_tr_b16 v[60:61], v5 offset:8192
    ds_read_b64_tr_b16 v[62:63], v5 offset:10240
    s_lshl_b32 s52, s50, 10
    v_mfma_f32_16x16x32_bf16 v[24:27], v[72:75], v[88:91], v[24:27]
    s_add_u32 s52, s52, s55
    s_bitset0_b32 s46, s50
    v_mfma_f32_16x16x32_bf16 v[40:43], v[72:75], v[92:95], v[40:43]
    buffer_load_dwordx4 v[80:83], v1, s[64:67], s52 offen offset:0 sc1
    s_lshr_b32 s48, s54, s51
    v_mfma_f32_16x16x32_bf16 v[28:31], v[76:79], v[88:91], v[28:31]
    buffer_load_dwordx4 v[84:87], v6, s[64:67], s52 offen offset:0 sc1
    s_and_b32 s48, s48, 15
    v_mfma_f32_16x16x32_bf16 v[44:47], v[76:79], v[92:95], v[44:47]
    s_lshl_b32 s48, s48, 14
    s_waitcnt vmcnt(12) lgkmcnt(0)
    v_mfma_f32_16x16x32_bf16 v[16:19], v[48:51], v[96:99], v[16:19]
    ds_read_b64_tr_b16 v[64:65], v2 offset:12288
    ds_read_b64_tr_b16 v[66:67], v2 offset:14336
    v_mfma_f32_16x16x32_bf16 v[32:35], v[48:51], v[100:103], v[32:35]
    ds_read_b64_tr_b16 v[68:69], v3 offset:12288
    ds_read_b64_tr_b16 v[70:71], v3 offset:14336
    v_mfma_f32_16x16x32_bf16 v[20:23], v[52:55], v[96:99], v[20:23]
    ds_read_b64_tr_b16 v[72:73], v4 offset:12288
    ds_read_b64_tr_b16 v[74:75], v4 offset:14336
    v_mfma_f32_16x16x32_bf16 v[36:39], v[52:55], v[100:103], v[36:39]
    ds_read_b64_tr_b16 v[76:77], v5 offset:12288
    ds_read_b64_tr_b16 v[78:79], v5 offset:14336
    v_mfma_f32_16x16x32_bf16 v[24:27], v[56:59], v[96:99], v[24:27]
    buffer_load_dwordx4 v[88:91], v1, s[64:67], s52 offen offset:1024 sc1
    v_add_u32 v2, s48, v207
    v_mfma_f32_16x16x32_bf16 v[40:43], v[56:59], v[100:103], v[40:43]
    buffer_load_dwordx4 v[92:95], v6, s[64:67], s52 offen offset:1024 sc1
    v_xor_b32 v3, 32, v2
    v_mfma_f32_16x16x32_bf16 v[28:31], v[60:63], v[96:99], v[28:31]
    v_xor_b32 v4, 64, v2
    v_xor_b32 v5, 96, v2
    v_mfma_f32_16x16x32_bf16 v[44:47], v[60:63], v[100:103], v[44:47]
    s_waitcnt vmcnt(12) lgkmcnt(0)
    v_mfma_f32_16x16x32_bf16 v[16:19], v[64:67], v[104:107], v[16:19]
    ds_read_b64_tr_b16 v[48:49], v2 offset:0
    ds_read_b64_tr_b16 v[50:51], v2 offset:2048
    v_mfma_f32_16x16x32_bf16 v[32:35], v[64:67], v[108:111], v[32:35]
    ds_read_b64_tr_b16 v[52:53], v3 offset:0
    ds_read_b64_tr_b16 v[54:55], v3 offset:2048
    v_mfma_f32_16x16x32_bf16 v[20:23], v[68:71], v[104:107], v[20:23]
    ds_read_b64_tr_b16 v[56:57], v4 offset:0
    ds_read_b64_tr_b16 v[58:59], v4 offset:2048
    v_mfma_f32_16x16x32_bf16 v[36:39], v[68:71], v[108:111], v[36:39]
    ds_read_b64_tr_b16 v[60:61], v5 offset:0
    ds_read_b64_tr_b16 v[62:63], v5 offset:2048
    v_mfma_f32_16x16x32_bf16 v[24:27], v[72:75], v[104:107], v[24:27]
    buffer_load_dwordx4 v[96:99], v1, s[64:67], s52 offen offset:2048 sc1
    v_mfma_f32_16x16x32_bf16 v[40:43], v[72:75], v[108:111], v[40:43]
    buffer_load_dwordx4 v[100:103], v6, s[64:67], s52 offen offset:2048 sc1
    v_mfma_f32_16x16x32_bf16 v[28:31], v[76:79], v[104:107], v[28:31]
    v_mfma_f32_16x16x32_bf16 v[44:47], v[76:79], v[108:111], v[44:47]
    buffer_load_dwordx4 v[104:107], v1, s[64:67], s52 offen offset:3072 sc1
    buffer_load_dwordx4 v[108:111], v6, s[64:67], s52 offen offset:3072 sc1
    s_cmp_lt_i32 s51, 0
    s_cbranch_scc1 F_GE1
F_GC1:
F_GK1:
    s_waitcnt vmcnt(14) lgkmcnt(0)
    v_mfma_f32_16x16x32_bf16 v[16:19], v[48:51], v[112:115], v[16:19]
    ds_read_b64_tr_b16 v[64:65], v2 offset:4096
    ds_read_b64_tr_b16 v[66:67], v2 offset:6144
    v_mfma_f32_16x16x32_bf16 v[32:35], v[48:51], v[116:119], v[32:35]
    ds_read_b64_tr_b16 v[68:69], v3 offset:4096
    ds_read_b64_tr_b16 v[70:71], v3 offset:6144
    v_mfma_f32_16x16x32_bf16 v[20:23], v[52:55], v[112:115], v[20:23]
    ds_read_b64_tr_b16 v[72:73], v4 offset:4096
    ds_read_b64_tr_b16 v[74:75], v4 offset:6144
    v_mfma_f32_16x16x32_bf16 v[36:39], v[52:55], v[116:119], v[36:39]
    ds_read_b64_tr_b16 v[76:77], v5 offset:4096
    ds_read_b64_tr_b16 v[78:79], v5 offset:6144
    v_mfma_f32_16x16x32_bf16 v[24:27], v[56:59], v[112:115], v[24:27]
    v_mfma_f32_16x16x32_bf16 v[40:43], v[56:59], v[116:119], v[40:43]
    v_mfma_f32_16x16x32_bf16 v[28:31], v[60:63], v[112:115], v[28:31]
    v_mfma_f32_16x16x32_bf16 v[44:47], v[60:63], v[116:119], v[44:47]
    s_and_b32 s45, s46, s47
    s_cbranch_scc0 F_GP1
F_GQ1:
    s_waitcnt vmcnt(12) lgkmcnt(0)
    v_mfma_f32_16x16x32_bf16 v[16:19], v[64:67], v[120:123], v[16:19]
    ds_read_b64_tr_b16 v[48:49], v2 offset:8192
    ds_read_b64_tr_b16 v[50:51], v2 offset:10240
    s_and_b32 s45, s46, s47
    v_mfma_f32_16x16x32_bf16 v[32:35], v[64:67], v[124:127], v[32:35]
    ds_read_b64_tr_b16 v[52:53], v3 offset:8192
    ds_read_b64_tr_b16 v[54:55], v3 offset:10240
    s_cselect_b32 s66, s38, 0
    v_mfma_f32_16x16x32_bf16 v[20:23], v[68:71], v[120:123], v[20:23]
    ds_read_b64_tr_b16 v[56:57], v4 offset:8192
    ds_read_b64_tr_b16 v[58:59], v4 offset:10240
    s_ff1_i32_b32 s51, s45
    v_mfma_f32_16x16x32_bf16 v[36:39], v[68:71], v[124:127], v[36:39]
    ds_read_b64_tr_b16 v[60:61], v5 offset:8192
    ds_read_b64_tr_b16 v[62:63], v5 offset:10240
    s_lshl_b32 s53, s51, 10
    v_mfma_f32_16x16x32_bf16 v[24:27], v[72:75], v[120:123], v[24:27]
    s_add_u32 s53, s53, s55
    s_bitset0_b32 s46, s51
    v_mfma_f32_16x16x32_bf16 v[40:43], v[72:75], v[124:127], v[40:43]
    buffer_load_dwordx4 v[112:115], v1, s[64:67], s53 offen offset:0 sc1
    s_lshr_b32 s48, s54, s50
    v_mfma_f32_16x16x32_bf16 v[28:31], v[76:79], v[120:123], v[28:31]
    buffer_load_dwordx4 v[116:119], v6, s[64:67], s53 offen offset:0 sc1
    s_and_b32 s48, s48, 15
    v_mfma_f32_16x16x32_bf16 v[44:47], v[76:79], v[124:127], v[44:47]
    s_lshl_b32 s48, s48, 14
    s_waitcnt vmcnt(12) lgkmcnt(0)
    v_mfma_f32_16x16x32_bf16 v[16:19], v[48:51], v[128:131], v[16:19]
    ds_read_b64_tr_b16 v[64:65], v2 offset:12288
    ds_read_b64_tr_b16 v[66:67], v2 offset:14336
    v_mfma_f32_16x16x32_bf16 v[32:35], v[48:51], v[132:135], v[32:35]
    ds_read_b64_tr_b16 v[68:69], v3 offset:12288
    ds_read_b64_tr_b16 v[70:71], v3 offset:14336
    v_mfma_f32_16x16x32_bf16 v[20:23], v[52:55], v[128:131], v[20:23]
    ds_read_b64_tr_b16 v[72:73], v4 offset:12288
    ds_read_b64_tr_b16 v[74:75], v4 offset:14336
    v_mfma_f32_16x16x32_bf16 v[36:39], v[52:55], v[132:135], v[36:39]
    ds_read_b64_tr_b16 v[76:77], v5 offset:12288
    ds_read_b64_tr_b16 v[78:79], v5 offset:14336
    v_mfma_f32_16x16x32_bf16 v[24:27], v[56:59], v[128:131], v[24:27]
    buffer_load_dwordx4 v[120:123], v1, s[64:67], s53 offen offset:1024 sc1
    v_add_u32 v2, s48, v207
    v_mfma_f32_16x16x32_bf16 v[40:43], v[56:59], v[132:135], v[40:43]
    buffer_load_dwordx4 v[124:127], v6, s[64:67], s53 offen offset:1024 sc1
    v_xor_b32 v3, 32, v2
    v_mfma_f32_16x16x32_bf16 v[28:31], v[60:63], v[128:131], v[28:31]
    v_xor_b32 v4, 64, v2
    v_xor_b32 v5, 96, v2
    v_mfma_f32_16x16x32_bf16 v[44:47], v[60:63], v[132:135], v[44:47]
    s_waitcnt vmcnt(12) lgkmcnt(0)
    v_mfma_f32_16x16x32_bf16 v[16:19], v[64:67], v[136:139], v[16:19]
    ds_read_b64_tr_b16 v[48:49], v2 offset:0
    ds_read_b64_tr_b16 v[50:51], v2 offset:2048
    v_mfma_f32_16x16x32_bf16 v[32:35], v[64:67], v[140:143], v[32:35]
    ds_read_b64_tr_b16 v[52:53], v3 offset:0
    ds_read_b64_tr_b16 v[54:55], v3 offset:2048
    v_mfma_f32_16x16x32_bf16 v[20:23], v[68:71], v[136:139], v[20:23]
    ds_read_b64_tr_b16 v[56:57], v4 offset:0
    ds_read_b64_tr_b16 v[58:59], v4 offset:2048
    v_mfma_f32_16x16x32_bf16 v[36:39], v[68:71], v[140:143], v[36:39]
    ds_read_b64_tr_b16 v[60:61], v5 offset:0
    ds_read_b64_tr_b16 v[62:63], v5 offset:2048
    v_mfma_f32_16x16x32_bf16 v[24:27], v[72:75], v[136:139], v[24:27]
    buffer_load_dwordx4 v[128:131], v1, s[64:67], s53 offen offset:2048 sc1
    v_mfma_f32_16x16x32_bf16 v[40:43], v[72:75], v[140:143], v[40:43]
    buffer_load_dwordx4 v[132:135], v6, s[64:67], s53 offen offset:2048 sc1
    v_mfma_f32_16x16x32_bf16 v[28:31], v[76:79], v[136:139], v[28:31]
    v_mfma_f32_16x16x32_bf16 v[44:47], v[76:79], v[140:143], v[44:47]
    buffer_load_dwordx4 v[136:139], v1, s[64:67], s53 offen offset:3072 sc1
    buffer_load_dwordx4 v[140:143], v6, s[64:67], s53 offen offset:3072 sc1
    s_add_u32 s44, s44, 1
    s_cmp_lt_u32 s44, 4
    s_cbranch_scc1 F_GLOOP
    s_add_u32 s57, s56, 65536
    s_waitcnt lgkmcnt(0)
    v_cvt_pk_bf16_f32 v48, v16, v17
    v_cvt_pk_bf16_f32 v49, v18, v19
    v_cvt_pk_bf16_f32 v50, v20, v21
    v_cvt_pk_bf16_f32 v51, v22, v23
    v_cvt_pk_bf16_f32 v52, v24, v25
    v_cvt_pk_bf16_f32 v53, v26, v27
    v_cvt_pk_bf16_f32 v54, v28, v29
    v_cvt_pk_bf16_f32 v55, v30, v31
    v_cvt_pk_bf16_f32 v56, v32, v33
    v_cvt_pk_bf16_f32 v57, v34, v35
    v_cvt_pk_bf16_f32 v58, v36, v37
    v_cvt_pk_bf16_f32 v59, v38, v39
    v_cvt_pk_bf16_f32 v60, v40, v41
    v_cvt_pk_bf16_f32 v61, v42, v43
    v_cvt_pk_bf16_f32 v62, v44, v45
    v_cvt_pk_bf16_f32 v63, v46, v47
    v_permlane16_swap_b32 v48, v50
    v_permlane16_swap_b32 v49, v51
    buffer_store_dwordx4 v[48:51], v210, s[60:63], s56 offen offset:0 sc1
    v_permlane16_swap_b32 v52, v54
    v_permlane16_swap_b32 v53, v55
    buffer_store_dwordx4 v[52:55], v210, s[60:63], s56 offen offset:64 sc1
    v_permlane16_swap_b32 v56, v58
    v_permlane16_swap_b32 v57, v59
    buffer_store_dwordx4 v[56:59], v210, s[60:63], s57 offen offset:0 sc1
    v_permlane16_swap_b32 v60, v62
    v_permlane16_swap_b32 v61, v63
    buffer_store_dwordx4 v[60:63], v210, s[60:63], s57 offen offset:64 sc1
    s_endpgm
F_CNB0:
    ds_write_b32 v204, v14 offset:32
F_WS15:
    ds_read_b32 v15, v209 offset:128
    s_waitcnt lgkmcnt(0)
    v_cmp_ne_u32 vcc, 1, v15
    s_cbranch_vccz F_WS15_X
    s_branch F_WS15
F_WS15_X:
    s_branch F_CB0
F_CNB1:
    ds_write_b32 v204, v14
    s_branch F_CB1
F_GP0:
    s_cmp_eq_u32 s46, 0
    s_cbranch_scc1 F_GQ0
    s_cmp_lt_i32 s51, 0
    s_cbranch_scc1 F_GQ0
    s_mov_b32 s17, 0
    s_atomic_add s17, s[14:15], 0 glc
    ds_read_b32 v10, v211
    s_waitcnt lgkmcnt(0)
    v_cmp_ne_u32 s[40:41], 1, v10
    s_lshr_b32 s17, s17, 2
    s_or_b32 s45, s40, s41
    s_lshr_b32 s40, s45, 1
    s_or_b32 s45, s45, s40
    s_lshr_b32 s40, s45, 2
    s_or_b32 s45, s45, s40
    s_andn2_b32 s47, s17, s45
    s_cmp_gt_u32 s58, 400000
    s_cselect_b32 s47, -1, s47
    s_and_b32 s47, s47, s46
    s_branch F_GQ0
F_GS0:
    s_cmp_eq_u32 s18, 0
    s_cbranch_scc1 F_GT0
    s_waitcnt vmcnt(0)
    s_atomic_add s16, s[12:13], 0
    s_mov_b32 s18, 0
F_GT0:
    s_sleep 6
F_GE0:
    s_add_u32 s58, s58, 1
    s_mov_b32 s17, 0
    s_atomic_add s17, s[14:15], 0 glc
    ds_read_b32 v10, v211
F_GR0:
    s_waitcnt lgkmcnt(0)
    v_cmp_ne_u32 s[40:41], 1, v10
    s_lshr_b32 s17, s17, 2
    s_or_b32 s45, s40, s41
    s_lshr_b32 s40, s45, 1
    s_or_b32 s45, s45, s40
    s_lshr_b32 s40, s45, 2
    s_or_b32 s45, s45, s40
    s_andn2_b32 s47, s17, s45
    s_cmp_gt_u32 s58, 400000
    s_cselect_b32 s47, -1, s47
    s_and_b32 s47, s47, s46
    s_cbranch_scc0 F_GS0
    s_and_b32 s45, s46, s47
    s_cselect_b32 s66, s38, 0
    s_ff1_i32_b32 s50, s45
    s_bitset0_b32 s46, s50
    s_lshl_b32 s52, s50, 10
    s_add_u32 s52, s52, s55
    buffer_load_dwordx4 v[80:83], v1, s[36:39], s52 offen offset:0 sc1
    buffer_load_dwordx4 v[84:87], v6, s[36:39], s52 offen offset:0 sc1
    buffer_load_dwordx4 v[88:91], v1, s[36:39], s52 offen offset:1024 sc1
    buffer_load_dwordx4 v[92:95], v6, s[36:39], s52 offen offset:1024 sc1
    buffer_load_dwordx4 v[96:99], v1, s[36:39], s52 offen offset:2048 sc1
    buffer_load_dwordx4 v[100:103], v6, s[36:39], s52 offen offset:2048 sc1
    buffer_load_dwordx4 v[104:107], v1, s[36:39], s52 offen offset:3072 sc1
    buffer_load_dwordx4 v[108:111], v6, s[36:39], s52 offen offset:3072 sc1
    s_cmp_eq_u32 s18, 0
    s_cbranch_scc1 F_GU
    s_waitcnt vmcnt(8)
    s_atomic_add s16, s[12:13], 0
    s_mov_b32 s18, 0
F_GU:
    s_lshr_b32 s48, s54, s50
    s_and_b32 s48, s48, 15
    s_lshl_b32 s48, s48, 14
    v_add_u32 v2, s48, v207
    v_xor_b32 v3, 32, v2
    v_xor_b32 v4, 64, v2
    v_xor_b32 v5, 96, v2
    ds_read_b64_tr_b16 v[48:49], v2 offset:0
    ds_read_b64_tr_b16 v[50:51], v2 offset:2048
    ds_read_b64_tr_b16 v[52:53], v3 offset:0
    ds_read_b64_tr_b16 v[54:55], v3 offset:2048
    ds_read_b64_tr_b16 v[56:57], v4 offset:0
    ds_read_b64_tr_b16 v[58:59], v4 offset:2048
    ds_read_b64_tr_b16 v[60:61], v5 offset:0
    ds_read_b64_tr_b16 v[62:63], v5 offset:2048
    s_cmp_lt_i32 s51, 0
    s_cbranch_scc0 F_GN0
    s_and_b32 s45, s46, s47
    s_cselect_b32 s66, s38, 0
    s_ff1_i32_b32 s51, s45
    s_bitset0_b32 s46, s51
    s_lshl_b32 s53, s51, 10
    s_add_u32 s53, s53, s55
    buffer_load_dwordx4 v[112:115], v1, s[64:67], s53 offen offset:0 sc1
    buffer_load_dwordx4 v[116:119], v6, s[64:67], s53 offen offset:0 sc1
    buffer_load_dwordx4 v[120:123], v1, s[64:67], s53 offen offset:1024 sc1
    buffer_load_dwordx4 v[124:127], v6, s[64:67], s53 offen offset:1024 sc1
    buffer_load_dwordx4 v[128:131], v1, s[64:67], s53 offen offset:2048 sc1
    buffer_load_dwordx4 v[132:135], v6, s[64:67], s53 offen offset:2048 sc1
    buffer_load_dwordx4 v[136:139], v1, s[64:67], s53 offen offset:3072 sc1
    buffer_load_dwordx4 v[140:143], v6, s[64:67], s53 offen offset:3072 sc1
    s_branch F_GC0
F_GN0:
    s_waitcnt vmcnt(0)
    s_branch F_GC0
F_GP1:
    s_cmp_eq_u32 s46, 0
    s_cbranch_scc1 F_GQ1
    s_cmp_lt_i32 s50, 0
    s_cbranch_scc1 F_GQ1
    s_mov_b32 s17, 0
    s_atomic_add s17, s[14:15], 0 glc
    ds_read_b32 v10, v211
    s_waitcnt lgkmcnt(0)
    v_cmp_ne_u32 s[40:41], 1, v10
    s_lshr_b32 s17, s17, 2
    s_or_b32 s45, s40, s41
    s_lshr_b32 s40, s45, 1
    s_or_b32 s45, s45, s40
    s_lshr_b32 s40, s45, 2
    s_or_b32 s45, s45, s40
    s_andn2_b32 s47, s17, s45
    s_cmp_gt_u32 s58, 400000
    s_cselect_b32 s47, -1, s47
    s_and_b32 s47, s47, s46
    s_branch F_GQ1
F_GS1:
    s_cmp_eq_u32 s18, 0
    s_cbranch_scc1 F_GT1
    s_waitcnt vmcnt(0)
    s_atomic_add s16, s[12:13], 0
    s_mov_b32 s18, 0
F_GT1:
    s_sleep 6
F_GE1:
    s_add_u32 s58, s58, 1
    s_mov_b32 s17, 0
    s_atomic_add s17, s[14:15], 0 glc
    ds_read_b32 v10, v211
F_GR1:
    s_waitcnt lgkmcnt(0)
    v_cmp_ne_u32 s[40:41], 1, v10
    s_lshr_b32 s17, s17, 2
    s_or_b32 s45, s40, s41
    s_lshr_b32 s40, s45, 1
    s_or_b32 s45, s45, s40
    s_lshr_b32 s40, s45, 2
    s_or_b32 s45, s45, s40
    s_andn2_b32 s47, s17, s45
    s_cmp_gt_u32 s58, 400000
    s_cselect_b32 s47, -1, s47
    s_and_b32 s47, s47, s46
    s_cbranch_scc0 F_GS1
    s_and_b32 s45, s46, s47
    s_cselect_b32 s66, s38, 0
    s_ff1_i32_b32 s51, s45
    s_bitset0_b32 s46, s51
    s_lshl_b32 s53, s51, 10
    s_add_u32 s53, s53, s55
    buffer_load_dwordx4 v[112:115], v1, s[36:39], s53 offen offset:0 sc1
    buffer_load_dwordx4 v[116:119], v6, s[36:39], s53 offen offset:0 sc1
    buffer_load_dwordx4 v[120:123], v1, s[36:39], s53 offen offset:1024 sc1
    buffer_load_dwordx4 v[124:127], v6, s[36:39], s53 offen offset:1024 sc1
    buffer_load_dwordx4 v[128:131], v1, s[36:39], s53 offen offset:2048 sc1
    buffer_load_dwordx4 v[132:135], v6, s[36:39], s53 offen offset:2048 sc1
    buffer_load_dwordx4 v[136:139], v1, s[36:39], s53 offen offset:3072 sc1
    buffer_load_dwordx4 v[140:143], v6, s[36:39], s53 offen offset:3072 sc1
    s_lshr_b32 s48, s54, s51
    s_and_b32 s48, s48, 15
    s_lshl_b32 s48, s48, 14
    v_add_u32 v2, s48, v207
    v_xor_b32 v3, 32, v2
    v_xor_b32 v4, 64, v2
    v_xor_b32 v5, 96, v2
    ds_read_b64_tr_b16 v[48:49], v2 offset:0
    ds_read_b64_tr_b16 v[50:51], v2 offset:2048
    ds_read_b64_tr_b16 v[52:53], v3 offset:0
    ds_read_b64_tr_b16 v[54:55], v3 offset:2048
    ds_read_b64_tr_b16 v[56:57], v4 offset:0
    ds_read_b64_tr_b16 v[58:59], v4 offset:2048
    ds_read_b64_tr_b16 v[60:61], v5 offset:0
    ds_read_b64_tr_b16 v[62:63], v5 offset:2048
    s_cmp_lt_i32 s50, 0
    s_cbranch_scc0 F_GN1
    s_and_b32 s45, s46, s47
    s_cselect_b32 s66, s38, 0
    s_ff1_i32_b32 s50, s45
    s_bitset0_b32 s46, s50
    s_lshl_b32 s52, s50, 10
    s_add_u32 s52, s52, s55
    buffer_load_dwordx4 v[80:83], v1, s[64:67], s52 offen offset:0 sc1
    buffer_load_dwordx4 v[84:87], v6, s[64:67], s52 offen offset:0 sc1
    buffer_load_dwordx4 v[88:91], v1, s[64:67], s52 offen offset:1024 sc1
    buffer_load_dwordx4 v[92:95], v6, s[64:67], s52 offen offset:1024 sc1
    buffer_load_dwordx4 v[96:99], v1, s[64:67], s52 offen offset:2048 sc1
    buffer_load_dwordx4 v[100:103], v6, s[64:67], s52 offen offset:2048 sc1
    buffer_load_dwordx4 v[104:107], v1, s[64:67], s52 offen offset:3072 sc1
    buffer_load_dwordx4 v[108:111], v6, s[64:67], s52 offen offset:3072 sc1
    s_branch F_GC1
F_GN1:
    s_waitcnt vmcnt(0)
    s_branch F_GC1
F_END:
    s_endpgm

.section .rodata,"a"
.p2align 6
.amdhsa_kernel concat_heads__linear_attn_block__ssm_conv_h3__prompt_kernel
  .amdhsa_next_free_vgpr 256
  .amdhsa_next_free_sgpr 102
  .amdhsa_accum_offset 256
  .amdhsa_group_segment_fixed_size 0
  .amdhsa_kernarg_size 96
  .amdhsa_user_sgpr_count 2
  .amdhsa_user_sgpr_kernarg_segment_ptr 1
  .amdhsa_system_sgpr_workgroup_id_x 1
  .amdhsa_float_denorm_mode_32 3
  .amdhsa_float_denorm_mode_16_64 3
.end_amdhsa_kernel
```
